```python
import torch

def _softmax(x, axis=-1):
    return torch.softmax(x, dim=axis)
def _gelu(x):
    return torch.nn.functional.gelu(x, approximate="tanh")
def _silu(x):
    return torch.nn.functional.silu(x)
def _sigmoid(x):
    return torch.sigmoid(x)
def _layernorm(x, axis=-1, eps=1e-5):
    m = x.mean(dim=axis, keepdim=True)
    v = x.var(dim=axis, keepdim=True, unbiased=False)
    return (x - m) / torch.sqrt(v + eps)
def _scatter_add(tgt, idx, src, axis=0):
    return tgt.clone().index_add_(axis, idx, src)
def _segment_sum(src, seg, n):
    out = torch.zeros((n,) + src.shape[1:], dtype=src.dtype)
    return out.index_add_(0, seg, src)
def _pad(x, pw):
    flat = tuple(v for pair in reversed(pw) for v in pair)
    return torch.nn.functional.pad(x, flat)

kernel_name = 'recurrent_scan__linear_kernel_hedgehog__moe_arch_mod__prompt'

def setup_inputs():

    _w = (lambda a: (lambda t: t.to(torch.bfloat16) if t.is_floating_point() else t)(torch.as_tensor(a)))
    def _A_setup():
        B, S, D, H = 1, 2048, 1024, 32
        Dh = D // H
        return {
            "x": _w((lambda *s: torch.randn(*s, dtype=torch.bfloat16) * 0.05)(B, S, D)),
            "wqkv": _w((lambda *s: torch.randn(*s, dtype=torch.bfloat16) * 0.2)(D, 3 * D)),
            "w_phi": _w((lambda *s: torch.randn(*s, dtype=torch.bfloat16) * 0.2)(H, Dh, Dh) * (Dh ** -0.5)),
            "wo": _w((lambda *s: torch.randn(*s, dtype=torch.bfloat16) * 0.05)(D, D)),
        }
    _A_in = _A_setup()

    def _B_setup():
        B, S, D, F, C = 1, 2048, 1024, 3584, 1
        return {
            "x": _w((lambda *s: torch.randn(*s, dtype=torch.bfloat16) * 0.05)(B, S, D)),
            "w_r": _w((lambda *s: torch.randn(*s, dtype=torch.bfloat16) * 0.05)(D)),
            "w_gate": _w((lambda *s: torch.randn(*s, dtype=torch.bfloat16) * 0.05)(D, F)),
            "w_up": _w((lambda *s: torch.randn(*s, dtype=torch.bfloat16) * 0.05)(D, F)),
            "w_down": _w((lambda *s: torch.randn(*s, dtype=torch.bfloat16) * 0.05)(F, D)),
        }
    _B_in = _B_setup()

    return {
        "A_x": _A_in["x"],
        "A_wqkv": _A_in["wqkv"],
        "A_w_phi": _A_in["w_phi"],
        "A_wo": _A_in["wo"],
        "B_x": _B_in["x"],
        "B_w_r": _B_in["w_r"],
        "B_w_gate": _B_in["w_gate"],
        "B_w_up": _B_in["w_up"],
        "B_w_down": _B_in["w_down"],
    }

def reference(A_x, A_wqkv, A_w_phi, A_wo, B_x, B_w_r, B_w_gate, B_w_up, B_w_down):
    def _A_ref(x, wqkv, w_phi, wo):
        B, S, D = x.shape
        H = 32; Dh = D // H
        qkv = (lambda x, *d: x.permute(*d))((x @ wqkv).reshape(B, S, 3, H, Dh), 2, 0, 3, 1, 4)
        q, k, v = qkv[0], qkv[1], qkv[2]
        pq = torch.einsum("bhsd,hdf->bhsf", q, w_phi)
        pk = torch.einsum("bhsd,hdf->bhsf", k, w_phi)
        phi_q = torch.concatenate([_softmax(pq, axis=-1), _softmax(-pq, axis=-1)], axis=-1)
        phi_k = torch.concatenate([_softmax(pk, axis=-1), _softmax(-pk, axis=-1)], axis=-1)
        kv = torch.einsum("bhsf,bhsd->bhfd", phi_k, v)
        z  = torch.einsum("bhsf->bhf", phi_k)
        num = torch.einsum("bhqf,bhfd->bhqd", phi_q, kv)
        den = torch.einsum("bhqf,bhf->bhq", phi_q, z)[..., None] + 1e-6
        o = num / den
        return (lambda x, *d: x.permute(*d))(o, 0, 2, 1, 3).reshape(B, S, D) @ wo

    def _B_ref(x, w_r, w_gate, w_up, w_down):
        B, S, D = x.shape
        C = 1
        r = x @ w_r
        idx = torch.argsort(-r, axis=-1)[:, :C]
        idx_e = (lambda x, n, axis: torch.repeat_interleave(x, n, dim=axis))(idx.reshape(B, C, 1), D, axis=2)
        x_sel = (lambda x, i, axis: torch.take_along_dim(x, i, dim=axis))(x, idx_e, axis=1)
        g = _silu(x_sel @ w_gate)
        u = x_sel @ w_up
        y = (g * u) @ w_down
        r_sel = _sigmoid((lambda x, i, axis: torch.take_along_dim(x, i, dim=axis))(r, idx, axis=1))
        y = y * r_sel.reshape(B, C, 1)
        b_off = (torch.arange(B) * S).reshape(B, 1)
        flat_idx = (idx + b_off).reshape(B * C)
        zero = (x * 0.0).reshape(B * S, D)
        upd = _scatter_add(zero, flat_idx, y.reshape(B * C, D), axis=0)
        return x + upd.reshape(B, S, D)

    x = A_x
    xn = _layernorm(x, axis=-1)
    s = _A_ref(xn, A_wqkv, A_w_phi, A_wo)
    g = _silu(_B_ref(xn, B_w_r, B_w_gate, B_w_up, B_w_down))
    return x + s * g
```

```asm
; @launch grid=(256,1,1) block=(512,1,1) lds=163840
.amdgcn_target "amdgcn-amd-amdhsa--gfx950"
.text
.globl recurrent_scan__linear_kernel_hedgehog__moe_arch_mod__prompt_kernel
.p2align 8
.type recurrent_scan__linear_kernel_hedgehog__moe_arch_mod__prompt_kernel,@function
recurrent_scan__linear_kernel_hedgehog__moe_arch_mod__prompt_kernel:
    s_cmp_ge_u32 s2, 256
    s_cbranch_scc1 L_done
    s_load_dwordx16 s[40:55], s[0:1], 0
    s_load_dwordx8 s[56:63], s[0:1], 64
    v_and_b32 v1, 63, v0
    v_lshrrev_b32 v2, 6, v0
    s_nop 0
    v_readfirstlane_b32 s38, v2
    s_and_b32 s65, s2, 1
    s_bfe_u32 s66, s2, 0x30003
    s_bfe_u32 s67, s2, 0x20001
    s_lshl_b32 s67, s67, 2
    s_lshl_b32 s36, s65, 3
    s_add_u32 s36, s36, s66
    s_lshr_b32 s3, s2, 6
    s_add_u32 s37, s67, s3
    s_lshl_b32 s39, s66, 1
    s_add_u32 s39, s39, s65
    s_add_u32 s39, s39, s67
    s_and_b32 s39, s39, 15
    s_cmp_lt_u32 s38, 4
    s_cbranch_scc1 L_g1
    s_sub_u32 s38, s38, 4
    s_lshl_b32 s3, s38, 4
    v_lshrrev_b32 v7, 3, v1
    v_add_u32 v3, s3, v7
    v_mul_u32_u24 v3, 6144, v3
    s_lshl_b32 s3, s37, 7
    v_add_u32 v3, s3, v3
    v_and_b32 v6, 7, v1
    v_bfe_u32 v5, v1, 4, 1
    v_lshlrev_b32 v5, 1, v5
    v_xor_b32 v5, v6, v5
    v_lshl_add_u32 v16, v5, 4, v3
    v_xor_b32 v5, 4, v5
    v_lshl_add_u32 v5, v5, 4, v3
    v_add_u32 v17, 48128, v5
    v_add_u32 v12, 2048, v16
    v_add_u32 v13, 2048, v17
    v_add_u32 v14, 4096, v16
    v_add_u32 v15, 4096, v17
    s_lshl_b32 s3, s36, 7
    s_lshl_b32 s65, s38, 5
    s_add_u32 s3, s3, s65
    v_add_u32 v3, s3, v7
    v_lshlrev_b32 v3, 11, v3
    v_lshrrev_b32 v5, 4, v1
    v_xor_b32 v6, v6, v5
    v_xor_b32 v5, 4, v6
    v_lshl_add_u32 v8, v6, 4, v3
    v_lshl_add_u32 v5, v5, 4, v3
    v_add_u32 v9, 15360, v5
    v_add_u32 v10, 30720, v8
    v_add_u32 v11, 46080, v5
    s_lshl_b32 s72, s38, 12
    s_lshl_b32 s73, s38, 11
    s_lshl_b32 s74, s39, 7
    s_mul_i32 s75, s39, 393216
    s_mov_b32 s76, s75
    s_waitcnt lgkmcnt(0)
    s_mov_b32 s8, s42
    s_mov_b32 s9, s43
    s_mov_b32 s10, 6291456
    s_mov_b32 s11, 0x00020000
    s_mov_b32 s4, s40
    s_mov_b32 s5, s41
    s_mov_b32 s6, 4194304
    s_mov_b32 s7, 0x00020000
    s_add_u32 m0, s73, 65536
    s_nop 0
    buffer_load_dwordx4 v12, s[8:11], s75 offen offset:0 nt lds
    buffer_load_dwordx4 v13, s[8:11], s75 offen offset:1024 nt lds
    s_add_u32 m0, s73, 73728
    s_nop 0
    buffer_load_dwordx4 v14, s[8:11], s75 offen offset:0 nt lds
    buffer_load_dwordx4 v15, s[8:11], s75 offen offset:1024 nt lds
    s_add_u32 s75, s75, 393216
    s_cmp_eq_u32 s75, 6291456
    s_cselect_b32 s75, 0, s75
    s_add_u32 m0, s72, 0
    s_nop 0
    buffer_load_dwordx4 v8, s[4:7], s74 offen offset:0  lds
    buffer_load_dwordx4 v9, s[4:7], s74 offen offset:1024  lds
    buffer_load_dwordx4 v10, s[4:7], s74 offen offset:2048  lds
    buffer_load_dwordx4 v11, s[4:7], s74 offen offset:3072  lds
    s_add_u32 s74, s74, 128
    s_and_b32 s74, s74, 2047
    s_add_u32 m0, s73, 81920
    s_nop 0
    buffer_load_dwordx4 v12, s[8:11], s75 offen offset:0 nt lds
    buffer_load_dwordx4 v13, s[8:11], s75 offen offset:1024 nt lds
    s_add_u32 m0, s73, 90112
    s_nop 0
    buffer_load_dwordx4 v14, s[8:11], s75 offen offset:0 nt lds
    buffer_load_dwordx4 v15, s[8:11], s75 offen offset:1024 nt lds
    s_add_u32 s75, s75, 393216
    s_cmp_eq_u32 s75, 6291456
    s_cselect_b32 s75, 0, s75
    v_lshlrev_b32 v3, 4, v1
    s_mov_b32 s12, s62
    s_mov_b32 s13, s63
    s_mov_b32 s14, 268435456
    s_mov_b32 s15, 0x00020000
    s_mov_b32 s16, s60
    s_mov_b32 s17, s61
    s_mov_b32 s18, 256
    s_mov_b32 s19, 0x00020000
    s_mov_b32 s20, s44
    s_mov_b32 s21, s45
    s_mov_b32 s22, 65536
    s_mov_b32 s23, 0x00020000
    v_mov_b32 v20, 0x3f803f80
    v_mov_b32 v21, 0x3f803f80
    v_mov_b32 v22, 0x3f803f80
    v_mov_b32 v23, 0x3f803f80
    v_lshrrev_b32 v5, 4, v1
    v_lshlrev_b32 v4, 3, v5
    v_bfe_u32 v6, v1, 2, 2
    v_add_u32 v4, v4, v6
    v_lshlrev_b32 v4, 7, v4
    v_bfe_u32 v6, v1, 3, 2
    v_xor_b32 v6, s38, v6
    v_and_b32 v5, 3, v1
    v_lshl_add_u32 v4, v5, 3, v4
    v_lshl_add_u32 v19, v6, 5, v4
    v_add_u32 v19, 65536, v19
    s_and_b32 s30, s2, 7
    s_lshl_b32 s30, s30, 1
    s_bfe_u32 s3, s2, 0x10003
    s_add_u32 s30, s30, s3
    s_lshr_b32 s31, s2, 4
    s_mov_b32 s70, 0
    s_waitcnt vmcnt(4)
    s_barrier
    s_add_u32 m0, s72, 16384
    s_nop 0
    buffer_load_dwordx4 v8, s[4:7], s74 offen offset:0  lds
    buffer_load_dwordx4 v9, s[4:7], s74 offen offset:1024  lds
    buffer_load_dwordx4 v10, s[4:7], s74 offen offset:2048  lds
    buffer_load_dwordx4 v11, s[4:7], s74 offen offset:3072  lds
    s_add_u32 s74, s74, 128
    s_and_b32 s74, s74, 2047
    s_add_u32 m0, s73, 98304
    s_nop 0
    buffer_load_dwordx4 v12, s[8:11], s75 offen offset:0 nt lds
    buffer_load_dwordx4 v13, s[8:11], s75 offen offset:1024 nt lds
    s_add_u32 m0, s73, 106496
    s_nop 0
    buffer_load_dwordx4 v14, s[8:11], s75 offen offset:0 nt lds
    buffer_load_dwordx4 v15, s[8:11], s75 offen offset:1024 nt lds
    s_add_u32 s75, s75, 393216
    s_cmp_eq_u32 s75, 6291456
    s_cselect_b32 s75, 0, s75
    ds_read_b64_tr_b16 v[36:37], v19 offset:0
    ds_read_b64_tr_b16 v[38:39], v19 offset:512
    ds_read_b64_tr_b16 v[40:41], v19 offset:4096
    ds_read_b64_tr_b16 v[42:43], v19 offset:4608
    ds_read_b64_tr_b16 v[44:45], v19 offset:8192
    ds_read_b64_tr_b16 v[46:47], v19 offset:8704
    ds_read_b64_tr_b16 v[48:49], v19 offset:12288
    ds_read_b64_tr_b16 v[50:51], v19 offset:12800
    s_waitcnt lgkmcnt(0)
    v_mfma_f32_16x16x32_bf16 v[28:31], v[20:23], v[36:39], 0
    v_mfma_f32_16x16x32_bf16 v[32:35], v[20:23], v[44:47], 0
    v_mfma_f32_16x16x32_bf16 v[28:31], v[20:23], v[40:43], v[28:31]
    v_mfma_f32_16x16x32_bf16 v[32:35], v[20:23], v[48:51], v[32:35]
    s_waitcnt vmcnt(4)
    s_barrier
    s_add_u32 m0, s72, 32768
    s_nop 0
    buffer_load_dwordx4 v8, s[4:7], s74 offen offset:0  lds
    buffer_load_dwordx4 v9, s[4:7], s74 offen offset:1024  lds
    buffer_load_dwordx4 v10, s[4:7], s74 offen offset:2048  lds
    buffer_load_dwordx4 v11, s[4:7], s74 offen offset:3072  lds
    s_add_u32 s74, s74, 128
    s_and_b32 s74, s74, 2047
    s_add_u32 m0, s72, 49152
    s_nop 0
    buffer_load_dwordx4 v8, s[4:7], s74 offen offset:0  lds
    buffer_load_dwordx4 v9, s[4:7], s74 offen offset:1024  lds
    buffer_load_dwordx4 v10, s[4:7], s74 offen offset:2048  lds
    buffer_load_dwordx4 v11, s[4:7], s74 offen offset:3072  lds
    s_add_u32 s74, s74, 128
    s_and_b32 s74, s74, 2047
    s_add_u32 m0, s73, 114688
    s_nop 0
    buffer_load_dwordx4 v12, s[8:11], s75 offen offset:0 nt lds
    buffer_load_dwordx4 v13, s[8:11], s75 offen offset:1024 nt lds
    s_add_u32 m0, s73, 122880
    s_nop 0
    buffer_load_dwordx4 v14, s[8:11], s75 offen offset:0 nt lds
    buffer_load_dwordx4 v15, s[8:11], s75 offen offset:1024 nt lds
    s_add_u32 s75, s75, 393216
    s_cmp_eq_u32 s75, 6291456
    s_cselect_b32 s75, 0, s75
    v_mov_b32 v5, 0
    buffer_load_dword v18, v5, s[16:19], 0 offen sc1
    s_waitcnt vmcnt(9)
    s_barrier
    s_add_u32 m0, s72, 0
    s_nop 0
    buffer_load_dwordx4 v8, s[4:7], s74 offen offset:0  lds
    buffer_load_dwordx4 v9, s[4:7], s74 offen offset:1024  lds
    buffer_load_dwordx4 v10, s[4:7], s74 offen offset:2048  lds
    buffer_load_dwordx4 v11, s[4:7], s74 offen offset:3072  lds
    s_add_u32 s74, s74, 128
    s_and_b32 s74, s74, 2047
    s_add_u32 m0, s73, 65536
    s_nop 0
    buffer_load_dwordx4 v12, s[8:11], s75 offen offset:0 nt lds
    buffer_load_dwordx4 v13, s[8:11], s75 offen offset:1024 nt lds
    s_add_u32 m0, s73, 73728
    s_nop 0
    buffer_load_dwordx4 v14, s[8:11], s75 offen offset:0 nt lds
    buffer_load_dwordx4 v15, s[8:11], s75 offen offset:1024 nt lds
    s_add_u32 s75, s75, 393216
    s_cmp_eq_u32 s75, 6291456
    s_cselect_b32 s75, 0, s75
    s_add_u32 m0, s72, 16384
    s_nop 0
    buffer_load_dwordx4 v8, s[4:7], s74 offen offset:0  lds
    buffer_load_dwordx4 v9, s[4:7], s74 offen offset:1024  lds
    buffer_load_dwordx4 v10, s[4:7], s74 offen offset:2048  lds
    buffer_load_dwordx4 v11, s[4:7], s74 offen offset:3072  lds
    s_add_u32 s74, s74, 128
    s_and_b32 s74, s74, 2047
    s_add_u32 m0, s73, 81920
    s_nop 0
    buffer_load_dwordx4 v12, s[8:11], s75 offen offset:0 nt lds
    buffer_load_dwordx4 v13, s[8:11], s75 offen offset:1024 nt lds
    s_add_u32 m0, s73, 90112
    s_nop 0
    buffer_load_dwordx4 v14, s[8:11], s75 offen offset:0 nt lds
    buffer_load_dwordx4 v15, s[8:11], s75 offen offset:1024 nt lds
    s_add_u32 s75, s75, 393216
    s_cmp_eq_u32 s75, 6291456
    s_cselect_b32 s75, 0, s75
    s_add_u32 m0, s73, 140800
    s_nop 0
    buffer_load_dwordx4 v16, s[8:11], s76 offen offset:0 nt lds
    buffer_load_dwordx4 v17, s[8:11], s76 offen offset:1024 nt lds
    s_lshl_b32 s3, s38, 10
    s_add_u32 m0, s3, 131072
    s_lshl_b32 s65, s37, 12
    s_add_u32 s65, s65, s3
    buffer_load_dwordx4 v3, s[20:23], s65 offen lds
    s_waitcnt vmcnt(20)
    s_barrier
    s_add_u32 m0, s72, 32768
    s_nop 0
    buffer_load_dwordx4 v8, s[4:7], s74 offen offset:0  lds
    buffer_load_dwordx4 v9, s[4:7], s74 offen offset:1024  lds
    buffer_load_dwordx4 v10, s[4:7], s74 offen offset:2048  lds
    buffer_load_dwordx4 v11, s[4:7], s74 offen offset:3072  lds
    s_add_u32 s74, s74, 128
    s_and_b32 s74, s74, 2047
    s_add_u32 m0, s73, 98304
    s_nop 0
    buffer_load_dwordx4 v12, s[8:11], s75 offen offset:0 nt lds
    buffer_load_dwordx4 v13, s[8:11], s75 offen offset:1024 nt lds
    s_add_u32 m0, s73, 106496
    s_nop 0
    buffer_load_dwordx4 v14, s[8:11], s75 offen offset:0 nt lds
    buffer_load_dwordx4 v15, s[8:11], s75 offen offset:1024 nt lds
    s_add_u32 s75, s75, 393216
    s_cmp_eq_u32 s75, 6291456
    s_cselect_b32 s75, 0, s75
    s_waitcnt vmcnt(19)
    s_barrier
    s_add_u32 m0, s72, 49152
    s_nop 0
    buffer_load_dwordx4 v8, s[4:7], s74 offen offset:0  lds
    buffer_load_dwordx4 v9, s[4:7], s74 offen offset:1024  lds
    buffer_load_dwordx4 v10, s[4:7], s74 offen offset:2048  lds
    buffer_load_dwordx4 v11, s[4:7], s74 offen offset:3072  lds
    s_add_u32 s74, s74, 128
    s_and_b32 s74, s74, 2047
    s_add_u32 m0, s73, 114688
    s_nop 0
    buffer_load_dwordx4 v12, s[8:11], s75 offen offset:0 nt lds
    buffer_load_dwordx4 v13, s[8:11], s75 offen offset:1024 nt lds
    s_add_u32 m0, s73, 122880
    s_nop 0
    buffer_load_dwordx4 v14, s[8:11], s75 offen offset:0 nt lds
    buffer_load_dwordx4 v15, s[8:11], s75 offen offset:1024 nt lds
    s_add_u32 s75, s75, 393216
    s_cmp_eq_u32 s75, 6291456
    s_cselect_b32 s75, 0, s75
    s_waitcnt vmcnt(16)
    s_barrier
    s_add_u32 m0, s72, 0
    s_nop 0
    buffer_load_dwordx4 v8, s[4:7], s74 offen offset:0  lds
    buffer_load_dwordx4 v9, s[4:7], s74 offen offset:1024  lds
    buffer_load_dwordx4 v10, s[4:7], s74 offen offset:2048  lds
    buffer_load_dwordx4 v11, s[4:7], s74 offen offset:3072  lds
    s_add_u32 s74, s74, 128
    s_and_b32 s74, s74, 2047
    s_add_u32 m0, s73, 65536
    s_nop 0
    buffer_load_dwordx4 v12, s[8:11], s75 offen offset:0 nt lds
    buffer_load_dwordx4 v13, s[8:11], s75 offen offset:1024 nt lds
    s_add_u32 m0, s73, 73728
    s_nop 0
    buffer_load_dwordx4 v14, s[8:11], s75 offen offset:0 nt lds
    buffer_load_dwordx4 v15, s[8:11], s75 offen offset:1024 nt lds
    s_add_u32 s75, s75, 393216
    s_cmp_eq_u32 s75, 6291456
    s_cselect_b32 s75, 0, s75
    v_add_u32 v19, 75264, v19
    ds_read_b64_tr_b16 v[36:37], v19 offset:0
    ds_read_b64_tr_b16 v[38:39], v19 offset:512
    ds_read_b64_tr_b16 v[40:41], v19 offset:4096
    ds_read_b64_tr_b16 v[42:43], v19 offset:4608
    s_waitcnt lgkmcnt(0)
    v_mfma_f32_16x16x32_bf16 v[24:27], v[20:23], v[36:39], 0
    v_mfma_f32_16x16x32_bf16 v[24:27], v[20:23], v[40:43], v[24:27]
L_non:
    v_cmp_eq_u32 vcc, 0, v18
    s_nop 1
    v_cndmask_b32 v6, 0, 1, vcc
    v_cmp_ne_u32 vcc, 0, v6
    s_nop 0
    s_cmp_eq_u64 vcc, 0
    s_cbranch_scc1 L_nonok
    s_add_u32 s70, s70, 1
    s_cmp_ge_u32 s70, 200000
    s_cbranch_scc1 L_nonok
    s_sleep 2
    v_mov_b32 v5, 0
    buffer_load_dword v18, v5, s[16:19], 0 offen sc1
    s_waitcnt vmcnt(0)
    s_branch L_non
L_nonok:
    v_readfirstlane_b32 s32, v18
    v_mov_b32 v36, v24
    v_mov_b32 v37, v28
    v_mov_b32 v38, v32
    v_mov_b32 v39, v18
    s_lshl_b32 s3, s37, 4
    s_add_u32 s3, s3, s36
    s_lshl_b32 s3, s3, 10
    s_lshl_b32 s65, s38, 8
    s_add_u32 s3, s3, s65
    s_add_u32 s3, s3, 1048576
    s_mov_b64 exec, 0xffff
    buffer_store_dwordx4 v[36:39], v3, s[12:15], s3 offen sc1
    s_mov_b64 exec, -1
    s_cmp_lg_u32 s38, 0
    s_cbranch_scc1 L_npub
    v_and_b32 v5, 7, v1
    v_lshlrev_b32 v5, 3, v5
    v_add_u32 v6, 139008, v5
    ds_read_b64 v[40:41], v6
    s_waitcnt lgkmcnt(0)
    v_mov_b32 v44, v41
    s_nop 1
    v_max_u32 v44, v44, v44 quad_perm:[1,0,3,2] row_mask:0xf bank_mask:0xf
    s_nop 1
    v_max_u32 v44, v44, v44 quad_perm:[2,3,0,1] row_mask:0xf bank_mask:0xf
    s_nop 1
    v_max_u32 v44, v44, v44 row_half_mirror row_mask:0xf bank_mask:0xf
    v_cmp_eq_u32 vcc, v44, v41
    v_mov_b32 v45, v40
    v_mov_b32 v46, v18
    v_mov_b32 v47, v18
    v_mov_b32 v41, v18
    v_mov_b32 v6, 0
    s_lshl_b32 s3, s36, 4
    s_add_u32 s3, s3, s37
    s_lshl_b32 s3, s3, 6
    s_add_u32 s3, s3, 0
    s_mov_b64 exec, 0xff
    buffer_store_dwordx2 v[40:41], v5, s[12:15], s3 offen sc1
    s_lshl_b32 s3, s2, 4
    s_add_u32 s3, s3, 65536
    s_and_b64 exec, exec, vcc
    buffer_store_dwordx4 v[44:47], v6, s[12:15], s3 offen sc1
    s_mov_b64 exec, -1
L_npub:
    s_waitcnt vmcnt(17)
    s_barrier
    s_add_u32 m0, s72, 16384
    s_nop 0
    buffer_load_dwordx4 v8, s[4:7], s74 offen offset:0  lds
    buffer_load_dwordx4 v9, s[4:7], s74 offen offset:1024  lds
    buffer_load_dwordx4 v10, s[4:7], s74 offen offset:2048  lds
    buffer_load_dwordx4 v11, s[4:7], s74 offen offset:3072  lds
    s_add_u32 s74, s74, 128
    s_and_b32 s74, s74, 2047
    s_add_u32 m0, s73, 81920
    s_nop 0
    buffer_load_dwordx4 v12, s[8:11], s75 offen offset:0 nt lds
    buffer_load_dwordx4 v13, s[8:11], s75 offen offset:1024 nt lds
    s_add_u32 m0, s73, 90112
    s_nop 0
    buffer_load_dwordx4 v14, s[8:11], s75 offen offset:0 nt lds
    buffer_load_dwordx4 v15, s[8:11], s75 offen offset:1024 nt lds
    s_add_u32 s75, s75, 393216
    s_cmp_eq_u32 s75, 6291456
    s_cselect_b32 s75, 0, s75
    v_and_b32 v5, 1, v1
    v_cmp_eq_u32 vcc, 0, v5
    v_mov_b32 v6, 0xffff0000
    v_mov_b32 v7, 0xffff
    v_cndmask_b32 v6, v6, v7, vcc
    v_bfe_u32 v5, v1, 1, 2
    v_cmp_eq_u32 vcc, 0, v5
    s_nop 1
    v_cndmask_b32 v88, 0, v6, vcc
    v_cmp_eq_u32 vcc, 1, v5
    s_nop 1
    v_cndmask_b32 v89, 0, v6, vcc
    v_cmp_eq_u32 vcc, 2, v5
    s_nop 1
    v_cndmask_b32 v90, 0, v6, vcc
    v_cmp_eq_u32 vcc, 3, v5
    s_nop 1
    v_cndmask_b32 v91, 0, v6, vcc
    s_waitcnt vmcnt(17)
    s_barrier
    s_add_u32 m0, s72, 32768
    s_nop 0
    buffer_load_dwordx4 v8, s[4:7], s74 offen offset:0  lds
    buffer_load_dwordx4 v9, s[4:7], s74 offen offset:1024  lds
    buffer_load_dwordx4 v10, s[4:7], s74 offen offset:2048  lds
    buffer_load_dwordx4 v11, s[4:7], s74 offen offset:3072  lds
    s_add_u32 s74, s74, 128
    s_and_b32 s74, s74, 2047
    s_add_u32 m0, s73, 98304
    s_nop 0
    buffer_load_dwordx4 v12, s[8:11], s75 offen offset:0 nt lds
    buffer_load_dwordx4 v13, s[8:11], s75 offen offset:1024 nt lds
    s_add_u32 m0, s73, 106496
    s_nop 0
    buffer_load_dwordx4 v14, s[8:11], s75 offen offset:0 nt lds
    buffer_load_dwordx4 v15, s[8:11], s75 offen offset:1024 nt lds
    s_add_u32 s75, s75, 393216
    s_cmp_eq_u32 s75, 6291456
    s_cselect_b32 s75, 0, s75
    s_mov_b32 s16, s52
    s_mov_b32 s17, s53
    s_mov_b32 s18, 7340032
    s_mov_b32 s19, 0x00020000
    s_mov_b32 s20, s54
    s_mov_b32 s21, s55
    s_mov_b32 s22, 7340032
    s_mov_b32 s23, 0x00020000
    s_cmp_lt_u32 s2, 224
    s_cselect_b32 s18, s18, 0
    s_cselect_b32 s22, s22, 0
    s_and_b32 s3, s2, 3
    s_lshl_b32 s3, s3, 8
    s_lshl_b32 s65, s38, 6
    s_add_u32 s3, s3, s65
    v_and_b32 v5, 0x38, v1
    v_add_u32 v5, s3, v5
    v_mul_u32_u24 v5, 7168, v5
    v_and_b32 v6, 7, v1
    v_lshl_add_u32 v2, v6, 4, v5
    s_lshr_b32 s77, s2, 2
    s_lshl_b32 s77, s77, 7
    s_waitcnt vmcnt(17)
    s_barrier
    s_add_u32 m0, s72, 49152
    s_nop 0
    buffer_load_dwordx4 v8, s[4:7], s74 offen offset:0  lds
    buffer_load_dwordx4 v9, s[4:7], s74 offen offset:1024  lds
    buffer_load_dwordx4 v10, s[4:7], s74 offen offset:2048  lds
    buffer_load_dwordx4 v11, s[4:7], s74 offen offset:3072  lds
    s_add_u32 s74, s74, 128
    s_and_b32 s74, s74, 2047
    s_add_u32 m0, s73, 114688
    s_nop 0
    buffer_load_dwordx4 v12, s[8:11], s75 offen offset:0 nt lds
    buffer_load_dwordx4 v13, s[8:11], s75 offen offset:1024 nt lds
    s_add_u32 m0, s73, 122880
    s_nop 0
    buffer_load_dwordx4 v14, s[8:11], s75 offen offset:0 nt lds
    buffer_load_dwordx4 v15, s[8:11], s75 offen offset:1024 nt lds
    s_add_u32 s75, s75, 393216
    s_cmp_eq_u32 s75, 6291456
    s_cselect_b32 s75, 0, s75
    s_waitcnt vmcnt(16)
    s_barrier
    s_add_u32 m0, s72, 0
    s_nop 0
    buffer_load_dwordx4 v8, s[4:7], s74 offen offset:0  lds
    buffer_load_dwordx4 v9, s[4:7], s74 offen offset:1024  lds
    buffer_load_dwordx4 v10, s[4:7], s74 offen offset:2048  lds
    buffer_load_dwordx4 v11, s[4:7], s74 offen offset:3072  lds
    s_add_u32 s74, s74, 128
    s_and_b32 s74, s74, 2047
    s_add_u32 m0, s73, 65536
    s_nop 0
    buffer_load_dwordx4 v12, s[8:11], s75 offen offset:0 nt lds
    buffer_load_dwordx4 v13, s[8:11], s75 offen offset:1024 nt lds
    s_add_u32 m0, s73, 73728
    s_nop 0
    buffer_load_dwordx4 v14, s[8:11], s75 offen offset:0 nt lds
    buffer_load_dwordx4 v15, s[8:11], s75 offen offset:1024 nt lds
    s_add_u32 s75, s75, 393216
    s_cmp_eq_u32 s75, 6291456
    s_cselect_b32 s75, 0, s75
    s_waitcnt vmcnt(16)
    s_barrier
    s_add_u32 m0, s72, 16384
    s_nop 0
    buffer_load_dwordx4 v8, s[4:7], s74 offen offset:0  lds
    buffer_load_dwordx4 v9, s[4:7], s74 offen offset:1024  lds
    buffer_load_dwordx4 v10, s[4:7], s74 offen offset:2048  lds
    buffer_load_dwordx4 v11, s[4:7], s74 offen offset:3072  lds
    s_add_u32 s74, s74, 128
    s_and_b32 s74, s74, 2047
    s_add_u32 m0, s73, 81920
    s_nop 0
    buffer_load_dwordx4 v12, s[8:11], s75 offen offset:0 nt lds
    buffer_load_dwordx4 v13, s[8:11], s75 offen offset:1024 nt lds
    s_add_u32 m0, s73, 90112
    s_nop 0
    buffer_load_dwordx4 v14, s[8:11], s75 offen offset:0 nt lds
    buffer_load_dwordx4 v15, s[8:11], s75 offen offset:1024 nt lds
    s_add_u32 s75, s75, 393216
    s_cmp_eq_u32 s75, 6291456
    s_cselect_b32 s75, 0, s75
    s_lshl_b32 s3, s37, 4
    s_lshl_b32 s65, s38, 2
    s_add_u32 s3, s3, s65
    s_lshl_b32 s3, s3, 10
    s_add_u32 s3, s3, 1048576
    buffer_load_dwordx4 v[52:55], v3, s[12:15], s3 offen offset:0 sc1
    buffer_load_dwordx4 v[56:59], v3, s[12:15], s3 offen offset:1024 sc1
    buffer_load_dwordx4 v[60:63], v3, s[12:15], s3 offen offset:2048 sc1
    buffer_load_dwordx4 v[64:67], v3, s[12:15], s3 offen offset:3072 sc1
    s_lshl_b32 s3, s38, 10
    s_add_u32 s3, s3, 65536
    buffer_load_dwordx4 v[68:71], v3, s[12:15], s3 offen sc1
    s_cmp_lt_u32 s38, 2
    s_cselect_b32 s3, s36, s30
    s_lshl_b32 s3, s3, 10
    s_and_b32 s65, s38, 1
    s_lshl_b32 s65, s65, 9
    s_add_u32 s3, s3, s65
    v_lshlrev_b32 v5, 3, v1
    buffer_load_dwordx2 v[72:73], v5, s[12:15], s3 offen offset:0 sc1
    s_waitcnt vmcnt(22)
    s_barrier
    s_add_u32 m0, s72, 32768
    s_nop 0
    buffer_load_dwordx4 v8, s[4:7], s74 offen offset:0  lds
    buffer_load_dwordx4 v9, s[4:7], s74 offen offset:1024  lds
    buffer_load_dwordx4 v10, s[4:7], s74 offen offset:2048  lds
    buffer_load_dwordx4 v11, s[4:7], s74 offen offset:3072  lds
    s_add_u32 s74, s74, 128
    s_and_b32 s74, s74, 2047
    s_add_u32 m0, s73, 98304
    s_nop 0
    buffer_load_dwordx4 v12, s[8:11], s75 offen offset:0 nt lds
    buffer_load_dwordx4 v13, s[8:11], s75 offen offset:1024 nt lds
    s_add_u32 m0, s73, 106496
    s_nop 0
    buffer_load_dwordx4 v14, s[8:11], s75 offen offset:0 nt lds
    buffer_load_dwordx4 v15, s[8:11], s75 offen offset:1024 nt lds
    s_add_u32 s75, s75, 393216
    s_cmp_eq_u32 s75, 6291456
    s_cselect_b32 s75, 0, s75
    s_waitcnt vmcnt(22)
    s_barrier
    s_add_u32 m0, s72, 49152
    s_nop 0
    buffer_load_dwordx4 v8, s[4:7], s74 offen offset:0  lds
    buffer_load_dwordx4 v9, s[4:7], s74 offen offset:1024  lds
    buffer_load_dwordx4 v10, s[4:7], s74 offen offset:2048  lds
    buffer_load_dwordx4 v11, s[4:7], s74 offen offset:3072  lds
    s_add_u32 s74, s74, 128
    s_and_b32 s74, s74, 2047
    s_add_u32 m0, s73, 114688
    s_nop 0
    buffer_load_dwordx4 v12, s[8:11], s75 offen offset:0 nt lds
    buffer_load_dwordx4 v13, s[8:11], s75 offen offset:1024 nt lds
    s_add_u32 m0, s73, 122880
    s_nop 0
    buffer_load_dwordx4 v14, s[8:11], s75 offen offset:0 nt lds
    buffer_load_dwordx4 v15, s[8:11], s75 offen offset:1024 nt lds
    s_add_u32 s75, s75, 393216
    s_cmp_eq_u32 s75, 6291456
    s_cselect_b32 s75, 0, s75
    s_waitcnt vmcnt(16)
L_x0:
    v_xor_b32 v6, v73, v18
    v_xor_b32 v7, v70, v18
    v_or_b32 v6, v6, v7
    v_xor_b32 v7, v55, v18
    v_or_b32 v6, v6, v7
    v_xor_b32 v7, v59, v18
    v_or_b32 v6, v6, v7
    v_xor_b32 v7, v63, v18
    v_or_b32 v6, v6, v7
    v_xor_b32 v7, v67, v18
    v_or_b32 v6, v6, v7
    v_cmp_ne_u32 vcc, 0, v6
    s_nop 0
    s_cmp_eq_u64 vcc, 0
    s_cbranch_scc1 L_x0ok
    s_add_u32 s70, s70, 1
    s_cmp_ge_u32 s70, 200000
    s_cbranch_scc1 L_x0ok
    s_sleep 2
    s_lshl_b32 s3, s37, 4
    s_lshl_b32 s65, s38, 2
    s_add_u32 s3, s3, s65
    s_lshl_b32 s3, s3, 10
    s_add_u32 s3, s3, 1048576
    buffer_load_dwordx4 v[52:55], v3, s[12:15], s3 offen offset:0 sc1
    buffer_load_dwordx4 v[56:59], v3, s[12:15], s3 offen offset:1024 sc1
    buffer_load_dwordx4 v[60:63], v3, s[12:15], s3 offen offset:2048 sc1
    buffer_load_dwordx4 v[64:67], v3, s[12:15], s3 offen offset:3072 sc1
    s_lshl_b32 s3, s38, 10
    s_add_u32 s3, s3, 65536
    buffer_load_dwordx4 v[68:71], v3, s[12:15], s3 offen sc1
    s_cmp_lt_u32 s38, 2
    s_cselect_b32 s3, s36, s30
    s_lshl_b32 s3, s3, 10
    s_and_b32 s65, s38, 1
    s_lshl_b32 s65, s65, 9
    s_add_u32 s3, s3, s65
    v_lshlrev_b32 v5, 3, v1
    buffer_load_dwordx2 v[72:73], v5, s[12:15], s3 offen offset:0 sc1
    s_waitcnt vmcnt(0)
    s_branch L_x0
L_x0ok:
    v_pk_add_f32 v[52:53], v[52:53], v[56:57]
    v_pk_add_f32 v[60:61], v[60:61], v[64:65]
    v_pk_add_f32 v[52:53], v[52:53], v[60:61]
    v_add_f32 v54, v54, v58
    v_add_f32 v62, v62, v66
    v_add_f32 v54, v54, v62
    s_lshl_b32 s3, s38, 10
    s_add_u32 s3, s3, 148992
    v_add_u32 v5, s3, v3
    ds_write_b128 v5, v[52:55]
    v_and_b32 v73, 0xffff0000, v72
    v_rcp_f32 v6, v73
    v_lshlrev_b32 v7, 16, v72
    s_lshr_b32 s3, s38, 1
    s_mul_i32 s3, s3, 1536
    s_and_b32 s65, s38, 1
    s_lshl_b32 s66, s65, 8
    s_add_u32 s66, s66, s3
    s_add_u32 s66, s66, 135168
    v_lshl_add_u32 v5, v1, 2, s66
    v_fma_f32 v4, -v6, v73, 1.0
    v_fmac_f32 v6, v4, v6
    ds_write_b32 v5, v7
    ds_write_b32 v5, v6 offset:512
    s_lshl_b32 s66, s65, 7
    s_add_u32 s66, s66, s3
    s_add_u32 s66, s66, 136192
    v_lshl_add_u32 v5, v1, 1, s66
    ds_write_b16_d16_hi v5, v72
    v_mov_b32 v6, v68
    s_nop 1
    v_max_u32 v6, v6, v6 quad_perm:[1,0,3,2] row_mask:0xf bank_mask:0xf
    s_nop 1
    v_max_u32 v6, v6, v6 quad_perm:[2,3,0,1] row_mask:0xf bank_mask:0xf
    s_nop 1
    v_max_u32 v6, v6, v6 row_half_mirror row_mask:0xf bank_mask:0xf
    s_nop 1
    v_max_u32 v6, v6, v6 row_mirror row_mask:0xf bank_mask:0xf
    v_mov_b32 v7, v6
    s_nop 1
    v_permlane16_swap_b32 v6, v7
    v_max_u32 v6, v6, v7
    v_mov_b32 v7, v6
    s_nop 1
    v_permlane32_swap_b32 v6, v7
    v_max_u32 v6, v6, v7
    v_cmp_eq_u32 vcc, v6, v68
    s_lshl_b32 s3, s38, 3
    s_add_u32 s3, s3, 139072
    v_mov_b32 v5, s3
    s_mov_b64 exec, vcc
    ds_write_b64 v5, v[68:69]
    s_mov_b64 exec, -1
    s_waitcnt lgkmcnt(0)
    s_barrier
    s_add_u32 s76, s39, 12
    s_and_b32 s76, s76, 15
    s_mul_i32 s76, s76, 393216
    s_add_u32 m0, s73, 65536
    s_nop 0
    buffer_load_dwordx4 v16, s[8:11], s76 offen offset:0 nt lds
    buffer_load_dwordx4 v17, s[8:11], s76 offen offset:1024 nt lds
    s_add_u32 s76, s76, 393216
    s_cmp_eq_u32 s76, 6291456
    s_cselect_b32 s76, 0, s76
    s_add_u32 m0, s73, 73728
    s_nop 0
    buffer_load_dwordx4 v16, s[8:11], s76 offen offset:0 nt lds
    buffer_load_dwordx4 v17, s[8:11], s76 offen offset:1024 nt lds
    s_add_u32 s76, s76, 393216
    s_cmp_eq_u32 s76, 6291456
    s_cselect_b32 s76, 0, s76
    v_add_u32 v5, 148992, v3
    ds_read_b128 v[52:55], v5 offset:0
    ds_read_b128 v[56:59], v5 offset:1024
    ds_read_b128 v[60:63], v5 offset:2048
    ds_read_b128 v[64:67], v5 offset:3072
    v_and_b32 v6, 3, v1
    v_lshlrev_b32 v6, 3, v6
    v_add_u32 v6, 139072, v6
    ds_read_b64 v[68:69], v6
    s_waitcnt lgkmcnt(0)
    v_mov_b32 v6, v68
    s_nop 1
    v_max_u32 v6, v6, v6 quad_perm:[1,0,3,2] row_mask:0xf bank_mask:0xf
    s_nop 1
    v_max_u32 v6, v6, v6 quad_perm:[2,3,0,1] row_mask:0xf bank_mask:0xf
    v_pk_add_f32 v[52:53], v[52:53], v[56:57]
    v_pk_add_f32 v[60:61], v[60:61], v[64:65]
    v_pk_add_f32 v[52:53], v[52:53], v[60:61]
    v_add_f32 v54, v54, v58
    v_add_f32 v62, v62, v66
    v_add_f32 v54, v54, v62
    v_cmp_eq_u32 vcc, v6, v68
    v_lshlrev_b32 v5, 2, v1
    v_add_u32 v5, 138240, v5
    s_ff1_i32_b64 s3, vcc
    v_readfirstlane_b32 s33, v6
    ds_write_b32 v5, v52
    ds_write_b32 v5, v53 offset:256
    ds_write_b32 v5, v54 offset:512
    v_readlane_b32 s64, v69, s3
    v_mov_b32 v7, v18
    v_mov_b32 v5, 139072
    ds_write_b64 v5, v[6:7] offset:32
    s_and_b32 s34, s33, 0x7ff
    s_sub_u32 s34, 2047, s34
    s_lshr_b32 s3, s34, 7
    s_cmp_eq_u32 s3, s30
    s_cselect_b32 s35, 1, 0
    s_lshl_b32 s3, s34, 11
    s_and_b32 s65, s2, 3
    s_lshl_b32 s65, s65, 9
    s_add_u32 s3, s3, s65
    s_lshl_b32 s65, s38, 7
    s_add_u32 s3, s3, s65
    v_lshrrev_b32 v5, 3, v1
    v_lshlrev_b32 v5, 4, v5
    buffer_load_dwordx4 v[76:79], v5, s[4:7], s3 offen
    s_waitcnt lgkmcnt(0)
    s_waitcnt vmcnt(13)
    s_barrier
    s_add_u32 m0, s73, 81920
    s_nop 0
    buffer_load_dwordx4 v16, s[8:11], s76 offen offset:0 nt lds
    buffer_load_dwordx4 v17, s[8:11], s76 offen offset:1024 nt lds
    s_add_u32 s76, s76, 393216
    s_cmp_eq_u32 s76, 6291456
    s_cselect_b32 s76, 0, s76
    s_add_u32 m0, s73, 90112
    s_nop 0
    buffer_load_dwordx4 v16, s[8:11], s76 offen offset:0 nt lds
    buffer_load_dwordx4 v17, s[8:11], s76 offen offset:1024 nt lds
    s_add_u32 s76, s76, 393216
    s_cmp_eq_u32 s76, 6291456
    s_cselect_b32 s76, 0, s76
    buffer_load_dwordx4 v[128:131], v2, s[16:19], s77 offen nt
    buffer_load_dwordx4 v[160:163], v2, s[20:23], s77 offen nt
    s_add_u32 s77, s77, 7168
    s_waitcnt vmcnt(11)
    s_barrier
    s_add_u32 m0, s73, 98304
    s_nop 0
    buffer_load_dwordx4 v16, s[8:11], s76 offen offset:0 nt lds
    buffer_load_dwordx4 v17, s[8:11], s76 offen offset:1024 nt lds
    s_add_u32 s76, s76, 393216
    s_cmp_eq_u32 s76, 6291456
    s_cselect_b32 s76, 0, s76
    s_add_u32 m0, s73, 106496
    s_nop 0
    buffer_load_dwordx4 v16, s[8:11], s76 offen offset:0 nt lds
    buffer_load_dwordx4 v17, s[8:11], s76 offen offset:1024 nt lds
    s_add_u32 s76, s76, 393216
    s_cmp_eq_u32 s76, 6291456
    s_cselect_b32 s76, 0, s76
    buffer_load_dwordx4 v[132:135], v2, s[16:19], s77 offen nt
    buffer_load_dwordx4 v[164:167], v2, s[20:23], s77 offen nt
    s_add_u32 s77, s77, 7168
    buffer_load_dwordx4 v[136:139], v2, s[16:19], s77 offen nt
    buffer_load_dwordx4 v[168:171], v2, s[20:23], s77 offen nt
    s_add_u32 s77, s77, 7168
    s_barrier
    s_add_u32 m0, s73, 114688
    s_nop 0
    buffer_load_dwordx4 v16, s[8:11], s76 offen offset:0 nt lds
    buffer_load_dwordx4 v17, s[8:11], s76 offen offset:1024 nt lds
    s_add_u32 s76, s76, 393216
    s_cmp_eq_u32 s76, 6291456
    s_cselect_b32 s76, 0, s76
    s_add_u32 m0, s73, 122880
    s_nop 0
    buffer_load_dwordx4 v16, s[8:11], s76 offen offset:0 nt lds
    buffer_load_dwordx4 v17, s[8:11], s76 offen offset:1024 nt lds
    s_add_u32 s76, s76, 393216
    s_cmp_eq_u32 s76, 6291456
    s_cselect_b32 s76, 0, s76
    buffer_load_dwordx4 v[140:143], v2, s[16:19], s77 offen nt
    buffer_load_dwordx4 v[172:175], v2, s[20:23], s77 offen nt
    s_add_u32 s77, s77, 7168
    buffer_load_dwordx4 v[144:147], v2, s[16:19], s77 offen nt
    buffer_load_dwordx4 v[176:179], v2, s[20:23], s77 offen nt
    s_add_u32 s77, s77, 7168
    buffer_load_dwordx4 v[148:151], v2, s[16:19], s77 offen nt
    buffer_load_dwordx4 v[180:183], v2, s[20:23], s77 offen nt
    s_add_u32 s77, s77, 7168
    buffer_load_dwordx4 v[152:155], v2, s[16:19], s77 offen nt
    buffer_load_dwordx4 v[184:187], v2, s[20:23], s77 offen nt
    s_add_u32 s77, s77, 7168
    buffer_load_dwordx4 v[156:159], v2, s[16:19], s77 offen nt
    buffer_load_dwordx4 v[188:191], v2, s[20:23], s77 offen nt
    s_add_u32 s77, s77, 7168
    s_waitcnt vmcnt(28)
    s_lshl_b32 s65, s64, 16
    s_and_b32 s66, s64, 0xffff0000
    v_rcp_f32 v6, s66
    v_lshlrev_b32 v80, 16, v76
    v_and_b32 v81, 0xffff0000, v76
    v_lshlrev_b32 v82, 16, v77
    v_and_b32 v83, 0xffff0000, v77
    v_lshlrev_b32 v84, 16, v78
    v_and_b32 v85, 0xffff0000, v78
    v_lshlrev_b32 v86, 16, v79
    v_and_b32 v87, 0xffff0000, v79
    v_fma_f32 v4, -v6, s66, 1.0
    v_fmac_f32 v6, v4, v6
    v_subrev_f32 v80, s65, v80
    v_subrev_f32 v81, s65, v81
    v_subrev_f32 v82, s65, v82
    v_subrev_f32 v83, s65, v83
    v_subrev_f32 v84, s65, v84
    v_subrev_f32 v85, s65, v85
    v_subrev_f32 v86, s65, v86
    v_subrev_f32 v87, s65, v87
    v_cvt_pk_bf16_f32 v80, v80, v80
    v_cvt_pk_bf16_f32 v81, v81, v81
    v_cvt_pk_bf16_f32 v82, v82, v82
    v_cvt_pk_bf16_f32 v83, v83, v83
    v_cvt_pk_bf16_f32 v84, v84, v84
    v_cvt_pk_bf16_f32 v85, v85, v85
    v_cvt_pk_bf16_f32 v86, v86, v86
    v_cvt_pk_bf16_f32 v87, v87, v87
    v_lshlrev_b32 v80, 16, v80
    v_lshlrev_b32 v81, 16, v81
    v_lshlrev_b32 v82, 16, v82
    v_lshlrev_b32 v83, 16, v83
    v_lshlrev_b32 v84, 16, v84
    v_lshlrev_b32 v85, 16, v85
    v_lshlrev_b32 v86, 16, v86
    v_lshlrev_b32 v87, 16, v87
    v_mul_f32 v80, v80, v6
    v_mul_f32 v81, v81, v6
    v_mul_f32 v82, v82, v6
    v_mul_f32 v83, v83, v6
    v_mul_f32 v84, v84, v6
    v_mul_f32 v85, v85, v6
    v_mul_f32 v86, v86, v6
    v_mul_f32 v87, v87, v6
    v_cvt_pk_bf16_f32 v80, v80, v80
    v_cvt_pk_bf16_f32 v81, v81, v81
    v_cvt_pk_bf16_f32 v82, v82, v82
    v_cvt_pk_bf16_f32 v83, v83, v83
    v_cvt_pk_bf16_f32 v84, v84, v84
    v_cvt_pk_bf16_f32 v85, v85, v85
    v_cvt_pk_bf16_f32 v86, v86, v86
    v_cvt_pk_bf16_f32 v87, v87, v87
    s_barrier
    s_barrier
    s_add_u32 m0, s72, 0
    s_nop 0
    buffer_load_dwordx4 v8, s[4:7], s74 offen offset:0  lds
    buffer_load_dwordx4 v9, s[4:7], s74 offen offset:1024  lds
    buffer_load_dwordx4 v10, s[4:7], s74 offen offset:2048  lds
    buffer_load_dwordx4 v11, s[4:7], s74 offen offset:3072  lds
    s_add_u32 s74, s74, 128
    s_and_b32 s74, s74, 2047
    s_add_u32 m0, s73, 65536
    s_nop 0
    buffer_load_dwordx4 v16, s[8:11], s76 offen offset:0 nt lds
    buffer_load_dwordx4 v17, s[8:11], s76 offen offset:1024 nt lds
    s_add_u32 s76, s76, 393216
    s_cmp_eq_u32 s76, 6291456
    s_cselect_b32 s76, 0, s76
    s_waitcnt vmcnt(32)
    s_barrier
    s_add_u32 m0, s72, 16384
    s_nop 0
    buffer_load_dwordx4 v8, s[4:7], s74 offen offset:0  lds
    buffer_load_dwordx4 v9, s[4:7], s74 offen offset:1024  lds
    buffer_load_dwordx4 v10, s[4:7], s74 offen offset:2048  lds
    buffer_load_dwordx4 v11, s[4:7], s74 offen offset:3072  lds
    s_add_u32 s74, s74, 128
    s_and_b32 s74, s74, 2047
    s_add_u32 m0, s73, 73728
    s_nop 0
    buffer_load_dwordx4 v16, s[8:11], s76 offen offset:0 nt lds
    buffer_load_dwordx4 v17, s[8:11], s76 offen offset:1024 nt lds
    s_add_u32 s76, s76, 393216
    s_cmp_eq_u32 s76, 6291456
    s_cselect_b32 s76, 0, s76
    s_waitcnt vmcnt(36)
    s_barrier
    s_add_u32 m0, s72, 32768
    s_nop 0
    buffer_load_dwordx4 v8, s[4:7], s74 offen offset:0  lds
    buffer_load_dwordx4 v9, s[4:7], s74 offen offset:1024  lds
    buffer_load_dwordx4 v10, s[4:7], s74 offen offset:2048  lds
    buffer_load_dwordx4 v11, s[4:7], s74 offen offset:3072  lds
    s_add_u32 s74, s74, 128
    s_and_b32 s74, s74, 2047
    s_add_u32 m0, s73, 81920
    s_nop 0
    buffer_load_dwordx4 v16, s[8:11], s76 offen offset:0 nt lds
    buffer_load_dwordx4 v17, s[8:11], s76 offen offset:1024 nt lds
    s_add_u32 s76, s76, 393216
    s_cmp_eq_u32 s76, 6291456
    s_cselect_b32 s76, 0, s76
    s_waitcnt vmcnt(14)
    s_barrier
    s_add_u32 m0, s72, 49152
    s_nop 0
    buffer_load_dwordx4 v8, s[4:7], s74 offen offset:0  lds
    buffer_load_dwordx4 v9, s[4:7], s74 offen offset:1024  lds
    buffer_load_dwordx4 v10, s[4:7], s74 offen offset:2048  lds
    buffer_load_dwordx4 v11, s[4:7], s74 offen offset:3072  lds
    s_add_u32 s74, s74, 128
    s_and_b32 s74, s74, 2047
    s_add_u32 m0, s73, 90112
    s_nop 0
    buffer_load_dwordx4 v16, s[8:11], s76 offen offset:0 nt lds
    buffer_load_dwordx4 v17, s[8:11], s76 offen offset:1024 nt lds
    s_add_u32 s76, s76, 393216
    s_cmp_eq_u32 s76, 6291456
    s_cselect_b32 s76, 0, s76
    s_waitcnt vmcnt(14)
    s_barrier
    s_add_u32 m0, s72, 0
    s_nop 0
    buffer_load_dwordx4 v8, s[4:7], s74 offen offset:0  lds
    buffer_load_dwordx4 v9, s[4:7], s74 offen offset:1024  lds
    buffer_load_dwordx4 v10, s[4:7], s74 offen offset:2048  lds
    buffer_load_dwordx4 v11, s[4:7], s74 offen offset:3072  lds
    s_add_u32 s74, s74, 128
    s_and_b32 s74, s74, 2047
    s_add_u32 m0, s73, 98304
    s_nop 0
    buffer_load_dwordx4 v16, s[8:11], s76 offen offset:0 nt lds
    buffer_load_dwordx4 v17, s[8:11], s76 offen offset:1024 nt lds
    s_add_u32 s76, s76, 393216
    s_cmp_eq_u32 s76, 6291456
    s_cselect_b32 s76, 0, s76
    s_cmp_lg_u32 s38, 0
    s_cbranch_scc1 L_nkf
    s_lshl_b32 s3, s37, 7
    s_lshl_b32 s65, s36, 2
    s_add_u32 s3, s3, s65
    s_add_u32 s3, s3, 131072
    v_mov_b32 v5, 0
    s_mov_b64 exec, 1
    buffer_store_dword v18, v5, s[12:15], s3 offen sc1
    s_mov_b64 exec, -1
L_nkf:
    v_and_b32 v5, 1, v1
    v_cmp_eq_u32 vcc, 0, v5
    v_mov_b32 v6, 0x3f800000
    v_mov_b32 v7, 0x3f80
    v_cndmask_b32 v6, v6, v7, vcc
    v_lshrrev_b32 v5, 4, v1
    v_bfe_u32 v7, v1, 2, 2
    v_cmp_eq_u32 vcc, v5, v7
    s_nop 1
    v_cndmask_b32 v6, 0, v6, vcc
    v_and_b32 v5, 2, v1
    v_cmp_eq_u32 vcc, 0, v5
    s_nop 1
    v_cndmask_b32 v20, 0, v6, vcc
    v_cndmask_b32 v21, v6, 0, vcc
    v_mov_b32 v22, 0
    v_mov_b32 v23, 0
    v_mov_b32 v24, v20
    v_mov_b32 v25, v21
    s_waitcnt vmcnt(14)
    s_barrier
    s_add_u32 m0, s72, 16384
    s_nop 0
    buffer_load_dwordx4 v8, s[4:7], s74 offen offset:0  lds
    buffer_load_dwordx4 v9, s[4:7], s74 offen offset:1024  lds
    buffer_load_dwordx4 v10, s[4:7], s74 offen offset:2048  lds
    buffer_load_dwordx4 v11, s[4:7], s74 offen offset:3072  lds
    s_add_u32 s74, s74, 128
    s_and_b32 s74, s74, 2047
    s_add_u32 m0, s73, 106496
    s_nop 0
    buffer_load_dwordx4 v16, s[8:11], s76 offen offset:0 nt lds
    buffer_load_dwordx4 v17, s[8:11], s76 offen offset:1024 nt lds
    s_add_u32 s76, s76, 393216
    s_cmp_eq_u32 s76, 6291456
    s_cselect_b32 s76, 0, s76
    v_and_b32 v92, v80, v88
    v_and_b32 v93, v80, v89
    v_and_b32 v94, v80, v90
    v_and_b32 v95, v80, v91
    s_nop 1
    v_mfma_f32_16x16x32_bf16 v[100:103], v[92:95], v[128:131], 0
    v_mfma_f32_16x16x32_bf16 v[104:107], v[92:95], v[160:163], 0
    v_and_b32 v96, v81, v88
    v_and_b32 v97, v81, v89
    v_and_b32 v98, v81, v90
    v_and_b32 v99, v81, v91
    s_nop 1
    v_mfma_f32_16x16x32_bf16 v[100:103], v[96:99], v[132:135], v[100:103]
    v_mfma_f32_16x16x32_bf16 v[104:107], v[96:99], v[164:167], v[104:107]
    s_waitcnt vmcnt(14)
    s_barrier
    s_add_u32 m0, s72, 32768
    s_nop 0
    buffer_load_dwordx4 v8, s[4:7], s74 offen offset:0  lds
    buffer_load_dwordx4 v9, s[4:7], s74 offen offset:1024  lds
    buffer_load_dwordx4 v10, s[4:7], s74 offen offset:2048  lds
    buffer_load_dwordx4 v11, s[4:7], s74 offen offset:3072  lds
    s_add_u32 s74, s74, 128
    s_and_b32 s74, s74, 2047
    s_add_u32 m0, s73, 114688
    s_nop 0
    buffer_load_dwordx4 v16, s[8:11], s76 offen offset:0 nt lds
    buffer_load_dwordx4 v17, s[8:11], s76 offen offset:1024 nt lds
    s_add_u32 s76, s76, 393216
    s_cmp_eq_u32 s76, 6291456
    s_cselect_b32 s76, 0, s76
    v_and_b32 v92, v82, v88
    v_and_b32 v93, v82, v89
    v_and_b32 v94, v82, v90
    v_and_b32 v95, v82, v91
    s_nop 1
    v_mfma_f32_16x16x32_bf16 v[100:103], v[92:95], v[136:139], v[100:103]
    v_mfma_f32_16x16x32_bf16 v[104:107], v[92:95], v[168:171], v[104:107]
    v_and_b32 v96, v83, v88
    v_and_b32 v97, v83, v89
    v_and_b32 v98, v83, v90
    v_and_b32 v99, v83, v91
    s_nop 1
    v_mfma_f32_16x16x32_bf16 v[100:103], v[96:99], v[140:143], v[100:103]
    v_mfma_f32_16x16x32_bf16 v[104:107], v[96:99], v[172:175], v[104:107]
    s_waitcnt vmcnt(14)
    s_barrier
    s_add_u32 m0, s72, 49152
    s_nop 0
    buffer_load_dwordx4 v8, s[4:7], s74 offen offset:0  lds
    buffer_load_dwordx4 v9, s[4:7], s74 offen offset:1024  lds
    buffer_load_dwordx4 v10, s[4:7], s74 offen offset:2048  lds
    buffer_load_dwordx4 v11, s[4:7], s74 offen offset:3072  lds
    s_add_u32 s74, s74, 128
    s_and_b32 s74, s74, 2047
    s_add_u32 m0, s73, 122880
    s_nop 0
    buffer_load_dwordx4 v16, s[8:11], s76 offen offset:0 nt lds
    buffer_load_dwordx4 v17, s[8:11], s76 offen offset:1024 nt lds
    s_add_u32 s76, s76, 393216
    s_cmp_eq_u32 s76, 6291456
    s_cselect_b32 s76, 0, s76
    v_and_b32 v92, v84, v88
    v_and_b32 v93, v84, v89
    v_and_b32 v94, v84, v90
    v_and_b32 v95, v84, v91
    s_nop 1
    v_mfma_f32_16x16x32_bf16 v[100:103], v[92:95], v[144:147], v[100:103]
    v_mfma_f32_16x16x32_bf16 v[104:107], v[92:95], v[176:179], v[104:107]
    v_and_b32 v96, v85, v88
    v_and_b32 v97, v85, v89
    v_and_b32 v98, v85, v90
    v_and_b32 v99, v85, v91
    s_nop 1
    v_mfma_f32_16x16x32_bf16 v[100:103], v[96:99], v[148:151], v[100:103]
    v_mfma_f32_16x16x32_bf16 v[104:107], v[96:99], v[180:183], v[104:107]
    s_waitcnt vmcnt(14)
    s_barrier
    s_add_u32 m0, s72, 0
    s_nop 0
    buffer_load_dwordx4 v8, s[4:7], s74 offen offset:0  lds
    buffer_load_dwordx4 v9, s[4:7], s74 offen offset:1024  lds
    buffer_load_dwordx4 v10, s[4:7], s74 offen offset:2048  lds
    buffer_load_dwordx4 v11, s[4:7], s74 offen offset:3072  lds
    s_add_u32 s74, s74, 128
    s_and_b32 s74, s74, 2047
    v_and_b32 v92, v86, v88
    v_and_b32 v93, v86, v89
    v_and_b32 v94, v86, v90
    v_and_b32 v95, v86, v91
    s_nop 1
    v_mfma_f32_16x16x32_bf16 v[100:103], v[92:95], v[152:155], v[100:103]
    v_mfma_f32_16x16x32_bf16 v[104:107], v[92:95], v[184:187], v[104:107]
    v_and_b32 v96, v87, v88
    v_and_b32 v97, v87, v89
    v_and_b32 v98, v87, v90
    v_and_b32 v99, v87, v91
    s_nop 1
    v_mfma_f32_16x16x32_bf16 v[100:103], v[96:99], v[156:159], v[100:103]
    v_mfma_f32_16x16x32_bf16 v[104:107], v[96:99], v[188:191], v[104:107]
    s_waitcnt vmcnt(12)
    s_barrier
    s_add_u32 m0, s72, 16384
    s_nop 0
    buffer_load_dwordx4 v8, s[4:7], s74 offen offset:0  lds
    buffer_load_dwordx4 v9, s[4:7], s74 offen offset:1024  lds
    buffer_load_dwordx4 v10, s[4:7], s74 offen offset:2048  lds
    buffer_load_dwordx4 v11, s[4:7], s74 offen offset:3072  lds
    s_add_u32 s74, s74, 128
    s_and_b32 s74, s74, 2047
    s_lshl_b32 s3, s37, 7
    s_add_u32 s3, s3, 131072
    v_and_b32 v5, 15, v1
    v_lshlrev_b32 v5, 2, v5
    buffer_load_dword v19, v5, s[12:15], s3 offen sc1
    v_permlane32_swap_b32 v100, v104
    v_permlane32_swap_b32 v101, v105
    v_permlane32_swap_b32 v102, v106
    v_permlane32_swap_b32 v103, v107
    v_add_f32 v100, v104, v100 row_ror:8 row_mask:0xf bank_mask:0xf
    v_add_f32 v101, v105, v101 row_ror:8 row_mask:0xf bank_mask:0xf
    v_add_f32 v102, v106, v102 row_ror:8 row_mask:0xf bank_mask:0xf
    v_add_f32 v103, v107, v103 row_ror:8 row_mask:0xf bank_mask:0xf
    v_lshrrev_b32 v5, 5, v1
    v_mul_u32_u24 v7, 3584, v5
    v_and_b32 v5, 7, v1
    v_lshl_add_u32 v7, v5, 3, v7
    v_bfe_u32 v5, v1, 4, 1
    v_lshl_add_u32 v7, v5, 2, v7
    v_lshlrev_b32 v7, 7, v7
    s_lshr_b32 s3, s2, 2
    s_lshl_b32 s3, s3, 13
    s_and_b32 s65, s2, 3
    s_lshl_b32 s65, s65, 5
    s_add_u32 s3, s3, s65
    s_lshl_b32 s65, s38, 3
    s_add_u32 s3, s3, s65
    s_add_u32 s3, s3, 6291456
    v_mov_b32 v92, v100
    v_mov_b32 v93, v18
    v_mov_b32 v94, v101
    v_mov_b32 v95, v18
    v_mov_b32 v96, v102
    v_mov_b32 v97, v18
    v_mov_b32 v98, v103
    v_mov_b32 v99, v18
    s_cmp_ge_u32 s2, 224
    s_cbranch_scc1 L_nogu
    s_mov_b32 s66, 0x00ff00ff
    s_mov_b32 s67, 0x00ff00ff
    s_mov_b64 exec, s[66:67]
    buffer_store_dwordx2 v[92:93], v7, s[12:15], s3 offen offset:0 sc1
    buffer_store_dwordx2 v[94:95], v7, s[12:15], s3 offen offset:128 sc1
    buffer_store_dwordx2 v[96:97], v7, s[12:15], s3 offen offset:256 sc1
    buffer_store_dwordx2 v[98:99], v7, s[12:15], s3 offen offset:384 sc1
    s_mov_b64 exec, -1
L_nogu:
    s_waitcnt vmcnt(11)
    s_barrier
    s_add_u32 m0, s72, 32768
    s_nop 0
    buffer_load_dwordx4 v8, s[4:7], s74 offen offset:0  lds
    buffer_load_dwordx4 v9, s[4:7], s74 offen offset:1024  lds
    buffer_load_dwordx4 v10, s[4:7], s74 offen offset:2048  lds
    buffer_load_dwordx4 v11, s[4:7], s74 offen offset:3072  lds
    s_add_u32 s74, s74, 128
    s_and_b32 s74, s74, 2047
    s_waitcnt vmcnt(9)
    s_barrier
    s_add_u32 m0, s72, 49152
    s_nop 0
    buffer_load_dwordx4 v8, s[4:7], s74 offen offset:0  lds
    buffer_load_dwordx4 v9, s[4:7], s74 offen offset:1024  lds
    buffer_load_dwordx4 v10, s[4:7], s74 offen offset:2048  lds
    buffer_load_dwordx4 v11, s[4:7], s74 offen offset:3072  lds
    s_add_u32 s74, s74, 128
    s_and_b32 s74, s74, 2047
    s_waitcnt vmcnt(8)
L_kf:
    v_xor_b32 v6, v19, v18
    v_cmp_ne_u32 vcc, 0, v6
    s_nop 0
    s_cmp_eq_u64 vcc, 0
    s_cbranch_scc1 L_kfok
    s_add_u32 s70, s70, 1
    s_cmp_ge_u32 s70, 200000
    s_cbranch_scc1 L_kfok
    s_sleep 2
    s_lshl_b32 s3, s37, 7
    s_add_u32 s3, s3, 131072
    v_and_b32 v5, 15, v1
    v_lshlrev_b32 v5, 2, v5
    buffer_load_dword v19, v5, s[12:15], s3 offen sc1
    s_waitcnt vmcnt(0)
    s_branch L_kf
L_kfok:
    s_lshl_b32 s77, s37, 5
    s_mul_i32 s77, s77, 4352
    s_add_u32 s77, s77, 2097152
    s_and_b32 s3, s38, 1
    s_mul_i32 s3, s3, 69632
    s_add_u32 s3, s3, s77
    s_add_u32 s3, s3, 4096
    v_lshrrev_b32 v5, 4, v1
    v_mul_u32_u24 v5, 4352, v5
    v_and_b32 v6, 15, v1
    v_lshl_add_u32 v5, v6, 4, v5
    buffer_load_dwordx4 v[52:55], v5, s[12:15], s3 offen
    s_add_u32 s3, s3, 17408
    buffer_load_dwordx4 v[56:59], v5, s[12:15], s3 offen
    s_add_u32 s3, s3, 17408
    buffer_load_dwordx4 v[60:63], v5, s[12:15], s3 offen
    s_add_u32 s3, s3, 17408
    buffer_load_dwordx4 v[64:67], v5, s[12:15], s3 offen
    s_add_u32 s3, s3, 17408
    s_lshl_b32 s3, s38, 10
    s_add_u32 s77, s77, s3
    buffer_load_dwordx4 v[112:115], v3, s[12:15], s77 offen
    s_add_u32 s77, s77, 4352
    buffer_load_dwordx4 v[116:119], v3, s[12:15], s77 offen
    s_add_u32 s77, s77, 4352
    buffer_load_dwordx4 v[120:123], v3, s[12:15], s77 offen
    s_add_u32 s77, s77, 4352
    buffer_load_dwordx4 v[124:127], v3, s[12:15], s77 offen
    s_add_u32 s77, s77, 4352
    buffer_load_dwordx4 v[128:131], v3, s[12:15], s77 offen
    s_add_u32 s77, s77, 4352
    buffer_load_dwordx4 v[132:135], v3, s[12:15], s77 offen
    s_add_u32 s77, s77, 4352
    s_barrier
    buffer_load_dwordx4 v[136:139], v3, s[12:15], s77 offen
    s_add_u32 s77, s77, 4352
    buffer_load_dwordx4 v[140:143], v3, s[12:15], s77 offen
    s_add_u32 s77, s77, 4352
    buffer_load_dwordx4 v[144:147], v3, s[12:15], s77 offen
    s_add_u32 s77, s77, 4352
    buffer_load_dwordx4 v[148:151], v3, s[12:15], s77 offen
    s_add_u32 s77, s77, 4352
    buffer_load_dwordx4 v[152:155], v3, s[12:15], s77 offen
    s_add_u32 s77, s77, 4352
    buffer_load_dwordx4 v[156:159], v3, s[12:15], s77 offen
    s_add_u32 s77, s77, 4352
    s_waitcnt vmcnt(20)
    s_barrier
    buffer_load_dwordx4 v[160:163], v3, s[12:15], s77 offen
    s_add_u32 s77, s77, 4352
    buffer_load_dwordx4 v[164:167], v3, s[12:15], s77 offen
    s_add_u32 s77, s77, 4352
    buffer_load_dwordx4 v[168:171], v3, s[12:15], s77 offen
    s_add_u32 s77, s77, 4352
    buffer_load_dwordx4 v[172:175], v3, s[12:15], s77 offen
    s_add_u32 s77, s77, 4352
    buffer_load_dwordx4 v[176:179], v3, s[12:15], s77 offen
    s_add_u32 s77, s77, 4352
    buffer_load_dwordx4 v[180:183], v3, s[12:15], s77 offen
    s_add_u32 s77, s77, 4352
    s_waitcnt vmcnt(22)
    s_barrier
    buffer_load_dwordx4 v[184:187], v3, s[12:15], s77 offen
    s_add_u32 s77, s77, 4352
    buffer_load_dwordx4 v[188:191], v3, s[12:15], s77 offen
    s_add_u32 s77, s77, 4352
    buffer_load_dwordx4 v[192:195], v3, s[12:15], s77 offen
    s_add_u32 s77, s77, 4352
    buffer_load_dwordx4 v[196:199], v3, s[12:15], s77 offen
    s_add_u32 s77, s77, 4352
    buffer_load_dwordx4 v[200:203], v3, s[12:15], s77 offen
    s_add_u32 s77, s77, 4352
    buffer_load_dwordx4 v[204:207], v3, s[12:15], s77 offen
    s_add_u32 s77, s77, 4352
    s_barrier
    buffer_load_dwordx4 v[208:211], v3, s[12:15], s77 offen
    s_add_u32 s77, s77, 4352
    buffer_load_dwordx4 v[212:215], v3, s[12:15], s77 offen
    s_add_u32 s77, s77, 4352
    buffer_load_dwordx4 v[216:219], v3, s[12:15], s77 offen
    s_add_u32 s77, s77, 4352
    buffer_load_dwordx4 v[220:223], v3, s[12:15], s77 offen
    s_add_u32 s77, s77, 4352
    buffer_load_dwordx4 v[224:227], v3, s[12:15], s77 offen
    s_add_u32 s77, s77, 4352
    buffer_load_dwordx4 v[228:231], v3, s[12:15], s77 offen
    s_add_u32 s77, s77, 4352
    buffer_load_dwordx4 v[232:235], v3, s[12:15], s77 offen
    s_add_u32 s77, s77, 4352
    buffer_load_dwordx4 v[236:239], v3, s[12:15], s77 offen
    s_add_u32 s77, s77, 4352
    s_mov_b32 s16, s46
    s_mov_b32 s17, s47
    s_mov_b32 s18, 2097152
    s_mov_b32 s19, 0x00020000
    s_mov_b32 s20, s56
    s_mov_b32 s21, s57
    s_mov_b32 s22, 7340032
    s_mov_b32 s23, 0x00020000
    s_mov_b32 s24, s58
    s_mov_b32 s25, s59
    s_mov_b32 s26, 4194304
    s_mov_b32 s27, 0x00020000
    v_lshrrev_b32 v5, 3, v1
    v_lshlrev_b32 v5, 11, v5
    v_lshrrev_b32 v6, 4, v1
    v_lshlrev_b32 v6, 1, v6
    v_and_b32 v7, 7, v1
    v_xor_b32 v6, v6, v7
    v_lshl_add_u32 v5, v6, 4, v5
    s_lshl_b32 s3, s31, 7
    v_add_u32 v8, s3, v5
    v_add_u32 v9, 15360, v8
    v_add_u32 v10, 30720, v8
    v_add_u32 v11, 46080, v8
    s_lshl_b32 s74, s38, 16
    s_waitcnt vmcnt(32)
    v_pk_add_f32 v[52:53], v[52:53], v[56:57]
    v_pk_add_f32 v[60:61], v[60:61], v[64:65]
    v_pk_add_f32 v[54:55], v[54:55], v[58:59]
    v_pk_add_f32 v[62:63], v[62:63], v[66:67]
    v_pk_add_f32 v[52:53], v[52:53], v[60:61]
    v_pk_add_f32 v[54:55], v[54:55], v[62:63]
    v_mov_b32 v56, v52
    v_mov_b32 v57, v53
    v_mov_b32 v58, v54
    v_mov_b32 v59, v55
    v_permlane16_swap_b32 v52, v56
    v_permlane16_swap_b32 v53, v57
    v_permlane16_swap_b32 v54, v58
    v_permlane16_swap_b32 v55, v59
    v_pk_add_f32 v[52:53], v[52:53], v[56:57]
    v_pk_add_f32 v[54:55], v[54:55], v[58:59]
    v_mov_b32 v56, v52
    v_mov_b32 v57, v53
    v_mov_b32 v58, v54
    v_mov_b32 v59, v55
    v_permlane32_swap_b32 v52, v56
    v_permlane32_swap_b32 v53, v57
    v_permlane32_swap_b32 v54, v58
    v_permlane32_swap_b32 v55, v59
    v_pk_add_f32 v[52:53], v[52:53], v[56:57]
    v_pk_add_f32 v[54:55], v[54:55], v[58:59]
    v_cvt_pk_bf16_f32 v52, v52, v53
    v_cvt_pk_bf16_f32 v53, v54, v55
    s_and_b32 s3, s38, 1
    s_lshl_b32 s3, s3, 7
    s_add_u32 s3, s3, 148992
    v_and_b32 v5, 15, v1
    v_lshl_add_u32 v5, v5, 3, s3
    ds_write_b64 v5, v[52:53]
    s_waitcnt vmcnt(28)
    v_mfma_f32_16x16x32_bf16 v[36:39], v[20:23], v[112:115], 0
    v_mfma_f32_16x16x32_bf16 v[40:43], v[22:25], v[112:115], 0
    v_mfma_f32_16x16x32_bf16 v[36:39], v[20:23], v[116:119], v[36:39]
    v_mfma_f32_16x16x32_bf16 v[40:43], v[22:25], v[116:119], v[40:43]
    v_mfma_f32_16x16x32_bf16 v[36:39], v[20:23], v[120:123], v[36:39]
    v_mfma_f32_16x16x32_bf16 v[40:43], v[22:25], v[120:123], v[40:43]
    v_mfma_f32_16x16x32_bf16 v[36:39], v[20:23], v[124:127], v[36:39]
    v_mfma_f32_16x16x32_bf16 v[40:43], v[22:25], v[124:127], v[40:43]
    s_waitcnt vmcnt(24)
    v_mfma_f32_16x16x32_bf16 v[36:39], v[20:23], v[128:131], v[36:39]
    v_mfma_f32_16x16x32_bf16 v[40:43], v[22:25], v[128:131], v[40:43]
    v_mfma_f32_16x16x32_bf16 v[36:39], v[20:23], v[132:135], v[36:39]
    v_mfma_f32_16x16x32_bf16 v[40:43], v[22:25], v[132:135], v[40:43]
    v_mfma_f32_16x16x32_bf16 v[36:39], v[20:23], v[136:139], v[36:39]
    v_mfma_f32_16x16x32_bf16 v[40:43], v[22:25], v[136:139], v[40:43]
    v_mfma_f32_16x16x32_bf16 v[36:39], v[20:23], v[140:143], v[36:39]
    v_mfma_f32_16x16x32_bf16 v[40:43], v[22:25], v[140:143], v[40:43]
    s_waitcnt vmcnt(20)
    v_mfma_f32_16x16x32_bf16 v[36:39], v[20:23], v[144:147], v[36:39]
    v_mfma_f32_16x16x32_bf16 v[40:43], v[22:25], v[144:147], v[40:43]
    v_mfma_f32_16x16x32_bf16 v[36:39], v[20:23], v[148:151], v[36:39]
    v_mfma_f32_16x16x32_bf16 v[40:43], v[22:25], v[148:151], v[40:43]
    v_mfma_f32_16x16x32_bf16 v[36:39], v[20:23], v[152:155], v[36:39]
    v_mfma_f32_16x16x32_bf16 v[40:43], v[22:25], v[152:155], v[40:43]
    v_mfma_f32_16x16x32_bf16 v[36:39], v[20:23], v[156:159], v[36:39]
    v_mfma_f32_16x16x32_bf16 v[40:43], v[22:25], v[156:159], v[40:43]
    s_waitcnt vmcnt(16)
    v_mfma_f32_16x16x32_bf16 v[36:39], v[20:23], v[160:163], v[36:39]
    v_mfma_f32_16x16x32_bf16 v[40:43], v[22:25], v[160:163], v[40:43]
    v_mfma_f32_16x16x32_bf16 v[36:39], v[20:23], v[164:167], v[36:39]
    v_mfma_f32_16x16x32_bf16 v[40:43], v[22:25], v[164:167], v[40:43]
    v_mfma_f32_16x16x32_bf16 v[36:39], v[20:23], v[168:171], v[36:39]
    v_mfma_f32_16x16x32_bf16 v[40:43], v[22:25], v[168:171], v[40:43]
    v_mfma_f32_16x16x32_bf16 v[36:39], v[20:23], v[172:175], v[36:39]
    v_mfma_f32_16x16x32_bf16 v[40:43], v[22:25], v[172:175], v[40:43]
    s_waitcnt vmcnt(12)
    v_mfma_f32_16x16x32_bf16 v[44:47], v[20:23], v[176:179], 0
    v_mfma_f32_16x16x32_bf16 v[48:51], v[22:25], v[176:179], 0
    v_mfma_f32_16x16x32_bf16 v[44:47], v[20:23], v[180:183], v[44:47]
    v_mfma_f32_16x16x32_bf16 v[48:51], v[22:25], v[180:183], v[48:51]
    v_mfma_f32_16x16x32_bf16 v[44:47], v[20:23], v[184:187], v[44:47]
    v_mfma_f32_16x16x32_bf16 v[48:51], v[22:25], v[184:187], v[48:51]
    v_mfma_f32_16x16x32_bf16 v[44:47], v[20:23], v[188:191], v[44:47]
    v_mfma_f32_16x16x32_bf16 v[48:51], v[22:25], v[188:191], v[48:51]
    s_add_u32 m0, s72, 0
    s_nop 0
    buffer_load_dwordx4 v8, s[16:19], s74 offen offset:0 nt lds
    buffer_load_dwordx4 v9, s[16:19], s74 offen offset:1024 nt lds
    buffer_load_dwordx4 v10, s[16:19], s74 offen offset:2048 nt lds
    buffer_load_dwordx4 v11, s[16:19], s74 offen offset:3072 nt lds
    s_add_u32 s74, s74, 262144
    s_waitcnt vmcnt(12)
    v_mfma_f32_16x16x32_bf16 v[44:47], v[20:23], v[192:195], v[44:47]
    v_mfma_f32_16x16x32_bf16 v[48:51], v[22:25], v[192:195], v[48:51]
    v_mfma_f32_16x16x32_bf16 v[44:47], v[20:23], v[196:199], v[44:47]
    v_mfma_f32_16x16x32_bf16 v[48:51], v[22:25], v[196:199], v[48:51]
    v_mfma_f32_16x16x32_bf16 v[44:47], v[20:23], v[200:203], v[44:47]
    v_mfma_f32_16x16x32_bf16 v[48:51], v[22:25], v[200:203], v[48:51]
    v_mfma_f32_16x16x32_bf16 v[44:47], v[20:23], v[204:207], v[44:47]
    v_mfma_f32_16x16x32_bf16 v[48:51], v[22:25], v[204:207], v[48:51]
    s_waitcnt vmcnt(8)
    v_mfma_f32_16x16x32_bf16 v[44:47], v[20:23], v[208:211], v[44:47]
    v_mfma_f32_16x16x32_bf16 v[48:51], v[22:25], v[208:211], v[48:51]
    v_mfma_f32_16x16x32_bf16 v[44:47], v[20:23], v[212:215], v[44:47]
    v_mfma_f32_16x16x32_bf16 v[48:51], v[22:25], v[212:215], v[48:51]
    v_mfma_f32_16x16x32_bf16 v[44:47], v[20:23], v[216:219], v[44:47]
    v_mfma_f32_16x16x32_bf16 v[48:51], v[22:25], v[216:219], v[48:51]
    v_mfma_f32_16x16x32_bf16 v[44:47], v[20:23], v[220:223], v[44:47]
    v_mfma_f32_16x16x32_bf16 v[48:51], v[22:25], v[220:223], v[48:51]
    s_add_u32 m0, s72, 16384
    s_nop 0
    buffer_load_dwordx4 v8, s[16:19], s74 offen offset:0 nt lds
    buffer_load_dwordx4 v9, s[16:19], s74 offen offset:1024 nt lds
    buffer_load_dwordx4 v10, s[16:19], s74 offen offset:2048 nt lds
    buffer_load_dwordx4 v11, s[16:19], s74 offen offset:3072 nt lds
    s_add_u32 s74, s74, 262144
    s_waitcnt vmcnt(8)
    v_mfma_f32_16x16x32_bf16 v[44:47], v[20:23], v[224:227], v[44:47]
    v_mfma_f32_16x16x32_bf16 v[48:51], v[22:25], v[224:227], v[48:51]
    v_mfma_f32_16x16x32_bf16 v[44:47], v[20:23], v[228:231], v[44:47]
    v_mfma_f32_16x16x32_bf16 v[48:51], v[22:25], v[228:231], v[48:51]
    v_mfma_f32_16x16x32_bf16 v[44:47], v[20:23], v[232:235], v[44:47]
    v_mfma_f32_16x16x32_bf16 v[48:51], v[22:25], v[232:235], v[48:51]
    v_mfma_f32_16x16x32_bf16 v[44:47], v[20:23], v[236:239], v[44:47]
    v_mfma_f32_16x16x32_bf16 v[48:51], v[22:25], v[236:239], v[48:51]
    s_lshl_b32 s3, s38, 10
    s_add_u32 s3, s3, 140800
    v_add_u32 v5, s3, v3
    v_cvt_pk_bf16_f32 v56, v36, v37
    v_cvt_pk_bf16_f32 v57, v38, v39
    v_cvt_pk_bf16_f32 v58, v40, v41
    v_cvt_pk_bf16_f32 v59, v42, v43
    ds_write_b128 v5, v[56:59] offset:0
    v_cvt_pk_bf16_f32 v60, v44, v45
    v_cvt_pk_bf16_f32 v61, v46, v47
    v_cvt_pk_bf16_f32 v62, v48, v49
    v_cvt_pk_bf16_f32 v63, v50, v51
    ds_write_b128 v5, v[60:63] offset:4096
    s_waitcnt lgkmcnt(0)
    s_barrier
    s_add_u32 m0, s72, 32768
    s_nop 0
    buffer_load_dwordx4 v8, s[16:19], s74 offen offset:0 nt lds
    buffer_load_dwordx4 v9, s[16:19], s74 offen offset:1024 nt lds
    buffer_load_dwordx4 v10, s[16:19], s74 offen offset:2048 nt lds
    buffer_load_dwordx4 v11, s[16:19], s74 offen offset:3072 nt lds
    s_add_u32 s74, s74, 262144
    s_add_u32 m0, s72, 49152
    s_nop 0
    buffer_load_dwordx4 v8, s[16:19], s74 offen offset:0 nt lds
    buffer_load_dwordx4 v9, s[16:19], s74 offen offset:1024 nt lds
    buffer_load_dwordx4 v10, s[16:19], s74 offen offset:2048 nt lds
    buffer_load_dwordx4 v11, s[16:19], s74 offen offset:3072 nt lds
    s_add_u32 s74, s74, 262144
    s_add_u32 m0, s72, 65536
    s_nop 0
    buffer_load_dwordx4 v8, s[16:19], s74 offen offset:0 nt lds
    buffer_load_dwordx4 v9, s[16:19], s74 offen offset:1024 nt lds
    buffer_load_dwordx4 v10, s[16:19], s74 offen offset:2048 nt lds
    buffer_load_dwordx4 v11, s[16:19], s74 offen offset:3072 nt lds
    s_add_u32 s74, s74, 262144
    s_add_u32 m0, s72, 81920
    s_nop 0
    buffer_load_dwordx4 v8, s[16:19], s74 offen offset:0 nt lds
    buffer_load_dwordx4 v9, s[16:19], s74 offen offset:1024 nt lds
    buffer_load_dwordx4 v10, s[16:19], s74 offen offset:2048 nt lds
    buffer_load_dwordx4 v11, s[16:19], s74 offen offset:3072 nt lds
    s_add_u32 s74, s74, 262144
    s_add_u32 m0, s72, 98304
    s_nop 0
    buffer_load_dwordx4 v8, s[16:19], s74 offen offset:0 nt lds
    buffer_load_dwordx4 v9, s[16:19], s74 offen offset:1024 nt lds
    buffer_load_dwordx4 v10, s[16:19], s74 offen offset:2048 nt lds
    buffer_load_dwordx4 v11, s[16:19], s74 offen offset:3072 nt lds
    s_add_u32 s74, s74, 262144
    s_add_u32 m0, s72, 114688
    s_nop 0
    buffer_load_dwordx4 v8, s[16:19], s74 offen offset:0 nt lds
    buffer_load_dwordx4 v9, s[16:19], s74 offen offset:1024 nt lds
    buffer_load_dwordx4 v10, s[16:19], s74 offen offset:2048 nt lds
    buffer_load_dwordx4 v11, s[16:19], s74 offen offset:3072 nt lds
    s_add_u32 s74, s74, 262144
    s_cmp_lt_u32 s2, 224
    s_cselect_b32 s22, s22, 0
    v_lshrrev_b32 v5, 4, v1
    v_lshlrev_b32 v5, 11, v5
    v_and_b32 v6, 15, v1
    v_lshl_add_u32 v5, v6, 4, v5
    s_lshl_b32 s3, s2, 15
    s_lshl_b32 s65, s38, 9
    s_add_u32 s3, s3, s65
    buffer_load_dwordx4 v[128:131], v5, s[20:23], s3 offen offset:0 nt
    buffer_load_dwordx4 v[132:135], v5, s[20:23], s3 offen offset:256 nt
    s_add_u32 s3, s3, 8192
    buffer_load_dwordx4 v[136:139], v5, s[20:23], s3 offen offset:0 nt
    buffer_load_dwordx4 v[140:143], v5, s[20:23], s3 offen offset:256 nt
    s_add_u32 s3, s3, 8192
    buffer_load_dwordx4 v[144:147], v5, s[20:23], s3 offen offset:0 nt
    buffer_load_dwordx4 v[148:151], v5, s[20:23], s3 offen offset:256 nt
    s_add_u32 s3, s3, 8192
    buffer_load_dwordx4 v[152:155], v5, s[20:23], s3 offen offset:0 nt
    buffer_load_dwordx4 v[156:159], v5, s[20:23], s3 offen offset:256 nt
    v_lshlrev_b32 v5, 5, v1
    s_min_u32 s3, s2, 223
    s_lshl_b32 s3, s3, 11
    s_add_u32 s3, s3, 6291456
    s_add_u32 s65, s3, 458752
    buffer_load_dwordx4 v[52:55], v5, s[12:15], s3 offen offset:0 sc1
    buffer_load_dwordx4 v[56:59], v5, s[12:15], s3 offen offset:16 sc1
    buffer_load_dwordx4 v[60:63], v5, s[12:15], s65 offen offset:0 sc1
    buffer_load_dwordx4 v[64:67], v5, s[12:15], s65 offen offset:16 sc1
    s_waitcnt vmcnt(12)
    s_barrier
    s_waitcnt vmcnt(0)
L_gu:
    v_xor_b32 v6, v53, v18
    v_xor_b32 v7, v55, v18
    v_or_b32 v6, v6, v7
    v_xor_b32 v7, v57, v18
    v_or_b32 v6, v6, v7
    v_xor_b32 v7, v59, v18
    v_or_b32 v6, v6, v7
    v_xor_b32 v7, v61, v18
    v_or_b32 v6, v6, v7
    v_xor_b32 v7, v63, v18
    v_or_b32 v6, v6, v7
    v_xor_b32 v7, v65, v18
    v_or_b32 v6, v6, v7
    v_xor_b32 v7, v67, v18
    v_or_b32 v6, v6, v7
    v_cmp_ne_u32 vcc, 0, v6
    s_nop 0
    s_cmp_eq_u64 vcc, 0
    s_cbranch_scc1 L_guok
    s_add_u32 s70, s70, 1
    s_cmp_ge_u32 s70, 200000
    s_cbranch_scc1 L_guok
    s_sleep 8
    v_lshlrev_b32 v5, 5, v1
    s_min_u32 s3, s2, 223
    s_lshl_b32 s3, s3, 11
    s_add_u32 s3, s3, 6291456
    s_add_u32 s65, s3, 458752
    buffer_load_dwordx4 v[52:55], v5, s[12:15], s3 offen offset:0 sc1
    buffer_load_dwordx4 v[56:59], v5, s[12:15], s3 offen offset:16 sc1
    buffer_load_dwordx4 v[60:63], v5, s[12:15], s65 offen offset:0 sc1
    buffer_load_dwordx4 v[64:67], v5, s[12:15], s65 offen offset:16 sc1
    s_waitcnt vmcnt(0)
    s_branch L_gu
L_guok:
    v_add_f32 v52, v52, v54
    v_add_f32 v56, v56, v58
    v_add_f32 v60, v60, v62
    v_add_f32 v64, v64, v66
    v_add_f32 v52, v52, v56
    v_add_f32 v60, v60, v64
    s_nop 0
    v_add_f32 v52, v52, v52 quad_perm:[1,0,3,2] row_mask:0xf bank_mask:0xf
    v_add_f32 v60, v60, v60 quad_perm:[1,0,3,2] row_mask:0xf bank_mask:0xf
    s_nop 0
    v_add_f32 v52, v52, v52 quad_perm:[2,3,0,1] row_mask:0xf bank_mask:0xf
    v_add_f32 v60, v60, v60 quad_perm:[2,3,0,1] row_mask:0xf bank_mask:0xf
    v_cvt_pk_bf16_f32 v52, v52, v52
    v_lshlrev_b32 v52, 16, v52
    v_cvt_pk_bf16_f32 v60, v60, v60
    v_lshlrev_b32 v60, 16, v60
    v_mul_f32 v53, 0xbfb8aa3b, v52
    v_exp_f32 v53, v53
    s_nop 0
    v_add_f32 v53, 1.0, v53
    v_rcp_f32 v53, v53
    s_nop 0
    v_mul_f32 v52, v52, v53
    v_cvt_pk_bf16_f32 v52, v52, v52
    v_lshlrev_b32 v52, 16, v52
    v_mul_f32 v52, v52, v60
    v_cvt_pk_bf16_f32 v52, v52, v52
    v_lshrrev_b32 v5, 4, v1
    v_lshlrev_b32 v5, 4, v5
    ds_bpermute_b32 v80, v5, v52 offset:0
    ds_bpermute_b32 v81, v5, v52 offset:64
    ds_bpermute_b32 v82, v5, v52 offset:128
    ds_bpermute_b32 v83, v5, v52 offset:192
    s_waitcnt lgkmcnt(0)
    v_and_b32 v92, v80, v88
    v_and_b32 v93, v80, v89
    v_and_b32 v94, v80, v90
    v_and_b32 v95, v80, v91
    s_nop 1
    v_mfma_f32_16x16x32_bf16 v[100:103], v[92:95], v[128:131], 0
    v_mfma_f32_16x16x32_bf16 v[104:107], v[92:95], v[132:135], 0
    v_and_b32 v96, v81, v88
    v_and_b32 v97, v81, v89
    v_and_b32 v98, v81, v90
    v_and_b32 v99, v81, v91
    s_nop 1
    v_mfma_f32_16x16x32_bf16 v[100:103], v[96:99], v[136:139], v[100:103]
    v_mfma_f32_16x16x32_bf16 v[104:107], v[96:99], v[140:143], v[104:107]
    v_and_b32 v92, v82, v88
    v_and_b32 v93, v82, v89
    v_and_b32 v94, v82, v90
    v_and_b32 v95, v82, v91
    s_nop 1
    v_mfma_f32_16x16x32_bf16 v[100:103], v[92:95], v[144:147], v[100:103]
    v_mfma_f32_16x16x32_bf16 v[104:107], v[92:95], v[148:151], v[104:107]
    v_and_b32 v96, v83, v88
    v_and_b32 v97, v83, v89
    v_and_b32 v98, v83, v90
    v_and_b32 v99, v83, v91
    s_nop 1
    v_mfma_f32_16x16x32_bf16 v[100:103], v[96:99], v[152:155], v[100:103]
    v_mfma_f32_16x16x32_bf16 v[104:107], v[96:99], v[156:159], v[104:107]
    v_and_b32 v5, 15, v1
    v_lshlrev_b32 v5, 5, v5
    v_bfe_u32 v6, v1, 4, 1
    v_lshl_add_u32 v5, v6, 4, v5
    v_lshrrev_b32 v6, 5, v1
    v_lshl_add_u32 v5, v6, 9, v5
    v_cmp_eq_u32 vcc, 0, v6
    s_lshl_b32 s3, s2, 12
    s_lshl_b32 s65, s38, 10
    s_add_u32 s3, s3, s65
    s_add_u32 s3, s3, 8388608
    v_cndmask_b32 v100, v104, v100, vcc
    v_cndmask_b32 v101, v105, v101, vcc
    v_cndmask_b32 v102, v106, v102, vcc
    v_cndmask_b32 v103, v107, v103, vcc
    s_cmp_ge_u32 s2, 224
    s_cbranch_scc1 L_noy
    buffer_store_dwordx4 v[100:103], v5, s[12:15], s3 offen sc1
    s_waitcnt vmcnt(0)
L_noy:
    s_lshl_b32 s3, s38, 10
    s_lshl_b32 s65, s2, 2
    s_add_u32 s3, s3, s65
    s_add_u32 s3, s3, 262144
    v_mov_b32 v5, 0
    s_mov_b64 exec, 1
    buffer_store_dword v18, v5, s[12:15], s3 offen sc1
    s_mov_b64 exec, -1
    s_cmp_eq_u32 s35, 0
    s_cbranch_scc1 L_done
    s_lshr_b32 s3, s31, 2
    s_lshl_b32 s3, s3, 10
    s_add_u32 s3, s3, 262144
    buffer_load_dwordx4 v[8:11], v3, s[12:15], s3 offen sc1
    s_waitcnt vmcnt(0)
L_yf:
    v_xor_b32 v8, v8, v18
    v_xor_b32 v9, v9, v18
    v_xor_b32 v10, v10, v18
    v_xor_b32 v11, v11, v18
    v_or3_b32 v6, v8, v9, v10
    v_or_b32 v6, v6, v11
    v_cmp_ne_u32 vcc, 0, v6
    s_nop 0
    s_cmp_eq_u64 vcc, 0
    s_cbranch_scc1 L_yfok
    s_add_u32 s70, s70, 1
    s_cmp_ge_u32 s70, 200000
    s_cbranch_scc1 L_yfok
    s_sleep 8
    s_lshr_b32 s3, s31, 2
    s_lshl_b32 s3, s3, 10
    s_add_u32 s3, s3, 262144
    buffer_load_dwordx4 v[8:11], v3, s[12:15], s3 offen sc1
    s_waitcnt vmcnt(0)
    s_branch L_yf
L_yfok:
    s_lshl_b32 s65, s38, 2
    v_lshrrev_b32 v5, 4, v1
    v_add_u32 v5, s65, v5
    v_lshlrev_b32 v5, 12, v5
    v_and_b32 v6, 15, v1
    v_lshl_add_u32 v5, v6, 4, v5
    s_lshl_b32 s3, s31, 8
    s_add_u32 s3, s3, 8388608
    buffer_load_dwordx4 v[128:131], v5, s[12:15], s3 offen sc1
    s_add_u32 s3, s3, 65536
    buffer_load_dwordx4 v[132:135], v5, s[12:15], s3 offen sc1
    s_add_u32 s3, s3, 65536
    buffer_load_dwordx4 v[136:139], v5, s[12:15], s3 offen sc1
    s_add_u32 s3, s3, 65536
    buffer_load_dwordx4 v[140:143], v5, s[12:15], s3 offen sc1
    s_add_u32 s3, s3, 65536
    buffer_load_dwordx4 v[144:147], v5, s[12:15], s3 offen sc1
    s_add_u32 s3, s3, 65536
    buffer_load_dwordx4 v[148:151], v5, s[12:15], s3 offen sc1
    s_add_u32 s3, s3, 65536
    buffer_load_dwordx4 v[152:155], v5, s[12:15], s3 offen sc1
    s_add_u32 s3, s3, 65536
    buffer_load_dwordx4 v[156:159], v5, s[12:15], s3 offen sc1
    s_add_u32 s3, s3, 65536
    buffer_load_dwordx4 v[160:163], v5, s[12:15], s3 offen sc1
    s_add_u32 s3, s3, 65536
    buffer_load_dwordx4 v[164:167], v5, s[12:15], s3 offen sc1
    s_add_u32 s3, s3, 65536
    buffer_load_dwordx4 v[168:171], v5, s[12:15], s3 offen sc1
    s_add_u32 s3, s3, 65536
    buffer_load_dwordx4 v[172:175], v5, s[12:15], s3 offen sc1
    s_add_u32 s3, s3, 65536
    buffer_load_dwordx4 v[176:179], v5, s[12:15], s3 offen sc1
    s_add_u32 s3, s3, 65536
    buffer_load_dwordx4 v[180:183], v5, s[12:15], s3 offen sc1
    s_lshl_b32 s68, s34, 11
    s_lshl_b32 s3, s31, 7
    s_add_u32 s68, s68, s3
    v_lshlrev_b32 v7, 1, v1
    buffer_load_ushort v8, v7, s[4:7], s68 offen
    s_and_b32 s3, s33, 0xfffff800
    s_xor_b32 s65, s3, 0x80000000
    s_not_b32 s66, s3
    s_and_b32 s66, s66, 0xfffff800
    s_bitcmp1_b32 s3, 31
    s_cselect_b32 s3, s65, s66
    v_mov_b32 v5, s3
    v_cvt_pk_bf16_f32 v5, v5, v5
    v_lshlrev_b32 v5, 16, v5
    v_mul_f32 v5, 0xbfb8aa3b, v5
    v_exp_f32 v5, v5
    s_nop 0
    v_add_f32 v5, 1.0, v5
    v_rcp_f32 v5, v5
    s_nop 0
    v_cvt_pk_bf16_f32 v5, v5, v5
    v_lshlrev_b32 v5, 16, v5
    s_lshl_b32 s65, s64, 16
    s_and_b32 s66, s64, 0xffff0000
    v_rcp_f32 v10, s66
    s_nop 0
    v_fma_f32 v4, -v10, s66, 1.0
    v_fmac_f32 v10, v4, v10
    s_waitcnt vmcnt(0)
    v_pk_add_f32 v[128:129], v[128:129], v[136:137]
    v_pk_add_f32 v[130:131], v[130:131], v[138:139]
    v_pk_add_f32 v[132:133], v[132:133], v[140:141]
    v_pk_add_f32 v[134:135], v[134:135], v[142:143]
    v_pk_add_f32 v[128:129], v[128:129], v[144:145]
    v_pk_add_f32 v[130:131], v[130:131], v[146:147]
    v_pk_add_f32 v[132:133], v[132:133], v[148:149]
    v_pk_add_f32 v[134:135], v[134:135], v[150:151]
    v_pk_add_f32 v[128:129], v[128:129], v[152:153]
    v_pk_add_f32 v[130:131], v[130:131], v[154:155]
    v_pk_add_f32 v[132:133], v[132:133], v[156:157]
    v_pk_add_f32 v[134:135], v[134:135], v[158:159]
    v_pk_add_f32 v[128:129], v[128:129], v[160:161]
    v_pk_add_f32 v[130:131], v[130:131], v[162:163]
    v_pk_add_f32 v[132:133], v[132:133], v[164:165]
    v_pk_add_f32 v[134:135], v[134:135], v[166:167]
    v_pk_add_f32 v[128:129], v[128:129], v[168:169]
    v_pk_add_f32 v[130:131], v[130:131], v[170:171]
    v_pk_add_f32 v[132:133], v[132:133], v[172:173]
    v_pk_add_f32 v[134:135], v[134:135], v[174:175]
    v_pk_add_f32 v[128:129], v[128:129], v[176:177]
    v_pk_add_f32 v[130:131], v[130:131], v[178:179]
    v_pk_add_f32 v[132:133], v[132:133], v[180:181]
    v_pk_add_f32 v[134:135], v[134:135], v[182:183]
    v_pk_add_f32 v[128:129], v[128:129], v[132:133]
    v_pk_add_f32 v[130:131], v[130:131], v[134:135]
    v_mov_b32 v132, v128
    v_mov_b32 v133, v129
    v_mov_b32 v134, v130
    v_mov_b32 v135, v131
    v_permlane16_swap_b32 v128, v132
    v_permlane16_swap_b32 v129, v133
    v_permlane16_swap_b32 v130, v134
    v_permlane16_swap_b32 v131, v135
    v_pk_add_f32 v[128:129], v[128:129], v[132:133]
    v_pk_add_f32 v[130:131], v[130:131], v[134:135]
    v_mov_b32 v132, v128
    v_mov_b32 v133, v129
    v_mov_b32 v134, v130
    v_mov_b32 v135, v131
    v_permlane32_swap_b32 v128, v132
    v_permlane32_swap_b32 v129, v133
    v_permlane32_swap_b32 v130, v134
    v_permlane32_swap_b32 v131, v135
    v_pk_add_f32 v[128:129], v[128:129], v[132:133]
    v_pk_add_f32 v[130:131], v[130:131], v[134:135]
    s_lshl_b32 s3, s38, 8
    s_add_u32 s3, s3, 139264
    v_lshl_add_u32 v6, v6, 4, s3
    ds_write_b128 v6, v[128:131]
    v_lshlrev_b32 v8, 16, v8
    v_subrev_f32 v9, s65, v8
    v_cvt_pk_bf16_f32 v9, v9, v9
    v_lshlrev_b32 v9, 16, v9
    v_mul_f32 v9, v9, v10
    v_cvt_pk_bf16_f32 v9, v9, v9
    v_lshlrev_b32 v9, 16, v9
    v_lshlrev_b32 v6, 2, v1
    v_add_u32 v6, 139264, v6
    s_waitcnt lgkmcnt(0)
    s_barrier
    s_cmp_lg_u32 s38, 0
    s_cbranch_scc1 L_done
    ds_read_b32 v12, v6 offset:0
    ds_read_b32 v13, v6 offset:256
    ds_read_b32 v14, v6 offset:512
    ds_read_b32 v15, v6 offset:768
    ds_read_b32 v16, v6 offset:1024
    s_waitcnt lgkmcnt(0)
    v_add_f32 v12, v12, v13
    v_add_f32 v14, v14, v15
    v_add_f32 v12, v12, v14
    v_cvt_pk_bf16_f32 v12, v12, v12
    v_lshlrev_b32 v12, 16, v12
    v_mul_f32 v12, v12, v5
    v_cvt_pk_bf16_f32 v12, v12, v12
    v_lshlrev_b32 v12, 16, v12
    v_add_f32 v12, v12, v9
    v_cvt_pk_bf16_f32 v12, v12, v12
    v_lshlrev_b32 v12, 16, v12
    v_mul_f32 v13, 0xbfb8aa3b, v12
    v_exp_f32 v13, v13
    s_nop 0
    v_add_f32 v13, 1.0, v13
    v_rcp_f32 v13, v13
    s_nop 0
    v_mul_f32 v12, v12, v13
    v_fmac_f32 v8, v12, v16
    v_cvt_pk_bf16_f32 v8, v8, v8
    buffer_store_short v8, v7, s[24:27], s68 offen
L_done:
    s_endpgm
L_g1:
    s_and_b32 s28, s38, 1
    s_lshr_b32 s29, s38, 1
    s_lshl_b32 s3, s36, 7
    s_lshl_b32 s65, s37, 3
    s_add_u32 s3, s3, s65
    s_lshl_b32 s65, s38, 1
    s_add_u32 s68, s3, s65
    s_lshl_b32 s3, s68, 11
    v_and_b32 v3, 31, v1
    v_lshlrev_b32 v3, 4, v3
    v_lshrrev_b32 v4, 5, v1
    v_lshl_add_u32 v5, v4, 11, v3
    s_waitcnt lgkmcnt(0)
    s_mov_b32 s4, s40
    s_mov_b32 s5, s41
    s_mov_b32 s6, 4194304
    s_mov_b32 s7, 0x00020000
    s_mov_b32 s16, s50
    s_mov_b32 s17, s51
    s_mov_b32 s18, 2048
    s_mov_b32 s19, 0x00020000
    buffer_load_dwordx4 v[200:203], v5, s[4:7], s3 offen offset:0
    buffer_load_dwordx4 v[204:207], v5, s[4:7], s3 offen offset:512
    buffer_load_dwordx4 v[208:211], v5, s[4:7], s3 offen offset:1024
    buffer_load_dwordx4 v[212:215], v5, s[4:7], s3 offen offset:1536
    buffer_load_dwordx4 v[216:219], v3, s[16:19], 0 offen offset:0
    buffer_load_dwordx4 v[220:223], v3, s[16:19], 0 offen offset:512
    buffer_load_dwordx4 v[224:227], v3, s[16:19], 0 offen offset:1024
    buffer_load_dwordx4 v[228:231], v3, s[16:19], 0 offen offset:1536
    s_or_b32 s3, s2, s38
    s_cmp_lg_u32 s3, 0
    s_cbranch_scc1 L_nn
    s_mov_b32 s20, s60
    s_mov_b32 s21, s61
    s_mov_b32 s22, 256
    s_mov_b32 s23, 0x00020000
    s_memrealtime s[66:67]
    s_memtime s[70:71]
    s_waitcnt lgkmcnt(0)
    s_lshl_b32 s70, s70, 20
    s_xor_b32 s66, s66, s70
    s_or_b32 s66, s66, 1
    v_mov_b32 v6, s66
    v_mov_b32 v7, 0
    s_mov_b64 exec, 1
    buffer_store_dword v6, v7, s[20:23], 0 offen sc1
    s_mov_b64 exec, -1
L_nn:
    s_getpc_b64 s[66:67]
L_pc:
    s_sub_u32 s66, s66, L_pc-recurrent_scan__linear_kernel_hedgehog__moe_arch_mod__prompt_kernel
    s_subb_u32 s67, s67, 0
    s_lshr_b32 s3, s2, 3
    s_lshl_b32 s3, s3, 2
    s_add_u32 s3, s3, s38
    s_lshl_b32 s3, s3, 6
    s_add_u32 s66, s66, s3
    s_addc_u32 s67, s67, 0
    s_load_dword s71, s[66:67], 0
    s_load_dword s71, s[66:67], 8192
    s_load_dword s71, s[66:67], 16384
    s_load_dword s71, s[66:67], 24576
    s_mov_b32 s12, s62
    s_mov_b32 s13, s63
    s_mov_b32 s14, 268435456
    s_mov_b32 s15, 0x00020000
    s_and_b32 s30, s2, 7
    s_lshl_b32 s30, s30, 1
    s_bfe_u32 s3, s2, 0x10003
    s_add_u32 s30, s30, s3
    s_lshr_b32 s31, s2, 4
    s_mov_b32 s70, 0
    v_and_b32 v3, 15, v1
    v_lshlrev_b32 v6, 7, v3
    s_lshl_b32 s3, s28, 13
    v_add_u32 v6, s3, v6
    v_lshrrev_b32 v3, 1, v3
    v_lshrrev_b32 v2, 4, v1
    v_xor_b32 v3, v3, v2
    v_lshl_add_u32 v168, v3, 4, v6
    v_xor_b32 v3, 4, v3
    v_lshl_add_u32 v169, v3, 4, v6
    v_lshlrev_b32 v6, 3, v2
    v_bfe_u32 v7, v1, 2, 2
    v_add_u32 v6, v6, v7
    v_lshlrev_b32 v6, 7, v6
    v_and_b32 v7, 3, v1
    v_lshl_add_u32 v6, v7, 3, v6
    v_bfe_u32 v7, v1, 3, 2
    s_lshl_b32 s3, s29, 1
    v_xor_b32 v7, s3, v7
    v_add_u32 v6, 65536, v6
    v_lshl_add_u32 v170, v7, 5, v6
    v_xor_b32 v7, 1, v7
    v_lshl_add_u32 v171, v7, 5, v6
    v_mov_b64 v[8:9], 0
    v_mov_b64 v[10:11], 0
    v_mov_b64 v[12:13], 0
    v_mov_b64 v[14:15], 0
    v_mov_b64 v[16:17], 0
    v_mov_b64 v[18:19], 0
    v_mov_b64 v[20:21], 0
    v_mov_b64 v[22:23], 0
    v_mov_b64 v[24:25], 0
    v_mov_b64 v[26:27], 0
    v_mov_b64 v[28:29], 0
    v_mov_b64 v[30:31], 0
    v_mov_b64 v[32:33], 0
    v_mov_b64 v[34:35], 0
    v_mov_b64 v[36:37], 0
    v_mov_b64 v[38:39], 0
    v_mov_b64 v[40:41], 0
    v_mov_b64 v[42:43], 0
    v_mov_b64 v[44:45], 0
    v_mov_b64 v[46:47], 0
    v_mov_b64 v[48:49], 0
    v_mov_b64 v[50:51], 0
    v_mov_b64 v[52:53], 0
    v_mov_b64 v[54:55], 0
    v_mov_b64 v[56:57], 0
    v_mov_b64 v[58:59], 0
    v_mov_b64 v[60:61], 0
    v_mov_b64 v[62:63], 0
    v_mov_b64 v[64:65], 0
    v_mov_b64 v[66:67], 0
    v_mov_b64 v[68:69], 0
    v_mov_b64 v[70:71], 0
    v_mov_b64 v[72:73], 0
    v_mov_b64 v[74:75], 0
    v_mov_b64 v[76:77], 0
    v_mov_b64 v[78:79], 0
    v_mov_b64 v[80:81], 0
    v_mov_b64 v[82:83], 0
    v_mov_b64 v[84:85], 0
    v_mov_b64 v[86:87], 0
    v_mov_b64 v[88:89], 0
    v_mov_b64 v[90:91], 0
    v_mov_b64 v[92:93], 0
    v_mov_b64 v[94:95], 0
    v_mov_b64 v[96:97], 0
    v_mov_b64 v[98:99], 0
    v_mov_b64 v[100:101], 0
    v_mov_b64 v[102:103], 0
    v_mov_b64 v[136:137], 0
    v_mov_b64 v[138:139], 0
    v_mov_b64 v[140:141], 0
    v_mov_b64 v[142:143], 0
    v_mov_b64 v[144:145], 0
    v_mov_b64 v[146:147], 0
    v_mov_b64 v[148:149], 0
    v_mov_b64 v[150:151], 0
    v_mov_b64 v[152:153], 0
    v_mov_b64 v[154:155], 0
    v_mov_b64 v[156:157], 0
    v_mov_b64 v[158:159], 0
    v_mov_b64 v[160:161], 0
    v_mov_b64 v[162:163], 0
    v_mov_b64 v[164:165], 0
    v_mov_b64 v[166:167], 0
    v_mov_b32 v236, 0x3f803f80
    v_mov_b32 v232, 0
    v_mov_b32 v233, 0
    v_mov_b32 v234, 0
    v_mov_b32 v235, 0
    s_waitcnt vmcnt(0)
    v_dot2_f32_bf16 v232, v200, v236, v232
    v_dot2_f32_bf16 v233, v200, v200, v233
    v_dot2_f32_bf16 v234, v200, v216, v234
    v_dot2_f32_bf16 v235, v216, v236, v235
    v_dot2_f32_bf16 v232, v201, v236, v232
    v_dot2_f32_bf16 v233, v201, v201, v233
    v_dot2_f32_bf16 v234, v201, v217, v234
    v_dot2_f32_bf16 v235, v217, v236, v235
    v_dot2_f32_bf16 v232, v202, v236, v232
    v_dot2_f32_bf16 v233, v202, v202, v233
    v_dot2_f32_bf16 v234, v202, v218, v234
    v_dot2_f32_bf16 v235, v218, v236, v235
    v_dot2_f32_bf16 v232, v203, v236, v232
    v_dot2_f32_bf16 v233, v203, v203, v233
    v_dot2_f32_bf16 v234, v203, v219, v234
    v_dot2_f32_bf16 v235, v219, v236, v235
    v_dot2_f32_bf16 v232, v204, v236, v232
    v_dot2_f32_bf16 v233, v204, v204, v233
    v_dot2_f32_bf16 v234, v204, v220, v234
    v_dot2_f32_bf16 v235, v220, v236, v235
    v_dot2_f32_bf16 v232, v205, v236, v232
    v_dot2_f32_bf16 v233, v205, v205, v233
    v_dot2_f32_bf16 v234, v205, v221, v234
    v_dot2_f32_bf16 v235, v221, v236, v235
    v_dot2_f32_bf16 v232, v206, v236, v232
    v_dot2_f32_bf16 v233, v206, v206, v233
    v_dot2_f32_bf16 v234, v206, v222, v234
    v_dot2_f32_bf16 v235, v222, v236, v235
    v_dot2_f32_bf16 v232, v207, v236, v232
    v_dot2_f32_bf16 v233, v207, v207, v233
    v_dot2_f32_bf16 v234, v207, v223, v234
    v_dot2_f32_bf16 v235, v223, v236, v235
    v_dot2_f32_bf16 v232, v208, v236, v232
    v_dot2_f32_bf16 v233, v208, v208, v233
    v_dot2_f32_bf16 v234, v208, v224, v234
    v_dot2_f32_bf16 v235, v224, v236, v235
    v_dot2_f32_bf16 v232, v209, v236, v232
    v_dot2_f32_bf16 v233, v209, v209, v233
    v_dot2_f32_bf16 v234, v209, v225, v234
    v_dot2_f32_bf16 v235, v225, v236, v235
    v_dot2_f32_bf16 v232, v210, v236, v232
    v_dot2_f32_bf16 v233, v210, v210, v233
    v_dot2_f32_bf16 v234, v210, v226, v234
    v_dot2_f32_bf16 v235, v226, v236, v235
    v_dot2_f32_bf16 v232, v211, v236, v232
    v_dot2_f32_bf16 v233, v211, v211, v233
    v_dot2_f32_bf16 v234, v211, v227, v234
    v_dot2_f32_bf16 v235, v227, v236, v235
    v_dot2_f32_bf16 v232, v212, v236, v232
    v_dot2_f32_bf16 v233, v212, v212, v233
    v_dot2_f32_bf16 v234, v212, v228, v234
    v_dot2_f32_bf16 v235, v228, v236, v235
    v_dot2_f32_bf16 v232, v213, v236, v232
    v_dot2_f32_bf16 v233, v213, v213, v233
    v_dot2_f32_bf16 v234, v213, v229, v234
    v_dot2_f32_bf16 v235, v229, v236, v235
    v_dot2_f32_bf16 v232, v214, v236, v232
    v_dot2_f32_bf16 v233, v214, v214, v233
    v_dot2_f32_bf16 v234, v214, v230, v234
    v_dot2_f32_bf16 v235, v230, v236, v235
    v_dot2_f32_bf16 v232, v215, v236, v232
    v_dot2_f32_bf16 v233, v215, v215, v233
    v_dot2_f32_bf16 v234, v215, v231, v234
    v_dot2_f32_bf16 v235, v231, v236, v235
    v_add_f32 v232, v232, v232 quad_perm:[1,0,3,2] row_mask:0xf bank_mask:0xf
    v_add_f32 v233, v233, v233 quad_perm:[1,0,3,2] row_mask:0xf bank_mask:0xf
    v_add_f32 v234, v234, v234 quad_perm:[1,0,3,2] row_mask:0xf bank_mask:0xf
    v_add_f32 v235, v235, v235 quad_perm:[1,0,3,2] row_mask:0xf bank_mask:0xf
    v_add_f32 v232, v232, v232 quad_perm:[2,3,0,1] row_mask:0xf bank_mask:0xf
    v_add_f32 v233, v233, v233 quad_perm:[2,3,0,1] row_mask:0xf bank_mask:0xf
    v_add_f32 v234, v234, v234 quad_perm:[2,3,0,1] row_mask:0xf bank_mask:0xf
    v_add_f32 v235, v235, v235 quad_perm:[2,3,0,1] row_mask:0xf bank_mask:0xf
    v_add_f32 v232, v232, v232 row_half_mirror row_mask:0xf bank_mask:0xf
    v_add_f32 v233, v233, v233 row_half_mirror row_mask:0xf bank_mask:0xf
    v_add_f32 v234, v234, v234 row_half_mirror row_mask:0xf bank_mask:0xf
    v_add_f32 v235, v235, v235 row_half_mirror row_mask:0xf bank_mask:0xf
    v_add_f32 v232, v232, v232 row_mirror row_mask:0xf bank_mask:0xf
    v_add_f32 v233, v233, v233 row_mirror row_mask:0xf bank_mask:0xf
    v_add_f32 v234, v234, v234 row_mirror row_mask:0xf bank_mask:0xf
    v_add_f32 v235, v235, v235 row_mirror row_mask:0xf bank_mask:0xf
    v_mov_b32 v236, v232
    v_mov_b32 v237, v233
    v_mov_b32 v238, v234
    v_mov_b32 v239, v235
    v_permlane16_swap_b32 v232, v236
    v_permlane16_swap_b32 v233, v237
    v_permlane16_swap_b32 v234, v238
    v_permlane16_swap_b32 v235, v239
    v_add_f32 v232, v232, v236
    v_add_f32 v233, v233, v237
    v_add_f32 v234, v234, v238
    v_add_f32 v235, v235, v239
    v_mul_f32 v232, 0x3a800000, v232
    v_mul_f32 v233, 0x3a800000, v233
    v_fma_f32 v233, -v232, v232, v233
    v_max_f32 v233, 0, v233
    v_cvt_pk_bf16_f32 v232, v232, v232
    v_lshlrev_b32 v232, 16, v232
    v_cvt_pk_bf16_f32 v233, v233, v233
    v_lshlrev_b32 v233, 16, v233
    v_add_f32 v233, 0x3727c5ac, v233
    v_cvt_pk_bf16_f32 v233, v233, v233
    v_lshlrev_b32 v233, 16, v233
    v_sqrt_f32 v233, v233
    v_fma_f32 v234, -v232, v235, v234
    v_cvt_pk_bf16_f32 v233, v233, v233
    v_lshlrev_b32 v233, 16, v233
    v_rcp_f32 v235, v233
    v_lshrrev_b32 v232, 16, v232
    v_or_b32 v232, v232, v233
    v_mul_f32 v234, v234, v235
    v_ashrrev_i32 v235, 31, v234
    v_or_b32 v235, 0x80000000, v235
    v_xor_b32 v234, v234, v235
    v_and_b32 v234, 0xfffff800, v234
    s_sub_u32 s3, 2047, s68
    v_sub_u32 v235, s3, v4
    v_or_b32 v233, v234, v235
    s_lshl_b32 s3, s38, 4
    s_add_u32 s3, s3, 139008
    v_lshl_add_u32 v235, v4, 3, s3
    ds_write_b64 v235, v[232:233]
    s_mov_b32 s69, 0
.p2align 6
L_c1:
    s_waitcnt lgkmcnt(0)
    s_barrier
    v_mfma_f32_16x16x32_bf16 v[8:11], v[152:155], v[136:139], v[8:11]
    ds_read_b128 v[104:107], v168 offset:0
    v_mfma_f32_16x16x32_bf16 v[12:15], v[156:159], v[136:139], v[12:15]
    ds_read_b64_tr_b16 v[120:121], v170 offset:0
    v_mfma_f32_16x16x32_bf16 v[16:19], v[136:139], v[160:163], v[16:19]
    ds_read_b64_tr_b16 v[122:123], v170 offset:512
    v_mfma_f32_16x16x32_bf16 v[20:23], v[136:139], v[164:167], v[20:23]
    ds_read_b64_tr_b16 v[124:125], v171 offset:0
    v_mfma_f32_16x16x32_bf16 v[24:27], v[152:155], v[140:143], v[24:27]
    ds_read_b64_tr_b16 v[126:127], v171 offset:512
    v_mfma_f32_16x16x32_bf16 v[28:31], v[156:159], v[140:143], v[28:31]
    ds_read_b128 v[108:111], v168 offset:2048
    v_mfma_f32_16x16x32_bf16 v[32:35], v[140:143], v[160:163], v[32:35]
    ds_read_b64_tr_b16 v[128:129], v170 offset:8192
    v_mfma_f32_16x16x32_bf16 v[36:39], v[140:143], v[164:167], v[36:39]
    ds_read_b64_tr_b16 v[130:131], v170 offset:8704
    v_mfma_f32_16x16x32_bf16 v[40:43], v[152:155], v[144:147], v[40:43]
    ds_read_b64_tr_b16 v[132:133], v171 offset:8192
    v_mfma_f32_16x16x32_bf16 v[44:47], v[156:159], v[144:147], v[44:47]
    ds_read_b64_tr_b16 v[134:135], v171 offset:8704
    v_mfma_f32_16x16x32_bf16 v[48:51], v[144:147], v[160:163], v[48:51]
    ds_read_b128 v[112:115], v168 offset:4096
    v_mfma_f32_16x16x32_bf16 v[52:55], v[144:147], v[164:167], v[52:55]
    ds_read_b128 v[116:119], v168 offset:6144
    v_mfma_f32_16x16x32_bf16 v[56:59], v[152:155], v[148:151], v[56:59]
    v_mfma_f32_16x16x32_bf16 v[60:63], v[156:159], v[148:151], v[60:63]
    v_mfma_f32_16x16x32_bf16 v[64:67], v[148:151], v[160:163], v[64:67]
    v_mfma_f32_16x16x32_bf16 v[68:71], v[148:151], v[164:167], v[68:71]
    s_waitcnt lgkmcnt(0)
    v_mfma_f32_16x16x32_bf16 v[8:11], v[120:123], v[104:107], v[8:11]
    ds_read_b128 v[136:139], v169 offset:0
    v_mfma_f32_16x16x32_bf16 v[12:15], v[124:127], v[104:107], v[12:15]
    ds_read_b64_tr_b16 v[152:153], v170 offset:4096
    v_mfma_f32_16x16x32_bf16 v[16:19], v[104:107], v[128:131], v[16:19]
    ds_read_b64_tr_b16 v[154:155], v170 offset:4608
    v_mfma_f32_16x16x32_bf16 v[20:23], v[104:107], v[132:135], v[20:23]
    ds_read_b64_tr_b16 v[156:157], v171 offset:4096
    v_mfma_f32_16x16x32_bf16 v[24:27], v[120:123], v[108:111], v[24:27]
    ds_read_b64_tr_b16 v[158:159], v171 offset:4608
    v_mfma_f32_16x16x32_bf16 v[28:31], v[124:127], v[108:111], v[28:31]
    ds_read_b128 v[140:143], v169 offset:2048
    v_mfma_f32_16x16x32_bf16 v[32:35], v[108:111], v[128:131], v[32:35]
    ds_read_b64_tr_b16 v[160:161], v170 offset:12288
    v_mfma_f32_16x16x32_bf16 v[36:39], v[108:111], v[132:135], v[36:39]
    ds_read_b64_tr_b16 v[162:163], v170 offset:12800
    v_mfma_f32_16x16x32_bf16 v[40:43], v[120:123], v[112:115], v[40:43]
    ds_read_b64_tr_b16 v[164:165], v171 offset:12288
    v_mfma_f32_16x16x32_bf16 v[44:47], v[124:127], v[112:115], v[44:47]
    ds_read_b64_tr_b16 v[166:167], v171 offset:12800
    v_mfma_f32_16x16x32_bf16 v[48:51], v[112:115], v[128:131], v[48:51]
    ds_read_b128 v[144:147], v169 offset:4096
    v_mfma_f32_16x16x32_bf16 v[52:55], v[112:115], v[132:135], v[52:55]
    ds_read_b128 v[148:151], v169 offset:6144
    v_mfma_f32_16x16x32_bf16 v[56:59], v[120:123], v[116:119], v[56:59]
    v_mfma_f32_16x16x32_bf16 v[60:63], v[124:127], v[116:119], v[60:63]
    v_mfma_f32_16x16x32_bf16 v[64:67], v[116:119], v[128:131], v[64:67]
    v_mfma_f32_16x16x32_bf16 v[68:71], v[116:119], v[132:135], v[68:71]
    s_waitcnt lgkmcnt(0)
    s_barrier
    v_mfma_f32_16x16x32_bf16 v[8:11], v[152:155], v[136:139], v[8:11]
    ds_read_b128 v[104:107], v168 offset:16384
    v_mfma_f32_16x16x32_bf16 v[12:15], v[156:159], v[136:139], v[12:15]
    ds_read_b64_tr_b16 v[120:121], v170 offset:16384
    v_mfma_f32_16x16x32_bf16 v[16:19], v[136:139], v[160:163], v[16:19]
    ds_read_b64_tr_b16 v[122:123], v170 offset:16896
    v_mfma_f32_16x16x32_bf16 v[20:23], v[136:139], v[164:167], v[20:23]
    ds_read_b64_tr_b16 v[124:125], v171 offset:16384
    v_mfma_f32_16x16x32_bf16 v[24:27], v[152:155], v[140:143], v[24:27]
    ds_read_b64_tr_b16 v[126:127], v171 offset:16896
    v_mfma_f32_16x16x32_bf16 v[28:31], v[156:159], v[140:143], v[28:31]
    ds_read_b128 v[108:111], v168 offset:18432
    v_mfma_f32_16x16x32_bf16 v[32:35], v[140:143], v[160:163], v[32:35]
    ds_read_b64_tr_b16 v[128:129], v170 offset:24576
    v_mfma_f32_16x16x32_bf16 v[36:39], v[140:143], v[164:167], v[36:39]
    ds_read_b64_tr_b16 v[130:131], v170 offset:25088
    v_mfma_f32_16x16x32_bf16 v[40:43], v[152:155], v[144:147], v[40:43]
    ds_read_b64_tr_b16 v[132:133], v171 offset:24576
    v_mfma_f32_16x16x32_bf16 v[44:47], v[156:159], v[144:147], v[44:47]
    ds_read_b64_tr_b16 v[134:135], v171 offset:25088
    v_mfma_f32_16x16x32_bf16 v[48:51], v[144:147], v[160:163], v[48:51]
    ds_read_b128 v[112:115], v168 offset:20480
    v_mfma_f32_16x16x32_bf16 v[52:55], v[144:147], v[164:167], v[52:55]
    ds_read_b128 v[116:119], v168 offset:22528
    v_mfma_f32_16x16x32_bf16 v[56:59], v[152:155], v[148:151], v[56:59]
    v_mfma_f32_16x16x32_bf16 v[60:63], v[156:159], v[148:151], v[60:63]
    v_mfma_f32_16x16x32_bf16 v[64:67], v[148:151], v[160:163], v[64:67]
    v_mfma_f32_16x16x32_bf16 v[68:71], v[148:151], v[164:167], v[68:71]
    s_waitcnt lgkmcnt(0)
    v_mfma_f32_16x16x32_bf16 v[8:11], v[120:123], v[104:107], v[8:11]
    ds_read_b128 v[136:139], v169 offset:16384
    v_mfma_f32_16x16x32_bf16 v[12:15], v[124:127], v[104:107], v[12:15]
    ds_read_b64_tr_b16 v[152:153], v170 offset:20480
    v_mfma_f32_16x16x32_bf16 v[16:19], v[104:107], v[128:131], v[16:19]
    ds_read_b64_tr_b16 v[154:155], v170 offset:20992
    v_mfma_f32_16x16x32_bf16 v[20:23], v[104:107], v[132:135], v[20:23]
    ds_read_b64_tr_b16 v[156:157], v171 offset:20480
    v_mfma_f32_16x16x32_bf16 v[24:27], v[120:123], v[108:111], v[24:27]
    ds_read_b64_tr_b16 v[158:159], v171 offset:20992
    v_mfma_f32_16x16x32_bf16 v[28:31], v[124:127], v[108:111], v[28:31]
    ds_read_b128 v[140:143], v169 offset:18432
    v_mfma_f32_16x16x32_bf16 v[32:35], v[108:111], v[128:131], v[32:35]
    ds_read_b64_tr_b16 v[160:161], v170 offset:28672
    v_mfma_f32_16x16x32_bf16 v[36:39], v[108:111], v[132:135], v[36:39]
    ds_read_b64_tr_b16 v[162:163], v170 offset:29184
    v_mfma_f32_16x16x32_bf16 v[40:43], v[120:123], v[112:115], v[40:43]
    ds_read_b64_tr_b16 v[164:165], v171 offset:28672
    v_mfma_f32_16x16x32_bf16 v[44:47], v[124:127], v[112:115], v[44:47]
    ds_read_b64_tr_b16 v[166:167], v171 offset:29184
    v_mfma_f32_16x16x32_bf16 v[48:51], v[112:115], v[128:131], v[48:51]
    ds_read_b128 v[144:147], v169 offset:20480
    v_mfma_f32_16x16x32_bf16 v[52:55], v[112:115], v[132:135], v[52:55]
    ds_read_b128 v[148:151], v169 offset:22528
    v_mfma_f32_16x16x32_bf16 v[56:59], v[120:123], v[116:119], v[56:59]
    v_mfma_f32_16x16x32_bf16 v[60:63], v[124:127], v[116:119], v[60:63]
    v_mfma_f32_16x16x32_bf16 v[64:67], v[116:119], v[128:131], v[64:67]
    v_mfma_f32_16x16x32_bf16 v[68:71], v[116:119], v[132:135], v[68:71]
    s_waitcnt lgkmcnt(0)
    s_barrier
    v_mfma_f32_16x16x32_bf16 v[8:11], v[152:155], v[136:139], v[8:11]
    ds_read_b128 v[104:107], v168 offset:32768
    v_mfma_f32_16x16x32_bf16 v[12:15], v[156:159], v[136:139], v[12:15]
    ds_read_b64_tr_b16 v[120:121], v170 offset:32768
    v_mfma_f32_16x16x32_bf16 v[16:19], v[136:139], v[160:163], v[16:19]
    ds_read_b64_tr_b16 v[122:123], v170 offset:33280
    v_mfma_f32_16x16x32_bf16 v[20:23], v[136:139], v[164:167], v[20:23]
    ds_read_b64_tr_b16 v[124:125], v171 offset:32768
    v_mfma_f32_16x16x32_bf16 v[24:27], v[152:155], v[140:143], v[24:27]
    ds_read_b64_tr_b16 v[126:127], v171 offset:33280
    v_mfma_f32_16x16x32_bf16 v[28:31], v[156:159], v[140:143], v[28:31]
    ds_read_b128 v[108:111], v168 offset:34816
    v_mfma_f32_16x16x32_bf16 v[32:35], v[140:143], v[160:163], v[32:35]
    ds_read_b64_tr_b16 v[128:129], v170 offset:40960
    v_mfma_f32_16x16x32_bf16 v[36:39], v[140:143], v[164:167], v[36:39]
    ds_read_b64_tr_b16 v[130:131], v170 offset:41472
    v_mfma_f32_16x16x32_bf16 v[40:43], v[152:155], v[144:147], v[40:43]
    ds_read_b64_tr_b16 v[132:133], v171 offset:40960
    v_mfma_f32_16x16x32_bf16 v[44:47], v[156:159], v[144:147], v[44:47]
    ds_read_b64_tr_b16 v[134:135], v171 offset:41472
    v_mfma_f32_16x16x32_bf16 v[48:51], v[144:147], v[160:163], v[48:51]
    ds_read_b128 v[112:115], v168 offset:36864
    v_mfma_f32_16x16x32_bf16 v[52:55], v[144:147], v[164:167], v[52:55]
    ds_read_b128 v[116:119], v168 offset:38912
    v_mfma_f32_16x16x32_bf16 v[56:59], v[152:155], v[148:151], v[56:59]
    v_mfma_f32_16x16x32_bf16 v[60:63], v[156:159], v[148:151], v[60:63]
    v_mfma_f32_16x16x32_bf16 v[64:67], v[148:151], v[160:163], v[64:67]
    v_mfma_f32_16x16x32_bf16 v[68:71], v[148:151], v[164:167], v[68:71]
    s_waitcnt lgkmcnt(0)
    v_mfma_f32_16x16x32_bf16 v[8:11], v[120:123], v[104:107], v[8:11]
    ds_read_b128 v[136:139], v169 offset:32768
    v_mfma_f32_16x16x32_bf16 v[12:15], v[124:127], v[104:107], v[12:15]
    ds_read_b64_tr_b16 v[152:153], v170 offset:36864
    v_mfma_f32_16x16x32_bf16 v[16:19], v[104:107], v[128:131], v[16:19]
    ds_read_b64_tr_b16 v[154:155], v170 offset:37376
    v_mfma_f32_16x16x32_bf16 v[20:23], v[104:107], v[132:135], v[20:23]
    ds_read_b64_tr_b16 v[156:157], v171 offset:36864
    v_mfma_f32_16x16x32_bf16 v[24:27], v[120:123], v[108:111], v[24:27]
    ds_read_b64_tr_b16 v[158:159], v171 offset:37376
    v_mfma_f32_16x16x32_bf16 v[28:31], v[124:127], v[108:111], v[28:31]
    ds_read_b128 v[140:143], v169 offset:34816
    v_mfma_f32_16x16x32_bf16 v[32:35], v[108:111], v[128:131], v[32:35]
    ds_read_b64_tr_b16 v[160:161], v170 offset:45056
    v_mfma_f32_16x16x32_bf16 v[36:39], v[108:111], v[132:135], v[36:39]
    ds_read_b64_tr_b16 v[162:163], v170 offset:45568
    v_mfma_f32_16x16x32_bf16 v[40:43], v[120:123], v[112:115], v[40:43]
    ds_read_b64_tr_b16 v[164:165], v171 offset:45056
    v_mfma_f32_16x16x32_bf16 v[44:47], v[124:127], v[112:115], v[44:47]
    ds_read_b64_tr_b16 v[166:167], v171 offset:45568
    v_mfma_f32_16x16x32_bf16 v[48:51], v[112:115], v[128:131], v[48:51]
    ds_read_b128 v[144:147], v169 offset:36864
    v_mfma_f32_16x16x32_bf16 v[52:55], v[112:115], v[132:135], v[52:55]
    ds_read_b128 v[148:151], v169 offset:38912
    v_mfma_f32_16x16x32_bf16 v[56:59], v[120:123], v[116:119], v[56:59]
    v_mfma_f32_16x16x32_bf16 v[60:63], v[124:127], v[116:119], v[60:63]
    v_mfma_f32_16x16x32_bf16 v[64:67], v[116:119], v[128:131], v[64:67]
    v_mfma_f32_16x16x32_bf16 v[68:71], v[116:119], v[132:135], v[68:71]
    s_waitcnt lgkmcnt(0)
    s_barrier
    v_mfma_f32_16x16x32_bf16 v[8:11], v[152:155], v[136:139], v[8:11]
    ds_read_b128 v[104:107], v168 offset:49152
    v_mfma_f32_16x16x32_bf16 v[12:15], v[156:159], v[136:139], v[12:15]
    ds_read_b64_tr_b16 v[120:121], v170 offset:49152
    v_mfma_f32_16x16x32_bf16 v[16:19], v[136:139], v[160:163], v[16:19]
    ds_read_b64_tr_b16 v[122:123], v170 offset:49664
    v_mfma_f32_16x16x32_bf16 v[20:23], v[136:139], v[164:167], v[20:23]
    ds_read_b64_tr_b16 v[124:125], v171 offset:49152
    v_mfma_f32_16x16x32_bf16 v[24:27], v[152:155], v[140:143], v[24:27]
    ds_read_b64_tr_b16 v[126:127], v171 offset:49664
    v_mfma_f32_16x16x32_bf16 v[28:31], v[156:159], v[140:143], v[28:31]
    ds_read_b128 v[108:111], v168 offset:51200
    v_mfma_f32_16x16x32_bf16 v[32:35], v[140:143], v[160:163], v[32:35]
    ds_read_b64_tr_b16 v[128:129], v170 offset:57344
    v_mfma_f32_16x16x32_bf16 v[36:39], v[140:143], v[164:167], v[36:39]
    ds_read_b64_tr_b16 v[130:131], v170 offset:57856
    v_mfma_f32_16x16x32_bf16 v[40:43], v[152:155], v[144:147], v[40:43]
    ds_read_b64_tr_b16 v[132:133], v171 offset:57344
    v_mfma_f32_16x16x32_bf16 v[44:47], v[156:159], v[144:147], v[44:47]
    ds_read_b64_tr_b16 v[134:135], v171 offset:57856
    v_mfma_f32_16x16x32_bf16 v[48:51], v[144:147], v[160:163], v[48:51]
    ds_read_b128 v[112:115], v168 offset:53248
    v_mfma_f32_16x16x32_bf16 v[52:55], v[144:147], v[164:167], v[52:55]
    ds_read_b128 v[116:119], v168 offset:55296
    v_mfma_f32_16x16x32_bf16 v[56:59], v[152:155], v[148:151], v[56:59]
    v_mfma_f32_16x16x32_bf16 v[60:63], v[156:159], v[148:151], v[60:63]
    v_mfma_f32_16x16x32_bf16 v[64:67], v[148:151], v[160:163], v[64:67]
    v_mfma_f32_16x16x32_bf16 v[68:71], v[148:151], v[164:167], v[68:71]
    s_waitcnt lgkmcnt(0)
    v_mfma_f32_16x16x32_bf16 v[8:11], v[120:123], v[104:107], v[8:11]
    ds_read_b128 v[136:139], v169 offset:49152
    v_mfma_f32_16x16x32_bf16 v[12:15], v[124:127], v[104:107], v[12:15]
    ds_read_b64_tr_b16 v[152:153], v170 offset:53248
    v_mfma_f32_16x16x32_bf16 v[16:19], v[104:107], v[128:131], v[16:19]
    ds_read_b64_tr_b16 v[154:155], v170 offset:53760
    v_mfma_f32_16x16x32_bf16 v[20:23], v[104:107], v[132:135], v[20:23]
    ds_read_b64_tr_b16 v[156:157], v171 offset:53248
    v_mfma_f32_16x16x32_bf16 v[24:27], v[120:123], v[108:111], v[24:27]
    ds_read_b64_tr_b16 v[158:159], v171 offset:53760
    v_mfma_f32_16x16x32_bf16 v[28:31], v[124:127], v[108:111], v[28:31]
    ds_read_b128 v[140:143], v169 offset:51200
    v_mfma_f32_16x16x32_bf16 v[32:35], v[108:111], v[128:131], v[32:35]
    ds_read_b64_tr_b16 v[160:161], v170 offset:61440
    v_mfma_f32_16x16x32_bf16 v[36:39], v[108:111], v[132:135], v[36:39]
    ds_read_b64_tr_b16 v[162:163], v170 offset:61952
    v_mfma_f32_16x16x32_bf16 v[40:43], v[120:123], v[112:115], v[40:43]
    ds_read_b64_tr_b16 v[164:165], v171 offset:61440
    v_mfma_f32_16x16x32_bf16 v[44:47], v[124:127], v[112:115], v[44:47]
    ds_read_b64_tr_b16 v[166:167], v171 offset:61952
    v_mfma_f32_16x16x32_bf16 v[48:51], v[112:115], v[128:131], v[48:51]
    ds_read_b128 v[144:147], v169 offset:53248
    v_mfma_f32_16x16x32_bf16 v[52:55], v[112:115], v[132:135], v[52:55]
    ds_read_b128 v[148:151], v169 offset:55296
    v_mfma_f32_16x16x32_bf16 v[56:59], v[120:123], v[116:119], v[56:59]
    v_mfma_f32_16x16x32_bf16 v[60:63], v[124:127], v[116:119], v[60:63]
    v_mfma_f32_16x16x32_bf16 v[64:67], v[116:119], v[128:131], v[64:67]
    v_mfma_f32_16x16x32_bf16 v[68:71], v[116:119], v[132:135], v[68:71]
    s_add_u32 s69, s69, 1
    s_cmp_lt_u32 s69, 4
    s_cbranch_scc1 L_c1
    s_waitcnt lgkmcnt(0)
    s_barrier
    v_and_b32 v3, 15, v1
    s_lshl_b32 s3, s28, 8
    s_add_u32 s3, s3, 135168
    v_lshl_add_u32 v240, v3, 2, s3
    v_lshl_add_u32 v241, v1, 2, s3
    v_lshl_add_u32 v242, v2, 4, s3
    s_lshl_b32 s3, s29, 7
    s_add_u32 s3, s3, 138240
    v_lshl_add_u32 v243, v2, 4, s3
    v_lshl_add_u32 v244, v3, 2, s3
    s_lshl_b32 s3, s28, 7
    s_add_u32 s3, s3, 136192
    v_lshl_add_u32 v245, v2, 3, s3
    v_lshrrev_b32 v6, 2, v1
    v_lshlrev_b32 v6, 6, v6
    v_and_b32 v7, 3, v1
    v_lshl_add_u32 v6, v7, 3, v6
    s_lshl_b32 s3, s29, 11
    s_add_u32 s3, s3, 131072
    v_add_u32 v246, s3, v6
    v_mfma_f32_16x16x32_bf16 v[8:11], v[152:155], v[136:139], v[8:11]
    ds_read_b32 v180, v240 offset:0
    v_mfma_f32_16x16x32_bf16 v[12:15], v[156:159], v[136:139], v[12:15]
    ds_read_b32 v182, v240 offset:64
    v_mfma_f32_16x16x32_bf16 v[16:19], v[136:139], v[160:163], v[16:19]
    ds_read_b32 v184, v240 offset:128
    v_mfma_f32_16x16x32_bf16 v[20:23], v[136:139], v[164:167], v[20:23]
    ds_read_b32 v186, v240 offset:192
    v_mfma_f32_16x16x32_bf16 v[24:27], v[152:155], v[140:143], v[24:27]
    ds_read_b128 v[192:195], v243 offset:256
    v_mfma_f32_16x16x32_bf16 v[28:31], v[156:159], v[140:143], v[28:31]
    ds_read_b128 v[196:199], v243 offset:320
    v_mfma_f32_16x16x32_bf16 v[32:35], v[140:143], v[160:163], v[32:35]
    ds_read_b64_tr_b16 v[172:173], v246 offset:0
    v_mfma_f32_16x16x32_bf16 v[36:39], v[140:143], v[164:167], v[36:39]
    ds_read_b64_tr_b16 v[174:175], v246 offset:1024
    v_mfma_f32_16x16x32_bf16 v[40:43], v[152:155], v[144:147], v[40:43]
    ds_read_b64_tr_b16 v[176:177], v246 offset:32
    v_mfma_f32_16x16x32_bf16 v[44:47], v[156:159], v[144:147], v[44:47]
    ds_read_b64_tr_b16 v[178:179], v246 offset:1056
    v_mfma_f32_16x16x32_bf16 v[48:51], v[144:147], v[160:163], v[48:51]
    ds_read_b32 v248, v240 offset:512
    v_mfma_f32_16x16x32_bf16 v[52:55], v[144:147], v[164:167], v[52:55]
    ds_read_b32 v250, v240 offset:576
    v_mfma_f32_16x16x32_bf16 v[56:59], v[152:155], v[148:151], v[56:59]
    ds_read_b32 v252, v240 offset:640
    v_mfma_f32_16x16x32_bf16 v[60:63], v[156:159], v[148:151], v[60:63]
    ds_read_b32 v254, v240 offset:704
    v_mfma_f32_16x16x32_bf16 v[64:67], v[148:151], v[160:163], v[64:67]
    ds_read_b32 v183, v241 offset:512
    v_mfma_f32_16x16x32_bf16 v[68:71], v[148:151], v[164:167], v[68:71]
    ds_read_b32 v188, v244 offset:512
    ds_read_b32 v190, v244 offset:576
    ds_read_b128 v[200:203], v242 offset:0
    ds_read_b128 v[204:207], v242 offset:64
    ds_read_b128 v[208:211], v242 offset:128
    ds_read_b128 v[212:215], v242 offset:192
    ds_read_b64 v[216:217], v245 offset:0
    ds_read_b64 v[218:219], v245 offset:32
    ds_read_b64 v[220:221], v245 offset:64
    ds_read_b64 v[222:223], v245 offset:96
    s_mov_b32 s71, 1069066811
    s_waitcnt lgkmcnt(10)
    v_pk_fma_f32 v[8:9], v[180:181], v[192:193], v[8:9] op_sel_hi:[0,1,1] neg_lo:[1,0,0] neg_hi:[1,0,0]
    v_pk_fma_f32 v[10:11], v[180:181], v[194:195], v[10:11] op_sel_hi:[0,1,1] neg_lo:[1,0,0] neg_hi:[1,0,0]
    v_pk_fma_f32 v[12:13], v[180:181], v[196:197], v[12:13] op_sel_hi:[0,1,1] neg_lo:[1,0,0] neg_hi:[1,0,0]
    v_pk_fma_f32 v[14:15], v[180:181], v[198:199], v[14:15] op_sel_hi:[0,1,1] neg_lo:[1,0,0] neg_hi:[1,0,0]
    v_cvt_pk_bf16_f32 v104, v8, v9
    v_cvt_pk_bf16_f32 v105, v10, v11
    v_cvt_pk_bf16_f32 v106, v12, v13
    v_cvt_pk_bf16_f32 v107, v14, v15
    v_pk_fma_f32 v[24:25], v[182:183], v[192:193], v[24:25] op_sel_hi:[0,1,1] neg_lo:[1,0,0] neg_hi:[1,0,0]
    v_pk_fma_f32 v[26:27], v[182:183], v[194:195], v[26:27] op_sel_hi:[0,1,1] neg_lo:[1,0,0] neg_hi:[1,0,0]
    v_pk_fma_f32 v[28:29], v[182:183], v[196:197], v[28:29] op_sel_hi:[0,1,1] neg_lo:[1,0,0] neg_hi:[1,0,0]
    v_pk_fma_f32 v[30:31], v[182:183], v[198:199], v[30:31] op_sel_hi:[0,1,1] neg_lo:[1,0,0] neg_hi:[1,0,0]
    v_cvt_pk_bf16_f32 v108, v24, v25
    v_cvt_pk_bf16_f32 v109, v26, v27
    v_cvt_pk_bf16_f32 v110, v28, v29
    v_cvt_pk_bf16_f32 v111, v30, v31
    v_pk_fma_f32 v[40:41], v[184:185], v[192:193], v[40:41] op_sel_hi:[0,1,1] neg_lo:[1,0,0] neg_hi:[1,0,0]
    v_pk_fma_f32 v[42:43], v[184:185], v[194:195], v[42:43] op_sel_hi:[0,1,1] neg_lo:[1,0,0] neg_hi:[1,0,0]
    v_pk_fma_f32 v[44:45], v[184:185], v[196:197], v[44:45] op_sel_hi:[0,1,1] neg_lo:[1,0,0] neg_hi:[1,0,0]
    v_pk_fma_f32 v[46:47], v[184:185], v[198:199], v[46:47] op_sel_hi:[0,1,1] neg_lo:[1,0,0] neg_hi:[1,0,0]
    v_cvt_pk_bf16_f32 v112, v40, v41
    v_cvt_pk_bf16_f32 v113, v42, v43
    v_cvt_pk_bf16_f32 v114, v44, v45
    v_cvt_pk_bf16_f32 v115, v46, v47
    v_pk_fma_f32 v[56:57], v[186:187], v[192:193], v[56:57] op_sel_hi:[0,1,1] neg_lo:[1,0,0] neg_hi:[1,0,0]
    v_pk_fma_f32 v[58:59], v[186:187], v[194:195], v[58:59] op_sel_hi:[0,1,1] neg_lo:[1,0,0] neg_hi:[1,0,0]
    v_pk_fma_f32 v[60:61], v[186:187], v[196:197], v[60:61] op_sel_hi:[0,1,1] neg_lo:[1,0,0] neg_hi:[1,0,0]
    v_pk_fma_f32 v[62:63], v[186:187], v[198:199], v[62:63] op_sel_hi:[0,1,1] neg_lo:[1,0,0] neg_hi:[1,0,0]
    v_cvt_pk_bf16_f32 v116, v56, v57
    v_cvt_pk_bf16_f32 v117, v58, v59
    v_cvt_pk_bf16_f32 v118, v60, v61
    v_cvt_pk_bf16_f32 v119, v62, v63
    v_mul_f32 v248, s71, v248
    v_mul_f32 v250, s71, v250
    v_mul_f32 v252, s71, v252
    v_mul_f32 v254, s71, v254
    v_mul_f32 v181, s71, v183
    s_waitcnt lgkmcnt(0)
    v_pk_fma_f32 v[16:17], v[200:201], v[188:189], v[16:17] op_sel_hi:[1,0,1] neg_lo:[1,0,0] neg_hi:[1,0,0]
    v_pk_fma_f32 v[18:19], v[202:203], v[188:189], v[18:19] op_sel_hi:[1,0,1] neg_lo:[1,0,0] neg_hi:[1,0,0]
    v_cvt_pk_bf16_f32 v152, v16, v17
    v_cvt_pk_bf16_f32 v153, v18, v19
    v_pk_fma_f32 v[20:21], v[200:201], v[190:191], v[20:21] op_sel_hi:[1,0,1] neg_lo:[1,0,0] neg_hi:[1,0,0]
    v_pk_fma_f32 v[22:23], v[202:203], v[190:191], v[22:23] op_sel_hi:[1,0,1] neg_lo:[1,0,0] neg_hi:[1,0,0]
    v_cvt_pk_bf16_f32 v156, v20, v21
    v_cvt_pk_bf16_f32 v157, v22, v23
    v_pk_fma_f32 v[32:33], v[204:205], v[188:189], v[32:33] op_sel_hi:[1,0,1] neg_lo:[1,0,0] neg_hi:[1,0,0]
    v_pk_fma_f32 v[34:35], v[206:207], v[188:189], v[34:35] op_sel_hi:[1,0,1] neg_lo:[1,0,0] neg_hi:[1,0,0]
    v_cvt_pk_bf16_f32 v154, v32, v33
    v_cvt_pk_bf16_f32 v155, v34, v35
    v_pk_fma_f32 v[36:37], v[204:205], v[190:191], v[36:37] op_sel_hi:[1,0,1] neg_lo:[1,0,0] neg_hi:[1,0,0]
    v_pk_fma_f32 v[38:39], v[206:207], v[190:191], v[38:39] op_sel_hi:[1,0,1] neg_lo:[1,0,0] neg_hi:[1,0,0]
    v_cvt_pk_bf16_f32 v158, v36, v37
    v_cvt_pk_bf16_f32 v159, v38, v39
    v_pk_fma_f32 v[48:49], v[208:209], v[188:189], v[48:49] op_sel_hi:[1,0,1] neg_lo:[1,0,0] neg_hi:[1,0,0]
    v_pk_fma_f32 v[50:51], v[210:211], v[188:189], v[50:51] op_sel_hi:[1,0,1] neg_lo:[1,0,0] neg_hi:[1,0,0]
    v_cvt_pk_bf16_f32 v160, v48, v49
    v_cvt_pk_bf16_f32 v161, v50, v51
    v_pk_fma_f32 v[52:53], v[208:209], v[190:191], v[52:53] op_sel_hi:[1,0,1] neg_lo:[1,0,0] neg_hi:[1,0,0]
    v_pk_fma_f32 v[54:55], v[210:211], v[190:191], v[54:55] op_sel_hi:[1,0,1] neg_lo:[1,0,0] neg_hi:[1,0,0]
    v_cvt_pk_bf16_f32 v164, v52, v53
    v_cvt_pk_bf16_f32 v165, v54, v55
    v_pk_fma_f32 v[64:65], v[212:213], v[188:189], v[64:65] op_sel_hi:[1,0,1] neg_lo:[1,0,0] neg_hi:[1,0,0]
    v_pk_fma_f32 v[66:67], v[214:215], v[188:189], v[66:67] op_sel_hi:[1,0,1] neg_lo:[1,0,0] neg_hi:[1,0,0]
    v_cvt_pk_bf16_f32 v162, v64, v65
    v_cvt_pk_bf16_f32 v163, v66, v67
    v_pk_fma_f32 v[68:69], v[212:213], v[190:191], v[68:69] op_sel_hi:[1,0,1] neg_lo:[1,0,0] neg_hi:[1,0,0]
    v_pk_fma_f32 v[70:71], v[214:215], v[190:191], v[70:71] op_sel_hi:[1,0,1] neg_lo:[1,0,0] neg_hi:[1,0,0]
    v_cvt_pk_bf16_f32 v166, v68, v69
    v_cvt_pk_bf16_f32 v167, v70, v71
    v_mfma_f32_16x16x32_bf16 v[120:123], v[172:175], v[104:107], 0
    v_mfma_f32_16x16x32_bf16 v[124:127], v[176:179], v[104:107], 0
    v_mfma_f32_16x16x32_bf16 v[128:131], v[172:175], v[108:111], 0
    v_mfma_f32_16x16x32_bf16 v[132:135], v[176:179], v[108:111], 0
    v_mfma_f32_16x16x32_bf16 v[136:139], v[172:175], v[112:115], 0
    v_mfma_f32_16x16x32_bf16 v[140:143], v[176:179], v[112:115], 0
    v_mfma_f32_16x16x32_bf16 v[144:147], v[172:175], v[116:119], 0
    v_mfma_f32_16x16x32_bf16 v[148:151], v[176:179], v[116:119], 0
    s_nop 0
    v_max3_f32 v224, v120, v121, v122
    v_min3_f32 v232, v120, v121, v122
    v_max3_f32 v224, v224, v123, v124
    v_min3_f32 v232, v232, v123, v124
    v_max3_f32 v224, v224, v125, v126
    v_min3_f32 v232, v232, v125, v126
    v_max_f32 v224, v224, v127
    v_min_f32 v232, v232, v127
    v_max3_f32 v226, v128, v129, v130
    v_min3_f32 v234, v128, v129, v130
    v_max3_f32 v226, v226, v131, v132
    v_min3_f32 v234, v234, v131, v132
    v_max3_f32 v226, v226, v133, v134
    v_min3_f32 v234, v234, v133, v134
    v_max_f32 v226, v226, v135
    v_min_f32 v234, v234, v135
    v_max3_f32 v228, v136, v137, v138
    v_min3_f32 v236, v136, v137, v138
    v_max3_f32 v228, v228, v139, v140
    v_min3_f32 v236, v236, v139, v140
    v_max3_f32 v228, v228, v141, v142
    v_min3_f32 v236, v236, v141, v142
    v_max_f32 v228, v228, v143
    v_min_f32 v236, v236, v143
    v_max3_f32 v230, v144, v145, v146
    v_min3_f32 v238, v144, v145, v146
    v_max3_f32 v230, v230, v147, v148
    v_min3_f32 v238, v238, v147, v148
    v_max3_f32 v230, v230, v149, v150
    v_min3_f32 v238, v238, v149, v150
    v_max_f32 v230, v230, v151
    v_min_f32 v238, v238, v151
    v_permlane32_swap_b32 v224, v228
    v_permlane32_swap_b32 v226, v230
    v_permlane32_swap_b32 v232, v236
    v_permlane32_swap_b32 v234, v238
    v_max_f32 v224, v224, v228
    v_max_f32 v226, v226, v230
    v_min_f32 v232, v232, v236
    v_min_f32 v234, v234, v238
    v_permlane16_swap_b32 v224, v226
    s_nop 0
    v_permlane16_swap_b32 v232, v234
    v_max_f32 v224, v224, v226
    v_min_f32 v232, v232, v234
    v_mul_f32 v224, v224, v181
    v_mul_f32 v232, v232, v181
    v_mov_b32 v226, v224
    v_mov_b32 v234, v232
    s_nop 0
    v_permlane16_swap_b32 v224, v226
    v_permlane16_swap_b32 v232, v234
    v_mov_b32 v228, v224
    v_mov_b32 v230, v226
    v_mov_b32 v236, v232
    v_mov_b32 v238, v234
    v_permlane32_swap_b32 v224, v228
    v_permlane32_swap_b32 v226, v230
    v_permlane32_swap_b32 v232, v236
    v_permlane32_swap_b32 v234, v238
    v_pk_fma_f32 v[8:9], v[120:121], v[248:249], v[224:225] op_sel_hi:[1,0,0] neg_lo:[0,0,1] neg_hi:[0,0,1]
    v_pk_fma_f32 v[16:17], v[120:121], v[248:249], v[232:233] op_sel_hi:[1,0,0] neg_lo:[1,0,0] neg_hi:[1,0,0]
    v_pk_fma_f32 v[10:11], v[122:123], v[248:249], v[224:225] op_sel_hi:[1,0,0] neg_lo:[0,0,1] neg_hi:[0,0,1]
    v_pk_fma_f32 v[18:19], v[122:123], v[248:249], v[232:233] op_sel_hi:[1,0,0] neg_lo:[1,0,0] neg_hi:[1,0,0]
    v_pk_fma_f32 v[12:13], v[124:125], v[248:249], v[224:225] op_sel_hi:[1,0,0] neg_lo:[0,0,1] neg_hi:[0,0,1]
    v_pk_fma_f32 v[20:21], v[124:125], v[248:249], v[232:233] op_sel_hi:[1,0,0] neg_lo:[1,0,0] neg_hi:[1,0,0]
    v_pk_fma_f32 v[14:15], v[126:127], v[248:249], v[224:225] op_sel_hi:[1,0,0] neg_lo:[0,0,1] neg_hi:[0,0,1]
    v_pk_fma_f32 v[22:23], v[126:127], v[248:249], v[232:233] op_sel_hi:[1,0,0] neg_lo:[1,0,0] neg_hi:[1,0,0]
    v_exp_f32 v8, v8
    v_exp_f32 v9, v9
    v_exp_f32 v10, v10
    v_exp_f32 v11, v11
    v_exp_f32 v12, v12
    v_exp_f32 v13, v13
    v_exp_f32 v14, v14
    v_exp_f32 v15, v15
    v_exp_f32 v16, v16
    v_exp_f32 v17, v17
    v_exp_f32 v18, v18
    v_exp_f32 v19, v19
    v_exp_f32 v20, v20
    v_exp_f32 v21, v21
    v_exp_f32 v22, v22
    v_exp_f32 v23, v23
    v_pk_fma_f32 v[24:25], v[128:129], v[250:251], v[226:227] op_sel_hi:[1,0,0] neg_lo:[0,0,1] neg_hi:[0,0,1]
    v_pk_fma_f32 v[32:33], v[128:129], v[250:251], v[234:235] op_sel_hi:[1,0,0] neg_lo:[1,0,0] neg_hi:[1,0,0]
    v_pk_fma_f32 v[26:27], v[130:131], v[250:251], v[226:227] op_sel_hi:[1,0,0] neg_lo:[0,0,1] neg_hi:[0,0,1]
    v_pk_fma_f32 v[34:35], v[130:131], v[250:251], v[234:235] op_sel_hi:[1,0,0] neg_lo:[1,0,0] neg_hi:[1,0,0]
    v_pk_fma_f32 v[28:29], v[132:133], v[250:251], v[226:227] op_sel_hi:[1,0,0] neg_lo:[0,0,1] neg_hi:[0,0,1]
    v_pk_fma_f32 v[36:37], v[132:133], v[250:251], v[234:235] op_sel_hi:[1,0,0] neg_lo:[1,0,0] neg_hi:[1,0,0]
    v_pk_fma_f32 v[30:31], v[134:135], v[250:251], v[226:227] op_sel_hi:[1,0,0] neg_lo:[0,0,1] neg_hi:[0,0,1]
    v_pk_fma_f32 v[38:39], v[134:135], v[250:251], v[234:235] op_sel_hi:[1,0,0] neg_lo:[1,0,0] neg_hi:[1,0,0]
    v_exp_f32 v24, v24
    v_exp_f32 v25, v25
    v_exp_f32 v26, v26
    v_exp_f32 v27, v27
    v_exp_f32 v28, v28
    v_exp_f32 v29, v29
    v_exp_f32 v30, v30
    v_exp_f32 v31, v31
    v_exp_f32 v32, v32
    v_exp_f32 v33, v33
    v_exp_f32 v34, v34
    v_exp_f32 v35, v35
    v_exp_f32 v36, v36
    v_exp_f32 v37, v37
    v_exp_f32 v38, v38
    v_exp_f32 v39, v39
    v_pk_fma_f32 v[40:41], v[136:137], v[252:253], v[228:229] op_sel_hi:[1,0,0] neg_lo:[0,0,1] neg_hi:[0,0,1]
    v_pk_fma_f32 v[48:49], v[136:137], v[252:253], v[236:237] op_sel_hi:[1,0,0] neg_lo:[1,0,0] neg_hi:[1,0,0]
    v_pk_fma_f32 v[42:43], v[138:139], v[252:253], v[228:229] op_sel_hi:[1,0,0] neg_lo:[0,0,1] neg_hi:[0,0,1]
    v_pk_fma_f32 v[50:51], v[138:139], v[252:253], v[236:237] op_sel_hi:[1,0,0] neg_lo:[1,0,0] neg_hi:[1,0,0]
    v_pk_fma_f32 v[44:45], v[140:141], v[252:253], v[228:229] op_sel_hi:[1,0,0] neg_lo:[0,0,1] neg_hi:[0,0,1]
    v_pk_fma_f32 v[52:53], v[140:141], v[252:253], v[236:237] op_sel_hi:[1,0,0] neg_lo:[1,0,0] neg_hi:[1,0,0]
    v_pk_fma_f32 v[46:47], v[142:143], v[252:253], v[228:229] op_sel_hi:[1,0,0] neg_lo:[0,0,1] neg_hi:[0,0,1]
    v_pk_fma_f32 v[54:55], v[142:143], v[252:253], v[236:237] op_sel_hi:[1,0,0] neg_lo:[1,0,0] neg_hi:[1,0,0]
    v_exp_f32 v40, v40
    v_exp_f32 v41, v41
    v_exp_f32 v42, v42
    v_exp_f32 v43, v43
    v_exp_f32 v44, v44
    v_exp_f32 v45, v45
    v_exp_f32 v46, v46
    v_exp_f32 v47, v47
    v_exp_f32 v48, v48
    v_exp_f32 v49, v49
    v_exp_f32 v50, v50
    v_exp_f32 v51, v51
    v_exp_f32 v52, v52
    v_exp_f32 v53, v53
    v_exp_f32 v54, v54
    v_exp_f32 v55, v55
    v_pk_fma_f32 v[56:57], v[144:145], v[254:255], v[230:231] op_sel_hi:[1,0,0] neg_lo:[0,0,1] neg_hi:[0,0,1]
    v_pk_fma_f32 v[64:65], v[144:145], v[254:255], v[238:239] op_sel_hi:[1,0,0] neg_lo:[1,0,0] neg_hi:[1,0,0]
    v_pk_fma_f32 v[58:59], v[146:147], v[254:255], v[230:231] op_sel_hi:[1,0,0] neg_lo:[0,0,1] neg_hi:[0,0,1]
    v_pk_fma_f32 v[66:67], v[146:147], v[254:255], v[238:239] op_sel_hi:[1,0,0] neg_lo:[1,0,0] neg_hi:[1,0,0]
    v_pk_fma_f32 v[60:61], v[148:149], v[254:255], v[230:231] op_sel_hi:[1,0,0] neg_lo:[0,0,1] neg_hi:[0,0,1]
    v_pk_fma_f32 v[68:69], v[148:149], v[254:255], v[238:239] op_sel_hi:[1,0,0] neg_lo:[1,0,0] neg_hi:[1,0,0]
    v_pk_fma_f32 v[62:63], v[150:151], v[254:255], v[230:231] op_sel_hi:[1,0,0] neg_lo:[0,0,1] neg_hi:[0,0,1]
    v_pk_fma_f32 v[70:71], v[150:151], v[254:255], v[238:239] op_sel_hi:[1,0,0] neg_lo:[1,0,0] neg_hi:[1,0,0]
    v_exp_f32 v56, v56
    v_exp_f32 v57, v57
    v_exp_f32 v58, v58
    v_exp_f32 v59, v59
    v_exp_f32 v60, v60
    v_exp_f32 v61, v61
    v_exp_f32 v62, v62
    v_exp_f32 v63, v63
    v_exp_f32 v64, v64
    v_exp_f32 v65, v65
    v_exp_f32 v66, v66
    v_exp_f32 v67, v67
    v_exp_f32 v68, v68
    v_exp_f32 v69, v69
    v_exp_f32 v70, v70
    v_exp_f32 v71, v71
    v_pk_add_f32 v[120:121], v[8:9], v[10:11]
    v_pk_add_f32 v[122:123], v[12:13], v[14:15]
    v_pk_add_f32 v[124:125], v[16:17], v[18:19]
    v_pk_add_f32 v[126:127], v[20:21], v[22:23]
    v_pk_add_f32 v[128:129], v[24:25], v[26:27]
    v_pk_add_f32 v[130:131], v[28:29], v[30:31]
    v_pk_add_f32 v[132:133], v[32:33], v[34:35]
    v_pk_add_f32 v[134:135], v[36:37], v[38:39]
    v_pk_add_f32 v[136:137], v[40:41], v[42:43]
    v_pk_add_f32 v[138:139], v[44:45], v[46:47]
    v_pk_add_f32 v[140:141], v[48:49], v[50:51]
    v_pk_add_f32 v[142:143], v[52:53], v[54:55]
    v_pk_add_f32 v[144:145], v[56:57], v[58:59]
    v_pk_add_f32 v[146:147], v[60:61], v[62:63]
    v_pk_add_f32 v[148:149], v[64:65], v[66:67]
    v_pk_add_f32 v[150:151], v[68:69], v[70:71]
    v_pk_add_f32 v[120:121], v[120:121], v[122:123]
    v_pk_add_f32 v[124:125], v[124:125], v[126:127]
    v_pk_add_f32 v[128:129], v[128:129], v[130:131]
    v_pk_add_f32 v[132:133], v[132:133], v[134:135]
    v_pk_add_f32 v[136:137], v[136:137], v[138:139]
    v_pk_add_f32 v[140:141], v[140:141], v[142:143]
    v_pk_add_f32 v[144:145], v[144:145], v[146:147]
    v_pk_add_f32 v[148:149], v[148:149], v[150:151]
    v_add_f32 v224, v120, v121
    v_add_f32 v232, v124, v125
    v_add_f32 v226, v128, v129
    v_add_f32 v234, v132, v133
    v_add_f32 v228, v136, v137
    v_add_f32 v236, v140, v141
    v_add_f32 v230, v144, v145
    v_add_f32 v238, v148, v149
    v_permlane32_swap_b32 v224, v228
    v_permlane32_swap_b32 v226, v230
    v_permlane32_swap_b32 v232, v236
    v_permlane32_swap_b32 v234, v238
    v_add_f32 v224, v224, v228
    v_add_f32 v226, v226, v230
    v_add_f32 v232, v232, v236
    v_add_f32 v234, v234, v238
    v_permlane16_swap_b32 v224, v226
    s_nop 0
    v_permlane16_swap_b32 v232, v234
    v_add_f32 v224, v224, v226
    v_add_f32 v232, v232, v234
    v_rcp_f32 v224, v224
    v_rcp_f32 v232, v232
    s_mul_i32 s3, s38, 4352
    s_add_u32 s3, s3, 140800
    v_mul_u32_u24 v6, 136, v3
    v_lshl_add_u32 v6, v2, 3, v6
    v_add_u32 v240, s3, v6
    v_mul_f32 v224, v224, v183
    v_mul_f32 v232, v232, v183
    v_lshrrev_b32 v6, 2, v1
    v_mul_u32_u24 v6, 136, v6
    v_lshl_add_u32 v6, v7, 3, v6
    v_add_u32 v6, s3, v6
    s_lshl_b32 s65, s28, 6
    v_add_u32 v241, s65, v6
    s_xor_b32 s65, s65, 64
    v_add_u32 v242, s65, v6
    v_mov_b32 v226, v224
    v_mov_b32 v234, v232
    s_nop 0
    v_permlane16_swap_b32 v224, v226
    v_permlane16_swap_b32 v232, v234
    v_mov_b32 v228, v224
    v_mov_b32 v230, v226
    v_mov_b32 v236, v232
    v_mov_b32 v238, v234
    v_permlane32_swap_b32 v224, v228
    v_permlane32_swap_b32 v226, v230
    v_permlane32_swap_b32 v232, v236
    v_permlane32_swap_b32 v234, v238
    v_pk_mul_f32 v[8:9], v[8:9], v[224:225] op_sel_hi:[1,0]
    v_pk_mul_f32 v[10:11], v[10:11], v[224:225] op_sel_hi:[1,0]
    v_pk_mul_f32 v[12:13], v[12:13], v[224:225] op_sel_hi:[1,0]
    v_pk_mul_f32 v[14:15], v[14:15], v[224:225] op_sel_hi:[1,0]
    v_cvt_pk_bf16_f32 v104, v8, v9
    v_cvt_pk_bf16_f32 v105, v10, v11
    v_cvt_pk_bf16_f32 v106, v12, v13
    v_cvt_pk_bf16_f32 v107, v14, v15
    ds_write_b64 v240, v[104:105] offset:0
    ds_write_b64 v240, v[106:107] offset:32
    v_pk_mul_f32 v[16:17], v[16:17], v[232:233] op_sel_hi:[1,0]
    v_pk_mul_f32 v[18:19], v[18:19], v[232:233] op_sel_hi:[1,0]
    v_pk_mul_f32 v[20:21], v[20:21], v[232:233] op_sel_hi:[1,0]
    v_pk_mul_f32 v[22:23], v[22:23], v[232:233] op_sel_hi:[1,0]
    v_cvt_pk_bf16_f32 v108, v16, v17
    v_cvt_pk_bf16_f32 v109, v18, v19
    v_cvt_pk_bf16_f32 v110, v20, v21
    v_cvt_pk_bf16_f32 v111, v22, v23
    ds_write_b64 v240, v[108:109] offset:64
    ds_write_b64 v240, v[110:111] offset:96
    v_pk_mul_f32 v[24:25], v[24:25], v[226:227] op_sel_hi:[1,0]
    v_pk_mul_f32 v[26:27], v[26:27], v[226:227] op_sel_hi:[1,0]
    v_pk_mul_f32 v[28:29], v[28:29], v[226:227] op_sel_hi:[1,0]
    v_pk_mul_f32 v[30:31], v[30:31], v[226:227] op_sel_hi:[1,0]
    v_cvt_pk_bf16_f32 v112, v24, v25
    v_cvt_pk_bf16_f32 v113, v26, v27
    v_cvt_pk_bf16_f32 v114, v28, v29
    v_cvt_pk_bf16_f32 v115, v30, v31
    ds_write_b64 v240, v[112:113] offset:2176
    ds_write_b64 v240, v[114:115] offset:2208
    v_pk_mul_f32 v[32:33], v[32:33], v[234:235] op_sel_hi:[1,0]
    v_pk_mul_f32 v[34:35], v[34:35], v[234:235] op_sel_hi:[1,0]
    v_pk_mul_f32 v[36:37], v[36:37], v[234:235] op_sel_hi:[1,0]
    v_pk_mul_f32 v[38:39], v[38:39], v[234:235] op_sel_hi:[1,0]
    v_cvt_pk_bf16_f32 v116, v32, v33
    v_cvt_pk_bf16_f32 v117, v34, v35
    v_cvt_pk_bf16_f32 v118, v36, v37
    v_cvt_pk_bf16_f32 v119, v38, v39
    ds_write_b64 v240, v[116:117] offset:2240
    ds_write_b64 v240, v[118:119] offset:2272
    ds_read_b64_tr_b16 v[120:121], v241 offset:0
    ds_read_b64_tr_b16 v[122:123], v241 offset:2176
    ds_read_b64_tr_b16 v[124:125], v241 offset:32
    ds_read_b64_tr_b16 v[126:127], v241 offset:2208
    ds_read_b64_tr_b16 v[128:129], v242 offset:0
    ds_read_b64_tr_b16 v[130:131], v242 offset:2176
    ds_read_b64_tr_b16 v[132:133], v242 offset:32
    ds_read_b64_tr_b16 v[134:135], v242 offset:2208
    v_pk_mul_f32 v[40:41], v[40:41], v[228:229] op_sel_hi:[1,0]
    v_pk_mul_f32 v[42:43], v[42:43], v[228:229] op_sel_hi:[1,0]
    v_pk_mul_f32 v[44:45], v[44:45], v[228:229] op_sel_hi:[1,0]
    v_pk_mul_f32 v[46:47], v[46:47], v[228:229] op_sel_hi:[1,0]
    v_cvt_pk_bf16_f32 v104, v40, v41
    v_cvt_pk_bf16_f32 v105, v42, v43
    v_cvt_pk_bf16_f32 v106, v44, v45
    v_cvt_pk_bf16_f32 v107, v46, v47
    ds_write_b64 v240, v[104:105] offset:0
    ds_write_b64 v240, v[106:107] offset:32
    v_pk_mul_f32 v[48:49], v[48:49], v[236:237] op_sel_hi:[1,0]
    v_pk_mul_f32 v[50:51], v[50:51], v[236:237] op_sel_hi:[1,0]
    v_pk_mul_f32 v[52:53], v[52:53], v[236:237] op_sel_hi:[1,0]
    v_pk_mul_f32 v[54:55], v[54:55], v[236:237] op_sel_hi:[1,0]
    v_cvt_pk_bf16_f32 v108, v48, v49
    v_cvt_pk_bf16_f32 v109, v50, v51
    v_cvt_pk_bf16_f32 v110, v52, v53
    v_cvt_pk_bf16_f32 v111, v54, v55
    ds_write_b64 v240, v[108:109] offset:64
    ds_write_b64 v240, v[110:111] offset:96
    v_pk_mul_f32 v[56:57], v[56:57], v[230:231] op_sel_hi:[1,0]
    v_pk_mul_f32 v[58:59], v[58:59], v[230:231] op_sel_hi:[1,0]
    v_pk_mul_f32 v[60:61], v[60:61], v[230:231] op_sel_hi:[1,0]
    v_pk_mul_f32 v[62:63], v[62:63], v[230:231] op_sel_hi:[1,0]
    v_cvt_pk_bf16_f32 v112, v56, v57
    v_cvt_pk_bf16_f32 v113, v58, v59
    v_cvt_pk_bf16_f32 v114, v60, v61
    v_cvt_pk_bf16_f32 v115, v62, v63
    ds_write_b64 v240, v[112:113] offset:2176
    ds_write_b64 v240, v[114:115] offset:2208
    v_pk_mul_f32 v[64:65], v[64:65], v[238:239] op_sel_hi:[1,0]
    v_pk_mul_f32 v[66:67], v[66:67], v[238:239] op_sel_hi:[1,0]
    v_pk_mul_f32 v[68:69], v[68:69], v[238:239] op_sel_hi:[1,0]
    v_pk_mul_f32 v[70:71], v[70:71], v[238:239] op_sel_hi:[1,0]
    v_cvt_pk_bf16_f32 v116, v64, v65
    v_cvt_pk_bf16_f32 v117, v66, v67
    v_cvt_pk_bf16_f32 v118, v68, v69
    v_cvt_pk_bf16_f32 v119, v70, v71
    ds_write_b64 v240, v[116:117] offset:2240
    ds_write_b64 v240, v[118:119] offset:2272
    ds_read_b64_tr_b16 v[136:137], v241 offset:0
    ds_read_b64_tr_b16 v[138:139], v241 offset:2176
    ds_read_b64_tr_b16 v[140:141], v241 offset:32
    ds_read_b64_tr_b16 v[142:143], v241 offset:2208
    ds_read_b64_tr_b16 v[144:145], v242 offset:0
    ds_read_b64_tr_b16 v[146:147], v242 offset:2176
    ds_read_b64_tr_b16 v[148:149], v242 offset:32
    ds_read_b64_tr_b16 v[150:151], v242 offset:2208
    s_waitcnt lgkmcnt(0)
    v_mfma_f32_16x16x32_bf16 v[24:27], v[128:131], v[152:155], 0
    v_mfma_f32_16x16x32_bf16 v[28:31], v[128:131], v[156:159], 0
    v_mfma_f32_16x16x32_bf16 v[48:51], v[128:131], v[216:219], 0
    v_mfma_f32_16x16x32_bf16 v[24:27], v[144:147], v[160:163], v[24:27]
    v_mfma_f32_16x16x32_bf16 v[28:31], v[144:147], v[164:167], v[28:31]
    v_mfma_f32_16x16x32_bf16 v[48:51], v[144:147], v[220:223], v[48:51]
    v_mfma_f32_16x16x32_bf16 v[32:35], v[132:135], v[152:155], 0
    v_mfma_f32_16x16x32_bf16 v[36:39], v[132:135], v[156:159], 0
    v_mfma_f32_16x16x32_bf16 v[52:55], v[132:135], v[216:219], 0
    v_mfma_f32_16x16x32_bf16 v[32:35], v[148:151], v[160:163], v[32:35]
    v_mfma_f32_16x16x32_bf16 v[36:39], v[148:151], v[164:167], v[36:39]
    v_mfma_f32_16x16x32_bf16 v[52:55], v[148:151], v[220:223], v[52:55]
    v_mfma_f32_16x16x32_bf16 v[8:11], v[120:123], v[152:155], 0
    v_mfma_f32_16x16x32_bf16 v[12:15], v[120:123], v[156:159], 0
    v_mfma_f32_16x16x32_bf16 v[40:43], v[120:123], v[216:219], 0
    v_mfma_f32_16x16x32_bf16 v[8:11], v[136:139], v[160:163], v[8:11]
    v_mfma_f32_16x16x32_bf16 v[12:15], v[136:139], v[164:167], v[12:15]
    v_mfma_f32_16x16x32_bf16 v[40:43], v[136:139], v[220:223], v[40:43]
    v_mfma_f32_16x16x32_bf16 v[16:19], v[124:127], v[152:155], 0
    v_mfma_f32_16x16x32_bf16 v[20:23], v[124:127], v[156:159], 0
    v_mfma_f32_16x16x32_bf16 v[44:47], v[124:127], v[216:219], 0
    v_mfma_f32_16x16x32_bf16 v[16:19], v[140:143], v[160:163], v[16:19]
    v_mfma_f32_16x16x32_bf16 v[20:23], v[140:143], v[164:167], v[20:23]
    v_mfma_f32_16x16x32_bf16 v[44:47], v[140:143], v[220:223], v[44:47]
    v_lshlrev_b32 v5, 4, v1
    v_add_u32 v240, s3, v5
    v_lshl_add_u32 v241, v2, 5, s3
    s_xor_b32 s65, s38, 1
    s_mul_i32 s65, s65, 4352
    s_add_u32 s65, s65, 140800
    v_add_u32 v242, s65, v5
    v_lshl_add_u32 v243, v2, 5, s65
    ds_write_b128 v240, v[24:27] offset:0
    ds_write_b128 v240, v[28:31] offset:1024
    ds_write_b128 v240, v[32:35] offset:2048
    ds_write_b128 v240, v[36:39] offset:3072
    ds_write_b128 v241, v[48:51] offset:4096
    ds_write_b128 v241, v[52:55] offset:4112
    s_lshl_b32 s3, s37, 1
    s_add_u32 s3, s3, s29
    s_lshl_b32 s3, s3, 4
    s_add_u32 s3, s3, s36
    s_mul_i32 s3, s3, 4352
    s_add_u32 s3, s3, 2097152
    s_lshl_b32 s65, s28, 7
    s_add_u32 s65, s65, s3
    s_add_u32 s65, s65, 4096
    s_lshl_b32 s66, s28, 11
    s_add_u32 s3, s3, s66
    v_lshlrev_b32 v6, 4, v2
    s_waitcnt lgkmcnt(0)
    s_barrier
    ds_read_b128 v[192:195], v242 offset:0
    ds_read_b128 v[196:199], v242 offset:1024
    ds_read_b128 v[200:203], v242 offset:2048
    ds_read_b128 v[204:207], v242 offset:3072
    ds_read_b128 v[208:211], v243 offset:4096
    ds_read_b128 v[212:215], v243 offset:4112
    ds_read_b128 v[104:107], v168 offset:0
    ds_read_b64_tr_b16 v[120:121], v170 offset:0
    ds_read_b64_tr_b16 v[122:123], v170 offset:512
    ds_read_b64_tr_b16 v[124:125], v171 offset:0
    ds_read_b64_tr_b16 v[126:127], v171 offset:512
    ds_read_b128 v[108:111], v168 offset:2048
    ds_read_b128 v[112:115], v168 offset:4096
    ds_read_b128 v[116:119], v168 offset:6144
    s_waitcnt lgkmcnt(8)
    v_pk_add_f32 v[8:9], v[8:9], v[192:193]
    v_pk_add_f32 v[10:11], v[10:11], v[194:195]
    v_pk_add_f32 v[12:13], v[12:13], v[196:197]
    v_pk_add_f32 v[14:15], v[14:15], v[198:199]
    v_pk_add_f32 v[16:17], v[16:17], v[200:201]
    v_pk_add_f32 v[18:19], v[18:19], v[202:203]
    v_pk_add_f32 v[20:21], v[20:21], v[204:205]
    v_pk_add_f32 v[22:23], v[22:23], v[206:207]
    v_pk_add_f32 v[40:41], v[40:41], v[208:209]
    v_pk_add_f32 v[42:43], v[42:43], v[210:211]
    v_pk_add_f32 v[44:45], v[44:45], v[212:213]
    v_pk_add_f32 v[46:47], v[46:47], v[214:215]
    v_cvt_pk_bf16_f32 v192, v8, v9
    v_cvt_pk_bf16_f32 v193, v10, v11
    v_cvt_pk_bf16_f32 v194, v16, v17
    v_cvt_pk_bf16_f32 v195, v18, v19
    buffer_store_dwordx4 v[192:195], v5, s[12:15], s3 offen offset:0 sc1
    v_cvt_pk_bf16_f32 v196, v12, v13
    v_cvt_pk_bf16_f32 v197, v14, v15
    v_cvt_pk_bf16_f32 v198, v20, v21
    v_cvt_pk_bf16_f32 v199, v22, v23
    buffer_store_dwordx4 v[196:199], v5, s[12:15], s3 offen offset:1024 sc1
    s_mov_b32 s66, 0x00010001
    s_mov_b32 s67, 0x00010001
    s_mov_b64 exec, s[66:67]
    buffer_store_dwordx4 v[40:43], v6, s[12:15], s65 offen offset:0 sc1
    buffer_store_dwordx4 v[44:47], v6, s[12:15], s65 offen offset:64 sc1
    s_mov_b64 exec, -1
    s_mov_b32 s69, 0
    s_branch L_c2e
.p2align 6
L_c2:
    s_waitcnt lgkmcnt(0)
    s_barrier
    v_mfma_f32_16x16x32_bf16 v[72:75], v[152:155], v[136:139], v[72:75]
    ds_read_b128 v[104:107], v168 offset:0
    v_mfma_f32_16x16x32_bf16 v[76:79], v[156:159], v[136:139], v[76:79]
    ds_read_b64_tr_b16 v[120:121], v170 offset:0
    v_mfma_f32_16x16x32_bf16 v[80:83], v[152:155], v[140:143], v[80:83]
    ds_read_b64_tr_b16 v[122:123], v170 offset:512
    v_mfma_f32_16x16x32_bf16 v[84:87], v[156:159], v[140:143], v[84:87]
    ds_read_b64_tr_b16 v[124:125], v171 offset:0
    v_mfma_f32_16x16x32_bf16 v[88:91], v[152:155], v[144:147], v[88:91]
    ds_read_b64_tr_b16 v[126:127], v171 offset:512
    v_mfma_f32_16x16x32_bf16 v[92:95], v[156:159], v[144:147], v[92:95]
    ds_read_b128 v[108:111], v168 offset:2048
    v_mfma_f32_16x16x32_bf16 v[96:99], v[152:155], v[148:151], v[96:99]
    ds_read_b128 v[112:115], v168 offset:4096
    v_mfma_f32_16x16x32_bf16 v[100:103], v[156:159], v[148:151], v[100:103]
    ds_read_b128 v[116:119], v168 offset:6144
L_c2e:
    s_waitcnt lgkmcnt(0)
    v_mfma_f32_16x16x32_bf16 v[72:75], v[120:123], v[104:107], v[72:75]
    ds_read_b128 v[136:139], v169 offset:0
    v_mfma_f32_16x16x32_bf16 v[76:79], v[124:127], v[104:107], v[76:79]
    ds_read_b64_tr_b16 v[152:153], v170 offset:4096
    v_mfma_f32_16x16x32_bf16 v[80:83], v[120:123], v[108:111], v[80:83]
    ds_read_b64_tr_b16 v[154:155], v170 offset:4608
    v_mfma_f32_16x16x32_bf16 v[84:87], v[124:127], v[108:111], v[84:87]
    ds_read_b64_tr_b16 v[156:157], v171 offset:4096
    v_mfma_f32_16x16x32_bf16 v[88:91], v[120:123], v[112:115], v[88:91]
    ds_read_b64_tr_b16 v[158:159], v171 offset:4608
    v_mfma_f32_16x16x32_bf16 v[92:95], v[124:127], v[112:115], v[92:95]
    ds_read_b128 v[140:143], v169 offset:2048
    v_mfma_f32_16x16x32_bf16 v[96:99], v[120:123], v[116:119], v[96:99]
    ds_read_b128 v[144:147], v169 offset:4096
    v_mfma_f32_16x16x32_bf16 v[100:103], v[124:127], v[116:119], v[100:103]
    ds_read_b128 v[148:151], v169 offset:6144
    s_waitcnt lgkmcnt(0)
    s_barrier
    v_mfma_f32_16x16x32_bf16 v[72:75], v[152:155], v[136:139], v[72:75]
    ds_read_b128 v[104:107], v168 offset:16384
    v_mfma_f32_16x16x32_bf16 v[76:79], v[156:159], v[136:139], v[76:79]
    ds_read_b64_tr_b16 v[120:121], v170 offset:8192
    v_mfma_f32_16x16x32_bf16 v[80:83], v[152:155], v[140:143], v[80:83]
    ds_read_b64_tr_b16 v[122:123], v170 offset:8704
    v_mfma_f32_16x16x32_bf16 v[84:87], v[156:159], v[140:143], v[84:87]
    ds_read_b64_tr_b16 v[124:125], v171 offset:8192
    v_mfma_f32_16x16x32_bf16 v[88:91], v[152:155], v[144:147], v[88:91]
    ds_read_b64_tr_b16 v[126:127], v171 offset:8704
    v_mfma_f32_16x16x32_bf16 v[92:95], v[156:159], v[144:147], v[92:95]
    ds_read_b128 v[108:111], v168 offset:18432
    v_mfma_f32_16x16x32_bf16 v[96:99], v[152:155], v[148:151], v[96:99]
    ds_read_b128 v[112:115], v168 offset:20480
    v_mfma_f32_16x16x32_bf16 v[100:103], v[156:159], v[148:151], v[100:103]
    ds_read_b128 v[116:119], v168 offset:22528
    s_waitcnt lgkmcnt(0)
    v_mfma_f32_16x16x32_bf16 v[72:75], v[120:123], v[104:107], v[72:75]
    ds_read_b128 v[136:139], v169 offset:16384
    v_mfma_f32_16x16x32_bf16 v[76:79], v[124:127], v[104:107], v[76:79]
    ds_read_b64_tr_b16 v[152:153], v170 offset:12288
    v_mfma_f32_16x16x32_bf16 v[80:83], v[120:123], v[108:111], v[80:83]
    ds_read_b64_tr_b16 v[154:155], v170 offset:12800
    v_mfma_f32_16x16x32_bf16 v[84:87], v[124:127], v[108:111], v[84:87]
    ds_read_b64_tr_b16 v[156:157], v171 offset:12288
    v_mfma_f32_16x16x32_bf16 v[88:91], v[120:123], v[112:115], v[88:91]
    ds_read_b64_tr_b16 v[158:159], v171 offset:12800
    v_mfma_f32_16x16x32_bf16 v[92:95], v[124:127], v[112:115], v[92:95]
    ds_read_b128 v[140:143], v169 offset:18432
    v_mfma_f32_16x16x32_bf16 v[96:99], v[120:123], v[116:119], v[96:99]
    ds_read_b128 v[144:147], v169 offset:20480
    v_mfma_f32_16x16x32_bf16 v[100:103], v[124:127], v[116:119], v[100:103]
    ds_read_b128 v[148:151], v169 offset:22528
    s_waitcnt lgkmcnt(0)
    s_barrier
    v_mfma_f32_16x16x32_bf16 v[72:75], v[152:155], v[136:139], v[72:75]
    ds_read_b128 v[104:107], v168 offset:32768
    v_mfma_f32_16x16x32_bf16 v[76:79], v[156:159], v[136:139], v[76:79]
    ds_read_b64_tr_b16 v[120:121], v170 offset:16384
    v_mfma_f32_16x16x32_bf16 v[80:83], v[152:155], v[140:143], v[80:83]
    ds_read_b64_tr_b16 v[122:123], v170 offset:16896
    v_mfma_f32_16x16x32_bf16 v[84:87], v[156:159], v[140:143], v[84:87]
    ds_read_b64_tr_b16 v[124:125], v171 offset:16384
    v_mfma_f32_16x16x32_bf16 v[88:91], v[152:155], v[144:147], v[88:91]
    ds_read_b64_tr_b16 v[126:127], v171 offset:16896
    v_mfma_f32_16x16x32_bf16 v[92:95], v[156:159], v[144:147], v[92:95]
    ds_read_b128 v[108:111], v168 offset:34816
    v_mfma_f32_16x16x32_bf16 v[96:99], v[152:155], v[148:151], v[96:99]
    ds_read_b128 v[112:115], v168 offset:36864
    v_mfma_f32_16x16x32_bf16 v[100:103], v[156:159], v[148:151], v[100:103]
    ds_read_b128 v[116:119], v168 offset:38912
    s_waitcnt lgkmcnt(0)
    v_mfma_f32_16x16x32_bf16 v[72:75], v[120:123], v[104:107], v[72:75]
    ds_read_b128 v[136:139], v169 offset:32768
    v_mfma_f32_16x16x32_bf16 v[76:79], v[124:127], v[104:107], v[76:79]
    ds_read_b64_tr_b16 v[152:153], v170 offset:20480
    v_mfma_f32_16x16x32_bf16 v[80:83], v[120:123], v[108:111], v[80:83]
    ds_read_b64_tr_b16 v[154:155], v170 offset:20992
    v_mfma_f32_16x16x32_bf16 v[84:87], v[124:127], v[108:111], v[84:87]
    ds_read_b64_tr_b16 v[156:157], v171 offset:20480
    v_mfma_f32_16x16x32_bf16 v[88:91], v[120:123], v[112:115], v[88:91]
    ds_read_b64_tr_b16 v[158:159], v171 offset:20992
    v_mfma_f32_16x16x32_bf16 v[92:95], v[124:127], v[112:115], v[92:95]
    ds_read_b128 v[140:143], v169 offset:34816
    v_mfma_f32_16x16x32_bf16 v[96:99], v[120:123], v[116:119], v[96:99]
    ds_read_b128 v[144:147], v169 offset:36864
    v_mfma_f32_16x16x32_bf16 v[100:103], v[124:127], v[116:119], v[100:103]
    ds_read_b128 v[148:151], v169 offset:38912
    s_waitcnt lgkmcnt(0)
    s_barrier
    v_mfma_f32_16x16x32_bf16 v[72:75], v[152:155], v[136:139], v[72:75]
    ds_read_b128 v[104:107], v168 offset:49152
    v_mfma_f32_16x16x32_bf16 v[76:79], v[156:159], v[136:139], v[76:79]
    ds_read_b64_tr_b16 v[120:121], v170 offset:24576
    v_mfma_f32_16x16x32_bf16 v[80:83], v[152:155], v[140:143], v[80:83]
    ds_read_b64_tr_b16 v[122:123], v170 offset:25088
    v_mfma_f32_16x16x32_bf16 v[84:87], v[156:159], v[140:143], v[84:87]
    ds_read_b64_tr_b16 v[124:125], v171 offset:24576
    v_mfma_f32_16x16x32_bf16 v[88:91], v[152:155], v[144:147], v[88:91]
    ds_read_b64_tr_b16 v[126:127], v171 offset:25088
    v_mfma_f32_16x16x32_bf16 v[92:95], v[156:159], v[144:147], v[92:95]
    ds_read_b128 v[108:111], v168 offset:51200
    v_mfma_f32_16x16x32_bf16 v[96:99], v[152:155], v[148:151], v[96:99]
    ds_read_b128 v[112:115], v168 offset:53248
    v_mfma_f32_16x16x32_bf16 v[100:103], v[156:159], v[148:151], v[100:103]
    ds_read_b128 v[116:119], v168 offset:55296
    s_waitcnt lgkmcnt(0)
    v_mfma_f32_16x16x32_bf16 v[72:75], v[120:123], v[104:107], v[72:75]
    ds_read_b128 v[136:139], v169 offset:49152
    v_mfma_f32_16x16x32_bf16 v[76:79], v[124:127], v[104:107], v[76:79]
    ds_read_b64_tr_b16 v[152:153], v170 offset:28672
    v_mfma_f32_16x16x32_bf16 v[80:83], v[120:123], v[108:111], v[80:83]
    ds_read_b64_tr_b16 v[154:155], v170 offset:29184
    v_mfma_f32_16x16x32_bf16 v[84:87], v[124:127], v[108:111], v[84:87]
    ds_read_b64_tr_b16 v[156:157], v171 offset:28672
    v_mfma_f32_16x16x32_bf16 v[88:91], v[120:123], v[112:115], v[88:91]
    ds_read_b64_tr_b16 v[158:159], v171 offset:29184
    v_mfma_f32_16x16x32_bf16 v[92:95], v[124:127], v[112:115], v[92:95]
    ds_read_b128 v[140:143], v169 offset:51200
    v_mfma_f32_16x16x32_bf16 v[96:99], v[120:123], v[116:119], v[96:99]
    ds_read_b128 v[144:147], v169 offset:53248
    v_mfma_f32_16x16x32_bf16 v[100:103], v[124:127], v[116:119], v[100:103]
    ds_read_b128 v[148:151], v169 offset:55296
    s_waitcnt lgkmcnt(0)
    s_barrier
    v_mfma_f32_16x16x32_bf16 v[72:75], v[152:155], v[136:139], v[72:75]
    ds_read_b128 v[104:107], v168 offset:0
    v_mfma_f32_16x16x32_bf16 v[76:79], v[156:159], v[136:139], v[76:79]
    ds_read_b64_tr_b16 v[120:121], v170 offset:32768
    v_mfma_f32_16x16x32_bf16 v[80:83], v[152:155], v[140:143], v[80:83]
    ds_read_b64_tr_b16 v[122:123], v170 offset:33280
    v_mfma_f32_16x16x32_bf16 v[84:87], v[156:159], v[140:143], v[84:87]
    ds_read_b64_tr_b16 v[124:125], v171 offset:32768
    v_mfma_f32_16x16x32_bf16 v[88:91], v[152:155], v[144:147], v[88:91]
    ds_read_b64_tr_b16 v[126:127], v171 offset:33280
    v_mfma_f32_16x16x32_bf16 v[92:95], v[156:159], v[144:147], v[92:95]
    ds_read_b128 v[108:111], v168 offset:2048
    v_mfma_f32_16x16x32_bf16 v[96:99], v[152:155], v[148:151], v[96:99]
    ds_read_b128 v[112:115], v168 offset:4096
    v_mfma_f32_16x16x32_bf16 v[100:103], v[156:159], v[148:151], v[100:103]
    ds_read_b128 v[116:119], v168 offset:6144
    s_waitcnt lgkmcnt(0)
    v_mfma_f32_16x16x32_bf16 v[72:75], v[120:123], v[104:107], v[72:75]
    ds_read_b128 v[136:139], v169 offset:0
    v_mfma_f32_16x16x32_bf16 v[76:79], v[124:127], v[104:107], v[76:79]
    ds_read_b64_tr_b16 v[152:153], v170 offset:36864
    v_mfma_f32_16x16x32_bf16 v[80:83], v[120:123], v[108:111], v[80:83]
    ds_read_b64_tr_b16 v[154:155], v170 offset:37376
    v_mfma_f32_16x16x32_bf16 v[84:87], v[124:127], v[108:111], v[84:87]
    ds_read_b64_tr_b16 v[156:157], v171 offset:36864
    v_mfma_f32_16x16x32_bf16 v[88:91], v[120:123], v[112:115], v[88:91]
    ds_read_b64_tr_b16 v[158:159], v171 offset:37376
    v_mfma_f32_16x16x32_bf16 v[92:95], v[124:127], v[112:115], v[92:95]
    ds_read_b128 v[140:143], v169 offset:2048
    v_mfma_f32_16x16x32_bf16 v[96:99], v[120:123], v[116:119], v[96:99]
    ds_read_b128 v[144:147], v169 offset:4096
    v_mfma_f32_16x16x32_bf16 v[100:103], v[124:127], v[116:119], v[100:103]
    ds_read_b128 v[148:151], v169 offset:6144
    s_waitcnt vmcnt(0) lgkmcnt(0)
    s_barrier
    v_mfma_f32_16x16x32_bf16 v[72:75], v[152:155], v[136:139], v[72:75]
    ds_read_b128 v[104:107], v168 offset:16384
    v_mfma_f32_16x16x32_bf16 v[76:79], v[156:159], v[136:139], v[76:79]
    ds_read_b64_tr_b16 v[120:121], v170 offset:40960
    v_mfma_f32_16x16x32_bf16 v[80:83], v[152:155], v[140:143], v[80:83]
    ds_read_b64_tr_b16 v[122:123], v170 offset:41472
    v_mfma_f32_16x16x32_bf16 v[84:87], v[156:159], v[140:143], v[84:87]
    ds_read_b64_tr_b16 v[124:125], v171 offset:40960
    v_mfma_f32_16x16x32_bf16 v[88:91], v[152:155], v[144:147], v[88:91]
    ds_read_b64_tr_b16 v[126:127], v171 offset:41472
    v_mfma_f32_16x16x32_bf16 v[92:95], v[156:159], v[144:147], v[92:95]
    ds_read_b128 v[108:111], v168 offset:18432
    v_mfma_f32_16x16x32_bf16 v[96:99], v[152:155], v[148:151], v[96:99]
    ds_read_b128 v[112:115], v168 offset:20480
    v_mfma_f32_16x16x32_bf16 v[100:103], v[156:159], v[148:151], v[100:103]
    ds_read_b128 v[116:119], v168 offset:22528
    s_waitcnt lgkmcnt(0)
    v_mfma_f32_16x16x32_bf16 v[72:75], v[120:123], v[104:107], v[72:75]
    ds_read_b128 v[136:139], v169 offset:16384
    v_mfma_f32_16x16x32_bf16 v[76:79], v[124:127], v[104:107], v[76:79]
    ds_read_b64_tr_b16 v[152:153], v170 offset:45056
    v_mfma_f32_16x16x32_bf16 v[80:83], v[120:123], v[108:111], v[80:83]
    ds_read_b64_tr_b16 v[154:155], v170 offset:45568
    v_mfma_f32_16x16x32_bf16 v[84:87], v[124:127], v[108:111], v[84:87]
    ds_read_b64_tr_b16 v[156:157], v171 offset:45056
    v_mfma_f32_16x16x32_bf16 v[88:91], v[120:123], v[112:115], v[88:91]
    ds_read_b64_tr_b16 v[158:159], v171 offset:45568
    v_mfma_f32_16x16x32_bf16 v[92:95], v[124:127], v[112:115], v[92:95]
    ds_read_b128 v[140:143], v169 offset:18432
    v_mfma_f32_16x16x32_bf16 v[96:99], v[120:123], v[116:119], v[96:99]
    ds_read_b128 v[144:147], v169 offset:20480
    v_mfma_f32_16x16x32_bf16 v[100:103], v[124:127], v[116:119], v[100:103]
    ds_read_b128 v[148:151], v169 offset:22528
    s_waitcnt lgkmcnt(0)
    s_barrier
    v_mfma_f32_16x16x32_bf16 v[72:75], v[152:155], v[136:139], v[72:75]
    ds_read_b128 v[104:107], v168 offset:32768
    v_mfma_f32_16x16x32_bf16 v[76:79], v[156:159], v[136:139], v[76:79]
    ds_read_b64_tr_b16 v[120:121], v170 offset:49152
    v_mfma_f32_16x16x32_bf16 v[80:83], v[152:155], v[140:143], v[80:83]
    ds_read_b64_tr_b16 v[122:123], v170 offset:49664
    v_mfma_f32_16x16x32_bf16 v[84:87], v[156:159], v[140:143], v[84:87]
    ds_read_b64_tr_b16 v[124:125], v171 offset:49152
    v_mfma_f32_16x16x32_bf16 v[88:91], v[152:155], v[144:147], v[88:91]
    ds_read_b64_tr_b16 v[126:127], v171 offset:49664
    v_mfma_f32_16x16x32_bf16 v[92:95], v[156:159], v[144:147], v[92:95]
    ds_read_b128 v[108:111], v168 offset:34816
    v_mfma_f32_16x16x32_bf16 v[96:99], v[152:155], v[148:151], v[96:99]
    ds_read_b128 v[112:115], v168 offset:36864
    v_mfma_f32_16x16x32_bf16 v[100:103], v[156:159], v[148:151], v[100:103]
    ds_read_b128 v[116:119], v168 offset:38912
    s_waitcnt lgkmcnt(0)
    v_mfma_f32_16x16x32_bf16 v[72:75], v[120:123], v[104:107], v[72:75]
    ds_read_b128 v[136:139], v169 offset:32768
    v_mfma_f32_16x16x32_bf16 v[76:79], v[124:127], v[104:107], v[76:79]
    ds_read_b64_tr_b16 v[152:153], v170 offset:53248
    v_mfma_f32_16x16x32_bf16 v[80:83], v[120:123], v[108:111], v[80:83]
    ds_read_b64_tr_b16 v[154:155], v170 offset:53760
    v_mfma_f32_16x16x32_bf16 v[84:87], v[124:127], v[108:111], v[84:87]
    ds_read_b64_tr_b16 v[156:157], v171 offset:53248
    v_mfma_f32_16x16x32_bf16 v[88:91], v[120:123], v[112:115], v[88:91]
    ds_read_b64_tr_b16 v[158:159], v171 offset:53760
    v_mfma_f32_16x16x32_bf16 v[92:95], v[124:127], v[112:115], v[92:95]
    ds_read_b128 v[140:143], v169 offset:34816
    v_mfma_f32_16x16x32_bf16 v[96:99], v[120:123], v[116:119], v[96:99]
    ds_read_b128 v[144:147], v169 offset:36864
    v_mfma_f32_16x16x32_bf16 v[100:103], v[124:127], v[116:119], v[100:103]
    ds_read_b128 v[148:151], v169 offset:38912
    s_waitcnt lgkmcnt(0)
    s_barrier
    v_mfma_f32_16x16x32_bf16 v[72:75], v[152:155], v[136:139], v[72:75]
    ds_read_b128 v[104:107], v168 offset:49152
    v_mfma_f32_16x16x32_bf16 v[76:79], v[156:159], v[136:139], v[76:79]
    ds_read_b64_tr_b16 v[120:121], v170 offset:57344
    v_mfma_f32_16x16x32_bf16 v[80:83], v[152:155], v[140:143], v[80:83]
    ds_read_b64_tr_b16 v[122:123], v170 offset:57856
    v_mfma_f32_16x16x32_bf16 v[84:87], v[156:159], v[140:143], v[84:87]
    ds_read_b64_tr_b16 v[124:125], v171 offset:57344
    v_mfma_f32_16x16x32_bf16 v[88:91], v[152:155], v[144:147], v[88:91]
    ds_read_b64_tr_b16 v[126:127], v171 offset:57856
    v_mfma_f32_16x16x32_bf16 v[92:95], v[156:159], v[144:147], v[92:95]
    ds_read_b128 v[108:111], v168 offset:51200
    v_mfma_f32_16x16x32_bf16 v[96:99], v[152:155], v[148:151], v[96:99]
    ds_read_b128 v[112:115], v168 offset:53248
    v_mfma_f32_16x16x32_bf16 v[100:103], v[156:159], v[148:151], v[100:103]
    ds_read_b128 v[116:119], v168 offset:55296
    s_waitcnt lgkmcnt(0)
    v_mfma_f32_16x16x32_bf16 v[72:75], v[120:123], v[104:107], v[72:75]
    ds_read_b128 v[136:139], v169 offset:49152
    v_mfma_f32_16x16x32_bf16 v[76:79], v[124:127], v[104:107], v[76:79]
    ds_read_b64_tr_b16 v[152:153], v170 offset:61440
    v_mfma_f32_16x16x32_bf16 v[80:83], v[120:123], v[108:111], v[80:83]
    ds_read_b64_tr_b16 v[154:155], v170 offset:61952
    v_mfma_f32_16x16x32_bf16 v[84:87], v[124:127], v[108:111], v[84:87]
    ds_read_b64_tr_b16 v[156:157], v171 offset:61440
    v_mfma_f32_16x16x32_bf16 v[88:91], v[120:123], v[112:115], v[88:91]
    ds_read_b64_tr_b16 v[158:159], v171 offset:61952
    v_mfma_f32_16x16x32_bf16 v[92:95], v[124:127], v[112:115], v[92:95]
    ds_read_b128 v[140:143], v169 offset:51200
    v_mfma_f32_16x16x32_bf16 v[96:99], v[120:123], v[116:119], v[96:99]
    ds_read_b128 v[144:147], v169 offset:53248
    v_mfma_f32_16x16x32_bf16 v[100:103], v[124:127], v[116:119], v[100:103]
    ds_read_b128 v[148:151], v169 offset:55296
    s_add_u32 s69, s69, 1
    s_cmp_lt_u32 s69, 2
    s_cbranch_scc1 L_c2
    s_waitcnt lgkmcnt(0)
    s_barrier
    s_lshl_b32 s3, s29, 7
    s_add_u32 s3, s3, 138240
    v_lshl_add_u32 v243, v2, 4, s3
    v_mov_b32 v244, 139072
    v_mfma_f32_16x16x32_bf16 v[72:75], v[152:155], v[136:139], v[72:75]
    ds_read_b128 v[192:195], v243 offset:0
    v_mfma_f32_16x16x32_bf16 v[76:79], v[156:159], v[136:139], v[76:79]
    ds_read_b128 v[196:199], v243 offset:64
    v_mfma_f32_16x16x32_bf16 v[80:83], v[152:155], v[140:143], v[80:83]
    ds_read_b64 v[200:201], v244 offset:32
    v_mfma_f32_16x16x32_bf16 v[84:87], v[156:159], v[140:143], v[84:87]
    v_mfma_f32_16x16x32_bf16 v[88:91], v[152:155], v[144:147], v[88:91]
    v_mfma_f32_16x16x32_bf16 v[92:95], v[156:159], v[144:147], v[92:95]
    v_mfma_f32_16x16x32_bf16 v[96:99], v[152:155], v[148:151], v[96:99]
    v_mfma_f32_16x16x32_bf16 v[100:103], v[156:159], v[148:151], v[100:103]
    s_waitcnt lgkmcnt(0)
    v_readfirstlane_b32 s33, v200
    v_readfirstlane_b32 s32, v201
    v_pk_fma_f32 v[72:73], v[180:181], v[192:193], v[72:73] op_sel_hi:[0,1,1] neg_lo:[1,0,0] neg_hi:[1,0,0]
    v_pk_fma_f32 v[74:75], v[180:181], v[194:195], v[74:75] op_sel_hi:[0,1,1] neg_lo:[1,0,0] neg_hi:[1,0,0]
    v_pk_fma_f32 v[76:77], v[180:181], v[196:197], v[76:77] op_sel_hi:[0,1,1] neg_lo:[1,0,0] neg_hi:[1,0,0]
    v_pk_fma_f32 v[78:79], v[180:181], v[198:199], v[78:79] op_sel_hi:[0,1,1] neg_lo:[1,0,0] neg_hi:[1,0,0]
    v_cvt_pk_bf16_f32 v104, v72, v73
    v_cvt_pk_bf16_f32 v105, v74, v75
    v_cvt_pk_bf16_f32 v106, v76, v77
    v_cvt_pk_bf16_f32 v107, v78, v79
    v_pk_fma_f32 v[80:81], v[182:183], v[192:193], v[80:81] op_sel_hi:[0,1,1] neg_lo:[1,0,0] neg_hi:[1,0,0]
    v_pk_fma_f32 v[82:83], v[182:183], v[194:195], v[82:83] op_sel_hi:[0,1,1] neg_lo:[1,0,0] neg_hi:[1,0,0]
    v_pk_fma_f32 v[84:85], v[182:183], v[196:197], v[84:85] op_sel_hi:[0,1,1] neg_lo:[1,0,0] neg_hi:[1,0,0]
    v_pk_fma_f32 v[86:87], v[182:183], v[198:199], v[86:87] op_sel_hi:[0,1,1] neg_lo:[1,0,0] neg_hi:[1,0,0]
    v_cvt_pk_bf16_f32 v108, v80, v81
    v_cvt_pk_bf16_f32 v109, v82, v83
    v_cvt_pk_bf16_f32 v110, v84, v85
    v_cvt_pk_bf16_f32 v111, v86, v87
    v_pk_fma_f32 v[88:89], v[184:185], v[192:193], v[88:89] op_sel_hi:[0,1,1] neg_lo:[1,0,0] neg_hi:[1,0,0]
    v_pk_fma_f32 v[90:91], v[184:185], v[194:195], v[90:91] op_sel_hi:[0,1,1] neg_lo:[1,0,0] neg_hi:[1,0,0]
    v_pk_fma_f32 v[92:93], v[184:185], v[196:197], v[92:93] op_sel_hi:[0,1,1] neg_lo:[1,0,0] neg_hi:[1,0,0]
    v_pk_fma_f32 v[94:95], v[184:185], v[198:199], v[94:95] op_sel_hi:[0,1,1] neg_lo:[1,0,0] neg_hi:[1,0,0]
    v_cvt_pk_bf16_f32 v112, v88, v89
    v_cvt_pk_bf16_f32 v113, v90, v91
    v_cvt_pk_bf16_f32 v114, v92, v93
    v_cvt_pk_bf16_f32 v115, v94, v95
    v_pk_fma_f32 v[96:97], v[186:187], v[192:193], v[96:97] op_sel_hi:[0,1,1] neg_lo:[1,0,0] neg_hi:[1,0,0]
    v_pk_fma_f32 v[98:99], v[186:187], v[194:195], v[98:99] op_sel_hi:[0,1,1] neg_lo:[1,0,0] neg_hi:[1,0,0]
    v_pk_fma_f32 v[100:101], v[186:187], v[196:197], v[100:101] op_sel_hi:[0,1,1] neg_lo:[1,0,0] neg_hi:[1,0,0]
    v_pk_fma_f32 v[102:103], v[186:187], v[198:199], v[102:103] op_sel_hi:[0,1,1] neg_lo:[1,0,0] neg_hi:[1,0,0]
    v_cvt_pk_bf16_f32 v116, v96, v97
    v_cvt_pk_bf16_f32 v117, v98, v99
    v_cvt_pk_bf16_f32 v118, v100, v101
    v_cvt_pk_bf16_f32 v119, v102, v103
    v_mfma_f32_16x16x32_bf16 v[120:123], v[172:175], v[104:107], 0
    v_mfma_f32_16x16x32_bf16 v[124:127], v[176:179], v[104:107], 0
    v_mfma_f32_16x16x32_bf16 v[128:131], v[172:175], v[108:111], 0
    v_mfma_f32_16x16x32_bf16 v[132:135], v[176:179], v[108:111], 0
    v_mfma_f32_16x16x32_bf16 v[136:139], v[172:175], v[112:115], 0
    v_mfma_f32_16x16x32_bf16 v[140:143], v[176:179], v[112:115], 0
    v_mfma_f32_16x16x32_bf16 v[144:147], v[172:175], v[116:119], 0
    v_mfma_f32_16x16x32_bf16 v[148:151], v[176:179], v[116:119], 0
    s_nop 0
    v_max3_f32 v224, v120, v121, v122
    v_min3_f32 v232, v120, v121, v122
    v_max3_f32 v224, v224, v123, v124
    v_min3_f32 v232, v232, v123, v124
    v_max3_f32 v224, v224, v125, v126
    v_min3_f32 v232, v232, v125, v126
    v_max_f32 v224, v224, v127
    v_min_f32 v232, v232, v127
    v_max3_f32 v226, v128, v129, v130
    v_min3_f32 v234, v128, v129, v130
    v_max3_f32 v226, v226, v131, v132
    v_min3_f32 v234, v234, v131, v132
    v_max3_f32 v226, v226, v133, v134
    v_min3_f32 v234, v234, v133, v134
    v_max_f32 v226, v226, v135
    v_min_f32 v234, v234, v135
    v_max3_f32 v228, v136, v137, v138
    v_min3_f32 v236, v136, v137, v138
    v_max3_f32 v228, v228, v139, v140
    v_min3_f32 v236, v236, v139, v140
    v_max3_f32 v228, v228, v141, v142
    v_min3_f32 v236, v236, v141, v142
    v_max_f32 v228, v228, v143
    v_min_f32 v236, v236, v143
    v_max3_f32 v230, v144, v145, v146
    v_min3_f32 v238, v144, v145, v146
    v_max3_f32 v230, v230, v147, v148
    v_min3_f32 v238, v238, v147, v148
    v_max3_f32 v230, v230, v149, v150
    v_min3_f32 v238, v238, v149, v150
    v_max_f32 v230, v230, v151
    v_min_f32 v238, v238, v151
    v_permlane32_swap_b32 v224, v228
    v_permlane32_swap_b32 v226, v230
    v_permlane32_swap_b32 v232, v236
    v_permlane32_swap_b32 v234, v238
    v_max_f32 v224, v224, v228
    v_max_f32 v226, v226, v230
    v_min_f32 v232, v232, v236
    v_min_f32 v234, v234, v238
    v_permlane16_swap_b32 v224, v226
    s_nop 0
    v_permlane16_swap_b32 v232, v234
    v_max_f32 v224, v224, v226
    v_min_f32 v232, v232, v234
    v_mul_f32 v224, v224, v181
    v_mul_f32 v232, v232, v181
    v_mov_b32 v226, v224
    v_mov_b32 v234, v232
    s_nop 0
    v_permlane16_swap_b32 v224, v226
    v_permlane16_swap_b32 v232, v234
    v_mov_b32 v228, v224
    v_mov_b32 v230, v226
    v_mov_b32 v236, v232
    v_mov_b32 v238, v234
    v_permlane32_swap_b32 v224, v228
    v_permlane32_swap_b32 v226, v230
    v_permlane32_swap_b32 v232, v236
    v_permlane32_swap_b32 v234, v238
    v_pk_fma_f32 v[8:9], v[120:121], v[248:249], v[224:225] op_sel_hi:[1,0,0] neg_lo:[0,0,1] neg_hi:[0,0,1]
    v_pk_fma_f32 v[16:17], v[120:121], v[248:249], v[232:233] op_sel_hi:[1,0,0] neg_lo:[1,0,0] neg_hi:[1,0,0]
    v_pk_fma_f32 v[10:11], v[122:123], v[248:249], v[224:225] op_sel_hi:[1,0,0] neg_lo:[0,0,1] neg_hi:[0,0,1]
    v_pk_fma_f32 v[18:19], v[122:123], v[248:249], v[232:233] op_sel_hi:[1,0,0] neg_lo:[1,0,0] neg_hi:[1,0,0]
    v_pk_fma_f32 v[12:13], v[124:125], v[248:249], v[224:225] op_sel_hi:[1,0,0] neg_lo:[0,0,1] neg_hi:[0,0,1]
    v_pk_fma_f32 v[20:21], v[124:125], v[248:249], v[232:233] op_sel_hi:[1,0,0] neg_lo:[1,0,0] neg_hi:[1,0,0]
    v_pk_fma_f32 v[14:15], v[126:127], v[248:249], v[224:225] op_sel_hi:[1,0,0] neg_lo:[0,0,1] neg_hi:[0,0,1]
    v_pk_fma_f32 v[22:23], v[126:127], v[248:249], v[232:233] op_sel_hi:[1,0,0] neg_lo:[1,0,0] neg_hi:[1,0,0]
    v_exp_f32 v8, v8
    v_exp_f32 v9, v9
    v_exp_f32 v10, v10
    v_exp_f32 v11, v11
    v_exp_f32 v12, v12
    v_exp_f32 v13, v13
    v_exp_f32 v14, v14
    v_exp_f32 v15, v15
    v_exp_f32 v16, v16
    v_exp_f32 v17, v17
    v_exp_f32 v18, v18
    v_exp_f32 v19, v19
    v_exp_f32 v20, v20
    v_exp_f32 v21, v21
    v_exp_f32 v22, v22
    v_exp_f32 v23, v23
    v_pk_fma_f32 v[24:25], v[128:129], v[250:251], v[226:227] op_sel_hi:[1,0,0] neg_lo:[0,0,1] neg_hi:[0,0,1]
    v_pk_fma_f32 v[32:33], v[128:129], v[250:251], v[234:235] op_sel_hi:[1,0,0] neg_lo:[1,0,0] neg_hi:[1,0,0]
    v_pk_fma_f32 v[26:27], v[130:131], v[250:251], v[226:227] op_sel_hi:[1,0,0] neg_lo:[0,0,1] neg_hi:[0,0,1]
    v_pk_fma_f32 v[34:35], v[130:131], v[250:251], v[234:235] op_sel_hi:[1,0,0] neg_lo:[1,0,0] neg_hi:[1,0,0]
    v_pk_fma_f32 v[28:29], v[132:133], v[250:251], v[226:227] op_sel_hi:[1,0,0] neg_lo:[0,0,1] neg_hi:[0,0,1]
    v_pk_fma_f32 v[36:37], v[132:133], v[250:251], v[234:235] op_sel_hi:[1,0,0] neg_lo:[1,0,0] neg_hi:[1,0,0]
    v_pk_fma_f32 v[30:31], v[134:135], v[250:251], v[226:227] op_sel_hi:[1,0,0] neg_lo:[0,0,1] neg_hi:[0,0,1]
    v_pk_fma_f32 v[38:39], v[134:135], v[250:251], v[234:235] op_sel_hi:[1,0,0] neg_lo:[1,0,0] neg_hi:[1,0,0]
    v_exp_f32 v24, v24
    v_exp_f32 v25, v25
    v_exp_f32 v26, v26
    v_exp_f32 v27, v27
    v_exp_f32 v28, v28
    v_exp_f32 v29, v29
    v_exp_f32 v30, v30
    v_exp_f32 v31, v31
    v_exp_f32 v32, v32
    v_exp_f32 v33, v33
    v_exp_f32 v34, v34
    v_exp_f32 v35, v35
    v_exp_f32 v36, v36
    v_exp_f32 v37, v37
    v_exp_f32 v38, v38
    v_exp_f32 v39, v39
    v_pk_fma_f32 v[40:41], v[136:137], v[252:253], v[228:229] op_sel_hi:[1,0,0] neg_lo:[0,0,1] neg_hi:[0,0,1]
    v_pk_fma_f32 v[48:49], v[136:137], v[252:253], v[236:237] op_sel_hi:[1,0,0] neg_lo:[1,0,0] neg_hi:[1,0,0]
    v_pk_fma_f32 v[42:43], v[138:139], v[252:253], v[228:229] op_sel_hi:[1,0,0] neg_lo:[0,0,1] neg_hi:[0,0,1]
    v_pk_fma_f32 v[50:51], v[138:139], v[252:253], v[236:237] op_sel_hi:[1,0,0] neg_lo:[1,0,0] neg_hi:[1,0,0]
    v_pk_fma_f32 v[44:45], v[140:141], v[252:253], v[228:229] op_sel_hi:[1,0,0] neg_lo:[0,0,1] neg_hi:[0,0,1]
    v_pk_fma_f32 v[52:53], v[140:141], v[252:253], v[236:237] op_sel_hi:[1,0,0] neg_lo:[1,0,0] neg_hi:[1,0,0]
    v_pk_fma_f32 v[46:47], v[142:143], v[252:253], v[228:229] op_sel_hi:[1,0,0] neg_lo:[0,0,1] neg_hi:[0,0,1]
    v_pk_fma_f32 v[54:55], v[142:143], v[252:253], v[236:237] op_sel_hi:[1,0,0] neg_lo:[1,0,0] neg_hi:[1,0,0]
    v_exp_f32 v40, v40
    v_exp_f32 v41, v41
    v_exp_f32 v42, v42
    v_exp_f32 v43, v43
    v_exp_f32 v44, v44
    v_exp_f32 v45, v45
    v_exp_f32 v46, v46
    v_exp_f32 v47, v47
    v_exp_f32 v48, v48
    v_exp_f32 v49, v49
    v_exp_f32 v50, v50
    v_exp_f32 v51, v51
    v_exp_f32 v52, v52
    v_exp_f32 v53, v53
    v_exp_f32 v54, v54
    v_exp_f32 v55, v55
    v_pk_fma_f32 v[56:57], v[144:145], v[254:255], v[230:231] op_sel_hi:[1,0,0] neg_lo:[0,0,1] neg_hi:[0,0,1]
    v_pk_fma_f32 v[64:65], v[144:145], v[254:255], v[238:239] op_sel_hi:[1,0,0] neg_lo:[1,0,0] neg_hi:[1,0,0]
    v_pk_fma_f32 v[58:59], v[146:147], v[254:255], v[230:231] op_sel_hi:[1,0,0] neg_lo:[0,0,1] neg_hi:[0,0,1]
    v_pk_fma_f32 v[66:67], v[146:147], v[254:255], v[238:239] op_sel_hi:[1,0,0] neg_lo:[1,0,0] neg_hi:[1,0,0]
    v_pk_fma_f32 v[60:61], v[148:149], v[254:255], v[230:231] op_sel_hi:[1,0,0] neg_lo:[0,0,1] neg_hi:[0,0,1]
    v_pk_fma_f32 v[68:69], v[148:149], v[254:255], v[238:239] op_sel_hi:[1,0,0] neg_lo:[1,0,0] neg_hi:[1,0,0]
    v_pk_fma_f32 v[62:63], v[150:151], v[254:255], v[230:231] op_sel_hi:[1,0,0] neg_lo:[0,0,1] neg_hi:[0,0,1]
    v_pk_fma_f32 v[70:71], v[150:151], v[254:255], v[238:239] op_sel_hi:[1,0,0] neg_lo:[1,0,0] neg_hi:[1,0,0]
    v_exp_f32 v56, v56
    v_exp_f32 v57, v57
    v_exp_f32 v58, v58
    v_exp_f32 v59, v59
    v_exp_f32 v60, v60
    v_exp_f32 v61, v61
    v_exp_f32 v62, v62
    v_exp_f32 v63, v63
    v_exp_f32 v64, v64
    v_exp_f32 v65, v65
    v_exp_f32 v66, v66
    v_exp_f32 v67, v67
    v_exp_f32 v68, v68
    v_exp_f32 v69, v69
    v_exp_f32 v70, v70
    v_exp_f32 v71, v71
    v_pk_add_f32 v[120:121], v[8:9], v[10:11]
    v_pk_add_f32 v[122:123], v[12:13], v[14:15]
    v_pk_add_f32 v[124:125], v[16:17], v[18:19]
    v_pk_add_f32 v[126:127], v[20:21], v[22:23]
    v_pk_add_f32 v[128:129], v[24:25], v[26:27]
    v_pk_add_f32 v[130:131], v[28:29], v[30:31]
    v_pk_add_f32 v[132:133], v[32:33], v[34:35]
    v_pk_add_f32 v[134:135], v[36:37], v[38:39]
    v_pk_add_f32 v[136:137], v[40:41], v[42:43]
    v_pk_add_f32 v[138:139], v[44:45], v[46:47]
    v_pk_add_f32 v[140:141], v[48:49], v[50:51]
    v_pk_add_f32 v[142:143], v[52:53], v[54:55]
    v_pk_add_f32 v[144:145], v[56:57], v[58:59]
    v_pk_add_f32 v[146:147], v[60:61], v[62:63]
    v_pk_add_f32 v[148:149], v[64:65], v[66:67]
    v_pk_add_f32 v[150:151], v[68:69], v[70:71]
    v_pk_add_f32 v[120:121], v[120:121], v[122:123]
    v_pk_add_f32 v[124:125], v[124:125], v[126:127]
    v_pk_add_f32 v[128:129], v[128:129], v[130:131]
    v_pk_add_f32 v[132:133], v[132:133], v[134:135]
    v_pk_add_f32 v[136:137], v[136:137], v[138:139]
    v_pk_add_f32 v[140:141], v[140:141], v[142:143]
    v_pk_add_f32 v[144:145], v[144:145], v[146:147]
    v_pk_add_f32 v[148:149], v[148:149], v[150:151]
    v_add_f32 v224, v120, v121
    v_add_f32 v232, v124, v125
    v_add_f32 v226, v128, v129
    v_add_f32 v234, v132, v133
    v_add_f32 v228, v136, v137
    v_add_f32 v236, v140, v141
    v_add_f32 v230, v144, v145
    v_add_f32 v238, v148, v149
    v_permlane32_swap_b32 v224, v228
    v_permlane32_swap_b32 v226, v230
    v_permlane32_swap_b32 v232, v236
    v_permlane32_swap_b32 v234, v238
    v_add_f32 v224, v224, v228
    v_add_f32 v226, v226, v230
    v_add_f32 v232, v232, v236
    v_add_f32 v234, v234, v238
    v_permlane16_swap_b32 v224, v226
    s_nop 0
    v_permlane16_swap_b32 v232, v234
    v_add_f32 v224, v224, v226
    v_add_f32 v232, v232, v234
    v_rcp_f32 v232, v232
    s_lshl_b32 s3, s29, 12
    s_add_u32 s3, s3, 140800
    v_add_u32 v240, s3, v5
    s_lshl_b32 s3, s29, 7
    s_add_u32 s3, s3, 148992
    v_lshl_add_u32 v241, v2, 3, s3
    v_mul_f32 v232, v232, v224
    v_mul_f32 v224, 0x358637bd, v224
    v_mov_b32 v226, v224
    v_mov_b32 v234, v232
    s_nop 0
    v_permlane16_swap_b32 v224, v226
    v_permlane16_swap_b32 v232, v234
    v_mov_b32 v228, v224
    v_mov_b32 v230, v226
    v_mov_b32 v236, v232
    v_mov_b32 v238, v234
    v_permlane32_swap_b32 v224, v228
    v_permlane32_swap_b32 v226, v230
    v_permlane32_swap_b32 v232, v236
    v_permlane32_swap_b32 v234, v238
    v_pk_mul_f32 v[16:17], v[16:17], v[232:233] op_sel_hi:[1,0]
    v_pk_mul_f32 v[18:19], v[18:19], v[232:233] op_sel_hi:[1,0]
    v_pk_mul_f32 v[20:21], v[20:21], v[232:233] op_sel_hi:[1,0]
    v_pk_mul_f32 v[22:23], v[22:23], v[232:233] op_sel_hi:[1,0]
    v_cvt_pk_bf16_f32 v72, v8, v9
    v_cvt_pk_bf16_f32 v73, v10, v11
    v_cvt_pk_bf16_f32 v74, v12, v13
    v_cvt_pk_bf16_f32 v75, v14, v15
    v_cvt_pk_bf16_f32 v76, v16, v17
    v_cvt_pk_bf16_f32 v77, v18, v19
    v_cvt_pk_bf16_f32 v78, v20, v21
    v_cvt_pk_bf16_f32 v79, v22, v23
    v_pk_mul_f32 v[32:33], v[32:33], v[234:235] op_sel_hi:[1,0]
    v_pk_mul_f32 v[34:35], v[34:35], v[234:235] op_sel_hi:[1,0]
    v_pk_mul_f32 v[36:37], v[36:37], v[234:235] op_sel_hi:[1,0]
    v_pk_mul_f32 v[38:39], v[38:39], v[234:235] op_sel_hi:[1,0]
    v_cvt_pk_bf16_f32 v80, v24, v25
    v_cvt_pk_bf16_f32 v81, v26, v27
    v_cvt_pk_bf16_f32 v82, v28, v29
    v_cvt_pk_bf16_f32 v83, v30, v31
    v_cvt_pk_bf16_f32 v84, v32, v33
    v_cvt_pk_bf16_f32 v85, v34, v35
    v_cvt_pk_bf16_f32 v86, v36, v37
    v_cvt_pk_bf16_f32 v87, v38, v39
    v_pk_mul_f32 v[48:49], v[48:49], v[236:237] op_sel_hi:[1,0]
    v_pk_mul_f32 v[50:51], v[50:51], v[236:237] op_sel_hi:[1,0]
    v_pk_mul_f32 v[52:53], v[52:53], v[236:237] op_sel_hi:[1,0]
    v_pk_mul_f32 v[54:55], v[54:55], v[236:237] op_sel_hi:[1,0]
    v_cvt_pk_bf16_f32 v88, v40, v41
    v_cvt_pk_bf16_f32 v89, v42, v43
    v_cvt_pk_bf16_f32 v90, v44, v45
    v_cvt_pk_bf16_f32 v91, v46, v47
    v_cvt_pk_bf16_f32 v92, v48, v49
    v_cvt_pk_bf16_f32 v93, v50, v51
    v_cvt_pk_bf16_f32 v94, v52, v53
    v_cvt_pk_bf16_f32 v95, v54, v55
    v_pk_mul_f32 v[64:65], v[64:65], v[238:239] op_sel_hi:[1,0]
    v_pk_mul_f32 v[66:67], v[66:67], v[238:239] op_sel_hi:[1,0]
    v_pk_mul_f32 v[68:69], v[68:69], v[238:239] op_sel_hi:[1,0]
    v_pk_mul_f32 v[70:71], v[70:71], v[238:239] op_sel_hi:[1,0]
    v_cvt_pk_bf16_f32 v96, v56, v57
    v_cvt_pk_bf16_f32 v97, v58, v59
    v_cvt_pk_bf16_f32 v98, v60, v61
    v_cvt_pk_bf16_f32 v99, v62, v63
    v_cvt_pk_bf16_f32 v100, v64, v65
    v_cvt_pk_bf16_f32 v101, v66, v67
    v_cvt_pk_bf16_f32 v102, v68, v69
    v_cvt_pk_bf16_f32 v103, v70, v71
    s_and_b32 s34, s33, 0x7ff
    s_sub_u32 s34, 2047, s34
    s_lshr_b32 s3, s34, 7
    s_cmp_eq_u32 s3, s30
    s_cselect_b32 s35, 1, 0
    s_lshl_b32 s3, s36, 3
    s_lshl_b32 s65, s28, 2
    s_add_u32 s3, s3, s65
    s_lshl_b32 s3, s3, 5
    s_lshl_b32 s65, s37, 1
    s_add_u32 s65, s65, s29
    s_add_u32 s3, s3, s65
    s_lshl_b32 s3, s3, 10
    s_add_u32 s3, s3, 12582912
    s_lshl_b32 s66, s36, 1
    s_add_u32 s66, s66, s28
    s_lshl_b32 s66, s66, 5
    s_add_u32 s66, s66, s65
    s_lshl_b32 s66, s66, 2
    s_add_u32 s66, s66, 196608
    s_barrier
    ds_read_b128 v[104:107], v240 offset:0
    ds_read_b128 v[108:111], v240 offset:1024
    ds_read_b128 v[112:115], v240 offset:2048
    ds_read_b128 v[116:119], v240 offset:3072
    ds_read_b64 v[120:121], v241 offset:0
    ds_read_b64 v[122:123], v241 offset:32
    ds_read_b64 v[124:125], v241 offset:64
    ds_read_b64 v[126:127], v241 offset:96
    s_waitcnt lgkmcnt(0)
    v_mfma_f32_16x16x32_bf16 v[40:43], v[120:123], v[72:75], 0
    v_mfma_f32_16x16x32_bf16 v[40:43], v[124:127], v[76:79], v[40:43]
    v_mfma_f32_16x16x32_bf16 v[44:47], v[120:123], v[80:83], 0
    v_mfma_f32_16x16x32_bf16 v[44:47], v[124:127], v[84:87], v[44:47]
    v_mfma_f32_16x16x32_bf16 v[48:51], v[120:123], v[88:91], 0
    v_mfma_f32_16x16x32_bf16 v[48:51], v[124:127], v[92:95], v[48:51]
    v_mfma_f32_16x16x32_bf16 v[52:55], v[120:123], v[96:99], 0
    v_mfma_f32_16x16x32_bf16 v[52:55], v[124:127], v[100:103], v[52:55]
    v_mfma_f32_16x16x32_bf16 v[8:11], v[104:107], v[72:75], 0
    v_mfma_f32_16x16x32_bf16 v[8:11], v[112:115], v[76:79], v[8:11]
    v_mfma_f32_16x16x32_bf16 v[12:15], v[108:111], v[72:75], 0
    v_mfma_f32_16x16x32_bf16 v[12:15], v[116:119], v[76:79], v[12:15]
    v_add_f32 v40, v40, v224
    v_add_f32 v44, v44, v226
    v_add_f32 v48, v48, v228
    s_nop 0
    v_add_f32 v52, v52, v230
    v_mfma_f32_16x16x32_bf16 v[16:19], v[104:107], v[80:83], 0
    v_mfma_f32_16x16x32_bf16 v[16:19], v[112:115], v[84:87], v[16:19]
    v_mfma_f32_16x16x32_bf16 v[20:23], v[108:111], v[80:83], 0
    v_mfma_f32_16x16x32_bf16 v[20:23], v[116:119], v[84:87], v[20:23]
    v_rcp_f32 v40, v40
    v_rcp_f32 v44, v44
    v_rcp_f32 v48, v48
    v_rcp_f32 v52, v52
    v_mfma_f32_16x16x32_bf16 v[24:27], v[104:107], v[88:91], 0
    v_mfma_f32_16x16x32_bf16 v[24:27], v[112:115], v[92:95], v[24:27]
    v_mfma_f32_16x16x32_bf16 v[28:31], v[108:111], v[88:91], 0
    v_mfma_f32_16x16x32_bf16 v[28:31], v[116:119], v[92:95], v[28:31]
    v_mfma_f32_16x16x32_bf16 v[32:35], v[104:107], v[96:99], 0
    v_mfma_f32_16x16x32_bf16 v[32:35], v[112:115], v[100:103], v[32:35]
    v_mfma_f32_16x16x32_bf16 v[36:39], v[108:111], v[96:99], 0
    v_mfma_f32_16x16x32_bf16 v[36:39], v[116:119], v[100:103], v[36:39]
    v_pk_mul_f32 v[8:9], v[8:9], v[40:41] op_sel_hi:[1,0]
    v_pk_mul_f32 v[10:11], v[10:11], v[40:41] op_sel_hi:[1,0]
    v_pk_mul_f32 v[12:13], v[12:13], v[40:41] op_sel_hi:[1,0]
    v_pk_mul_f32 v[14:15], v[14:15], v[40:41] op_sel_hi:[1,0]
    v_cvt_pk_bf16_f32 v128, v8, v9
    v_cvt_pk_bf16_f32 v129, v10, v11
    v_cvt_pk_bf16_f32 v130, v12, v13
    v_cvt_pk_bf16_f32 v131, v14, v15
    buffer_store_dwordx4 v[128:131], v5, s[12:15], s3 offen sc1
    s_add_u32 s3, s3, 32768
    v_pk_mul_f32 v[16:17], v[16:17], v[44:45] op_sel_hi:[1,0]
    v_pk_mul_f32 v[18:19], v[18:19], v[44:45] op_sel_hi:[1,0]
    v_pk_mul_f32 v[20:21], v[20:21], v[44:45] op_sel_hi:[1,0]
    v_pk_mul_f32 v[22:23], v[22:23], v[44:45] op_sel_hi:[1,0]
    v_cvt_pk_bf16_f32 v132, v16, v17
    v_cvt_pk_bf16_f32 v133, v18, v19
    v_cvt_pk_bf16_f32 v134, v20, v21
    v_cvt_pk_bf16_f32 v135, v22, v23
    buffer_store_dwordx4 v[132:135], v5, s[12:15], s3 offen sc1
    s_add_u32 s3, s3, 32768
    v_pk_mul_f32 v[24:25], v[24:25], v[48:49] op_sel_hi:[1,0]
    v_pk_mul_f32 v[26:27], v[26:27], v[48:49] op_sel_hi:[1,0]
    v_pk_mul_f32 v[28:29], v[28:29], v[48:49] op_sel_hi:[1,0]
    v_pk_mul_f32 v[30:31], v[30:31], v[48:49] op_sel_hi:[1,0]
    v_cvt_pk_bf16_f32 v136, v24, v25
    v_cvt_pk_bf16_f32 v137, v26, v27
    v_cvt_pk_bf16_f32 v138, v28, v29
    v_cvt_pk_bf16_f32 v139, v30, v31
    buffer_store_dwordx4 v[136:139], v5, s[12:15], s3 offen sc1
    s_add_u32 s3, s3, 32768
    v_pk_mul_f32 v[32:33], v[32:33], v[52:53] op_sel_hi:[1,0]
    v_pk_mul_f32 v[34:35], v[34:35], v[52:53] op_sel_hi:[1,0]
    v_pk_mul_f32 v[36:37], v[36:37], v[52:53] op_sel_hi:[1,0]
    v_pk_mul_f32 v[38:39], v[38:39], v[52:53] op_sel_hi:[1,0]
    v_cvt_pk_bf16_f32 v140, v32, v33
    v_cvt_pk_bf16_f32 v141, v34, v35
    v_cvt_pk_bf16_f32 v142, v36, v37
    v_cvt_pk_bf16_f32 v143, v38, v39
    buffer_store_dwordx4 v[140:143], v5, s[12:15], s3 offen sc1
    s_mov_b32 s24, s58
    s_mov_b32 s25, s59
    s_mov_b32 s26, 4194304
    s_mov_b32 s27, 0x00020000
    s_lshl_b32 s3, s30, 7
    s_lshl_b32 s65, s38, 5
    s_add_u32 s3, s3, s65
    v_add_u32 v6, s3, v3
    v_lshlrev_b32 v6, 11, v6
    v_and_b32 v7, 1, v2
    v_lshl_add_u32 v6, v7, 5, v6
    v_lshrrev_b32 v7, 1, v2
    v_lshl_add_u32 v6, v7, 4, v6
    s_lshl_b32 s3, s31, 7
    v_add_u32 v248, s3, v6
    s_lshl_b32 s3, s38, 7
    s_add_u32 s3, s3, 136704
    v_lshl_add_u32 v6, v3, 2, s3
    s_mov_b32 s68, 32768
    ds_read_b32 v144, v6 offset:0
    ds_read_b32 v148, v6 offset:512
    ds_read_b32 v146, v6 offset:64
    ds_read_b32 v150, v6 offset:576
    s_waitcnt vmcnt(0)
    v_mov_b32 v6, 0
    v_mov_b32 v7, s32
    s_mov_b64 exec, 1
    buffer_store_dword v7, v6, s[12:15], s66 offen sc1
    s_mov_b64 exec, -1
    buffer_load_dwordx4 v[56:59], v248, s[4:7], 0 offen offset:0
    buffer_load_dwordx4 v[60:63], v248, s[4:7], 0 offen offset:64
    buffer_load_dwordx4 v[64:67], v248, s[4:7], s68 offen offset:0
    buffer_load_dwordx4 v[68:71], v248, s[4:7], s68 offen offset:64
    v_lshrrev_b32 v6, 2, v1
    v_lshlrev_b32 v6, 7, v6
    v_and_b32 v7, 3, v1
    v_lshl_add_u32 v6, v7, 3, v6
    v_bfe_u32 v7, v1, 3, 2
    v_xor_b32 v4, 0, v7
    v_lshl_add_u32 v250, v4, 5, v6
    v_xor_b32 v4, 1, v7
    v_lshl_add_u32 v251, v4, 5, v6
    v_xor_b32 v4, 2, v7
    v_lshl_add_u32 v252, v4, 5, v6
    v_xor_b32 v4, 3, v7
    v_lshl_add_u32 v253, v4, 5, v6
    s_lshl_b32 s72, s30, 3
    s_lshl_b32 s3, s38, 1
    s_add_u32 s72, s72, s3
    s_lshl_b32 s72, s72, 15
    s_add_u32 s72, s72, 12582912
    v_add_u32 v4, 32768, v5
    s_mov_b32 s71, 0xbfb8aa3b
    s_waitcnt vmcnt(0) lgkmcnt(0)
    v_lshlrev_b32 v176, 16, v56
    v_and_b32 v177, 0xffff0000, v56
    v_lshlrev_b32 v178, 16, v57
    v_and_b32 v179, 0xffff0000, v57
    v_lshlrev_b32 v180, 16, v58
    v_and_b32 v181, 0xffff0000, v58
    v_lshlrev_b32 v182, 16, v59
    v_and_b32 v183, 0xffff0000, v59
    v_lshlrev_b32 v184, 16, v60
    v_and_b32 v185, 0xffff0000, v60
    v_lshlrev_b32 v186, 16, v61
    v_and_b32 v187, 0xffff0000, v61
    v_lshlrev_b32 v188, 16, v62
    v_and_b32 v189, 0xffff0000, v62
    v_lshlrev_b32 v190, 16, v63
    v_and_b32 v191, 0xffff0000, v63
    v_lshlrev_b32 v192, 16, v64
    v_and_b32 v193, 0xffff0000, v64
    v_lshlrev_b32 v194, 16, v65
    v_and_b32 v195, 0xffff0000, v65
    v_lshlrev_b32 v196, 16, v66
    v_and_b32 v197, 0xffff0000, v66
    v_lshlrev_b32 v198, 16, v67
    v_and_b32 v199, 0xffff0000, v67
    v_lshlrev_b32 v200, 16, v68
    v_and_b32 v201, 0xffff0000, v68
    v_lshlrev_b32 v202, 16, v69
    v_and_b32 v203, 0xffff0000, v69
    v_lshlrev_b32 v204, 16, v70
    v_and_b32 v205, 0xffff0000, v70
    v_lshlrev_b32 v206, 16, v71
    v_and_b32 v207, 0xffff0000, v71
    v_pk_add_f32 v[208:209], v[176:177], v[144:145] op_sel_hi:[1,0] neg_lo:[0,1] neg_hi:[0,1]
    v_pk_add_f32 v[210:211], v[178:179], v[144:145] op_sel_hi:[1,0] neg_lo:[0,1] neg_hi:[0,1]
    v_pk_add_f32 v[212:213], v[180:181], v[144:145] op_sel_hi:[1,0] neg_lo:[0,1] neg_hi:[0,1]
    v_pk_add_f32 v[214:215], v[182:183], v[144:145] op_sel_hi:[1,0] neg_lo:[0,1] neg_hi:[0,1]
    v_pk_add_f32 v[216:217], v[184:185], v[144:145] op_sel_hi:[1,0] neg_lo:[0,1] neg_hi:[0,1]
    v_pk_add_f32 v[218:219], v[186:187], v[144:145] op_sel_hi:[1,0] neg_lo:[0,1] neg_hi:[0,1]
    v_pk_add_f32 v[220:221], v[188:189], v[144:145] op_sel_hi:[1,0] neg_lo:[0,1] neg_hi:[0,1]
    v_pk_add_f32 v[222:223], v[190:191], v[144:145] op_sel_hi:[1,0] neg_lo:[0,1] neg_hi:[0,1]
    v_pk_add_f32 v[224:225], v[192:193], v[146:147] op_sel_hi:[1,0] neg_lo:[0,1] neg_hi:[0,1]
    v_pk_add_f32 v[226:227], v[194:195], v[146:147] op_sel_hi:[1,0] neg_lo:[0,1] neg_hi:[0,1]
    v_pk_add_f32 v[228:229], v[196:197], v[146:147] op_sel_hi:[1,0] neg_lo:[0,1] neg_hi:[0,1]
    v_pk_add_f32 v[230:231], v[198:199], v[146:147] op_sel_hi:[1,0] neg_lo:[0,1] neg_hi:[0,1]
    v_pk_add_f32 v[232:233], v[200:201], v[146:147] op_sel_hi:[1,0] neg_lo:[0,1] neg_hi:[0,1]
    v_pk_add_f32 v[234:235], v[202:203], v[146:147] op_sel_hi:[1,0] neg_lo:[0,1] neg_hi:[0,1]
    v_pk_add_f32 v[236:237], v[204:205], v[146:147] op_sel_hi:[1,0] neg_lo:[0,1] neg_hi:[0,1]
    v_pk_add_f32 v[238:239], v[206:207], v[146:147] op_sel_hi:[1,0] neg_lo:[0,1] neg_hi:[0,1]
    v_cvt_pk_bf16_f32 v72, v208, v209
    v_cvt_pk_bf16_f32 v73, v210, v211
    v_cvt_pk_bf16_f32 v74, v212, v213
    v_cvt_pk_bf16_f32 v75, v214, v215
    v_cvt_pk_bf16_f32 v76, v216, v217
    v_cvt_pk_bf16_f32 v77, v218, v219
    v_cvt_pk_bf16_f32 v78, v220, v221
    v_cvt_pk_bf16_f32 v79, v222, v223
    v_cvt_pk_bf16_f32 v80, v224, v225
    v_cvt_pk_bf16_f32 v81, v226, v227
    v_cvt_pk_bf16_f32 v82, v228, v229
    v_cvt_pk_bf16_f32 v83, v230, v231
    v_cvt_pk_bf16_f32 v84, v232, v233
    v_cvt_pk_bf16_f32 v85, v234, v235
    v_cvt_pk_bf16_f32 v86, v236, v237
    v_cvt_pk_bf16_f32 v87, v238, v239
    v_lshlrev_b32 v208, 16, v72
    v_and_b32 v209, 0xffff0000, v72
    v_lshlrev_b32 v210, 16, v73
    v_and_b32 v211, 0xffff0000, v73
    v_lshlrev_b32 v212, 16, v74
    v_and_b32 v213, 0xffff0000, v74
    v_lshlrev_b32 v214, 16, v75
    v_and_b32 v215, 0xffff0000, v75
    v_lshlrev_b32 v216, 16, v76
    v_and_b32 v217, 0xffff0000, v76
    v_lshlrev_b32 v218, 16, v77
    v_and_b32 v219, 0xffff0000, v77
    v_lshlrev_b32 v220, 16, v78
    v_and_b32 v221, 0xffff0000, v78
    v_lshlrev_b32 v222, 16, v79
    v_and_b32 v223, 0xffff0000, v79
    v_lshlrev_b32 v224, 16, v80
    v_and_b32 v225, 0xffff0000, v80
    v_lshlrev_b32 v226, 16, v81
    v_and_b32 v227, 0xffff0000, v81
    v_lshlrev_b32 v228, 16, v82
    v_and_b32 v229, 0xffff0000, v82
    v_lshlrev_b32 v230, 16, v83
    v_and_b32 v231, 0xffff0000, v83
    v_lshlrev_b32 v232, 16, v84
    v_and_b32 v233, 0xffff0000, v84
    v_lshlrev_b32 v234, 16, v85
    v_and_b32 v235, 0xffff0000, v85
    v_lshlrev_b32 v236, 16, v86
    v_and_b32 v237, 0xffff0000, v86
    v_lshlrev_b32 v238, 16, v87
    v_and_b32 v239, 0xffff0000, v87
    v_pk_mul_f32 v[208:209], v[208:209], v[148:149] op_sel_hi:[1,0]
    v_pk_mul_f32 v[210:211], v[210:211], v[148:149] op_sel_hi:[1,0]
    v_pk_mul_f32 v[212:213], v[212:213], v[148:149] op_sel_hi:[1,0]
    v_pk_mul_f32 v[214:215], v[214:215], v[148:149] op_sel_hi:[1,0]
    v_pk_mul_f32 v[216:217], v[216:217], v[148:149] op_sel_hi:[1,0]
    v_pk_mul_f32 v[218:219], v[218:219], v[148:149] op_sel_hi:[1,0]
    v_pk_mul_f32 v[220:221], v[220:221], v[148:149] op_sel_hi:[1,0]
    v_pk_mul_f32 v[222:223], v[222:223], v[148:149] op_sel_hi:[1,0]
    v_pk_mul_f32 v[224:225], v[224:225], v[150:151] op_sel_hi:[1,0]
    v_pk_mul_f32 v[226:227], v[226:227], v[150:151] op_sel_hi:[1,0]
    v_pk_mul_f32 v[228:229], v[228:229], v[150:151] op_sel_hi:[1,0]
    v_pk_mul_f32 v[230:231], v[230:231], v[150:151] op_sel_hi:[1,0]
    v_pk_mul_f32 v[232:233], v[232:233], v[150:151] op_sel_hi:[1,0]
    v_pk_mul_f32 v[234:235], v[234:235], v[150:151] op_sel_hi:[1,0]
    v_pk_mul_f32 v[236:237], v[236:237], v[150:151] op_sel_hi:[1,0]
    v_pk_mul_f32 v[238:239], v[238:239], v[150:151] op_sel_hi:[1,0]
    v_cvt_pk_bf16_f32 v72, v208, v209
    v_cvt_pk_bf16_f32 v73, v210, v211
    v_cvt_pk_bf16_f32 v74, v212, v213
    v_cvt_pk_bf16_f32 v75, v214, v215
    v_cvt_pk_bf16_f32 v76, v216, v217
    v_cvt_pk_bf16_f32 v77, v218, v219
    v_cvt_pk_bf16_f32 v78, v220, v221
    v_cvt_pk_bf16_f32 v79, v222, v223
    v_cvt_pk_bf16_f32 v80, v224, v225
    v_cvt_pk_bf16_f32 v81, v226, v227
    v_cvt_pk_bf16_f32 v82, v228, v229
    v_cvt_pk_bf16_f32 v83, v230, v231
    v_cvt_pk_bf16_f32 v84, v232, v233
    v_cvt_pk_bf16_f32 v85, v234, v235
    v_cvt_pk_bf16_f32 v86, v236, v237
    v_cvt_pk_bf16_f32 v87, v238, v239
    v_lshlrev_b32 v208, 16, v72
    v_and_b32 v209, 0xffff0000, v72
    v_lshlrev_b32 v210, 16, v73
    v_and_b32 v211, 0xffff0000, v73
    v_lshlrev_b32 v212, 16, v74
    v_and_b32 v213, 0xffff0000, v74
    v_lshlrev_b32 v214, 16, v75
    v_and_b32 v215, 0xffff0000, v75
    v_lshlrev_b32 v216, 16, v76
    v_and_b32 v217, 0xffff0000, v76
    v_lshlrev_b32 v218, 16, v77
    v_and_b32 v219, 0xffff0000, v77
    v_lshlrev_b32 v220, 16, v78
    v_and_b32 v221, 0xffff0000, v78
    v_lshlrev_b32 v222, 16, v79
    v_and_b32 v223, 0xffff0000, v79
    v_lshlrev_b32 v224, 16, v80
    v_and_b32 v225, 0xffff0000, v80
    v_lshlrev_b32 v226, 16, v81
    v_and_b32 v227, 0xffff0000, v81
    v_lshlrev_b32 v228, 16, v82
    v_and_b32 v229, 0xffff0000, v82
    v_lshlrev_b32 v230, 16, v83
    v_and_b32 v231, 0xffff0000, v83
    v_lshlrev_b32 v232, 16, v84
    v_and_b32 v233, 0xffff0000, v84
    v_lshlrev_b32 v234, 16, v85
    v_and_b32 v235, 0xffff0000, v85
    v_lshlrev_b32 v236, 16, v86
    v_and_b32 v237, 0xffff0000, v86
    v_lshlrev_b32 v238, 16, v87
    v_and_b32 v239, 0xffff0000, v87
    v_mul_f32 v72, s71, v208
    v_mul_f32 v73, s71, v209
    v_mul_f32 v74, s71, v210
    v_mul_f32 v75, s71, v211
    v_mul_f32 v76, s71, v212
    v_mul_f32 v77, s71, v213
    v_mul_f32 v78, s71, v214
    v_mul_f32 v79, s71, v215
    v_mul_f32 v80, s71, v216
    v_mul_f32 v81, s71, v217
    v_mul_f32 v82, s71, v218
    v_mul_f32 v83, s71, v219
    v_mul_f32 v84, s71, v220
    v_mul_f32 v85, s71, v221
    v_mul_f32 v86, s71, v222
    v_mul_f32 v87, s71, v223
    v_mul_f32 v88, s71, v224
    v_mul_f32 v89, s71, v225
    v_mul_f32 v90, s71, v226
    v_mul_f32 v91, s71, v227
    v_mul_f32 v92, s71, v228
    v_mul_f32 v93, s71, v229
    v_mul_f32 v94, s71, v230
    v_mul_f32 v95, s71, v231
    v_mul_f32 v96, s71, v232
    v_mul_f32 v97, s71, v233
    v_mul_f32 v98, s71, v234
    v_mul_f32 v99, s71, v235
    v_mul_f32 v100, s71, v236
    v_mul_f32 v101, s71, v237
    v_mul_f32 v102, s71, v238
    v_mul_f32 v103, s71, v239
    v_exp_f32 v72, v72
    v_exp_f32 v73, v73
    v_exp_f32 v74, v74
    v_exp_f32 v75, v75
    v_exp_f32 v76, v76
    v_exp_f32 v77, v77
    v_exp_f32 v78, v78
    v_exp_f32 v79, v79
    v_exp_f32 v80, v80
    v_exp_f32 v81, v81
    v_exp_f32 v82, v82
    v_exp_f32 v83, v83
    v_exp_f32 v84, v84
    v_exp_f32 v85, v85
    v_exp_f32 v86, v86
    v_exp_f32 v87, v87
    v_exp_f32 v88, v88
    v_exp_f32 v89, v89
    v_exp_f32 v90, v90
    v_exp_f32 v91, v91
    v_exp_f32 v92, v92
    v_exp_f32 v93, v93
    v_exp_f32 v94, v94
    v_exp_f32 v95, v95
    v_exp_f32 v96, v96
    v_exp_f32 v97, v97
    v_exp_f32 v98, v98
    v_exp_f32 v99, v99
    v_exp_f32 v100, v100
    v_exp_f32 v101, v101
    v_exp_f32 v102, v102
    v_exp_f32 v103, v103
    v_add_f32 v72, 1.0, v72
    v_add_f32 v73, 1.0, v73
    v_add_f32 v74, 1.0, v74
    v_add_f32 v75, 1.0, v75
    v_add_f32 v76, 1.0, v76
    v_add_f32 v77, 1.0, v77
    v_add_f32 v78, 1.0, v78
    v_add_f32 v79, 1.0, v79
    v_add_f32 v80, 1.0, v80
    v_add_f32 v81, 1.0, v81
    v_add_f32 v82, 1.0, v82
    v_add_f32 v83, 1.0, v83
    v_add_f32 v84, 1.0, v84
    v_add_f32 v85, 1.0, v85
    v_add_f32 v86, 1.0, v86
    v_add_f32 v87, 1.0, v87
    v_add_f32 v88, 1.0, v88
    v_add_f32 v89, 1.0, v89
    v_add_f32 v90, 1.0, v90
    v_add_f32 v91, 1.0, v91
    v_add_f32 v92, 1.0, v92
    v_add_f32 v93, 1.0, v93
    v_add_f32 v94, 1.0, v94
    v_add_f32 v95, 1.0, v95
    v_add_f32 v96, 1.0, v96
    v_add_f32 v97, 1.0, v97
    v_add_f32 v98, 1.0, v98
    v_add_f32 v99, 1.0, v99
    v_add_f32 v100, 1.0, v100
    v_add_f32 v101, 1.0, v101
    v_add_f32 v102, 1.0, v102
    v_add_f32 v103, 1.0, v103
    v_rcp_f32 v72, v72
    v_rcp_f32 v73, v73
    v_rcp_f32 v74, v74
    v_rcp_f32 v75, v75
    v_rcp_f32 v76, v76
    v_rcp_f32 v77, v77
    v_rcp_f32 v78, v78
    v_rcp_f32 v79, v79
    v_rcp_f32 v80, v80
    v_rcp_f32 v81, v81
    v_rcp_f32 v82, v82
    v_rcp_f32 v83, v83
    v_rcp_f32 v84, v84
    v_rcp_f32 v85, v85
    v_rcp_f32 v86, v86
    v_rcp_f32 v87, v87
    v_rcp_f32 v88, v88
    v_rcp_f32 v89, v89
    v_rcp_f32 v90, v90
    v_rcp_f32 v91, v91
    v_rcp_f32 v92, v92
    v_rcp_f32 v93, v93
    v_rcp_f32 v94, v94
    v_rcp_f32 v95, v95
    v_rcp_f32 v96, v96
    v_rcp_f32 v97, v97
    v_rcp_f32 v98, v98
    v_rcp_f32 v99, v99
    v_rcp_f32 v100, v100
    v_rcp_f32 v101, v101
    v_rcp_f32 v102, v102
    v_rcp_f32 v103, v103
    v_pk_mul_f32 v[208:209], v[208:209], v[72:73]
    v_pk_mul_f32 v[210:211], v[210:211], v[74:75]
    v_pk_mul_f32 v[212:213], v[212:213], v[76:77]
    v_pk_mul_f32 v[214:215], v[214:215], v[78:79]
    v_pk_mul_f32 v[216:217], v[216:217], v[80:81]
    v_pk_mul_f32 v[218:219], v[218:219], v[82:83]
    v_pk_mul_f32 v[220:221], v[220:221], v[84:85]
    v_pk_mul_f32 v[222:223], v[222:223], v[86:87]
    v_pk_mul_f32 v[224:225], v[224:225], v[88:89]
    v_pk_mul_f32 v[226:227], v[226:227], v[90:91]
    v_pk_mul_f32 v[228:229], v[228:229], v[92:93]
    v_pk_mul_f32 v[230:231], v[230:231], v[94:95]
    v_pk_mul_f32 v[232:233], v[232:233], v[96:97]
    v_pk_mul_f32 v[234:235], v[234:235], v[98:99]
    v_pk_mul_f32 v[236:237], v[236:237], v[100:101]
    v_pk_mul_f32 v[238:239], v[238:239], v[102:103]
    s_barrier
    ds_read_b64_tr_b16 v[40:41], v250 offset:0
    ds_read_b64_tr_b16 v[42:43], v250 offset:2048
    ds_read_b64_tr_b16 v[44:45], v251 offset:0
    ds_read_b64_tr_b16 v[46:47], v251 offset:2048
    ds_read_b64_tr_b16 v[48:49], v252 offset:0
    ds_read_b64_tr_b16 v[50:51], v252 offset:2048
    ds_read_b64_tr_b16 v[52:53], v253 offset:0
    ds_read_b64_tr_b16 v[54:55], v253 offset:2048
    s_lshl_b32 s3, s30, 1
    s_lshr_b32 s65, s38, 1
    s_add_u32 s3, s3, s65
    s_lshl_b32 s3, s3, 7
    s_add_u32 s3, s3, 196608
    v_and_b32 v6, 31, v1
    v_lshlrev_b32 v6, 2, v6
    buffer_load_dword v7, v6, s[12:15], s3 offen sc1
    s_waitcnt vmcnt(0)
L_op:
    v_xor_b32 v7, s32, v7
    v_cmp_ne_u32 vcc, 0, v7
    s_nop 0
    s_cmp_eq_u64 vcc, 0
    s_cbranch_scc1 L_opok
    s_add_u32 s70, s70, 1
    s_cmp_ge_u32 s70, 200000
    s_cbranch_scc1 L_opok
    s_sleep 4
    buffer_load_dword v7, v6, s[12:15], s3 offen sc1
    s_waitcnt vmcnt(0)
    s_branch L_op
L_opok:
    buffer_load_dwordx4 v[72:75], v5, s[12:15], s72 offen offset:0
    buffer_load_dwordx4 v[76:79], v4, s[12:15], s72 offen offset:0
    buffer_load_dwordx4 v[80:83], v5, s[12:15], s72 offen offset:1024
    buffer_load_dwordx4 v[84:87], v4, s[12:15], s72 offen offset:1024
    buffer_load_dwordx4 v[88:91], v5, s[12:15], s72 offen offset:2048
    buffer_load_dwordx4 v[92:95], v4, s[12:15], s72 offen offset:2048
    buffer_load_dwordx4 v[96:99], v5, s[12:15], s72 offen offset:3072
    buffer_load_dwordx4 v[100:103], v4, s[12:15], s72 offen offset:3072
    s_add_u32 s72, s72, 4096
    buffer_load_dwordx4 v[104:107], v5, s[12:15], s72 offen offset:0
    buffer_load_dwordx4 v[108:111], v4, s[12:15], s72 offen offset:0
    buffer_load_dwordx4 v[112:115], v5, s[12:15], s72 offen offset:1024
    buffer_load_dwordx4 v[116:119], v4, s[12:15], s72 offen offset:1024
    buffer_load_dwordx4 v[120:123], v5, s[12:15], s72 offen offset:2048
    buffer_load_dwordx4 v[124:127], v4, s[12:15], s72 offen offset:2048
    buffer_load_dwordx4 v[128:131], v5, s[12:15], s72 offen offset:3072
    buffer_load_dwordx4 v[132:135], v4, s[12:15], s72 offen offset:3072
    s_add_u32 s72, s72, 4096
    buffer_load_dwordx4 v[136:139], v5, s[12:15], s72 offen offset:0
    buffer_load_dwordx4 v[140:143], v4, s[12:15], s72 offen offset:0
    buffer_load_dwordx4 v[144:147], v5, s[12:15], s72 offen offset:1024
    buffer_load_dwordx4 v[148:151], v4, s[12:15], s72 offen offset:1024
    buffer_load_dwordx4 v[152:155], v5, s[12:15], s72 offen offset:2048
    buffer_load_dwordx4 v[156:159], v4, s[12:15], s72 offen offset:2048
    buffer_load_dwordx4 v[160:163], v5, s[12:15], s72 offen offset:3072
    buffer_load_dwordx4 v[164:167], v4, s[12:15], s72 offen offset:3072
    s_add_u32 s72, s72, 4096
    s_waitcnt vmcnt(22)
    s_waitcnt lgkmcnt(0)
    v_mfma_f32_16x16x32_bf16 v[8:11], v[40:43], v[72:75], 0
    ds_read_b64_tr_b16 v[56:57], v250 offset:4096
    v_mfma_f32_16x16x32_bf16 v[12:15], v[44:47], v[72:75], 0
    ds_read_b64_tr_b16 v[58:59], v250 offset:6144
    v_mfma_f32_16x16x32_bf16 v[16:19], v[48:51], v[72:75], 0
    ds_read_b64_tr_b16 v[60:61], v251 offset:4096
    v_mfma_f32_16x16x32_bf16 v[20:23], v[52:55], v[72:75], 0
    ds_read_b64_tr_b16 v[62:63], v251 offset:6144
    v_mfma_f32_16x16x32_bf16 v[24:27], v[40:43], v[76:79], 0
    ds_read_b64_tr_b16 v[64:65], v252 offset:4096
    v_mfma_f32_16x16x32_bf16 v[28:31], v[44:47], v[76:79], 0
    ds_read_b64_tr_b16 v[66:67], v252 offset:6144
    v_mfma_f32_16x16x32_bf16 v[32:35], v[48:51], v[76:79], 0
    ds_read_b64_tr_b16 v[68:69], v253 offset:4096
    v_mfma_f32_16x16x32_bf16 v[36:39], v[52:55], v[76:79], 0
    ds_read_b64_tr_b16 v[70:71], v253 offset:6144
    buffer_load_dwordx4 v[72:75], v5, s[12:15], s72 offen offset:0
    buffer_load_dwordx4 v[76:79], v4, s[12:15], s72 offen offset:0
    s_waitcnt vmcnt(22)
    s_waitcnt lgkmcnt(0)
    v_mfma_f32_16x16x32_bf16 v[8:11], v[56:59], v[80:83], v[8:11]
    ds_read_b64_tr_b16 v[40:41], v250 offset:8192
    v_mfma_f32_16x16x32_bf16 v[12:15], v[60:63], v[80:83], v[12:15]
    ds_read_b64_tr_b16 v[42:43], v250 offset:10240
    v_mfma_f32_16x16x32_bf16 v[16:19], v[64:67], v[80:83], v[16:19]
    ds_read_b64_tr_b16 v[44:45], v251 offset:8192
    v_mfma_f32_16x16x32_bf16 v[20:23], v[68:71], v[80:83], v[20:23]
    ds_read_b64_tr_b16 v[46:47], v251 offset:10240
    v_mfma_f32_16x16x32_bf16 v[24:27], v[56:59], v[84:87], v[24:27]
    ds_read_b64_tr_b16 v[48:49], v252 offset:8192
    v_mfma_f32_16x16x32_bf16 v[28:31], v[60:63], v[84:87], v[28:31]
    ds_read_b64_tr_b16 v[50:51], v252 offset:10240
    v_mfma_f32_16x16x32_bf16 v[32:35], v[64:67], v[84:87], v[32:35]
    ds_read_b64_tr_b16 v[52:53], v253 offset:8192
    v_mfma_f32_16x16x32_bf16 v[36:39], v[68:71], v[84:87], v[36:39]
    ds_read_b64_tr_b16 v[54:55], v253 offset:10240
    buffer_load_dwordx4 v[80:83], v5, s[12:15], s72 offen offset:1024
    buffer_load_dwordx4 v[84:87], v4, s[12:15], s72 offen offset:1024
    s_waitcnt vmcnt(22)
    s_waitcnt lgkmcnt(0)
    v_mfma_f32_16x16x32_bf16 v[8:11], v[40:43], v[88:91], v[8:11]
    ds_read_b64_tr_b16 v[56:57], v250 offset:12288
    v_mfma_f32_16x16x32_bf16 v[12:15], v[44:47], v[88:91], v[12:15]
    ds_read_b64_tr_b16 v[58:59], v250 offset:14336
    v_mfma_f32_16x16x32_bf16 v[16:19], v[48:51], v[88:91], v[16:19]
    ds_read_b64_tr_b16 v[60:61], v251 offset:12288
    v_mfma_f32_16x16x32_bf16 v[20:23], v[52:55], v[88:91], v[20:23]
    ds_read_b64_tr_b16 v[62:63], v251 offset:14336
    v_mfma_f32_16x16x32_bf16 v[24:27], v[40:43], v[92:95], v[24:27]
    ds_read_b64_tr_b16 v[64:65], v252 offset:12288
    v_mfma_f32_16x16x32_bf16 v[28:31], v[44:47], v[92:95], v[28:31]
    ds_read_b64_tr_b16 v[66:67], v252 offset:14336
    v_mfma_f32_16x16x32_bf16 v[32:35], v[48:51], v[92:95], v[32:35]
    ds_read_b64_tr_b16 v[68:69], v253 offset:12288
    v_mfma_f32_16x16x32_bf16 v[36:39], v[52:55], v[92:95], v[36:39]
    ds_read_b64_tr_b16 v[70:71], v253 offset:14336
    buffer_load_dwordx4 v[88:91], v5, s[12:15], s72 offen offset:2048
    buffer_load_dwordx4 v[92:95], v4, s[12:15], s72 offen offset:2048
    s_waitcnt vmcnt(22)
    s_waitcnt lgkmcnt(0)
    v_mfma_f32_16x16x32_bf16 v[8:11], v[56:59], v[96:99], v[8:11]
    ds_read_b64_tr_b16 v[40:41], v250 offset:16384
    v_mfma_f32_16x16x32_bf16 v[12:15], v[60:63], v[96:99], v[12:15]
    ds_read_b64_tr_b16 v[42:43], v250 offset:18432
    v_mfma_f32_16x16x32_bf16 v[16:19], v[64:67], v[96:99], v[16:19]
    ds_read_b64_tr_b16 v[44:45], v251 offset:16384
    v_mfma_f32_16x16x32_bf16 v[20:23], v[68:71], v[96:99], v[20:23]
    ds_read_b64_tr_b16 v[46:47], v251 offset:18432
    v_mfma_f32_16x16x32_bf16 v[24:27], v[56:59], v[100:103], v[24:27]
    ds_read_b64_tr_b16 v[48:49], v252 offset:16384
    v_mfma_f32_16x16x32_bf16 v[28:31], v[60:63], v[100:103], v[28:31]
    ds_read_b64_tr_b16 v[50:51], v252 offset:18432
    v_mfma_f32_16x16x32_bf16 v[32:35], v[64:67], v[100:103], v[32:35]
    ds_read_b64_tr_b16 v[52:53], v253 offset:16384
    v_mfma_f32_16x16x32_bf16 v[36:39], v[68:71], v[100:103], v[36:39]
    ds_read_b64_tr_b16 v[54:55], v253 offset:18432
    buffer_load_dwordx4 v[96:99], v5, s[12:15], s72 offen offset:3072
    buffer_load_dwordx4 v[100:103], v4, s[12:15], s72 offen offset:3072
    s_add_u32 s72, s72, 4096
    s_waitcnt vmcnt(22)
    s_waitcnt lgkmcnt(0)
    v_mfma_f32_16x16x32_bf16 v[8:11], v[40:43], v[104:107], v[8:11]
    ds_read_b64_tr_b16 v[56:57], v250 offset:20480
    v_mfma_f32_16x16x32_bf16 v[12:15], v[44:47], v[104:107], v[12:15]
    ds_read_b64_tr_b16 v[58:59], v250 offset:22528
    v_mfma_f32_16x16x32_bf16 v[16:19], v[48:51], v[104:107], v[16:19]
    ds_read_b64_tr_b16 v[60:61], v251 offset:20480
    v_mfma_f32_16x16x32_bf16 v[20:23], v[52:55], v[104:107], v[20:23]
    ds_read_b64_tr_b16 v[62:63], v251 offset:22528
    v_mfma_f32_16x16x32_bf16 v[24:27], v[40:43], v[108:111], v[24:27]
    ds_read_b64_tr_b16 v[64:65], v252 offset:20480
    v_mfma_f32_16x16x32_bf16 v[28:31], v[44:47], v[108:111], v[28:31]
    ds_read_b64_tr_b16 v[66:67], v252 offset:22528
    v_mfma_f32_16x16x32_bf16 v[32:35], v[48:51], v[108:111], v[32:35]
    ds_read_b64_tr_b16 v[68:69], v253 offset:20480
    v_mfma_f32_16x16x32_bf16 v[36:39], v[52:55], v[108:111], v[36:39]
    ds_read_b64_tr_b16 v[70:71], v253 offset:22528
    buffer_load_dwordx4 v[104:107], v5, s[12:15], s72 offen offset:0
    buffer_load_dwordx4 v[108:111], v4, s[12:15], s72 offen offset:0
    s_waitcnt vmcnt(22)
    s_waitcnt lgkmcnt(0)
    v_mfma_f32_16x16x32_bf16 v[8:11], v[56:59], v[112:115], v[8:11]
    ds_read_b64_tr_b16 v[40:41], v250 offset:24576
    v_mfma_f32_16x16x32_bf16 v[12:15], v[60:63], v[112:115], v[12:15]
    ds_read_b64_tr_b16 v[42:43], v250 offset:26624
    v_mfma_f32_16x16x32_bf16 v[16:19], v[64:67], v[112:115], v[16:19]
    ds_read_b64_tr_b16 v[44:45], v251 offset:24576
    v_mfma_f32_16x16x32_bf16 v[20:23], v[68:71], v[112:115], v[20:23]
    ds_read_b64_tr_b16 v[46:47], v251 offset:26624
    v_mfma_f32_16x16x32_bf16 v[24:27], v[56:59], v[116:119], v[24:27]
    ds_read_b64_tr_b16 v[48:49], v252 offset:24576
    v_mfma_f32_16x16x32_bf16 v[28:31], v[60:63], v[116:119], v[28:31]
    ds_read_b64_tr_b16 v[50:51], v252 offset:26624
    v_mfma_f32_16x16x32_bf16 v[32:35], v[64:67], v[116:119], v[32:35]
    ds_read_b64_tr_b16 v[52:53], v253 offset:24576
    v_mfma_f32_16x16x32_bf16 v[36:39], v[68:71], v[116:119], v[36:39]
    ds_read_b64_tr_b16 v[54:55], v253 offset:26624
    buffer_load_dwordx4 v[112:115], v5, s[12:15], s72 offen offset:1024
    buffer_load_dwordx4 v[116:119], v4, s[12:15], s72 offen offset:1024
    s_waitcnt vmcnt(22)
    s_waitcnt lgkmcnt(0)
    v_mfma_f32_16x16x32_bf16 v[8:11], v[40:43], v[120:123], v[8:11]
    ds_read_b64_tr_b16 v[56:57], v250 offset:28672
    v_mfma_f32_16x16x32_bf16 v[12:15], v[44:47], v[120:123], v[12:15]
    ds_read_b64_tr_b16 v[58:59], v250 offset:30720
    v_mfma_f32_16x16x32_bf16 v[16:19], v[48:51], v[120:123], v[16:19]
    ds_read_b64_tr_b16 v[60:61], v251 offset:28672
    v_mfma_f32_16x16x32_bf16 v[20:23], v[52:55], v[120:123], v[20:23]
    ds_read_b64_tr_b16 v[62:63], v251 offset:30720
    v_mfma_f32_16x16x32_bf16 v[24:27], v[40:43], v[124:127], v[24:27]
    ds_read_b64_tr_b16 v[64:65], v252 offset:28672
    v_mfma_f32_16x16x32_bf16 v[28:31], v[44:47], v[124:127], v[28:31]
    ds_read_b64_tr_b16 v[66:67], v252 offset:30720
    v_mfma_f32_16x16x32_bf16 v[32:35], v[48:51], v[124:127], v[32:35]
    ds_read_b64_tr_b16 v[68:69], v253 offset:28672
    v_mfma_f32_16x16x32_bf16 v[36:39], v[52:55], v[124:127], v[36:39]
    ds_read_b64_tr_b16 v[70:71], v253 offset:30720
    buffer_load_dwordx4 v[120:123], v5, s[12:15], s72 offen offset:2048
    buffer_load_dwordx4 v[124:127], v4, s[12:15], s72 offen offset:2048
    s_waitcnt vmcnt(22)
    s_waitcnt lgkmcnt(0)
    v_mfma_f32_16x16x32_bf16 v[8:11], v[56:59], v[128:131], v[8:11]
    ds_read_b64_tr_b16 v[40:41], v250 offset:32768
    v_mfma_f32_16x16x32_bf16 v[12:15], v[60:63], v[128:131], v[12:15]
    ds_read_b64_tr_b16 v[42:43], v250 offset:34816
    v_mfma_f32_16x16x32_bf16 v[16:19], v[64:67], v[128:131], v[16:19]
    ds_read_b64_tr_b16 v[44:45], v251 offset:32768
    v_mfma_f32_16x16x32_bf16 v[20:23], v[68:71], v[128:131], v[20:23]
    ds_read_b64_tr_b16 v[46:47], v251 offset:34816
    v_mfma_f32_16x16x32_bf16 v[24:27], v[56:59], v[132:135], v[24:27]
    ds_read_b64_tr_b16 v[48:49], v252 offset:32768
    v_mfma_f32_16x16x32_bf16 v[28:31], v[60:63], v[132:135], v[28:31]
    ds_read_b64_tr_b16 v[50:51], v252 offset:34816
    v_mfma_f32_16x16x32_bf16 v[32:35], v[64:67], v[132:135], v[32:35]
    ds_read_b64_tr_b16 v[52:53], v253 offset:32768
    v_mfma_f32_16x16x32_bf16 v[36:39], v[68:71], v[132:135], v[36:39]
    ds_read_b64_tr_b16 v[54:55], v253 offset:34816
    buffer_load_dwordx4 v[128:131], v5, s[12:15], s72 offen offset:3072
    buffer_load_dwordx4 v[132:135], v4, s[12:15], s72 offen offset:3072
    s_add_u32 s72, s72, 4096
    s_waitcnt vmcnt(22)
    s_waitcnt lgkmcnt(0)
    v_mfma_f32_16x16x32_bf16 v[8:11], v[40:43], v[136:139], v[8:11]
    ds_read_b64_tr_b16 v[56:57], v250 offset:36864
    v_mfma_f32_16x16x32_bf16 v[12:15], v[44:47], v[136:139], v[12:15]
    ds_read_b64_tr_b16 v[58:59], v250 offset:38912
    v_mfma_f32_16x16x32_bf16 v[16:19], v[48:51], v[136:139], v[16:19]
    ds_read_b64_tr_b16 v[60:61], v251 offset:36864
    v_mfma_f32_16x16x32_bf16 v[20:23], v[52:55], v[136:139], v[20:23]
    ds_read_b64_tr_b16 v[62:63], v251 offset:38912
    v_mfma_f32_16x16x32_bf16 v[24:27], v[40:43], v[140:143], v[24:27]
    ds_read_b64_tr_b16 v[64:65], v252 offset:36864
    v_mfma_f32_16x16x32_bf16 v[28:31], v[44:47], v[140:143], v[28:31]
    ds_read_b64_tr_b16 v[66:67], v252 offset:38912
    v_mfma_f32_16x16x32_bf16 v[32:35], v[48:51], v[140:143], v[32:35]
    ds_read_b64_tr_b16 v[68:69], v253 offset:36864
    v_mfma_f32_16x16x32_bf16 v[36:39], v[52:55], v[140:143], v[36:39]
    ds_read_b64_tr_b16 v[70:71], v253 offset:38912
    buffer_load_dwordx4 v[136:139], v5, s[12:15], s72 offen offset:0
    buffer_load_dwordx4 v[140:143], v4, s[12:15], s72 offen offset:0
    s_waitcnt vmcnt(22)
    s_waitcnt lgkmcnt(0)
    v_mfma_f32_16x16x32_bf16 v[8:11], v[56:59], v[144:147], v[8:11]
    ds_read_b64_tr_b16 v[40:41], v250 offset:40960
    v_mfma_f32_16x16x32_bf16 v[12:15], v[60:63], v[144:147], v[12:15]
    ds_read_b64_tr_b16 v[42:43], v250 offset:43008
    v_mfma_f32_16x16x32_bf16 v[16:19], v[64:67], v[144:147], v[16:19]
    ds_read_b64_tr_b16 v[44:45], v251 offset:40960
    v_mfma_f32_16x16x32_bf16 v[20:23], v[68:71], v[144:147], v[20:23]
    ds_read_b64_tr_b16 v[46:47], v251 offset:43008
    v_mfma_f32_16x16x32_bf16 v[24:27], v[56:59], v[148:151], v[24:27]
    ds_read_b64_tr_b16 v[48:49], v252 offset:40960
    v_mfma_f32_16x16x32_bf16 v[28:31], v[60:63], v[148:151], v[28:31]
    ds_read_b64_tr_b16 v[50:51], v252 offset:43008
    v_mfma_f32_16x16x32_bf16 v[32:35], v[64:67], v[148:151], v[32:35]
    ds_read_b64_tr_b16 v[52:53], v253 offset:40960
    v_mfma_f32_16x16x32_bf16 v[36:39], v[68:71], v[148:151], v[36:39]
    ds_read_b64_tr_b16 v[54:55], v253 offset:43008
    buffer_load_dwordx4 v[144:147], v5, s[12:15], s72 offen offset:1024
    buffer_load_dwordx4 v[148:151], v4, s[12:15], s72 offen offset:1024
    s_waitcnt vmcnt(22)
    s_waitcnt lgkmcnt(0)
    v_mfma_f32_16x16x32_bf16 v[8:11], v[40:43], v[152:155], v[8:11]
    ds_read_b64_tr_b16 v[56:57], v250 offset:45056
    v_mfma_f32_16x16x32_bf16 v[12:15], v[44:47], v[152:155], v[12:15]
    ds_read_b64_tr_b16 v[58:59], v250 offset:47104
    v_mfma_f32_16x16x32_bf16 v[16:19], v[48:51], v[152:155], v[16:19]
    ds_read_b64_tr_b16 v[60:61], v251 offset:45056
    v_mfma_f32_16x16x32_bf16 v[20:23], v[52:55], v[152:155], v[20:23]
    ds_read_b64_tr_b16 v[62:63], v251 offset:47104
    v_mfma_f32_16x16x32_bf16 v[24:27], v[40:43], v[156:159], v[24:27]
    ds_read_b64_tr_b16 v[64:65], v252 offset:45056
    v_mfma_f32_16x16x32_bf16 v[28:31], v[44:47], v[156:159], v[28:31]
    ds_read_b64_tr_b16 v[66:67], v252 offset:47104
    v_mfma_f32_16x16x32_bf16 v[32:35], v[48:51], v[156:159], v[32:35]
    ds_read_b64_tr_b16 v[68:69], v253 offset:45056
    v_mfma_f32_16x16x32_bf16 v[36:39], v[52:55], v[156:159], v[36:39]
    ds_read_b64_tr_b16 v[70:71], v253 offset:47104
    buffer_load_dwordx4 v[152:155], v5, s[12:15], s72 offen offset:2048
    buffer_load_dwordx4 v[156:159], v4, s[12:15], s72 offen offset:2048
    s_waitcnt vmcnt(22)
    s_waitcnt lgkmcnt(0)
    v_mfma_f32_16x16x32_bf16 v[8:11], v[56:59], v[160:163], v[8:11]
    ds_read_b64_tr_b16 v[40:41], v250 offset:49152
    v_mfma_f32_16x16x32_bf16 v[12:15], v[60:63], v[160:163], v[12:15]
    ds_read_b64_tr_b16 v[42:43], v250 offset:51200
    v_mfma_f32_16x16x32_bf16 v[16:19], v[64:67], v[160:163], v[16:19]
    ds_read_b64_tr_b16 v[44:45], v251 offset:49152
    v_mfma_f32_16x16x32_bf16 v[20:23], v[68:71], v[160:163], v[20:23]
    ds_read_b64_tr_b16 v[46:47], v251 offset:51200
    v_mfma_f32_16x16x32_bf16 v[24:27], v[56:59], v[164:167], v[24:27]
    ds_read_b64_tr_b16 v[48:49], v252 offset:49152
    v_mfma_f32_16x16x32_bf16 v[28:31], v[60:63], v[164:167], v[28:31]
    ds_read_b64_tr_b16 v[50:51], v252 offset:51200
    v_mfma_f32_16x16x32_bf16 v[32:35], v[64:67], v[164:167], v[32:35]
    ds_read_b64_tr_b16 v[52:53], v253 offset:49152
    v_mfma_f32_16x16x32_bf16 v[36:39], v[68:71], v[164:167], v[36:39]
    ds_read_b64_tr_b16 v[54:55], v253 offset:51200
    buffer_load_dwordx4 v[160:163], v5, s[12:15], s72 offen offset:3072
    buffer_load_dwordx4 v[164:167], v4, s[12:15], s72 offen offset:3072
    s_add_u32 s72, s72, 4096
    s_waitcnt vmcnt(22)
    s_waitcnt lgkmcnt(0)
    v_mfma_f32_16x16x32_bf16 v[8:11], v[40:43], v[72:75], v[8:11]
    ds_read_b64_tr_b16 v[56:57], v250 offset:53248
    v_mfma_f32_16x16x32_bf16 v[12:15], v[44:47], v[72:75], v[12:15]
    ds_read_b64_tr_b16 v[58:59], v250 offset:55296
    v_mfma_f32_16x16x32_bf16 v[16:19], v[48:51], v[72:75], v[16:19]
    ds_read_b64_tr_b16 v[60:61], v251 offset:53248
    v_mfma_f32_16x16x32_bf16 v[20:23], v[52:55], v[72:75], v[20:23]
    ds_read_b64_tr_b16 v[62:63], v251 offset:55296
    v_mfma_f32_16x16x32_bf16 v[24:27], v[40:43], v[76:79], v[24:27]
    ds_read_b64_tr_b16 v[64:65], v252 offset:53248
    v_mfma_f32_16x16x32_bf16 v[28:31], v[44:47], v[76:79], v[28:31]
    ds_read_b64_tr_b16 v[66:67], v252 offset:55296
    v_mfma_f32_16x16x32_bf16 v[32:35], v[48:51], v[76:79], v[32:35]
    ds_read_b64_tr_b16 v[68:69], v253 offset:53248
    v_mfma_f32_16x16x32_bf16 v[36:39], v[52:55], v[76:79], v[36:39]
    ds_read_b64_tr_b16 v[70:71], v253 offset:55296
    buffer_load_dwordx4 v[72:75], v5, s[12:15], s72 offen offset:0
    buffer_load_dwordx4 v[76:79], v4, s[12:15], s72 offen offset:0
    s_waitcnt vmcnt(22)
    s_waitcnt lgkmcnt(0)
    v_mfma_f32_16x16x32_bf16 v[8:11], v[56:59], v[80:83], v[8:11]
    ds_read_b64_tr_b16 v[40:41], v250 offset:57344
    v_mfma_f32_16x16x32_bf16 v[12:15], v[60:63], v[80:83], v[12:15]
    ds_read_b64_tr_b16 v[42:43], v250 offset:59392
    v_mfma_f32_16x16x32_bf16 v[16:19], v[64:67], v[80:83], v[16:19]
    ds_read_b64_tr_b16 v[44:45], v251 offset:57344
    v_mfma_f32_16x16x32_bf16 v[20:23], v[68:71], v[80:83], v[20:23]
    ds_read_b64_tr_b16 v[46:47], v251 offset:59392
    v_mfma_f32_16x16x32_bf16 v[24:27], v[56:59], v[84:87], v[24:27]
    ds_read_b64_tr_b16 v[48:49], v252 offset:57344
    v_mfma_f32_16x16x32_bf16 v[28:31], v[60:63], v[84:87], v[28:31]
    ds_read_b64_tr_b16 v[50:51], v252 offset:59392
    v_mfma_f32_16x16x32_bf16 v[32:35], v[64:67], v[84:87], v[32:35]
    ds_read_b64_tr_b16 v[52:53], v253 offset:57344
    v_mfma_f32_16x16x32_bf16 v[36:39], v[68:71], v[84:87], v[36:39]
    ds_read_b64_tr_b16 v[54:55], v253 offset:59392
    buffer_load_dwordx4 v[80:83], v5, s[12:15], s72 offen offset:1024
    buffer_load_dwordx4 v[84:87], v4, s[12:15], s72 offen offset:1024
    s_waitcnt vmcnt(22)
    s_waitcnt lgkmcnt(0)
    v_mfma_f32_16x16x32_bf16 v[8:11], v[40:43], v[88:91], v[8:11]
    ds_read_b64_tr_b16 v[56:57], v250 offset:61440
    v_mfma_f32_16x16x32_bf16 v[12:15], v[44:47], v[88:91], v[12:15]
    ds_read_b64_tr_b16 v[58:59], v250 offset:63488
    v_mfma_f32_16x16x32_bf16 v[16:19], v[48:51], v[88:91], v[16:19]
    ds_read_b64_tr_b16 v[60:61], v251 offset:61440
    v_mfma_f32_16x16x32_bf16 v[20:23], v[52:55], v[88:91], v[20:23]
    ds_read_b64_tr_b16 v[62:63], v251 offset:63488
    v_mfma_f32_16x16x32_bf16 v[24:27], v[40:43], v[92:95], v[24:27]
    ds_read_b64_tr_b16 v[64:65], v252 offset:61440
    v_mfma_f32_16x16x32_bf16 v[28:31], v[44:47], v[92:95], v[28:31]
    ds_read_b64_tr_b16 v[66:67], v252 offset:63488
    v_mfma_f32_16x16x32_bf16 v[32:35], v[48:51], v[92:95], v[32:35]
    ds_read_b64_tr_b16 v[68:69], v253 offset:61440
    v_mfma_f32_16x16x32_bf16 v[36:39], v[52:55], v[92:95], v[36:39]
    ds_read_b64_tr_b16 v[70:71], v253 offset:63488
    buffer_load_dwordx4 v[88:91], v5, s[12:15], s72 offen offset:2048
    buffer_load_dwordx4 v[92:95], v4, s[12:15], s72 offen offset:2048
    s_waitcnt vmcnt(22)
    s_waitcnt lgkmcnt(0)
    v_add_u32 v250, 0x10000, v250
    v_add_u32 v251, 0x10000, v251
    v_add_u32 v252, 0x10000, v252
    v_add_u32 v253, 0x10000, v253
    v_mfma_f32_16x16x32_bf16 v[8:11], v[56:59], v[96:99], v[8:11]
    ds_read_b64_tr_b16 v[40:41], v250 offset:0
    v_mfma_f32_16x16x32_bf16 v[12:15], v[60:63], v[96:99], v[12:15]
    ds_read_b64_tr_b16 v[42:43], v250 offset:2048
    v_mfma_f32_16x16x32_bf16 v[16:19], v[64:67], v[96:99], v[16:19]
    ds_read_b64_tr_b16 v[44:45], v251 offset:0
    v_mfma_f32_16x16x32_bf16 v[20:23], v[68:71], v[96:99], v[20:23]
    ds_read_b64_tr_b16 v[46:47], v251 offset:2048
    v_mfma_f32_16x16x32_bf16 v[24:27], v[56:59], v[100:103], v[24:27]
    ds_read_b64_tr_b16 v[48:49], v252 offset:0
    v_mfma_f32_16x16x32_bf16 v[28:31], v[60:63], v[100:103], v[28:31]
    ds_read_b64_tr_b16 v[50:51], v252 offset:2048
    v_mfma_f32_16x16x32_bf16 v[32:35], v[64:67], v[100:103], v[32:35]
    ds_read_b64_tr_b16 v[52:53], v253 offset:0
    v_mfma_f32_16x16x32_bf16 v[36:39], v[68:71], v[100:103], v[36:39]
    ds_read_b64_tr_b16 v[54:55], v253 offset:2048
    buffer_load_dwordx4 v[96:99], v5, s[12:15], s72 offen offset:3072
    buffer_load_dwordx4 v[100:103], v4, s[12:15], s72 offen offset:3072
    s_add_u32 s72, s72, 4096
    s_waitcnt vmcnt(22)
    s_waitcnt lgkmcnt(0)
    v_mfma_f32_16x16x32_bf16 v[8:11], v[40:43], v[104:107], v[8:11]
    ds_read_b64_tr_b16 v[56:57], v250 offset:4096
    v_mfma_f32_16x16x32_bf16 v[12:15], v[44:47], v[104:107], v[12:15]
    ds_read_b64_tr_b16 v[58:59], v250 offset:6144
    v_mfma_f32_16x16x32_bf16 v[16:19], v[48:51], v[104:107], v[16:19]
    ds_read_b64_tr_b16 v[60:61], v251 offset:4096
    v_mfma_f32_16x16x32_bf16 v[20:23], v[52:55], v[104:107], v[20:23]
    ds_read_b64_tr_b16 v[62:63], v251 offset:6144
    v_mfma_f32_16x16x32_bf16 v[24:27], v[40:43], v[108:111], v[24:27]
    ds_read_b64_tr_b16 v[64:65], v252 offset:4096
    v_mfma_f32_16x16x32_bf16 v[28:31], v[44:47], v[108:111], v[28:31]
    ds_read_b64_tr_b16 v[66:67], v252 offset:6144
    v_mfma_f32_16x16x32_bf16 v[32:35], v[48:51], v[108:111], v[32:35]
    ds_read_b64_tr_b16 v[68:69], v253 offset:4096
    v_mfma_f32_16x16x32_bf16 v[36:39], v[52:55], v[108:111], v[36:39]
    ds_read_b64_tr_b16 v[70:71], v253 offset:6144
    buffer_load_dwordx4 v[104:107], v5, s[12:15], s72 offen offset:0
    buffer_load_dwordx4 v[108:111], v4, s[12:15], s72 offen offset:0
    s_waitcnt vmcnt(22)
    s_waitcnt lgkmcnt(0)
    v_mfma_f32_16x16x32_bf16 v[8:11], v[56:59], v[112:115], v[8:11]
    ds_read_b64_tr_b16 v[40:41], v250 offset:8192
    v_mfma_f32_16x16x32_bf16 v[12:15], v[60:63], v[112:115], v[12:15]
    ds_read_b64_tr_b16 v[42:43], v250 offset:10240
    v_mfma_f32_16x16x32_bf16 v[16:19], v[64:67], v[112:115], v[16:19]
    ds_read_b64_tr_b16 v[44:45], v251 offset:8192
    v_mfma_f32_16x16x32_bf16 v[20:23], v[68:71], v[112:115], v[20:23]
    ds_read_b64_tr_b16 v[46:47], v251 offset:10240
    v_mfma_f32_16x16x32_bf16 v[24:27], v[56:59], v[116:119], v[24:27]
    ds_read_b64_tr_b16 v[48:49], v252 offset:8192
    v_mfma_f32_16x16x32_bf16 v[28:31], v[60:63], v[116:119], v[28:31]
    ds_read_b64_tr_b16 v[50:51], v252 offset:10240
    v_mfma_f32_16x16x32_bf16 v[32:35], v[64:67], v[116:119], v[32:35]
    ds_read_b64_tr_b16 v[52:53], v253 offset:8192
    v_mfma_f32_16x16x32_bf16 v[36:39], v[68:71], v[116:119], v[36:39]
    ds_read_b64_tr_b16 v[54:55], v253 offset:10240
    buffer_load_dwordx4 v[112:115], v5, s[12:15], s72 offen offset:1024
    buffer_load_dwordx4 v[116:119], v4, s[12:15], s72 offen offset:1024
    s_waitcnt vmcnt(22)
    s_waitcnt lgkmcnt(0)
    v_mfma_f32_16x16x32_bf16 v[8:11], v[40:43], v[120:123], v[8:11]
    ds_read_b64_tr_b16 v[56:57], v250 offset:12288
    v_mfma_f32_16x16x32_bf16 v[12:15], v[44:47], v[120:123], v[12:15]
    ds_read_b64_tr_b16 v[58:59], v250 offset:14336
    v_mfma_f32_16x16x32_bf16 v[16:19], v[48:51], v[120:123], v[16:19]
    ds_read_b64_tr_b16 v[60:61], v251 offset:12288
    v_mfma_f32_16x16x32_bf16 v[20:23], v[52:55], v[120:123], v[20:23]
    ds_read_b64_tr_b16 v[62:63], v251 offset:14336
    v_mfma_f32_16x16x32_bf16 v[24:27], v[40:43], v[124:127], v[24:27]
    ds_read_b64_tr_b16 v[64:65], v252 offset:12288
    v_mfma_f32_16x16x32_bf16 v[28:31], v[44:47], v[124:127], v[28:31]
    ds_read_b64_tr_b16 v[66:67], v252 offset:14336
    v_mfma_f32_16x16x32_bf16 v[32:35], v[48:51], v[124:127], v[32:35]
    ds_read_b64_tr_b16 v[68:69], v253 offset:12288
    v_mfma_f32_16x16x32_bf16 v[36:39], v[52:55], v[124:127], v[36:39]
    ds_read_b64_tr_b16 v[70:71], v253 offset:14336
    buffer_load_dwordx4 v[120:123], v5, s[12:15], s72 offen offset:2048
    buffer_load_dwordx4 v[124:127], v4, s[12:15], s72 offen offset:2048
    s_waitcnt vmcnt(22)
    s_waitcnt lgkmcnt(0)
    v_mfma_f32_16x16x32_bf16 v[8:11], v[56:59], v[128:131], v[8:11]
    ds_read_b64_tr_b16 v[40:41], v250 offset:16384
    v_mfma_f32_16x16x32_bf16 v[12:15], v[60:63], v[128:131], v[12:15]
    ds_read_b64_tr_b16 v[42:43], v250 offset:18432
    v_mfma_f32_16x16x32_bf16 v[16:19], v[64:67], v[128:131], v[16:19]
    ds_read_b64_tr_b16 v[44:45], v251 offset:16384
    v_mfma_f32_16x16x32_bf16 v[20:23], v[68:71], v[128:131], v[20:23]
    ds_read_b64_tr_b16 v[46:47], v251 offset:18432
    v_mfma_f32_16x16x32_bf16 v[24:27], v[56:59], v[132:135], v[24:27]
    ds_read_b64_tr_b16 v[48:49], v252 offset:16384
    v_mfma_f32_16x16x32_bf16 v[28:31], v[60:63], v[132:135], v[28:31]
    ds_read_b64_tr_b16 v[50:51], v252 offset:18432
    v_mfma_f32_16x16x32_bf16 v[32:35], v[64:67], v[132:135], v[32:35]
    ds_read_b64_tr_b16 v[52:53], v253 offset:16384
    v_mfma_f32_16x16x32_bf16 v[36:39], v[68:71], v[132:135], v[36:39]
    ds_read_b64_tr_b16 v[54:55], v253 offset:18432
    buffer_load_dwordx4 v[128:131], v5, s[12:15], s72 offen offset:3072
    buffer_load_dwordx4 v[132:135], v4, s[12:15], s72 offen offset:3072
    s_add_u32 s72, s72, 4096
    s_waitcnt vmcnt(22)
    s_waitcnt lgkmcnt(0)
    v_mfma_f32_16x16x32_bf16 v[8:11], v[40:43], v[136:139], v[8:11]
    ds_read_b64_tr_b16 v[56:57], v250 offset:20480
    v_mfma_f32_16x16x32_bf16 v[12:15], v[44:47], v[136:139], v[12:15]
    ds_read_b64_tr_b16 v[58:59], v250 offset:22528
    v_mfma_f32_16x16x32_bf16 v[16:19], v[48:51], v[136:139], v[16:19]
    ds_read_b64_tr_b16 v[60:61], v251 offset:20480
    v_mfma_f32_16x16x32_bf16 v[20:23], v[52:55], v[136:139], v[20:23]
    ds_read_b64_tr_b16 v[62:63], v251 offset:22528
    v_mfma_f32_16x16x32_bf16 v[24:27], v[40:43], v[140:143], v[24:27]
    ds_read_b64_tr_b16 v[64:65], v252 offset:20480
    v_mfma_f32_16x16x32_bf16 v[28:31], v[44:47], v[140:143], v[28:31]
    ds_read_b64_tr_b16 v[66:67], v252 offset:22528
    v_mfma_f32_16x16x32_bf16 v[32:35], v[48:51], v[140:143], v[32:35]
    ds_read_b64_tr_b16 v[68:69], v253 offset:20480
    v_mfma_f32_16x16x32_bf16 v[36:39], v[52:55], v[140:143], v[36:39]
    ds_read_b64_tr_b16 v[70:71], v253 offset:22528
    s_waitcnt vmcnt(20)
    s_waitcnt lgkmcnt(0)
    v_mfma_f32_16x16x32_bf16 v[8:11], v[56:59], v[144:147], v[8:11]
    ds_read_b64_tr_b16 v[40:41], v250 offset:24576
    v_mfma_f32_16x16x32_bf16 v[12:15], v[60:63], v[144:147], v[12:15]
    ds_read_b64_tr_b16 v[42:43], v250 offset:26624
    v_mfma_f32_16x16x32_bf16 v[16:19], v[64:67], v[144:147], v[16:19]
    ds_read_b64_tr_b16 v[44:45], v251 offset:24576
    v_mfma_f32_16x16x32_bf16 v[20:23], v[68:71], v[144:147], v[20:23]
    ds_read_b64_tr_b16 v[46:47], v251 offset:26624
    v_mfma_f32_16x16x32_bf16 v[24:27], v[56:59], v[148:151], v[24:27]
    ds_read_b64_tr_b16 v[48:49], v252 offset:24576
    v_mfma_f32_16x16x32_bf16 v[28:31], v[60:63], v[148:151], v[28:31]
    ds_read_b64_tr_b16 v[50:51], v252 offset:26624
    v_mfma_f32_16x16x32_bf16 v[32:35], v[64:67], v[148:151], v[32:35]
    ds_read_b64_tr_b16 v[52:53], v253 offset:24576
    v_mfma_f32_16x16x32_bf16 v[36:39], v[68:71], v[148:151], v[36:39]
    ds_read_b64_tr_b16 v[54:55], v253 offset:26624
    s_waitcnt vmcnt(18)
    s_waitcnt lgkmcnt(0)
    v_mfma_f32_16x16x32_bf16 v[8:11], v[40:43], v[152:155], v[8:11]
    ds_read_b64_tr_b16 v[56:57], v250 offset:28672
    v_mfma_f32_16x16x32_bf16 v[12:15], v[44:47], v[152:155], v[12:15]
    ds_read_b64_tr_b16 v[58:59], v250 offset:30720
    v_mfma_f32_16x16x32_bf16 v[16:19], v[48:51], v[152:155], v[16:19]
    ds_read_b64_tr_b16 v[60:61], v251 offset:28672
    v_mfma_f32_16x16x32_bf16 v[20:23], v[52:55], v[152:155], v[20:23]
    ds_read_b64_tr_b16 v[62:63], v251 offset:30720
    v_mfma_f32_16x16x32_bf16 v[24:27], v[40:43], v[156:159], v[24:27]
    ds_read_b64_tr_b16 v[64:65], v252 offset:28672
    v_mfma_f32_16x16x32_bf16 v[28:31], v[44:47], v[156:159], v[28:31]
    ds_read_b64_tr_b16 v[66:67], v252 offset:30720
    v_mfma_f32_16x16x32_bf16 v[32:35], v[48:51], v[156:159], v[32:35]
    ds_read_b64_tr_b16 v[68:69], v253 offset:28672
    v_mfma_f32_16x16x32_bf16 v[36:39], v[52:55], v[156:159], v[36:39]
    ds_read_b64_tr_b16 v[70:71], v253 offset:30720
    s_waitcnt vmcnt(16)
    s_waitcnt lgkmcnt(0)
    v_mfma_f32_16x16x32_bf16 v[8:11], v[56:59], v[160:163], v[8:11]
    ds_read_b64_tr_b16 v[40:41], v250 offset:32768
    v_mfma_f32_16x16x32_bf16 v[12:15], v[60:63], v[160:163], v[12:15]
    ds_read_b64_tr_b16 v[42:43], v250 offset:34816
    v_mfma_f32_16x16x32_bf16 v[16:19], v[64:67], v[160:163], v[16:19]
    ds_read_b64_tr_b16 v[44:45], v251 offset:32768
    v_mfma_f32_16x16x32_bf16 v[20:23], v[68:71], v[160:163], v[20:23]
    ds_read_b64_tr_b16 v[46:47], v251 offset:34816
    v_mfma_f32_16x16x32_bf16 v[24:27], v[56:59], v[164:167], v[24:27]
    ds_read_b64_tr_b16 v[48:49], v252 offset:32768
    v_mfma_f32_16x16x32_bf16 v[28:31], v[60:63], v[164:167], v[28:31]
    ds_read_b64_tr_b16 v[50:51], v252 offset:34816
    v_mfma_f32_16x16x32_bf16 v[32:35], v[64:67], v[164:167], v[32:35]
    ds_read_b64_tr_b16 v[52:53], v253 offset:32768
    v_mfma_f32_16x16x32_bf16 v[36:39], v[68:71], v[164:167], v[36:39]
    ds_read_b64_tr_b16 v[54:55], v253 offset:34816
    s_waitcnt vmcnt(14)
    s_waitcnt lgkmcnt(0)
    v_mfma_f32_16x16x32_bf16 v[8:11], v[40:43], v[72:75], v[8:11]
    ds_read_b64_tr_b16 v[56:57], v250 offset:36864
    v_mfma_f32_16x16x32_bf16 v[12:15], v[44:47], v[72:75], v[12:15]
    ds_read_b64_tr_b16 v[58:59], v250 offset:38912
    v_mfma_f32_16x16x32_bf16 v[16:19], v[48:51], v[72:75], v[16:19]
    ds_read_b64_tr_b16 v[60:61], v251 offset:36864
    v_mfma_f32_16x16x32_bf16 v[20:23], v[52:55], v[72:75], v[20:23]
    ds_read_b64_tr_b16 v[62:63], v251 offset:38912
    v_mfma_f32_16x16x32_bf16 v[24:27], v[40:43], v[76:79], v[24:27]
    ds_read_b64_tr_b16 v[64:65], v252 offset:36864
    v_mfma_f32_16x16x32_bf16 v[28:31], v[44:47], v[76:79], v[28:31]
    ds_read_b64_tr_b16 v[66:67], v252 offset:38912
    v_mfma_f32_16x16x32_bf16 v[32:35], v[48:51], v[76:79], v[32:35]
    ds_read_b64_tr_b16 v[68:69], v253 offset:36864
    v_mfma_f32_16x16x32_bf16 v[36:39], v[52:55], v[76:79], v[36:39]
    ds_read_b64_tr_b16 v[70:71], v253 offset:38912
    s_waitcnt vmcnt(12)
    s_waitcnt lgkmcnt(0)
    v_mfma_f32_16x16x32_bf16 v[8:11], v[56:59], v[80:83], v[8:11]
    ds_read_b64_tr_b16 v[40:41], v250 offset:40960
    v_mfma_f32_16x16x32_bf16 v[12:15], v[60:63], v[80:83], v[12:15]
    ds_read_b64_tr_b16 v[42:43], v250 offset:43008
    v_mfma_f32_16x16x32_bf16 v[16:19], v[64:67], v[80:83], v[16:19]
    ds_read_b64_tr_b16 v[44:45], v251 offset:40960
    v_mfma_f32_16x16x32_bf16 v[20:23], v[68:71], v[80:83], v[20:23]
    ds_read_b64_tr_b16 v[46:47], v251 offset:43008
    v_mfma_f32_16x16x32_bf16 v[24:27], v[56:59], v[84:87], v[24:27]
    ds_read_b64_tr_b16 v[48:49], v252 offset:40960
    v_mfma_f32_16x16x32_bf16 v[28:31], v[60:63], v[84:87], v[28:31]
    ds_read_b64_tr_b16 v[50:51], v252 offset:43008
    v_mfma_f32_16x16x32_bf16 v[32:35], v[64:67], v[84:87], v[32:35]
    ds_read_b64_tr_b16 v[52:53], v253 offset:40960
    v_mfma_f32_16x16x32_bf16 v[36:39], v[68:71], v[84:87], v[36:39]
    ds_read_b64_tr_b16 v[54:55], v253 offset:43008
    s_waitcnt vmcnt(10)
    s_waitcnt lgkmcnt(0)
    v_mfma_f32_16x16x32_bf16 v[8:11], v[40:43], v[88:91], v[8:11]
    ds_read_b64_tr_b16 v[56:57], v250 offset:45056
    v_mfma_f32_16x16x32_bf16 v[12:15], v[44:47], v[88:91], v[12:15]
    ds_read_b64_tr_b16 v[58:59], v250 offset:47104
    v_mfma_f32_16x16x32_bf16 v[16:19], v[48:51], v[88:91], v[16:19]
    ds_read_b64_tr_b16 v[60:61], v251 offset:45056
    v_mfma_f32_16x16x32_bf16 v[20:23], v[52:55], v[88:91], v[20:23]
    ds_read_b64_tr_b16 v[62:63], v251 offset:47104
    v_mfma_f32_16x16x32_bf16 v[24:27], v[40:43], v[92:95], v[24:27]
    ds_read_b64_tr_b16 v[64:65], v252 offset:45056
    v_mfma_f32_16x16x32_bf16 v[28:31], v[44:47], v[92:95], v[28:31]
    ds_read_b64_tr_b16 v[66:67], v252 offset:47104
    v_mfma_f32_16x16x32_bf16 v[32:35], v[48:51], v[92:95], v[32:35]
    ds_read_b64_tr_b16 v[68:69], v253 offset:45056
    v_mfma_f32_16x16x32_bf16 v[36:39], v[52:55], v[92:95], v[36:39]
    ds_read_b64_tr_b16 v[70:71], v253 offset:47104
    s_waitcnt vmcnt(8)
    s_waitcnt lgkmcnt(0)
    v_mfma_f32_16x16x32_bf16 v[8:11], v[56:59], v[96:99], v[8:11]
    ds_read_b64_tr_b16 v[40:41], v250 offset:49152
    v_mfma_f32_16x16x32_bf16 v[12:15], v[60:63], v[96:99], v[12:15]
    ds_read_b64_tr_b16 v[42:43], v250 offset:51200
    v_mfma_f32_16x16x32_bf16 v[16:19], v[64:67], v[96:99], v[16:19]
    ds_read_b64_tr_b16 v[44:45], v251 offset:49152
    v_mfma_f32_16x16x32_bf16 v[20:23], v[68:71], v[96:99], v[20:23]
    ds_read_b64_tr_b16 v[46:47], v251 offset:51200
    v_mfma_f32_16x16x32_bf16 v[24:27], v[56:59], v[100:103], v[24:27]
    ds_read_b64_tr_b16 v[48:49], v252 offset:49152
    v_mfma_f32_16x16x32_bf16 v[28:31], v[60:63], v[100:103], v[28:31]
    ds_read_b64_tr_b16 v[50:51], v252 offset:51200
    v_mfma_f32_16x16x32_bf16 v[32:35], v[64:67], v[100:103], v[32:35]
    ds_read_b64_tr_b16 v[52:53], v253 offset:49152
    v_mfma_f32_16x16x32_bf16 v[36:39], v[68:71], v[100:103], v[36:39]
    ds_read_b64_tr_b16 v[54:55], v253 offset:51200
    s_waitcnt vmcnt(6)
    s_waitcnt lgkmcnt(0)
    v_mfma_f32_16x16x32_bf16 v[8:11], v[40:43], v[104:107], v[8:11]
    ds_read_b64_tr_b16 v[56:57], v250 offset:53248
    v_mfma_f32_16x16x32_bf16 v[12:15], v[44:47], v[104:107], v[12:15]
    ds_read_b64_tr_b16 v[58:59], v250 offset:55296
    v_mfma_f32_16x16x32_bf16 v[16:19], v[48:51], v[104:107], v[16:19]
    ds_read_b64_tr_b16 v[60:61], v251 offset:53248
    v_mfma_f32_16x16x32_bf16 v[20:23], v[52:55], v[104:107], v[20:23]
    ds_read_b64_tr_b16 v[62:63], v251 offset:55296
    v_mfma_f32_16x16x32_bf16 v[24:27], v[40:43], v[108:111], v[24:27]
    ds_read_b64_tr_b16 v[64:65], v252 offset:53248
    v_mfma_f32_16x16x32_bf16 v[28:31], v[44:47], v[108:111], v[28:31]
    ds_read_b64_tr_b16 v[66:67], v252 offset:55296
    v_mfma_f32_16x16x32_bf16 v[32:35], v[48:51], v[108:111], v[32:35]
    ds_read_b64_tr_b16 v[68:69], v253 offset:53248
    v_mfma_f32_16x16x32_bf16 v[36:39], v[52:55], v[108:111], v[36:39]
    ds_read_b64_tr_b16 v[70:71], v253 offset:55296
    s_waitcnt vmcnt(4)
    s_waitcnt lgkmcnt(0)
    v_mfma_f32_16x16x32_bf16 v[8:11], v[56:59], v[112:115], v[8:11]
    ds_read_b64_tr_b16 v[40:41], v250 offset:57344
    v_mfma_f32_16x16x32_bf16 v[12:15], v[60:63], v[112:115], v[12:15]
    ds_read_b64_tr_b16 v[42:43], v250 offset:59392
    v_mfma_f32_16x16x32_bf16 v[16:19], v[64:67], v[112:115], v[16:19]
    ds_read_b64_tr_b16 v[44:45], v251 offset:57344
    v_mfma_f32_16x16x32_bf16 v[20:23], v[68:71], v[112:115], v[20:23]
    ds_read_b64_tr_b16 v[46:47], v251 offset:59392
    v_mfma_f32_16x16x32_bf16 v[24:27], v[56:59], v[116:119], v[24:27]
    ds_read_b64_tr_b16 v[48:49], v252 offset:57344
    v_mfma_f32_16x16x32_bf16 v[28:31], v[60:63], v[116:119], v[28:31]
    ds_read_b64_tr_b16 v[50:51], v252 offset:59392
    v_mfma_f32_16x16x32_bf16 v[32:35], v[64:67], v[116:119], v[32:35]
    ds_read_b64_tr_b16 v[52:53], v253 offset:57344
    v_mfma_f32_16x16x32_bf16 v[36:39], v[68:71], v[116:119], v[36:39]
    ds_read_b64_tr_b16 v[54:55], v253 offset:59392
    s_waitcnt vmcnt(2)
    s_waitcnt lgkmcnt(0)
    v_mfma_f32_16x16x32_bf16 v[8:11], v[40:43], v[120:123], v[8:11]
    ds_read_b64_tr_b16 v[56:57], v250 offset:61440
    v_mfma_f32_16x16x32_bf16 v[12:15], v[44:47], v[120:123], v[12:15]
    ds_read_b64_tr_b16 v[58:59], v250 offset:63488
    v_mfma_f32_16x16x32_bf16 v[16:19], v[48:51], v[120:123], v[16:19]
    ds_read_b64_tr_b16 v[60:61], v251 offset:61440
    v_mfma_f32_16x16x32_bf16 v[20:23], v[52:55], v[120:123], v[20:23]
    ds_read_b64_tr_b16 v[62:63], v251 offset:63488
    v_mfma_f32_16x16x32_bf16 v[24:27], v[40:43], v[124:127], v[24:27]
    ds_read_b64_tr_b16 v[64:65], v252 offset:61440
    v_mfma_f32_16x16x32_bf16 v[28:31], v[44:47], v[124:127], v[28:31]
    ds_read_b64_tr_b16 v[66:67], v252 offset:63488
    v_mfma_f32_16x16x32_bf16 v[32:35], v[48:51], v[124:127], v[32:35]
    ds_read_b64_tr_b16 v[68:69], v253 offset:61440
    v_mfma_f32_16x16x32_bf16 v[36:39], v[52:55], v[124:127], v[36:39]
    ds_read_b64_tr_b16 v[70:71], v253 offset:63488
    s_waitcnt vmcnt(0)
    s_waitcnt lgkmcnt(0)
    v_mfma_f32_16x16x32_bf16 v[8:11], v[56:59], v[128:131], v[8:11]
    v_mfma_f32_16x16x32_bf16 v[12:15], v[60:63], v[128:131], v[12:15]
    v_mfma_f32_16x16x32_bf16 v[16:19], v[64:67], v[128:131], v[16:19]
    v_mfma_f32_16x16x32_bf16 v[20:23], v[68:71], v[128:131], v[20:23]
    v_mfma_f32_16x16x32_bf16 v[24:27], v[56:59], v[132:135], v[24:27]
    v_mfma_f32_16x16x32_bf16 v[28:31], v[60:63], v[132:135], v[28:31]
    v_mfma_f32_16x16x32_bf16 v[32:35], v[64:67], v[132:135], v[32:35]
    v_mfma_f32_16x16x32_bf16 v[36:39], v[68:71], v[132:135], v[36:39]
    s_bfe_u32 s3, s34, 0x20005
    s_cmp_eq_u32 s3, s38
    s_cselect_b32 s3, s35, 0
    s_and_b32 s65, s34, 15
    s_lshl_b32 s66, 0x00010001, s65
    s_cmp_eq_u32 s3, 0
    s_cselect_b32 s66, 0, s66
    s_bfe_u32 s65, s34, 0x10004
    v_and_b32 v7, 1, v2
    v_lshlrev_b32 v6, 6, v7
    v_lshrrev_b32 v7, 1, v2
    v_lshl_add_u32 v6, v7, 5, v6
    v_add_u32 v6, 140288, v6
    v_permlane16_swap_b32 v8, v12
    v_permlane16_swap_b32 v9, v13
    v_permlane16_swap_b32 v10, v14
    v_permlane16_swap_b32 v11, v15
    v_permlane16_swap_b32 v16, v20
    v_permlane16_swap_b32 v17, v21
    v_permlane16_swap_b32 v18, v22
    v_permlane16_swap_b32 v19, v23
    s_cmp_eq_u32 s65, 0
    s_cselect_b32 s74, s66, 0
    s_mov_b32 s75, s74
    v_pk_fma_f32 v[176:177], v[8:9], v[208:209], v[176:177]
    v_pk_fma_f32 v[178:179], v[10:11], v[210:211], v[178:179]
    v_pk_fma_f32 v[180:181], v[12:13], v[212:213], v[180:181]
    v_pk_fma_f32 v[182:183], v[14:15], v[214:215], v[182:183]
    v_cvt_pk_bf16_f32 v72, v176, v177
    v_cvt_pk_bf16_f32 v73, v178, v179
    v_cvt_pk_bf16_f32 v74, v180, v181
    v_cvt_pk_bf16_f32 v75, v182, v183
    v_pk_fma_f32 v[184:185], v[16:17], v[216:217], v[184:185]
    v_pk_fma_f32 v[186:187], v[18:19], v[218:219], v[186:187]
    v_pk_fma_f32 v[188:189], v[20:21], v[220:221], v[188:189]
    v_pk_fma_f32 v[190:191], v[22:23], v[222:223], v[190:191]
    v_cvt_pk_bf16_f32 v76, v184, v185
    v_cvt_pk_bf16_f32 v77, v186, v187
    v_cvt_pk_bf16_f32 v78, v188, v189
    v_cvt_pk_bf16_f32 v79, v190, v191
    s_andn2_b64 exec, -1, s[74:75]
    buffer_store_dwordx4 v[72:75], v248, s[24:27], 0 offen offset:0 nt
    buffer_store_dwordx4 v[76:79], v248, s[24:27], 0 offen offset:64 nt
    s_cmp_eq_u32 s74, 0
    s_cbranch_scc1 L_ns0
    s_mov_b64 exec, s[74:75]
    ds_write_b128 v6, v[8:11] offset:0
    ds_write_b128 v6, v[12:15] offset:16
    ds_write_b128 v6, v[16:19] offset:128
    ds_write_b128 v6, v[20:23] offset:144
L_ns0:
    s_mov_b64 exec, -1
    v_permlane16_swap_b32 v24, v28
    v_permlane16_swap_b32 v25, v29
    v_permlane16_swap_b32 v26, v30
    v_permlane16_swap_b32 v27, v31
    v_permlane16_swap_b32 v32, v36
    v_permlane16_swap_b32 v33, v37
    v_permlane16_swap_b32 v34, v38
    v_permlane16_swap_b32 v35, v39
    s_cmp_eq_u32 s65, 1
    s_cselect_b32 s74, s66, 0
    s_mov_b32 s75, s74
    v_pk_fma_f32 v[192:193], v[24:25], v[224:225], v[192:193]
    v_pk_fma_f32 v[194:195], v[26:27], v[226:227], v[194:195]
    v_pk_fma_f32 v[196:197], v[28:29], v[228:229], v[196:197]
    v_pk_fma_f32 v[198:199], v[30:31], v[230:231], v[198:199]
    v_cvt_pk_bf16_f32 v80, v192, v193
    v_cvt_pk_bf16_f32 v81, v194, v195
    v_cvt_pk_bf16_f32 v82, v196, v197
    v_cvt_pk_bf16_f32 v83, v198, v199
    v_pk_fma_f32 v[200:201], v[32:33], v[232:233], v[200:201]
    v_pk_fma_f32 v[202:203], v[34:35], v[234:235], v[202:203]
    v_pk_fma_f32 v[204:205], v[36:37], v[236:237], v[204:205]
    v_pk_fma_f32 v[206:207], v[38:39], v[238:239], v[206:207]
    v_cvt_pk_bf16_f32 v84, v200, v201
    v_cvt_pk_bf16_f32 v85, v202, v203
    v_cvt_pk_bf16_f32 v86, v204, v205
    v_cvt_pk_bf16_f32 v87, v206, v207
    s_andn2_b64 exec, -1, s[74:75]
    buffer_store_dwordx4 v[80:83], v248, s[24:27], s68 offen offset:0 nt
    buffer_store_dwordx4 v[84:87], v248, s[24:27], s68 offen offset:64 nt
    s_cmp_eq_u32 s74, 0
    s_cbranch_scc1 L_ns1
    s_mov_b64 exec, s[74:75]
    ds_write_b128 v6, v[24:27] offset:0
    ds_write_b128 v6, v[28:31] offset:16
    ds_write_b128 v6, v[32:35] offset:128
    ds_write_b128 v6, v[36:39] offset:144
L_ns1:
    s_mov_b64 exec, -1
    s_cmp_eq_u32 s35, 0
    s_cbranch_scc1 L_g1end
    s_waitcnt lgkmcnt(0)
    s_barrier
L_g1end:
    s_endpgm
.p2align 8
L_code_end:
.fill 2048, 4, 0xbf800000
.section .rodata,"a"
.p2align 6
.amdhsa_kernel recurrent_scan__linear_kernel_hedgehog__moe_arch_mod__prompt_kernel
  .amdhsa_next_free_vgpr 256
  .amdhsa_next_free_sgpr 102
  .amdhsa_accum_offset 256
  .amdhsa_group_segment_fixed_size 0
  .amdhsa_kernarg_size 96
  .amdhsa_user_sgpr_count 2
  .amdhsa_user_sgpr_kernarg_segment_ptr 1
  .amdhsa_system_sgpr_workgroup_id_x 1
.end_amdhsa_kernel
```

```asm
; @launch grid=(256,1,1) block=(512,1,1) lds=163840
.amdgcn_target "amdgcn-amd-amdhsa--gfx950"
.text
.globl recurrent_scan__linear_kernel_hedgehog__moe_arch_mod__prompt_kernel
.p2align 8
.type recurrent_scan__linear_kernel_hedgehog__moe_arch_mod__prompt_kernel,@function
recurrent_scan__linear_kernel_hedgehog__moe_arch_mod__prompt_kernel:
    s_cmp_ge_u32 s2, 256
    s_cbranch_scc1 L_done
    s_load_dwordx16 s[40:55], s[0:1], 0
    s_load_dwordx8 s[56:63], s[0:1], 64
    v_and_b32 v1, 63, v0
    v_lshrrev_b32 v2, 6, v0
    s_nop 0
    v_readfirstlane_b32 s38, v2
    s_and_b32 s65, s2, 1
    s_bfe_u32 s66, s2, 0x30003
    s_bfe_u32 s67, s2, 0x20001
    s_lshl_b32 s67, s67, 2
    s_lshl_b32 s36, s65, 3
    s_add_u32 s36, s36, s66
    s_lshr_b32 s3, s2, 6
    s_add_u32 s37, s67, s3
    s_lshl_b32 s39, s66, 1
    s_add_u32 s39, s39, s65
    s_add_u32 s39, s39, s67
    s_and_b32 s39, s39, 15
    s_cmp_lt_u32 s38, 4
    s_cbranch_scc1 L_g1
    s_sub_u32 s38, s38, 4
    s_lshl_b32 s3, s38, 4
    v_lshrrev_b32 v7, 3, v1
    v_add_u32 v3, s3, v7
    v_mul_u32_u24 v3, 6144, v3
    s_lshl_b32 s3, s37, 7
    v_add_u32 v3, s3, v3
    v_and_b32 v6, 7, v1
    v_bfe_u32 v5, v1, 4, 1
    v_lshlrev_b32 v5, 1, v5
    v_xor_b32 v5, v6, v5
    v_lshl_add_u32 v16, v5, 4, v3
    v_xor_b32 v5, 4, v5
    v_lshl_add_u32 v5, v5, 4, v3
    v_add_u32 v17, 48128, v5
    v_add_u32 v12, 2048, v16
    v_add_u32 v13, 2048, v17
    v_add_u32 v14, 4096, v16
    v_add_u32 v15, 4096, v17
    s_lshl_b32 s3, s36, 7
    s_lshl_b32 s65, s38, 5
    s_add_u32 s3, s3, s65
    v_add_u32 v3, s3, v7
    v_lshlrev_b32 v3, 11, v3
    v_lshrrev_b32 v5, 4, v1
    v_xor_b32 v6, v6, v5
    v_xor_b32 v5, 4, v6
    v_lshl_add_u32 v8, v6, 4, v3
    v_lshl_add_u32 v5, v5, 4, v3
    v_add_u32 v9, 15360, v5
    v_add_u32 v10, 30720, v8
    v_add_u32 v11, 46080, v5
    s_lshl_b32 s72, s38, 12
    s_lshl_b32 s73, s38, 11
    s_lshl_b32 s74, s39, 7
    s_mul_i32 s75, s39, 393216
    s_mov_b32 s76, s75
    s_waitcnt lgkmcnt(0)
    s_mov_b32 s8, s42
    s_mov_b32 s9, s43
    s_mov_b32 s10, 6291456
    s_mov_b32 s11, 0x00020000
    s_mov_b32 s4, s40
    s_mov_b32 s5, s41
    s_mov_b32 s6, 4194304
    s_mov_b32 s7, 0x00020000
    s_cmp_ge_u32 s38, 2
    s_cbranch_scc1 L_xw
    s_add_u32 s3, s75, 196608
    s_add_u32 m0, s73, 65536
    s_nop 0
    buffer_load_dwordx4 v12, s[8:11], s75 offen offset:0  lds
    buffer_load_dwordx4 v13, s[8:11], s75 offen offset:1024  lds
    s_add_u32 m0, s73, 73728
    s_nop 0
    buffer_load_dwordx4 v14, s[8:11], s75 offen offset:0  lds
    buffer_load_dwordx4 v15, s[8:11], s75 offen offset:1024  lds
    s_add_u32 m0, s73, 69632
    s_nop 0
    buffer_load_dwordx4 v12, s[8:11], s3 offen offset:0  lds
    buffer_load_dwordx4 v13, s[8:11], s3 offen offset:1024  lds
    s_add_u32 m0, s73, 77824
    s_nop 0
    buffer_load_dwordx4 v14, s[8:11], s3 offen offset:0  lds
    buffer_load_dwordx4 v15, s[8:11], s3 offen offset:1024  lds
    s_add_u32 s75, s75, 393216
    s_cmp_eq_u32 s75, 6291456
    s_cselect_b32 s75, 0, s75
    s_add_u32 m0, s72, 0
    s_nop 0
    buffer_load_dwordx4 v8, s[4:7], s74 offen offset:0  lds
    buffer_load_dwordx4 v9, s[4:7], s74 offen offset:1024  lds
    buffer_load_dwordx4 v10, s[4:7], s74 offen offset:2048  lds
    buffer_load_dwordx4 v11, s[4:7], s74 offen offset:3072  lds
    s_add_u32 m0, s72, 8192
    s_add_u32 s3, s74, 131072
    buffer_load_dwordx4 v8, s[4:7], s3 offen offset:0  lds
    buffer_load_dwordx4 v9, s[4:7], s3 offen offset:1024  lds
    buffer_load_dwordx4 v10, s[4:7], s3 offen offset:2048  lds
    buffer_load_dwordx4 v11, s[4:7], s3 offen offset:3072  lds
    s_add_u32 s74, s74, 128
    s_and_b32 s74, s74, 2047
    s_add_u32 s3, s75, 196608
    s_add_u32 m0, s73, 81920
    s_nop 0
    buffer_load_dwordx4 v12, s[8:11], s75 offen offset:0  lds
    buffer_load_dwordx4 v13, s[8:11], s75 offen offset:1024  lds
    s_add_u32 m0, s73, 90112
    s_nop 0
    buffer_load_dwordx4 v14, s[8:11], s75 offen offset:0  lds
    buffer_load_dwordx4 v15, s[8:11], s75 offen offset:1024  lds
    s_add_u32 m0, s73, 86016
    s_nop 0
    buffer_load_dwordx4 v12, s[8:11], s3 offen offset:0  lds
    buffer_load_dwordx4 v13, s[8:11], s3 offen offset:1024  lds
    s_add_u32 m0, s73, 94208
    s_nop 0
    buffer_load_dwordx4 v14, s[8:11], s3 offen offset:0  lds
    buffer_load_dwordx4 v15, s[8:11], s3 offen offset:1024  lds
    s_add_u32 s75, s75, 393216
    s_cmp_eq_u32 s75, 6291456
    s_cselect_b32 s75, 0, s75
    v_lshlrev_b32 v3, 4, v1
    s_mov_b32 s12, s62
    s_mov_b32 s13, s63
    s_mov_b32 s14, 268435456
    s_mov_b32 s15, 0x00020000
    s_and_b32 s30, s2, 3
    s_lshl_b32 s30, s30, 2
    s_bfe_u32 s3, s2, 0x20003
    s_add_u32 s30, s30, s3
    s_bfe_u32 s31, s2, 0x10002
    s_lshl_b32 s31, s31, 3
    s_lshr_b32 s3, s2, 5
    s_add_u32 s31, s31, s3
    s_lshl_b32 s88, s31, 1
    s_and_b32 s88, s88, 15
    s_mov_b32 s70, 0
    s_mov_b32 s80, s52
    s_mov_b32 s81, s53
    s_mov_b32 s82, 7340032
    s_mov_b32 s83, 0x00020000
    s_mov_b32 s84, s54
    s_mov_b32 s85, s55
    s_mov_b32 s86, 7340032
    s_mov_b32 s87, 0x00020000
    s_cmp_lt_u32 s2, 224
    s_cselect_b32 s82, s82, 0
    s_cselect_b32 s86, s86, 0
    s_and_b32 s3, s2, 3
    s_lshl_b32 s3, s3, 8
    s_lshl_b32 s65, s38, 6
    s_add_u32 s3, s3, s65
    v_and_b32 v5, 0x38, v1
    v_add_u32 v5, s3, v5
    v_mul_u32_u24 v5, 7168, v5
    v_and_b32 v6, 7, v1
    v_lshl_add_u32 v2, v6, 4, v5
    s_lshr_b32 s77, s2, 2
    s_lshl_b32 s77, s77, 7
    v_and_b32 v5, 1, v1
    v_cmp_eq_u32 vcc, 0, v5
    v_mov_b32 v6, 0xffff0000
    v_mov_b32 v7, 0xffff
    v_cndmask_b32 v6, v6, v7, vcc
    v_bfe_u32 v5, v1, 1, 2
    v_cmp_eq_u32 vcc, 0, v5
    s_nop 1
    v_cndmask_b32 v88, 0, v6, vcc
    v_cmp_eq_u32 vcc, 1, v5
    s_nop 1
    v_cndmask_b32 v89, 0, v6, vcc
    v_cmp_eq_u32 vcc, 2, v5
    s_nop 1
    v_cndmask_b32 v90, 0, v6, vcc
    v_cmp_eq_u32 vcc, 3, v5
    s_nop 1
    v_cndmask_b32 v91, 0, v6, vcc
    v_and_b32 v20, 0x3f803f80, v88
    v_and_b32 v21, 0x3f803f80, v89
    v_and_b32 v22, 0x3f803f80, v90
    v_and_b32 v23, 0x3f803f80, v91
    s_waitcnt vmcnt(8)
    s_barrier
    s_add_u32 m0, s72, 16384
    s_nop 0
    buffer_load_dwordx4 v8, s[4:7], s74 offen offset:0  lds
    buffer_load_dwordx4 v9, s[4:7], s74 offen offset:1024  lds
    buffer_load_dwordx4 v10, s[4:7], s74 offen offset:2048  lds
    buffer_load_dwordx4 v11, s[4:7], s74 offen offset:3072  lds
    s_add_u32 m0, s72, 24576
    s_add_u32 s3, s74, 131072
    buffer_load_dwordx4 v8, s[4:7], s3 offen offset:0  lds
    buffer_load_dwordx4 v9, s[4:7], s3 offen offset:1024  lds
    buffer_load_dwordx4 v10, s[4:7], s3 offen offset:2048  lds
    buffer_load_dwordx4 v11, s[4:7], s3 offen offset:3072  lds
    s_add_u32 s74, s74, 128
    s_and_b32 s74, s74, 2047
    s_add_u32 s3, s75, 196608
    s_add_u32 m0, s73, 98304
    s_nop 0
    buffer_load_dwordx4 v12, s[8:11], s75 offen offset:0  lds
    buffer_load_dwordx4 v13, s[8:11], s75 offen offset:1024  lds
    s_add_u32 m0, s73, 106496
    s_nop 0
    buffer_load_dwordx4 v14, s[8:11], s75 offen offset:0  lds
    buffer_load_dwordx4 v15, s[8:11], s75 offen offset:1024  lds
    s_add_u32 m0, s73, 102400
    s_nop 0
    buffer_load_dwordx4 v12, s[8:11], s3 offen offset:0  lds
    buffer_load_dwordx4 v13, s[8:11], s3 offen offset:1024  lds
    s_add_u32 m0, s73, 110592
    s_nop 0
    buffer_load_dwordx4 v14, s[8:11], s3 offen offset:0  lds
    buffer_load_dwordx4 v15, s[8:11], s3 offen offset:1024  lds
    s_add_u32 s75, s75, 393216
    s_cmp_eq_u32 s75, 6291456
    s_cselect_b32 s75, 0, s75
    s_waitcnt vmcnt(8)
    s_barrier
    s_add_u32 m0, s72, 32768
    s_nop 0
    buffer_load_dwordx4 v8, s[4:7], s74 offen offset:0  lds
    buffer_load_dwordx4 v9, s[4:7], s74 offen offset:1024  lds
    buffer_load_dwordx4 v10, s[4:7], s74 offen offset:2048  lds
    buffer_load_dwordx4 v11, s[4:7], s74 offen offset:3072  lds
    s_add_u32 m0, s72, 40960
    s_add_u32 s3, s74, 131072
    buffer_load_dwordx4 v8, s[4:7], s3 offen offset:0  lds
    buffer_load_dwordx4 v9, s[4:7], s3 offen offset:1024  lds
    buffer_load_dwordx4 v10, s[4:7], s3 offen offset:2048  lds
    buffer_load_dwordx4 v11, s[4:7], s3 offen offset:3072  lds
    s_add_u32 s74, s74, 128
    s_and_b32 s74, s74, 2047
    s_add_u32 m0, s72, 49152
    s_nop 0
    buffer_load_dwordx4 v8, s[4:7], s74 offen offset:0  lds
    buffer_load_dwordx4 v9, s[4:7], s74 offen offset:1024  lds
    buffer_load_dwordx4 v10, s[4:7], s74 offen offset:2048  lds
    buffer_load_dwordx4 v11, s[4:7], s74 offen offset:3072  lds
    s_add_u32 m0, s72, 57344
    s_add_u32 s3, s74, 131072
    buffer_load_dwordx4 v8, s[4:7], s3 offen offset:0  lds
    buffer_load_dwordx4 v9, s[4:7], s3 offen offset:1024  lds
    buffer_load_dwordx4 v10, s[4:7], s3 offen offset:2048  lds
    buffer_load_dwordx4 v11, s[4:7], s3 offen offset:3072  lds
    s_add_u32 s74, s74, 128
    s_and_b32 s74, s74, 2047
    s_add_u32 s3, s75, 196608
    s_add_u32 m0, s73, 114688
    s_nop 0
    buffer_load_dwordx4 v12, s[8:11], s75 offen offset:0  lds
    buffer_load_dwordx4 v13, s[8:11], s75 offen offset:1024  lds
    s_add_u32 m0, s73, 122880
    s_nop 0
    buffer_load_dwordx4 v14, s[8:11], s75 offen offset:0  lds
    buffer_load_dwordx4 v15, s[8:11], s75 offen offset:1024  lds
    s_add_u32 m0, s73, 118784
    s_nop 0
    buffer_load_dwordx4 v12, s[8:11], s3 offen offset:0  lds
    buffer_load_dwordx4 v13, s[8:11], s3 offen offset:1024  lds
    s_add_u32 m0, s73, 126976
    s_nop 0
    buffer_load_dwordx4 v14, s[8:11], s3 offen offset:0  lds
    buffer_load_dwordx4 v15, s[8:11], s3 offen offset:1024  lds
    s_add_u32 s75, s75, 393216
    s_cmp_eq_u32 s75, 6291456
    s_cselect_b32 s75, 0, s75
    s_waitcnt vmcnt(16)
    s_barrier
    s_add_u32 m0, s72, 0
    s_nop 0
    buffer_load_dwordx4 v8, s[4:7], s74 offen offset:0  lds
    buffer_load_dwordx4 v9, s[4:7], s74 offen offset:1024  lds
    buffer_load_dwordx4 v10, s[4:7], s74 offen offset:2048  lds
    buffer_load_dwordx4 v11, s[4:7], s74 offen offset:3072  lds
    s_add_u32 m0, s72, 8192
    s_add_u32 s3, s74, 131072
    buffer_load_dwordx4 v8, s[4:7], s3 offen offset:0  lds
    buffer_load_dwordx4 v9, s[4:7], s3 offen offset:1024  lds
    buffer_load_dwordx4 v10, s[4:7], s3 offen offset:2048  lds
    buffer_load_dwordx4 v11, s[4:7], s3 offen offset:3072  lds
    s_add_u32 s74, s74, 128
    s_and_b32 s74, s74, 2047
    s_add_u32 s3, s75, 196608
    s_add_u32 m0, s73, 65536
    s_nop 0
    buffer_load_dwordx4 v12, s[8:11], s75 offen offset:0  lds
    buffer_load_dwordx4 v13, s[8:11], s75 offen offset:1024  lds
    s_add_u32 m0, s73, 73728
    s_nop 0
    buffer_load_dwordx4 v14, s[8:11], s75 offen offset:0  lds
    buffer_load_dwordx4 v15, s[8:11], s75 offen offset:1024  lds
    s_add_u32 m0, s73, 69632
    s_nop 0
    buffer_load_dwordx4 v12, s[8:11], s3 offen offset:0  lds
    buffer_load_dwordx4 v13, s[8:11], s3 offen offset:1024  lds
    s_add_u32 m0, s73, 77824
    s_nop 0
    buffer_load_dwordx4 v14, s[8:11], s3 offen offset:0  lds
    buffer_load_dwordx4 v15, s[8:11], s3 offen offset:1024  lds
    s_add_u32 s75, s75, 393216
    s_cmp_eq_u32 s75, 6291456
    s_cselect_b32 s75, 0, s75
    s_add_u32 m0, s72, 16384
    s_nop 0
    buffer_load_dwordx4 v8, s[4:7], s74 offen offset:0  lds
    buffer_load_dwordx4 v9, s[4:7], s74 offen offset:1024  lds
    buffer_load_dwordx4 v10, s[4:7], s74 offen offset:2048  lds
    buffer_load_dwordx4 v11, s[4:7], s74 offen offset:3072  lds
    s_add_u32 m0, s72, 24576
    s_add_u32 s3, s74, 131072
    buffer_load_dwordx4 v8, s[4:7], s3 offen offset:0  lds
    buffer_load_dwordx4 v9, s[4:7], s3 offen offset:1024  lds
    buffer_load_dwordx4 v10, s[4:7], s3 offen offset:2048  lds
    buffer_load_dwordx4 v11, s[4:7], s3 offen offset:3072  lds
    s_add_u32 s74, s74, 128
    s_and_b32 s74, s74, 2047
    s_waitcnt vmcnt(24)
    s_barrier
    s_add_u32 s3, s75, 196608
    s_add_u32 m0, s73, 81920
    s_nop 0
    buffer_load_dwordx4 v12, s[8:11], s75 offen offset:0  lds
    buffer_load_dwordx4 v13, s[8:11], s75 offen offset:1024  lds
    s_add_u32 m0, s73, 90112
    s_nop 0
    buffer_load_dwordx4 v14, s[8:11], s75 offen offset:0  lds
    buffer_load_dwordx4 v15, s[8:11], s75 offen offset:1024  lds
    s_add_u32 m0, s73, 86016
    s_nop 0
    buffer_load_dwordx4 v12, s[8:11], s3 offen offset:0  lds
    buffer_load_dwordx4 v13, s[8:11], s3 offen offset:1024  lds
    s_add_u32 m0, s73, 94208
    s_nop 0
    buffer_load_dwordx4 v14, s[8:11], s3 offen offset:0  lds
    buffer_load_dwordx4 v15, s[8:11], s3 offen offset:1024  lds
    s_add_u32 s75, s75, 393216
    s_cmp_eq_u32 s75, 6291456
    s_cselect_b32 s75, 0, s75
    s_add_u32 m0, s72, 32768
    s_nop 0
    buffer_load_dwordx4 v8, s[4:7], s74 offen offset:0  lds
    buffer_load_dwordx4 v9, s[4:7], s74 offen offset:1024  lds
    buffer_load_dwordx4 v10, s[4:7], s74 offen offset:2048  lds
    buffer_load_dwordx4 v11, s[4:7], s74 offen offset:3072  lds
    s_add_u32 m0, s72, 40960
    s_add_u32 s3, s74, 131072
    buffer_load_dwordx4 v8, s[4:7], s3 offen offset:0  lds
    buffer_load_dwordx4 v9, s[4:7], s3 offen offset:1024  lds
    buffer_load_dwordx4 v10, s[4:7], s3 offen offset:2048  lds
    buffer_load_dwordx4 v11, s[4:7], s3 offen offset:3072  lds
    s_add_u32 s74, s74, 128
    s_and_b32 s74, s74, 2047
    s_add_u32 s3, s75, 196608
    s_add_u32 m0, s73, 98304
    s_nop 0
    buffer_load_dwordx4 v12, s[8:11], s75 offen offset:0  lds
    buffer_load_dwordx4 v13, s[8:11], s75 offen offset:1024  lds
    s_add_u32 m0, s73, 106496
    s_nop 0
    buffer_load_dwordx4 v14, s[8:11], s75 offen offset:0  lds
    buffer_load_dwordx4 v15, s[8:11], s75 offen offset:1024  lds
    s_add_u32 m0, s73, 102400
    s_nop 0
    buffer_load_dwordx4 v12, s[8:11], s3 offen offset:0  lds
    buffer_load_dwordx4 v13, s[8:11], s3 offen offset:1024  lds
    s_add_u32 m0, s73, 110592
    s_nop 0
    buffer_load_dwordx4 v14, s[8:11], s3 offen offset:0  lds
    buffer_load_dwordx4 v15, s[8:11], s3 offen offset:1024  lds
    s_add_u32 s75, s75, 393216
    s_cmp_eq_u32 s75, 6291456
    s_cselect_b32 s75, 0, s75
    s_waitcnt vmcnt(32)
    s_barrier
    s_add_u32 m0, s72, 49152
    s_nop 0
    buffer_load_dwordx4 v8, s[4:7], s74 offen offset:0  lds
    buffer_load_dwordx4 v9, s[4:7], s74 offen offset:1024  lds
    buffer_load_dwordx4 v10, s[4:7], s74 offen offset:2048  lds
    buffer_load_dwordx4 v11, s[4:7], s74 offen offset:3072  lds
    s_add_u32 m0, s72, 57344
    s_add_u32 s3, s74, 131072
    buffer_load_dwordx4 v8, s[4:7], s3 offen offset:0  lds
    buffer_load_dwordx4 v9, s[4:7], s3 offen offset:1024  lds
    buffer_load_dwordx4 v10, s[4:7], s3 offen offset:2048  lds
    buffer_load_dwordx4 v11, s[4:7], s3 offen offset:3072  lds
    s_add_u32 s74, s74, 128
    s_and_b32 s74, s74, 2047
    s_add_u32 s3, s75, 196608
    s_add_u32 m0, s73, 114688
    s_nop 0
    buffer_load_dwordx4 v12, s[8:11], s75 offen offset:0  lds
    buffer_load_dwordx4 v13, s[8:11], s75 offen offset:1024  lds
    s_add_u32 m0, s73, 122880
    s_nop 0
    buffer_load_dwordx4 v14, s[8:11], s75 offen offset:0  lds
    buffer_load_dwordx4 v15, s[8:11], s75 offen offset:1024  lds
    s_add_u32 m0, s73, 118784
    s_nop 0
    buffer_load_dwordx4 v12, s[8:11], s3 offen offset:0  lds
    buffer_load_dwordx4 v13, s[8:11], s3 offen offset:1024  lds
    s_add_u32 m0, s73, 126976
    s_nop 0
    buffer_load_dwordx4 v14, s[8:11], s3 offen offset:0  lds
    buffer_load_dwordx4 v15, s[8:11], s3 offen offset:1024  lds
    s_add_u32 s75, s75, 393216
    s_cmp_eq_u32 s75, 6291456
    s_cselect_b32 s75, 0, s75
    s_waitcnt vmcnt(32)
    s_barrier
    s_add_u32 m0, s72, 0
    s_nop 0
    buffer_load_dwordx4 v8, s[4:7], s74 offen offset:0  lds
    buffer_load_dwordx4 v9, s[4:7], s74 offen offset:1024  lds
    buffer_load_dwordx4 v10, s[4:7], s74 offen offset:2048  lds
    buffer_load_dwordx4 v11, s[4:7], s74 offen offset:3072  lds
    s_add_u32 m0, s72, 8192
    s_add_u32 s3, s74, 131072
    buffer_load_dwordx4 v8, s[4:7], s3 offen offset:0  lds
    buffer_load_dwordx4 v9, s[4:7], s3 offen offset:1024  lds
    buffer_load_dwordx4 v10, s[4:7], s3 offen offset:2048  lds
    buffer_load_dwordx4 v11, s[4:7], s3 offen offset:3072  lds
    s_add_u32 s74, s74, 128
    s_and_b32 s74, s74, 2047
    s_add_u32 s3, s75, 196608
    s_add_u32 m0, s73, 65536
    s_nop 0
    buffer_load_dwordx4 v12, s[8:11], s75 offen offset:0  lds
    buffer_load_dwordx4 v13, s[8:11], s75 offen offset:1024  lds
    s_add_u32 m0, s73, 73728
    s_nop 0
    buffer_load_dwordx4 v14, s[8:11], s75 offen offset:0  lds
    buffer_load_dwordx4 v15, s[8:11], s75 offen offset:1024  lds
    s_add_u32 m0, s73, 69632
    s_nop 0
    buffer_load_dwordx4 v12, s[8:11], s3 offen offset:0  lds
    buffer_load_dwordx4 v13, s[8:11], s3 offen offset:1024  lds
    s_add_u32 m0, s73, 77824
    s_nop 0
    buffer_load_dwordx4 v14, s[8:11], s3 offen offset:0  lds
    buffer_load_dwordx4 v15, s[8:11], s3 offen offset:1024  lds
    s_add_u32 s75, s75, 393216
    s_cmp_eq_u32 s75, 6291456
    s_cselect_b32 s75, 0, s75
    s_waitcnt vmcnt(32)
    s_barrier
    s_add_u32 m0, s72, 16384
    s_nop 0
    buffer_load_dwordx4 v8, s[4:7], s74 offen offset:0  lds
    buffer_load_dwordx4 v9, s[4:7], s74 offen offset:1024  lds
    buffer_load_dwordx4 v10, s[4:7], s74 offen offset:2048  lds
    buffer_load_dwordx4 v11, s[4:7], s74 offen offset:3072  lds
    s_add_u32 m0, s72, 24576
    s_add_u32 s3, s74, 131072
    buffer_load_dwordx4 v8, s[4:7], s3 offen offset:0  lds
    buffer_load_dwordx4 v9, s[4:7], s3 offen offset:1024  lds
    buffer_load_dwordx4 v10, s[4:7], s3 offen offset:2048  lds
    buffer_load_dwordx4 v11, s[4:7], s3 offen offset:3072  lds
    s_add_u32 s74, s74, 128
    s_and_b32 s74, s74, 2047
    s_add_u32 s3, s75, 196608
    s_add_u32 m0, s73, 81920
    s_nop 0
    buffer_load_dwordx4 v12, s[8:11], s75 offen offset:0  lds
    buffer_load_dwordx4 v13, s[8:11], s75 offen offset:1024  lds
    s_add_u32 m0, s73, 90112
    s_nop 0
    buffer_load_dwordx4 v14, s[8:11], s75 offen offset:0  lds
    buffer_load_dwordx4 v15, s[8:11], s75 offen offset:1024  lds
    s_add_u32 m0, s73, 86016
    s_nop 0
    buffer_load_dwordx4 v12, s[8:11], s3 offen offset:0  lds
    buffer_load_dwordx4 v13, s[8:11], s3 offen offset:1024  lds
    s_add_u32 m0, s73, 94208
    s_nop 0
    buffer_load_dwordx4 v14, s[8:11], s3 offen offset:0  lds
    buffer_load_dwordx4 v15, s[8:11], s3 offen offset:1024  lds
    s_add_u32 s75, s75, 393216
    s_cmp_eq_u32 s75, 6291456
    s_cselect_b32 s75, 0, s75
    s_waitcnt vmcnt(32)
    s_barrier
    s_add_u32 m0, s72, 32768
    s_nop 0
    buffer_load_dwordx4 v8, s[4:7], s74 offen offset:0  lds
    buffer_load_dwordx4 v9, s[4:7], s74 offen offset:1024  lds
    buffer_load_dwordx4 v10, s[4:7], s74 offen offset:2048  lds
    buffer_load_dwordx4 v11, s[4:7], s74 offen offset:3072  lds
    s_add_u32 m0, s72, 40960
    s_add_u32 s3, s74, 131072
    buffer_load_dwordx4 v8, s[4:7], s3 offen offset:0  lds
    buffer_load_dwordx4 v9, s[4:7], s3 offen offset:1024  lds
    buffer_load_dwordx4 v10, s[4:7], s3 offen offset:2048  lds
    buffer_load_dwordx4 v11, s[4:7], s3 offen offset:3072  lds
    s_add_u32 s74, s74, 128
    s_and_b32 s74, s74, 2047
    s_add_u32 s3, s75, 196608
    s_add_u32 m0, s73, 98304
    s_nop 0
    buffer_load_dwordx4 v12, s[8:11], s75 offen offset:0  lds
    buffer_load_dwordx4 v13, s[8:11], s75 offen offset:1024  lds
    s_add_u32 m0, s73, 106496
    s_nop 0
    buffer_load_dwordx4 v14, s[8:11], s75 offen offset:0  lds
    buffer_load_dwordx4 v15, s[8:11], s75 offen offset:1024  lds
    s_add_u32 m0, s73, 102400
    s_nop 0
    buffer_load_dwordx4 v12, s[8:11], s3 offen offset:0  lds
    buffer_load_dwordx4 v13, s[8:11], s3 offen offset:1024  lds
    s_add_u32 m0, s73, 110592
    s_nop 0
    buffer_load_dwordx4 v14, s[8:11], s3 offen offset:0  lds
    buffer_load_dwordx4 v15, s[8:11], s3 offen offset:1024  lds
    s_add_u32 s75, s75, 393216
    s_cmp_eq_u32 s75, 6291456
    s_cselect_b32 s75, 0, s75
    s_waitcnt vmcnt(32)
    s_barrier
    s_add_u32 m0, s72, 49152
    s_nop 0
    buffer_load_dwordx4 v8, s[4:7], s74 offen offset:0  lds
    buffer_load_dwordx4 v9, s[4:7], s74 offen offset:1024  lds
    buffer_load_dwordx4 v10, s[4:7], s74 offen offset:2048  lds
    buffer_load_dwordx4 v11, s[4:7], s74 offen offset:3072  lds
    s_add_u32 m0, s72, 57344
    s_add_u32 s3, s74, 131072
    buffer_load_dwordx4 v8, s[4:7], s3 offen offset:0  lds
    buffer_load_dwordx4 v9, s[4:7], s3 offen offset:1024  lds
    buffer_load_dwordx4 v10, s[4:7], s3 offen offset:2048  lds
    buffer_load_dwordx4 v11, s[4:7], s3 offen offset:3072  lds
    s_add_u32 s74, s74, 128
    s_and_b32 s74, s74, 2047
    s_add_u32 s3, s75, 196608
    s_add_u32 m0, s73, 114688
    s_nop 0
    buffer_load_dwordx4 v12, s[8:11], s75 offen offset:0  lds
    buffer_load_dwordx4 v13, s[8:11], s75 offen offset:1024  lds
    s_add_u32 m0, s73, 122880
    s_nop 0
    buffer_load_dwordx4 v14, s[8:11], s75 offen offset:0  lds
    buffer_load_dwordx4 v15, s[8:11], s75 offen offset:1024  lds
    s_add_u32 m0, s73, 118784
    s_nop 0
    buffer_load_dwordx4 v12, s[8:11], s3 offen offset:0  lds
    buffer_load_dwordx4 v13, s[8:11], s3 offen offset:1024  lds
    s_add_u32 m0, s73, 126976
    s_nop 0
    buffer_load_dwordx4 v14, s[8:11], s3 offen offset:0  lds
    buffer_load_dwordx4 v15, s[8:11], s3 offen offset:1024  lds
    s_add_u32 s75, s75, 393216
    s_cmp_eq_u32 s75, 6291456
    s_cselect_b32 s75, 0, s75
    s_waitcnt vmcnt(32)
    s_barrier
    s_add_u32 m0, s72, 0
    s_nop 0
    buffer_load_dwordx4 v8, s[4:7], s74 offen offset:0  lds
    buffer_load_dwordx4 v9, s[4:7], s74 offen offset:1024  lds
    buffer_load_dwordx4 v10, s[4:7], s74 offen offset:2048  lds
    buffer_load_dwordx4 v11, s[4:7], s74 offen offset:3072  lds
    s_add_u32 m0, s72, 8192
    s_add_u32 s3, s74, 131072
    buffer_load_dwordx4 v8, s[4:7], s3 offen offset:0  lds
    buffer_load_dwordx4 v9, s[4:7], s3 offen offset:1024  lds
    buffer_load_dwordx4 v10, s[4:7], s3 offen offset:2048  lds
    buffer_load_dwordx4 v11, s[4:7], s3 offen offset:3072  lds
    s_add_u32 s74, s74, 128
    s_and_b32 s74, s74, 2047
    s_add_u32 s3, s75, 196608
    s_add_u32 m0, s73, 65536
    s_nop 0
    buffer_load_dwordx4 v12, s[8:11], s75 offen offset:0  lds
    buffer_load_dwordx4 v13, s[8:11], s75 offen offset:1024  lds
    s_add_u32 m0, s73, 73728
    s_nop 0
    buffer_load_dwordx4 v14, s[8:11], s75 offen offset:0  lds
    buffer_load_dwordx4 v15, s[8:11], s75 offen offset:1024  lds
    s_add_u32 m0, s73, 69632
    s_nop 0
    buffer_load_dwordx4 v12, s[8:11], s3 offen offset:0  lds
    buffer_load_dwordx4 v13, s[8:11], s3 offen offset:1024  lds
    s_add_u32 m0, s73, 77824
    s_nop 0
    buffer_load_dwordx4 v14, s[8:11], s3 offen offset:0  lds
    buffer_load_dwordx4 v15, s[8:11], s3 offen offset:1024  lds
    s_add_u32 s75, s75, 393216
    s_cmp_eq_u32 s75, 6291456
    s_cselect_b32 s75, 0, s75
    s_waitcnt vmcnt(32)
    s_barrier
    s_add_u32 m0, s72, 16384
    s_nop 0
    buffer_load_dwordx4 v8, s[4:7], s74 offen offset:0  lds
    buffer_load_dwordx4 v9, s[4:7], s74 offen offset:1024  lds
    buffer_load_dwordx4 v10, s[4:7], s74 offen offset:2048  lds
    buffer_load_dwordx4 v11, s[4:7], s74 offen offset:3072  lds
    s_add_u32 m0, s72, 24576
    s_add_u32 s3, s74, 131072
    buffer_load_dwordx4 v8, s[4:7], s3 offen offset:0  lds
    buffer_load_dwordx4 v9, s[4:7], s3 offen offset:1024  lds
    buffer_load_dwordx4 v10, s[4:7], s3 offen offset:2048  lds
    buffer_load_dwordx4 v11, s[4:7], s3 offen offset:3072  lds
    s_add_u32 s74, s74, 128
    s_and_b32 s74, s74, 2047
    s_add_u32 s3, s75, 196608
    s_add_u32 m0, s73, 81920
    s_nop 0
    buffer_load_dwordx4 v12, s[8:11], s75 offen offset:0  lds
    buffer_load_dwordx4 v13, s[8:11], s75 offen offset:1024  lds
    s_add_u32 m0, s73, 90112
    s_nop 0
    buffer_load_dwordx4 v14, s[8:11], s75 offen offset:0  lds
    buffer_load_dwordx4 v15, s[8:11], s75 offen offset:1024  lds
    s_add_u32 m0, s73, 86016
    s_nop 0
    buffer_load_dwordx4 v12, s[8:11], s3 offen offset:0  lds
    buffer_load_dwordx4 v13, s[8:11], s3 offen offset:1024  lds
    s_add_u32 m0, s73, 94208
    s_nop 0
    buffer_load_dwordx4 v14, s[8:11], s3 offen offset:0  lds
    buffer_load_dwordx4 v15, s[8:11], s3 offen offset:1024  lds
    s_add_u32 s75, s75, 393216
    s_cmp_eq_u32 s75, 6291456
    s_cselect_b32 s75, 0, s75
    s_waitcnt vmcnt(32)
    s_barrier
    s_add_u32 m0, s72, 32768
    s_nop 0
    buffer_load_dwordx4 v8, s[4:7], s74 offen offset:0  lds
    buffer_load_dwordx4 v9, s[4:7], s74 offen offset:1024  lds
    buffer_load_dwordx4 v10, s[4:7], s74 offen offset:2048  lds
    buffer_load_dwordx4 v11, s[4:7], s74 offen offset:3072  lds
    s_add_u32 m0, s72, 40960
    s_add_u32 s3, s74, 131072
    buffer_load_dwordx4 v8, s[4:7], s3 offen offset:0  lds
    buffer_load_dwordx4 v9, s[4:7], s3 offen offset:1024  lds
    buffer_load_dwordx4 v10, s[4:7], s3 offen offset:2048  lds
    buffer_load_dwordx4 v11, s[4:7], s3 offen offset:3072  lds
    s_add_u32 s74, s74, 128
    s_and_b32 s74, s74, 2047
    s_add_u32 s3, s75, 196608
    s_add_u32 m0, s73, 98304
    s_nop 0
    buffer_load_dwordx4 v12, s[8:11], s75 offen offset:0  lds
    buffer_load_dwordx4 v13, s[8:11], s75 offen offset:1024  lds
    s_add_u32 m0, s73, 106496
    s_nop 0
    buffer_load_dwordx4 v14, s[8:11], s75 offen offset:0  lds
    buffer_load_dwordx4 v15, s[8:11], s75 offen offset:1024  lds
    s_add_u32 m0, s73, 102400
    s_nop 0
    buffer_load_dwordx4 v12, s[8:11], s3 offen offset:0  lds
    buffer_load_dwordx4 v13, s[8:11], s3 offen offset:1024  lds
    s_add_u32 m0, s73, 110592
    s_nop 0
    buffer_load_dwordx4 v14, s[8:11], s3 offen offset:0  lds
    buffer_load_dwordx4 v15, s[8:11], s3 offen offset:1024  lds
    s_add_u32 s75, s75, 393216
    s_cmp_eq_u32 s75, 6291456
    s_cselect_b32 s75, 0, s75
    s_waitcnt vmcnt(32)
    s_barrier
    s_add_u32 m0, s72, 49152
    s_nop 0
    buffer_load_dwordx4 v8, s[4:7], s74 offen offset:0  lds
    buffer_load_dwordx4 v9, s[4:7], s74 offen offset:1024  lds
    buffer_load_dwordx4 v10, s[4:7], s74 offen offset:2048  lds
    buffer_load_dwordx4 v11, s[4:7], s74 offen offset:3072  lds
    s_add_u32 m0, s72, 57344
    s_add_u32 s3, s74, 131072
    buffer_load_dwordx4 v8, s[4:7], s3 offen offset:0  lds
    buffer_load_dwordx4 v9, s[4:7], s3 offen offset:1024  lds
    buffer_load_dwordx4 v10, s[4:7], s3 offen offset:2048  lds
    buffer_load_dwordx4 v11, s[4:7], s3 offen offset:3072  lds
    s_add_u32 s74, s74, 128
    s_and_b32 s74, s74, 2047
    s_add_u32 s3, s75, 196608
    s_add_u32 m0, s73, 114688
    s_nop 0
    buffer_load_dwordx4 v12, s[8:11], s75 offen offset:0  lds
    buffer_load_dwordx4 v13, s[8:11], s75 offen offset:1024  lds
    s_add_u32 m0, s73, 122880
    s_nop 0
    buffer_load_dwordx4 v14, s[8:11], s75 offen offset:0  lds
    buffer_load_dwordx4 v15, s[8:11], s75 offen offset:1024  lds
    s_add_u32 m0, s73, 118784
    s_nop 0
    buffer_load_dwordx4 v12, s[8:11], s3 offen offset:0  lds
    buffer_load_dwordx4 v13, s[8:11], s3 offen offset:1024  lds
    s_add_u32 m0, s73, 126976
    s_nop 0
    buffer_load_dwordx4 v14, s[8:11], s3 offen offset:0  lds
    buffer_load_dwordx4 v15, s[8:11], s3 offen offset:1024  lds
    s_add_u32 s75, s75, 393216
    s_cmp_eq_u32 s75, 6291456
    s_cselect_b32 s75, 0, s75
    s_waitcnt vmcnt(32)
    s_barrier
    s_branch L_join
L_xw:
    s_mov_b32 s16, s60
    s_mov_b32 s17, s61
    s_mov_b32 s18, 256
    s_mov_b32 s19, 0x00020000
    s_mov_b32 s20, s44
    s_mov_b32 s21, s45
    s_mov_b32 s22, 65536
    s_mov_b32 s23, 0x00020000
    v_subrev_u32 v4, 196608, v16
    v_subrev_u32 v5, 196608, v17
    s_add_u32 m0, s73, 140800
    s_nop 0
    buffer_load_dwordx4 v16, s[8:11], s76 offen offset:0  lds
    buffer_load_dwordx4 v17, s[8:11], s76 offen offset:1024  lds
    s_add_u32 m0, s73, 136704
    s_nop 0
    buffer_load_dwordx4 v4, s[8:11], s76 offen offset:0  lds
    buffer_load_dwordx4 v5, s[8:11], s76 offen offset:1024  lds
    v_lshlrev_b32 v3, 4, v1
    s_add_u32 m0, s73, 126976
    s_lshl_b32 s65, s37, 12
    s_add_u32 s65, s65, s73
    s_sub_u32 s65, s65, 4096
    buffer_load_dwordx4 v3, s[20:23], s65 offen offset:0 lds
    buffer_load_dwordx4 v3, s[20:23], s65 offen offset:1024 lds
    v_lshlrev_b32 v3, 4, v1
    s_mov_b32 s12, s62
    s_mov_b32 s13, s63
    s_mov_b32 s14, 268435456
    s_mov_b32 s15, 0x00020000
    s_and_b32 s30, s2, 3
    s_lshl_b32 s30, s30, 2
    s_bfe_u32 s3, s2, 0x20003
    s_add_u32 s30, s30, s3
    s_bfe_u32 s31, s2, 0x10002
    s_lshl_b32 s31, s31, 3
    s_lshr_b32 s3, s2, 5
    s_add_u32 s31, s31, s3
    s_lshl_b32 s88, s31, 1
    s_and_b32 s88, s88, 15
    s_mov_b32 s70, 0
    s_mov_b32 s80, s52
    s_mov_b32 s81, s53
    s_mov_b32 s82, 7340032
    s_mov_b32 s83, 0x00020000
    s_mov_b32 s84, s54
    s_mov_b32 s85, s55
    s_mov_b32 s86, 7340032
    s_mov_b32 s87, 0x00020000
    s_cmp_lt_u32 s2, 224
    s_cselect_b32 s82, s82, 0
    s_cselect_b32 s86, s86, 0
    s_and_b32 s3, s2, 3
    s_lshl_b32 s3, s3, 8
    s_lshl_b32 s65, s38, 6
    s_add_u32 s3, s3, s65
    v_and_b32 v5, 0x38, v1
    v_add_u32 v5, s3, v5
    v_mul_u32_u24 v5, 7168, v5
    v_and_b32 v6, 7, v1
    v_lshl_add_u32 v2, v6, 4, v5
    s_lshr_b32 s77, s2, 2
    s_lshl_b32 s77, s77, 7
    v_and_b32 v5, 1, v1
    v_cmp_eq_u32 vcc, 0, v5
    v_mov_b32 v6, 0xffff0000
    v_mov_b32 v7, 0xffff
    v_cndmask_b32 v6, v6, v7, vcc
    v_bfe_u32 v5, v1, 1, 2
    v_cmp_eq_u32 vcc, 0, v5
    s_nop 1
    v_cndmask_b32 v88, 0, v6, vcc
    v_cmp_eq_u32 vcc, 1, v5
    s_nop 1
    v_cndmask_b32 v89, 0, v6, vcc
    v_cmp_eq_u32 vcc, 2, v5
    s_nop 1
    v_cndmask_b32 v90, 0, v6, vcc
    v_cmp_eq_u32 vcc, 3, v5
    s_nop 1
    v_cndmask_b32 v91, 0, v6, vcc
    v_and_b32 v20, 0x3f803f80, v88
    v_and_b32 v21, 0x3f803f80, v89
    v_and_b32 v22, 0x3f803f80, v90
    v_and_b32 v23, 0x3f803f80, v91
    v_mov_b32 v28, 0x3f803f80
    v_mov_b32 v29, 0x3f803f80
    v_mov_b32 v30, 0x3f803f80
    v_mov_b32 v31, 0x3f803f80
    v_lshrrev_b32 v5, 4, v1
    v_lshlrev_b32 v4, 3, v5
    v_bfe_u32 v6, v1, 2, 2
    v_add_u32 v4, v4, v6
    v_lshlrev_b32 v4, 7, v4
    v_and_b32 v5, 3, v1
    v_lshl_add_u32 v4, v5, 3, v4
    v_add_u32 v4, 65536, v4
    s_and_b32 s3, s38, 1
    s_lshl_b32 s3, s3, 1
    v_bfe_u32 v6, v1, 3, 2
    v_xor_b32 v6, s3, v6
    v_lshl_add_u32 v26, v6, 5, v4
    v_xor_b32 v6, 1, v6
    v_lshl_add_u32 v27, v6, 5, v4
    v_add_u32 v32, 75264, v26
    v_add_u32 v33, 75264, v27
    s_lshl_b32 s3, s37, 4
    s_add_u32 s3, s3, s36
    s_lshl_b32 s3, s3, 10
    s_and_b32 s65, s38, 1
    s_lshl_b32 s65, s65, 9
    s_add_u32 s3, s3, s65
    s_add_u32 s68, s3, 1048576
    s_mov_b32 s79, 0
    v_mov_b32 v34, 0
    s_waitcnt vmcnt(0)
    s_barrier
    s_add_u32 s79, s79, 1
    ds_read_b64_tr_b16 v[144:145], v26 offset:0
    ds_read_b64_tr_b16 v[146:147], v26 offset:512
    ds_read_b64_tr_b16 v[148:149], v26 offset:4096
    ds_read_b64_tr_b16 v[150:151], v26 offset:4608
    ds_read_b64_tr_b16 v[168:169], v27 offset:0
    ds_read_b64_tr_b16 v[170:171], v27 offset:512
    ds_read_b64_tr_b16 v[172:173], v27 offset:4096
    ds_read_b64_tr_b16 v[174:175], v27 offset:4608
    s_waitcnt lgkmcnt(4)
    ds_read_b64_tr_b16 v[152:153], v26 offset:8192
    ds_read_b64_tr_b16 v[154:155], v26 offset:8704
    ds_read_b64_tr_b16 v[156:157], v26 offset:12288
    ds_read_b64_tr_b16 v[158:159], v26 offset:12800
    ds_read_b64_tr_b16 v[176:177], v27 offset:8192
    ds_read_b64_tr_b16 v[178:179], v27 offset:8704
    ds_read_b64_tr_b16 v[180:181], v27 offset:12288
    ds_read_b64_tr_b16 v[182:183], v27 offset:12800
    s_waitcnt lgkmcnt(4)
    ds_read_b64_tr_b16 v[136:137], v32 offset:0
    ds_read_b64_tr_b16 v[138:139], v32 offset:512
    ds_read_b64_tr_b16 v[140:141], v32 offset:4096
    ds_read_b64_tr_b16 v[142:143], v32 offset:4608
    ds_read_b64_tr_b16 v[160:161], v33 offset:0
    ds_read_b64_tr_b16 v[162:163], v33 offset:512
    ds_read_b64_tr_b16 v[164:165], v33 offset:4096
    ds_read_b64_tr_b16 v[166:167], v33 offset:4608
    s_waitcnt lgkmcnt(0)
    s_barrier
    s_add_u32 s79, s79, 1
    v_mfma_f32_16x16x32_bf16 v[112:115], v[28:31], v[136:139], 0
    v_mfma_f32_16x16x32_bf16 v[116:119], v[28:31], v[144:147], 0
    v_mfma_f32_16x16x32_bf16 v[120:123], v[28:31], v[152:155], 0
    v_mfma_f32_16x16x32_bf16 v[124:127], v[28:31], v[160:163], 0
    v_mfma_f32_16x16x32_bf16 v[128:131], v[28:31], v[168:171], 0
    v_mfma_f32_16x16x32_bf16 v[132:135], v[28:31], v[176:179], 0
    v_mfma_f32_16x16x32_bf16 v[112:115], v[28:31], v[140:143], v[112:115]
    v_mfma_f32_16x16x32_bf16 v[116:119], v[28:31], v[148:151], v[116:119]
    v_mfma_f32_16x16x32_bf16 v[120:123], v[28:31], v[156:159], v[120:123]
    v_mfma_f32_16x16x32_bf16 v[124:127], v[28:31], v[164:167], v[124:127]
    v_mfma_f32_16x16x32_bf16 v[128:131], v[28:31], v[172:175], v[128:131]
    v_mfma_f32_16x16x32_bf16 v[132:135], v[28:31], v[180:183], v[132:135]
    v_mov_b32 v36, -1
    v_mov_b32 v37, -1
    v_mov_b32 v38, -1
    v_mov_b32 v39, -1
    s_lshl_b32 s65, s37, 1
    s_add_u32 s65, s65, s38
    s_sub_u32 s65, s65, 2
    s_lshl_b32 s3, s36, 8
    s_add_u32 s3, s3, s65
    s_lshl_b32 s3, s3, 10
    s_add_u32 s3, s3, 12582912
    s_barrier
    s_add_u32 s79, s79, 1
    buffer_store_dwordx4 v[36:39], v3, s[12:15], s3 offen sc1
    s_add_u32 s3, s3, 32768
    buffer_store_dwordx4 v[36:39], v3, s[12:15], s3 offen sc1
    s_add_u32 s3, s3, 32768
    buffer_store_dwordx4 v[36:39], v3, s[12:15], s3 offen sc1
    s_add_u32 s3, s3, 32768
    buffer_store_dwordx4 v[36:39], v3, s[12:15], s3 offen sc1
    s_add_u32 s3, s3, 32768
    buffer_store_dwordx4 v[36:39], v3, s[12:15], s3 offen sc1
    s_add_u32 s3, s3, 32768
    buffer_store_dwordx4 v[36:39], v3, s[12:15], s3 offen sc1
    s_add_u32 s3, s3, 32768
    buffer_store_dwordx4 v[36:39], v3, s[12:15], s3 offen sc1
    s_add_u32 s3, s3, 32768
    buffer_store_dwordx4 v[36:39], v3, s[12:15], s3 offen sc1
    s_add_u32 s3, s3, 32768
    s_barrier
    s_add_u32 s79, s79, 1
    s_lshl_b32 s3, s65, 4
    s_add_u32 s3, s3, s36
    s_mul_i32 s3, s3, 4352
    s_add_u32 s3, s3, 2097152
    buffer_store_dwordx4 v[36:39], v3, s[12:15], s3 offen offset:0 sc1
    buffer_store_dwordx4 v[36:39], v3, s[12:15], s3 offen offset:1024 sc1
    buffer_store_dwordx4 v[36:39], v3, s[12:15], s3 offen offset:2048 sc1
    buffer_store_dwordx4 v[36:39], v3, s[12:15], s3 offen offset:3072 sc1
    s_add_u32 s3, s3, 4096
    s_mov_b64 exec, 0xffff
    buffer_store_dwordx4 v[36:39], v3, s[12:15], s3 offen sc1
    s_mov_b64 exec, -1
    s_lshl_b32 s3, s2, 12
    s_add_u32 s3, s3, s73
    s_add_u32 s3, s3, 8384512
    buffer_store_dwordx4 v[36:39], v3, s[12:15], s3 offen offset:0 sc1
    buffer_store_dwordx4 v[36:39], v3, s[12:15], s3 offen offset:1024 sc1
L_non:
    buffer_load_dword v18, v34, s[16:19], 0 offen sc1
    s_cmp_lt_u32 s79, 14
    s_cbranch_scc0 L_xb5
    s_barrier
    s_add_u32 s79, s79, 1
L_xb5:
    s_cmp_lt_u32 s79, 14
    s_cbranch_scc0 L_xb6
    s_barrier
    s_add_u32 s79, s79, 1
L_xb6:
    s_waitcnt vmcnt(0)
    v_cmp_eq_u32 vcc, 0, v18
    s_nop 1
    v_cndmask_b32 v6, 0, 1, vcc
    v_cmp_ne_u32 vcc, 0, v6
    s_add_u32 s70, s70, 1
    s_cmp_ge_u32 s70, 200000
    s_cbranch_scc1 L_nonok
    s_cmp_lg_u64 vcc, 0
    s_cbranch_scc1 L_non
L_nonok:
    v_and_b32 v5, 16, v1
    v_cmp_eq_u32 vcc, 0, v5
    v_mov_b32 v139, v18
    s_nop 0
    v_cndmask_b32 v136, v124, v112, vcc
    v_cndmask_b32 v137, v128, v116, vcc
    v_cndmask_b32 v138, v132, v120, vcc
    s_mov_b64 exec, 0xffffffff
    buffer_store_dwordx4 v[136:139], v3, s[12:15], s68 offen sc1
    s_mov_b64 exec, -1
    s_cmp_eq_u32 s38, 3
    s_cbranch_scc1 L_xbw
L_xu7:
    s_cmp_ge_u32 s79, 10
    s_cbranch_scc1 L_xe7
    s_barrier
    s_add_u32 s79, s79, 1
    s_branch L_xu7
L_xe7:
    s_lshl_b32 s68, s37, 14
    s_add_u32 s68, s68, 1048576
L_cs:
    s_mov_b32 s3, s68
    buffer_load_dwordx4 v[112:115], v3, s[12:15], s3 offen offset:0 sc1
    buffer_load_dwordx4 v[116:119], v3, s[12:15], s3 offen offset:1024 sc1
    buffer_load_dwordx4 v[120:123], v3, s[12:15], s3 offen offset:2048 sc1
    buffer_load_dwordx4 v[124:127], v3, s[12:15], s3 offen offset:3072 sc1
    s_add_u32 s3, s3, 4096
    buffer_load_dwordx4 v[128:131], v3, s[12:15], s3 offen offset:0 sc1
    buffer_load_dwordx4 v[132:135], v3, s[12:15], s3 offen offset:1024 sc1
    buffer_load_dwordx4 v[136:139], v3, s[12:15], s3 offen offset:2048 sc1
    buffer_load_dwordx4 v[140:143], v3, s[12:15], s3 offen offset:3072 sc1
    s_add_u32 s3, s3, 4096
    s_cmp_lt_u32 s79, 14
    s_cbranch_scc0 L_xb8
    s_barrier
    s_add_u32 s79, s79, 1
L_xb8:
    buffer_load_dwordx4 v[144:147], v3, s[12:15], s3 offen offset:0 sc1
    buffer_load_dwordx4 v[148:151], v3, s[12:15], s3 offen offset:1024 sc1
    buffer_load_dwordx4 v[152:155], v3, s[12:15], s3 offen offset:2048 sc1
    buffer_load_dwordx4 v[156:159], v3, s[12:15], s3 offen offset:3072 sc1
    s_add_u32 s3, s3, 4096
    buffer_load_dwordx4 v[160:163], v3, s[12:15], s3 offen offset:0 sc1
    buffer_load_dwordx4 v[164:167], v3, s[12:15], s3 offen offset:1024 sc1
    buffer_load_dwordx4 v[168:171], v3, s[12:15], s3 offen offset:2048 sc1
    buffer_load_dwordx4 v[172:175], v3, s[12:15], s3 offen offset:3072 sc1
    s_cmp_lt_u32 s79, 14
    s_cbranch_scc0 L_xb9
    s_barrier
    s_add_u32 s79, s79, 1
L_xb9:
    s_cmp_lt_u32 s79, 14
    s_cbranch_scc0 L_xb10
    s_barrier
    s_add_u32 s79, s79, 1
L_xb10:
    s_waitcnt vmcnt(0)
    v_and_b32 v6, v115, v119
    v_or_b32 v7, v115, v119
    v_min3_u32 v6, v6, v123, v127
    v_max3_u32 v7, v7, v123, v127
    v_min3_u32 v6, v6, v131, v135
    v_max3_u32 v7, v7, v131, v135
    v_min3_u32 v6, v6, v139, v143
    v_max3_u32 v7, v7, v139, v143
    v_min3_u32 v6, v6, v147, v151
    v_max3_u32 v7, v7, v147, v151
    v_min3_u32 v6, v6, v155, v159
    v_max3_u32 v7, v7, v155, v159
    v_min3_u32 v6, v6, v163, v167
    v_max3_u32 v7, v7, v163, v167
    v_min3_u32 v6, v6, v171, v175
    v_max3_u32 v7, v7, v171, v175
    v_xor_b32 v6, v6, v18
    v_xor_b32 v7, v7, v18
    v_or_b32 v6, v6, v7
    v_cmp_ne_u32 vcc, 0, v6
    s_add_u32 s70, s70, 1
    s_cmp_ge_u32 s70, 200000
    s_cbranch_scc1 L_csok
    s_cmp_lg_u64 vcc, 0
    s_cbranch_scc1 L_cs
L_csok:
    s_cmp_lt_u32 s79, 14
    s_cbranch_scc0 L_xb11
    s_barrier
    s_add_u32 s79, s79, 1
L_xb11:
    v_pk_add_f32 v[112:113], v[112:113], v[144:145]
    v_add_f32 v114, v114, v146
    v_pk_add_f32 v[116:117], v[116:117], v[148:149]
    v_add_f32 v118, v118, v150
    v_pk_add_f32 v[120:121], v[120:121], v[152:153]
    v_add_f32 v122, v122, v154
    v_pk_add_f32 v[124:125], v[124:125], v[156:157]
    v_add_f32 v126, v126, v158
    v_pk_add_f32 v[128:129], v[128:129], v[160:161]
    v_add_f32 v130, v130, v162
    v_pk_add_f32 v[132:133], v[132:133], v[164:165]
    v_add_f32 v134, v134, v166
    v_pk_add_f32 v[136:137], v[136:137], v[168:169]
    v_add_f32 v138, v138, v170
    v_pk_add_f32 v[140:141], v[140:141], v[172:173]
    v_add_f32 v142, v142, v174
    v_pk_add_f32 v[112:113], v[112:113], v[128:129]
    v_add_f32 v114, v114, v130
    v_pk_add_f32 v[116:117], v[116:117], v[132:133]
    v_add_f32 v118, v118, v134
    v_pk_add_f32 v[120:121], v[120:121], v[136:137]
    v_add_f32 v122, v122, v138
    v_pk_add_f32 v[124:125], v[124:125], v[140:141]
    v_add_f32 v126, v126, v142
    s_cmp_lt_u32 s79, 14
    s_cbranch_scc0 L_xb12
    s_barrier
    s_add_u32 s79, s79, 1
L_xb12:
    v_pk_add_f32 v[112:113], v[112:113], v[120:121]
    v_add_f32 v114, v114, v122
    v_pk_add_f32 v[116:117], v[116:117], v[124:125]
    v_add_f32 v118, v118, v126
    v_pk_add_f32 v[112:113], v[112:113], v[116:117]
    v_add_f32 v114, v114, v118
    v_lshlrev_b32 v5, 2, v1
    v_add_u32 v5, 138240, v5
    ds_write_b32 v5, v112
    ds_write_b32 v5, v113 offset:256
    ds_write_b32 v5, v114 offset:512
    s_branch L_xend
L_xbw:
    s_cmp_lt_u32 s79, 14
    s_cbranch_scc0 L_xb13
    s_barrier
    s_add_u32 s79, s79, 1
L_xb13:
    v_and_b32 v5, 7, v1
    v_lshlrev_b32 v5, 3, v5
    v_add_u32 v6, 139008, v5
    ds_read_b64 v[140:141], v6
    s_lshl_b32 s65, s36, 4
    s_add_u32 s65, s65, s37
    s_lshl_b32 s65, s65, 6
    s_add_u32 s65, s65, 0
    s_lshl_b32 s3, s2, 4
    s_add_u32 s3, s3, 65536
    v_mov_b32 v146, v18
    v_mov_b32 v147, v18
    s_waitcnt lgkmcnt(0)
    v_mov_b32 v144, v141
    v_mov_b32 v145, v140
    s_nop 0
    v_max_u32 v144, v144, v144 quad_perm:[1,0,3,2] row_mask:0xf bank_mask:0xf
    s_nop 1
    v_max_u32 v144, v144, v144 quad_perm:[2,3,0,1] row_mask:0xf bank_mask:0xf
    s_nop 1
    v_max_u32 v144, v144, v144 row_half_mirror row_mask:0xf bank_mask:0xf
    v_cmp_eq_u32 vcc, v144, v141
    v_mov_b32 v141, v18
    s_mov_b64 exec, 0xff
    buffer_store_dwordx2 v[140:141], v5, s[12:15], s65 offen sc1
    s_and_b64 exec, exec, vcc
    buffer_store_dwordx4 v[144:147], v34, s[12:15], s3 offen sc1
    s_mov_b64 exec, -1
L_xu14:
    s_cmp_ge_u32 s79, 10
    s_cbranch_scc1 L_xe14
    s_barrier
    s_add_u32 s79, s79, 1
    s_branch L_xu14
L_xe14:
    s_mov_b32 s68, 65536
    s_lshl_b32 s66, s36, 10
    s_lshl_b32 s67, s30, 10
L_st:
    buffer_load_dwordx4 v[112:115], v3, s[12:15], s68 offen offset:0 sc1
    buffer_load_dwordx4 v[116:119], v3, s[12:15], s68 offen offset:1024 sc1
    buffer_load_dwordx4 v[120:123], v3, s[12:15], s68 offen offset:2048 sc1
    buffer_load_dwordx4 v[124:127], v3, s[12:15], s68 offen offset:3072 sc1
    buffer_load_dwordx4 v[128:131], v3, s[12:15], s66 offen offset:0 sc1
    buffer_load_dwordx4 v[132:135], v3, s[12:15], s67 offen offset:0 sc1
    s_cmp_lt_u32 s79, 14
    s_cbranch_scc0 L_xb15
    s_barrier
    s_add_u32 s79, s79, 1
L_xb15:
    s_cmp_lt_u32 s79, 14
    s_cbranch_scc0 L_xb16
    s_barrier
    s_add_u32 s79, s79, 1
L_xb16:
    s_waitcnt vmcnt(0)
    v_and_b32 v6, v114, v118
    v_or_b32 v7, v114, v118
    v_min3_u32 v6, v6, v122, v126
    v_max3_u32 v7, v7, v122, v126
    v_min3_u32 v6, v6, v129, v131
    v_max3_u32 v7, v7, v129, v131
    v_min3_u32 v6, v6, v133, v135
    v_max3_u32 v7, v7, v133, v135
    v_xor_b32 v6, v6, v18
    v_xor_b32 v7, v7, v18
    v_or_b32 v6, v6, v7
    v_cmp_ne_u32 vcc, 0, v6
    s_add_u32 s70, s70, 1
    s_cmp_ge_u32 s70, 200000
    s_cbranch_scc1 L_stok
    s_cmp_lg_u64 vcc, 0
    s_cbranch_scc1 L_st
L_stok:
    s_cmp_lt_u32 s79, 14
    s_cbranch_scc0 L_xb17
    s_barrier
    s_add_u32 s79, s79, 1
L_xb17:
    v_and_b32 v140, 0xffff0000, v128
    v_and_b32 v141, 0xffff0000, v130
    v_and_b32 v142, 0xffff0000, v132
    v_and_b32 v143, 0xffff0000, v134
    v_rcp_f32 v144, v140
    v_rcp_f32 v145, v141
    v_rcp_f32 v146, v142
    v_rcp_f32 v147, v143
    v_lshlrev_b32 v136, 16, v128
    v_lshlrev_b32 v137, 16, v130
    v_lshlrev_b32 v138, 16, v132
    v_lshlrev_b32 v139, 16, v134
    v_lshrrev_b32 v7, 16, v128
    v_or_b32 v7, v7, v141
    v_lshlrev_b32 v5, 3, v1
    v_add_u32 v5, 135168, v5
    v_lshlrev_b32 v4, 2, v1
    v_add_u32 v4, 136192, v4
    v_fma_f32 v140, -v144, v140, 1.0
    v_fma_f32 v141, -v145, v141, 1.0
    v_fma_f32 v142, -v146, v142, 1.0
    v_fma_f32 v143, -v147, v143, 1.0
    v_fmac_f32 v144, v140, v144
    v_fmac_f32 v145, v141, v145
    v_fmac_f32 v146, v142, v146
    v_fmac_f32 v147, v143, v147
    s_cmp_lt_u32 s79, 14
    s_cbranch_scc0 L_xb18
    s_barrier
    s_add_u32 s79, s79, 1
L_xb18:
    ds_write_b64 v5, v[136:137]
    ds_write_b64 v5, v[144:145] offset:512
    ds_write_b64 v5, v[138:139] offset:1536
    ds_write_b64 v5, v[146:147] offset:2048
    ds_write_b32 v4, v7
    v_cmp_gt_u32 vcc, v116, v112
    s_nop 1
    v_cndmask_b32 v112, v112, v116, vcc
    v_cndmask_b32 v113, v113, v117, vcc
    v_cmp_gt_u32 vcc, v124, v120
    s_nop 1
    v_cndmask_b32 v120, v120, v124, vcc
    v_cndmask_b32 v121, v121, v125, vcc
    v_cmp_gt_u32 vcc, v120, v112
    s_nop 1
    v_cndmask_b32 v112, v112, v120, vcc
    v_cndmask_b32 v113, v113, v121, vcc
    v_mov_b32 v6, v112
    s_cmp_lt_u32 s79, 14
    s_cbranch_scc0 L_xb19
    s_barrier
    s_add_u32 s79, s79, 1
L_xb19:
    v_max_u32 v6, v6, v6 quad_perm:[1,0,3,2] row_mask:0xf bank_mask:0xf
    s_nop 1
    v_max_u32 v6, v6, v6 quad_perm:[2,3,0,1] row_mask:0xf bank_mask:0xf
    s_nop 1
    v_max_u32 v6, v6, v6 row_half_mirror row_mask:0xf bank_mask:0xf
    s_nop 1
    v_max_u32 v6, v6, v6 row_mirror row_mask:0xf bank_mask:0xf
    v_mov_b32 v7, v6
    s_nop 1
    v_permlane16_swap_b32 v6, v7
    v_max_u32 v6, v6, v7
    v_mov_b32 v7, v6
    s_nop 1
    v_permlane32_swap_b32 v6, v7
    v_max_u32 v6, v6, v7
    v_cmp_eq_u32 vcc, v6, v112
    v_mov_b32 v5, 139072
    s_mov_b64 exec, vcc
    ds_write_b128 v5, v[112:115]
    s_mov_b64 exec, -1
L_xend:
    s_waitcnt lgkmcnt(0)
L_xu20:
    s_cmp_ge_u32 s79, 14
    s_cbranch_scc1 L_xe20
    s_barrier
    s_add_u32 s79, s79, 1
    s_branch L_xu20
L_xe20:
L_join:
    s_add_u32 s76, s39, 12
    s_and_b32 s76, s76, 15
    s_mul_i32 s76, s76, 393216
    s_add_u32 m0, s73, 65536
    s_nop 0
    buffer_load_dwordx4 v16, s[8:11], s76 offen offset:0  lds
    buffer_load_dwordx4 v17, s[8:11], s76 offen offset:1024  lds
    s_add_u32 s76, s76, 393216
    s_cmp_eq_u32 s76, 6291456
    s_cselect_b32 s76, 0, s76
    s_add_u32 m0, s73, 73728
    s_nop 0
    buffer_load_dwordx4 v16, s[8:11], s76 offen offset:0  lds
    buffer_load_dwordx4 v17, s[8:11], s76 offen offset:1024  lds
    s_add_u32 s76, s76, 393216
    s_cmp_eq_u32 s76, 6291456
    s_cselect_b32 s76, 0, s76
    s_waitcnt vmcnt(20)
    s_barrier
    v_mov_b32 v5, 139072
    ds_read_b128 v[80:83], v5
    s_and_b32 s65, s2, 3
    s_lshl_b32 s65, s65, 9
    s_lshl_b32 s3, s38, 7
    s_add_u32 s65, s65, s3
    v_lshrrev_b32 v5, 3, v1
    v_lshlrev_b32 v5, 4, v5
    s_waitcnt lgkmcnt(0)
    v_readfirstlane_b32 s33, v80
    v_readfirstlane_b32 s64, v81
    v_mov_b32 v18, v82
    s_and_b32 s34, s33, 0x7ff
    s_sub_u32 s34, 2047, s34
    s_lshl_b32 s3, s34, 11
    s_add_u32 s3, s3, s65
    buffer_load_dwordx4 v[76:79], v5, s[4:7], s3 offen
    s_lshr_b32 s3, s34, 7
    s_cmp_eq_u32 s3, s30
    s_cselect_b32 s35, 1, 0
    s_add_u32 m0, s73, 81920
    s_nop 0
    buffer_load_dwordx4 v16, s[8:11], s76 offen offset:0  lds
    buffer_load_dwordx4 v17, s[8:11], s76 offen offset:1024  lds
    s_add_u32 s76, s76, 393216
    s_cmp_eq_u32 s76, 6291456
    s_cselect_b32 s76, 0, s76
    s_add_u32 m0, s73, 90112
    s_nop 0
    buffer_load_dwordx4 v16, s[8:11], s76 offen offset:0  lds
    buffer_load_dwordx4 v17, s[8:11], s76 offen offset:1024  lds
    s_add_u32 s76, s76, 393216
    s_cmp_eq_u32 s76, 6291456
    s_cselect_b32 s76, 0, s76
    buffer_load_dwordx4 v[128:131], v2, s[80:83], s77 offen nt
    buffer_load_dwordx4 v[160:163], v2, s[84:87], s77 offen nt
    s_add_u32 s77, s77, 7168
    s_waitcnt vmcnt(11)
    s_barrier
    s_add_u32 m0, s73, 98304
    s_nop 0
    buffer_load_dwordx4 v16, s[8:11], s76 offen offset:0  lds
    buffer_load_dwordx4 v17, s[8:11], s76 offen offset:1024  lds
    s_add_u32 s76, s76, 393216
    s_cmp_eq_u32 s76, 6291456
    s_cselect_b32 s76, 0, s76
    s_add_u32 m0, s73, 106496
    s_nop 0
    buffer_load_dwordx4 v16, s[8:11], s76 offen offset:0  lds
    buffer_load_dwordx4 v17, s[8:11], s76 offen offset:1024  lds
    s_add_u32 s76, s76, 393216
    s_cmp_eq_u32 s76, 6291456
    s_cselect_b32 s76, 0, s76
    buffer_load_dwordx4 v[132:135], v2, s[80:83], s77 offen nt
    buffer_load_dwordx4 v[164:167], v2, s[84:87], s77 offen nt
    s_add_u32 s77, s77, 7168
    buffer_load_dwordx4 v[136:139], v2, s[80:83], s77 offen nt
    buffer_load_dwordx4 v[168:171], v2, s[84:87], s77 offen nt
    s_add_u32 s77, s77, 7168
    s_barrier
    s_add_u32 m0, s73, 114688
    s_nop 0
    buffer_load_dwordx4 v16, s[8:11], s76 offen offset:0  lds
    buffer_load_dwordx4 v17, s[8:11], s76 offen offset:1024  lds
    s_add_u32 s76, s76, 393216
    s_cmp_eq_u32 s76, 6291456
    s_cselect_b32 s76, 0, s76
    s_add_u32 m0, s73, 122880
    s_nop 0
    buffer_load_dwordx4 v16, s[8:11], s76 offen offset:0  lds
    buffer_load_dwordx4 v17, s[8:11], s76 offen offset:1024  lds
    s_add_u32 s76, s76, 393216
    s_cmp_eq_u32 s76, 6291456
    s_cselect_b32 s76, 0, s76
    buffer_load_dwordx4 v[140:143], v2, s[80:83], s77 offen nt
    buffer_load_dwordx4 v[172:175], v2, s[84:87], s77 offen nt
    s_add_u32 s77, s77, 7168
    buffer_load_dwordx4 v[144:147], v2, s[80:83], s77 offen nt
    buffer_load_dwordx4 v[176:179], v2, s[84:87], s77 offen nt
    s_add_u32 s77, s77, 7168
    buffer_load_dwordx4 v[148:151], v2, s[80:83], s77 offen nt
    buffer_load_dwordx4 v[180:183], v2, s[84:87], s77 offen nt
    s_add_u32 s77, s77, 7168
    buffer_load_dwordx4 v[152:155], v2, s[80:83], s77 offen nt
    buffer_load_dwordx4 v[184:187], v2, s[84:87], s77 offen nt
    s_add_u32 s77, s77, 7168
    buffer_load_dwordx4 v[156:159], v2, s[80:83], s77 offen nt
    buffer_load_dwordx4 v[188:191], v2, s[84:87], s77 offen nt
    s_add_u32 s77, s77, 7168
    s_waitcnt vmcnt(28)
    s_lshl_b32 s65, s64, 16
    s_and_b32 s66, s64, 0xffff0000
    v_rcp_f32 v6, s66
    v_lshlrev_b32 v80, 16, v76
    v_and_b32 v81, 0xffff0000, v76
    v_lshlrev_b32 v82, 16, v77
    v_and_b32 v83, 0xffff0000, v77
    v_lshlrev_b32 v84, 16, v78
    v_and_b32 v85, 0xffff0000, v78
    v_lshlrev_b32 v86, 16, v79
    v_and_b32 v87, 0xffff0000, v79
    v_fma_f32 v4, -v6, s66, 1.0
    v_fmac_f32 v6, v4, v6
    v_subrev_f32 v80, s65, v80
    v_subrev_f32 v81, s65, v81
    v_subrev_f32 v82, s65, v82
    v_subrev_f32 v83, s65, v83
    v_subrev_f32 v84, s65, v84
    v_subrev_f32 v85, s65, v85
    v_subrev_f32 v86, s65, v86
    v_subrev_f32 v87, s65, v87
    v_cvt_pk_bf16_f32 v80, v80, v80
    v_cvt_pk_bf16_f32 v81, v81, v81
    v_cvt_pk_bf16_f32 v82, v82, v82
    v_cvt_pk_bf16_f32 v83, v83, v83
    v_cvt_pk_bf16_f32 v84, v84, v84
    v_cvt_pk_bf16_f32 v85, v85, v85
    v_cvt_pk_bf16_f32 v86, v86, v86
    v_cvt_pk_bf16_f32 v87, v87, v87
    v_lshlrev_b32 v80, 16, v80
    v_lshlrev_b32 v81, 16, v81
    v_lshlrev_b32 v82, 16, v82
    v_lshlrev_b32 v83, 16, v83
    v_lshlrev_b32 v84, 16, v84
    v_lshlrev_b32 v85, 16, v85
    v_lshlrev_b32 v86, 16, v86
    v_lshlrev_b32 v87, 16, v87
    v_mul_f32 v80, v80, v6
    v_mul_f32 v81, v81, v6
    v_mul_f32 v82, v82, v6
    v_mul_f32 v83, v83, v6
    v_mul_f32 v84, v84, v6
    v_mul_f32 v85, v85, v6
    v_mul_f32 v86, v86, v6
    v_mul_f32 v87, v87, v6
    v_cvt_pk_bf16_f32 v80, v80, v80
    v_cvt_pk_bf16_f32 v81, v81, v81
    v_cvt_pk_bf16_f32 v82, v82, v82
    v_cvt_pk_bf16_f32 v83, v83, v83
    v_cvt_pk_bf16_f32 v84, v84, v84
    v_cvt_pk_bf16_f32 v85, v85, v85
    v_cvt_pk_bf16_f32 v86, v86, v86
    v_cvt_pk_bf16_f32 v87, v87, v87
    v_and_b32 v36, v80, v88
    v_and_b32 v37, v80, v89
    v_and_b32 v38, v80, v90
    v_and_b32 v39, v80, v91
    v_and_b32 v40, v81, v88
    v_and_b32 v41, v81, v89
    v_and_b32 v42, v81, v90
    v_and_b32 v43, v81, v91
    v_and_b32 v44, v82, v88
    v_and_b32 v45, v82, v89
    v_and_b32 v46, v82, v90
    v_and_b32 v47, v82, v91
    v_and_b32 v48, v83, v88
    v_and_b32 v49, v83, v89
    v_and_b32 v50, v83, v90
    v_and_b32 v51, v83, v91
    v_and_b32 v52, v84, v88
    v_and_b32 v53, v84, v89
    v_and_b32 v54, v84, v90
    v_and_b32 v55, v84, v91
    v_and_b32 v56, v85, v88
    v_and_b32 v57, v85, v89
    v_and_b32 v58, v85, v90
    v_and_b32 v59, v85, v91
    v_and_b32 v60, v86, v88
    v_and_b32 v61, v86, v89
    v_and_b32 v62, v86, v90
    v_and_b32 v63, v86, v91
    v_and_b32 v64, v87, v88
    v_and_b32 v65, v87, v89
    v_and_b32 v66, v87, v90
    v_and_b32 v67, v87, v91
    v_lshrrev_b32 v5, 5, v1
    v_and_b32 v6, 7, v1
    v_lshlrev_b32 v6, 1, v6
    v_lshl_add_u32 v6, v5, 4, v6
    v_bfe_u32 v5, v1, 4, 1
    v_add_u32 v6, v6, v5
    v_lshlrev_b32 v108, 4, v6
    s_lshl_b32 s3, s2, 2
    s_add_u32 s3, s3, s38
    s_lshl_b32 s3, s3, 10
    s_add_u32 s78, s3, 6291456
    s_mov_b32 s66, 0x00ff00ff
    s_mov_b32 s67, 0x00ff00ff
    v_mov_b32 v93, v18
    v_mov_b32 v95, v18
    v_mov_b32 v97, v18
    v_mov_b32 v99, v18
    s_mov_b32 s16, s46
    s_mov_b32 s17, s47
    s_mov_b32 s18, 2097152
    s_mov_b32 s19, 0x00020000
    v_lshrrev_b32 v5, 3, v1
    v_lshlrev_b32 v5, 11, v5
    v_lshrrev_b32 v6, 4, v1
    v_lshlrev_b32 v6, 1, v6
    v_and_b32 v7, 7, v1
    v_xor_b32 v6, v6, v7
    v_lshl_add_u32 v5, v6, 4, v5
    s_lshl_b32 s3, s31, 7
    s_lshl_b32 s65, s38, 15
    s_add_u32 s3, s3, s65
    v_add_u32 v110, s3, v5
    v_add_u32 v111, 15360, v110
    s_lshl_b32 s65, s37, 1
    s_add_u32 s65, s65, s38
    s_sub_u32 s65, s65, 2
    s_mul_i32 s68, s65, 69632
    s_add_u32 s68, s68, 2097152
    s_lshl_b32 s69, s65, 13
    s_add_u32 s69, s69, 524288
    v_lshrrev_b32 v5, 4, v1
    v_mul_u32_u24 v28, 4352, v5
    v_and_b32 v6, 15, v1
    v_lshl_add_u32 v28, v6, 4, v28
    s_lshl_b32 s3, s36, 8
    v_add_u32 v28, s3, v28
    v_mul_u32_u24 v29, 4352, v6
    s_lshl_b32 s3, s36, 4
    s_add_u32 s3, s3, 4096
    v_add_u32 v29, s3, v29
    v_lshrrev_b32 v7, 5, v1
    v_and_b32 v5, 1, v5
    v_lshlrev_b32 v30, 8, v7
    v_lshl_add_u32 v30, v6, 4, v30
    v_lshl_add_u32 v30, v5, 3, v30
    s_lshl_b32 s3, s38, 12
    s_add_u32 s3, s3, 132608
    v_add_u32 v30, s3, v30
    v_lshrrev_b32 v7, 4, v1
    s_lshl_b32 s3, s38, 7
    s_add_u32 s3, s3, 148736
    v_lshl_add_u32 v31, v7, 2, s3
    v_cmp_eq_u32 s[90:91], 0, v5
    s_lshl_b32 s71, s36, 9
    s_add_u32 s71, s71, s69
    s_mov_b32 s20, s56
    s_mov_b32 s21, s57
    s_mov_b32 s22, 7340032
    s_mov_b32 s23, 0x00020000
    s_mov_b32 s24, s58
    s_mov_b32 s25, s59
    s_mov_b32 s26, 4194304
    s_mov_b32 s27, 0x00020000
    s_waitcnt vmcnt(22)
    v_mfma_f32_16x16x32_bf16 v[100:103], v[36:39], v[128:131], 0
    v_mfma_f32_16x16x32_bf16 v[104:107], v[36:39], v[160:163], 0
    s_waitcnt vmcnt(16)
    v_mfma_f32_16x16x32_bf16 v[100:103], v[40:43], v[132:135], v[100:103]
    v_mfma_f32_16x16x32_bf16 v[104:107], v[40:43], v[164:167], v[104:107]
    s_waitcnt vmcnt(14)
    v_mfma_f32_16x16x32_bf16 v[100:103], v[44:47], v[136:139], v[100:103]
    v_mfma_f32_16x16x32_bf16 v[104:107], v[44:47], v[168:171], v[104:107]
    s_waitcnt vmcnt(10)
    s_cmp_ge_u32 s38, 2
    s_cbranch_scc1 L_xw2
    s_barrier
    s_barrier
    s_add_u32 m0, s72, 0
    s_nop 0
    buffer_load_dwordx4 v8, s[4:7], s74 offen offset:0  lds
    buffer_load_dwordx4 v9, s[4:7], s74 offen offset:1024  lds
    buffer_load_dwordx4 v10, s[4:7], s74 offen offset:2048  lds
    buffer_load_dwordx4 v11, s[4:7], s74 offen offset:3072  lds
    s_add_u32 m0, s72, 8192
    s_add_u32 s3, s74, 131072
    buffer_load_dwordx4 v8, s[4:7], s3 offen offset:0  lds
    buffer_load_dwordx4 v9, s[4:7], s3 offen offset:1024  lds
    buffer_load_dwordx4 v10, s[4:7], s3 offen offset:2048  lds
    buffer_load_dwordx4 v11, s[4:7], s3 offen offset:3072  lds
    s_add_u32 s74, s74, 128
    s_and_b32 s74, s74, 2047
    s_add_u32 m0, s73, 65536
    s_nop 0
    buffer_load_dwordx4 v16, s[8:11], s76 offen offset:0  lds
    buffer_load_dwordx4 v17, s[8:11], s76 offen offset:1024  lds
    s_add_u32 m0, s73, 69632
    s_add_u32 s3, s76, 196608
    buffer_load_dwordx4 v16, s[8:11], s3 offen offset:0  lds
    buffer_load_dwordx4 v17, s[8:11], s3 offen offset:1024  lds
    s_add_u32 s76, s76, 393216
    s_cmp_eq_u32 s76, 6291456
    s_cselect_b32 s76, 0, s76
    s_barrier
    s_add_u32 m0, s72, 16384
    s_nop 0
    buffer_load_dwordx4 v8, s[4:7], s74 offen offset:0  lds
    buffer_load_dwordx4 v9, s[4:7], s74 offen offset:1024  lds
    buffer_load_dwordx4 v10, s[4:7], s74 offen offset:2048  lds
    buffer_load_dwordx4 v11, s[4:7], s74 offen offset:3072  lds
    s_add_u32 m0, s72, 24576
    s_add_u32 s3, s74, 131072
    buffer_load_dwordx4 v8, s[4:7], s3 offen offset:0  lds
    buffer_load_dwordx4 v9, s[4:7], s3 offen offset:1024  lds
    buffer_load_dwordx4 v10, s[4:7], s3 offen offset:2048  lds
    buffer_load_dwordx4 v11, s[4:7], s3 offen offset:3072  lds
    s_add_u32 s74, s74, 128
    s_and_b32 s74, s74, 2047
    s_add_u32 m0, s73, 73728
    s_nop 0
    buffer_load_dwordx4 v16, s[8:11], s76 offen offset:0  lds
    buffer_load_dwordx4 v17, s[8:11], s76 offen offset:1024  lds
    s_add_u32 m0, s73, 77824
    s_add_u32 s3, s76, 196608
    buffer_load_dwordx4 v16, s[8:11], s3 offen offset:0  lds
    buffer_load_dwordx4 v17, s[8:11], s3 offen offset:1024  lds
    s_add_u32 s76, s76, 393216
    s_cmp_eq_u32 s76, 6291456
    s_cselect_b32 s76, 0, s76
    s_barrier
    s_add_u32 m0, s72, 32768
    s_nop 0
    buffer_load_dwordx4 v8, s[4:7], s74 offen offset:0  lds
    buffer_load_dwordx4 v9, s[4:7], s74 offen offset:1024  lds
    buffer_load_dwordx4 v10, s[4:7], s74 offen offset:2048  lds
    buffer_load_dwordx4 v11, s[4:7], s74 offen offset:3072  lds
    s_add_u32 m0, s72, 40960
    s_add_u32 s3, s74, 131072
    buffer_load_dwordx4 v8, s[4:7], s3 offen offset:0  lds
    buffer_load_dwordx4 v9, s[4:7], s3 offen offset:1024  lds
    buffer_load_dwordx4 v10, s[4:7], s3 offen offset:2048  lds
    buffer_load_dwordx4 v11, s[4:7], s3 offen offset:3072  lds
    s_add_u32 s74, s74, 128
    s_and_b32 s74, s74, 2047
    s_add_u32 m0, s73, 81920
    s_nop 0
    buffer_load_dwordx4 v16, s[8:11], s76 offen offset:0  lds
    buffer_load_dwordx4 v17, s[8:11], s76 offen offset:1024  lds
    s_add_u32 m0, s73, 86016
    s_add_u32 s3, s76, 196608
    buffer_load_dwordx4 v16, s[8:11], s3 offen offset:0  lds
    buffer_load_dwordx4 v17, s[8:11], s3 offen offset:1024  lds
    s_add_u32 s76, s76, 393216
    s_cmp_eq_u32 s76, 6291456
    s_cselect_b32 s76, 0, s76
    s_waitcnt vmcnt(28)
    s_barrier
    v_mfma_f32_16x16x32_bf16 v[100:103], v[48:51], v[140:143], v[100:103]
    v_mfma_f32_16x16x32_bf16 v[104:107], v[48:51], v[172:175], v[104:107]
    s_add_u32 m0, s72, 49152
    s_nop 0
    buffer_load_dwordx4 v8, s[4:7], s74 offen offset:0  lds
    buffer_load_dwordx4 v9, s[4:7], s74 offen offset:1024  lds
    buffer_load_dwordx4 v10, s[4:7], s74 offen offset:2048  lds
    buffer_load_dwordx4 v11, s[4:7], s74 offen offset:3072  lds
    s_add_u32 m0, s72, 57344
    s_add_u32 s3, s74, 131072
    buffer_load_dwordx4 v8, s[4:7], s3 offen offset:0  lds
    buffer_load_dwordx4 v9, s[4:7], s3 offen offset:1024  lds
    buffer_load_dwordx4 v10, s[4:7], s3 offen offset:2048  lds
    buffer_load_dwordx4 v11, s[4:7], s3 offen offset:3072  lds
    s_add_u32 s74, s74, 128
    s_and_b32 s74, s74, 2047
    s_add_u32 m0, s73, 90112
    s_nop 0
    buffer_load_dwordx4 v16, s[8:11], s76 offen offset:0  lds
    buffer_load_dwordx4 v17, s[8:11], s76 offen offset:1024  lds
    s_add_u32 m0, s73, 94208
    s_add_u32 s3, s76, 196608
    buffer_load_dwordx4 v16, s[8:11], s3 offen offset:0  lds
    buffer_load_dwordx4 v17, s[8:11], s3 offen offset:1024  lds
    s_add_u32 s76, s76, 393216
    s_cmp_eq_u32 s76, 6291456
    s_cselect_b32 s76, 0, s76
    s_waitcnt vmcnt(28)
    s_barrier
    v_mfma_f32_16x16x32_bf16 v[100:103], v[52:55], v[144:147], v[100:103]
    v_mfma_f32_16x16x32_bf16 v[104:107], v[52:55], v[176:179], v[104:107]
    s_add_u32 m0, s72, 0
    s_nop 0
    buffer_load_dwordx4 v8, s[4:7], s74 offen offset:0  lds
    buffer_load_dwordx4 v9, s[4:7], s74 offen offset:1024  lds
    buffer_load_dwordx4 v10, s[4:7], s74 offen offset:2048  lds
    buffer_load_dwordx4 v11, s[4:7], s74 offen offset:3072  lds
    s_add_u32 m0, s72, 8192
    s_add_u32 s3, s74, 131072
    buffer_load_dwordx4 v8, s[4:7], s3 offen offset:0  lds
    buffer_load_dwordx4 v9, s[4:7], s3 offen offset:1024  lds
    buffer_load_dwordx4 v10, s[4:7], s3 offen offset:2048  lds
    buffer_load_dwordx4 v11, s[4:7], s3 offen offset:3072  lds
    s_add_u32 s74, s74, 128
    s_and_b32 s74, s74, 2047
    s_add_u32 m0, s73, 98304
    s_nop 0
    buffer_load_dwordx4 v16, s[8:11], s76 offen offset:0  lds
    buffer_load_dwordx4 v17, s[8:11], s76 offen offset:1024  lds
    s_add_u32 m0, s73, 102400
    s_add_u32 s3, s76, 196608
    buffer_load_dwordx4 v16, s[8:11], s3 offen offset:0  lds
    buffer_load_dwordx4 v17, s[8:11], s3 offen offset:1024  lds
    s_add_u32 s76, s76, 393216
    s_cmp_eq_u32 s76, 6291456
    s_cselect_b32 s76, 0, s76
    s_waitcnt vmcnt(28)
    s_barrier
    v_mfma_f32_16x16x32_bf16 v[100:103], v[56:59], v[148:151], v[100:103]
    v_mfma_f32_16x16x32_bf16 v[104:107], v[56:59], v[180:183], v[104:107]
    s_add_u32 m0, s72, 16384
    s_nop 0
    buffer_load_dwordx4 v8, s[4:7], s74 offen offset:0  lds
    buffer_load_dwordx4 v9, s[4:7], s74 offen offset:1024  lds
    buffer_load_dwordx4 v10, s[4:7], s74 offen offset:2048  lds
    buffer_load_dwordx4 v11, s[4:7], s74 offen offset:3072  lds
    s_add_u32 m0, s72, 24576
    s_add_u32 s3, s74, 131072
    buffer_load_dwordx4 v8, s[4:7], s3 offen offset:0  lds
    buffer_load_dwordx4 v9, s[4:7], s3 offen offset:1024  lds
    buffer_load_dwordx4 v10, s[4:7], s3 offen offset:2048  lds
    buffer_load_dwordx4 v11, s[4:7], s3 offen offset:3072  lds
    s_add_u32 s74, s74, 128
    s_and_b32 s74, s74, 2047
    s_add_u32 m0, s73, 106496
    s_nop 0
    buffer_load_dwordx4 v16, s[8:11], s76 offen offset:0  lds
    buffer_load_dwordx4 v17, s[8:11], s76 offen offset:1024  lds
    s_add_u32 m0, s73, 110592
    s_add_u32 s3, s76, 196608
    buffer_load_dwordx4 v16, s[8:11], s3 offen offset:0  lds
    buffer_load_dwordx4 v17, s[8:11], s3 offen offset:1024  lds
    s_add_u32 s76, s76, 393216
    s_cmp_eq_u32 s76, 6291456
    s_cselect_b32 s76, 0, s76
    s_waitcnt vmcnt(28)
    s_barrier
    v_mfma_f32_16x16x32_bf16 v[100:103], v[60:63], v[152:155], v[100:103]
    v_mfma_f32_16x16x32_bf16 v[104:107], v[60:63], v[184:187], v[104:107]
    s_add_u32 m0, s72, 32768
    s_nop 0
    buffer_load_dwordx4 v8, s[4:7], s74 offen offset:0  lds
    buffer_load_dwordx4 v9, s[4:7], s74 offen offset:1024  lds
    buffer_load_dwordx4 v10, s[4:7], s74 offen offset:2048  lds
    buffer_load_dwordx4 v11, s[4:7], s74 offen offset:3072  lds
    s_add_u32 m0, s72, 40960
    s_add_u32 s3, s74, 131072
    buffer_load_dwordx4 v8, s[4:7], s3 offen offset:0  lds
    buffer_load_dwordx4 v9, s[4:7], s3 offen offset:1024  lds
    buffer_load_dwordx4 v10, s[4:7], s3 offen offset:2048  lds
    buffer_load_dwordx4 v11, s[4:7], s3 offen offset:3072  lds
    s_add_u32 s74, s74, 128
    s_and_b32 s74, s74, 2047
    s_add_u32 m0, s73, 114688
    s_nop 0
    buffer_load_dwordx4 v16, s[8:11], s76 offen offset:0  lds
    buffer_load_dwordx4 v17, s[8:11], s76 offen offset:1024  lds
    s_add_u32 m0, s73, 118784
    s_add_u32 s3, s76, 196608
    buffer_load_dwordx4 v16, s[8:11], s3 offen offset:0  lds
    buffer_load_dwordx4 v17, s[8:11], s3 offen offset:1024  lds
    s_add_u32 s76, s76, 393216
    s_cmp_eq_u32 s76, 6291456
    s_cselect_b32 s76, 0, s76
    s_waitcnt vmcnt(28)
    s_barrier
    v_mfma_f32_16x16x32_bf16 v[100:103], v[64:67], v[156:159], v[100:103]
    v_mfma_f32_16x16x32_bf16 v[104:107], v[64:67], v[188:191], v[104:107]
    s_add_u32 m0, s72, 49152
    s_nop 0
    buffer_load_dwordx4 v8, s[4:7], s74 offen offset:0  lds
    buffer_load_dwordx4 v9, s[4:7], s74 offen offset:1024  lds
    buffer_load_dwordx4 v10, s[4:7], s74 offen offset:2048  lds
    buffer_load_dwordx4 v11, s[4:7], s74 offen offset:3072  lds
    s_add_u32 m0, s72, 57344
    s_add_u32 s3, s74, 131072
    buffer_load_dwordx4 v8, s[4:7], s3 offen offset:0  lds
    buffer_load_dwordx4 v9, s[4:7], s3 offen offset:1024  lds
    buffer_load_dwordx4 v10, s[4:7], s3 offen offset:2048  lds
    buffer_load_dwordx4 v11, s[4:7], s3 offen offset:3072  lds
    s_add_u32 s74, s74, 128
    s_and_b32 s74, s74, 2047
    s_add_u32 m0, s73, 122880
    s_nop 0
    buffer_load_dwordx4 v16, s[8:11], s76 offen offset:0  lds
    buffer_load_dwordx4 v17, s[8:11], s76 offen offset:1024  lds
    s_add_u32 m0, s73, 126976
    s_add_u32 s3, s76, 196608
    buffer_load_dwordx4 v16, s[8:11], s3 offen offset:0  lds
    buffer_load_dwordx4 v17, s[8:11], s3 offen offset:1024  lds
    s_add_u32 s76, s76, 393216
    s_cmp_eq_u32 s76, 6291456
    s_cselect_b32 s76, 0, s76
    s_waitcnt vmcnt(28)
    s_barrier
    s_add_u32 m0, s72, 0
    s_nop 0
    buffer_load_dwordx4 v8, s[4:7], s74 offen offset:0  lds
    buffer_load_dwordx4 v9, s[4:7], s74 offen offset:1024  lds
    buffer_load_dwordx4 v10, s[4:7], s74 offen offset:2048  lds
    buffer_load_dwordx4 v11, s[4:7], s74 offen offset:3072  lds
    s_add_u32 m0, s72, 8192
    s_add_u32 s3, s74, 131072
    buffer_load_dwordx4 v8, s[4:7], s3 offen offset:0  lds
    buffer_load_dwordx4 v9, s[4:7], s3 offen offset:1024  lds
    buffer_load_dwordx4 v10, s[4:7], s3 offen offset:2048  lds
    buffer_load_dwordx4 v11, s[4:7], s3 offen offset:3072  lds
    s_add_u32 s74, s74, 128
    s_and_b32 s74, s74, 2047
    s_add_u32 m0, s73, 65536
    s_add_u32 s3, s88, 8
    s_and_b32 s3, s3, 15
    s_lshl_b32 s3, s3, 17
    buffer_load_dwordx4 v110, s[16:19], s3 offen offset:0  lds
    buffer_load_dwordx4 v111, s[16:19], s3 offen offset:1024  lds
    s_add_u32 m0, s73, 69632
    s_add_u32 s3, s3, 65536
    buffer_load_dwordx4 v110, s[16:19], s3 offen offset:0  lds
    buffer_load_dwordx4 v111, s[16:19], s3 offen offset:1024  lds
    s_waitcnt vmcnt(28)
    s_barrier
    s_add_u32 m0, s72, 16384
    s_nop 0
    buffer_load_dwordx4 v8, s[4:7], s74 offen offset:0  lds
    buffer_load_dwordx4 v9, s[4:7], s74 offen offset:1024  lds
    buffer_load_dwordx4 v10, s[4:7], s74 offen offset:2048  lds
    buffer_load_dwordx4 v11, s[4:7], s74 offen offset:3072  lds
    s_add_u32 m0, s72, 24576
    s_add_u32 s3, s74, 131072
    buffer_load_dwordx4 v8, s[4:7], s3 offen offset:0  lds
    buffer_load_dwordx4 v9, s[4:7], s3 offen offset:1024  lds
    buffer_load_dwordx4 v10, s[4:7], s3 offen offset:2048  lds
    buffer_load_dwordx4 v11, s[4:7], s3 offen offset:3072  lds
    s_add_u32 s74, s74, 128
    s_and_b32 s74, s74, 2047
    s_add_u32 m0, s73, 73728
    s_add_u32 s3, s88, 9
    s_and_b32 s3, s3, 15
    s_lshl_b32 s3, s3, 17
    buffer_load_dwordx4 v110, s[16:19], s3 offen offset:0  lds
    buffer_load_dwordx4 v111, s[16:19], s3 offen offset:1024  lds
    s_add_u32 m0, s73, 77824
    s_add_u32 s3, s3, 65536
    buffer_load_dwordx4 v110, s[16:19], s3 offen offset:0  lds
    buffer_load_dwordx4 v111, s[16:19], s3 offen offset:1024  lds
    s_waitcnt vmcnt(28)
    s_barrier
    s_add_u32 m0, s72, 32768
    s_nop 0
    buffer_load_dwordx4 v8, s[4:7], s74 offen offset:0  lds
    buffer_load_dwordx4 v9, s[4:7], s74 offen offset:1024  lds
    buffer_load_dwordx4 v10, s[4:7], s74 offen offset:2048  lds
    buffer_load_dwordx4 v11, s[4:7], s74 offen offset:3072  lds
    s_add_u32 m0, s72, 40960
    s_add_u32 s3, s74, 131072
    buffer_load_dwordx4 v8, s[4:7], s3 offen offset:0  lds
    buffer_load_dwordx4 v9, s[4:7], s3 offen offset:1024  lds
    buffer_load_dwordx4 v10, s[4:7], s3 offen offset:2048  lds
    buffer_load_dwordx4 v11, s[4:7], s3 offen offset:3072  lds
    s_add_u32 s74, s74, 128
    s_and_b32 s74, s74, 2047
    s_add_u32 m0, s73, 81920
    s_add_u32 s3, s88, 10
    s_and_b32 s3, s3, 15
    s_lshl_b32 s3, s3, 17
    buffer_load_dwordx4 v110, s[16:19], s3 offen offset:0  lds
    buffer_load_dwordx4 v111, s[16:19], s3 offen offset:1024  lds
    s_add_u32 m0, s73, 86016
    s_add_u32 s3, s3, 65536
    buffer_load_dwordx4 v110, s[16:19], s3 offen offset:0  lds
    buffer_load_dwordx4 v111, s[16:19], s3 offen offset:1024  lds
    s_waitcnt vmcnt(28)
    s_barrier
    s_add_u32 m0, s72, 49152
    s_nop 0
    buffer_load_dwordx4 v8, s[4:7], s74 offen offset:0  lds
    buffer_load_dwordx4 v9, s[4:7], s74 offen offset:1024  lds
    buffer_load_dwordx4 v10, s[4:7], s74 offen offset:2048  lds
    buffer_load_dwordx4 v11, s[4:7], s74 offen offset:3072  lds
    s_add_u32 m0, s72, 57344
    s_add_u32 s3, s74, 131072
    buffer_load_dwordx4 v8, s[4:7], s3 offen offset:0  lds
    buffer_load_dwordx4 v9, s[4:7], s3 offen offset:1024  lds
    buffer_load_dwordx4 v10, s[4:7], s3 offen offset:2048  lds
    buffer_load_dwordx4 v11, s[4:7], s3 offen offset:3072  lds
    s_add_u32 s74, s74, 128
    s_and_b32 s74, s74, 2047
    v_permlane32_swap_b32 v100, v104
    v_permlane32_swap_b32 v101, v105
    v_permlane32_swap_b32 v102, v106
    v_permlane32_swap_b32 v103, v107
    v_add_f32 v92, v104, v100 row_ror:8 row_mask:0xf bank_mask:0xf
    v_add_f32 v94, v105, v101 row_ror:8 row_mask:0xf bank_mask:0xf
    v_add_f32 v96, v106, v102 row_ror:8 row_mask:0xf bank_mask:0xf
    v_add_f32 v98, v107, v103 row_ror:8 row_mask:0xf bank_mask:0xf
    s_mov_b64 exec, s[66:67]
    buffer_store_dwordx4 v[92:95], v108, s[12:15], s78 offen offset:0 sc1
    buffer_store_dwordx4 v[96:99], v108, s[12:15], s78 offen offset:512 sc1
    s_mov_b64 exec, -1
    s_add_u32 m0, s73, 90112
    s_add_u32 s3, s88, 11
    s_and_b32 s3, s3, 15
    s_lshl_b32 s3, s3, 17
    buffer_load_dwordx4 v110, s[16:19], s3 offen offset:0  lds
    buffer_load_dwordx4 v111, s[16:19], s3 offen offset:1024  lds
    s_add_u32 m0, s73, 94208
    s_add_u32 s3, s3, 65536
    buffer_load_dwordx4 v110, s[16:19], s3 offen offset:0  lds
    buffer_load_dwordx4 v111, s[16:19], s3 offen offset:1024  lds
    s_waitcnt vmcnt(30)
    s_barrier
    s_add_u32 m0, s73, 98304
    s_add_u32 s3, s88, 12
    s_and_b32 s3, s3, 15
    s_lshl_b32 s3, s3, 17
    buffer_load_dwordx4 v110, s[16:19], s3 offen offset:0  lds
    buffer_load_dwordx4 v111, s[16:19], s3 offen offset:1024  lds
    s_add_u32 m0, s73, 102400
    s_add_u32 s3, s3, 65536
    buffer_load_dwordx4 v110, s[16:19], s3 offen offset:0  lds
    buffer_load_dwordx4 v111, s[16:19], s3 offen offset:1024  lds
    s_add_u32 m0, s73, 0
    s_add_u32 s3, s88, 0
    s_and_b32 s3, s3, 15
    s_lshl_b32 s3, s3, 17
    buffer_load_dwordx4 v110, s[16:19], s3 offen offset:0  lds
    buffer_load_dwordx4 v111, s[16:19], s3 offen offset:1024  lds
    s_add_u32 m0, s73, 4096
    s_add_u32 s3, s3, 65536
    buffer_load_dwordx4 v110, s[16:19], s3 offen offset:0  lds
    buffer_load_dwordx4 v111, s[16:19], s3 offen offset:1024  lds
    s_add_u32 m0, s73, 8192
    s_add_u32 s3, s88, 1
    s_and_b32 s3, s3, 15
    s_lshl_b32 s3, s3, 17
    buffer_load_dwordx4 v110, s[16:19], s3 offen offset:0  lds
    buffer_load_dwordx4 v111, s[16:19], s3 offen offset:1024  lds
    s_add_u32 m0, s73, 12288
    s_add_u32 s3, s3, 65536
    buffer_load_dwordx4 v110, s[16:19], s3 offen offset:0  lds
    buffer_load_dwordx4 v111, s[16:19], s3 offen offset:1024  lds
    s_waitcnt vmcnt(30)
    s_waitcnt vmcnt(18)
    s_barrier
    s_add_u32 m0, s73, 106496
    s_add_u32 s3, s88, 13
    s_and_b32 s3, s3, 15
    s_lshl_b32 s3, s3, 17
    buffer_load_dwordx4 v110, s[16:19], s3 offen offset:0  lds
    buffer_load_dwordx4 v111, s[16:19], s3 offen offset:1024  lds
    s_add_u32 m0, s73, 110592
    s_add_u32 s3, s3, 65536
    buffer_load_dwordx4 v110, s[16:19], s3 offen offset:0  lds
    buffer_load_dwordx4 v111, s[16:19], s3 offen offset:1024  lds
    s_add_u32 m0, s73, 16384
    s_add_u32 s3, s88, 2
    s_and_b32 s3, s3, 15
    s_lshl_b32 s3, s3, 17
    buffer_load_dwordx4 v110, s[16:19], s3 offen offset:0  lds
    buffer_load_dwordx4 v111, s[16:19], s3 offen offset:1024  lds
    s_add_u32 m0, s73, 20480
    s_add_u32 s3, s3, 65536
    buffer_load_dwordx4 v110, s[16:19], s3 offen offset:0  lds
    buffer_load_dwordx4 v111, s[16:19], s3 offen offset:1024  lds
    s_add_u32 m0, s73, 24576
    s_add_u32 s3, s88, 3
    s_and_b32 s3, s3, 15
    s_lshl_b32 s3, s3, 17
    buffer_load_dwordx4 v110, s[16:19], s3 offen offset:0  lds
    buffer_load_dwordx4 v111, s[16:19], s3 offen offset:1024  lds
    s_add_u32 m0, s73, 28672
    s_add_u32 s3, s3, 65536
    buffer_load_dwordx4 v110, s[16:19], s3 offen offset:0  lds
    buffer_load_dwordx4 v111, s[16:19], s3 offen offset:1024  lds
    s_barrier
    s_add_u32 m0, s73, 32768
    s_add_u32 s3, s88, 4
    s_and_b32 s3, s3, 15
    s_lshl_b32 s3, s3, 17
    buffer_load_dwordx4 v110, s[16:19], s3 offen offset:0  lds
    buffer_load_dwordx4 v111, s[16:19], s3 offen offset:1024  lds
    s_add_u32 m0, s73, 36864
    s_add_u32 s3, s3, 65536
    buffer_load_dwordx4 v110, s[16:19], s3 offen offset:0  lds
    buffer_load_dwordx4 v111, s[16:19], s3 offen offset:1024  lds
    s_add_u32 m0, s73, 40960
    s_add_u32 s3, s88, 5
    s_and_b32 s3, s3, 15
    s_lshl_b32 s3, s3, 17
    buffer_load_dwordx4 v110, s[16:19], s3 offen offset:0  lds
    buffer_load_dwordx4 v111, s[16:19], s3 offen offset:1024  lds
    s_add_u32 m0, s73, 45056
    s_add_u32 s3, s3, 65536
    buffer_load_dwordx4 v110, s[16:19], s3 offen offset:0  lds
    buffer_load_dwordx4 v111, s[16:19], s3 offen offset:1024  lds
    s_add_u32 m0, s73, 49152
    s_add_u32 s3, s88, 6
    s_and_b32 s3, s3, 15
    s_lshl_b32 s3, s3, 17
    buffer_load_dwordx4 v110, s[16:19], s3 offen offset:0  lds
    buffer_load_dwordx4 v111, s[16:19], s3 offen offset:1024  lds
    s_add_u32 m0, s73, 53248
    s_add_u32 s3, s3, 65536
    buffer_load_dwordx4 v110, s[16:19], s3 offen offset:0  lds
    buffer_load_dwordx4 v111, s[16:19], s3 offen offset:1024  lds
    s_add_u32 m0, s73, 57344
    s_add_u32 s3, s88, 7
    s_and_b32 s3, s3, 15
    s_lshl_b32 s3, s3, 17
    buffer_load_dwordx4 v110, s[16:19], s3 offen offset:0  lds
    buffer_load_dwordx4 v111, s[16:19], s3 offen offset:1024  lds
    s_add_u32 m0, s73, 61440
    s_add_u32 s3, s3, 65536
    buffer_load_dwordx4 v110, s[16:19], s3 offen offset:0  lds
    buffer_load_dwordx4 v111, s[16:19], s3 offen offset:1024  lds
    s_add_u32 m0, s73, 114688
    s_add_u32 s3, s88, 14
    s_and_b32 s3, s3, 15
    s_lshl_b32 s3, s3, 17
    buffer_load_dwordx4 v110, s[16:19], s3 offen offset:0  lds
    buffer_load_dwordx4 v111, s[16:19], s3 offen offset:1024  lds
    s_add_u32 m0, s73, 118784
    s_add_u32 s3, s3, 65536
    buffer_load_dwordx4 v110, s[16:19], s3 offen offset:0  lds
    buffer_load_dwordx4 v111, s[16:19], s3 offen offset:1024  lds
    s_add_u32 m0, s73, 122880
    s_add_u32 s3, s88, 15
    s_and_b32 s3, s3, 15
    s_lshl_b32 s3, s3, 17
    buffer_load_dwordx4 v110, s[16:19], s3 offen offset:0  lds
    buffer_load_dwordx4 v111, s[16:19], s3 offen offset:1024  lds
    s_add_u32 m0, s73, 126976
    s_add_u32 s3, s3, 65536
    buffer_load_dwordx4 v110, s[16:19], s3 offen offset:0  lds
    buffer_load_dwordx4 v111, s[16:19], s3 offen offset:1024  lds
    s_branch L_join2
L_xw2:
    s_mov_b32 s79, 0
    s_barrier
    s_add_u32 s79, s79, 1
    s_barrier
    s_add_u32 s79, s79, 1
    s_barrier
    s_add_u32 s79, s79, 1
    s_barrier
    s_add_u32 s79, s79, 1
    s_barrier
    s_add_u32 s79, s79, 1
    s_waitcnt vmcnt(0)
    v_mfma_f32_16x16x32_bf16 v[100:103], v[48:51], v[140:143], v[100:103]
    v_mfma_f32_16x16x32_bf16 v[104:107], v[48:51], v[172:175], v[104:107]
    v_mfma_f32_16x16x32_bf16 v[100:103], v[52:55], v[144:147], v[100:103]
    v_mfma_f32_16x16x32_bf16 v[104:107], v[52:55], v[176:179], v[104:107]
    s_barrier
    s_add_u32 s79, s79, 1
    v_mfma_f32_16x16x32_bf16 v[100:103], v[56:59], v[148:151], v[100:103]
    v_mfma_f32_16x16x32_bf16 v[104:107], v[56:59], v[180:183], v[104:107]
    v_mfma_f32_16x16x32_bf16 v[100:103], v[60:63], v[152:155], v[100:103]
    v_mfma_f32_16x16x32_bf16 v[104:107], v[60:63], v[184:187], v[104:107]
    s_barrier
    s_add_u32 s79, s79, 1
    v_mfma_f32_16x16x32_bf16 v[100:103], v[64:67], v[156:159], v[100:103]
    v_mfma_f32_16x16x32_bf16 v[104:107], v[64:67], v[188:191], v[104:107]
L_ha:
    s_mov_b32 s3, s68
    buffer_load_dwordx4 v[192:195], v28, s[12:15], s3 offen sc1
    s_add_u32 s3, s3, 17408
    buffer_load_dwordx4 v[196:199], v28, s[12:15], s3 offen sc1
    s_add_u32 s3, s3, 17408
    buffer_load_dwordx4 v[200:203], v28, s[12:15], s3 offen sc1
    s_add_u32 s3, s3, 17408
    buffer_load_dwordx4 v[204:207], v28, s[12:15], s3 offen sc1
    buffer_load_dwordx4 v[208:211], v29, s[12:15], s68 offen sc1
    s_cmp_lt_u32 s79, 16
    s_cbranch_scc0 L_xb28
    s_barrier
    s_add_u32 s79, s79, 1
L_xb28:
    s_cmp_lt_u32 s79, 16
    s_cbranch_scc0 L_xb29
    s_barrier
    s_add_u32 s79, s79, 1
L_xb29:
    s_cmp_lt_u32 s79, 16
    s_cbranch_scc0 L_xb30
    s_barrier
    s_add_u32 s79, s79, 1
L_xb30:
    s_waitcnt vmcnt(0)
    v_max3_u32 v6, v192, v196, v200
    v_max3_u32 v6, v6, v204, v208
    v_cmp_eq_u32 vcc, -1, v6
    s_nop 1
    v_cndmask_b32 v6, 0, 1, vcc
    v_cmp_ne_u32 vcc, 0, v6
    s_add_u32 s70, s70, 1
    s_cmp_ge_u32 s70, 200000
    s_cbranch_scc1 L_haok
    s_cmp_lg_u64 vcc, 0
    s_cbranch_scc1 L_ha
L_haok:
    v_mfma_f32_16x16x32_bf16 v[212:215], v[20:23], v[192:195], 0
    v_mfma_f32_16x16x32_bf16 v[212:215], v[20:23], v[196:199], v[212:215]
    v_mfma_f32_16x16x32_bf16 v[212:215], v[20:23], v[200:203], v[212:215]
    v_mfma_f32_16x16x32_bf16 v[212:215], v[20:23], v[204:207], v[212:215]
    v_add_f32 v208, v208, v208 row_ror:1 row_mask:0xf bank_mask:0xf
    v_add_f32 v209, v209, v209 row_ror:1 row_mask:0xf bank_mask:0xf
    v_add_f32 v210, v210, v210 row_ror:1 row_mask:0xf bank_mask:0xf
    v_add_f32 v211, v211, v211 row_ror:1 row_mask:0xf bank_mask:0xf
    v_add_f32 v208, v208, v208 row_ror:2 row_mask:0xf bank_mask:0xf
    v_add_f32 v209, v209, v209 row_ror:2 row_mask:0xf bank_mask:0xf
    v_add_f32 v210, v210, v210 row_ror:2 row_mask:0xf bank_mask:0xf
    v_add_f32 v211, v211, v211 row_ror:2 row_mask:0xf bank_mask:0xf
    s_cmp_lt_u32 s79, 16
    s_cbranch_scc0 L_xb31
    s_barrier
    s_add_u32 s79, s79, 1
L_xb31:
    v_add_f32 v208, v208, v208 row_ror:4 row_mask:0xf bank_mask:0xf
    v_add_f32 v209, v209, v209 row_ror:4 row_mask:0xf bank_mask:0xf
    v_add_f32 v210, v210, v210 row_ror:4 row_mask:0xf bank_mask:0xf
    v_add_f32 v211, v211, v211 row_ror:4 row_mask:0xf bank_mask:0xf
    v_add_f32 v208, v208, v208 row_ror:8 row_mask:0xf bank_mask:0xf
    v_add_f32 v209, v209, v209 row_ror:8 row_mask:0xf bank_mask:0xf
    v_add_f32 v210, v210, v210 row_ror:8 row_mask:0xf bank_mask:0xf
    v_add_f32 v211, v211, v211 row_ror:8 row_mask:0xf bank_mask:0xf
    v_cvt_pk_bf16_f32 v216, v212, v213
    v_cvt_pk_bf16_f32 v217, v214, v215
    v_mov_b32 v218, v18
    v_cvt_pk_bf16_f32 v208, v208, v209
    v_cvt_pk_bf16_f32 v209, v210, v211
    v_cndmask_b32 v219, v209, v208, s[90:91]
    s_mov_b64 exec, 0xffffffff
    buffer_store_dwordx4 v[216:219], v3, s[12:15], s71 offen sc1
    s_mov_b64 exec, -1
    s_add_u32 s71, s69, 4096
    s_cmp_lt_u32 s79, 16
    s_cbranch_scc0 L_xb32
    s_barrier
    s_add_u32 s79, s79, 1
L_xb32:
    v_permlane32_swap_b32 v100, v104
    v_permlane32_swap_b32 v101, v105
    v_permlane32_swap_b32 v102, v106
    v_permlane32_swap_b32 v103, v107
    v_add_f32 v92, v104, v100 row_ror:8 row_mask:0xf bank_mask:0xf
    v_add_f32 v94, v105, v101 row_ror:8 row_mask:0xf bank_mask:0xf
    v_add_f32 v96, v106, v102 row_ror:8 row_mask:0xf bank_mask:0xf
    v_add_f32 v98, v107, v103 row_ror:8 row_mask:0xf bank_mask:0xf
    s_mov_b64 exec, s[66:67]
    buffer_store_dwordx4 v[92:95], v108, s[12:15], s78 offen offset:0 sc1
    buffer_store_dwordx4 v[96:99], v108, s[12:15], s78 offen offset:512 sc1
    s_mov_b64 exec, -1
    s_cmp_lt_u32 s79, 16
    s_cbranch_scc0 L_xb33
    s_barrier
    s_add_u32 s79, s79, 1
L_xb33:
    s_cmp_lt_u32 s79, 16
    s_cbranch_scc0 L_xb34
    s_barrier
    s_add_u32 s79, s79, 1
L_xb34:
L_hb:
    buffer_load_dwordx4 v[220:223], v3, s[12:15], s69 offen offset:0 sc1
    buffer_load_dwordx4 v[224:227], v3, s[12:15], s69 offen offset:1024 sc1
    buffer_load_dwordx4 v[228:231], v3, s[12:15], s69 offen offset:2048 sc1
    buffer_load_dwordx4 v[232:235], v3, s[12:15], s69 offen offset:3072 sc1
    buffer_load_dwordx4 v[236:239], v3, s[12:15], s71 offen offset:0 sc1
    buffer_load_dwordx4 v[240:243], v3, s[12:15], s71 offen offset:1024 sc1
    buffer_load_dwordx4 v[244:247], v3, s[12:15], s71 offen offset:2048 sc1
    buffer_load_dwordx4 v[248:251], v3, s[12:15], s71 offen offset:3072 sc1
    s_cmp_lt_u32 s79, 16
    s_cbranch_scc0 L_xb35
    s_barrier
    s_add_u32 s79, s79, 1
L_xb35:
    s_cmp_lt_u32 s79, 16
    s_cbranch_scc0 L_xb36
    s_barrier
    s_add_u32 s79, s79, 1
L_xb36:
    s_cmp_lt_u32 s79, 16
    s_cbranch_scc0 L_xb37
    s_barrier
    s_add_u32 s79, s79, 1
L_xb37:
    s_waitcnt vmcnt(0)
    v_and_b32 v6, v222, v226
    v_or_b32 v7, v222, v226
    v_min3_u32 v6, v6, v230, v234
    v_max3_u32 v7, v7, v230, v234
    v_min3_u32 v6, v6, v238, v242
    v_max3_u32 v7, v7, v238, v242
    v_min3_u32 v6, v6, v246, v250
    v_max3_u32 v7, v7, v246, v250
    v_xor_b32 v6, v6, v18
    v_xor_b32 v7, v7, v18
    v_or_b32 v6, v6, v7
    v_cmp_ne_u32 vcc, 0, v6
    s_add_u32 s70, s70, 1
    s_cmp_ge_u32 s70, 200000
    s_cbranch_scc1 L_hbok
    s_cmp_lg_u64 vcc, 0
    s_cbranch_scc1 L_hb
L_hbok:
    s_cmp_lt_u32 s79, 16
    s_cbranch_scc0 L_xb38
    s_barrier
    s_add_u32 s79, s79, 1
L_xb38:
    ds_write_b64 v30, v[220:221] offset:0
    ds_write_b64 v30, v[224:225] offset:512
    ds_write_b64 v30, v[228:229] offset:1024
    ds_write_b64 v30, v[232:233] offset:1536
    ds_write_b64 v30, v[236:237] offset:2048
    ds_write_b64 v30, v[240:241] offset:2560
    ds_write_b64 v30, v[244:245] offset:3072
    ds_write_b64 v30, v[248:249] offset:3584
    s_cmp_lt_u32 s79, 16
    s_cbranch_scc0 L_xb39
    s_barrier
    s_add_u32 s79, s79, 1
L_xb39:
    ds_write_b32 v31, v223 offset:0
    ds_write_b32 v31, v227 offset:16
    ds_write_b32 v31, v231 offset:32
    ds_write_b32 v31, v235 offset:48
    ds_write_b32 v31, v239 offset:64
    ds_write_b32 v31, v243 offset:80
    ds_write_b32 v31, v247 offset:96
    ds_write_b32 v31, v251 offset:112
    s_waitcnt lgkmcnt(0)
L_xu40:
    s_cmp_ge_u32 s79, 16
    s_cbranch_scc1 L_xe40
    s_barrier
    s_add_u32 s79, s79, 1
    s_branch L_xu40
L_xe40:
L_join2:
    s_barrier
    s_cmp_lt_u32 s2, 224
    s_cselect_b32 s22, s22, 0
    v_lshrrev_b32 v5, 4, v1
    v_lshlrev_b32 v5, 11, v5
    v_and_b32 v6, 15, v1
    v_lshl_add_u32 v5, v6, 4, v5
    s_lshl_b32 s3, s2, 15
    s_lshl_b32 s65, s38, 9
    s_add_u32 s3, s3, s65
    buffer_load_dwordx4 v[128:131], v5, s[20:23], s3 offen offset:0 nt
    buffer_load_dwordx4 v[132:135], v5, s[20:23], s3 offen offset:256 nt
    s_add_u32 s3, s3, 8192
    buffer_load_dwordx4 v[136:139], v5, s[20:23], s3 offen offset:0 nt
    buffer_load_dwordx4 v[140:143], v5, s[20:23], s3 offen offset:256 nt
    s_add_u32 s3, s3, 8192
    buffer_load_dwordx4 v[144:147], v5, s[20:23], s3 offen offset:0 nt
    buffer_load_dwordx4 v[148:151], v5, s[20:23], s3 offen offset:256 nt
    s_add_u32 s3, s3, 8192
    buffer_load_dwordx4 v[152:155], v5, s[20:23], s3 offen offset:0 nt
    buffer_load_dwordx4 v[156:159], v5, s[20:23], s3 offen offset:256 nt
    v_lshrrev_b32 v5, 2, v1
    v_lshlrev_b32 v5, 10, v5
    v_and_b32 v6, 3, v1
    v_lshl_add_u32 v5, v6, 4, v5
    s_lshr_b32 s3, s2, 2
    s_lshl_b32 s3, s3, 14
    s_and_b32 s65, s2, 3
    s_lshl_b32 s65, s65, 6
    s_add_u32 s3, s3, s65
    s_add_u32 s3, s3, 6291456
    buffer_load_dwordx4 v[52:55], v5, s[12:15], s3 offen offset:0 sc1
    buffer_load_dwordx4 v[56:59], v5, s[12:15], s3 offen offset:512 sc1
    buffer_load_dwordx4 v[60:63], v5, s[12:15], s3 offen offset:256 sc1
    buffer_load_dwordx4 v[64:67], v5, s[12:15], s3 offen offset:768 sc1
    s_waitcnt vmcnt(0)
L_gu:
    v_xor_b32 v6, v53, v18
    v_xor_b32 v7, v55, v18
    v_or_b32 v6, v6, v7
    v_xor_b32 v7, v57, v18
    v_or_b32 v6, v6, v7
    v_xor_b32 v7, v59, v18
    v_or_b32 v6, v6, v7
    v_xor_b32 v7, v61, v18
    v_or_b32 v6, v6, v7
    v_xor_b32 v7, v63, v18
    v_or_b32 v6, v6, v7
    v_xor_b32 v7, v65, v18
    v_or_b32 v6, v6, v7
    v_xor_b32 v7, v67, v18
    v_or_b32 v6, v6, v7
    v_cmp_ne_u32 vcc, 0, v6
    s_nop 0
    s_cmp_eq_u64 vcc, 0
    s_cbranch_scc1 L_guok
    s_add_u32 s70, s70, 1
    s_cmp_ge_u32 s70, 200000
    s_cbranch_scc1 L_guok
    s_sleep 8
    v_lshrrev_b32 v5, 2, v1
    v_lshlrev_b32 v5, 10, v5
    v_and_b32 v6, 3, v1
    v_lshl_add_u32 v5, v6, 4, v5
    s_lshr_b32 s3, s2, 2
    s_lshl_b32 s3, s3, 14
    s_and_b32 s65, s2, 3
    s_lshl_b32 s65, s65, 6
    s_add_u32 s3, s3, s65
    s_add_u32 s3, s3, 6291456
    buffer_load_dwordx4 v[52:55], v5, s[12:15], s3 offen offset:0 sc1
    buffer_load_dwordx4 v[56:59], v5, s[12:15], s3 offen offset:512 sc1
    buffer_load_dwordx4 v[60:63], v5, s[12:15], s3 offen offset:256 sc1
    buffer_load_dwordx4 v[64:67], v5, s[12:15], s3 offen offset:768 sc1
    s_waitcnt vmcnt(0)
    s_branch L_gu
L_guok:
    v_permlane32_swap_b32 v52, v56
    v_permlane32_swap_b32 v54, v58
    v_permlane32_swap_b32 v60, v64
    v_permlane32_swap_b32 v62, v66
    v_add_f32 v52, v52, v56
    v_add_f32 v54, v54, v58
    v_add_f32 v60, v60, v64
    v_add_f32 v62, v62, v66
    v_permlane16_swap_b32 v52, v54
    s_nop 0
    v_permlane16_swap_b32 v60, v62
    v_add_f32 v52, v52, v54
    v_add_f32 v60, v60, v62
    s_nop 0
    v_add_f32 v52, v52, v52 row_ror:4 row_mask:0xf bank_mask:0xf
    v_add_f32 v60, v60, v60 row_ror:4 row_mask:0xf bank_mask:0xf
    s_nop 0
    v_add_f32 v52, v52, v52 row_ror:8 row_mask:0xf bank_mask:0xf
    v_add_f32 v60, v60, v60 row_ror:8 row_mask:0xf bank_mask:0xf
    v_cvt_pk_bf16_f32 v52, v52, v52
    v_lshlrev_b32 v52, 16, v52
    v_cvt_pk_bf16_f32 v60, v60, v60
    v_lshlrev_b32 v60, 16, v60
    v_mul_f32 v53, 0xbfb8aa3b, v52
    v_exp_f32 v53, v53
    s_nop 0
    v_add_f32 v53, 1.0, v53
    v_rcp_f32 v53, v53
    s_nop 0
    v_mul_f32 v52, v52, v53
    v_cvt_pk_bf16_f32 v52, v52, v52
    v_lshlrev_b32 v52, 16, v52
    v_mul_f32 v52, v52, v60
    v_cvt_pk_bf16_f32 v52, v52, v52
    s_nop 1
    v_mov_b32 v80, v52 quad_perm:[0,0,0,0] row_mask:0xf bank_mask:0xf
    v_mov_b32 v81, v52 quad_perm:[1,1,1,1] row_mask:0xf bank_mask:0xf
    v_mov_b32 v82, v52 quad_perm:[2,2,2,2] row_mask:0xf bank_mask:0xf
    v_mov_b32 v83, v52 quad_perm:[3,3,3,3] row_mask:0xf bank_mask:0xf
    s_waitcnt lgkmcnt(0)
    v_and_b32 v92, v80, v88
    v_and_b32 v93, v80, v89
    v_and_b32 v94, v80, v90
    v_and_b32 v95, v80, v91
    s_nop 1
    v_mfma_f32_16x16x32_bf16 v[100:103], v[92:95], v[128:131], 0
    v_mfma_f32_16x16x32_bf16 v[104:107], v[92:95], v[132:135], 0
    v_and_b32 v96, v81, v88
    v_and_b32 v97, v81, v89
    v_and_b32 v98, v81, v90
    v_and_b32 v99, v81, v91
    s_nop 1
    v_mfma_f32_16x16x32_bf16 v[100:103], v[96:99], v[136:139], v[100:103]
    v_mfma_f32_16x16x32_bf16 v[104:107], v[96:99], v[140:143], v[104:107]
    v_and_b32 v92, v82, v88
    v_and_b32 v93, v82, v89
    v_and_b32 v94, v82, v90
    v_and_b32 v95, v82, v91
    s_nop 1
    v_mfma_f32_16x16x32_bf16 v[100:103], v[92:95], v[144:147], v[100:103]
    v_mfma_f32_16x16x32_bf16 v[104:107], v[92:95], v[148:151], v[104:107]
    v_and_b32 v96, v83, v88
    v_and_b32 v97, v83, v89
    v_and_b32 v98, v83, v90
    v_and_b32 v99, v83, v91
    s_nop 1
    v_mfma_f32_16x16x32_bf16 v[100:103], v[96:99], v[152:155], v[100:103]
    v_mfma_f32_16x16x32_bf16 v[104:107], v[96:99], v[156:159], v[104:107]
    v_and_b32 v5, 15, v1
    v_lshlrev_b32 v5, 5, v5
    v_bfe_u32 v6, v1, 4, 1
    v_lshl_add_u32 v5, v6, 4, v5
    v_lshrrev_b32 v6, 5, v1
    v_lshl_add_u32 v5, v6, 9, v5
    v_cmp_eq_u32 vcc, 0, v6
    s_lshl_b32 s3, s2, 12
    s_lshl_b32 s65, s38, 10
    s_add_u32 s3, s3, s65
    s_add_u32 s3, s3, 8388608
    v_cndmask_b32 v100, v104, v100, vcc
    v_cndmask_b32 v101, v105, v101, vcc
    v_cndmask_b32 v102, v106, v102, vcc
    v_cndmask_b32 v103, v107, v103, vcc
    s_cmp_ge_u32 s2, 224
    s_cbranch_scc1 L_noy
    buffer_store_dwordx4 v[100:103], v5, s[12:15], s3 offen sc1
L_noy:
    s_barrier
    s_cmp_eq_u32 s35, 0
    s_cbranch_scc1 L_done
    s_lshl_b32 s65, s38, 2
    v_lshrrev_b32 v5, 4, v1
    v_add_u32 v5, s65, v5
    v_lshlrev_b32 v5, 12, v5
    v_and_b32 v6, 15, v1
    v_lshl_add_u32 v11, v6, 4, v5
    s_sleep 30
    s_lshl_b32 s3, s31, 8
    s_add_u32 s3, s3, 8388608
    buffer_load_dwordx4 v[128:131], v11, s[12:15], s3 offen sc1
    s_add_u32 s3, s3, 65536
    buffer_load_dwordx4 v[132:135], v11, s[12:15], s3 offen sc1
    s_add_u32 s3, s3, 65536
    buffer_load_dwordx4 v[136:139], v11, s[12:15], s3 offen sc1
    s_add_u32 s3, s3, 65536
    buffer_load_dwordx4 v[140:143], v11, s[12:15], s3 offen sc1
    s_add_u32 s3, s3, 65536
    buffer_load_dwordx4 v[144:147], v11, s[12:15], s3 offen sc1
    s_add_u32 s3, s3, 65536
    buffer_load_dwordx4 v[148:151], v11, s[12:15], s3 offen sc1
    s_add_u32 s3, s3, 65536
    buffer_load_dwordx4 v[152:155], v11, s[12:15], s3 offen sc1
    s_add_u32 s3, s3, 65536
    buffer_load_dwordx4 v[156:159], v11, s[12:15], s3 offen sc1
    s_add_u32 s3, s3, 65536
    buffer_load_dwordx4 v[160:163], v11, s[12:15], s3 offen sc1
    s_add_u32 s3, s3, 65536
    buffer_load_dwordx4 v[164:167], v11, s[12:15], s3 offen sc1
    s_add_u32 s3, s3, 65536
    buffer_load_dwordx4 v[168:171], v11, s[12:15], s3 offen sc1
    s_add_u32 s3, s3, 65536
    buffer_load_dwordx4 v[172:175], v11, s[12:15], s3 offen sc1
    s_add_u32 s3, s3, 65536
    buffer_load_dwordx4 v[176:179], v11, s[12:15], s3 offen sc1
    s_add_u32 s3, s3, 65536
    buffer_load_dwordx4 v[180:183], v11, s[12:15], s3 offen sc1
    s_lshl_b32 s68, s34, 11
    s_lshl_b32 s3, s31, 7
    s_add_u32 s68, s68, s3
    v_lshlrev_b32 v7, 1, v1
    buffer_load_ushort v8, v7, s[4:7], s68 offen
    s_and_b32 s3, s33, 0xfffff800
    s_xor_b32 s65, s3, 0x80000000
    s_not_b32 s66, s3
    s_and_b32 s66, s66, 0xfffff800
    s_bitcmp1_b32 s3, 31
    s_cselect_b32 s3, s65, s66
    v_mov_b32 v5, s3
    v_cvt_pk_bf16_f32 v5, v5, v5
    v_lshlrev_b32 v5, 16, v5
    v_mul_f32 v5, 0xbfb8aa3b, v5
    v_exp_f32 v5, v5
    s_nop 0
    v_add_f32 v5, 1.0, v5
    v_rcp_f32 v5, v5
    s_nop 0
    v_cvt_pk_bf16_f32 v5, v5, v5
    v_lshlrev_b32 v5, 16, v5
    s_lshl_b32 s65, s64, 16
    s_and_b32 s66, s64, 0xffff0000
    v_rcp_f32 v10, s66
    s_nop 0
    v_fma_f32 v4, -v10, s66, 1.0
    v_fmac_f32 v10, v4, v10
    s_waitcnt vmcnt(0)
L_yf:
    v_max_u32 v6, v128, v132
    v_max3_u32 v6, v6, v136, v140
    v_max3_u32 v6, v6, v144, v148
    v_max3_u32 v6, v6, v152, v156
    v_max3_u32 v6, v6, v160, v164
    v_max3_u32 v6, v6, v168, v172
    v_max3_u32 v6, v6, v176, v180
    v_cmp_eq_u32 vcc, -1, v6
    s_nop 1
    v_cndmask_b32 v6, 0, 1, vcc
    v_cmp_ne_u32 vcc, 0, v6
    s_nop 0
    s_cmp_eq_u64 vcc, 0
    s_cbranch_scc1 L_yfok
    s_add_u32 s70, s70, 1
    s_cmp_ge_u32 s70, 200000
    s_cbranch_scc1 L_yfok
    s_sleep 16
    s_lshl_b32 s3, s31, 8
    s_add_u32 s3, s3, 8388608
    buffer_load_dwordx4 v[128:131], v11, s[12:15], s3 offen sc1
    s_add_u32 s3, s3, 65536
    buffer_load_dwordx4 v[132:135], v11, s[12:15], s3 offen sc1
    s_add_u32 s3, s3, 65536
    buffer_load_dwordx4 v[136:139], v11, s[12:15], s3 offen sc1
    s_add_u32 s3, s3, 65536
    buffer_load_dwordx4 v[140:143], v11, s[12:15], s3 offen sc1
    s_add_u32 s3, s3, 65536
    buffer_load_dwordx4 v[144:147], v11, s[12:15], s3 offen sc1
    s_add_u32 s3, s3, 65536
    buffer_load_dwordx4 v[148:151], v11, s[12:15], s3 offen sc1
    s_add_u32 s3, s3, 65536
    buffer_load_dwordx4 v[152:155], v11, s[12:15], s3 offen sc1
    s_add_u32 s3, s3, 65536
    buffer_load_dwordx4 v[156:159], v11, s[12:15], s3 offen sc1
    s_add_u32 s3, s3, 65536
    buffer_load_dwordx4 v[160:163], v11, s[12:15], s3 offen sc1
    s_add_u32 s3, s3, 65536
    buffer_load_dwordx4 v[164:167], v11, s[12:15], s3 offen sc1
    s_add_u32 s3, s3, 65536
    buffer_load_dwordx4 v[168:171], v11, s[12:15], s3 offen sc1
    s_add_u32 s3, s3, 65536
    buffer_load_dwordx4 v[172:175], v11, s[12:15], s3 offen sc1
    s_add_u32 s3, s3, 65536
    buffer_load_dwordx4 v[176:179], v11, s[12:15], s3 offen sc1
    s_add_u32 s3, s3, 65536
    buffer_load_dwordx4 v[180:183], v11, s[12:15], s3 offen sc1
    s_waitcnt vmcnt(0)
    s_branch L_yf
L_yfok:
    v_and_b32 v6, 15, v1
    v_pk_add_f32 v[128:129], v[128:129], v[136:137]
    v_pk_add_f32 v[130:131], v[130:131], v[138:139]
    v_pk_add_f32 v[132:133], v[132:133], v[140:141]
    v_pk_add_f32 v[134:135], v[134:135], v[142:143]
    v_pk_add_f32 v[128:129], v[128:129], v[144:145]
    v_pk_add_f32 v[130:131], v[130:131], v[146:147]
    v_pk_add_f32 v[132:133], v[132:133], v[148:149]
    v_pk_add_f32 v[134:135], v[134:135], v[150:151]
    v_pk_add_f32 v[128:129], v[128:129], v[152:153]
    v_pk_add_f32 v[130:131], v[130:131], v[154:155]
    v_pk_add_f32 v[132:133], v[132:133], v[156:157]
    v_pk_add_f32 v[134:135], v[134:135], v[158:159]
    v_pk_add_f32 v[128:129], v[128:129], v[160:161]
    v_pk_add_f32 v[130:131], v[130:131], v[162:163]
    v_pk_add_f32 v[132:133], v[132:133], v[164:165]
    v_pk_add_f32 v[134:135], v[134:135], v[166:167]
    v_pk_add_f32 v[128:129], v[128:129], v[168:169]
    v_pk_add_f32 v[130:131], v[130:131], v[170:171]
    v_pk_add_f32 v[132:133], v[132:133], v[172:173]
    v_pk_add_f32 v[134:135], v[134:135], v[174:175]
    v_pk_add_f32 v[128:129], v[128:129], v[176:177]
    v_pk_add_f32 v[130:131], v[130:131], v[178:179]
    v_pk_add_f32 v[132:133], v[132:133], v[180:181]
    v_pk_add_f32 v[134:135], v[134:135], v[182:183]
    v_pk_add_f32 v[128:129], v[128:129], v[132:133]
    v_pk_add_f32 v[130:131], v[130:131], v[134:135]
    v_mov_b32 v132, v128
    v_mov_b32 v133, v129
    v_mov_b32 v134, v130
    v_mov_b32 v135, v131
    v_permlane16_swap_b32 v128, v132
    v_permlane16_swap_b32 v129, v133
    v_permlane16_swap_b32 v130, v134
    v_permlane16_swap_b32 v131, v135
    v_pk_add_f32 v[128:129], v[128:129], v[132:133]
    v_pk_add_f32 v[130:131], v[130:131], v[134:135]
    v_mov_b32 v132, v128
    v_mov_b32 v133, v129
    v_mov_b32 v134, v130
    v_mov_b32 v135, v131
    v_permlane32_swap_b32 v128, v132
    v_permlane32_swap_b32 v129, v133
    v_permlane32_swap_b32 v130, v134
    v_permlane32_swap_b32 v131, v135
    v_pk_add_f32 v[128:129], v[128:129], v[132:133]
    v_pk_add_f32 v[130:131], v[130:131], v[134:135]
    s_lshl_b32 s3, s38, 8
    s_add_u32 s3, s3, 139264
    v_lshl_add_u32 v6, v6, 4, s3
    ds_write_b128 v6, v[128:131]
    v_lshlrev_b32 v8, 16, v8
    v_subrev_f32 v9, s65, v8
    v_cvt_pk_bf16_f32 v9, v9, v9
    v_lshlrev_b32 v9, 16, v9
    v_mul_f32 v9, v9, v10
    v_cvt_pk_bf16_f32 v9, v9, v9
    v_lshlrev_b32 v9, 16, v9
    v_lshlrev_b32 v6, 2, v1
    v_add_u32 v6, 139264, v6
    s_waitcnt lgkmcnt(0)
    s_barrier
    s_cmp_lg_u32 s38, 0
    s_cbranch_scc1 L_done
    ds_read_b32 v12, v6 offset:0
    ds_read_b32 v13, v6 offset:256
    ds_read_b32 v14, v6 offset:512
    ds_read_b32 v15, v6 offset:768
    ds_read_b32 v16, v6 offset:1024
    s_waitcnt lgkmcnt(0)
    v_add_f32 v12, v12, v13
    v_add_f32 v14, v14, v15
    v_add_f32 v12, v12, v14
    v_cvt_pk_bf16_f32 v12, v12, v12
    v_lshlrev_b32 v12, 16, v12
    v_mul_f32 v12, v12, v5
    v_cvt_pk_bf16_f32 v12, v12, v12
    v_lshlrev_b32 v12, 16, v12
    v_add_f32 v12, v12, v9
    v_cvt_pk_bf16_f32 v12, v12, v12
    v_lshlrev_b32 v12, 16, v12
    v_mul_f32 v13, 0xbfb8aa3b, v12
    v_exp_f32 v13, v13
    s_nop 0
    v_add_f32 v13, 1.0, v13
    v_rcp_f32 v13, v13
    s_nop 0
    v_mul_f32 v12, v12, v13
    v_fmac_f32 v8, v12, v16
    v_cvt_pk_bf16_f32 v8, v8, v8
    buffer_store_short v8, v7, s[24:27], s68 offen
L_done:
    s_endpgm
L_g1:
    s_and_b32 s28, s38, 1
    s_lshr_b32 s29, s38, 1
    s_lshl_b32 s3, s36, 7
    s_lshl_b32 s65, s37, 3
    s_add_u32 s3, s3, s65
    s_lshl_b32 s65, s38, 1
    s_add_u32 s68, s3, s65
    s_lshl_b32 s3, s68, 11
    v_and_b32 v3, 31, v1
    v_lshlrev_b32 v3, 4, v3
    v_lshrrev_b32 v4, 5, v1
    v_lshl_add_u32 v5, v4, 11, v3
    s_waitcnt lgkmcnt(0)
    s_mov_b32 s4, s40
    s_mov_b32 s5, s41
    s_mov_b32 s6, 4194304
    s_mov_b32 s7, 0x00020000
    s_mov_b32 s16, s50
    s_mov_b32 s17, s51
    s_mov_b32 s18, 2048
    s_mov_b32 s19, 0x00020000
    buffer_load_dwordx4 v[200:203], v5, s[4:7], s3 offen offset:0
    buffer_load_dwordx4 v[204:207], v5, s[4:7], s3 offen offset:512
    buffer_load_dwordx4 v[208:211], v5, s[4:7], s3 offen offset:1024
    buffer_load_dwordx4 v[212:215], v5, s[4:7], s3 offen offset:1536
    buffer_load_dwordx4 v[216:219], v3, s[16:19], 0 offen offset:0
    buffer_load_dwordx4 v[220:223], v3, s[16:19], 0 offen offset:512
    buffer_load_dwordx4 v[224:227], v3, s[16:19], 0 offen offset:1024
    buffer_load_dwordx4 v[228:231], v3, s[16:19], 0 offen offset:1536
    s_or_b32 s3, s2, s38
    s_cmp_lg_u32 s3, 0
    s_cbranch_scc1 L_nn
    s_mov_b32 s20, s60
    s_mov_b32 s21, s61
    s_mov_b32 s22, 256
    s_mov_b32 s23, 0x00020000
    s_memrealtime s[66:67]
    s_memtime s[70:71]
    s_waitcnt lgkmcnt(0)
    s_lshl_b32 s70, s70, 20
    s_xor_b32 s66, s66, s70
    s_or_b32 s66, s66, 1
    v_mov_b32 v6, s66
    v_mov_b32 v7, 0
    s_mov_b64 exec, 1
    buffer_store_dword v6, v7, s[20:23], 0 offen sc1
    s_mov_b64 exec, -1
L_nn:
    s_getpc_b64 s[66:67]
L_pc:
    s_sub_u32 s66, s66, L_pc-recurrent_scan__linear_kernel_hedgehog__moe_arch_mod__prompt_kernel
    s_subb_u32 s67, s67, 0
    s_lshr_b32 s3, s2, 3
    s_lshl_b32 s3, s3, 2
    s_add_u32 s3, s3, s38
    s_lshl_b32 s3, s3, 6
    s_add_u32 s66, s66, s3
    s_addc_u32 s67, s67, 0
    s_load_dword s71, s[66:67], 0
    s_load_dword s71, s[66:67], 8192
    s_load_dword s71, s[66:67], 16384
    s_load_dword s71, s[66:67], 24576
    s_load_dword s71, s[66:67], 32768
    s_mov_b32 s12, s62
    s_mov_b32 s13, s63
    s_mov_b32 s14, 268435456
    s_mov_b32 s15, 0x00020000
    s_and_b32 s30, s2, 3
    s_lshl_b32 s30, s30, 2
    s_bfe_u32 s3, s2, 0x20003
    s_add_u32 s30, s30, s3
    s_bfe_u32 s31, s2, 0x10002
    s_lshl_b32 s31, s31, 3
    s_lshr_b32 s3, s2, 5
    s_add_u32 s31, s31, s3
    s_lshl_b32 s88, s31, 1
    s_and_b32 s88, s88, 15
    s_mov_b32 s70, 0
    v_and_b32 v3, 15, v1
    v_lshlrev_b32 v6, 7, v3
    s_lshl_b32 s3, s28, 13
    v_add_u32 v6, s3, v6
    v_lshrrev_b32 v3, 1, v3
    v_lshrrev_b32 v2, 4, v1
    v_xor_b32 v3, v3, v2
    v_lshl_add_u32 v168, v3, 4, v6
    v_xor_b32 v3, 4, v3
    v_lshl_add_u32 v169, v3, 4, v6
    v_lshlrev_b32 v6, 3, v2
    v_bfe_u32 v7, v1, 2, 2
    v_add_u32 v6, v6, v7
    v_lshlrev_b32 v6, 7, v6
    v_and_b32 v7, 3, v1
    v_lshl_add_u32 v6, v7, 3, v6
    v_bfe_u32 v7, v1, 3, 2
    s_lshl_b32 s3, s29, 1
    v_xor_b32 v7, s3, v7
    v_add_u32 v6, 65536, v6
    v_lshl_add_u32 v170, v7, 5, v6
    v_xor_b32 v7, 1, v7
    v_lshl_add_u32 v171, v7, 5, v6
    v_mov_b64 v[8:9], 0
    v_mov_b64 v[10:11], 0
    v_mov_b64 v[12:13], 0
    v_mov_b64 v[14:15], 0
    v_mov_b64 v[16:17], 0
    v_mov_b64 v[18:19], 0
    v_mov_b64 v[20:21], 0
    v_mov_b64 v[22:23], 0
    v_mov_b64 v[24:25], 0
    v_mov_b64 v[26:27], 0
    v_mov_b64 v[28:29], 0
    v_mov_b64 v[30:31], 0
    v_mov_b64 v[32:33], 0
    v_mov_b64 v[34:35], 0
    v_mov_b64 v[36:37], 0
    v_mov_b64 v[38:39], 0
    v_mov_b64 v[40:41], 0
    v_mov_b64 v[42:43], 0
    v_mov_b64 v[44:45], 0
    v_mov_b64 v[46:47], 0
    v_mov_b64 v[48:49], 0
    v_mov_b64 v[50:51], 0
    v_mov_b64 v[52:53], 0
    v_mov_b64 v[54:55], 0
    v_mov_b64 v[56:57], 0
    v_mov_b64 v[58:59], 0
    v_mov_b64 v[60:61], 0
    v_mov_b64 v[62:63], 0
    v_mov_b64 v[64:65], 0
    v_mov_b64 v[66:67], 0
    v_mov_b64 v[68:69], 0
    v_mov_b64 v[70:71], 0
    v_mov_b64 v[72:73], 0
    v_mov_b64 v[74:75], 0
    v_mov_b64 v[76:77], 0
    v_mov_b64 v[78:79], 0
    v_mov_b64 v[80:81], 0
    v_mov_b64 v[82:83], 0
    v_mov_b64 v[84:85], 0
    v_mov_b64 v[86:87], 0
    v_mov_b64 v[88:89], 0
    v_mov_b64 v[90:91], 0
    v_mov_b64 v[92:93], 0
    v_mov_b64 v[94:95], 0
    v_mov_b64 v[96:97], 0
    v_mov_b64 v[98:99], 0
    v_mov_b64 v[100:101], 0
    v_mov_b64 v[102:103], 0
    v_mov_b64 v[136:137], 0
    v_mov_b64 v[138:139], 0
    v_mov_b64 v[140:141], 0
    v_mov_b64 v[142:143], 0
    v_mov_b64 v[144:145], 0
    v_mov_b64 v[146:147], 0
    v_mov_b64 v[148:149], 0
    v_mov_b64 v[150:151], 0
    v_mov_b64 v[152:153], 0
    v_mov_b64 v[154:155], 0
    v_mov_b64 v[156:157], 0
    v_mov_b64 v[158:159], 0
    v_mov_b64 v[160:161], 0
    v_mov_b64 v[162:163], 0
    v_mov_b64 v[164:165], 0
    v_mov_b64 v[166:167], 0
    v_mov_b32 v236, 0x3f803f80
    v_mov_b32 v232, 0
    v_mov_b32 v233, 0
    v_mov_b32 v234, 0
    v_mov_b32 v235, 0
    s_waitcnt vmcnt(0)
    v_dot2_f32_bf16 v232, v200, v236, v232
    v_dot2_f32_bf16 v233, v200, v200, v233
    v_dot2_f32_bf16 v234, v200, v216, v234
    v_dot2_f32_bf16 v235, v216, v236, v235
    v_dot2_f32_bf16 v232, v201, v236, v232
    v_dot2_f32_bf16 v233, v201, v201, v233
    v_dot2_f32_bf16 v234, v201, v217, v234
    v_dot2_f32_bf16 v235, v217, v236, v235
    v_dot2_f32_bf16 v232, v202, v236, v232
    v_dot2_f32_bf16 v233, v202, v202, v233
    v_dot2_f32_bf16 v234, v202, v218, v234
    v_dot2_f32_bf16 v235, v218, v236, v235
    v_dot2_f32_bf16 v232, v203, v236, v232
    v_dot2_f32_bf16 v233, v203, v203, v233
    v_dot2_f32_bf16 v234, v203, v219, v234
    v_dot2_f32_bf16 v235, v219, v236, v235
    v_dot2_f32_bf16 v232, v204, v236, v232
    v_dot2_f32_bf16 v233, v204, v204, v233
    v_dot2_f32_bf16 v234, v204, v220, v234
    v_dot2_f32_bf16 v235, v220, v236, v235
    v_dot2_f32_bf16 v232, v205, v236, v232
    v_dot2_f32_bf16 v233, v205, v205, v233
    v_dot2_f32_bf16 v234, v205, v221, v234
    v_dot2_f32_bf16 v235, v221, v236, v235
    v_dot2_f32_bf16 v232, v206, v236, v232
    v_dot2_f32_bf16 v233, v206, v206, v233
    v_dot2_f32_bf16 v234, v206, v222, v234
    v_dot2_f32_bf16 v235, v222, v236, v235
    v_dot2_f32_bf16 v232, v207, v236, v232
    v_dot2_f32_bf16 v233, v207, v207, v233
    v_dot2_f32_bf16 v234, v207, v223, v234
    v_dot2_f32_bf16 v235, v223, v236, v235
    v_dot2_f32_bf16 v232, v208, v236, v232
    v_dot2_f32_bf16 v233, v208, v208, v233
    v_dot2_f32_bf16 v234, v208, v224, v234
    v_dot2_f32_bf16 v235, v224, v236, v235
    v_dot2_f32_bf16 v232, v209, v236, v232
    v_dot2_f32_bf16 v233, v209, v209, v233
    v_dot2_f32_bf16 v234, v209, v225, v234
    v_dot2_f32_bf16 v235, v225, v236, v235
    v_dot2_f32_bf16 v232, v210, v236, v232
    v_dot2_f32_bf16 v233, v210, v210, v233
    v_dot2_f32_bf16 v234, v210, v226, v234
    v_dot2_f32_bf16 v235, v226, v236, v235
    v_dot2_f32_bf16 v232, v211, v236, v232
    v_dot2_f32_bf16 v233, v211, v211, v233
    v_dot2_f32_bf16 v234, v211, v227, v234
    v_dot2_f32_bf16 v235, v227, v236, v235
    v_dot2_f32_bf16 v232, v212, v236, v232
    v_dot2_f32_bf16 v233, v212, v212, v233
    v_dot2_f32_bf16 v234, v212, v228, v234
    v_dot2_f32_bf16 v235, v228, v236, v235
    v_dot2_f32_bf16 v232, v213, v236, v232
    v_dot2_f32_bf16 v233, v213, v213, v233
    v_dot2_f32_bf16 v234, v213, v229, v234
    v_dot2_f32_bf16 v235, v229, v236, v235
    v_dot2_f32_bf16 v232, v214, v236, v232
    v_dot2_f32_bf16 v233, v214, v214, v233
    v_dot2_f32_bf16 v234, v214, v230, v234
    v_dot2_f32_bf16 v235, v230, v236, v235
    v_dot2_f32_bf16 v232, v215, v236, v232
    v_dot2_f32_bf16 v233, v215, v215, v233
    v_dot2_f32_bf16 v234, v215, v231, v234
    v_dot2_f32_bf16 v235, v231, v236, v235
    v_add_f32 v232, v232, v232 quad_perm:[1,0,3,2] row_mask:0xf bank_mask:0xf
    v_add_f32 v233, v233, v233 quad_perm:[1,0,3,2] row_mask:0xf bank_mask:0xf
    v_add_f32 v234, v234, v234 quad_perm:[1,0,3,2] row_mask:0xf bank_mask:0xf
    v_add_f32 v235, v235, v235 quad_perm:[1,0,3,2] row_mask:0xf bank_mask:0xf
    v_add_f32 v232, v232, v232 quad_perm:[2,3,0,1] row_mask:0xf bank_mask:0xf
    v_add_f32 v233, v233, v233 quad_perm:[2,3,0,1] row_mask:0xf bank_mask:0xf
    v_add_f32 v234, v234, v234 quad_perm:[2,3,0,1] row_mask:0xf bank_mask:0xf
    v_add_f32 v235, v235, v235 quad_perm:[2,3,0,1] row_mask:0xf bank_mask:0xf
    v_add_f32 v232, v232, v232 row_half_mirror row_mask:0xf bank_mask:0xf
    v_add_f32 v233, v233, v233 row_half_mirror row_mask:0xf bank_mask:0xf
    v_add_f32 v234, v234, v234 row_half_mirror row_mask:0xf bank_mask:0xf
    v_add_f32 v235, v235, v235 row_half_mirror row_mask:0xf bank_mask:0xf
    v_add_f32 v232, v232, v232 row_mirror row_mask:0xf bank_mask:0xf
    v_add_f32 v233, v233, v233 row_mirror row_mask:0xf bank_mask:0xf
    v_add_f32 v234, v234, v234 row_mirror row_mask:0xf bank_mask:0xf
    v_add_f32 v235, v235, v235 row_mirror row_mask:0xf bank_mask:0xf
    v_mov_b32 v236, v232
    v_mov_b32 v237, v233
    v_mov_b32 v238, v234
    v_mov_b32 v239, v235
    v_permlane16_swap_b32 v232, v236
    v_permlane16_swap_b32 v233, v237
    v_permlane16_swap_b32 v234, v238
    v_permlane16_swap_b32 v235, v239
    v_add_f32 v232, v232, v236
    v_add_f32 v233, v233, v237
    v_add_f32 v234, v234, v238
    v_add_f32 v235, v235, v239
    v_mul_f32 v232, 0x3a800000, v232
    v_mul_f32 v233, 0x3a800000, v233
    v_fma_f32 v233, -v232, v232, v233
    v_max_f32 v233, 0, v233
    v_cvt_pk_bf16_f32 v232, v232, v232
    v_lshlrev_b32 v232, 16, v232
    v_cvt_pk_bf16_f32 v233, v233, v233
    v_lshlrev_b32 v233, 16, v233
    v_add_f32 v233, 0x3727c5ac, v233
    v_cvt_pk_bf16_f32 v233, v233, v233
    v_lshlrev_b32 v233, 16, v233
    v_sqrt_f32 v233, v233
    v_fma_f32 v234, -v232, v235, v234
    v_cvt_pk_bf16_f32 v233, v233, v233
    v_lshlrev_b32 v233, 16, v233
    v_rcp_f32 v235, v233
    v_lshrrev_b32 v232, 16, v232
    v_or_b32 v232, v232, v233
    v_mul_f32 v234, v234, v235
    v_ashrrev_i32 v235, 31, v234
    v_or_b32 v235, 0x80000000, v235
    v_xor_b32 v234, v234, v235
    v_and_b32 v234, 0xfffff800, v234
    s_sub_u32 s3, 2047, s68
    v_sub_u32 v235, s3, v4
    v_or_b32 v233, v234, v235
    s_lshl_b32 s3, s38, 4
    s_add_u32 s3, s3, 139008
    v_lshl_add_u32 v235, v4, 3, s3
    ds_write_b64 v235, v[232:233]
    s_mov_b32 s69, 0
.p2align 6
L_c1:
    s_waitcnt lgkmcnt(0)
    s_barrier
    v_mfma_f32_16x16x32_bf16 v[8:11], v[152:155], v[136:139], v[8:11]
    ds_read_b128 v[104:107], v168 offset:0
    v_mfma_f32_16x16x32_bf16 v[12:15], v[156:159], v[136:139], v[12:15]
    ds_read_b64_tr_b16 v[120:121], v170 offset:0
    v_mfma_f32_16x16x32_bf16 v[16:19], v[136:139], v[160:163], v[16:19]
    ds_read_b64_tr_b16 v[122:123], v170 offset:512
    v_mfma_f32_16x16x32_bf16 v[20:23], v[136:139], v[164:167], v[20:23]
    ds_read_b64_tr_b16 v[124:125], v171 offset:0
    v_mfma_f32_16x16x32_bf16 v[24:27], v[152:155], v[140:143], v[24:27]
    ds_read_b64_tr_b16 v[126:127], v171 offset:512
    v_mfma_f32_16x16x32_bf16 v[28:31], v[156:159], v[140:143], v[28:31]
    ds_read_b128 v[108:111], v168 offset:2048
    v_mfma_f32_16x16x32_bf16 v[32:35], v[140:143], v[160:163], v[32:35]
    ds_read_b64_tr_b16 v[128:129], v170 offset:8192
    v_mfma_f32_16x16x32_bf16 v[36:39], v[140:143], v[164:167], v[36:39]
    ds_read_b64_tr_b16 v[130:131], v170 offset:8704
    v_mfma_f32_16x16x32_bf16 v[40:43], v[152:155], v[144:147], v[40:43]
    ds_read_b64_tr_b16 v[132:133], v171 offset:8192
    v_mfma_f32_16x16x32_bf16 v[44:47], v[156:159], v[144:147], v[44:47]
    ds_read_b64_tr_b16 v[134:135], v171 offset:8704
    v_mfma_f32_16x16x32_bf16 v[48:51], v[144:147], v[160:163], v[48:51]
    ds_read_b128 v[112:115], v168 offset:4096
    v_mfma_f32_16x16x32_bf16 v[52:55], v[144:147], v[164:167], v[52:55]
    ds_read_b128 v[116:119], v168 offset:6144
    v_mfma_f32_16x16x32_bf16 v[56:59], v[152:155], v[148:151], v[56:59]
    v_mfma_f32_16x16x32_bf16 v[60:63], v[156:159], v[148:151], v[60:63]
    v_mfma_f32_16x16x32_bf16 v[64:67], v[148:151], v[160:163], v[64:67]
    v_mfma_f32_16x16x32_bf16 v[68:71], v[148:151], v[164:167], v[68:71]
    s_waitcnt lgkmcnt(0)
    v_mfma_f32_16x16x32_bf16 v[8:11], v[120:123], v[104:107], v[8:11]
    ds_read_b128 v[136:139], v169 offset:0
    v_mfma_f32_16x16x32_bf16 v[12:15], v[124:127], v[104:107], v[12:15]
    ds_read_b64_tr_b16 v[152:153], v170 offset:4096
    v_mfma_f32_16x16x32_bf16 v[16:19], v[104:107], v[128:131], v[16:19]
    ds_read_b64_tr_b16 v[154:155], v170 offset:4608
    v_mfma_f32_16x16x32_bf16 v[20:23], v[104:107], v[132:135], v[20:23]
    ds_read_b64_tr_b16 v[156:157], v171 offset:4096
    v_mfma_f32_16x16x32_bf16 v[24:27], v[120:123], v[108:111], v[24:27]
    ds_read_b64_tr_b16 v[158:159], v171 offset:4608
    v_mfma_f32_16x16x32_bf16 v[28:31], v[124:127], v[108:111], v[28:31]
    ds_read_b128 v[140:143], v169 offset:2048
    v_mfma_f32_16x16x32_bf16 v[32:35], v[108:111], v[128:131], v[32:35]
    ds_read_b64_tr_b16 v[160:161], v170 offset:12288
    v_mfma_f32_16x16x32_bf16 v[36:39], v[108:111], v[132:135], v[36:39]
    ds_read_b64_tr_b16 v[162:163], v170 offset:12800
    v_mfma_f32_16x16x32_bf16 v[40:43], v[120:123], v[112:115], v[40:43]
    ds_read_b64_tr_b16 v[164:165], v171 offset:12288
    v_mfma_f32_16x16x32_bf16 v[44:47], v[124:127], v[112:115], v[44:47]
    ds_read_b64_tr_b16 v[166:167], v171 offset:12800
    v_mfma_f32_16x16x32_bf16 v[48:51], v[112:115], v[128:131], v[48:51]
    ds_read_b128 v[144:147], v169 offset:4096
    v_mfma_f32_16x16x32_bf16 v[52:55], v[112:115], v[132:135], v[52:55]
    ds_read_b128 v[148:151], v169 offset:6144
    v_mfma_f32_16x16x32_bf16 v[56:59], v[120:123], v[116:119], v[56:59]
    v_mfma_f32_16x16x32_bf16 v[60:63], v[124:127], v[116:119], v[60:63]
    v_mfma_f32_16x16x32_bf16 v[64:67], v[116:119], v[128:131], v[64:67]
    v_mfma_f32_16x16x32_bf16 v[68:71], v[116:119], v[132:135], v[68:71]
    s_waitcnt lgkmcnt(0)
    s_barrier
    v_mfma_f32_16x16x32_bf16 v[8:11], v[152:155], v[136:139], v[8:11]
    ds_read_b128 v[104:107], v168 offset:16384
    v_mfma_f32_16x16x32_bf16 v[12:15], v[156:159], v[136:139], v[12:15]
    ds_read_b64_tr_b16 v[120:121], v170 offset:16384
    v_mfma_f32_16x16x32_bf16 v[16:19], v[136:139], v[160:163], v[16:19]
    ds_read_b64_tr_b16 v[122:123], v170 offset:16896
    v_mfma_f32_16x16x32_bf16 v[20:23], v[136:139], v[164:167], v[20:23]
    ds_read_b64_tr_b16 v[124:125], v171 offset:16384
    v_mfma_f32_16x16x32_bf16 v[24:27], v[152:155], v[140:143], v[24:27]
    ds_read_b64_tr_b16 v[126:127], v171 offset:16896
    v_mfma_f32_16x16x32_bf16 v[28:31], v[156:159], v[140:143], v[28:31]
    ds_read_b128 v[108:111], v168 offset:18432
    v_mfma_f32_16x16x32_bf16 v[32:35], v[140:143], v[160:163], v[32:35]
    ds_read_b64_tr_b16 v[128:129], v170 offset:24576
    v_mfma_f32_16x16x32_bf16 v[36:39], v[140:143], v[164:167], v[36:39]
    ds_read_b64_tr_b16 v[130:131], v170 offset:25088
    v_mfma_f32_16x16x32_bf16 v[40:43], v[152:155], v[144:147], v[40:43]
    ds_read_b64_tr_b16 v[132:133], v171 offset:24576
    v_mfma_f32_16x16x32_bf16 v[44:47], v[156:159], v[144:147], v[44:47]
    ds_read_b64_tr_b16 v[134:135], v171 offset:25088
    v_mfma_f32_16x16x32_bf16 v[48:51], v[144:147], v[160:163], v[48:51]
    ds_read_b128 v[112:115], v168 offset:20480
    v_mfma_f32_16x16x32_bf16 v[52:55], v[144:147], v[164:167], v[52:55]
    ds_read_b128 v[116:119], v168 offset:22528
    v_mfma_f32_16x16x32_bf16 v[56:59], v[152:155], v[148:151], v[56:59]
    v_mfma_f32_16x16x32_bf16 v[60:63], v[156:159], v[148:151], v[60:63]
    v_mfma_f32_16x16x32_bf16 v[64:67], v[148:151], v[160:163], v[64:67]
    v_mfma_f32_16x16x32_bf16 v[68:71], v[148:151], v[164:167], v[68:71]
    s_waitcnt lgkmcnt(0)
    v_mfma_f32_16x16x32_bf16 v[8:11], v[120:123], v[104:107], v[8:11]
    ds_read_b128 v[136:139], v169 offset:16384
    v_mfma_f32_16x16x32_bf16 v[12:15], v[124:127], v[104:107], v[12:15]
    ds_read_b64_tr_b16 v[152:153], v170 offset:20480
    v_mfma_f32_16x16x32_bf16 v[16:19], v[104:107], v[128:131], v[16:19]
    ds_read_b64_tr_b16 v[154:155], v170 offset:20992
    v_mfma_f32_16x16x32_bf16 v[20:23], v[104:107], v[132:135], v[20:23]
    ds_read_b64_tr_b16 v[156:157], v171 offset:20480
    v_mfma_f32_16x16x32_bf16 v[24:27], v[120:123], v[108:111], v[24:27]
    ds_read_b64_tr_b16 v[158:159], v171 offset:20992
    v_mfma_f32_16x16x32_bf16 v[28:31], v[124:127], v[108:111], v[28:31]
    ds_read_b128 v[140:143], v169 offset:18432
    v_mfma_f32_16x16x32_bf16 v[32:35], v[108:111], v[128:131], v[32:35]
    ds_read_b64_tr_b16 v[160:161], v170 offset:28672
    v_mfma_f32_16x16x32_bf16 v[36:39], v[108:111], v[132:135], v[36:39]
    ds_read_b64_tr_b16 v[162:163], v170 offset:29184
    v_mfma_f32_16x16x32_bf16 v[40:43], v[120:123], v[112:115], v[40:43]
    ds_read_b64_tr_b16 v[164:165], v171 offset:28672
    v_mfma_f32_16x16x32_bf16 v[44:47], v[124:127], v[112:115], v[44:47]
    ds_read_b64_tr_b16 v[166:167], v171 offset:29184
    v_mfma_f32_16x16x32_bf16 v[48:51], v[112:115], v[128:131], v[48:51]
    ds_read_b128 v[144:147], v169 offset:20480
    v_mfma_f32_16x16x32_bf16 v[52:55], v[112:115], v[132:135], v[52:55]
    ds_read_b128 v[148:151], v169 offset:22528
    v_mfma_f32_16x16x32_bf16 v[56:59], v[120:123], v[116:119], v[56:59]
    v_mfma_f32_16x16x32_bf16 v[60:63], v[124:127], v[116:119], v[60:63]
    v_mfma_f32_16x16x32_bf16 v[64:67], v[116:119], v[128:131], v[64:67]
    v_mfma_f32_16x16x32_bf16 v[68:71], v[116:119], v[132:135], v[68:71]
    s_waitcnt lgkmcnt(0)
    s_barrier
    v_mfma_f32_16x16x32_bf16 v[8:11], v[152:155], v[136:139], v[8:11]
    ds_read_b128 v[104:107], v168 offset:32768
    v_mfma_f32_16x16x32_bf16 v[12:15], v[156:159], v[136:139], v[12:15]
    ds_read_b64_tr_b16 v[120:121], v170 offset:32768
    v_mfma_f32_16x16x32_bf16 v[16:19], v[136:139], v[160:163], v[16:19]
    ds_read_b64_tr_b16 v[122:123], v170 offset:33280
    v_mfma_f32_16x16x32_bf16 v[20:23], v[136:139], v[164:167], v[20:23]
    ds_read_b64_tr_b16 v[124:125], v171 offset:32768
    v_mfma_f32_16x16x32_bf16 v[24:27], v[152:155], v[140:143], v[24:27]
    ds_read_b64_tr_b16 v[126:127], v171 offset:33280
    v_mfma_f32_16x16x32_bf16 v[28:31], v[156:159], v[140:143], v[28:31]
    ds_read_b128 v[108:111], v168 offset:34816
    v_mfma_f32_16x16x32_bf16 v[32:35], v[140:143], v[160:163], v[32:35]
    ds_read_b64_tr_b16 v[128:129], v170 offset:40960
    v_mfma_f32_16x16x32_bf16 v[36:39], v[140:143], v[164:167], v[36:39]
    ds_read_b64_tr_b16 v[130:131], v170 offset:41472
    v_mfma_f32_16x16x32_bf16 v[40:43], v[152:155], v[144:147], v[40:43]
    ds_read_b64_tr_b16 v[132:133], v171 offset:40960
    v_mfma_f32_16x16x32_bf16 v[44:47], v[156:159], v[144:147], v[44:47]
    ds_read_b64_tr_b16 v[134:135], v171 offset:41472
    v_mfma_f32_16x16x32_bf16 v[48:51], v[144:147], v[160:163], v[48:51]
    ds_read_b128 v[112:115], v168 offset:36864
    v_mfma_f32_16x16x32_bf16 v[52:55], v[144:147], v[164:167], v[52:55]
    ds_read_b128 v[116:119], v168 offset:38912
    v_mfma_f32_16x16x32_bf16 v[56:59], v[152:155], v[148:151], v[56:59]
    v_mfma_f32_16x16x32_bf16 v[60:63], v[156:159], v[148:151], v[60:63]
    v_mfma_f32_16x16x32_bf16 v[64:67], v[148:151], v[160:163], v[64:67]
    v_mfma_f32_16x16x32_bf16 v[68:71], v[148:151], v[164:167], v[68:71]
    s_waitcnt lgkmcnt(0)
    v_mfma_f32_16x16x32_bf16 v[8:11], v[120:123], v[104:107], v[8:11]
    ds_read_b128 v[136:139], v169 offset:32768
    v_mfma_f32_16x16x32_bf16 v[12:15], v[124:127], v[104:107], v[12:15]
    ds_read_b64_tr_b16 v[152:153], v170 offset:36864
    v_mfma_f32_16x16x32_bf16 v[16:19], v[104:107], v[128:131], v[16:19]
    ds_read_b64_tr_b16 v[154:155], v170 offset:37376
    v_mfma_f32_16x16x32_bf16 v[20:23], v[104:107], v[132:135], v[20:23]
    ds_read_b64_tr_b16 v[156:157], v171 offset:36864
    v_mfma_f32_16x16x32_bf16 v[24:27], v[120:123], v[108:111], v[24:27]
    ds_read_b64_tr_b16 v[158:159], v171 offset:37376
    v_mfma_f32_16x16x32_bf16 v[28:31], v[124:127], v[108:111], v[28:31]
    ds_read_b128 v[140:143], v169 offset:34816
    v_mfma_f32_16x16x32_bf16 v[32:35], v[108:111], v[128:131], v[32:35]
    ds_read_b64_tr_b16 v[160:161], v170 offset:45056
    v_mfma_f32_16x16x32_bf16 v[36:39], v[108:111], v[132:135], v[36:39]
    ds_read_b64_tr_b16 v[162:163], v170 offset:45568
    v_mfma_f32_16x16x32_bf16 v[40:43], v[120:123], v[112:115], v[40:43]
    ds_read_b64_tr_b16 v[164:165], v171 offset:45056
    v_mfma_f32_16x16x32_bf16 v[44:47], v[124:127], v[112:115], v[44:47]
    ds_read_b64_tr_b16 v[166:167], v171 offset:45568
    v_mfma_f32_16x16x32_bf16 v[48:51], v[112:115], v[128:131], v[48:51]
    ds_read_b128 v[144:147], v169 offset:36864
    v_mfma_f32_16x16x32_bf16 v[52:55], v[112:115], v[132:135], v[52:55]
    ds_read_b128 v[148:151], v169 offset:38912
    v_mfma_f32_16x16x32_bf16 v[56:59], v[120:123], v[116:119], v[56:59]
    v_mfma_f32_16x16x32_bf16 v[60:63], v[124:127], v[116:119], v[60:63]
    v_mfma_f32_16x16x32_bf16 v[64:67], v[116:119], v[128:131], v[64:67]
    v_mfma_f32_16x16x32_bf16 v[68:71], v[116:119], v[132:135], v[68:71]
    s_waitcnt lgkmcnt(0)
    s_barrier
    v_mfma_f32_16x16x32_bf16 v[8:11], v[152:155], v[136:139], v[8:11]
    ds_read_b128 v[104:107], v168 offset:49152
    v_mfma_f32_16x16x32_bf16 v[12:15], v[156:159], v[136:139], v[12:15]
    ds_read_b64_tr_b16 v[120:121], v170 offset:49152
    v_mfma_f32_16x16x32_bf16 v[16:19], v[136:139], v[160:163], v[16:19]
    ds_read_b64_tr_b16 v[122:123], v170 offset:49664
    v_mfma_f32_16x16x32_bf16 v[20:23], v[136:139], v[164:167], v[20:23]
    ds_read_b64_tr_b16 v[124:125], v171 offset:49152
    v_mfma_f32_16x16x32_bf16 v[24:27], v[152:155], v[140:143], v[24:27]
    ds_read_b64_tr_b16 v[126:127], v171 offset:49664
    v_mfma_f32_16x16x32_bf16 v[28:31], v[156:159], v[140:143], v[28:31]
    ds_read_b128 v[108:111], v168 offset:51200
    v_mfma_f32_16x16x32_bf16 v[32:35], v[140:143], v[160:163], v[32:35]
    ds_read_b64_tr_b16 v[128:129], v170 offset:57344
    v_mfma_f32_16x16x32_bf16 v[36:39], v[140:143], v[164:167], v[36:39]
    ds_read_b64_tr_b16 v[130:131], v170 offset:57856
    v_mfma_f32_16x16x32_bf16 v[40:43], v[152:155], v[144:147], v[40:43]
    ds_read_b64_tr_b16 v[132:133], v171 offset:57344
    v_mfma_f32_16x16x32_bf16 v[44:47], v[156:159], v[144:147], v[44:47]
    ds_read_b64_tr_b16 v[134:135], v171 offset:57856
    v_mfma_f32_16x16x32_bf16 v[48:51], v[144:147], v[160:163], v[48:51]
    ds_read_b128 v[112:115], v168 offset:53248
    v_mfma_f32_16x16x32_bf16 v[52:55], v[144:147], v[164:167], v[52:55]
    ds_read_b128 v[116:119], v168 offset:55296
    v_mfma_f32_16x16x32_bf16 v[56:59], v[152:155], v[148:151], v[56:59]
    v_mfma_f32_16x16x32_bf16 v[60:63], v[156:159], v[148:151], v[60:63]
    v_mfma_f32_16x16x32_bf16 v[64:67], v[148:151], v[160:163], v[64:67]
    v_mfma_f32_16x16x32_bf16 v[68:71], v[148:151], v[164:167], v[68:71]
    s_waitcnt lgkmcnt(0)
    v_mfma_f32_16x16x32_bf16 v[8:11], v[120:123], v[104:107], v[8:11]
    ds_read_b128 v[136:139], v169 offset:49152
    v_mfma_f32_16x16x32_bf16 v[12:15], v[124:127], v[104:107], v[12:15]
    ds_read_b64_tr_b16 v[152:153], v170 offset:53248
    v_mfma_f32_16x16x32_bf16 v[16:19], v[104:107], v[128:131], v[16:19]
    ds_read_b64_tr_b16 v[154:155], v170 offset:53760
    v_mfma_f32_16x16x32_bf16 v[20:23], v[104:107], v[132:135], v[20:23]
    ds_read_b64_tr_b16 v[156:157], v171 offset:53248
    v_mfma_f32_16x16x32_bf16 v[24:27], v[120:123], v[108:111], v[24:27]
    ds_read_b64_tr_b16 v[158:159], v171 offset:53760
    v_mfma_f32_16x16x32_bf16 v[28:31], v[124:127], v[108:111], v[28:31]
    ds_read_b128 v[140:143], v169 offset:51200
    v_mfma_f32_16x16x32_bf16 v[32:35], v[108:111], v[128:131], v[32:35]
    ds_read_b64_tr_b16 v[160:161], v170 offset:61440
    v_mfma_f32_16x16x32_bf16 v[36:39], v[108:111], v[132:135], v[36:39]
    ds_read_b64_tr_b16 v[162:163], v170 offset:61952
    v_mfma_f32_16x16x32_bf16 v[40:43], v[120:123], v[112:115], v[40:43]
    ds_read_b64_tr_b16 v[164:165], v171 offset:61440
    v_mfma_f32_16x16x32_bf16 v[44:47], v[124:127], v[112:115], v[44:47]
    ds_read_b64_tr_b16 v[166:167], v171 offset:61952
    v_mfma_f32_16x16x32_bf16 v[48:51], v[112:115], v[128:131], v[48:51]
    ds_read_b128 v[144:147], v169 offset:53248
    v_mfma_f32_16x16x32_bf16 v[52:55], v[112:115], v[132:135], v[52:55]
    ds_read_b128 v[148:151], v169 offset:55296
    v_mfma_f32_16x16x32_bf16 v[56:59], v[120:123], v[116:119], v[56:59]
    v_mfma_f32_16x16x32_bf16 v[60:63], v[124:127], v[116:119], v[60:63]
    v_mfma_f32_16x16x32_bf16 v[64:67], v[116:119], v[128:131], v[64:67]
    v_mfma_f32_16x16x32_bf16 v[68:71], v[116:119], v[132:135], v[68:71]
    s_add_u32 s69, s69, 1
    s_cmp_lt_u32 s69, 4
    s_cbranch_scc1 L_c1
    s_waitcnt lgkmcnt(0)
    s_barrier
    v_and_b32 v3, 15, v1
    s_lshl_b32 s3, s28, 8
    s_add_u32 s3, s3, 135168
    v_lshl_add_u32 v240, v3, 2, s3
    v_lshl_add_u32 v241, v1, 2, s3
    v_lshl_add_u32 v242, v2, 4, s3
    s_lshl_b32 s3, s29, 7
    s_add_u32 s3, s3, 138240
    v_lshl_add_u32 v243, v2, 4, s3
    v_lshl_add_u32 v244, v3, 2, s3
    s_lshl_b32 s3, s28, 7
    s_add_u32 s3, s3, 136192
    v_lshl_add_u32 v245, v2, 3, s3
    v_lshrrev_b32 v6, 2, v1
    v_lshlrev_b32 v6, 6, v6
    v_and_b32 v7, 3, v1
    v_lshl_add_u32 v6, v7, 3, v6
    s_lshl_b32 s3, s29, 11
    s_add_u32 s3, s3, 131072
    v_add_u32 v246, s3, v6
    v_mfma_f32_16x16x32_bf16 v[8:11], v[152:155], v[136:139], v[8:11]
    ds_read_b32 v180, v240 offset:0
    v_mfma_f32_16x16x32_bf16 v[12:15], v[156:159], v[136:139], v[12:15]
    ds_read_b32 v182, v240 offset:64
    v_mfma_f32_16x16x32_bf16 v[16:19], v[136:139], v[160:163], v[16:19]
    ds_read_b32 v184, v240 offset:128
    v_mfma_f32_16x16x32_bf16 v[20:23], v[136:139], v[164:167], v[20:23]
    ds_read_b32 v186, v240 offset:192
    v_mfma_f32_16x16x32_bf16 v[24:27], v[152:155], v[140:143], v[24:27]
    ds_read_b128 v[192:195], v243 offset:256
    v_mfma_f32_16x16x32_bf16 v[28:31], v[156:159], v[140:143], v[28:31]
    ds_read_b128 v[196:199], v243 offset:320
    v_mfma_f32_16x16x32_bf16 v[32:35], v[140:143], v[160:163], v[32:35]
    ds_read_b64_tr_b16 v[172:173], v246 offset:0
    v_mfma_f32_16x16x32_bf16 v[36:39], v[140:143], v[164:167], v[36:39]
    ds_read_b64_tr_b16 v[174:175], v246 offset:1024
    v_mfma_f32_16x16x32_bf16 v[40:43], v[152:155], v[144:147], v[40:43]
    ds_read_b64_tr_b16 v[176:177], v246 offset:32
    v_mfma_f32_16x16x32_bf16 v[44:47], v[156:159], v[144:147], v[44:47]
    ds_read_b64_tr_b16 v[178:179], v246 offset:1056
    v_mfma_f32_16x16x32_bf16 v[48:51], v[144:147], v[160:163], v[48:51]
    ds_read_b32 v248, v240 offset:512
    v_mfma_f32_16x16x32_bf16 v[52:55], v[144:147], v[164:167], v[52:55]
    ds_read_b32 v250, v240 offset:576
    v_mfma_f32_16x16x32_bf16 v[56:59], v[152:155], v[148:151], v[56:59]
    ds_read_b32 v252, v240 offset:640
    v_mfma_f32_16x16x32_bf16 v[60:63], v[156:159], v[148:151], v[60:63]
    ds_read_b32 v254, v240 offset:704
    v_mfma_f32_16x16x32_bf16 v[64:67], v[148:151], v[160:163], v[64:67]
    ds_read_b32 v183, v241 offset:512
    v_mfma_f32_16x16x32_bf16 v[68:71], v[148:151], v[164:167], v[68:71]
    v_mov_b32 v247, 139072
    ds_read_b32 v185, v247
    ds_read_b32 v187, v247 offset:8
    ds_read_b32 v188, v244 offset:512
    ds_read_b32 v190, v244 offset:576
    ds_read_b128 v[200:203], v242 offset:0
    ds_read_b128 v[204:207], v242 offset:64
    ds_read_b128 v[208:211], v242 offset:128
    ds_read_b128 v[212:215], v242 offset:192
    ds_read_b64 v[216:217], v245 offset:0
    ds_read_b64 v[218:219], v245 offset:32
    ds_read_b64 v[220:221], v245 offset:64
    ds_read_b64 v[222:223], v245 offset:96
    s_mov_b32 s71, 1069066811
    s_waitcnt lgkmcnt(12)
    v_pk_fma_f32 v[8:9], v[180:181], v[192:193], v[8:9] op_sel_hi:[0,1,1] neg_lo:[1,0,0] neg_hi:[1,0,0]
    v_pk_fma_f32 v[10:11], v[180:181], v[194:195], v[10:11] op_sel_hi:[0,1,1] neg_lo:[1,0,0] neg_hi:[1,0,0]
    v_pk_fma_f32 v[12:13], v[180:181], v[196:197], v[12:13] op_sel_hi:[0,1,1] neg_lo:[1,0,0] neg_hi:[1,0,0]
    v_pk_fma_f32 v[14:15], v[180:181], v[198:199], v[14:15] op_sel_hi:[0,1,1] neg_lo:[1,0,0] neg_hi:[1,0,0]
    v_cvt_pk_bf16_f32 v104, v8, v9
    v_cvt_pk_bf16_f32 v105, v10, v11
    v_cvt_pk_bf16_f32 v106, v12, v13
    v_cvt_pk_bf16_f32 v107, v14, v15
    v_pk_fma_f32 v[24:25], v[182:183], v[192:193], v[24:25] op_sel_hi:[0,1,1] neg_lo:[1,0,0] neg_hi:[1,0,0]
    v_pk_fma_f32 v[26:27], v[182:183], v[194:195], v[26:27] op_sel_hi:[0,1,1] neg_lo:[1,0,0] neg_hi:[1,0,0]
    v_pk_fma_f32 v[28:29], v[182:183], v[196:197], v[28:29] op_sel_hi:[0,1,1] neg_lo:[1,0,0] neg_hi:[1,0,0]
    v_pk_fma_f32 v[30:31], v[182:183], v[198:199], v[30:31] op_sel_hi:[0,1,1] neg_lo:[1,0,0] neg_hi:[1,0,0]
    v_cvt_pk_bf16_f32 v108, v24, v25
    v_cvt_pk_bf16_f32 v109, v26, v27
    v_cvt_pk_bf16_f32 v110, v28, v29
    v_cvt_pk_bf16_f32 v111, v30, v31
    v_pk_fma_f32 v[40:41], v[184:185], v[192:193], v[40:41] op_sel_hi:[0,1,1] neg_lo:[1,0,0] neg_hi:[1,0,0]
    v_pk_fma_f32 v[42:43], v[184:185], v[194:195], v[42:43] op_sel_hi:[0,1,1] neg_lo:[1,0,0] neg_hi:[1,0,0]
    v_pk_fma_f32 v[44:45], v[184:185], v[196:197], v[44:45] op_sel_hi:[0,1,1] neg_lo:[1,0,0] neg_hi:[1,0,0]
    v_pk_fma_f32 v[46:47], v[184:185], v[198:199], v[46:47] op_sel_hi:[0,1,1] neg_lo:[1,0,0] neg_hi:[1,0,0]
    v_cvt_pk_bf16_f32 v112, v40, v41
    v_cvt_pk_bf16_f32 v113, v42, v43
    v_cvt_pk_bf16_f32 v114, v44, v45
    v_cvt_pk_bf16_f32 v115, v46, v47
    v_pk_fma_f32 v[56:57], v[186:187], v[192:193], v[56:57] op_sel_hi:[0,1,1] neg_lo:[1,0,0] neg_hi:[1,0,0]
    v_pk_fma_f32 v[58:59], v[186:187], v[194:195], v[58:59] op_sel_hi:[0,1,1] neg_lo:[1,0,0] neg_hi:[1,0,0]
    v_pk_fma_f32 v[60:61], v[186:187], v[196:197], v[60:61] op_sel_hi:[0,1,1] neg_lo:[1,0,0] neg_hi:[1,0,0]
    v_pk_fma_f32 v[62:63], v[186:187], v[198:199], v[62:63] op_sel_hi:[0,1,1] neg_lo:[1,0,0] neg_hi:[1,0,0]
    v_cvt_pk_bf16_f32 v116, v56, v57
    v_cvt_pk_bf16_f32 v117, v58, v59
    v_cvt_pk_bf16_f32 v118, v60, v61
    v_cvt_pk_bf16_f32 v119, v62, v63
    v_mul_f32 v248, s71, v248
    v_mul_f32 v250, s71, v250
    v_mul_f32 v252, s71, v252
    v_mul_f32 v254, s71, v254
    v_mul_f32 v181, s71, v183
    s_waitcnt lgkmcnt(0)
    v_readfirstlane_b32 s33, v185
    v_readfirstlane_b32 s32, v187
    v_pk_fma_f32 v[16:17], v[200:201], v[188:189], v[16:17] op_sel_hi:[1,0,1] neg_lo:[1,0,0] neg_hi:[1,0,0]
    v_pk_fma_f32 v[18:19], v[202:203], v[188:189], v[18:19] op_sel_hi:[1,0,1] neg_lo:[1,0,0] neg_hi:[1,0,0]
    v_cvt_pk_bf16_f32 v152, v16, v17
    v_cvt_pk_bf16_f32 v153, v18, v19
    v_pk_fma_f32 v[20:21], v[200:201], v[190:191], v[20:21] op_sel_hi:[1,0,1] neg_lo:[1,0,0] neg_hi:[1,0,0]
    v_pk_fma_f32 v[22:23], v[202:203], v[190:191], v[22:23] op_sel_hi:[1,0,1] neg_lo:[1,0,0] neg_hi:[1,0,0]
    v_cvt_pk_bf16_f32 v156, v20, v21
    v_cvt_pk_bf16_f32 v157, v22, v23
    v_pk_fma_f32 v[32:33], v[204:205], v[188:189], v[32:33] op_sel_hi:[1,0,1] neg_lo:[1,0,0] neg_hi:[1,0,0]
    v_pk_fma_f32 v[34:35], v[206:207], v[188:189], v[34:35] op_sel_hi:[1,0,1] neg_lo:[1,0,0] neg_hi:[1,0,0]
    v_cvt_pk_bf16_f32 v154, v32, v33
    v_cvt_pk_bf16_f32 v155, v34, v35
    v_pk_fma_f32 v[36:37], v[204:205], v[190:191], v[36:37] op_sel_hi:[1,0,1] neg_lo:[1,0,0] neg_hi:[1,0,0]
    v_pk_fma_f32 v[38:39], v[206:207], v[190:191], v[38:39] op_sel_hi:[1,0,1] neg_lo:[1,0,0] neg_hi:[1,0,0]
    v_cvt_pk_bf16_f32 v158, v36, v37
    v_cvt_pk_bf16_f32 v159, v38, v39
    v_pk_fma_f32 v[48:49], v[208:209], v[188:189], v[48:49] op_sel_hi:[1,0,1] neg_lo:[1,0,0] neg_hi:[1,0,0]
    v_pk_fma_f32 v[50:51], v[210:211], v[188:189], v[50:51] op_sel_hi:[1,0,1] neg_lo:[1,0,0] neg_hi:[1,0,0]
    v_cvt_pk_bf16_f32 v160, v48, v49
    v_cvt_pk_bf16_f32 v161, v50, v51
    v_pk_fma_f32 v[52:53], v[208:209], v[190:191], v[52:53] op_sel_hi:[1,0,1] neg_lo:[1,0,0] neg_hi:[1,0,0]
    v_pk_fma_f32 v[54:55], v[210:211], v[190:191], v[54:55] op_sel_hi:[1,0,1] neg_lo:[1,0,0] neg_hi:[1,0,0]
    v_cvt_pk_bf16_f32 v164, v52, v53
    v_cvt_pk_bf16_f32 v165, v54, v55
    v_pk_fma_f32 v[64:65], v[212:213], v[188:189], v[64:65] op_sel_hi:[1,0,1] neg_lo:[1,0,0] neg_hi:[1,0,0]
    v_pk_fma_f32 v[66:67], v[214:215], v[188:189], v[66:67] op_sel_hi:[1,0,1] neg_lo:[1,0,0] neg_hi:[1,0,0]
    v_cvt_pk_bf16_f32 v162, v64, v65
    v_cvt_pk_bf16_f32 v163, v66, v67
    v_pk_fma_f32 v[68:69], v[212:213], v[190:191], v[68:69] op_sel_hi:[1,0,1] neg_lo:[1,0,0] neg_hi:[1,0,0]
    v_pk_fma_f32 v[70:71], v[214:215], v[190:191], v[70:71] op_sel_hi:[1,0,1] neg_lo:[1,0,0] neg_hi:[1,0,0]
    v_cvt_pk_bf16_f32 v166, v68, v69
    v_cvt_pk_bf16_f32 v167, v70, v71
    v_mfma_f32_16x16x32_bf16 v[120:123], v[172:175], v[104:107], 0
    v_mfma_f32_16x16x32_bf16 v[124:127], v[176:179], v[104:107], 0
    v_mfma_f32_16x16x32_bf16 v[128:131], v[172:175], v[108:111], 0
    v_mfma_f32_16x16x32_bf16 v[132:135], v[176:179], v[108:111], 0
    v_mfma_f32_16x16x32_bf16 v[136:139], v[172:175], v[112:115], 0
    v_mfma_f32_16x16x32_bf16 v[140:143], v[176:179], v[112:115], 0
    v_mfma_f32_16x16x32_bf16 v[144:147], v[172:175], v[116:119], 0
    v_mfma_f32_16x16x32_bf16 v[148:151], v[176:179], v[116:119], 0
    s_nop 0
    v_max3_f32 v224, v120, v121, v122
    v_min3_f32 v232, v120, v121, v122
    v_max3_f32 v224, v224, v123, v124
    v_min3_f32 v232, v232, v123, v124
    v_max3_f32 v224, v224, v125, v126
    v_min3_f32 v232, v232, v125, v126
    v_max_f32 v224, v224, v127
    v_min_f32 v232, v232, v127
    v_max3_f32 v226, v128, v129, v130
    v_min3_f32 v234, v128, v129, v130
    v_max3_f32 v226, v226, v131, v132
    v_min3_f32 v234, v234, v131, v132
    v_max3_f32 v226, v226, v133, v134
    v_min3_f32 v234, v234, v133, v134
    v_max_f32 v226, v226, v135
    v_min_f32 v234, v234, v135
    v_max3_f32 v228, v136, v137, v138
    v_min3_f32 v236, v136, v137, v138
    v_max3_f32 v228, v228, v139, v140
    v_min3_f32 v236, v236, v139, v140
    v_max3_f32 v228, v228, v141, v142
    v_min3_f32 v236, v236, v141, v142
    v_max_f32 v228, v228, v143
    v_min_f32 v236, v236, v143
    v_max3_f32 v230, v144, v145, v146
    v_min3_f32 v238, v144, v145, v146
    v_max3_f32 v230, v230, v147, v148
    v_min3_f32 v238, v238, v147, v148
    v_max3_f32 v230, v230, v149, v150
    v_min3_f32 v238, v238, v149, v150
    v_max_f32 v230, v230, v151
    v_min_f32 v238, v238, v151
    v_permlane32_swap_b32 v224, v228
    v_permlane32_swap_b32 v226, v230
    v_permlane32_swap_b32 v232, v236
    v_permlane32_swap_b32 v234, v238
    v_max_f32 v224, v224, v228
    v_max_f32 v226, v226, v230
    v_min_f32 v232, v232, v236
    v_min_f32 v234, v234, v238
    v_permlane16_swap_b32 v224, v226
    s_nop 0
    v_permlane16_swap_b32 v232, v234
    v_max_f32 v224, v224, v226
    v_min_f32 v232, v232, v234
    v_mul_f32 v224, v224, v181
    v_mul_f32 v232, v232, v181
    v_mov_b32 v226, v224
    v_mov_b32 v234, v232
    s_nop 0
    v_permlane16_swap_b32 v224, v226
    v_permlane16_swap_b32 v232, v234
    v_mov_b32 v228, v224
    v_mov_b32 v230, v226
    v_mov_b32 v236, v232
    v_mov_b32 v238, v234
    v_permlane32_swap_b32 v224, v228
    v_permlane32_swap_b32 v226, v230
    v_permlane32_swap_b32 v232, v236
    v_permlane32_swap_b32 v234, v238
    v_pk_fma_f32 v[8:9], v[120:121], v[248:249], v[224:225] op_sel_hi:[1,0,0] neg_lo:[0,0,1] neg_hi:[0,0,1]
    v_pk_fma_f32 v[16:17], v[120:121], v[248:249], v[232:233] op_sel_hi:[1,0,0] neg_lo:[1,0,0] neg_hi:[1,0,0]
    v_pk_fma_f32 v[10:11], v[122:123], v[248:249], v[224:225] op_sel_hi:[1,0,0] neg_lo:[0,0,1] neg_hi:[0,0,1]
    v_pk_fma_f32 v[18:19], v[122:123], v[248:249], v[232:233] op_sel_hi:[1,0,0] neg_lo:[1,0,0] neg_hi:[1,0,0]
    v_pk_fma_f32 v[12:13], v[124:125], v[248:249], v[224:225] op_sel_hi:[1,0,0] neg_lo:[0,0,1] neg_hi:[0,0,1]
    v_pk_fma_f32 v[20:21], v[124:125], v[248:249], v[232:233] op_sel_hi:[1,0,0] neg_lo:[1,0,0] neg_hi:[1,0,0]
    v_pk_fma_f32 v[14:15], v[126:127], v[248:249], v[224:225] op_sel_hi:[1,0,0] neg_lo:[0,0,1] neg_hi:[0,0,1]
    v_pk_fma_f32 v[22:23], v[126:127], v[248:249], v[232:233] op_sel_hi:[1,0,0] neg_lo:[1,0,0] neg_hi:[1,0,0]
    v_exp_f32 v8, v8
    v_exp_f32 v9, v9
    v_exp_f32 v10, v10
    v_exp_f32 v11, v11
    v_exp_f32 v12, v12
    v_exp_f32 v13, v13
    v_exp_f32 v14, v14
    v_exp_f32 v15, v15
    v_exp_f32 v16, v16
    v_exp_f32 v17, v17
    v_exp_f32 v18, v18
    v_exp_f32 v19, v19
    v_exp_f32 v20, v20
    v_exp_f32 v21, v21
    v_exp_f32 v22, v22
    v_exp_f32 v23, v23
    v_pk_fma_f32 v[24:25], v[128:129], v[250:251], v[226:227] op_sel_hi:[1,0,0] neg_lo:[0,0,1] neg_hi:[0,0,1]
    v_pk_fma_f32 v[32:33], v[128:129], v[250:251], v[234:235] op_sel_hi:[1,0,0] neg_lo:[1,0,0] neg_hi:[1,0,0]
    v_pk_fma_f32 v[26:27], v[130:131], v[250:251], v[226:227] op_sel_hi:[1,0,0] neg_lo:[0,0,1] neg_hi:[0,0,1]
    v_pk_fma_f32 v[34:35], v[130:131], v[250:251], v[234:235] op_sel_hi:[1,0,0] neg_lo:[1,0,0] neg_hi:[1,0,0]
    v_pk_fma_f32 v[28:29], v[132:133], v[250:251], v[226:227] op_sel_hi:[1,0,0] neg_lo:[0,0,1] neg_hi:[0,0,1]
    v_pk_fma_f32 v[36:37], v[132:133], v[250:251], v[234:235] op_sel_hi:[1,0,0] neg_lo:[1,0,0] neg_hi:[1,0,0]
    v_pk_fma_f32 v[30:31], v[134:135], v[250:251], v[226:227] op_sel_hi:[1,0,0] neg_lo:[0,0,1] neg_hi:[0,0,1]
    v_pk_fma_f32 v[38:39], v[134:135], v[250:251], v[234:235] op_sel_hi:[1,0,0] neg_lo:[1,0,0] neg_hi:[1,0,0]
    v_exp_f32 v24, v24
    v_exp_f32 v25, v25
    v_exp_f32 v26, v26
    v_exp_f32 v27, v27
    v_exp_f32 v28, v28
    v_exp_f32 v29, v29
    v_exp_f32 v30, v30
    v_exp_f32 v31, v31
    v_exp_f32 v32, v32
    v_exp_f32 v33, v33
    v_exp_f32 v34, v34
    v_exp_f32 v35, v35
    v_exp_f32 v36, v36
    v_exp_f32 v37, v37
    v_exp_f32 v38, v38
    v_exp_f32 v39, v39
    v_pk_fma_f32 v[40:41], v[136:137], v[252:253], v[228:229] op_sel_hi:[1,0,0] neg_lo:[0,0,1] neg_hi:[0,0,1]
    v_pk_fma_f32 v[48:49], v[136:137], v[252:253], v[236:237] op_sel_hi:[1,0,0] neg_lo:[1,0,0] neg_hi:[1,0,0]
    v_pk_fma_f32 v[42:43], v[138:139], v[252:253], v[228:229] op_sel_hi:[1,0,0] neg_lo:[0,0,1] neg_hi:[0,0,1]
    v_pk_fma_f32 v[50:51], v[138:139], v[252:253], v[236:237] op_sel_hi:[1,0,0] neg_lo:[1,0,0] neg_hi:[1,0,0]
    v_pk_fma_f32 v[44:45], v[140:141], v[252:253], v[228:229] op_sel_hi:[1,0,0] neg_lo:[0,0,1] neg_hi:[0,0,1]
    v_pk_fma_f32 v[52:53], v[140:141], v[252:253], v[236:237] op_sel_hi:[1,0,0] neg_lo:[1,0,0] neg_hi:[1,0,0]
    v_pk_fma_f32 v[46:47], v[142:143], v[252:253], v[228:229] op_sel_hi:[1,0,0] neg_lo:[0,0,1] neg_hi:[0,0,1]
    v_pk_fma_f32 v[54:55], v[142:143], v[252:253], v[236:237] op_sel_hi:[1,0,0] neg_lo:[1,0,0] neg_hi:[1,0,0]
    v_exp_f32 v40, v40
    v_exp_f32 v41, v41
    v_exp_f32 v42, v42
    v_exp_f32 v43, v43
    v_exp_f32 v44, v44
    v_exp_f32 v45, v45
    v_exp_f32 v46, v46
    v_exp_f32 v47, v47
    v_exp_f32 v48, v48
    v_exp_f32 v49, v49
    v_exp_f32 v50, v50
    v_exp_f32 v51, v51
    v_exp_f32 v52, v52
    v_exp_f32 v53, v53
    v_exp_f32 v54, v54
    v_exp_f32 v55, v55
    v_pk_fma_f32 v[56:57], v[144:145], v[254:255], v[230:231] op_sel_hi:[1,0,0] neg_lo:[0,0,1] neg_hi:[0,0,1]
    v_pk_fma_f32 v[64:65], v[144:145], v[254:255], v[238:239] op_sel_hi:[1,0,0] neg_lo:[1,0,0] neg_hi:[1,0,0]
    v_pk_fma_f32 v[58:59], v[146:147], v[254:255], v[230:231] op_sel_hi:[1,0,0] neg_lo:[0,0,1] neg_hi:[0,0,1]
    v_pk_fma_f32 v[66:67], v[146:147], v[254:255], v[238:239] op_sel_hi:[1,0,0] neg_lo:[1,0,0] neg_hi:[1,0,0]
    v_pk_fma_f32 v[60:61], v[148:149], v[254:255], v[230:231] op_sel_hi:[1,0,0] neg_lo:[0,0,1] neg_hi:[0,0,1]
    v_pk_fma_f32 v[68:69], v[148:149], v[254:255], v[238:239] op_sel_hi:[1,0,0] neg_lo:[1,0,0] neg_hi:[1,0,0]
    v_pk_fma_f32 v[62:63], v[150:151], v[254:255], v[230:231] op_sel_hi:[1,0,0] neg_lo:[0,0,1] neg_hi:[0,0,1]
    v_pk_fma_f32 v[70:71], v[150:151], v[254:255], v[238:239] op_sel_hi:[1,0,0] neg_lo:[1,0,0] neg_hi:[1,0,0]
    v_exp_f32 v56, v56
    v_exp_f32 v57, v57
    v_exp_f32 v58, v58
    v_exp_f32 v59, v59
    v_exp_f32 v60, v60
    v_exp_f32 v61, v61
    v_exp_f32 v62, v62
    v_exp_f32 v63, v63
    v_exp_f32 v64, v64
    v_exp_f32 v65, v65
    v_exp_f32 v66, v66
    v_exp_f32 v67, v67
    v_exp_f32 v68, v68
    v_exp_f32 v69, v69
    v_exp_f32 v70, v70
    v_exp_f32 v71, v71
    v_pk_add_f32 v[120:121], v[8:9], v[10:11]
    v_pk_add_f32 v[122:123], v[12:13], v[14:15]
    v_pk_add_f32 v[124:125], v[16:17], v[18:19]
    v_pk_add_f32 v[126:127], v[20:21], v[22:23]
    v_pk_add_f32 v[128:129], v[24:25], v[26:27]
    v_pk_add_f32 v[130:131], v[28:29], v[30:31]
    v_pk_add_f32 v[132:133], v[32:33], v[34:35]
    v_pk_add_f32 v[134:135], v[36:37], v[38:39]
    v_pk_add_f32 v[136:137], v[40:41], v[42:43]
    v_pk_add_f32 v[138:139], v[44:45], v[46:47]
    v_pk_add_f32 v[140:141], v[48:49], v[50:51]
    v_pk_add_f32 v[142:143], v[52:53], v[54:55]
    v_pk_add_f32 v[144:145], v[56:57], v[58:59]
    v_pk_add_f32 v[146:147], v[60:61], v[62:63]
    v_pk_add_f32 v[148:149], v[64:65], v[66:67]
    v_pk_add_f32 v[150:151], v[68:69], v[70:71]
    v_pk_add_f32 v[120:121], v[120:121], v[122:123]
    v_pk_add_f32 v[124:125], v[124:125], v[126:127]
    v_pk_add_f32 v[128:129], v[128:129], v[130:131]
    v_pk_add_f32 v[132:133], v[132:133], v[134:135]
    v_pk_add_f32 v[136:137], v[136:137], v[138:139]
    v_pk_add_f32 v[140:141], v[140:141], v[142:143]
    v_pk_add_f32 v[144:145], v[144:145], v[146:147]
    v_pk_add_f32 v[148:149], v[148:149], v[150:151]
    v_add_f32 v224, v120, v121
    v_add_f32 v232, v124, v125
    v_add_f32 v226, v128, v129
    v_add_f32 v234, v132, v133
    v_add_f32 v228, v136, v137
    v_add_f32 v236, v140, v141
    v_add_f32 v230, v144, v145
    v_add_f32 v238, v148, v149
    v_permlane32_swap_b32 v224, v228
    v_permlane32_swap_b32 v226, v230
    v_permlane32_swap_b32 v232, v236
    v_permlane32_swap_b32 v234, v238
    v_add_f32 v224, v224, v228
    v_add_f32 v226, v226, v230
    v_add_f32 v232, v232, v236
    v_add_f32 v234, v234, v238
    v_permlane16_swap_b32 v224, v226
    s_nop 0
    v_permlane16_swap_b32 v232, v234
    v_add_f32 v224, v224, v226
    v_add_f32 v232, v232, v234
    v_rcp_f32 v224, v224
    v_rcp_f32 v232, v232
    s_mul_i32 s3, s38, 4352
    s_add_u32 s3, s3, 140800
    v_mul_u32_u24 v6, 136, v3
    v_lshl_add_u32 v6, v2, 3, v6
    v_add_u32 v240, s3, v6
    v_mul_f32 v224, v224, v183
    v_mul_f32 v232, v232, v183
    v_lshrrev_b32 v6, 2, v1
    v_mul_u32_u24 v6, 136, v6
    v_lshl_add_u32 v6, v7, 3, v6
    v_add_u32 v6, s3, v6
    s_lshl_b32 s65, s28, 6
    v_add_u32 v241, s65, v6
    s_xor_b32 s65, s65, 64
    v_add_u32 v242, s65, v6
    v_mov_b32 v226, v224
    v_mov_b32 v234, v232
    s_nop 0
    v_permlane16_swap_b32 v224, v226
    v_permlane16_swap_b32 v232, v234
    v_mov_b32 v228, v224
    v_mov_b32 v230, v226
    v_mov_b32 v236, v232
    v_mov_b32 v238, v234
    v_permlane32_swap_b32 v224, v228
    v_permlane32_swap_b32 v226, v230
    v_permlane32_swap_b32 v232, v236
    v_permlane32_swap_b32 v234, v238
    v_pk_mul_f32 v[8:9], v[8:9], v[224:225] op_sel_hi:[1,0]
    v_pk_mul_f32 v[10:11], v[10:11], v[224:225] op_sel_hi:[1,0]
    v_pk_mul_f32 v[12:13], v[12:13], v[224:225] op_sel_hi:[1,0]
    v_pk_mul_f32 v[14:15], v[14:15], v[224:225] op_sel_hi:[1,0]
    v_cvt_pk_bf16_f32 v104, v8, v9
    v_cvt_pk_bf16_f32 v105, v10, v11
    v_cvt_pk_bf16_f32 v106, v12, v13
    v_cvt_pk_bf16_f32 v107, v14, v15
    ds_write_b64 v240, v[104:105] offset:0
    ds_write_b64 v240, v[106:107] offset:32
    v_pk_mul_f32 v[16:17], v[16:17], v[232:233] op_sel_hi:[1,0]
    v_pk_mul_f32 v[18:19], v[18:19], v[232:233] op_sel_hi:[1,0]
    v_pk_mul_f32 v[20:21], v[20:21], v[232:233] op_sel_hi:[1,0]
    v_pk_mul_f32 v[22:23], v[22:23], v[232:233] op_sel_hi:[1,0]
    v_cvt_pk_bf16_f32 v108, v16, v17
    v_cvt_pk_bf16_f32 v109, v18, v19
    v_cvt_pk_bf16_f32 v110, v20, v21
    v_cvt_pk_bf16_f32 v111, v22, v23
    ds_write_b64 v240, v[108:109] offset:64
    ds_write_b64 v240, v[110:111] offset:96
    v_pk_mul_f32 v[24:25], v[24:25], v[226:227] op_sel_hi:[1,0]
    v_pk_mul_f32 v[26:27], v[26:27], v[226:227] op_sel_hi:[1,0]
    v_pk_mul_f32 v[28:29], v[28:29], v[226:227] op_sel_hi:[1,0]
    v_pk_mul_f32 v[30:31], v[30:31], v[226:227] op_sel_hi:[1,0]
    v_cvt_pk_bf16_f32 v112, v24, v25
    v_cvt_pk_bf16_f32 v113, v26, v27
    v_cvt_pk_bf16_f32 v114, v28, v29
    v_cvt_pk_bf16_f32 v115, v30, v31
    ds_write_b64 v240, v[112:113] offset:2176
    ds_write_b64 v240, v[114:115] offset:2208
    v_pk_mul_f32 v[32:33], v[32:33], v[234:235] op_sel_hi:[1,0]
    v_pk_mul_f32 v[34:35], v[34:35], v[234:235] op_sel_hi:[1,0]
    v_pk_mul_f32 v[36:37], v[36:37], v[234:235] op_sel_hi:[1,0]
    v_pk_mul_f32 v[38:39], v[38:39], v[234:235] op_sel_hi:[1,0]
    v_cvt_pk_bf16_f32 v116, v32, v33
    v_cvt_pk_bf16_f32 v117, v34, v35
    v_cvt_pk_bf16_f32 v118, v36, v37
    v_cvt_pk_bf16_f32 v119, v38, v39
    ds_write_b64 v240, v[116:117] offset:2240
    ds_write_b64 v240, v[118:119] offset:2272
    ds_read_b64_tr_b16 v[120:121], v241 offset:0
    ds_read_b64_tr_b16 v[122:123], v241 offset:2176
    ds_read_b64_tr_b16 v[124:125], v241 offset:32
    ds_read_b64_tr_b16 v[126:127], v241 offset:2208
    ds_read_b64_tr_b16 v[128:129], v242 offset:0
    ds_read_b64_tr_b16 v[130:131], v242 offset:2176
    ds_read_b64_tr_b16 v[132:133], v242 offset:32
    ds_read_b64_tr_b16 v[134:135], v242 offset:2208
    v_pk_mul_f32 v[40:41], v[40:41], v[228:229] op_sel_hi:[1,0]
    v_pk_mul_f32 v[42:43], v[42:43], v[228:229] op_sel_hi:[1,0]
    v_pk_mul_f32 v[44:45], v[44:45], v[228:229] op_sel_hi:[1,0]
    v_pk_mul_f32 v[46:47], v[46:47], v[228:229] op_sel_hi:[1,0]
    v_cvt_pk_bf16_f32 v104, v40, v41
    v_cvt_pk_bf16_f32 v105, v42, v43
    v_cvt_pk_bf16_f32 v106, v44, v45
    v_cvt_pk_bf16_f32 v107, v46, v47
    ds_write_b64 v240, v[104:105] offset:0
    ds_write_b64 v240, v[106:107] offset:32
    v_pk_mul_f32 v[48:49], v[48:49], v[236:237] op_sel_hi:[1,0]
    v_pk_mul_f32 v[50:51], v[50:51], v[236:237] op_sel_hi:[1,0]
    v_pk_mul_f32 v[52:53], v[52:53], v[236:237] op_sel_hi:[1,0]
    v_pk_mul_f32 v[54:55], v[54:55], v[236:237] op_sel_hi:[1,0]
    v_cvt_pk_bf16_f32 v108, v48, v49
    v_cvt_pk_bf16_f32 v109, v50, v51
    v_cvt_pk_bf16_f32 v110, v52, v53
    v_cvt_pk_bf16_f32 v111, v54, v55
    ds_write_b64 v240, v[108:109] offset:64
    ds_write_b64 v240, v[110:111] offset:96
    v_pk_mul_f32 v[56:57], v[56:57], v[230:231] op_sel_hi:[1,0]
    v_pk_mul_f32 v[58:59], v[58:59], v[230:231] op_sel_hi:[1,0]
    v_pk_mul_f32 v[60:61], v[60:61], v[230:231] op_sel_hi:[1,0]
    v_pk_mul_f32 v[62:63], v[62:63], v[230:231] op_sel_hi:[1,0]
    v_cvt_pk_bf16_f32 v112, v56, v57
    v_cvt_pk_bf16_f32 v113, v58, v59
    v_cvt_pk_bf16_f32 v114, v60, v61
    v_cvt_pk_bf16_f32 v115, v62, v63
    ds_write_b64 v240, v[112:113] offset:2176
    ds_write_b64 v240, v[114:115] offset:2208
    v_pk_mul_f32 v[64:65], v[64:65], v[238:239] op_sel_hi:[1,0]
    v_pk_mul_f32 v[66:67], v[66:67], v[238:239] op_sel_hi:[1,0]
    v_pk_mul_f32 v[68:69], v[68:69], v[238:239] op_sel_hi:[1,0]
    v_pk_mul_f32 v[70:71], v[70:71], v[238:239] op_sel_hi:[1,0]
    v_cvt_pk_bf16_f32 v116, v64, v65
    v_cvt_pk_bf16_f32 v117, v66, v67
    v_cvt_pk_bf16_f32 v118, v68, v69
    v_cvt_pk_bf16_f32 v119, v70, v71
    ds_write_b64 v240, v[116:117] offset:2240
    ds_write_b64 v240, v[118:119] offset:2272
    ds_read_b64_tr_b16 v[136:137], v241 offset:0
    ds_read_b64_tr_b16 v[138:139], v241 offset:2176
    ds_read_b64_tr_b16 v[140:141], v241 offset:32
    ds_read_b64_tr_b16 v[142:143], v241 offset:2208
    ds_read_b64_tr_b16 v[144:145], v242 offset:0
    ds_read_b64_tr_b16 v[146:147], v242 offset:2176
    ds_read_b64_tr_b16 v[148:149], v242 offset:32
    ds_read_b64_tr_b16 v[150:151], v242 offset:2208
    s_waitcnt lgkmcnt(0)
    v_mfma_f32_16x16x32_bf16 v[24:27], v[128:131], v[152:155], 0
    v_mfma_f32_16x16x32_bf16 v[28:31], v[128:131], v[156:159], 0
    v_mfma_f32_16x16x32_bf16 v[48:51], v[128:131], v[216:219], 0
    v_mfma_f32_16x16x32_bf16 v[24:27], v[144:147], v[160:163], v[24:27]
    v_mfma_f32_16x16x32_bf16 v[28:31], v[144:147], v[164:167], v[28:31]
    v_mfma_f32_16x16x32_bf16 v[48:51], v[144:147], v[220:223], v[48:51]
    v_mfma_f32_16x16x32_bf16 v[32:35], v[132:135], v[152:155], 0
    v_mfma_f32_16x16x32_bf16 v[36:39], v[132:135], v[156:159], 0
    v_mfma_f32_16x16x32_bf16 v[52:55], v[132:135], v[216:219], 0
    v_mfma_f32_16x16x32_bf16 v[32:35], v[148:151], v[160:163], v[32:35]
    v_mfma_f32_16x16x32_bf16 v[36:39], v[148:151], v[164:167], v[36:39]
    v_mfma_f32_16x16x32_bf16 v[52:55], v[148:151], v[220:223], v[52:55]
    v_mfma_f32_16x16x32_bf16 v[8:11], v[120:123], v[152:155], 0
    v_mfma_f32_16x16x32_bf16 v[12:15], v[120:123], v[156:159], 0
    v_mfma_f32_16x16x32_bf16 v[40:43], v[120:123], v[216:219], 0
    v_mfma_f32_16x16x32_bf16 v[8:11], v[136:139], v[160:163], v[8:11]
    v_mfma_f32_16x16x32_bf16 v[12:15], v[136:139], v[164:167], v[12:15]
    v_mfma_f32_16x16x32_bf16 v[40:43], v[136:139], v[220:223], v[40:43]
    v_mfma_f32_16x16x32_bf16 v[16:19], v[124:127], v[152:155], 0
    v_mfma_f32_16x16x32_bf16 v[20:23], v[124:127], v[156:159], 0
    v_mfma_f32_16x16x32_bf16 v[44:47], v[124:127], v[216:219], 0
    v_mfma_f32_16x16x32_bf16 v[16:19], v[140:143], v[160:163], v[16:19]
    v_mfma_f32_16x16x32_bf16 v[20:23], v[140:143], v[164:167], v[20:23]
    v_mfma_f32_16x16x32_bf16 v[44:47], v[140:143], v[220:223], v[44:47]
    v_lshlrev_b32 v5, 4, v1
    v_add_u32 v240, s3, v5
    v_lshl_add_u32 v241, v2, 5, s3
    s_xor_b32 s65, s38, 1
    s_mul_i32 s65, s65, 4352
    s_add_u32 s65, s65, 140800
    v_add_u32 v242, s65, v5
    v_lshl_add_u32 v243, v2, 5, s65
    ds_write_b128 v240, v[24:27] offset:0
    ds_write_b128 v240, v[28:31] offset:1024
    ds_write_b128 v240, v[32:35] offset:2048
    ds_write_b128 v240, v[36:39] offset:3072
    ds_write_b128 v241, v[48:51] offset:4096
    ds_write_b128 v241, v[52:55] offset:4112
    s_lshl_b32 s3, s37, 1
    s_add_u32 s3, s3, s29
    s_lshl_b32 s3, s3, 4
    s_add_u32 s3, s3, s36
    s_mul_i32 s3, s3, 4352
    s_add_u32 s3, s3, 2097152
    s_lshl_b32 s65, s28, 7
    s_add_u32 s65, s65, s3
    s_add_u32 s65, s65, 4096
    s_lshl_b32 s66, s28, 11
    s_add_u32 s3, s3, s66
    v_lshlrev_b32 v6, 4, v2
    s_waitcnt lgkmcnt(0)
    s_barrier
    ds_read_b128 v[192:195], v242 offset:0
    ds_read_b128 v[196:199], v242 offset:1024
    ds_read_b128 v[200:203], v242 offset:2048
    ds_read_b128 v[204:207], v242 offset:3072
    ds_read_b128 v[208:211], v243 offset:4096
    ds_read_b128 v[212:215], v243 offset:4112
    ds_read_b128 v[104:107], v168 offset:0
    ds_read_b64_tr_b16 v[120:121], v170 offset:0
    ds_read_b64_tr_b16 v[122:123], v170 offset:512
    ds_read_b64_tr_b16 v[124:125], v171 offset:0
    ds_read_b64_tr_b16 v[126:127], v171 offset:512
    ds_read_b128 v[108:111], v168 offset:2048
    ds_read_b128 v[112:115], v168 offset:4096
    ds_read_b128 v[116:119], v168 offset:6144
    s_waitcnt lgkmcnt(8)
    v_pk_add_f32 v[8:9], v[8:9], v[192:193]
    v_pk_add_f32 v[10:11], v[10:11], v[194:195]
    v_pk_add_f32 v[12:13], v[12:13], v[196:197]
    v_pk_add_f32 v[14:15], v[14:15], v[198:199]
    v_pk_add_f32 v[16:17], v[16:17], v[200:201]
    v_pk_add_f32 v[18:19], v[18:19], v[202:203]
    v_pk_add_f32 v[20:21], v[20:21], v[204:205]
    v_pk_add_f32 v[22:23], v[22:23], v[206:207]
    v_pk_add_f32 v[40:41], v[40:41], v[208:209]
    v_pk_add_f32 v[42:43], v[42:43], v[210:211]
    v_pk_add_f32 v[44:45], v[44:45], v[212:213]
    v_pk_add_f32 v[46:47], v[46:47], v[214:215]
    v_cvt_pk_bf16_f32 v192, v8, v9
    v_cvt_pk_bf16_f32 v193, v10, v11
    v_cvt_pk_bf16_f32 v194, v16, v17
    v_cvt_pk_bf16_f32 v195, v18, v19
    buffer_store_dwordx4 v[192:195], v5, s[12:15], s3 offen offset:0 sc1
    v_cvt_pk_bf16_f32 v196, v12, v13
    v_cvt_pk_bf16_f32 v197, v14, v15
    v_cvt_pk_bf16_f32 v198, v20, v21
    v_cvt_pk_bf16_f32 v199, v22, v23
    buffer_store_dwordx4 v[196:199], v5, s[12:15], s3 offen offset:1024 sc1
    s_mov_b32 s66, 0x00010001
    s_mov_b32 s67, 0x00010001
    s_mov_b64 exec, s[66:67]
    buffer_store_dwordx4 v[40:43], v6, s[12:15], s65 offen offset:0 sc1
    buffer_store_dwordx4 v[44:47], v6, s[12:15], s65 offen offset:64 sc1
    s_mov_b64 exec, -1
    s_mov_b32 s69, 0
    s_lshl_b32 s3, s30, 7
    s_lshl_b32 s65, s38, 5
    s_add_u32 s3, s3, s65
    v_add_u32 v6, s3, v3
    v_lshlrev_b32 v6, 11, v6
    v_and_b32 v7, 1, v2
    v_lshl_add_u32 v6, v7, 5, v6
    v_lshrrev_b32 v7, 1, v2
    v_lshl_add_u32 v6, v7, 4, v6
    s_lshl_b32 s3, s31, 7
    v_add_u32 v246, s3, v6
    s_mov_b32 s68, 32768
    s_waitcnt lgkmcnt(0)
    v_mfma_f32_16x16x32_bf16 v[72:75], v[120:123], v[104:107], v[72:75]
    ds_read_b128 v[136:139], v169 offset:0
    v_mfma_f32_16x16x32_bf16 v[76:79], v[124:127], v[104:107], v[76:79]
    ds_read_b64_tr_b16 v[152:153], v170 offset:4096
    v_mfma_f32_16x16x32_bf16 v[80:83], v[120:123], v[108:111], v[80:83]
    ds_read_b64_tr_b16 v[154:155], v170 offset:4608
    v_mfma_f32_16x16x32_bf16 v[84:87], v[124:127], v[108:111], v[84:87]
    ds_read_b64_tr_b16 v[156:157], v171 offset:4096
    v_mfma_f32_16x16x32_bf16 v[88:91], v[120:123], v[112:115], v[88:91]
    ds_read_b64_tr_b16 v[158:159], v171 offset:4608
    v_mfma_f32_16x16x32_bf16 v[92:95], v[124:127], v[112:115], v[92:95]
    ds_read_b128 v[140:143], v169 offset:2048
    v_mfma_f32_16x16x32_bf16 v[96:99], v[120:123], v[116:119], v[96:99]
    ds_read_b128 v[144:147], v169 offset:4096
    v_mfma_f32_16x16x32_bf16 v[100:103], v[124:127], v[116:119], v[100:103]
    ds_read_b128 v[148:151], v169 offset:6144
    s_waitcnt lgkmcnt(0)
    s_barrier
    v_mfma_f32_16x16x32_bf16 v[72:75], v[152:155], v[136:139], v[72:75]
    ds_read_b128 v[104:107], v168 offset:16384
    v_mfma_f32_16x16x32_bf16 v[76:79], v[156:159], v[136:139], v[76:79]
    ds_read_b64_tr_b16 v[120:121], v170 offset:8192
    v_mfma_f32_16x16x32_bf16 v[80:83], v[152:155], v[140:143], v[80:83]
    ds_read_b64_tr_b16 v[122:123], v170 offset:8704
    v_mfma_f32_16x16x32_bf16 v[84:87], v[156:159], v[140:143], v[84:87]
    ds_read_b64_tr_b16 v[124:125], v171 offset:8192
    v_mfma_f32_16x16x32_bf16 v[88:91], v[152:155], v[144:147], v[88:91]
    ds_read_b64_tr_b16 v[126:127], v171 offset:8704
    v_mfma_f32_16x16x32_bf16 v[92:95], v[156:159], v[144:147], v[92:95]
    ds_read_b128 v[108:111], v168 offset:18432
    v_mfma_f32_16x16x32_bf16 v[96:99], v[152:155], v[148:151], v[96:99]
    ds_read_b128 v[112:115], v168 offset:20480
    v_mfma_f32_16x16x32_bf16 v[100:103], v[156:159], v[148:151], v[100:103]
    ds_read_b128 v[116:119], v168 offset:22528
    s_waitcnt lgkmcnt(0)
    v_mfma_f32_16x16x32_bf16 v[72:75], v[120:123], v[104:107], v[72:75]
    ds_read_b128 v[136:139], v169 offset:16384
    v_mfma_f32_16x16x32_bf16 v[76:79], v[124:127], v[104:107], v[76:79]
    ds_read_b64_tr_b16 v[152:153], v170 offset:12288
    v_mfma_f32_16x16x32_bf16 v[80:83], v[120:123], v[108:111], v[80:83]
    ds_read_b64_tr_b16 v[154:155], v170 offset:12800
    v_mfma_f32_16x16x32_bf16 v[84:87], v[124:127], v[108:111], v[84:87]
    ds_read_b64_tr_b16 v[156:157], v171 offset:12288
    v_mfma_f32_16x16x32_bf16 v[88:91], v[120:123], v[112:115], v[88:91]
    ds_read_b64_tr_b16 v[158:159], v171 offset:12800
    v_mfma_f32_16x16x32_bf16 v[92:95], v[124:127], v[112:115], v[92:95]
    ds_read_b128 v[140:143], v169 offset:18432
    v_mfma_f32_16x16x32_bf16 v[96:99], v[120:123], v[116:119], v[96:99]
    ds_read_b128 v[144:147], v169 offset:20480
    v_mfma_f32_16x16x32_bf16 v[100:103], v[124:127], v[116:119], v[100:103]
    ds_read_b128 v[148:151], v169 offset:22528
    s_waitcnt lgkmcnt(0)
    s_barrier
    v_mfma_f32_16x16x32_bf16 v[72:75], v[152:155], v[136:139], v[72:75]
    ds_read_b128 v[104:107], v168 offset:32768
    v_mfma_f32_16x16x32_bf16 v[76:79], v[156:159], v[136:139], v[76:79]
    ds_read_b64_tr_b16 v[120:121], v170 offset:16384
    v_mfma_f32_16x16x32_bf16 v[80:83], v[152:155], v[140:143], v[80:83]
    ds_read_b64_tr_b16 v[122:123], v170 offset:16896
    v_mfma_f32_16x16x32_bf16 v[84:87], v[156:159], v[140:143], v[84:87]
    ds_read_b64_tr_b16 v[124:125], v171 offset:16384
    v_mfma_f32_16x16x32_bf16 v[88:91], v[152:155], v[144:147], v[88:91]
    ds_read_b64_tr_b16 v[126:127], v171 offset:16896
    v_mfma_f32_16x16x32_bf16 v[92:95], v[156:159], v[144:147], v[92:95]
    ds_read_b128 v[108:111], v168 offset:34816
    v_mfma_f32_16x16x32_bf16 v[96:99], v[152:155], v[148:151], v[96:99]
    ds_read_b128 v[112:115], v168 offset:36864
    v_mfma_f32_16x16x32_bf16 v[100:103], v[156:159], v[148:151], v[100:103]
    ds_read_b128 v[116:119], v168 offset:38912
    s_waitcnt lgkmcnt(0)
    v_mfma_f32_16x16x32_bf16 v[72:75], v[120:123], v[104:107], v[72:75]
    ds_read_b128 v[136:139], v169 offset:32768
    v_mfma_f32_16x16x32_bf16 v[76:79], v[124:127], v[104:107], v[76:79]
    ds_read_b64_tr_b16 v[152:153], v170 offset:20480
    v_mfma_f32_16x16x32_bf16 v[80:83], v[120:123], v[108:111], v[80:83]
    ds_read_b64_tr_b16 v[154:155], v170 offset:20992
    v_mfma_f32_16x16x32_bf16 v[84:87], v[124:127], v[108:111], v[84:87]
    ds_read_b64_tr_b16 v[156:157], v171 offset:20480
    v_mfma_f32_16x16x32_bf16 v[88:91], v[120:123], v[112:115], v[88:91]
    ds_read_b64_tr_b16 v[158:159], v171 offset:20992
    v_mfma_f32_16x16x32_bf16 v[92:95], v[124:127], v[112:115], v[92:95]
    ds_read_b128 v[140:143], v169 offset:34816
    v_mfma_f32_16x16x32_bf16 v[96:99], v[120:123], v[116:119], v[96:99]
    ds_read_b128 v[144:147], v169 offset:36864
    v_mfma_f32_16x16x32_bf16 v[100:103], v[124:127], v[116:119], v[100:103]
    ds_read_b128 v[148:151], v169 offset:38912
    s_waitcnt lgkmcnt(0)
    s_barrier
    v_mfma_f32_16x16x32_bf16 v[72:75], v[152:155], v[136:139], v[72:75]
    ds_read_b128 v[104:107], v168 offset:49152
    v_mfma_f32_16x16x32_bf16 v[76:79], v[156:159], v[136:139], v[76:79]
    ds_read_b64_tr_b16 v[120:121], v170 offset:24576
    v_mfma_f32_16x16x32_bf16 v[80:83], v[152:155], v[140:143], v[80:83]
    ds_read_b64_tr_b16 v[122:123], v170 offset:25088
    v_mfma_f32_16x16x32_bf16 v[84:87], v[156:159], v[140:143], v[84:87]
    ds_read_b64_tr_b16 v[124:125], v171 offset:24576
    v_mfma_f32_16x16x32_bf16 v[88:91], v[152:155], v[144:147], v[88:91]
    ds_read_b64_tr_b16 v[126:127], v171 offset:25088
    v_mfma_f32_16x16x32_bf16 v[92:95], v[156:159], v[144:147], v[92:95]
    ds_read_b128 v[108:111], v168 offset:51200
    v_mfma_f32_16x16x32_bf16 v[96:99], v[152:155], v[148:151], v[96:99]
    ds_read_b128 v[112:115], v168 offset:53248
    v_mfma_f32_16x16x32_bf16 v[100:103], v[156:159], v[148:151], v[100:103]
    ds_read_b128 v[116:119], v168 offset:55296
    s_waitcnt lgkmcnt(0)
    v_mfma_f32_16x16x32_bf16 v[72:75], v[120:123], v[104:107], v[72:75]
    ds_read_b128 v[136:139], v169 offset:49152
    v_mfma_f32_16x16x32_bf16 v[76:79], v[124:127], v[104:107], v[76:79]
    ds_read_b64_tr_b16 v[152:153], v170 offset:28672
    v_mfma_f32_16x16x32_bf16 v[80:83], v[120:123], v[108:111], v[80:83]
    ds_read_b64_tr_b16 v[154:155], v170 offset:29184
    v_mfma_f32_16x16x32_bf16 v[84:87], v[124:127], v[108:111], v[84:87]
    ds_read_b64_tr_b16 v[156:157], v171 offset:28672
    v_mfma_f32_16x16x32_bf16 v[88:91], v[120:123], v[112:115], v[88:91]
    ds_read_b64_tr_b16 v[158:159], v171 offset:29184
    v_mfma_f32_16x16x32_bf16 v[92:95], v[124:127], v[112:115], v[92:95]
    ds_read_b128 v[140:143], v169 offset:51200
    v_mfma_f32_16x16x32_bf16 v[96:99], v[120:123], v[116:119], v[96:99]
    ds_read_b128 v[144:147], v169 offset:53248
    v_mfma_f32_16x16x32_bf16 v[100:103], v[124:127], v[116:119], v[100:103]
    ds_read_b128 v[148:151], v169 offset:55296
    s_waitcnt lgkmcnt(0)
    s_barrier
    v_mfma_f32_16x16x32_bf16 v[72:75], v[152:155], v[136:139], v[72:75]
    ds_read_b128 v[104:107], v168 offset:0
    v_mfma_f32_16x16x32_bf16 v[76:79], v[156:159], v[136:139], v[76:79]
    ds_read_b64_tr_b16 v[120:121], v170 offset:32768
    v_mfma_f32_16x16x32_bf16 v[80:83], v[152:155], v[140:143], v[80:83]
    ds_read_b64_tr_b16 v[122:123], v170 offset:33280
    v_mfma_f32_16x16x32_bf16 v[84:87], v[156:159], v[140:143], v[84:87]
    ds_read_b64_tr_b16 v[124:125], v171 offset:32768
    v_mfma_f32_16x16x32_bf16 v[88:91], v[152:155], v[144:147], v[88:91]
    ds_read_b64_tr_b16 v[126:127], v171 offset:33280
    v_mfma_f32_16x16x32_bf16 v[92:95], v[156:159], v[144:147], v[92:95]
    ds_read_b128 v[108:111], v168 offset:2048
    v_mfma_f32_16x16x32_bf16 v[96:99], v[152:155], v[148:151], v[96:99]
    ds_read_b128 v[112:115], v168 offset:4096
    v_mfma_f32_16x16x32_bf16 v[100:103], v[156:159], v[148:151], v[100:103]
    ds_read_b128 v[116:119], v168 offset:6144
    s_waitcnt lgkmcnt(0)
    v_mfma_f32_16x16x32_bf16 v[72:75], v[120:123], v[104:107], v[72:75]
    ds_read_b128 v[136:139], v169 offset:0
    v_mfma_f32_16x16x32_bf16 v[76:79], v[124:127], v[104:107], v[76:79]
    ds_read_b64_tr_b16 v[152:153], v170 offset:36864
    v_mfma_f32_16x16x32_bf16 v[80:83], v[120:123], v[108:111], v[80:83]
    ds_read_b64_tr_b16 v[154:155], v170 offset:37376
    v_mfma_f32_16x16x32_bf16 v[84:87], v[124:127], v[108:111], v[84:87]
    ds_read_b64_tr_b16 v[156:157], v171 offset:36864
    v_mfma_f32_16x16x32_bf16 v[88:91], v[120:123], v[112:115], v[88:91]
    ds_read_b64_tr_b16 v[158:159], v171 offset:37376
    v_mfma_f32_16x16x32_bf16 v[92:95], v[124:127], v[112:115], v[92:95]
    ds_read_b128 v[140:143], v169 offset:2048
    v_mfma_f32_16x16x32_bf16 v[96:99], v[120:123], v[116:119], v[96:99]
    ds_read_b128 v[144:147], v169 offset:4096
    v_mfma_f32_16x16x32_bf16 v[100:103], v[124:127], v[116:119], v[100:103]
    ds_read_b128 v[148:151], v169 offset:6144
    s_waitcnt lgkmcnt(0)
    s_barrier
    v_mfma_f32_16x16x32_bf16 v[72:75], v[152:155], v[136:139], v[72:75]
    ds_read_b128 v[104:107], v168 offset:16384
    v_mfma_f32_16x16x32_bf16 v[76:79], v[156:159], v[136:139], v[76:79]
    ds_read_b64_tr_b16 v[120:121], v170 offset:40960
    v_mfma_f32_16x16x32_bf16 v[80:83], v[152:155], v[140:143], v[80:83]
    ds_read_b64_tr_b16 v[122:123], v170 offset:41472
    v_mfma_f32_16x16x32_bf16 v[84:87], v[156:159], v[140:143], v[84:87]
    ds_read_b64_tr_b16 v[124:125], v171 offset:40960
    v_mfma_f32_16x16x32_bf16 v[88:91], v[152:155], v[144:147], v[88:91]
    ds_read_b64_tr_b16 v[126:127], v171 offset:41472
    v_mfma_f32_16x16x32_bf16 v[92:95], v[156:159], v[144:147], v[92:95]
    ds_read_b128 v[108:111], v168 offset:18432
    v_mfma_f32_16x16x32_bf16 v[96:99], v[152:155], v[148:151], v[96:99]
    ds_read_b128 v[112:115], v168 offset:20480
    v_mfma_f32_16x16x32_bf16 v[100:103], v[156:159], v[148:151], v[100:103]
    ds_read_b128 v[116:119], v168 offset:22528
    s_waitcnt lgkmcnt(0)
    v_mfma_f32_16x16x32_bf16 v[72:75], v[120:123], v[104:107], v[72:75]
    ds_read_b128 v[136:139], v169 offset:16384
    v_mfma_f32_16x16x32_bf16 v[76:79], v[124:127], v[104:107], v[76:79]
    ds_read_b64_tr_b16 v[152:153], v170 offset:45056
    v_mfma_f32_16x16x32_bf16 v[80:83], v[120:123], v[108:111], v[80:83]
    ds_read_b64_tr_b16 v[154:155], v170 offset:45568
    v_mfma_f32_16x16x32_bf16 v[84:87], v[124:127], v[108:111], v[84:87]
    ds_read_b64_tr_b16 v[156:157], v171 offset:45056
    v_mfma_f32_16x16x32_bf16 v[88:91], v[120:123], v[112:115], v[88:91]
    ds_read_b64_tr_b16 v[158:159], v171 offset:45568
    v_mfma_f32_16x16x32_bf16 v[92:95], v[124:127], v[112:115], v[92:95]
    ds_read_b128 v[140:143], v169 offset:18432
    v_mfma_f32_16x16x32_bf16 v[96:99], v[120:123], v[116:119], v[96:99]
    ds_read_b128 v[144:147], v169 offset:20480
    v_mfma_f32_16x16x32_bf16 v[100:103], v[124:127], v[116:119], v[100:103]
    ds_read_b128 v[148:151], v169 offset:22528
    s_waitcnt lgkmcnt(0)
    s_barrier
    v_mfma_f32_16x16x32_bf16 v[72:75], v[152:155], v[136:139], v[72:75]
    ds_read_b128 v[104:107], v168 offset:32768
    v_mfma_f32_16x16x32_bf16 v[76:79], v[156:159], v[136:139], v[76:79]
    ds_read_b64_tr_b16 v[120:121], v170 offset:49152
    v_mfma_f32_16x16x32_bf16 v[80:83], v[152:155], v[140:143], v[80:83]
    ds_read_b64_tr_b16 v[122:123], v170 offset:49664
    v_mfma_f32_16x16x32_bf16 v[84:87], v[156:159], v[140:143], v[84:87]
    ds_read_b64_tr_b16 v[124:125], v171 offset:49152
    v_mfma_f32_16x16x32_bf16 v[88:91], v[152:155], v[144:147], v[88:91]
    ds_read_b64_tr_b16 v[126:127], v171 offset:49664
    v_mfma_f32_16x16x32_bf16 v[92:95], v[156:159], v[144:147], v[92:95]
    ds_read_b128 v[108:111], v168 offset:34816
    v_mfma_f32_16x16x32_bf16 v[96:99], v[152:155], v[148:151], v[96:99]
    ds_read_b128 v[112:115], v168 offset:36864
    v_mfma_f32_16x16x32_bf16 v[100:103], v[156:159], v[148:151], v[100:103]
    ds_read_b128 v[116:119], v168 offset:38912
    s_waitcnt lgkmcnt(0)
    v_mfma_f32_16x16x32_bf16 v[72:75], v[120:123], v[104:107], v[72:75]
    ds_read_b128 v[136:139], v169 offset:32768
    v_mfma_f32_16x16x32_bf16 v[76:79], v[124:127], v[104:107], v[76:79]
    ds_read_b64_tr_b16 v[152:153], v170 offset:53248
    v_mfma_f32_16x16x32_bf16 v[80:83], v[120:123], v[108:111], v[80:83]
    ds_read_b64_tr_b16 v[154:155], v170 offset:53760
    v_mfma_f32_16x16x32_bf16 v[84:87], v[124:127], v[108:111], v[84:87]
    ds_read_b64_tr_b16 v[156:157], v171 offset:53248
    v_mfma_f32_16x16x32_bf16 v[88:91], v[120:123], v[112:115], v[88:91]
    ds_read_b64_tr_b16 v[158:159], v171 offset:53760
    v_mfma_f32_16x16x32_bf16 v[92:95], v[124:127], v[112:115], v[92:95]
    ds_read_b128 v[140:143], v169 offset:34816
    v_mfma_f32_16x16x32_bf16 v[96:99], v[120:123], v[116:119], v[96:99]
    ds_read_b128 v[144:147], v169 offset:36864
    v_mfma_f32_16x16x32_bf16 v[100:103], v[124:127], v[116:119], v[100:103]
    ds_read_b128 v[148:151], v169 offset:38912
    s_waitcnt lgkmcnt(0)
    s_barrier
    v_mfma_f32_16x16x32_bf16 v[72:75], v[152:155], v[136:139], v[72:75]
    ds_read_b128 v[104:107], v168 offset:49152
    v_mfma_f32_16x16x32_bf16 v[76:79], v[156:159], v[136:139], v[76:79]
    ds_read_b64_tr_b16 v[120:121], v170 offset:57344
    v_mfma_f32_16x16x32_bf16 v[80:83], v[152:155], v[140:143], v[80:83]
    ds_read_b64_tr_b16 v[122:123], v170 offset:57856
    v_mfma_f32_16x16x32_bf16 v[84:87], v[156:159], v[140:143], v[84:87]
    ds_read_b64_tr_b16 v[124:125], v171 offset:57344
    v_mfma_f32_16x16x32_bf16 v[88:91], v[152:155], v[144:147], v[88:91]
    ds_read_b64_tr_b16 v[126:127], v171 offset:57856
    v_mfma_f32_16x16x32_bf16 v[92:95], v[156:159], v[144:147], v[92:95]
    ds_read_b128 v[108:111], v168 offset:51200
    v_mfma_f32_16x16x32_bf16 v[96:99], v[152:155], v[148:151], v[96:99]
    ds_read_b128 v[112:115], v168 offset:53248
    v_mfma_f32_16x16x32_bf16 v[100:103], v[156:159], v[148:151], v[100:103]
    ds_read_b128 v[116:119], v168 offset:55296
    s_waitcnt lgkmcnt(0)
    v_mfma_f32_16x16x32_bf16 v[72:75], v[120:123], v[104:107], v[72:75]
    ds_read_b128 v[136:139], v169 offset:49152
    v_mfma_f32_16x16x32_bf16 v[76:79], v[124:127], v[104:107], v[76:79]
    ds_read_b64_tr_b16 v[152:153], v170 offset:61440
    v_mfma_f32_16x16x32_bf16 v[80:83], v[120:123], v[108:111], v[80:83]
    ds_read_b64_tr_b16 v[154:155], v170 offset:61952
    v_mfma_f32_16x16x32_bf16 v[84:87], v[124:127], v[108:111], v[84:87]
    ds_read_b64_tr_b16 v[156:157], v171 offset:61440
    v_mfma_f32_16x16x32_bf16 v[88:91], v[120:123], v[112:115], v[88:91]
    ds_read_b64_tr_b16 v[158:159], v171 offset:61952
    v_mfma_f32_16x16x32_bf16 v[92:95], v[124:127], v[112:115], v[92:95]
    ds_read_b128 v[140:143], v169 offset:51200
    v_mfma_f32_16x16x32_bf16 v[96:99], v[120:123], v[116:119], v[96:99]
    ds_read_b128 v[144:147], v169 offset:53248
    v_mfma_f32_16x16x32_bf16 v[100:103], v[124:127], v[116:119], v[100:103]
    ds_read_b128 v[148:151], v169 offset:55296
    s_waitcnt lgkmcnt(0)
    s_barrier
    v_mfma_f32_16x16x32_bf16 v[72:75], v[152:155], v[136:139], v[72:75]
    ds_read_b128 v[104:107], v168 offset:0
    v_mfma_f32_16x16x32_bf16 v[76:79], v[156:159], v[136:139], v[76:79]
    ds_read_b64_tr_b16 v[120:121], v170 offset:0
    v_mfma_f32_16x16x32_bf16 v[80:83], v[152:155], v[140:143], v[80:83]
    ds_read_b64_tr_b16 v[122:123], v170 offset:512
    v_mfma_f32_16x16x32_bf16 v[84:87], v[156:159], v[140:143], v[84:87]
    ds_read_b64_tr_b16 v[124:125], v171 offset:0
    v_mfma_f32_16x16x32_bf16 v[88:91], v[152:155], v[144:147], v[88:91]
    ds_read_b64_tr_b16 v[126:127], v171 offset:512
    v_mfma_f32_16x16x32_bf16 v[92:95], v[156:159], v[144:147], v[92:95]
    ds_read_b128 v[108:111], v168 offset:2048
    v_mfma_f32_16x16x32_bf16 v[96:99], v[152:155], v[148:151], v[96:99]
    ds_read_b128 v[112:115], v168 offset:4096
    v_mfma_f32_16x16x32_bf16 v[100:103], v[156:159], v[148:151], v[100:103]
    ds_read_b128 v[116:119], v168 offset:6144
    s_waitcnt lgkmcnt(0)
    v_mfma_f32_16x16x32_bf16 v[72:75], v[120:123], v[104:107], v[72:75]
    ds_read_b128 v[136:139], v169 offset:0
    v_mfma_f32_16x16x32_bf16 v[76:79], v[124:127], v[104:107], v[76:79]
    ds_read_b64_tr_b16 v[152:153], v170 offset:4096
    v_mfma_f32_16x16x32_bf16 v[80:83], v[120:123], v[108:111], v[80:83]
    ds_read_b64_tr_b16 v[154:155], v170 offset:4608
    v_mfma_f32_16x16x32_bf16 v[84:87], v[124:127], v[108:111], v[84:87]
    ds_read_b64_tr_b16 v[156:157], v171 offset:4096
    v_mfma_f32_16x16x32_bf16 v[88:91], v[120:123], v[112:115], v[88:91]
    ds_read_b64_tr_b16 v[158:159], v171 offset:4608
    v_mfma_f32_16x16x32_bf16 v[92:95], v[124:127], v[112:115], v[92:95]
    ds_read_b128 v[140:143], v169 offset:2048
    v_mfma_f32_16x16x32_bf16 v[96:99], v[120:123], v[116:119], v[96:99]
    ds_read_b128 v[144:147], v169 offset:4096
    v_mfma_f32_16x16x32_bf16 v[100:103], v[124:127], v[116:119], v[100:103]
    ds_read_b128 v[148:151], v169 offset:6144
    s_waitcnt lgkmcnt(0)
    s_barrier
    v_mfma_f32_16x16x32_bf16 v[72:75], v[152:155], v[136:139], v[72:75]
    ds_read_b128 v[104:107], v168 offset:16384
    v_mfma_f32_16x16x32_bf16 v[76:79], v[156:159], v[136:139], v[76:79]
    ds_read_b64_tr_b16 v[120:121], v170 offset:8192
    v_mfma_f32_16x16x32_bf16 v[80:83], v[152:155], v[140:143], v[80:83]
    ds_read_b64_tr_b16 v[122:123], v170 offset:8704
    v_mfma_f32_16x16x32_bf16 v[84:87], v[156:159], v[140:143], v[84:87]
    ds_read_b64_tr_b16 v[124:125], v171 offset:8192
    v_mfma_f32_16x16x32_bf16 v[88:91], v[152:155], v[144:147], v[88:91]
    ds_read_b64_tr_b16 v[126:127], v171 offset:8704
    v_mfma_f32_16x16x32_bf16 v[92:95], v[156:159], v[144:147], v[92:95]
    ds_read_b128 v[108:111], v168 offset:18432
    v_mfma_f32_16x16x32_bf16 v[96:99], v[152:155], v[148:151], v[96:99]
    ds_read_b128 v[112:115], v168 offset:20480
    v_mfma_f32_16x16x32_bf16 v[100:103], v[156:159], v[148:151], v[100:103]
    ds_read_b128 v[116:119], v168 offset:22528
    s_waitcnt lgkmcnt(0)
    v_mfma_f32_16x16x32_bf16 v[72:75], v[120:123], v[104:107], v[72:75]
    ds_read_b128 v[136:139], v169 offset:16384
    v_mfma_f32_16x16x32_bf16 v[76:79], v[124:127], v[104:107], v[76:79]
    ds_read_b64_tr_b16 v[152:153], v170 offset:12288
    v_mfma_f32_16x16x32_bf16 v[80:83], v[120:123], v[108:111], v[80:83]
    ds_read_b64_tr_b16 v[154:155], v170 offset:12800
    v_mfma_f32_16x16x32_bf16 v[84:87], v[124:127], v[108:111], v[84:87]
    ds_read_b64_tr_b16 v[156:157], v171 offset:12288
    v_mfma_f32_16x16x32_bf16 v[88:91], v[120:123], v[112:115], v[88:91]
    ds_read_b64_tr_b16 v[158:159], v171 offset:12800
    v_mfma_f32_16x16x32_bf16 v[92:95], v[124:127], v[112:115], v[92:95]
    ds_read_b128 v[140:143], v169 offset:18432
    v_mfma_f32_16x16x32_bf16 v[96:99], v[120:123], v[116:119], v[96:99]
    ds_read_b128 v[144:147], v169 offset:20480
    v_mfma_f32_16x16x32_bf16 v[100:103], v[124:127], v[116:119], v[100:103]
    ds_read_b128 v[148:151], v169 offset:22528
    s_waitcnt lgkmcnt(0)
    s_barrier
    v_mfma_f32_16x16x32_bf16 v[72:75], v[152:155], v[136:139], v[72:75]
    ds_read_b128 v[104:107], v168 offset:32768
    v_mfma_f32_16x16x32_bf16 v[76:79], v[156:159], v[136:139], v[76:79]
    ds_read_b64_tr_b16 v[120:121], v170 offset:16384
    v_mfma_f32_16x16x32_bf16 v[80:83], v[152:155], v[140:143], v[80:83]
    ds_read_b64_tr_b16 v[122:123], v170 offset:16896
    v_mfma_f32_16x16x32_bf16 v[84:87], v[156:159], v[140:143], v[84:87]
    ds_read_b64_tr_b16 v[124:125], v171 offset:16384
    v_mfma_f32_16x16x32_bf16 v[88:91], v[152:155], v[144:147], v[88:91]
    ds_read_b64_tr_b16 v[126:127], v171 offset:16896
    v_mfma_f32_16x16x32_bf16 v[92:95], v[156:159], v[144:147], v[92:95]
    ds_read_b128 v[108:111], v168 offset:34816
    v_mfma_f32_16x16x32_bf16 v[96:99], v[152:155], v[148:151], v[96:99]
    ds_read_b128 v[112:115], v168 offset:36864
    v_mfma_f32_16x16x32_bf16 v[100:103], v[156:159], v[148:151], v[100:103]
    ds_read_b128 v[116:119], v168 offset:38912
    s_waitcnt lgkmcnt(0)
    v_mfma_f32_16x16x32_bf16 v[72:75], v[120:123], v[104:107], v[72:75]
    ds_read_b128 v[136:139], v169 offset:32768
    v_mfma_f32_16x16x32_bf16 v[76:79], v[124:127], v[104:107], v[76:79]
    ds_read_b64_tr_b16 v[152:153], v170 offset:20480
    v_mfma_f32_16x16x32_bf16 v[80:83], v[120:123], v[108:111], v[80:83]
    ds_read_b64_tr_b16 v[154:155], v170 offset:20992
    v_mfma_f32_16x16x32_bf16 v[84:87], v[124:127], v[108:111], v[84:87]
    ds_read_b64_tr_b16 v[156:157], v171 offset:20480
    v_mfma_f32_16x16x32_bf16 v[88:91], v[120:123], v[112:115], v[88:91]
    ds_read_b64_tr_b16 v[158:159], v171 offset:20992
    v_mfma_f32_16x16x32_bf16 v[92:95], v[124:127], v[112:115], v[92:95]
    ds_read_b128 v[140:143], v169 offset:34816
    v_mfma_f32_16x16x32_bf16 v[96:99], v[120:123], v[116:119], v[96:99]
    ds_read_b128 v[144:147], v169 offset:36864
    v_mfma_f32_16x16x32_bf16 v[100:103], v[124:127], v[116:119], v[100:103]
    ds_read_b128 v[148:151], v169 offset:38912
    s_waitcnt lgkmcnt(0)
    s_barrier
    v_mfma_f32_16x16x32_bf16 v[72:75], v[152:155], v[136:139], v[72:75]
    ds_read_b128 v[104:107], v168 offset:49152
    v_mfma_f32_16x16x32_bf16 v[76:79], v[156:159], v[136:139], v[76:79]
    ds_read_b64_tr_b16 v[120:121], v170 offset:24576
    v_mfma_f32_16x16x32_bf16 v[80:83], v[152:155], v[140:143], v[80:83]
    ds_read_b64_tr_b16 v[122:123], v170 offset:25088
    v_mfma_f32_16x16x32_bf16 v[84:87], v[156:159], v[140:143], v[84:87]
    ds_read_b64_tr_b16 v[124:125], v171 offset:24576
    v_mfma_f32_16x16x32_bf16 v[88:91], v[152:155], v[144:147], v[88:91]
    ds_read_b64_tr_b16 v[126:127], v171 offset:25088
    v_mfma_f32_16x16x32_bf16 v[92:95], v[156:159], v[144:147], v[92:95]
    ds_read_b128 v[108:111], v168 offset:51200
    v_mfma_f32_16x16x32_bf16 v[96:99], v[152:155], v[148:151], v[96:99]
    ds_read_b128 v[112:115], v168 offset:53248
    v_mfma_f32_16x16x32_bf16 v[100:103], v[156:159], v[148:151], v[100:103]
    ds_read_b128 v[116:119], v168 offset:55296
    s_waitcnt lgkmcnt(0)
    v_mfma_f32_16x16x32_bf16 v[72:75], v[120:123], v[104:107], v[72:75]
    ds_read_b128 v[136:139], v169 offset:49152
    v_mfma_f32_16x16x32_bf16 v[76:79], v[124:127], v[104:107], v[76:79]
    ds_read_b64_tr_b16 v[152:153], v170 offset:28672
    v_mfma_f32_16x16x32_bf16 v[80:83], v[120:123], v[108:111], v[80:83]
    ds_read_b64_tr_b16 v[154:155], v170 offset:29184
    v_mfma_f32_16x16x32_bf16 v[84:87], v[124:127], v[108:111], v[84:87]
    ds_read_b64_tr_b16 v[156:157], v171 offset:28672
    v_mfma_f32_16x16x32_bf16 v[88:91], v[120:123], v[112:115], v[88:91]
    ds_read_b64_tr_b16 v[158:159], v171 offset:29184
    v_mfma_f32_16x16x32_bf16 v[92:95], v[124:127], v[112:115], v[92:95]
    ds_read_b128 v[140:143], v169 offset:51200
    v_mfma_f32_16x16x32_bf16 v[96:99], v[120:123], v[116:119], v[96:99]
    ds_read_b128 v[144:147], v169 offset:53248
    v_mfma_f32_16x16x32_bf16 v[100:103], v[124:127], v[116:119], v[100:103]
    ds_read_b128 v[148:151], v169 offset:55296
    s_waitcnt lgkmcnt(0)
    s_barrier
    v_mfma_f32_16x16x32_bf16 v[72:75], v[152:155], v[136:139], v[72:75]
    ds_read_b128 v[104:107], v168 offset:0
    v_mfma_f32_16x16x32_bf16 v[76:79], v[156:159], v[136:139], v[76:79]
    ds_read_b64_tr_b16 v[120:121], v170 offset:32768
    v_mfma_f32_16x16x32_bf16 v[80:83], v[152:155], v[140:143], v[80:83]
    ds_read_b64_tr_b16 v[122:123], v170 offset:33280
    v_mfma_f32_16x16x32_bf16 v[84:87], v[156:159], v[140:143], v[84:87]
    ds_read_b64_tr_b16 v[124:125], v171 offset:32768
    v_mfma_f32_16x16x32_bf16 v[88:91], v[152:155], v[144:147], v[88:91]
    ds_read_b64_tr_b16 v[126:127], v171 offset:33280
    v_mfma_f32_16x16x32_bf16 v[92:95], v[156:159], v[144:147], v[92:95]
    ds_read_b128 v[108:111], v168 offset:2048
    v_mfma_f32_16x16x32_bf16 v[96:99], v[152:155], v[148:151], v[96:99]
    ds_read_b128 v[112:115], v168 offset:4096
    v_mfma_f32_16x16x32_bf16 v[100:103], v[156:159], v[148:151], v[100:103]
    ds_read_b128 v[116:119], v168 offset:6144
    s_waitcnt lgkmcnt(0)
    v_mfma_f32_16x16x32_bf16 v[72:75], v[120:123], v[104:107], v[72:75]
    ds_read_b128 v[136:139], v169 offset:0
    v_mfma_f32_16x16x32_bf16 v[76:79], v[124:127], v[104:107], v[76:79]
    ds_read_b64_tr_b16 v[152:153], v170 offset:36864
    v_mfma_f32_16x16x32_bf16 v[80:83], v[120:123], v[108:111], v[80:83]
    ds_read_b64_tr_b16 v[154:155], v170 offset:37376
    v_mfma_f32_16x16x32_bf16 v[84:87], v[124:127], v[108:111], v[84:87]
    ds_read_b64_tr_b16 v[156:157], v171 offset:36864
    v_mfma_f32_16x16x32_bf16 v[88:91], v[120:123], v[112:115], v[88:91]
    ds_read_b64_tr_b16 v[158:159], v171 offset:37376
    v_mfma_f32_16x16x32_bf16 v[92:95], v[124:127], v[112:115], v[92:95]
    ds_read_b128 v[140:143], v169 offset:2048
    v_mfma_f32_16x16x32_bf16 v[96:99], v[120:123], v[116:119], v[96:99]
    ds_read_b128 v[144:147], v169 offset:4096
    v_mfma_f32_16x16x32_bf16 v[100:103], v[124:127], v[116:119], v[100:103]
    ds_read_b128 v[148:151], v169 offset:6144
    s_waitcnt lgkmcnt(0)
    s_barrier
    v_mfma_f32_16x16x32_bf16 v[72:75], v[152:155], v[136:139], v[72:75]
    ds_read_b128 v[104:107], v168 offset:16384
    v_mfma_f32_16x16x32_bf16 v[76:79], v[156:159], v[136:139], v[76:79]
    ds_read_b64_tr_b16 v[120:121], v170 offset:40960
    v_mfma_f32_16x16x32_bf16 v[80:83], v[152:155], v[140:143], v[80:83]
    ds_read_b64_tr_b16 v[122:123], v170 offset:41472
    v_mfma_f32_16x16x32_bf16 v[84:87], v[156:159], v[140:143], v[84:87]
    ds_read_b64_tr_b16 v[124:125], v171 offset:40960
    v_mfma_f32_16x16x32_bf16 v[88:91], v[152:155], v[144:147], v[88:91]
    ds_read_b64_tr_b16 v[126:127], v171 offset:41472
    v_mfma_f32_16x16x32_bf16 v[92:95], v[156:159], v[144:147], v[92:95]
    ds_read_b128 v[108:111], v168 offset:18432
    v_mfma_f32_16x16x32_bf16 v[96:99], v[152:155], v[148:151], v[96:99]
    ds_read_b128 v[112:115], v168 offset:20480
    v_mfma_f32_16x16x32_bf16 v[100:103], v[156:159], v[148:151], v[100:103]
    ds_read_b128 v[116:119], v168 offset:22528
    s_waitcnt lgkmcnt(0)
    v_mfma_f32_16x16x32_bf16 v[72:75], v[120:123], v[104:107], v[72:75]
    ds_read_b128 v[136:139], v169 offset:16384
    v_mfma_f32_16x16x32_bf16 v[76:79], v[124:127], v[104:107], v[76:79]
    ds_read_b64_tr_b16 v[152:153], v170 offset:45056
    v_mfma_f32_16x16x32_bf16 v[80:83], v[120:123], v[108:111], v[80:83]
    ds_read_b64_tr_b16 v[154:155], v170 offset:45568
    v_mfma_f32_16x16x32_bf16 v[84:87], v[124:127], v[108:111], v[84:87]
    ds_read_b64_tr_b16 v[156:157], v171 offset:45056
    v_mfma_f32_16x16x32_bf16 v[88:91], v[120:123], v[112:115], v[88:91]
    ds_read_b64_tr_b16 v[158:159], v171 offset:45568
    v_mfma_f32_16x16x32_bf16 v[92:95], v[124:127], v[112:115], v[92:95]
    ds_read_b128 v[140:143], v169 offset:18432
    v_mfma_f32_16x16x32_bf16 v[96:99], v[120:123], v[116:119], v[96:99]
    ds_read_b128 v[144:147], v169 offset:20480
    v_mfma_f32_16x16x32_bf16 v[100:103], v[124:127], v[116:119], v[100:103]
    ds_read_b128 v[148:151], v169 offset:22528
    s_waitcnt lgkmcnt(0)
    s_barrier
    v_mfma_f32_16x16x32_bf16 v[72:75], v[152:155], v[136:139], v[72:75]
    ds_read_b128 v[104:107], v168 offset:32768
    v_mfma_f32_16x16x32_bf16 v[76:79], v[156:159], v[136:139], v[76:79]
    ds_read_b64_tr_b16 v[120:121], v170 offset:49152
    v_mfma_f32_16x16x32_bf16 v[80:83], v[152:155], v[140:143], v[80:83]
    ds_read_b64_tr_b16 v[122:123], v170 offset:49664
    v_mfma_f32_16x16x32_bf16 v[84:87], v[156:159], v[140:143], v[84:87]
    ds_read_b64_tr_b16 v[124:125], v171 offset:49152
    v_mfma_f32_16x16x32_bf16 v[88:91], v[152:155], v[144:147], v[88:91]
    ds_read_b64_tr_b16 v[126:127], v171 offset:49664
    v_mfma_f32_16x16x32_bf16 v[92:95], v[156:159], v[144:147], v[92:95]
    ds_read_b128 v[108:111], v168 offset:34816
    v_mfma_f32_16x16x32_bf16 v[96:99], v[152:155], v[148:151], v[96:99]
    ds_read_b128 v[112:115], v168 offset:36864
    v_mfma_f32_16x16x32_bf16 v[100:103], v[156:159], v[148:151], v[100:103]
    ds_read_b128 v[116:119], v168 offset:38912
    s_waitcnt lgkmcnt(0)
    v_mfma_f32_16x16x32_bf16 v[72:75], v[120:123], v[104:107], v[72:75]
    ds_read_b128 v[136:139], v169 offset:32768
    v_mfma_f32_16x16x32_bf16 v[76:79], v[124:127], v[104:107], v[76:79]
    ds_read_b64_tr_b16 v[152:153], v170 offset:53248
    v_mfma_f32_16x16x32_bf16 v[80:83], v[120:123], v[108:111], v[80:83]
    ds_read_b64_tr_b16 v[154:155], v170 offset:53760
    v_mfma_f32_16x16x32_bf16 v[84:87], v[124:127], v[108:111], v[84:87]
    ds_read_b64_tr_b16 v[156:157], v171 offset:53248
    v_mfma_f32_16x16x32_bf16 v[88:91], v[120:123], v[112:115], v[88:91]
    ds_read_b64_tr_b16 v[158:159], v171 offset:53760
    v_mfma_f32_16x16x32_bf16 v[92:95], v[124:127], v[112:115], v[92:95]
    ds_read_b128 v[140:143], v169 offset:34816
    v_mfma_f32_16x16x32_bf16 v[96:99], v[120:123], v[116:119], v[96:99]
    ds_read_b128 v[144:147], v169 offset:36864
    v_mfma_f32_16x16x32_bf16 v[100:103], v[124:127], v[116:119], v[100:103]
    ds_read_b128 v[148:151], v169 offset:38912
    s_waitcnt lgkmcnt(0)
    v_mfma_f32_16x16x32_bf16 v[72:75], v[152:155], v[136:139], v[72:75]
    ds_read_b128 v[104:107], v168 offset:49152
    v_mfma_f32_16x16x32_bf16 v[76:79], v[156:159], v[136:139], v[76:79]
    ds_read_b64_tr_b16 v[120:121], v170 offset:57344
    v_mfma_f32_16x16x32_bf16 v[80:83], v[152:155], v[140:143], v[80:83]
    ds_read_b64_tr_b16 v[122:123], v170 offset:57856
    v_mfma_f32_16x16x32_bf16 v[84:87], v[156:159], v[140:143], v[84:87]
    ds_read_b64_tr_b16 v[124:125], v171 offset:57344
    v_mfma_f32_16x16x32_bf16 v[88:91], v[152:155], v[144:147], v[88:91]
    ds_read_b64_tr_b16 v[126:127], v171 offset:57856
    v_mfma_f32_16x16x32_bf16 v[92:95], v[156:159], v[144:147], v[92:95]
    ds_read_b128 v[108:111], v168 offset:51200
    v_mfma_f32_16x16x32_bf16 v[96:99], v[152:155], v[148:151], v[96:99]
    ds_read_b128 v[112:115], v168 offset:53248
    v_mfma_f32_16x16x32_bf16 v[100:103], v[156:159], v[148:151], v[100:103]
    ds_read_b128 v[116:119], v168 offset:55296
    s_waitcnt lgkmcnt(0)
    v_mfma_f32_16x16x32_bf16 v[72:75], v[120:123], v[104:107], v[72:75]
    ds_read_b128 v[136:139], v169 offset:49152
    v_mfma_f32_16x16x32_bf16 v[76:79], v[124:127], v[104:107], v[76:79]
    ds_read_b64_tr_b16 v[152:153], v170 offset:61440
    v_mfma_f32_16x16x32_bf16 v[80:83], v[120:123], v[108:111], v[80:83]
    ds_read_b64_tr_b16 v[154:155], v170 offset:61952
    v_mfma_f32_16x16x32_bf16 v[84:87], v[124:127], v[108:111], v[84:87]
    ds_read_b64_tr_b16 v[156:157], v171 offset:61440
    v_mfma_f32_16x16x32_bf16 v[88:91], v[120:123], v[112:115], v[88:91]
    ds_read_b64_tr_b16 v[158:159], v171 offset:61952
    v_mfma_f32_16x16x32_bf16 v[92:95], v[124:127], v[112:115], v[92:95]
    ds_read_b128 v[140:143], v169 offset:51200
    v_mfma_f32_16x16x32_bf16 v[96:99], v[120:123], v[116:119], v[96:99]
    ds_read_b128 v[144:147], v169 offset:53248
    v_mfma_f32_16x16x32_bf16 v[100:103], v[124:127], v[116:119], v[100:103]
    ds_read_b128 v[148:151], v169 offset:55296
    s_waitcnt lgkmcnt(0)
    s_barrier
    s_lshl_b32 s3, s29, 7
    s_add_u32 s3, s3, 138240
    v_lshl_add_u32 v243, v2, 4, s3
    v_mfma_f32_16x16x32_bf16 v[72:75], v[152:155], v[136:139], v[72:75]
    ds_read_b128 v[192:195], v243 offset:0
    v_mfma_f32_16x16x32_bf16 v[76:79], v[156:159], v[136:139], v[76:79]
    ds_read_b128 v[196:199], v243 offset:64
    v_mfma_f32_16x16x32_bf16 v[80:83], v[152:155], v[140:143], v[80:83]
    v_mfma_f32_16x16x32_bf16 v[84:87], v[156:159], v[140:143], v[84:87]
    v_mfma_f32_16x16x32_bf16 v[88:91], v[152:155], v[144:147], v[88:91]
    v_mfma_f32_16x16x32_bf16 v[92:95], v[156:159], v[144:147], v[92:95]
    v_mfma_f32_16x16x32_bf16 v[96:99], v[152:155], v[148:151], v[96:99]
    v_mfma_f32_16x16x32_bf16 v[100:103], v[156:159], v[148:151], v[100:103]
    s_waitcnt lgkmcnt(0)
    v_pk_fma_f32 v[72:73], v[180:181], v[192:193], v[72:73] op_sel_hi:[0,1,1] neg_lo:[1,0,0] neg_hi:[1,0,0]
    v_pk_fma_f32 v[74:75], v[180:181], v[194:195], v[74:75] op_sel_hi:[0,1,1] neg_lo:[1,0,0] neg_hi:[1,0,0]
    v_pk_fma_f32 v[76:77], v[180:181], v[196:197], v[76:77] op_sel_hi:[0,1,1] neg_lo:[1,0,0] neg_hi:[1,0,0]
    v_pk_fma_f32 v[78:79], v[180:181], v[198:199], v[78:79] op_sel_hi:[0,1,1] neg_lo:[1,0,0] neg_hi:[1,0,0]
    v_cvt_pk_bf16_f32 v104, v72, v73
    v_cvt_pk_bf16_f32 v105, v74, v75
    v_cvt_pk_bf16_f32 v106, v76, v77
    v_cvt_pk_bf16_f32 v107, v78, v79
    v_pk_fma_f32 v[80:81], v[182:183], v[192:193], v[80:81] op_sel_hi:[0,1,1] neg_lo:[1,0,0] neg_hi:[1,0,0]
    v_pk_fma_f32 v[82:83], v[182:183], v[194:195], v[82:83] op_sel_hi:[0,1,1] neg_lo:[1,0,0] neg_hi:[1,0,0]
    v_pk_fma_f32 v[84:85], v[182:183], v[196:197], v[84:85] op_sel_hi:[0,1,1] neg_lo:[1,0,0] neg_hi:[1,0,0]
    v_pk_fma_f32 v[86:87], v[182:183], v[198:199], v[86:87] op_sel_hi:[0,1,1] neg_lo:[1,0,0] neg_hi:[1,0,0]
    v_cvt_pk_bf16_f32 v108, v80, v81
    v_cvt_pk_bf16_f32 v109, v82, v83
    v_cvt_pk_bf16_f32 v110, v84, v85
    v_cvt_pk_bf16_f32 v111, v86, v87
    v_pk_fma_f32 v[88:89], v[184:185], v[192:193], v[88:89] op_sel_hi:[0,1,1] neg_lo:[1,0,0] neg_hi:[1,0,0]
    v_pk_fma_f32 v[90:91], v[184:185], v[194:195], v[90:91] op_sel_hi:[0,1,1] neg_lo:[1,0,0] neg_hi:[1,0,0]
    v_pk_fma_f32 v[92:93], v[184:185], v[196:197], v[92:93] op_sel_hi:[0,1,1] neg_lo:[1,0,0] neg_hi:[1,0,0]
    v_pk_fma_f32 v[94:95], v[184:185], v[198:199], v[94:95] op_sel_hi:[0,1,1] neg_lo:[1,0,0] neg_hi:[1,0,0]
    v_cvt_pk_bf16_f32 v112, v88, v89
    v_cvt_pk_bf16_f32 v113, v90, v91
    v_cvt_pk_bf16_f32 v114, v92, v93
    v_cvt_pk_bf16_f32 v115, v94, v95
    v_pk_fma_f32 v[96:97], v[186:187], v[192:193], v[96:97] op_sel_hi:[0,1,1] neg_lo:[1,0,0] neg_hi:[1,0,0]
    v_pk_fma_f32 v[98:99], v[186:187], v[194:195], v[98:99] op_sel_hi:[0,1,1] neg_lo:[1,0,0] neg_hi:[1,0,0]
    v_pk_fma_f32 v[100:101], v[186:187], v[196:197], v[100:101] op_sel_hi:[0,1,1] neg_lo:[1,0,0] neg_hi:[1,0,0]
    v_pk_fma_f32 v[102:103], v[186:187], v[198:199], v[102:103] op_sel_hi:[0,1,1] neg_lo:[1,0,0] neg_hi:[1,0,0]
    v_cvt_pk_bf16_f32 v116, v96, v97
    v_cvt_pk_bf16_f32 v117, v98, v99
    v_cvt_pk_bf16_f32 v118, v100, v101
    v_cvt_pk_bf16_f32 v119, v102, v103
    v_mfma_f32_16x16x32_bf16 v[120:123], v[172:175], v[104:107], 0
    v_mfma_f32_16x16x32_bf16 v[124:127], v[176:179], v[104:107], 0
    v_mfma_f32_16x16x32_bf16 v[128:131], v[172:175], v[108:111], 0
    v_mfma_f32_16x16x32_bf16 v[132:135], v[176:179], v[108:111], 0
    v_mfma_f32_16x16x32_bf16 v[136:139], v[172:175], v[112:115], 0
    v_mfma_f32_16x16x32_bf16 v[140:143], v[176:179], v[112:115], 0
    v_mfma_f32_16x16x32_bf16 v[144:147], v[172:175], v[116:119], 0
    v_mfma_f32_16x16x32_bf16 v[148:151], v[176:179], v[116:119], 0
    s_nop 0
    v_max3_f32 v224, v120, v121, v122
    v_min3_f32 v232, v120, v121, v122
    v_max3_f32 v224, v224, v123, v124
    v_min3_f32 v232, v232, v123, v124
    v_max3_f32 v224, v224, v125, v126
    v_min3_f32 v232, v232, v125, v126
    v_max_f32 v224, v224, v127
    v_min_f32 v232, v232, v127
    v_max3_f32 v226, v128, v129, v130
    v_min3_f32 v234, v128, v129, v130
    v_max3_f32 v226, v226, v131, v132
    v_min3_f32 v234, v234, v131, v132
    v_max3_f32 v226, v226, v133, v134
    v_min3_f32 v234, v234, v133, v134
    v_max_f32 v226, v226, v135
    v_min_f32 v234, v234, v135
    v_max3_f32 v228, v136, v137, v138
    v_min3_f32 v236, v136, v137, v138
    v_max3_f32 v228, v228, v139, v140
    v_min3_f32 v236, v236, v139, v140
    v_max3_f32 v228, v228, v141, v142
    v_min3_f32 v236, v236, v141, v142
    v_max_f32 v228, v228, v143
    v_min_f32 v236, v236, v143
    v_max3_f32 v230, v144, v145, v146
    v_min3_f32 v238, v144, v145, v146
    v_max3_f32 v230, v230, v147, v148
    v_min3_f32 v238, v238, v147, v148
    v_max3_f32 v230, v230, v149, v150
    v_min3_f32 v238, v238, v149, v150
    v_max_f32 v230, v230, v151
    v_min_f32 v238, v238, v151
    v_permlane32_swap_b32 v224, v228
    v_permlane32_swap_b32 v226, v230
    v_permlane32_swap_b32 v232, v236
    v_permlane32_swap_b32 v234, v238
    v_max_f32 v224, v224, v228
    v_max_f32 v226, v226, v230
    v_min_f32 v232, v232, v236
    v_min_f32 v234, v234, v238
    v_permlane16_swap_b32 v224, v226
    s_nop 0
    v_permlane16_swap_b32 v232, v234
    v_max_f32 v224, v224, v226
    v_min_f32 v232, v232, v234
    v_mul_f32 v224, v224, v181
    v_mul_f32 v232, v232, v181
    v_mov_b32 v226, v224
    v_mov_b32 v234, v232
    s_nop 0
    v_permlane16_swap_b32 v224, v226
    v_permlane16_swap_b32 v232, v234
    v_mov_b32 v228, v224
    v_mov_b32 v230, v226
    v_mov_b32 v236, v232
    v_mov_b32 v238, v234
    v_permlane32_swap_b32 v224, v228
    v_permlane32_swap_b32 v226, v230
    v_permlane32_swap_b32 v232, v236
    v_permlane32_swap_b32 v234, v238
    v_pk_fma_f32 v[8:9], v[120:121], v[248:249], v[224:225] op_sel_hi:[1,0,0] neg_lo:[0,0,1] neg_hi:[0,0,1]
    v_pk_fma_f32 v[16:17], v[120:121], v[248:249], v[232:233] op_sel_hi:[1,0,0] neg_lo:[1,0,0] neg_hi:[1,0,0]
    v_pk_fma_f32 v[10:11], v[122:123], v[248:249], v[224:225] op_sel_hi:[1,0,0] neg_lo:[0,0,1] neg_hi:[0,0,1]
    v_pk_fma_f32 v[18:19], v[122:123], v[248:249], v[232:233] op_sel_hi:[1,0,0] neg_lo:[1,0,0] neg_hi:[1,0,0]
    v_pk_fma_f32 v[12:13], v[124:125], v[248:249], v[224:225] op_sel_hi:[1,0,0] neg_lo:[0,0,1] neg_hi:[0,0,1]
    v_pk_fma_f32 v[20:21], v[124:125], v[248:249], v[232:233] op_sel_hi:[1,0,0] neg_lo:[1,0,0] neg_hi:[1,0,0]
    v_pk_fma_f32 v[14:15], v[126:127], v[248:249], v[224:225] op_sel_hi:[1,0,0] neg_lo:[0,0,1] neg_hi:[0,0,1]
    v_pk_fma_f32 v[22:23], v[126:127], v[248:249], v[232:233] op_sel_hi:[1,0,0] neg_lo:[1,0,0] neg_hi:[1,0,0]
    v_exp_f32 v8, v8
    v_exp_f32 v9, v9
    v_exp_f32 v10, v10
    v_exp_f32 v11, v11
    v_exp_f32 v12, v12
    v_exp_f32 v13, v13
    v_exp_f32 v14, v14
    v_exp_f32 v15, v15
    v_exp_f32 v16, v16
    v_exp_f32 v17, v17
    v_exp_f32 v18, v18
    v_exp_f32 v19, v19
    v_exp_f32 v20, v20
    v_exp_f32 v21, v21
    v_exp_f32 v22, v22
    v_exp_f32 v23, v23
    v_pk_fma_f32 v[24:25], v[128:129], v[250:251], v[226:227] op_sel_hi:[1,0,0] neg_lo:[0,0,1] neg_hi:[0,0,1]
    v_pk_fma_f32 v[32:33], v[128:129], v[250:251], v[234:235] op_sel_hi:[1,0,0] neg_lo:[1,0,0] neg_hi:[1,0,0]
    v_pk_fma_f32 v[26:27], v[130:131], v[250:251], v[226:227] op_sel_hi:[1,0,0] neg_lo:[0,0,1] neg_hi:[0,0,1]
    v_pk_fma_f32 v[34:35], v[130:131], v[250:251], v[234:235] op_sel_hi:[1,0,0] neg_lo:[1,0,0] neg_hi:[1,0,0]
    v_pk_fma_f32 v[28:29], v[132:133], v[250:251], v[226:227] op_sel_hi:[1,0,0] neg_lo:[0,0,1] neg_hi:[0,0,1]
    v_pk_fma_f32 v[36:37], v[132:133], v[250:251], v[234:235] op_sel_hi:[1,0,0] neg_lo:[1,0,0] neg_hi:[1,0,0]
    v_pk_fma_f32 v[30:31], v[134:135], v[250:251], v[226:227] op_sel_hi:[1,0,0] neg_lo:[0,0,1] neg_hi:[0,0,1]
    v_pk_fma_f32 v[38:39], v[134:135], v[250:251], v[234:235] op_sel_hi:[1,0,0] neg_lo:[1,0,0] neg_hi:[1,0,0]
    v_exp_f32 v24, v24
    v_exp_f32 v25, v25
    v_exp_f32 v26, v26
    v_exp_f32 v27, v27
    v_exp_f32 v28, v28
    v_exp_f32 v29, v29
    v_exp_f32 v30, v30
    v_exp_f32 v31, v31
    v_exp_f32 v32, v32
    v_exp_f32 v33, v33
    v_exp_f32 v34, v34
    v_exp_f32 v35, v35
    v_exp_f32 v36, v36
    v_exp_f32 v37, v37
    v_exp_f32 v38, v38
    v_exp_f32 v39, v39
    v_pk_fma_f32 v[40:41], v[136:137], v[252:253], v[228:229] op_sel_hi:[1,0,0] neg_lo:[0,0,1] neg_hi:[0,0,1]
    v_pk_fma_f32 v[48:49], v[136:137], v[252:253], v[236:237] op_sel_hi:[1,0,0] neg_lo:[1,0,0] neg_hi:[1,0,0]
    v_pk_fma_f32 v[42:43], v[138:139], v[252:253], v[228:229] op_sel_hi:[1,0,0] neg_lo:[0,0,1] neg_hi:[0,0,1]
    v_pk_fma_f32 v[50:51], v[138:139], v[252:253], v[236:237] op_sel_hi:[1,0,0] neg_lo:[1,0,0] neg_hi:[1,0,0]
    v_pk_fma_f32 v[44:45], v[140:141], v[252:253], v[228:229] op_sel_hi:[1,0,0] neg_lo:[0,0,1] neg_hi:[0,0,1]
    v_pk_fma_f32 v[52:53], v[140:141], v[252:253], v[236:237] op_sel_hi:[1,0,0] neg_lo:[1,0,0] neg_hi:[1,0,0]
    v_pk_fma_f32 v[46:47], v[142:143], v[252:253], v[228:229] op_sel_hi:[1,0,0] neg_lo:[0,0,1] neg_hi:[0,0,1]
    v_pk_fma_f32 v[54:55], v[142:143], v[252:253], v[236:237] op_sel_hi:[1,0,0] neg_lo:[1,0,0] neg_hi:[1,0,0]
    v_exp_f32 v40, v40
    v_exp_f32 v41, v41
    v_exp_f32 v42, v42
    v_exp_f32 v43, v43
    v_exp_f32 v44, v44
    v_exp_f32 v45, v45
    v_exp_f32 v46, v46
    v_exp_f32 v47, v47
    v_exp_f32 v48, v48
    v_exp_f32 v49, v49
    v_exp_f32 v50, v50
    v_exp_f32 v51, v51
    v_exp_f32 v52, v52
    v_exp_f32 v53, v53
    v_exp_f32 v54, v54
    v_exp_f32 v55, v55
    v_pk_fma_f32 v[56:57], v[144:145], v[254:255], v[230:231] op_sel_hi:[1,0,0] neg_lo:[0,0,1] neg_hi:[0,0,1]
    v_pk_fma_f32 v[64:65], v[144:145], v[254:255], v[238:239] op_sel_hi:[1,0,0] neg_lo:[1,0,0] neg_hi:[1,0,0]
    v_pk_fma_f32 v[58:59], v[146:147], v[254:255], v[230:231] op_sel_hi:[1,0,0] neg_lo:[0,0,1] neg_hi:[0,0,1]
    v_pk_fma_f32 v[66:67], v[146:147], v[254:255], v[238:239] op_sel_hi:[1,0,0] neg_lo:[1,0,0] neg_hi:[1,0,0]
    v_pk_fma_f32 v[60:61], v[148:149], v[254:255], v[230:231] op_sel_hi:[1,0,0] neg_lo:[0,0,1] neg_hi:[0,0,1]
    v_pk_fma_f32 v[68:69], v[148:149], v[254:255], v[238:239] op_sel_hi:[1,0,0] neg_lo:[1,0,0] neg_hi:[1,0,0]
    v_pk_fma_f32 v[62:63], v[150:151], v[254:255], v[230:231] op_sel_hi:[1,0,0] neg_lo:[0,0,1] neg_hi:[0,0,1]
    v_pk_fma_f32 v[70:71], v[150:151], v[254:255], v[238:239] op_sel_hi:[1,0,0] neg_lo:[1,0,0] neg_hi:[1,0,0]
    v_exp_f32 v56, v56
    v_exp_f32 v57, v57
    v_exp_f32 v58, v58
    v_exp_f32 v59, v59
    v_exp_f32 v60, v60
    v_exp_f32 v61, v61
    v_exp_f32 v62, v62
    v_exp_f32 v63, v63
    v_exp_f32 v64, v64
    v_exp_f32 v65, v65
    v_exp_f32 v66, v66
    v_exp_f32 v67, v67
    v_exp_f32 v68, v68
    v_exp_f32 v69, v69
    v_exp_f32 v70, v70
    v_exp_f32 v71, v71
    v_pk_add_f32 v[120:121], v[8:9], v[10:11]
    v_pk_add_f32 v[122:123], v[12:13], v[14:15]
    v_pk_add_f32 v[124:125], v[16:17], v[18:19]
    v_pk_add_f32 v[126:127], v[20:21], v[22:23]
    v_pk_add_f32 v[128:129], v[24:25], v[26:27]
    v_pk_add_f32 v[130:131], v[28:29], v[30:31]
    v_pk_add_f32 v[132:133], v[32:33], v[34:35]
    v_pk_add_f32 v[134:135], v[36:37], v[38:39]
    v_pk_add_f32 v[136:137], v[40:41], v[42:43]
    v_pk_add_f32 v[138:139], v[44:45], v[46:47]
    v_pk_add_f32 v[140:141], v[48:49], v[50:51]
    v_pk_add_f32 v[142:143], v[52:53], v[54:55]
    v_pk_add_f32 v[144:145], v[56:57], v[58:59]
    v_pk_add_f32 v[146:147], v[60:61], v[62:63]
    v_pk_add_f32 v[148:149], v[64:65], v[66:67]
    v_pk_add_f32 v[150:151], v[68:69], v[70:71]
    v_pk_add_f32 v[120:121], v[120:121], v[122:123]
    v_pk_add_f32 v[124:125], v[124:125], v[126:127]
    v_pk_add_f32 v[128:129], v[128:129], v[130:131]
    v_pk_add_f32 v[132:133], v[132:133], v[134:135]
    v_pk_add_f32 v[136:137], v[136:137], v[138:139]
    v_pk_add_f32 v[140:141], v[140:141], v[142:143]
    v_pk_add_f32 v[144:145], v[144:145], v[146:147]
    v_pk_add_f32 v[148:149], v[148:149], v[150:151]
    v_add_f32 v224, v120, v121
    v_add_f32 v232, v124, v125
    v_add_f32 v226, v128, v129
    v_add_f32 v234, v132, v133
    v_add_f32 v228, v136, v137
    v_add_f32 v236, v140, v141
    v_add_f32 v230, v144, v145
    v_add_f32 v238, v148, v149
    v_permlane32_swap_b32 v224, v228
    v_permlane32_swap_b32 v226, v230
    v_permlane32_swap_b32 v232, v236
    v_permlane32_swap_b32 v234, v238
    v_add_f32 v224, v224, v228
    v_add_f32 v226, v226, v230
    v_add_f32 v232, v232, v236
    v_add_f32 v234, v234, v238
    v_permlane16_swap_b32 v224, v226
    s_nop 0
    v_permlane16_swap_b32 v232, v234
    v_add_f32 v224, v224, v226
    v_add_f32 v232, v232, v234
    v_rcp_f32 v232, v232
    s_lshl_b32 s3, s29, 12
    s_add_u32 s3, s3, 140800
    v_add_u32 v240, s3, v5
    s_lshl_b32 s3, s29, 7
    s_add_u32 s3, s3, 148992
    v_lshl_add_u32 v241, v2, 3, s3
    v_mul_f32 v232, v232, v224
    v_mul_f32 v224, 0x358637bd, v224
    v_mov_b32 v226, v224
    v_mov_b32 v234, v232
    s_nop 0
    v_permlane16_swap_b32 v224, v226
    v_permlane16_swap_b32 v232, v234
    v_mov_b32 v228, v224
    v_mov_b32 v230, v226
    v_mov_b32 v236, v232
    v_mov_b32 v238, v234
    v_permlane32_swap_b32 v224, v228
    v_permlane32_swap_b32 v226, v230
    v_permlane32_swap_b32 v232, v236
    v_permlane32_swap_b32 v234, v238
    v_pk_mul_f32 v[16:17], v[16:17], v[232:233] op_sel_hi:[1,0]
    v_pk_mul_f32 v[18:19], v[18:19], v[232:233] op_sel_hi:[1,0]
    v_pk_mul_f32 v[20:21], v[20:21], v[232:233] op_sel_hi:[1,0]
    v_pk_mul_f32 v[22:23], v[22:23], v[232:233] op_sel_hi:[1,0]
    v_cvt_pk_bf16_f32 v72, v8, v9
    v_cvt_pk_bf16_f32 v73, v10, v11
    v_cvt_pk_bf16_f32 v74, v12, v13
    v_cvt_pk_bf16_f32 v75, v14, v15
    v_cvt_pk_bf16_f32 v76, v16, v17
    v_cvt_pk_bf16_f32 v77, v18, v19
    v_cvt_pk_bf16_f32 v78, v20, v21
    v_cvt_pk_bf16_f32 v79, v22, v23
    v_pk_mul_f32 v[32:33], v[32:33], v[234:235] op_sel_hi:[1,0]
    v_pk_mul_f32 v[34:35], v[34:35], v[234:235] op_sel_hi:[1,0]
    v_pk_mul_f32 v[36:37], v[36:37], v[234:235] op_sel_hi:[1,0]
    v_pk_mul_f32 v[38:39], v[38:39], v[234:235] op_sel_hi:[1,0]
    v_cvt_pk_bf16_f32 v80, v24, v25
    v_cvt_pk_bf16_f32 v81, v26, v27
    v_cvt_pk_bf16_f32 v82, v28, v29
    v_cvt_pk_bf16_f32 v83, v30, v31
    v_cvt_pk_bf16_f32 v84, v32, v33
    v_cvt_pk_bf16_f32 v85, v34, v35
    v_cvt_pk_bf16_f32 v86, v36, v37
    v_cvt_pk_bf16_f32 v87, v38, v39
    v_pk_mul_f32 v[48:49], v[48:49], v[236:237] op_sel_hi:[1,0]
    v_pk_mul_f32 v[50:51], v[50:51], v[236:237] op_sel_hi:[1,0]
    v_pk_mul_f32 v[52:53], v[52:53], v[236:237] op_sel_hi:[1,0]
    v_pk_mul_f32 v[54:55], v[54:55], v[236:237] op_sel_hi:[1,0]
    v_cvt_pk_bf16_f32 v88, v40, v41
    v_cvt_pk_bf16_f32 v89, v42, v43
    v_cvt_pk_bf16_f32 v90, v44, v45
    v_cvt_pk_bf16_f32 v91, v46, v47
    v_cvt_pk_bf16_f32 v92, v48, v49
    v_cvt_pk_bf16_f32 v93, v50, v51
    v_cvt_pk_bf16_f32 v94, v52, v53
    v_cvt_pk_bf16_f32 v95, v54, v55
    v_pk_mul_f32 v[64:65], v[64:65], v[238:239] op_sel_hi:[1,0]
    v_pk_mul_f32 v[66:67], v[66:67], v[238:239] op_sel_hi:[1,0]
    v_pk_mul_f32 v[68:69], v[68:69], v[238:239] op_sel_hi:[1,0]
    v_pk_mul_f32 v[70:71], v[70:71], v[238:239] op_sel_hi:[1,0]
    v_cvt_pk_bf16_f32 v96, v56, v57
    v_cvt_pk_bf16_f32 v97, v58, v59
    v_cvt_pk_bf16_f32 v98, v60, v61
    v_cvt_pk_bf16_f32 v99, v62, v63
    v_cvt_pk_bf16_f32 v100, v64, v65
    v_cvt_pk_bf16_f32 v101, v66, v67
    v_cvt_pk_bf16_f32 v102, v68, v69
    v_cvt_pk_bf16_f32 v103, v70, v71
    s_and_b32 s34, s33, 0x7ff
    s_sub_u32 s34, 2047, s34
    s_lshr_b32 s3, s34, 7
    s_cmp_eq_u32 s3, s30
    s_cselect_b32 s35, 1, 0
    s_lshl_b32 s3, s36, 3
    s_lshl_b32 s65, s28, 2
    s_add_u32 s3, s3, s65
    s_lshl_b32 s3, s3, 5
    s_lshl_b32 s65, s37, 1
    s_add_u32 s65, s65, s29
    s_add_u32 s3, s3, s65
    s_lshl_b32 s3, s3, 10
    s_add_u32 s3, s3, 12582912
    buffer_load_dwordx4 v[200:203], v246, s[4:7], 0 offen offset:0
    buffer_load_dwordx4 v[204:207], v246, s[4:7], 0 offen offset:64
    buffer_load_dwordx4 v[208:211], v246, s[4:7], s68 offen offset:0
    buffer_load_dwordx4 v[212:215], v246, s[4:7], s68 offen offset:64
    s_barrier
    ds_read_b128 v[104:107], v240 offset:0
    ds_read_b128 v[108:111], v240 offset:1024
    ds_read_b128 v[112:115], v240 offset:2048
    ds_read_b128 v[116:119], v240 offset:3072
    ds_read_b64 v[120:121], v241 offset:0
    ds_read_b64 v[122:123], v241 offset:32
    ds_read_b64 v[124:125], v241 offset:64
    ds_read_b64 v[126:127], v241 offset:96
    s_waitcnt lgkmcnt(0)
    v_mfma_f32_16x16x32_bf16 v[40:43], v[120:123], v[72:75], 0
    v_mfma_f32_16x16x32_bf16 v[40:43], v[124:127], v[76:79], v[40:43]
    v_mfma_f32_16x16x32_bf16 v[44:47], v[120:123], v[80:83], 0
    v_mfma_f32_16x16x32_bf16 v[44:47], v[124:127], v[84:87], v[44:47]
    v_mfma_f32_16x16x32_bf16 v[48:51], v[120:123], v[88:91], 0
    v_mfma_f32_16x16x32_bf16 v[48:51], v[124:127], v[92:95], v[48:51]
    v_mfma_f32_16x16x32_bf16 v[52:55], v[120:123], v[96:99], 0
    v_mfma_f32_16x16x32_bf16 v[52:55], v[124:127], v[100:103], v[52:55]
    v_mfma_f32_16x16x32_bf16 v[8:11], v[104:107], v[72:75], 0
    v_mfma_f32_16x16x32_bf16 v[8:11], v[112:115], v[76:79], v[8:11]
    v_mfma_f32_16x16x32_bf16 v[12:15], v[108:111], v[72:75], 0
    v_mfma_f32_16x16x32_bf16 v[12:15], v[116:119], v[76:79], v[12:15]
    v_add_f32 v40, v40, v224
    v_add_f32 v44, v44, v226
    v_add_f32 v48, v48, v228
    s_nop 0
    v_add_f32 v52, v52, v230
    v_mfma_f32_16x16x32_bf16 v[16:19], v[104:107], v[80:83], 0
    v_mfma_f32_16x16x32_bf16 v[16:19], v[112:115], v[84:87], v[16:19]
    v_mfma_f32_16x16x32_bf16 v[20:23], v[108:111], v[80:83], 0
    v_mfma_f32_16x16x32_bf16 v[20:23], v[116:119], v[84:87], v[20:23]
    v_rcp_f32 v40, v40
    v_rcp_f32 v44, v44
    v_rcp_f32 v48, v48
    v_rcp_f32 v52, v52
    v_mfma_f32_16x16x32_bf16 v[24:27], v[104:107], v[88:91], 0
    v_mfma_f32_16x16x32_bf16 v[24:27], v[112:115], v[92:95], v[24:27]
    v_mfma_f32_16x16x32_bf16 v[28:31], v[108:111], v[88:91], 0
    v_mfma_f32_16x16x32_bf16 v[28:31], v[116:119], v[92:95], v[28:31]
    v_mfma_f32_16x16x32_bf16 v[32:35], v[104:107], v[96:99], 0
    v_mfma_f32_16x16x32_bf16 v[32:35], v[112:115], v[100:103], v[32:35]
    v_mfma_f32_16x16x32_bf16 v[36:39], v[108:111], v[96:99], 0
    v_mfma_f32_16x16x32_bf16 v[36:39], v[116:119], v[100:103], v[36:39]
    v_pk_mul_f32 v[8:9], v[8:9], v[40:41] op_sel_hi:[1,0]
    v_pk_mul_f32 v[10:11], v[10:11], v[40:41] op_sel_hi:[1,0]
    v_pk_mul_f32 v[12:13], v[12:13], v[40:41] op_sel_hi:[1,0]
    v_pk_mul_f32 v[14:15], v[14:15], v[40:41] op_sel_hi:[1,0]
    v_cvt_pk_bf16_f32 v128, v8, v9
    v_cvt_pk_bf16_f32 v129, v10, v11
    v_cvt_pk_bf16_f32 v130, v12, v13
    v_cvt_pk_bf16_f32 v131, v14, v15
    buffer_store_dwordx4 v[128:131], v5, s[12:15], s3 offen sc1
    s_add_u32 s3, s3, 32768
    v_pk_mul_f32 v[16:17], v[16:17], v[44:45] op_sel_hi:[1,0]
    v_pk_mul_f32 v[18:19], v[18:19], v[44:45] op_sel_hi:[1,0]
    v_pk_mul_f32 v[20:21], v[20:21], v[44:45] op_sel_hi:[1,0]
    v_pk_mul_f32 v[22:23], v[22:23], v[44:45] op_sel_hi:[1,0]
    v_cvt_pk_bf16_f32 v132, v16, v17
    v_cvt_pk_bf16_f32 v133, v18, v19
    v_cvt_pk_bf16_f32 v134, v20, v21
    v_cvt_pk_bf16_f32 v135, v22, v23
    buffer_store_dwordx4 v[132:135], v5, s[12:15], s3 offen sc1
    s_add_u32 s3, s3, 32768
    v_pk_mul_f32 v[24:25], v[24:25], v[48:49] op_sel_hi:[1,0]
    v_pk_mul_f32 v[26:27], v[26:27], v[48:49] op_sel_hi:[1,0]
    v_pk_mul_f32 v[28:29], v[28:29], v[48:49] op_sel_hi:[1,0]
    v_pk_mul_f32 v[30:31], v[30:31], v[48:49] op_sel_hi:[1,0]
    v_cvt_pk_bf16_f32 v136, v24, v25
    v_cvt_pk_bf16_f32 v137, v26, v27
    v_cvt_pk_bf16_f32 v138, v28, v29
    v_cvt_pk_bf16_f32 v139, v30, v31
    buffer_store_dwordx4 v[136:139], v5, s[12:15], s3 offen sc1
    s_add_u32 s3, s3, 32768
    v_pk_mul_f32 v[32:33], v[32:33], v[52:53] op_sel_hi:[1,0]
    v_pk_mul_f32 v[34:35], v[34:35], v[52:53] op_sel_hi:[1,0]
    v_pk_mul_f32 v[36:37], v[36:37], v[52:53] op_sel_hi:[1,0]
    v_pk_mul_f32 v[38:39], v[38:39], v[52:53] op_sel_hi:[1,0]
    v_cvt_pk_bf16_f32 v140, v32, v33
    v_cvt_pk_bf16_f32 v141, v34, v35
    v_cvt_pk_bf16_f32 v142, v36, v37
    v_cvt_pk_bf16_f32 v143, v38, v39
    buffer_store_dwordx4 v[140:143], v5, s[12:15], s3 offen sc1
    s_mov_b32 s24, s58
    s_mov_b32 s25, s59
    s_mov_b32 s26, 4194304
    s_mov_b32 s27, 0x00020000
    s_lshl_b32 s3, s38, 7
    s_add_u32 s3, s3, 136704
    v_lshl_add_u32 v6, v3, 2, s3
    ds_read_b32 v144, v6 offset:0
    ds_read_b32 v148, v6 offset:512
    ds_read_b32 v146, v6 offset:64
    ds_read_b32 v150, v6 offset:576
    v_lshrrev_b32 v6, 2, v1
    v_lshlrev_b32 v6, 7, v6
    v_and_b32 v7, 3, v1
    v_lshl_add_u32 v6, v7, 3, v6
    v_bfe_u32 v7, v1, 3, 2
    v_xor_b32 v4, 0, v7
    v_lshl_add_u32 v250, v4, 5, v6
    v_xor_b32 v4, 1, v7
    v_lshl_add_u32 v251, v4, 5, v6
    v_xor_b32 v4, 2, v7
    v_lshl_add_u32 v252, v4, 5, v6
    v_xor_b32 v4, 3, v7
    v_lshl_add_u32 v253, v4, 5, v6
    s_lshl_b32 s72, s30, 3
    s_lshl_b32 s3, s38, 1
    s_add_u32 s72, s72, s3
    s_lshl_b32 s72, s72, 15
    s_add_u32 s72, s72, 12582912
    v_add_u32 v4, 32768, v5
    s_mov_b32 s71, 0xbfb8aa3b
    s_waitcnt vmcnt(4) lgkmcnt(0)
    v_lshlrev_b32 v176, 16, v200
    v_and_b32 v177, 0xffff0000, v200
    v_lshlrev_b32 v178, 16, v201
    v_and_b32 v179, 0xffff0000, v201
    v_lshlrev_b32 v180, 16, v202
    v_and_b32 v181, 0xffff0000, v202
    v_lshlrev_b32 v182, 16, v203
    v_and_b32 v183, 0xffff0000, v203
    v_lshlrev_b32 v184, 16, v204
    v_and_b32 v185, 0xffff0000, v204
    v_lshlrev_b32 v186, 16, v205
    v_and_b32 v187, 0xffff0000, v205
    v_lshlrev_b32 v188, 16, v206
    v_and_b32 v189, 0xffff0000, v206
    v_lshlrev_b32 v190, 16, v207
    v_and_b32 v191, 0xffff0000, v207
    v_lshlrev_b32 v192, 16, v208
    v_and_b32 v193, 0xffff0000, v208
    v_lshlrev_b32 v194, 16, v209
    v_and_b32 v195, 0xffff0000, v209
    v_lshlrev_b32 v196, 16, v210
    v_and_b32 v197, 0xffff0000, v210
    v_lshlrev_b32 v198, 16, v211
    v_and_b32 v199, 0xffff0000, v211
    v_lshlrev_b32 v200, 16, v212
    v_and_b32 v201, 0xffff0000, v212
    v_lshlrev_b32 v202, 16, v213
    v_and_b32 v203, 0xffff0000, v213
    v_lshlrev_b32 v204, 16, v214
    v_and_b32 v205, 0xffff0000, v214
    v_lshlrev_b32 v206, 16, v215
    v_and_b32 v207, 0xffff0000, v215
    v_pk_add_f32 v[208:209], v[176:177], v[144:145] op_sel_hi:[1,0] neg_lo:[0,1] neg_hi:[0,1]
    v_pk_add_f32 v[210:211], v[178:179], v[144:145] op_sel_hi:[1,0] neg_lo:[0,1] neg_hi:[0,1]
    v_pk_add_f32 v[212:213], v[180:181], v[144:145] op_sel_hi:[1,0] neg_lo:[0,1] neg_hi:[0,1]
    v_pk_add_f32 v[214:215], v[182:183], v[144:145] op_sel_hi:[1,0] neg_lo:[0,1] neg_hi:[0,1]
    v_pk_add_f32 v[216:217], v[184:185], v[144:145] op_sel_hi:[1,0] neg_lo:[0,1] neg_hi:[0,1]
    v_pk_add_f32 v[218:219], v[186:187], v[144:145] op_sel_hi:[1,0] neg_lo:[0,1] neg_hi:[0,1]
    v_pk_add_f32 v[220:221], v[188:189], v[144:145] op_sel_hi:[1,0] neg_lo:[0,1] neg_hi:[0,1]
    v_pk_add_f32 v[222:223], v[190:191], v[144:145] op_sel_hi:[1,0] neg_lo:[0,1] neg_hi:[0,1]
    v_pk_add_f32 v[224:225], v[192:193], v[146:147] op_sel_hi:[1,0] neg_lo:[0,1] neg_hi:[0,1]
    v_pk_add_f32 v[226:227], v[194:195], v[146:147] op_sel_hi:[1,0] neg_lo:[0,1] neg_hi:[0,1]
    v_pk_add_f32 v[228:229], v[196:197], v[146:147] op_sel_hi:[1,0] neg_lo:[0,1] neg_hi:[0,1]
    v_pk_add_f32 v[230:231], v[198:199], v[146:147] op_sel_hi:[1,0] neg_lo:[0,1] neg_hi:[0,1]
    v_pk_add_f32 v[232:233], v[200:201], v[146:147] op_sel_hi:[1,0] neg_lo:[0,1] neg_hi:[0,1]
    v_pk_add_f32 v[234:235], v[202:203], v[146:147] op_sel_hi:[1,0] neg_lo:[0,1] neg_hi:[0,1]
    v_pk_add_f32 v[236:237], v[204:205], v[146:147] op_sel_hi:[1,0] neg_lo:[0,1] neg_hi:[0,1]
    v_pk_add_f32 v[238:239], v[206:207], v[146:147] op_sel_hi:[1,0] neg_lo:[0,1] neg_hi:[0,1]
    v_cvt_pk_bf16_f32 v72, v208, v209
    v_cvt_pk_bf16_f32 v73, v210, v211
    v_cvt_pk_bf16_f32 v74, v212, v213
    v_cvt_pk_bf16_f32 v75, v214, v215
    v_cvt_pk_bf16_f32 v76, v216, v217
    v_cvt_pk_bf16_f32 v77, v218, v219
    v_cvt_pk_bf16_f32 v78, v220, v221
    v_cvt_pk_bf16_f32 v79, v222, v223
    v_cvt_pk_bf16_f32 v80, v224, v225
    v_cvt_pk_bf16_f32 v81, v226, v227
    v_cvt_pk_bf16_f32 v82, v228, v229
    v_cvt_pk_bf16_f32 v83, v230, v231
    v_cvt_pk_bf16_f32 v84, v232, v233
    v_cvt_pk_bf16_f32 v85, v234, v235
    v_cvt_pk_bf16_f32 v86, v236, v237
    v_cvt_pk_bf16_f32 v87, v238, v239
    v_lshlrev_b32 v208, 16, v72
    v_and_b32 v209, 0xffff0000, v72
    v_lshlrev_b32 v210, 16, v73
    v_and_b32 v211, 0xffff0000, v73
    v_lshlrev_b32 v212, 16, v74
    v_and_b32 v213, 0xffff0000, v74
    v_lshlrev_b32 v214, 16, v75
    v_and_b32 v215, 0xffff0000, v75
    v_lshlrev_b32 v216, 16, v76
    v_and_b32 v217, 0xffff0000, v76
    v_lshlrev_b32 v218, 16, v77
    v_and_b32 v219, 0xffff0000, v77
    v_lshlrev_b32 v220, 16, v78
    v_and_b32 v221, 0xffff0000, v78
    v_lshlrev_b32 v222, 16, v79
    v_and_b32 v223, 0xffff0000, v79
    v_lshlrev_b32 v224, 16, v80
    v_and_b32 v225, 0xffff0000, v80
    v_lshlrev_b32 v226, 16, v81
    v_and_b32 v227, 0xffff0000, v81
    v_lshlrev_b32 v228, 16, v82
    v_and_b32 v229, 0xffff0000, v82
    v_lshlrev_b32 v230, 16, v83
    v_and_b32 v231, 0xffff0000, v83
    v_lshlrev_b32 v232, 16, v84
    v_and_b32 v233, 0xffff0000, v84
    v_lshlrev_b32 v234, 16, v85
    v_and_b32 v235, 0xffff0000, v85
    v_lshlrev_b32 v236, 16, v86
    v_and_b32 v237, 0xffff0000, v86
    v_lshlrev_b32 v238, 16, v87
    v_and_b32 v239, 0xffff0000, v87
    v_pk_mul_f32 v[208:209], v[208:209], v[148:149] op_sel_hi:[1,0]
    v_pk_mul_f32 v[210:211], v[210:211], v[148:149] op_sel_hi:[1,0]
    v_pk_mul_f32 v[212:213], v[212:213], v[148:149] op_sel_hi:[1,0]
    v_pk_mul_f32 v[214:215], v[214:215], v[148:149] op_sel_hi:[1,0]
    v_pk_mul_f32 v[216:217], v[216:217], v[148:149] op_sel_hi:[1,0]
    v_pk_mul_f32 v[218:219], v[218:219], v[148:149] op_sel_hi:[1,0]
    v_pk_mul_f32 v[220:221], v[220:221], v[148:149] op_sel_hi:[1,0]
    v_pk_mul_f32 v[222:223], v[222:223], v[148:149] op_sel_hi:[1,0]
    v_pk_mul_f32 v[224:225], v[224:225], v[150:151] op_sel_hi:[1,0]
    v_pk_mul_f32 v[226:227], v[226:227], v[150:151] op_sel_hi:[1,0]
    v_pk_mul_f32 v[228:229], v[228:229], v[150:151] op_sel_hi:[1,0]
    v_pk_mul_f32 v[230:231], v[230:231], v[150:151] op_sel_hi:[1,0]
    v_pk_mul_f32 v[232:233], v[232:233], v[150:151] op_sel_hi:[1,0]
    v_pk_mul_f32 v[234:235], v[234:235], v[150:151] op_sel_hi:[1,0]
    v_pk_mul_f32 v[236:237], v[236:237], v[150:151] op_sel_hi:[1,0]
    v_pk_mul_f32 v[238:239], v[238:239], v[150:151] op_sel_hi:[1,0]
    v_cvt_pk_bf16_f32 v72, v208, v209
    v_cvt_pk_bf16_f32 v73, v210, v211
    v_cvt_pk_bf16_f32 v74, v212, v213
    v_cvt_pk_bf16_f32 v75, v214, v215
    v_cvt_pk_bf16_f32 v76, v216, v217
    v_cvt_pk_bf16_f32 v77, v218, v219
    v_cvt_pk_bf16_f32 v78, v220, v221
    v_cvt_pk_bf16_f32 v79, v222, v223
    v_cvt_pk_bf16_f32 v80, v224, v225
    v_cvt_pk_bf16_f32 v81, v226, v227
    v_cvt_pk_bf16_f32 v82, v228, v229
    v_cvt_pk_bf16_f32 v83, v230, v231
    v_cvt_pk_bf16_f32 v84, v232, v233
    v_cvt_pk_bf16_f32 v85, v234, v235
    v_cvt_pk_bf16_f32 v86, v236, v237
    v_cvt_pk_bf16_f32 v87, v238, v239
    v_lshlrev_b32 v208, 16, v72
    v_and_b32 v209, 0xffff0000, v72
    v_lshlrev_b32 v210, 16, v73
    v_and_b32 v211, 0xffff0000, v73
    v_lshlrev_b32 v212, 16, v74
    v_and_b32 v213, 0xffff0000, v74
    v_lshlrev_b32 v214, 16, v75
    v_and_b32 v215, 0xffff0000, v75
    v_lshlrev_b32 v216, 16, v76
    v_and_b32 v217, 0xffff0000, v76
    v_lshlrev_b32 v218, 16, v77
    v_and_b32 v219, 0xffff0000, v77
    v_lshlrev_b32 v220, 16, v78
    v_and_b32 v221, 0xffff0000, v78
    v_lshlrev_b32 v222, 16, v79
    v_and_b32 v223, 0xffff0000, v79
    v_lshlrev_b32 v224, 16, v80
    v_and_b32 v225, 0xffff0000, v80
    v_lshlrev_b32 v226, 16, v81
    v_and_b32 v227, 0xffff0000, v81
    v_lshlrev_b32 v228, 16, v82
    v_and_b32 v229, 0xffff0000, v82
    v_lshlrev_b32 v230, 16, v83
    v_and_b32 v231, 0xffff0000, v83
    v_lshlrev_b32 v232, 16, v84
    v_and_b32 v233, 0xffff0000, v84
    v_lshlrev_b32 v234, 16, v85
    v_and_b32 v235, 0xffff0000, v85
    v_lshlrev_b32 v236, 16, v86
    v_and_b32 v237, 0xffff0000, v86
    v_lshlrev_b32 v238, 16, v87
    v_and_b32 v239, 0xffff0000, v87
    v_mul_f32 v72, s71, v208
    v_mul_f32 v73, s71, v209
    v_mul_f32 v74, s71, v210
    v_mul_f32 v75, s71, v211
    v_mul_f32 v76, s71, v212
    v_mul_f32 v77, s71, v213
    v_mul_f32 v78, s71, v214
    v_mul_f32 v79, s71, v215
    v_mul_f32 v80, s71, v216
    v_mul_f32 v81, s71, v217
    v_mul_f32 v82, s71, v218
    v_mul_f32 v83, s71, v219
    v_mul_f32 v84, s71, v220
    v_mul_f32 v85, s71, v221
    v_mul_f32 v86, s71, v222
    v_mul_f32 v87, s71, v223
    v_mul_f32 v88, s71, v224
    v_mul_f32 v89, s71, v225
    v_mul_f32 v90, s71, v226
    v_mul_f32 v91, s71, v227
    v_mul_f32 v92, s71, v228
    v_mul_f32 v93, s71, v229
    v_mul_f32 v94, s71, v230
    v_mul_f32 v95, s71, v231
    v_mul_f32 v96, s71, v232
    v_mul_f32 v97, s71, v233
    v_mul_f32 v98, s71, v234
    v_mul_f32 v99, s71, v235
    v_mul_f32 v100, s71, v236
    v_mul_f32 v101, s71, v237
    v_mul_f32 v102, s71, v238
    v_mul_f32 v103, s71, v239
    v_exp_f32 v72, v72
    v_exp_f32 v73, v73
    v_exp_f32 v74, v74
    v_exp_f32 v75, v75
    v_exp_f32 v76, v76
    v_exp_f32 v77, v77
    v_exp_f32 v78, v78
    v_exp_f32 v79, v79
    v_exp_f32 v80, v80
    v_exp_f32 v81, v81
    v_exp_f32 v82, v82
    v_exp_f32 v83, v83
    v_exp_f32 v84, v84
    v_exp_f32 v85, v85
    v_exp_f32 v86, v86
    v_exp_f32 v87, v87
    v_exp_f32 v88, v88
    v_exp_f32 v89, v89
    v_exp_f32 v90, v90
    v_exp_f32 v91, v91
    v_exp_f32 v92, v92
    v_exp_f32 v93, v93
    v_exp_f32 v94, v94
    v_exp_f32 v95, v95
    v_exp_f32 v96, v96
    v_exp_f32 v97, v97
    v_exp_f32 v98, v98
    v_exp_f32 v99, v99
    v_exp_f32 v100, v100
    v_exp_f32 v101, v101
    v_exp_f32 v102, v102
    v_exp_f32 v103, v103
    v_add_f32 v72, 1.0, v72
    v_add_f32 v73, 1.0, v73
    v_add_f32 v74, 1.0, v74
    v_add_f32 v75, 1.0, v75
    v_add_f32 v76, 1.0, v76
    v_add_f32 v77, 1.0, v77
    v_add_f32 v78, 1.0, v78
    v_add_f32 v79, 1.0, v79
    v_add_f32 v80, 1.0, v80
    v_add_f32 v81, 1.0, v81
    v_add_f32 v82, 1.0, v82
    v_add_f32 v83, 1.0, v83
    v_add_f32 v84, 1.0, v84
    v_add_f32 v85, 1.0, v85
    v_add_f32 v86, 1.0, v86
    v_add_f32 v87, 1.0, v87
    v_add_f32 v88, 1.0, v88
    v_add_f32 v89, 1.0, v89
    v_add_f32 v90, 1.0, v90
    v_add_f32 v91, 1.0, v91
    v_add_f32 v92, 1.0, v92
    v_add_f32 v93, 1.0, v93
    v_add_f32 v94, 1.0, v94
    v_add_f32 v95, 1.0, v95
    v_add_f32 v96, 1.0, v96
    v_add_f32 v97, 1.0, v97
    v_add_f32 v98, 1.0, v98
    v_add_f32 v99, 1.0, v99
    v_add_f32 v100, 1.0, v100
    v_add_f32 v101, 1.0, v101
    v_add_f32 v102, 1.0, v102
    v_add_f32 v103, 1.0, v103
    v_rcp_f32 v72, v72
    v_rcp_f32 v73, v73
    v_rcp_f32 v74, v74
    v_rcp_f32 v75, v75
    v_rcp_f32 v76, v76
    v_rcp_f32 v77, v77
    v_rcp_f32 v78, v78
    v_rcp_f32 v79, v79
    v_rcp_f32 v80, v80
    v_rcp_f32 v81, v81
    v_rcp_f32 v82, v82
    v_rcp_f32 v83, v83
    v_rcp_f32 v84, v84
    v_rcp_f32 v85, v85
    v_rcp_f32 v86, v86
    v_rcp_f32 v87, v87
    v_rcp_f32 v88, v88
    v_rcp_f32 v89, v89
    v_rcp_f32 v90, v90
    v_rcp_f32 v91, v91
    v_rcp_f32 v92, v92
    v_rcp_f32 v93, v93
    v_rcp_f32 v94, v94
    v_rcp_f32 v95, v95
    v_rcp_f32 v96, v96
    v_rcp_f32 v97, v97
    v_rcp_f32 v98, v98
    v_rcp_f32 v99, v99
    v_rcp_f32 v100, v100
    v_rcp_f32 v101, v101
    v_rcp_f32 v102, v102
    v_rcp_f32 v103, v103
    v_pk_mul_f32 v[208:209], v[208:209], v[72:73]
    v_pk_mul_f32 v[210:211], v[210:211], v[74:75]
    v_pk_mul_f32 v[212:213], v[212:213], v[76:77]
    v_pk_mul_f32 v[214:215], v[214:215], v[78:79]
    v_pk_mul_f32 v[216:217], v[216:217], v[80:81]
    v_pk_mul_f32 v[218:219], v[218:219], v[82:83]
    v_pk_mul_f32 v[220:221], v[220:221], v[84:85]
    v_pk_mul_f32 v[222:223], v[222:223], v[86:87]
    v_pk_mul_f32 v[224:225], v[224:225], v[88:89]
    v_pk_mul_f32 v[226:227], v[226:227], v[90:91]
    v_pk_mul_f32 v[228:229], v[228:229], v[92:93]
    v_pk_mul_f32 v[230:231], v[230:231], v[94:95]
    v_pk_mul_f32 v[232:233], v[232:233], v[96:97]
    v_pk_mul_f32 v[234:235], v[234:235], v[98:99]
    v_pk_mul_f32 v[236:237], v[236:237], v[100:101]
    v_pk_mul_f32 v[238:239], v[238:239], v[102:103]
    s_barrier
    ds_read_b64_tr_b16 v[40:41], v250 offset:0
    ds_read_b64_tr_b16 v[42:43], v250 offset:2048
    ds_read_b64_tr_b16 v[44:45], v251 offset:0
    ds_read_b64_tr_b16 v[46:47], v251 offset:2048
    ds_read_b64_tr_b16 v[48:49], v252 offset:0
    ds_read_b64_tr_b16 v[50:51], v252 offset:2048
    ds_read_b64_tr_b16 v[52:53], v253 offset:0
    ds_read_b64_tr_b16 v[54:55], v253 offset:2048
    v_lshlrev_b32 v6, 10, v1
    buffer_load_dword v7, v6, s[12:15], s72 offen offset:1008 sc1
    s_waitcnt vmcnt(0)
L_op:
    v_cmp_eq_u32 vcc, -1, v7
    s_nop 1
    v_cndmask_b32 v7, 0, 1, vcc
    v_cmp_ne_u32 vcc, 0, v7
    s_nop 0
    s_cmp_eq_u64 vcc, 0
    s_cbranch_scc1 L_opok
    s_add_u32 s70, s70, 1
    s_cmp_ge_u32 s70, 200000
    s_cbranch_scc1 L_opok
    s_sleep 2
    buffer_load_dword v7, v6, s[12:15], s72 offen offset:1008 sc1
    s_waitcnt vmcnt(0)
    s_branch L_op
L_opok:
    s_add_u32 s3, s88, 0
    s_and_b32 s3, s3, 15
    s_lshl_b32 s3, s3, 11
    s_add_u32 s3, s3, s72
    buffer_load_dwordx4 v[72:75], v5, s[12:15], s3 offen offset:0 sc1
    buffer_load_dwordx4 v[76:79], v4, s[12:15], s3 offen offset:0 sc1
    buffer_load_dwordx4 v[80:83], v5, s[12:15], s3 offen offset:1024 sc1
    buffer_load_dwordx4 v[84:87], v4, s[12:15], s3 offen offset:1024 sc1
    s_add_u32 s3, s88, 1
    s_and_b32 s3, s3, 15
    s_lshl_b32 s3, s3, 11
    s_add_u32 s3, s3, s72
    buffer_load_dwordx4 v[88:91], v5, s[12:15], s3 offen offset:0 sc1
    buffer_load_dwordx4 v[92:95], v4, s[12:15], s3 offen offset:0 sc1
    buffer_load_dwordx4 v[96:99], v5, s[12:15], s3 offen offset:1024 sc1
    buffer_load_dwordx4 v[100:103], v4, s[12:15], s3 offen offset:1024 sc1
    s_add_u32 s3, s88, 2
    s_and_b32 s3, s3, 15
    s_lshl_b32 s3, s3, 11
    s_add_u32 s3, s3, s72
    buffer_load_dwordx4 v[104:107], v5, s[12:15], s3 offen offset:0 sc1
    buffer_load_dwordx4 v[108:111], v4, s[12:15], s3 offen offset:0 sc1
    buffer_load_dwordx4 v[112:115], v5, s[12:15], s3 offen offset:1024 sc1
    buffer_load_dwordx4 v[116:119], v4, s[12:15], s3 offen offset:1024 sc1
    s_add_u32 s3, s88, 3
    s_and_b32 s3, s3, 15
    s_lshl_b32 s3, s3, 11
    s_add_u32 s3, s3, s72
    buffer_load_dwordx4 v[120:123], v5, s[12:15], s3 offen offset:0 sc1
    buffer_load_dwordx4 v[124:127], v4, s[12:15], s3 offen offset:0 sc1
    buffer_load_dwordx4 v[128:131], v5, s[12:15], s3 offen offset:1024 sc1
    buffer_load_dwordx4 v[132:135], v4, s[12:15], s3 offen offset:1024 sc1
    s_add_u32 s3, s88, 4
    s_and_b32 s3, s3, 15
    s_lshl_b32 s3, s3, 11
    s_add_u32 s3, s3, s72
    buffer_load_dwordx4 v[136:139], v5, s[12:15], s3 offen offset:0 sc1
    buffer_load_dwordx4 v[140:143], v4, s[12:15], s3 offen offset:0 sc1
    buffer_load_dwordx4 v[144:147], v5, s[12:15], s3 offen offset:1024 sc1
    buffer_load_dwordx4 v[148:151], v4, s[12:15], s3 offen offset:1024 sc1
    s_add_u32 s3, s88, 5
    s_and_b32 s3, s3, 15
    s_lshl_b32 s3, s3, 11
    s_add_u32 s3, s3, s72
    buffer_load_dwordx4 v[152:155], v5, s[12:15], s3 offen offset:0 sc1
    buffer_load_dwordx4 v[156:159], v4, s[12:15], s3 offen offset:0 sc1
    s_waitcnt vmcnt(20)
    v_max_u32 v7, v72, v76
    v_cmp_eq_u32 vcc, -1, v7
    s_nop 3
    s_cbranch_vccnz L_r0
L_b0:
    buffer_load_dwordx4 v[160:163], v5, s[12:15], s3 offen offset:1024 sc1
    buffer_load_dwordx4 v[164:167], v4, s[12:15], s3 offen offset:1024 sc1
    s_waitcnt lgkmcnt(0)
    v_mfma_f32_16x16x32_bf16 v[8:11], v[40:43], v[72:75], 0
    ds_read_b64_tr_b16 v[56:57], v250 offset:4096
    v_mfma_f32_16x16x32_bf16 v[12:15], v[44:47], v[72:75], 0
    ds_read_b64_tr_b16 v[58:59], v250 offset:6144
    v_mfma_f32_16x16x32_bf16 v[16:19], v[48:51], v[72:75], 0
    ds_read_b64_tr_b16 v[60:61], v251 offset:4096
    v_mfma_f32_16x16x32_bf16 v[20:23], v[52:55], v[72:75], 0
    ds_read_b64_tr_b16 v[62:63], v251 offset:6144
    v_mfma_f32_16x16x32_bf16 v[24:27], v[40:43], v[76:79], 0
    ds_read_b64_tr_b16 v[64:65], v252 offset:4096
    s_waitcnt vmcnt(20)
    v_max_u32 v7, v80, v84
    v_cmp_eq_u32 vcc, -1, v7
    v_mfma_f32_16x16x32_bf16 v[28:31], v[44:47], v[76:79], 0
    ds_read_b64_tr_b16 v[66:67], v252 offset:6144
    v_mfma_f32_16x16x32_bf16 v[32:35], v[48:51], v[76:79], 0
    ds_read_b64_tr_b16 v[68:69], v253 offset:4096
    v_mfma_f32_16x16x32_bf16 v[36:39], v[52:55], v[76:79], 0
    ds_read_b64_tr_b16 v[70:71], v253 offset:6144
    s_cbranch_vccnz L_r1
L_b1:
    s_add_u32 s3, s88, 6
    s_and_b32 s3, s3, 15
    s_lshl_b32 s3, s3, 11
    s_add_u32 s3, s3, s72
    buffer_load_dwordx4 v[72:75], v5, s[12:15], s3 offen offset:0 sc1
    buffer_load_dwordx4 v[76:79], v4, s[12:15], s3 offen offset:0 sc1
    s_waitcnt lgkmcnt(0)
    v_mfma_f32_16x16x32_bf16 v[8:11], v[56:59], v[80:83], v[8:11]
    ds_read_b64_tr_b16 v[40:41], v250 offset:8192
    v_mfma_f32_16x16x32_bf16 v[12:15], v[60:63], v[80:83], v[12:15]
    ds_read_b64_tr_b16 v[42:43], v250 offset:10240
    v_mfma_f32_16x16x32_bf16 v[16:19], v[64:67], v[80:83], v[16:19]
    ds_read_b64_tr_b16 v[44:45], v251 offset:8192
    v_mfma_f32_16x16x32_bf16 v[20:23], v[68:71], v[80:83], v[20:23]
    ds_read_b64_tr_b16 v[46:47], v251 offset:10240
    v_mfma_f32_16x16x32_bf16 v[24:27], v[56:59], v[84:87], v[24:27]
    ds_read_b64_tr_b16 v[48:49], v252 offset:8192
    s_waitcnt vmcnt(20)
    v_max_u32 v7, v88, v92
    v_cmp_eq_u32 vcc, -1, v7
    v_mfma_f32_16x16x32_bf16 v[28:31], v[60:63], v[84:87], v[28:31]
    ds_read_b64_tr_b16 v[50:51], v252 offset:10240
    v_mfma_f32_16x16x32_bf16 v[32:35], v[64:67], v[84:87], v[32:35]
    ds_read_b64_tr_b16 v[52:53], v253 offset:8192
    v_mfma_f32_16x16x32_bf16 v[36:39], v[68:71], v[84:87], v[36:39]
    ds_read_b64_tr_b16 v[54:55], v253 offset:10240
    s_cbranch_vccnz L_r2
L_b2:
    buffer_load_dwordx4 v[80:83], v5, s[12:15], s3 offen offset:1024 sc1
    buffer_load_dwordx4 v[84:87], v4, s[12:15], s3 offen offset:1024 sc1
    s_waitcnt lgkmcnt(0)
    v_mfma_f32_16x16x32_bf16 v[8:11], v[40:43], v[88:91], v[8:11]
    ds_read_b64_tr_b16 v[56:57], v250 offset:12288
    v_mfma_f32_16x16x32_bf16 v[12:15], v[44:47], v[88:91], v[12:15]
    ds_read_b64_tr_b16 v[58:59], v250 offset:14336
    v_mfma_f32_16x16x32_bf16 v[16:19], v[48:51], v[88:91], v[16:19]
    ds_read_b64_tr_b16 v[60:61], v251 offset:12288
    v_mfma_f32_16x16x32_bf16 v[20:23], v[52:55], v[88:91], v[20:23]
    ds_read_b64_tr_b16 v[62:63], v251 offset:14336
    v_mfma_f32_16x16x32_bf16 v[24:27], v[40:43], v[92:95], v[24:27]
    ds_read_b64_tr_b16 v[64:65], v252 offset:12288
    s_waitcnt vmcnt(20)
    v_max_u32 v7, v96, v100
    v_cmp_eq_u32 vcc, -1, v7
    v_mfma_f32_16x16x32_bf16 v[28:31], v[44:47], v[92:95], v[28:31]
    ds_read_b64_tr_b16 v[66:67], v252 offset:14336
    v_mfma_f32_16x16x32_bf16 v[32:35], v[48:51], v[92:95], v[32:35]
    ds_read_b64_tr_b16 v[68:69], v253 offset:12288
    v_mfma_f32_16x16x32_bf16 v[36:39], v[52:55], v[92:95], v[36:39]
    ds_read_b64_tr_b16 v[70:71], v253 offset:14336
    s_cbranch_vccnz L_r3
L_b3:
    s_add_u32 s3, s88, 7
    s_and_b32 s3, s3, 15
    s_lshl_b32 s3, s3, 11
    s_add_u32 s3, s3, s72
    buffer_load_dwordx4 v[88:91], v5, s[12:15], s3 offen offset:0 sc1
    buffer_load_dwordx4 v[92:95], v4, s[12:15], s3 offen offset:0 sc1
    s_waitcnt lgkmcnt(0)
    v_mfma_f32_16x16x32_bf16 v[8:11], v[56:59], v[96:99], v[8:11]
    ds_read_b64_tr_b16 v[40:41], v250 offset:16384
    v_mfma_f32_16x16x32_bf16 v[12:15], v[60:63], v[96:99], v[12:15]
    ds_read_b64_tr_b16 v[42:43], v250 offset:18432
    v_mfma_f32_16x16x32_bf16 v[16:19], v[64:67], v[96:99], v[16:19]
    ds_read_b64_tr_b16 v[44:45], v251 offset:16384
    v_mfma_f32_16x16x32_bf16 v[20:23], v[68:71], v[96:99], v[20:23]
    ds_read_b64_tr_b16 v[46:47], v251 offset:18432
    v_mfma_f32_16x16x32_bf16 v[24:27], v[56:59], v[100:103], v[24:27]
    ds_read_b64_tr_b16 v[48:49], v252 offset:16384
    s_waitcnt vmcnt(20)
    v_max_u32 v7, v104, v108
    v_cmp_eq_u32 vcc, -1, v7
    v_mfma_f32_16x16x32_bf16 v[28:31], v[60:63], v[100:103], v[28:31]
    ds_read_b64_tr_b16 v[50:51], v252 offset:18432
    v_mfma_f32_16x16x32_bf16 v[32:35], v[64:67], v[100:103], v[32:35]
    ds_read_b64_tr_b16 v[52:53], v253 offset:16384
    v_mfma_f32_16x16x32_bf16 v[36:39], v[68:71], v[100:103], v[36:39]
    ds_read_b64_tr_b16 v[54:55], v253 offset:18432
    s_cbranch_vccnz L_r4
L_b4:
    buffer_load_dwordx4 v[96:99], v5, s[12:15], s3 offen offset:1024 sc1
    buffer_load_dwordx4 v[100:103], v4, s[12:15], s3 offen offset:1024 sc1
    s_waitcnt lgkmcnt(0)
    v_mfma_f32_16x16x32_bf16 v[8:11], v[40:43], v[104:107], v[8:11]
    ds_read_b64_tr_b16 v[56:57], v250 offset:20480
    v_mfma_f32_16x16x32_bf16 v[12:15], v[44:47], v[104:107], v[12:15]
    ds_read_b64_tr_b16 v[58:59], v250 offset:22528
    v_mfma_f32_16x16x32_bf16 v[16:19], v[48:51], v[104:107], v[16:19]
    ds_read_b64_tr_b16 v[60:61], v251 offset:20480
    v_mfma_f32_16x16x32_bf16 v[20:23], v[52:55], v[104:107], v[20:23]
    ds_read_b64_tr_b16 v[62:63], v251 offset:22528
    v_mfma_f32_16x16x32_bf16 v[24:27], v[40:43], v[108:111], v[24:27]
    ds_read_b64_tr_b16 v[64:65], v252 offset:20480
    s_waitcnt vmcnt(20)
    v_max_u32 v7, v112, v116
    v_cmp_eq_u32 vcc, -1, v7
    v_mfma_f32_16x16x32_bf16 v[28:31], v[44:47], v[108:111], v[28:31]
    ds_read_b64_tr_b16 v[66:67], v252 offset:22528
    v_mfma_f32_16x16x32_bf16 v[32:35], v[48:51], v[108:111], v[32:35]
    ds_read_b64_tr_b16 v[68:69], v253 offset:20480
    v_mfma_f32_16x16x32_bf16 v[36:39], v[52:55], v[108:111], v[36:39]
    ds_read_b64_tr_b16 v[70:71], v253 offset:22528
    s_cbranch_vccnz L_r5
L_b5:
    s_add_u32 s3, s88, 8
    s_and_b32 s3, s3, 15
    s_lshl_b32 s3, s3, 11
    s_add_u32 s3, s3, s72
    buffer_load_dwordx4 v[104:107], v5, s[12:15], s3 offen offset:0 sc1
    buffer_load_dwordx4 v[108:111], v4, s[12:15], s3 offen offset:0 sc1
    s_waitcnt lgkmcnt(0)
    v_mfma_f32_16x16x32_bf16 v[8:11], v[56:59], v[112:115], v[8:11]
    ds_read_b64_tr_b16 v[40:41], v250 offset:24576
    v_mfma_f32_16x16x32_bf16 v[12:15], v[60:63], v[112:115], v[12:15]
    ds_read_b64_tr_b16 v[42:43], v250 offset:26624
    v_mfma_f32_16x16x32_bf16 v[16:19], v[64:67], v[112:115], v[16:19]
    ds_read_b64_tr_b16 v[44:45], v251 offset:24576
    v_mfma_f32_16x16x32_bf16 v[20:23], v[68:71], v[112:115], v[20:23]
    ds_read_b64_tr_b16 v[46:47], v251 offset:26624
    v_mfma_f32_16x16x32_bf16 v[24:27], v[56:59], v[116:119], v[24:27]
    ds_read_b64_tr_b16 v[48:49], v252 offset:24576
    s_waitcnt vmcnt(20)
    v_max_u32 v7, v120, v124
    v_cmp_eq_u32 vcc, -1, v7
    v_mfma_f32_16x16x32_bf16 v[28:31], v[60:63], v[116:119], v[28:31]
    ds_read_b64_tr_b16 v[50:51], v252 offset:26624
    v_mfma_f32_16x16x32_bf16 v[32:35], v[64:67], v[116:119], v[32:35]
    ds_read_b64_tr_b16 v[52:53], v253 offset:24576
    v_mfma_f32_16x16x32_bf16 v[36:39], v[68:71], v[116:119], v[36:39]
    ds_read_b64_tr_b16 v[54:55], v253 offset:26624
    s_cbranch_vccnz L_r6
L_b6:
    buffer_load_dwordx4 v[112:115], v5, s[12:15], s3 offen offset:1024 sc1
    buffer_load_dwordx4 v[116:119], v4, s[12:15], s3 offen offset:1024 sc1
    s_waitcnt lgkmcnt(0)
    v_mfma_f32_16x16x32_bf16 v[8:11], v[40:43], v[120:123], v[8:11]
    ds_read_b64_tr_b16 v[56:57], v250 offset:28672
    v_mfma_f32_16x16x32_bf16 v[12:15], v[44:47], v[120:123], v[12:15]
    ds_read_b64_tr_b16 v[58:59], v250 offset:30720
    v_mfma_f32_16x16x32_bf16 v[16:19], v[48:51], v[120:123], v[16:19]
    ds_read_b64_tr_b16 v[60:61], v251 offset:28672
    v_mfma_f32_16x16x32_bf16 v[20:23], v[52:55], v[120:123], v[20:23]
    ds_read_b64_tr_b16 v[62:63], v251 offset:30720
    v_mfma_f32_16x16x32_bf16 v[24:27], v[40:43], v[124:127], v[24:27]
    ds_read_b64_tr_b16 v[64:65], v252 offset:28672
    s_waitcnt vmcnt(20)
    v_max_u32 v7, v128, v132
    v_cmp_eq_u32 vcc, -1, v7
    v_mfma_f32_16x16x32_bf16 v[28:31], v[44:47], v[124:127], v[28:31]
    ds_read_b64_tr_b16 v[66:67], v252 offset:30720
    v_mfma_f32_16x16x32_bf16 v[32:35], v[48:51], v[124:127], v[32:35]
    ds_read_b64_tr_b16 v[68:69], v253 offset:28672
    v_mfma_f32_16x16x32_bf16 v[36:39], v[52:55], v[124:127], v[36:39]
    ds_read_b64_tr_b16 v[70:71], v253 offset:30720
    s_cbranch_vccnz L_r7
L_b7:
    s_add_u32 s3, s88, 9
    s_and_b32 s3, s3, 15
    s_lshl_b32 s3, s3, 11
    s_add_u32 s3, s3, s72
    buffer_load_dwordx4 v[120:123], v5, s[12:15], s3 offen offset:0 sc1
    buffer_load_dwordx4 v[124:127], v4, s[12:15], s3 offen offset:0 sc1
    s_waitcnt lgkmcnt(0)
    v_mfma_f32_16x16x32_bf16 v[8:11], v[56:59], v[128:131], v[8:11]
    ds_read_b64_tr_b16 v[40:41], v250 offset:32768
    v_mfma_f32_16x16x32_bf16 v[12:15], v[60:63], v[128:131], v[12:15]
    ds_read_b64_tr_b16 v[42:43], v250 offset:34816
    v_mfma_f32_16x16x32_bf16 v[16:19], v[64:67], v[128:131], v[16:19]
    ds_read_b64_tr_b16 v[44:45], v251 offset:32768
    v_mfma_f32_16x16x32_bf16 v[20:23], v[68:71], v[128:131], v[20:23]
    ds_read_b64_tr_b16 v[46:47], v251 offset:34816
    v_mfma_f32_16x16x32_bf16 v[24:27], v[56:59], v[132:135], v[24:27]
    ds_read_b64_tr_b16 v[48:49], v252 offset:32768
    s_waitcnt vmcnt(20)
    v_max_u32 v7, v136, v140
    v_cmp_eq_u32 vcc, -1, v7
    v_mfma_f32_16x16x32_bf16 v[28:31], v[60:63], v[132:135], v[28:31]
    ds_read_b64_tr_b16 v[50:51], v252 offset:34816
    v_mfma_f32_16x16x32_bf16 v[32:35], v[64:67], v[132:135], v[32:35]
    ds_read_b64_tr_b16 v[52:53], v253 offset:32768
    v_mfma_f32_16x16x32_bf16 v[36:39], v[68:71], v[132:135], v[36:39]
    ds_read_b64_tr_b16 v[54:55], v253 offset:34816
    s_cbranch_vccnz L_r8
L_b8:
    buffer_load_dwordx4 v[128:131], v5, s[12:15], s3 offen offset:1024 sc1
    buffer_load_dwordx4 v[132:135], v4, s[12:15], s3 offen offset:1024 sc1
    s_waitcnt lgkmcnt(0)
    v_mfma_f32_16x16x32_bf16 v[8:11], v[40:43], v[136:139], v[8:11]
    ds_read_b64_tr_b16 v[56:57], v250 offset:36864
    v_mfma_f32_16x16x32_bf16 v[12:15], v[44:47], v[136:139], v[12:15]
    ds_read_b64_tr_b16 v[58:59], v250 offset:38912
    v_mfma_f32_16x16x32_bf16 v[16:19], v[48:51], v[136:139], v[16:19]
    ds_read_b64_tr_b16 v[60:61], v251 offset:36864
    v_mfma_f32_16x16x32_bf16 v[20:23], v[52:55], v[136:139], v[20:23]
    ds_read_b64_tr_b16 v[62:63], v251 offset:38912
    v_mfma_f32_16x16x32_bf16 v[24:27], v[40:43], v[140:143], v[24:27]
    ds_read_b64_tr_b16 v[64:65], v252 offset:36864
    s_waitcnt vmcnt(20)
    v_max_u32 v7, v144, v148
    v_cmp_eq_u32 vcc, -1, v7
    v_mfma_f32_16x16x32_bf16 v[28:31], v[44:47], v[140:143], v[28:31]
    ds_read_b64_tr_b16 v[66:67], v252 offset:38912
    v_mfma_f32_16x16x32_bf16 v[32:35], v[48:51], v[140:143], v[32:35]
    ds_read_b64_tr_b16 v[68:69], v253 offset:36864
    v_mfma_f32_16x16x32_bf16 v[36:39], v[52:55], v[140:143], v[36:39]
    ds_read_b64_tr_b16 v[70:71], v253 offset:38912
    s_cbranch_vccnz L_r9
L_b9:
    s_add_u32 s3, s88, 10
    s_and_b32 s3, s3, 15
    s_lshl_b32 s3, s3, 11
    s_add_u32 s3, s3, s72
    buffer_load_dwordx4 v[136:139], v5, s[12:15], s3 offen offset:0 sc1
    buffer_load_dwordx4 v[140:143], v4, s[12:15], s3 offen offset:0 sc1
    s_waitcnt lgkmcnt(0)
    v_mfma_f32_16x16x32_bf16 v[8:11], v[56:59], v[144:147], v[8:11]
    ds_read_b64_tr_b16 v[40:41], v250 offset:40960
    v_mfma_f32_16x16x32_bf16 v[12:15], v[60:63], v[144:147], v[12:15]
    ds_read_b64_tr_b16 v[42:43], v250 offset:43008
    v_mfma_f32_16x16x32_bf16 v[16:19], v[64:67], v[144:147], v[16:19]
    ds_read_b64_tr_b16 v[44:45], v251 offset:40960
    v_mfma_f32_16x16x32_bf16 v[20:23], v[68:71], v[144:147], v[20:23]
    ds_read_b64_tr_b16 v[46:47], v251 offset:43008
    v_mfma_f32_16x16x32_bf16 v[24:27], v[56:59], v[148:151], v[24:27]
    ds_read_b64_tr_b16 v[48:49], v252 offset:40960
    s_waitcnt vmcnt(20)
    v_max_u32 v7, v152, v156
    v_cmp_eq_u32 vcc, -1, v7
    v_mfma_f32_16x16x32_bf16 v[28:31], v[60:63], v[148:151], v[28:31]
    ds_read_b64_tr_b16 v[50:51], v252 offset:43008
    v_mfma_f32_16x16x32_bf16 v[32:35], v[64:67], v[148:151], v[32:35]
    ds_read_b64_tr_b16 v[52:53], v253 offset:40960
    v_mfma_f32_16x16x32_bf16 v[36:39], v[68:71], v[148:151], v[36:39]
    ds_read_b64_tr_b16 v[54:55], v253 offset:43008
    s_cbranch_vccnz L_r10
L_b10:
    buffer_load_dwordx4 v[144:147], v5, s[12:15], s3 offen offset:1024 sc1
    buffer_load_dwordx4 v[148:151], v4, s[12:15], s3 offen offset:1024 sc1
    s_waitcnt lgkmcnt(0)
    v_mfma_f32_16x16x32_bf16 v[8:11], v[40:43], v[152:155], v[8:11]
    ds_read_b64_tr_b16 v[56:57], v250 offset:45056
    v_mfma_f32_16x16x32_bf16 v[12:15], v[44:47], v[152:155], v[12:15]
    ds_read_b64_tr_b16 v[58:59], v250 offset:47104
    v_mfma_f32_16x16x32_bf16 v[16:19], v[48:51], v[152:155], v[16:19]
    ds_read_b64_tr_b16 v[60:61], v251 offset:45056
    v_mfma_f32_16x16x32_bf16 v[20:23], v[52:55], v[152:155], v[20:23]
    ds_read_b64_tr_b16 v[62:63], v251 offset:47104
    v_mfma_f32_16x16x32_bf16 v[24:27], v[40:43], v[156:159], v[24:27]
    ds_read_b64_tr_b16 v[64:65], v252 offset:45056
    s_waitcnt vmcnt(20)
    v_max_u32 v7, v160, v164
    v_cmp_eq_u32 vcc, -1, v7
    v_mfma_f32_16x16x32_bf16 v[28:31], v[44:47], v[156:159], v[28:31]
    ds_read_b64_tr_b16 v[66:67], v252 offset:47104
    v_mfma_f32_16x16x32_bf16 v[32:35], v[48:51], v[156:159], v[32:35]
    ds_read_b64_tr_b16 v[68:69], v253 offset:45056
    v_mfma_f32_16x16x32_bf16 v[36:39], v[52:55], v[156:159], v[36:39]
    ds_read_b64_tr_b16 v[70:71], v253 offset:47104
    s_cbranch_vccnz L_r11
L_b11:
    s_add_u32 s3, s88, 11
    s_and_b32 s3, s3, 15
    s_lshl_b32 s3, s3, 11
    s_add_u32 s3, s3, s72
    buffer_load_dwordx4 v[152:155], v5, s[12:15], s3 offen offset:0 sc1
    buffer_load_dwordx4 v[156:159], v4, s[12:15], s3 offen offset:0 sc1
    s_waitcnt lgkmcnt(0)
    v_mfma_f32_16x16x32_bf16 v[8:11], v[56:59], v[160:163], v[8:11]
    ds_read_b64_tr_b16 v[40:41], v250 offset:49152
    v_mfma_f32_16x16x32_bf16 v[12:15], v[60:63], v[160:163], v[12:15]
    ds_read_b64_tr_b16 v[42:43], v250 offset:51200
    v_mfma_f32_16x16x32_bf16 v[16:19], v[64:67], v[160:163], v[16:19]
    ds_read_b64_tr_b16 v[44:45], v251 offset:49152
    v_mfma_f32_16x16x32_bf16 v[20:23], v[68:71], v[160:163], v[20:23]
    ds_read_b64_tr_b16 v[46:47], v251 offset:51200
    v_mfma_f32_16x16x32_bf16 v[24:27], v[56:59], v[164:167], v[24:27]
    ds_read_b64_tr_b16 v[48:49], v252 offset:49152
    s_waitcnt vmcnt(20)
    v_max_u32 v7, v72, v76
    v_cmp_eq_u32 vcc, -1, v7
    v_mfma_f32_16x16x32_bf16 v[28:31], v[60:63], v[164:167], v[28:31]
    ds_read_b64_tr_b16 v[50:51], v252 offset:51200
    v_mfma_f32_16x16x32_bf16 v[32:35], v[64:67], v[164:167], v[32:35]
    ds_read_b64_tr_b16 v[52:53], v253 offset:49152
    v_mfma_f32_16x16x32_bf16 v[36:39], v[68:71], v[164:167], v[36:39]
    ds_read_b64_tr_b16 v[54:55], v253 offset:51200
    s_cbranch_vccnz L_r12
L_b12:
    buffer_load_dwordx4 v[160:163], v5, s[12:15], s3 offen offset:1024 sc1
    buffer_load_dwordx4 v[164:167], v4, s[12:15], s3 offen offset:1024 sc1
    s_waitcnt lgkmcnt(0)
    v_mfma_f32_16x16x32_bf16 v[8:11], v[40:43], v[72:75], v[8:11]
    ds_read_b64_tr_b16 v[56:57], v250 offset:53248
    v_mfma_f32_16x16x32_bf16 v[12:15], v[44:47], v[72:75], v[12:15]
    ds_read_b64_tr_b16 v[58:59], v250 offset:55296
    v_mfma_f32_16x16x32_bf16 v[16:19], v[48:51], v[72:75], v[16:19]
    ds_read_b64_tr_b16 v[60:61], v251 offset:53248
    v_mfma_f32_16x16x32_bf16 v[20:23], v[52:55], v[72:75], v[20:23]
    ds_read_b64_tr_b16 v[62:63], v251 offset:55296
    v_mfma_f32_16x16x32_bf16 v[24:27], v[40:43], v[76:79], v[24:27]
    ds_read_b64_tr_b16 v[64:65], v252 offset:53248
    s_waitcnt vmcnt(20)
    v_max_u32 v7, v80, v84
    v_cmp_eq_u32 vcc, -1, v7
    v_mfma_f32_16x16x32_bf16 v[28:31], v[44:47], v[76:79], v[28:31]
    ds_read_b64_tr_b16 v[66:67], v252 offset:55296
    v_mfma_f32_16x16x32_bf16 v[32:35], v[48:51], v[76:79], v[32:35]
    ds_read_b64_tr_b16 v[68:69], v253 offset:53248
    v_mfma_f32_16x16x32_bf16 v[36:39], v[52:55], v[76:79], v[36:39]
    ds_read_b64_tr_b16 v[70:71], v253 offset:55296
    s_cbranch_vccnz L_r13
L_b13:
    s_add_u32 s3, s88, 12
    s_and_b32 s3, s3, 15
    s_lshl_b32 s3, s3, 11
    s_add_u32 s3, s3, s72
    buffer_load_dwordx4 v[72:75], v5, s[12:15], s3 offen offset:0 sc1
    buffer_load_dwordx4 v[76:79], v4, s[12:15], s3 offen offset:0 sc1
    s_waitcnt lgkmcnt(0)
    v_mfma_f32_16x16x32_bf16 v[8:11], v[56:59], v[80:83], v[8:11]
    ds_read_b64_tr_b16 v[40:41], v250 offset:57344
    v_mfma_f32_16x16x32_bf16 v[12:15], v[60:63], v[80:83], v[12:15]
    ds_read_b64_tr_b16 v[42:43], v250 offset:59392
    v_mfma_f32_16x16x32_bf16 v[16:19], v[64:67], v[80:83], v[16:19]
    ds_read_b64_tr_b16 v[44:45], v251 offset:57344
    v_mfma_f32_16x16x32_bf16 v[20:23], v[68:71], v[80:83], v[20:23]
    ds_read_b64_tr_b16 v[46:47], v251 offset:59392
    v_mfma_f32_16x16x32_bf16 v[24:27], v[56:59], v[84:87], v[24:27]
    ds_read_b64_tr_b16 v[48:49], v252 offset:57344
    s_waitcnt vmcnt(20)
    v_max_u32 v7, v88, v92
    v_cmp_eq_u32 vcc, -1, v7
    v_mfma_f32_16x16x32_bf16 v[28:31], v[60:63], v[84:87], v[28:31]
    ds_read_b64_tr_b16 v[50:51], v252 offset:59392
    v_mfma_f32_16x16x32_bf16 v[32:35], v[64:67], v[84:87], v[32:35]
    ds_read_b64_tr_b16 v[52:53], v253 offset:57344
    v_mfma_f32_16x16x32_bf16 v[36:39], v[68:71], v[84:87], v[36:39]
    ds_read_b64_tr_b16 v[54:55], v253 offset:59392
    s_cbranch_vccnz L_r14
L_b14:
    buffer_load_dwordx4 v[80:83], v5, s[12:15], s3 offen offset:1024 sc1
    buffer_load_dwordx4 v[84:87], v4, s[12:15], s3 offen offset:1024 sc1
    s_waitcnt lgkmcnt(0)
    v_mfma_f32_16x16x32_bf16 v[8:11], v[40:43], v[88:91], v[8:11]
    ds_read_b64_tr_b16 v[56:57], v250 offset:61440
    v_mfma_f32_16x16x32_bf16 v[12:15], v[44:47], v[88:91], v[12:15]
    ds_read_b64_tr_b16 v[58:59], v250 offset:63488
    v_mfma_f32_16x16x32_bf16 v[16:19], v[48:51], v[88:91], v[16:19]
    ds_read_b64_tr_b16 v[60:61], v251 offset:61440
    v_mfma_f32_16x16x32_bf16 v[20:23], v[52:55], v[88:91], v[20:23]
    ds_read_b64_tr_b16 v[62:63], v251 offset:63488
    v_mfma_f32_16x16x32_bf16 v[24:27], v[40:43], v[92:95], v[24:27]
    ds_read_b64_tr_b16 v[64:65], v252 offset:61440
    s_waitcnt vmcnt(20)
    v_max_u32 v7, v96, v100
    v_cmp_eq_u32 vcc, -1, v7
    v_mfma_f32_16x16x32_bf16 v[28:31], v[44:47], v[92:95], v[28:31]
    ds_read_b64_tr_b16 v[66:67], v252 offset:63488
    v_mfma_f32_16x16x32_bf16 v[32:35], v[48:51], v[92:95], v[32:35]
    ds_read_b64_tr_b16 v[68:69], v253 offset:61440
    v_mfma_f32_16x16x32_bf16 v[36:39], v[52:55], v[92:95], v[36:39]
    ds_read_b64_tr_b16 v[70:71], v253 offset:63488
    s_cbranch_vccnz L_r15
L_b15:
    s_add_u32 s3, s88, 13
    s_and_b32 s3, s3, 15
    s_lshl_b32 s3, s3, 11
    s_add_u32 s3, s3, s72
    buffer_load_dwordx4 v[88:91], v5, s[12:15], s3 offen offset:0 sc1
    buffer_load_dwordx4 v[92:95], v4, s[12:15], s3 offen offset:0 sc1
    s_waitcnt lgkmcnt(0)
    v_add_u32 v250, 0x10000, v250
    v_add_u32 v251, 0x10000, v251
    v_add_u32 v252, 0x10000, v252
    v_add_u32 v253, 0x10000, v253
    v_mfma_f32_16x16x32_bf16 v[8:11], v[56:59], v[96:99], v[8:11]
    ds_read_b64_tr_b16 v[40:41], v250 offset:0
    v_mfma_f32_16x16x32_bf16 v[12:15], v[60:63], v[96:99], v[12:15]
    ds_read_b64_tr_b16 v[42:43], v250 offset:2048
    v_mfma_f32_16x16x32_bf16 v[16:19], v[64:67], v[96:99], v[16:19]
    ds_read_b64_tr_b16 v[44:45], v251 offset:0
    v_mfma_f32_16x16x32_bf16 v[20:23], v[68:71], v[96:99], v[20:23]
    ds_read_b64_tr_b16 v[46:47], v251 offset:2048
    v_mfma_f32_16x16x32_bf16 v[24:27], v[56:59], v[100:103], v[24:27]
    ds_read_b64_tr_b16 v[48:49], v252 offset:0
    s_waitcnt vmcnt(20)
    v_max_u32 v7, v104, v108
    v_cmp_eq_u32 vcc, -1, v7
    v_mfma_f32_16x16x32_bf16 v[28:31], v[60:63], v[100:103], v[28:31]
    ds_read_b64_tr_b16 v[50:51], v252 offset:2048
    v_mfma_f32_16x16x32_bf16 v[32:35], v[64:67], v[100:103], v[32:35]
    ds_read_b64_tr_b16 v[52:53], v253 offset:0
    v_mfma_f32_16x16x32_bf16 v[36:39], v[68:71], v[100:103], v[36:39]
    ds_read_b64_tr_b16 v[54:55], v253 offset:2048
    s_cbranch_vccnz L_r16
L_b16:
    buffer_load_dwordx4 v[96:99], v5, s[12:15], s3 offen offset:1024 sc1
    buffer_load_dwordx4 v[100:103], v4, s[12:15], s3 offen offset:1024 sc1
    s_waitcnt lgkmcnt(0)
    v_mfma_f32_16x16x32_bf16 v[8:11], v[40:43], v[104:107], v[8:11]
    ds_read_b64_tr_b16 v[56:57], v250 offset:4096
    v_mfma_f32_16x16x32_bf16 v[12:15], v[44:47], v[104:107], v[12:15]
    ds_read_b64_tr_b16 v[58:59], v250 offset:6144
    v_mfma_f32_16x16x32_bf16 v[16:19], v[48:51], v[104:107], v[16:19]
    ds_read_b64_tr_b16 v[60:61], v251 offset:4096
    v_mfma_f32_16x16x32_bf16 v[20:23], v[52:55], v[104:107], v[20:23]
    ds_read_b64_tr_b16 v[62:63], v251 offset:6144
    v_mfma_f32_16x16x32_bf16 v[24:27], v[40:43], v[108:111], v[24:27]
    ds_read_b64_tr_b16 v[64:65], v252 offset:4096
    s_waitcnt vmcnt(20)
    v_max_u32 v7, v112, v116
    v_cmp_eq_u32 vcc, -1, v7
    v_mfma_f32_16x16x32_bf16 v[28:31], v[44:47], v[108:111], v[28:31]
    ds_read_b64_tr_b16 v[66:67], v252 offset:6144
    v_mfma_f32_16x16x32_bf16 v[32:35], v[48:51], v[108:111], v[32:35]
    ds_read_b64_tr_b16 v[68:69], v253 offset:4096
    v_mfma_f32_16x16x32_bf16 v[36:39], v[52:55], v[108:111], v[36:39]
    ds_read_b64_tr_b16 v[70:71], v253 offset:6144
    s_cbranch_vccnz L_r17
L_b17:
    s_add_u32 s3, s88, 14
    s_and_b32 s3, s3, 15
    s_lshl_b32 s3, s3, 11
    s_add_u32 s3, s3, s72
    buffer_load_dwordx4 v[104:107], v5, s[12:15], s3 offen offset:0 sc1
    buffer_load_dwordx4 v[108:111], v4, s[12:15], s3 offen offset:0 sc1
    s_waitcnt lgkmcnt(0)
    v_mfma_f32_16x16x32_bf16 v[8:11], v[56:59], v[112:115], v[8:11]
    ds_read_b64_tr_b16 v[40:41], v250 offset:8192
    v_mfma_f32_16x16x32_bf16 v[12:15], v[60:63], v[112:115], v[12:15]
    ds_read_b64_tr_b16 v[42:43], v250 offset:10240
    v_mfma_f32_16x16x32_bf16 v[16:19], v[64:67], v[112:115], v[16:19]
    ds_read_b64_tr_b16 v[44:45], v251 offset:8192
    v_mfma_f32_16x16x32_bf16 v[20:23], v[68:71], v[112:115], v[20:23]
    ds_read_b64_tr_b16 v[46:47], v251 offset:10240
    v_mfma_f32_16x16x32_bf16 v[24:27], v[56:59], v[116:119], v[24:27]
    ds_read_b64_tr_b16 v[48:49], v252 offset:8192
    s_waitcnt vmcnt(20)
    v_max_u32 v7, v120, v124
    v_cmp_eq_u32 vcc, -1, v7
    v_mfma_f32_16x16x32_bf16 v[28:31], v[60:63], v[116:119], v[28:31]
    ds_read_b64_tr_b16 v[50:51], v252 offset:10240
    v_mfma_f32_16x16x32_bf16 v[32:35], v[64:67], v[116:119], v[32:35]
    ds_read_b64_tr_b16 v[52:53], v253 offset:8192
    v_mfma_f32_16x16x32_bf16 v[36:39], v[68:71], v[116:119], v[36:39]
    ds_read_b64_tr_b16 v[54:55], v253 offset:10240
    s_cbranch_vccnz L_r18
L_b18:
    buffer_load_dwordx4 v[112:115], v5, s[12:15], s3 offen offset:1024 sc1
    buffer_load_dwordx4 v[116:119], v4, s[12:15], s3 offen offset:1024 sc1
    s_waitcnt lgkmcnt(0)
    v_mfma_f32_16x16x32_bf16 v[8:11], v[40:43], v[120:123], v[8:11]
    ds_read_b64_tr_b16 v[56:57], v250 offset:12288
    v_mfma_f32_16x16x32_bf16 v[12:15], v[44:47], v[120:123], v[12:15]
    ds_read_b64_tr_b16 v[58:59], v250 offset:14336
    v_mfma_f32_16x16x32_bf16 v[16:19], v[48:51], v[120:123], v[16:19]
    ds_read_b64_tr_b16 v[60:61], v251 offset:12288
    v_mfma_f32_16x16x32_bf16 v[20:23], v[52:55], v[120:123], v[20:23]
    ds_read_b64_tr_b16 v[62:63], v251 offset:14336
    v_mfma_f32_16x16x32_bf16 v[24:27], v[40:43], v[124:127], v[24:27]
    ds_read_b64_tr_b16 v[64:65], v252 offset:12288
    s_waitcnt vmcnt(20)
    v_max_u32 v7, v128, v132
    v_cmp_eq_u32 vcc, -1, v7
    v_mfma_f32_16x16x32_bf16 v[28:31], v[44:47], v[124:127], v[28:31]
    ds_read_b64_tr_b16 v[66:67], v252 offset:14336
    v_mfma_f32_16x16x32_bf16 v[32:35], v[48:51], v[124:127], v[32:35]
    ds_read_b64_tr_b16 v[68:69], v253 offset:12288
    v_mfma_f32_16x16x32_bf16 v[36:39], v[52:55], v[124:127], v[36:39]
    ds_read_b64_tr_b16 v[70:71], v253 offset:14336
    s_cbranch_vccnz L_r19
L_b19:
    s_add_u32 s3, s88, 15
    s_and_b32 s3, s3, 15
    s_lshl_b32 s3, s3, 11
    s_add_u32 s3, s3, s72
    buffer_load_dwordx4 v[120:123], v5, s[12:15], s3 offen offset:0 sc1
    buffer_load_dwordx4 v[124:127], v4, s[12:15], s3 offen offset:0 sc1
    s_waitcnt lgkmcnt(0)
    v_mfma_f32_16x16x32_bf16 v[8:11], v[56:59], v[128:131], v[8:11]
    ds_read_b64_tr_b16 v[40:41], v250 offset:16384
    v_mfma_f32_16x16x32_bf16 v[12:15], v[60:63], v[128:131], v[12:15]
    ds_read_b64_tr_b16 v[42:43], v250 offset:18432
    v_mfma_f32_16x16x32_bf16 v[16:19], v[64:67], v[128:131], v[16:19]
    ds_read_b64_tr_b16 v[44:45], v251 offset:16384
    v_mfma_f32_16x16x32_bf16 v[20:23], v[68:71], v[128:131], v[20:23]
    ds_read_b64_tr_b16 v[46:47], v251 offset:18432
    v_mfma_f32_16x16x32_bf16 v[24:27], v[56:59], v[132:135], v[24:27]
    ds_read_b64_tr_b16 v[48:49], v252 offset:16384
    s_waitcnt vmcnt(20)
    v_max_u32 v7, v136, v140
    v_cmp_eq_u32 vcc, -1, v7
    v_mfma_f32_16x16x32_bf16 v[28:31], v[60:63], v[132:135], v[28:31]
    ds_read_b64_tr_b16 v[50:51], v252 offset:18432
    v_mfma_f32_16x16x32_bf16 v[32:35], v[64:67], v[132:135], v[32:35]
    ds_read_b64_tr_b16 v[52:53], v253 offset:16384
    v_mfma_f32_16x16x32_bf16 v[36:39], v[68:71], v[132:135], v[36:39]
    ds_read_b64_tr_b16 v[54:55], v253 offset:18432
    s_cbranch_vccnz L_r20
L_b20:
    buffer_load_dwordx4 v[128:131], v5, s[12:15], s3 offen offset:1024 sc1
    buffer_load_dwordx4 v[132:135], v4, s[12:15], s3 offen offset:1024 sc1
    s_waitcnt lgkmcnt(0)
    v_mfma_f32_16x16x32_bf16 v[8:11], v[40:43], v[136:139], v[8:11]
    ds_read_b64_tr_b16 v[56:57], v250 offset:20480
    v_mfma_f32_16x16x32_bf16 v[12:15], v[44:47], v[136:139], v[12:15]
    ds_read_b64_tr_b16 v[58:59], v250 offset:22528
    v_mfma_f32_16x16x32_bf16 v[16:19], v[48:51], v[136:139], v[16:19]
    ds_read_b64_tr_b16 v[60:61], v251 offset:20480
    v_mfma_f32_16x16x32_bf16 v[20:23], v[52:55], v[136:139], v[20:23]
    ds_read_b64_tr_b16 v[62:63], v251 offset:22528
    v_mfma_f32_16x16x32_bf16 v[24:27], v[40:43], v[140:143], v[24:27]
    ds_read_b64_tr_b16 v[64:65], v252 offset:20480
    s_waitcnt vmcnt(20)
    v_max_u32 v7, v144, v148
    v_cmp_eq_u32 vcc, -1, v7
    v_mfma_f32_16x16x32_bf16 v[28:31], v[44:47], v[140:143], v[28:31]
    ds_read_b64_tr_b16 v[66:67], v252 offset:22528
    v_mfma_f32_16x16x32_bf16 v[32:35], v[48:51], v[140:143], v[32:35]
    ds_read_b64_tr_b16 v[68:69], v253 offset:20480
    v_mfma_f32_16x16x32_bf16 v[36:39], v[52:55], v[140:143], v[36:39]
    ds_read_b64_tr_b16 v[70:71], v253 offset:22528
    s_cbranch_vccnz L_r21
L_b21:
    s_waitcnt lgkmcnt(0)
    v_mfma_f32_16x16x32_bf16 v[8:11], v[56:59], v[144:147], v[8:11]
    ds_read_b64_tr_b16 v[40:41], v250 offset:24576
    v_mfma_f32_16x16x32_bf16 v[12:15], v[60:63], v[144:147], v[12:15]
    ds_read_b64_tr_b16 v[42:43], v250 offset:26624
    v_mfma_f32_16x16x32_bf16 v[16:19], v[64:67], v[144:147], v[16:19]
    ds_read_b64_tr_b16 v[44:45], v251 offset:24576
    v_mfma_f32_16x16x32_bf16 v[20:23], v[68:71], v[144:147], v[20:23]
    ds_read_b64_tr_b16 v[46:47], v251 offset:26624
    v_mfma_f32_16x16x32_bf16 v[24:27], v[56:59], v[148:151], v[24:27]
    ds_read_b64_tr_b16 v[48:49], v252 offset:24576
    s_waitcnt vmcnt(18)
    v_max_u32 v7, v152, v156
    v_cmp_eq_u32 vcc, -1, v7
    v_mfma_f32_16x16x32_bf16 v[28:31], v[60:63], v[148:151], v[28:31]
    ds_read_b64_tr_b16 v[50:51], v252 offset:26624
    v_mfma_f32_16x16x32_bf16 v[32:35], v[64:67], v[148:151], v[32:35]
    ds_read_b64_tr_b16 v[52:53], v253 offset:24576
    v_mfma_f32_16x16x32_bf16 v[36:39], v[68:71], v[148:151], v[36:39]
    ds_read_b64_tr_b16 v[54:55], v253 offset:26624
    s_cbranch_vccnz L_r22
L_b22:
    s_waitcnt lgkmcnt(0)
    v_mfma_f32_16x16x32_bf16 v[8:11], v[40:43], v[152:155], v[8:11]
    ds_read_b64_tr_b16 v[56:57], v250 offset:28672
    v_mfma_f32_16x16x32_bf16 v[12:15], v[44:47], v[152:155], v[12:15]
    ds_read_b64_tr_b16 v[58:59], v250 offset:30720
    v_mfma_f32_16x16x32_bf16 v[16:19], v[48:51], v[152:155], v[16:19]
    ds_read_b64_tr_b16 v[60:61], v251 offset:28672
    v_mfma_f32_16x16x32_bf16 v[20:23], v[52:55], v[152:155], v[20:23]
    ds_read_b64_tr_b16 v[62:63], v251 offset:30720
    v_mfma_f32_16x16x32_bf16 v[24:27], v[40:43], v[156:159], v[24:27]
    ds_read_b64_tr_b16 v[64:65], v252 offset:28672
    s_waitcnt vmcnt(16)
    v_max_u32 v7, v160, v164
    v_cmp_eq_u32 vcc, -1, v7
    v_mfma_f32_16x16x32_bf16 v[28:31], v[44:47], v[156:159], v[28:31]
    ds_read_b64_tr_b16 v[66:67], v252 offset:30720
    v_mfma_f32_16x16x32_bf16 v[32:35], v[48:51], v[156:159], v[32:35]
    ds_read_b64_tr_b16 v[68:69], v253 offset:28672
    v_mfma_f32_16x16x32_bf16 v[36:39], v[52:55], v[156:159], v[36:39]
    ds_read_b64_tr_b16 v[70:71], v253 offset:30720
    s_cbranch_vccnz L_r23
L_b23:
    s_waitcnt lgkmcnt(0)
    v_mfma_f32_16x16x32_bf16 v[8:11], v[56:59], v[160:163], v[8:11]
    ds_read_b64_tr_b16 v[40:41], v250 offset:32768
    v_mfma_f32_16x16x32_bf16 v[12:15], v[60:63], v[160:163], v[12:15]
    ds_read_b64_tr_b16 v[42:43], v250 offset:34816
    v_mfma_f32_16x16x32_bf16 v[16:19], v[64:67], v[160:163], v[16:19]
    ds_read_b64_tr_b16 v[44:45], v251 offset:32768
    v_mfma_f32_16x16x32_bf16 v[20:23], v[68:71], v[160:163], v[20:23]
    ds_read_b64_tr_b16 v[46:47], v251 offset:34816
    v_mfma_f32_16x16x32_bf16 v[24:27], v[56:59], v[164:167], v[24:27]
    ds_read_b64_tr_b16 v[48:49], v252 offset:32768
    s_waitcnt vmcnt(14)
    v_max_u32 v7, v72, v76
    v_cmp_eq_u32 vcc, -1, v7
    v_mfma_f32_16x16x32_bf16 v[28:31], v[60:63], v[164:167], v[28:31]
    ds_read_b64_tr_b16 v[50:51], v252 offset:34816
    v_mfma_f32_16x16x32_bf16 v[32:35], v[64:67], v[164:167], v[32:35]
    ds_read_b64_tr_b16 v[52:53], v253 offset:32768
    v_mfma_f32_16x16x32_bf16 v[36:39], v[68:71], v[164:167], v[36:39]
    ds_read_b64_tr_b16 v[54:55], v253 offset:34816
    s_cbranch_vccnz L_r24
L_b24:
    s_waitcnt lgkmcnt(0)
    v_mfma_f32_16x16x32_bf16 v[8:11], v[40:43], v[72:75], v[8:11]
    ds_read_b64_tr_b16 v[56:57], v250 offset:36864
    v_mfma_f32_16x16x32_bf16 v[12:15], v[44:47], v[72:75], v[12:15]
    ds_read_b64_tr_b16 v[58:59], v250 offset:38912
    v_mfma_f32_16x16x32_bf16 v[16:19], v[48:51], v[72:75], v[16:19]
    ds_read_b64_tr_b16 v[60:61], v251 offset:36864
    v_mfma_f32_16x16x32_bf16 v[20:23], v[52:55], v[72:75], v[20:23]
    ds_read_b64_tr_b16 v[62:63], v251 offset:38912
    v_mfma_f32_16x16x32_bf16 v[24:27], v[40:43], v[76:79], v[24:27]
    ds_read_b64_tr_b16 v[64:65], v252 offset:36864
    s_waitcnt vmcnt(12)
    v_max_u32 v7, v80, v84
    v_cmp_eq_u32 vcc, -1, v7
    v_mfma_f32_16x16x32_bf16 v[28:31], v[44:47], v[76:79], v[28:31]
    ds_read_b64_tr_b16 v[66:67], v252 offset:38912
    v_mfma_f32_16x16x32_bf16 v[32:35], v[48:51], v[76:79], v[32:35]
    ds_read_b64_tr_b16 v[68:69], v253 offset:36864
    v_mfma_f32_16x16x32_bf16 v[36:39], v[52:55], v[76:79], v[36:39]
    ds_read_b64_tr_b16 v[70:71], v253 offset:38912
    s_cbranch_vccnz L_r25
L_b25:
    s_waitcnt lgkmcnt(0)
    v_mfma_f32_16x16x32_bf16 v[8:11], v[56:59], v[80:83], v[8:11]
    ds_read_b64_tr_b16 v[40:41], v250 offset:40960
    v_mfma_f32_16x16x32_bf16 v[12:15], v[60:63], v[80:83], v[12:15]
    ds_read_b64_tr_b16 v[42:43], v250 offset:43008
    v_mfma_f32_16x16x32_bf16 v[16:19], v[64:67], v[80:83], v[16:19]
    ds_read_b64_tr_b16 v[44:45], v251 offset:40960
    v_mfma_f32_16x16x32_bf16 v[20:23], v[68:71], v[80:83], v[20:23]
    ds_read_b64_tr_b16 v[46:47], v251 offset:43008
    v_mfma_f32_16x16x32_bf16 v[24:27], v[56:59], v[84:87], v[24:27]
    ds_read_b64_tr_b16 v[48:49], v252 offset:40960
    s_waitcnt vmcnt(10)
    v_max_u32 v7, v88, v92
    v_cmp_eq_u32 vcc, -1, v7
    v_mfma_f32_16x16x32_bf16 v[28:31], v[60:63], v[84:87], v[28:31]
    ds_read_b64_tr_b16 v[50:51], v252 offset:43008
    v_mfma_f32_16x16x32_bf16 v[32:35], v[64:67], v[84:87], v[32:35]
    ds_read_b64_tr_b16 v[52:53], v253 offset:40960
    v_mfma_f32_16x16x32_bf16 v[36:39], v[68:71], v[84:87], v[36:39]
    ds_read_b64_tr_b16 v[54:55], v253 offset:43008
    s_cbranch_vccnz L_r26
L_b26:
    s_waitcnt lgkmcnt(0)
    v_mfma_f32_16x16x32_bf16 v[8:11], v[40:43], v[88:91], v[8:11]
    ds_read_b64_tr_b16 v[56:57], v250 offset:45056
    v_mfma_f32_16x16x32_bf16 v[12:15], v[44:47], v[88:91], v[12:15]
    ds_read_b64_tr_b16 v[58:59], v250 offset:47104
    v_mfma_f32_16x16x32_bf16 v[16:19], v[48:51], v[88:91], v[16:19]
    ds_read_b64_tr_b16 v[60:61], v251 offset:45056
    v_mfma_f32_16x16x32_bf16 v[20:23], v[52:55], v[88:91], v[20:23]
    ds_read_b64_tr_b16 v[62:63], v251 offset:47104
    v_mfma_f32_16x16x32_bf16 v[24:27], v[40:43], v[92:95], v[24:27]
    ds_read_b64_tr_b16 v[64:65], v252 offset:45056
    s_waitcnt vmcnt(8)
    v_max_u32 v7, v96, v100
    v_cmp_eq_u32 vcc, -1, v7
    v_mfma_f32_16x16x32_bf16 v[28:31], v[44:47], v[92:95], v[28:31]
    ds_read_b64_tr_b16 v[66:67], v252 offset:47104
    v_mfma_f32_16x16x32_bf16 v[32:35], v[48:51], v[92:95], v[32:35]
    ds_read_b64_tr_b16 v[68:69], v253 offset:45056
    v_mfma_f32_16x16x32_bf16 v[36:39], v[52:55], v[92:95], v[36:39]
    ds_read_b64_tr_b16 v[70:71], v253 offset:47104
    s_cbranch_vccnz L_r27
L_b27:
    s_waitcnt lgkmcnt(0)
    v_mfma_f32_16x16x32_bf16 v[8:11], v[56:59], v[96:99], v[8:11]
    ds_read_b64_tr_b16 v[40:41], v250 offset:49152
    v_mfma_f32_16x16x32_bf16 v[12:15], v[60:63], v[96:99], v[12:15]
    ds_read_b64_tr_b16 v[42:43], v250 offset:51200
    v_mfma_f32_16x16x32_bf16 v[16:19], v[64:67], v[96:99], v[16:19]
    ds_read_b64_tr_b16 v[44:45], v251 offset:49152
    v_mfma_f32_16x16x32_bf16 v[20:23], v[68:71], v[96:99], v[20:23]
    ds_read_b64_tr_b16 v[46:47], v251 offset:51200
    v_mfma_f32_16x16x32_bf16 v[24:27], v[56:59], v[100:103], v[24:27]
    ds_read_b64_tr_b16 v[48:49], v252 offset:49152
    s_waitcnt vmcnt(6)
    v_max_u32 v7, v104, v108
    v_cmp_eq_u32 vcc, -1, v7
    v_mfma_f32_16x16x32_bf16 v[28:31], v[60:63], v[100:103], v[28:31]
    ds_read_b64_tr_b16 v[50:51], v252 offset:51200
    v_mfma_f32_16x16x32_bf16 v[32:35], v[64:67], v[100:103], v[32:35]
    ds_read_b64_tr_b16 v[52:53], v253 offset:49152
    v_mfma_f32_16x16x32_bf16 v[36:39], v[68:71], v[100:103], v[36:39]
    ds_read_b64_tr_b16 v[54:55], v253 offset:51200
    s_cbranch_vccnz L_r28
L_b28:
    s_waitcnt lgkmcnt(0)
    v_mfma_f32_16x16x32_bf16 v[8:11], v[40:43], v[104:107], v[8:11]
    ds_read_b64_tr_b16 v[56:57], v250 offset:53248
    v_mfma_f32_16x16x32_bf16 v[12:15], v[44:47], v[104:107], v[12:15]
    ds_read_b64_tr_b16 v[58:59], v250 offset:55296
    v_mfma_f32_16x16x32_bf16 v[16:19], v[48:51], v[104:107], v[16:19]
    ds_read_b64_tr_b16 v[60:61], v251 offset:53248
    v_mfma_f32_16x16x32_bf16 v[20:23], v[52:55], v[104:107], v[20:23]
    ds_read_b64_tr_b16 v[62:63], v251 offset:55296
    v_mfma_f32_16x16x32_bf16 v[24:27], v[40:43], v[108:111], v[24:27]
    ds_read_b64_tr_b16 v[64:65], v252 offset:53248
    s_waitcnt vmcnt(4)
    v_max_u32 v7, v112, v116
    v_cmp_eq_u32 vcc, -1, v7
    v_mfma_f32_16x16x32_bf16 v[28:31], v[44:47], v[108:111], v[28:31]
    ds_read_b64_tr_b16 v[66:67], v252 offset:55296
    v_mfma_f32_16x16x32_bf16 v[32:35], v[48:51], v[108:111], v[32:35]
    ds_read_b64_tr_b16 v[68:69], v253 offset:53248
    v_mfma_f32_16x16x32_bf16 v[36:39], v[52:55], v[108:111], v[36:39]
    ds_read_b64_tr_b16 v[70:71], v253 offset:55296
    s_cbranch_vccnz L_r29
L_b29:
    s_waitcnt lgkmcnt(0)
    v_mfma_f32_16x16x32_bf16 v[8:11], v[56:59], v[112:115], v[8:11]
    ds_read_b64_tr_b16 v[40:41], v250 offset:57344
    v_mfma_f32_16x16x32_bf16 v[12:15], v[60:63], v[112:115], v[12:15]
    ds_read_b64_tr_b16 v[42:43], v250 offset:59392
    v_mfma_f32_16x16x32_bf16 v[16:19], v[64:67], v[112:115], v[16:19]
    ds_read_b64_tr_b16 v[44:45], v251 offset:57344
    v_mfma_f32_16x16x32_bf16 v[20:23], v[68:71], v[112:115], v[20:23]
    ds_read_b64_tr_b16 v[46:47], v251 offset:59392
    v_mfma_f32_16x16x32_bf16 v[24:27], v[56:59], v[116:119], v[24:27]
    ds_read_b64_tr_b16 v[48:49], v252 offset:57344
    s_waitcnt vmcnt(2)
    v_max_u32 v7, v120, v124
    v_cmp_eq_u32 vcc, -1, v7
    v_mfma_f32_16x16x32_bf16 v[28:31], v[60:63], v[116:119], v[28:31]
    ds_read_b64_tr_b16 v[50:51], v252 offset:59392
    v_mfma_f32_16x16x32_bf16 v[32:35], v[64:67], v[116:119], v[32:35]
    ds_read_b64_tr_b16 v[52:53], v253 offset:57344
    v_mfma_f32_16x16x32_bf16 v[36:39], v[68:71], v[116:119], v[36:39]
    ds_read_b64_tr_b16 v[54:55], v253 offset:59392
    s_cbranch_vccnz L_r30
L_b30:
    s_waitcnt lgkmcnt(0)
    v_mfma_f32_16x16x32_bf16 v[8:11], v[40:43], v[120:123], v[8:11]
    ds_read_b64_tr_b16 v[56:57], v250 offset:61440
    v_mfma_f32_16x16x32_bf16 v[12:15], v[44:47], v[120:123], v[12:15]
    ds_read_b64_tr_b16 v[58:59], v250 offset:63488
    v_mfma_f32_16x16x32_bf16 v[16:19], v[48:51], v[120:123], v[16:19]
    ds_read_b64_tr_b16 v[60:61], v251 offset:61440
    v_mfma_f32_16x16x32_bf16 v[20:23], v[52:55], v[120:123], v[20:23]
    ds_read_b64_tr_b16 v[62:63], v251 offset:63488
    v_mfma_f32_16x16x32_bf16 v[24:27], v[40:43], v[124:127], v[24:27]
    ds_read_b64_tr_b16 v[64:65], v252 offset:61440
    s_waitcnt vmcnt(0)
    v_max_u32 v7, v128, v132
    v_cmp_eq_u32 vcc, -1, v7
    v_mfma_f32_16x16x32_bf16 v[28:31], v[44:47], v[124:127], v[28:31]
    ds_read_b64_tr_b16 v[66:67], v252 offset:63488
    v_mfma_f32_16x16x32_bf16 v[32:35], v[48:51], v[124:127], v[32:35]
    ds_read_b64_tr_b16 v[68:69], v253 offset:61440
    v_mfma_f32_16x16x32_bf16 v[36:39], v[52:55], v[124:127], v[36:39]
    ds_read_b64_tr_b16 v[70:71], v253 offset:63488
    s_cbranch_vccnz L_r31
L_b31:
    s_waitcnt lgkmcnt(0)
    v_mfma_f32_16x16x32_bf16 v[8:11], v[56:59], v[128:131], v[8:11]
    v_mfma_f32_16x16x32_bf16 v[12:15], v[60:63], v[128:131], v[12:15]
    v_mfma_f32_16x16x32_bf16 v[16:19], v[64:67], v[128:131], v[16:19]
    v_mfma_f32_16x16x32_bf16 v[20:23], v[68:71], v[128:131], v[20:23]
    v_mfma_f32_16x16x32_bf16 v[24:27], v[56:59], v[132:135], v[24:27]
    v_mfma_f32_16x16x32_bf16 v[28:31], v[60:63], v[132:135], v[28:31]
    v_mfma_f32_16x16x32_bf16 v[32:35], v[64:67], v[132:135], v[32:35]
    v_mfma_f32_16x16x32_bf16 v[36:39], v[68:71], v[132:135], v[36:39]
    s_bfe_u32 s3, s34, 0x20005
    s_cmp_eq_u32 s3, s38
    s_cselect_b32 s3, s35, 0
    s_and_b32 s65, s34, 15
    s_lshl_b32 s66, 0x00010001, s65
    s_cmp_eq_u32 s3, 0
    s_cselect_b32 s66, 0, s66
    s_bfe_u32 s65, s34, 0x10004
    v_and_b32 v7, 1, v2
    v_lshlrev_b32 v6, 6, v7
    v_lshrrev_b32 v7, 1, v2
    v_lshl_add_u32 v6, v7, 5, v6
    v_add_u32 v6, 140288, v6
    v_permlane16_swap_b32 v8, v12
    v_permlane16_swap_b32 v9, v13
    v_permlane16_swap_b32 v10, v14
    v_permlane16_swap_b32 v11, v15
    v_permlane16_swap_b32 v16, v20
    v_permlane16_swap_b32 v17, v21
    v_permlane16_swap_b32 v18, v22
    v_permlane16_swap_b32 v19, v23
    s_cmp_eq_u32 s65, 0
    s_cselect_b32 s74, s66, 0
    s_mov_b32 s75, s74
    v_pk_fma_f32 v[176:177], v[8:9], v[208:209], v[176:177]
    v_pk_fma_f32 v[178:179], v[10:11], v[210:211], v[178:179]
    v_pk_fma_f32 v[180:181], v[12:13], v[212:213], v[180:181]
    v_pk_fma_f32 v[182:183], v[14:15], v[214:215], v[182:183]
    v_cvt_pk_bf16_f32 v72, v176, v177
    v_cvt_pk_bf16_f32 v73, v178, v179
    v_cvt_pk_bf16_f32 v74, v180, v181
    v_cvt_pk_bf16_f32 v75, v182, v183
    v_pk_fma_f32 v[184:185], v[16:17], v[216:217], v[184:185]
    v_pk_fma_f32 v[186:187], v[18:19], v[218:219], v[186:187]
    v_pk_fma_f32 v[188:189], v[20:21], v[220:221], v[188:189]
    v_pk_fma_f32 v[190:191], v[22:23], v[222:223], v[190:191]
    v_cvt_pk_bf16_f32 v76, v184, v185
    v_cvt_pk_bf16_f32 v77, v186, v187
    v_cvt_pk_bf16_f32 v78, v188, v189
    v_cvt_pk_bf16_f32 v79, v190, v191
    s_andn2_b64 exec, -1, s[74:75]
    buffer_store_dwordx4 v[72:75], v246, s[24:27], 0 offen offset:0 nt
    buffer_store_dwordx4 v[76:79], v246, s[24:27], 0 offen offset:64 nt
    s_cmp_eq_u32 s74, 0
    s_cbranch_scc1 L_ns0
    s_mov_b64 exec, s[74:75]
    ds_write_b128 v6, v[8:11] offset:0
    ds_write_b128 v6, v[12:15] offset:16
    ds_write_b128 v6, v[16:19] offset:128
    ds_write_b128 v6, v[20:23] offset:144
L_ns0:
    s_mov_b64 exec, -1
    v_permlane16_swap_b32 v24, v28
    v_permlane16_swap_b32 v25, v29
    v_permlane16_swap_b32 v26, v30
    v_permlane16_swap_b32 v27, v31
    v_permlane16_swap_b32 v32, v36
    v_permlane16_swap_b32 v33, v37
    v_permlane16_swap_b32 v34, v38
    v_permlane16_swap_b32 v35, v39
    s_cmp_eq_u32 s65, 1
    s_cselect_b32 s74, s66, 0
    s_mov_b32 s75, s74
    v_pk_fma_f32 v[192:193], v[24:25], v[224:225], v[192:193]
    v_pk_fma_f32 v[194:195], v[26:27], v[226:227], v[194:195]
    v_pk_fma_f32 v[196:197], v[28:29], v[228:229], v[196:197]
    v_pk_fma_f32 v[198:199], v[30:31], v[230:231], v[198:199]
    v_cvt_pk_bf16_f32 v80, v192, v193
    v_cvt_pk_bf16_f32 v81, v194, v195
    v_cvt_pk_bf16_f32 v82, v196, v197
    v_cvt_pk_bf16_f32 v83, v198, v199
    v_pk_fma_f32 v[200:201], v[32:33], v[232:233], v[200:201]
    v_pk_fma_f32 v[202:203], v[34:35], v[234:235], v[202:203]
    v_pk_fma_f32 v[204:205], v[36:37], v[236:237], v[204:205]
    v_pk_fma_f32 v[206:207], v[38:39], v[238:239], v[206:207]
    v_cvt_pk_bf16_f32 v84, v200, v201
    v_cvt_pk_bf16_f32 v85, v202, v203
    v_cvt_pk_bf16_f32 v86, v204, v205
    v_cvt_pk_bf16_f32 v87, v206, v207
    s_andn2_b64 exec, -1, s[74:75]
    buffer_store_dwordx4 v[80:83], v246, s[24:27], s68 offen offset:0 nt
    buffer_store_dwordx4 v[84:87], v246, s[24:27], s68 offen offset:64 nt
    s_cmp_eq_u32 s74, 0
    s_cbranch_scc1 L_ns1
    s_mov_b64 exec, s[74:75]
    ds_write_b128 v6, v[24:27] offset:0
    ds_write_b128 v6, v[28:31] offset:16
    ds_write_b128 v6, v[32:35] offset:128
    ds_write_b128 v6, v[36:39] offset:144
L_ns1:
    s_mov_b64 exec, -1
    s_cmp_eq_u32 s35, 0
    s_cbranch_scc1 L_g1end
    s_waitcnt lgkmcnt(0)
    s_barrier
L_g1end:
    s_endpgm
L_r0:
    s_add_u32 s70, s70, 1
    s_cmp_ge_u32 s70, 200000
    s_cbranch_scc1 L_b0
    s_add_u32 s76, s88, 0
    s_and_b32 s76, s76, 15
    s_lshl_b32 s76, s76, 11
    s_add_u32 s76, s76, s72
    buffer_load_dwordx4 v[72:75], v5, s[12:15], s76 offen offset:0 sc1
    buffer_load_dwordx4 v[76:79], v4, s[12:15], s76 offen offset:0 sc1
    s_waitcnt vmcnt(0)
    v_max_u32 v7, v72, v76
    v_cmp_eq_u32 vcc, -1, v7
    s_nop 3
    s_cbranch_vccnz L_r0
    s_branch L_b0
L_r1:
    s_add_u32 s70, s70, 1
    s_cmp_ge_u32 s70, 200000
    s_cbranch_scc1 L_b1
    s_add_u32 s76, s88, 0
    s_and_b32 s76, s76, 15
    s_lshl_b32 s76, s76, 11
    s_add_u32 s76, s76, s72
    buffer_load_dwordx4 v[80:83], v5, s[12:15], s76 offen offset:1024 sc1
    buffer_load_dwordx4 v[84:87], v4, s[12:15], s76 offen offset:1024 sc1
    s_waitcnt vmcnt(0)
    v_max_u32 v7, v80, v84
    v_cmp_eq_u32 vcc, -1, v7
    s_nop 3
    s_cbranch_vccnz L_r1
    s_branch L_b1
L_r2:
    s_add_u32 s70, s70, 1
    s_cmp_ge_u32 s70, 200000
    s_cbranch_scc1 L_b2
    s_add_u32 s76, s88, 1
    s_and_b32 s76, s76, 15
    s_lshl_b32 s76, s76, 11
    s_add_u32 s76, s76, s72
    buffer_load_dwordx4 v[88:91], v5, s[12:15], s76 offen offset:0 sc1
    buffer_load_dwordx4 v[92:95], v4, s[12:15], s76 offen offset:0 sc1
    s_waitcnt vmcnt(0)
    v_max_u32 v7, v88, v92
    v_cmp_eq_u32 vcc, -1, v7
    s_nop 3
    s_cbranch_vccnz L_r2
    s_branch L_b2
L_r3:
    s_add_u32 s70, s70, 1
    s_cmp_ge_u32 s70, 200000
    s_cbranch_scc1 L_b3
    s_add_u32 s76, s88, 1
    s_and_b32 s76, s76, 15
    s_lshl_b32 s76, s76, 11
    s_add_u32 s76, s76, s72
    buffer_load_dwordx4 v[96:99], v5, s[12:15], s76 offen offset:1024 sc1
    buffer_load_dwordx4 v[100:103], v4, s[12:15], s76 offen offset:1024 sc1
    s_waitcnt vmcnt(0)
    v_max_u32 v7, v96, v100
    v_cmp_eq_u32 vcc, -1, v7
    s_nop 3
    s_cbranch_vccnz L_r3
    s_branch L_b3
L_r4:
    s_add_u32 s70, s70, 1
    s_cmp_ge_u32 s70, 200000
    s_cbranch_scc1 L_b4
    s_add_u32 s76, s88, 2
    s_and_b32 s76, s76, 15
    s_lshl_b32 s76, s76, 11
    s_add_u32 s76, s76, s72
    buffer_load_dwordx4 v[104:107], v5, s[12:15], s76 offen offset:0 sc1
    buffer_load_dwordx4 v[108:111], v4, s[12:15], s76 offen offset:0 sc1
    s_waitcnt vmcnt(0)
    v_max_u32 v7, v104, v108
    v_cmp_eq_u32 vcc, -1, v7
    s_nop 3
    s_cbranch_vccnz L_r4
    s_branch L_b4
L_r5:
    s_add_u32 s70, s70, 1
    s_cmp_ge_u32 s70, 200000
    s_cbranch_scc1 L_b5
    s_add_u32 s76, s88, 2
    s_and_b32 s76, s76, 15
    s_lshl_b32 s76, s76, 11
    s_add_u32 s76, s76, s72
    buffer_load_dwordx4 v[112:115], v5, s[12:15], s76 offen offset:1024 sc1
    buffer_load_dwordx4 v[116:119], v4, s[12:15], s76 offen offset:1024 sc1
    s_waitcnt vmcnt(0)
    v_max_u32 v7, v112, v116
    v_cmp_eq_u32 vcc, -1, v7
    s_nop 3
    s_cbranch_vccnz L_r5
    s_branch L_b5
L_r6:
    s_add_u32 s70, s70, 1
    s_cmp_ge_u32 s70, 200000
    s_cbranch_scc1 L_b6
    s_add_u32 s76, s88, 3
    s_and_b32 s76, s76, 15
    s_lshl_b32 s76, s76, 11
    s_add_u32 s76, s76, s72
    buffer_load_dwordx4 v[120:123], v5, s[12:15], s76 offen offset:0 sc1
    buffer_load_dwordx4 v[124:127], v4, s[12:15], s76 offen offset:0 sc1
    s_waitcnt vmcnt(0)
    v_max_u32 v7, v120, v124
    v_cmp_eq_u32 vcc, -1, v7
    s_nop 3
    s_cbranch_vccnz L_r6
    s_branch L_b6
L_r7:
    s_add_u32 s70, s70, 1
    s_cmp_ge_u32 s70, 200000
    s_cbranch_scc1 L_b7
    s_add_u32 s76, s88, 3
    s_and_b32 s76, s76, 15
    s_lshl_b32 s76, s76, 11
    s_add_u32 s76, s76, s72
    buffer_load_dwordx4 v[128:131], v5, s[12:15], s76 offen offset:1024 sc1
    buffer_load_dwordx4 v[132:135], v4, s[12:15], s76 offen offset:1024 sc1
    s_waitcnt vmcnt(0)
    v_max_u32 v7, v128, v132
    v_cmp_eq_u32 vcc, -1, v7
    s_nop 3
    s_cbranch_vccnz L_r7
    s_branch L_b7
L_r8:
    s_add_u32 s70, s70, 1
    s_cmp_ge_u32 s70, 200000
    s_cbranch_scc1 L_b8
    s_add_u32 s76, s88, 4
    s_and_b32 s76, s76, 15
    s_lshl_b32 s76, s76, 11
    s_add_u32 s76, s76, s72
    buffer_load_dwordx4 v[136:139], v5, s[12:15], s76 offen offset:0 sc1
    buffer_load_dwordx4 v[140:143], v4, s[12:15], s76 offen offset:0 sc1
    s_waitcnt vmcnt(0)
    v_max_u32 v7, v136, v140
    v_cmp_eq_u32 vcc, -1, v7
    s_nop 3
    s_cbranch_vccnz L_r8
    s_branch L_b8
L_r9:
    s_add_u32 s70, s70, 1
    s_cmp_ge_u32 s70, 200000
    s_cbranch_scc1 L_b9
    s_add_u32 s76, s88, 4
    s_and_b32 s76, s76, 15
    s_lshl_b32 s76, s76, 11
    s_add_u32 s76, s76, s72
    buffer_load_dwordx4 v[144:147], v5, s[12:15], s76 offen offset:1024 sc1
    buffer_load_dwordx4 v[148:151], v4, s[12:15], s76 offen offset:1024 sc1
    s_waitcnt vmcnt(0)
    v_max_u32 v7, v144, v148
    v_cmp_eq_u32 vcc, -1, v7
    s_nop 3
    s_cbranch_vccnz L_r9
    s_branch L_b9
L_r10:
    s_add_u32 s70, s70, 1
    s_cmp_ge_u32 s70, 200000
    s_cbranch_scc1 L_b10
    s_add_u32 s76, s88, 5
    s_and_b32 s76, s76, 15
    s_lshl_b32 s76, s76, 11
    s_add_u32 s76, s76, s72
    buffer_load_dwordx4 v[152:155], v5, s[12:15], s76 offen offset:0 sc1
    buffer_load_dwordx4 v[156:159], v4, s[12:15], s76 offen offset:0 sc1
    s_waitcnt vmcnt(0)
    v_max_u32 v7, v152, v156
    v_cmp_eq_u32 vcc, -1, v7
    s_nop 3
    s_cbranch_vccnz L_r10
    s_branch L_b10
L_r11:
    s_add_u32 s70, s70, 1
    s_cmp_ge_u32 s70, 200000
    s_cbranch_scc1 L_b11
    s_add_u32 s76, s88, 5
    s_and_b32 s76, s76, 15
    s_lshl_b32 s76, s76, 11
    s_add_u32 s76, s76, s72
    buffer_load_dwordx4 v[160:163], v5, s[12:15], s76 offen offset:1024 sc1
    buffer_load_dwordx4 v[164:167], v4, s[12:15], s76 offen offset:1024 sc1
    s_waitcnt vmcnt(0)
    v_max_u32 v7, v160, v164
    v_cmp_eq_u32 vcc, -1, v7
    s_nop 3
    s_cbranch_vccnz L_r11
    s_branch L_b11
L_r12:
    s_add_u32 s70, s70, 1
    s_cmp_ge_u32 s70, 200000
    s_cbranch_scc1 L_b12
    s_add_u32 s76, s88, 6
    s_and_b32 s76, s76, 15
    s_lshl_b32 s76, s76, 11
    s_add_u32 s76, s76, s72
    buffer_load_dwordx4 v[72:75], v5, s[12:15], s76 offen offset:0 sc1
    buffer_load_dwordx4 v[76:79], v4, s[12:15], s76 offen offset:0 sc1
    s_waitcnt vmcnt(0)
    v_max_u32 v7, v72, v76
    v_cmp_eq_u32 vcc, -1, v7
    s_nop 3
    s_cbranch_vccnz L_r12
    s_branch L_b12
L_r13:
    s_add_u32 s70, s70, 1
    s_cmp_ge_u32 s70, 200000
    s_cbranch_scc1 L_b13
    s_add_u32 s76, s88, 6
    s_and_b32 s76, s76, 15
    s_lshl_b32 s76, s76, 11
    s_add_u32 s76, s76, s72
    buffer_load_dwordx4 v[80:83], v5, s[12:15], s76 offen offset:1024 sc1
    buffer_load_dwordx4 v[84:87], v4, s[12:15], s76 offen offset:1024 sc1
    s_waitcnt vmcnt(0)
    v_max_u32 v7, v80, v84
    v_cmp_eq_u32 vcc, -1, v7
    s_nop 3
    s_cbranch_vccnz L_r13
    s_branch L_b13
L_r14:
    s_add_u32 s70, s70, 1
    s_cmp_ge_u32 s70, 200000
    s_cbranch_scc1 L_b14
    s_add_u32 s76, s88, 7
    s_and_b32 s76, s76, 15
    s_lshl_b32 s76, s76, 11
    s_add_u32 s76, s76, s72
    buffer_load_dwordx4 v[88:91], v5, s[12:15], s76 offen offset:0 sc1
    buffer_load_dwordx4 v[92:95], v4, s[12:15], s76 offen offset:0 sc1
    s_waitcnt vmcnt(0)
    v_max_u32 v7, v88, v92
    v_cmp_eq_u32 vcc, -1, v7
    s_nop 3
    s_cbranch_vccnz L_r14
    s_branch L_b14
L_r15:
    s_add_u32 s70, s70, 1
    s_cmp_ge_u32 s70, 200000
    s_cbranch_scc1 L_b15
    s_add_u32 s76, s88, 7
    s_and_b32 s76, s76, 15
    s_lshl_b32 s76, s76, 11
    s_add_u32 s76, s76, s72
    buffer_load_dwordx4 v[96:99], v5, s[12:15], s76 offen offset:1024 sc1
    buffer_load_dwordx4 v[100:103], v4, s[12:15], s76 offen offset:1024 sc1
    s_waitcnt vmcnt(0)
    v_max_u32 v7, v96, v100
    v_cmp_eq_u32 vcc, -1, v7
    s_nop 3
    s_cbranch_vccnz L_r15
    s_branch L_b15
L_r16:
    s_add_u32 s70, s70, 1
    s_cmp_ge_u32 s70, 200000
    s_cbranch_scc1 L_b16
    s_add_u32 s76, s88, 8
    s_and_b32 s76, s76, 15
    s_lshl_b32 s76, s76, 11
    s_add_u32 s76, s76, s72
    buffer_load_dwordx4 v[104:107], v5, s[12:15], s76 offen offset:0 sc1
    buffer_load_dwordx4 v[108:111], v4, s[12:15], s76 offen offset:0 sc1
    s_waitcnt vmcnt(0)
    v_max_u32 v7, v104, v108
    v_cmp_eq_u32 vcc, -1, v7
    s_nop 3
    s_cbranch_vccnz L_r16
    s_branch L_b16
L_r17:
    s_add_u32 s70, s70, 1
    s_cmp_ge_u32 s70, 200000
    s_cbranch_scc1 L_b17
    s_add_u32 s76, s88, 8
    s_and_b32 s76, s76, 15
    s_lshl_b32 s76, s76, 11
    s_add_u32 s76, s76, s72
    buffer_load_dwordx4 v[112:115], v5, s[12:15], s76 offen offset:1024 sc1
    buffer_load_dwordx4 v[116:119], v4, s[12:15], s76 offen offset:1024 sc1
    s_waitcnt vmcnt(0)
    v_max_u32 v7, v112, v116
    v_cmp_eq_u32 vcc, -1, v7
    s_nop 3
    s_cbranch_vccnz L_r17
    s_branch L_b17
L_r18:
    s_add_u32 s70, s70, 1
    s_cmp_ge_u32 s70, 200000
    s_cbranch_scc1 L_b18
    s_add_u32 s76, s88, 9
    s_and_b32 s76, s76, 15
    s_lshl_b32 s76, s76, 11
    s_add_u32 s76, s76, s72
    buffer_load_dwordx4 v[120:123], v5, s[12:15], s76 offen offset:0 sc1
    buffer_load_dwordx4 v[124:127], v4, s[12:15], s76 offen offset:0 sc1
    s_waitcnt vmcnt(0)
    v_max_u32 v7, v120, v124
    v_cmp_eq_u32 vcc, -1, v7
    s_nop 3
    s_cbranch_vccnz L_r18
    s_branch L_b18
L_r19:
    s_add_u32 s70, s70, 1
    s_cmp_ge_u32 s70, 200000
    s_cbranch_scc1 L_b19
    s_add_u32 s76, s88, 9
    s_and_b32 s76, s76, 15
    s_lshl_b32 s76, s76, 11
    s_add_u32 s76, s76, s72
    buffer_load_dwordx4 v[128:131], v5, s[12:15], s76 offen offset:1024 sc1
    buffer_load_dwordx4 v[132:135], v4, s[12:15], s76 offen offset:1024 sc1
    s_waitcnt vmcnt(0)
    v_max_u32 v7, v128, v132
    v_cmp_eq_u32 vcc, -1, v7
    s_nop 3
    s_cbranch_vccnz L_r19
    s_branch L_b19
L_r20:
    s_add_u32 s70, s70, 1
    s_cmp_ge_u32 s70, 200000
    s_cbranch_scc1 L_b20
    s_add_u32 s76, s88, 10
    s_and_b32 s76, s76, 15
    s_lshl_b32 s76, s76, 11
    s_add_u32 s76, s76, s72
    buffer_load_dwordx4 v[136:139], v5, s[12:15], s76 offen offset:0 sc1
    buffer_load_dwordx4 v[140:143], v4, s[12:15], s76 offen offset:0 sc1
    s_waitcnt vmcnt(0)
    v_max_u32 v7, v136, v140
    v_cmp_eq_u32 vcc, -1, v7
    s_nop 3
    s_cbranch_vccnz L_r20
    s_branch L_b20
L_r21:
    s_add_u32 s70, s70, 1
    s_cmp_ge_u32 s70, 200000
    s_cbranch_scc1 L_b21
    s_add_u32 s76, s88, 10
    s_and_b32 s76, s76, 15
    s_lshl_b32 s76, s76, 11
    s_add_u32 s76, s76, s72
    buffer_load_dwordx4 v[144:147], v5, s[12:15], s76 offen offset:1024 sc1
    buffer_load_dwordx4 v[148:151], v4, s[12:15], s76 offen offset:1024 sc1
    s_waitcnt vmcnt(0)
    v_max_u32 v7, v144, v148
    v_cmp_eq_u32 vcc, -1, v7
    s_nop 3
    s_cbranch_vccnz L_r21
    s_branch L_b21
L_r22:
    s_add_u32 s70, s70, 1
    s_cmp_ge_u32 s70, 200000
    s_cbranch_scc1 L_b22
    s_add_u32 s76, s88, 11
    s_and_b32 s76, s76, 15
    s_lshl_b32 s76, s76, 11
    s_add_u32 s76, s76, s72
    buffer_load_dwordx4 v[152:155], v5, s[12:15], s76 offen offset:0 sc1
    buffer_load_dwordx4 v[156:159], v4, s[12:15], s76 offen offset:0 sc1
    s_waitcnt vmcnt(0)
    v_max_u32 v7, v152, v156
    v_cmp_eq_u32 vcc, -1, v7
    s_nop 3
    s_cbranch_vccnz L_r22
    s_branch L_b22
L_r23:
    s_add_u32 s70, s70, 1
    s_cmp_ge_u32 s70, 200000
    s_cbranch_scc1 L_b23
    s_add_u32 s76, s88, 11
    s_and_b32 s76, s76, 15
    s_lshl_b32 s76, s76, 11
    s_add_u32 s76, s76, s72
    buffer_load_dwordx4 v[160:163], v5, s[12:15], s76 offen offset:1024 sc1
    buffer_load_dwordx4 v[164:167], v4, s[12:15], s76 offen offset:1024 sc1
    s_waitcnt vmcnt(0)
    v_max_u32 v7, v160, v164
    v_cmp_eq_u32 vcc, -1, v7
    s_nop 3
    s_cbranch_vccnz L_r23
    s_branch L_b23
L_r24:
    s_add_u32 s70, s70, 1
    s_cmp_ge_u32 s70, 200000
    s_cbranch_scc1 L_b24
    s_add_u32 s76, s88, 12
    s_and_b32 s76, s76, 15
    s_lshl_b32 s76, s76, 11
    s_add_u32 s76, s76, s72
    buffer_load_dwordx4 v[72:75], v5, s[12:15], s76 offen offset:0 sc1
    buffer_load_dwordx4 v[76:79], v4, s[12:15], s76 offen offset:0 sc1
    s_waitcnt vmcnt(0)
    v_max_u32 v7, v72, v76
    v_cmp_eq_u32 vcc, -1, v7
    s_nop 3
    s_cbranch_vccnz L_r24
    s_branch L_b24
L_r25:
    s_add_u32 s70, s70, 1
    s_cmp_ge_u32 s70, 200000
    s_cbranch_scc1 L_b25
    s_add_u32 s76, s88, 12
    s_and_b32 s76, s76, 15
    s_lshl_b32 s76, s76, 11
    s_add_u32 s76, s76, s72
    buffer_load_dwordx4 v[80:83], v5, s[12:15], s76 offen offset:1024 sc1
    buffer_load_dwordx4 v[84:87], v4, s[12:15], s76 offen offset:1024 sc1
    s_waitcnt vmcnt(0)
    v_max_u32 v7, v80, v84
    v_cmp_eq_u32 vcc, -1, v7
    s_nop 3
    s_cbranch_vccnz L_r25
    s_branch L_b25
L_r26:
    s_add_u32 s70, s70, 1
    s_cmp_ge_u32 s70, 200000
    s_cbranch_scc1 L_b26
    s_add_u32 s76, s88, 13
    s_and_b32 s76, s76, 15
    s_lshl_b32 s76, s76, 11
    s_add_u32 s76, s76, s72
    buffer_load_dwordx4 v[88:91], v5, s[12:15], s76 offen offset:0 sc1
    buffer_load_dwordx4 v[92:95], v4, s[12:15], s76 offen offset:0 sc1
    s_waitcnt vmcnt(0)
    v_max_u32 v7, v88, v92
    v_cmp_eq_u32 vcc, -1, v7
    s_nop 3
    s_cbranch_vccnz L_r26
    s_branch L_b26
L_r27:
    s_add_u32 s70, s70, 1
    s_cmp_ge_u32 s70, 200000
    s_cbranch_scc1 L_b27
    s_add_u32 s76, s88, 13
    s_and_b32 s76, s76, 15
    s_lshl_b32 s76, s76, 11
    s_add_u32 s76, s76, s72
    buffer_load_dwordx4 v[96:99], v5, s[12:15], s76 offen offset:1024 sc1
    buffer_load_dwordx4 v[100:103], v4, s[12:15], s76 offen offset:1024 sc1
    s_waitcnt vmcnt(0)
    v_max_u32 v7, v96, v100
    v_cmp_eq_u32 vcc, -1, v7
    s_nop 3
    s_cbranch_vccnz L_r27
    s_branch L_b27
L_r28:
    s_add_u32 s70, s70, 1
    s_cmp_ge_u32 s70, 200000
    s_cbranch_scc1 L_b28
    s_add_u32 s76, s88, 14
    s_and_b32 s76, s76, 15
    s_lshl_b32 s76, s76, 11
    s_add_u32 s76, s76, s72
    buffer_load_dwordx4 v[104:107], v5, s[12:15], s76 offen offset:0 sc1
    buffer_load_dwordx4 v[108:111], v4, s[12:15], s76 offen offset:0 sc1
    s_waitcnt vmcnt(0)
    v_max_u32 v7, v104, v108
    v_cmp_eq_u32 vcc, -1, v7
    s_nop 3
    s_cbranch_vccnz L_r28
    s_branch L_b28
L_r29:
    s_add_u32 s70, s70, 1
    s_cmp_ge_u32 s70, 200000
    s_cbranch_scc1 L_b29
    s_add_u32 s76, s88, 14
    s_and_b32 s76, s76, 15
    s_lshl_b32 s76, s76, 11
    s_add_u32 s76, s76, s72
    buffer_load_dwordx4 v[112:115], v5, s[12:15], s76 offen offset:1024 sc1
    buffer_load_dwordx4 v[116:119], v4, s[12:15], s76 offen offset:1024 sc1
    s_waitcnt vmcnt(0)
    v_max_u32 v7, v112, v116
    v_cmp_eq_u32 vcc, -1, v7
    s_nop 3
    s_cbranch_vccnz L_r29
    s_branch L_b29
L_r30:
    s_add_u32 s70, s70, 1
    s_cmp_ge_u32 s70, 200000
    s_cbranch_scc1 L_b30
    s_add_u32 s76, s88, 15
    s_and_b32 s76, s76, 15
    s_lshl_b32 s76, s76, 11
    s_add_u32 s76, s76, s72
    buffer_load_dwordx4 v[120:123], v5, s[12:15], s76 offen offset:0 sc1
    buffer_load_dwordx4 v[124:127], v4, s[12:15], s76 offen offset:0 sc1
    s_waitcnt vmcnt(0)
    v_max_u32 v7, v120, v124
    v_cmp_eq_u32 vcc, -1, v7
    s_nop 3
    s_cbranch_vccnz L_r30
    s_branch L_b30
L_r31:
    s_add_u32 s70, s70, 1
    s_cmp_ge_u32 s70, 200000
    s_cbranch_scc1 L_b31
    s_add_u32 s76, s88, 15
    s_and_b32 s76, s76, 15
    s_lshl_b32 s76, s76, 11
    s_add_u32 s76, s76, s72
    buffer_load_dwordx4 v[128:131], v5, s[12:15], s76 offen offset:1024 sc1
    buffer_load_dwordx4 v[132:135], v4, s[12:15], s76 offen offset:1024 sc1
    s_waitcnt vmcnt(0)
    v_max_u32 v7, v128, v132
    v_cmp_eq_u32 vcc, -1, v7
    s_nop 3
    s_cbranch_vccnz L_r31
    s_branch L_b31
.p2align 8
L_code_end:
.fill 2048, 4, 0xbf800000
.section .rodata,"a"
.p2align 6
.amdhsa_kernel recurrent_scan__linear_kernel_hedgehog__moe_arch_mod__prompt_kernel
  .amdhsa_next_free_vgpr 256
  .amdhsa_next_free_sgpr 102
  .amdhsa_accum_offset 256
  .amdhsa_group_segment_fixed_size 0
  .amdhsa_kernarg_size 96
  .amdhsa_user_sgpr_count 2
  .amdhsa_user_sgpr_kernarg_segment_ptr 1
  .amdhsa_system_sgpr_workgroup_id_x 1
.end_amdhsa_kernel
```

```asm
; @launch grid=(256,1,1) block=(512,1,1) lds=163840
.amdgcn_target "amdgcn-amd-amdhsa--gfx950"
.text
.globl recurrent_scan__linear_kernel_hedgehog__moe_arch_mod__prompt_kernel
.p2align 8
.type recurrent_scan__linear_kernel_hedgehog__moe_arch_mod__prompt_kernel,@function
recurrent_scan__linear_kernel_hedgehog__moe_arch_mod__prompt_kernel:
    s_cmp_ge_u32 s2, 256
    s_cbranch_scc1 L_done
    s_load_dwordx16 s[40:55], s[0:1], 0
    s_load_dwordx8 s[56:63], s[0:1], 64
    v_and_b32 v1, 63, v0
    v_lshrrev_b32 v2, 6, v0
    s_nop 0
    v_readfirstlane_b32 s38, v2
    s_and_b32 s65, s2, 1
    s_bfe_u32 s66, s2, 0x30003
    s_bfe_u32 s67, s2, 0x20001
    s_lshl_b32 s67, s67, 2
    s_lshl_b32 s36, s65, 3
    s_add_u32 s36, s36, s66
    s_lshr_b32 s3, s2, 6
    s_add_u32 s37, s67, s3
    s_lshl_b32 s39, s66, 1
    s_add_u32 s39, s39, s65
    s_add_u32 s39, s39, s67
    s_and_b32 s39, s39, 15
    s_cmp_lt_u32 s38, 4
    s_cbranch_scc1 L_g1
    s_sub_u32 s38, s38, 4
    s_lshl_b32 s3, s38, 4
    v_lshrrev_b32 v7, 3, v1
    v_add_u32 v3, s3, v7
    v_mul_u32_u24 v3, 6144, v3
    s_lshl_b32 s3, s37, 7
    v_add_u32 v3, s3, v3
    v_and_b32 v6, 7, v1
    v_bfe_u32 v5, v1, 4, 1
    v_lshlrev_b32 v5, 1, v5
    v_xor_b32 v5, v6, v5
    v_lshl_add_u32 v16, v5, 4, v3
    v_xor_b32 v5, 4, v5
    v_lshl_add_u32 v5, v5, 4, v3
    v_add_u32 v17, 48128, v5
    v_add_u32 v12, 2048, v16
    v_add_u32 v13, 2048, v17
    v_add_u32 v14, 4096, v16
    v_add_u32 v15, 4096, v17
    s_lshl_b32 s3, s36, 7
    s_lshl_b32 s65, s38, 5
    s_add_u32 s3, s3, s65
    v_add_u32 v3, s3, v7
    v_lshlrev_b32 v3, 11, v3
    v_lshrrev_b32 v5, 4, v1
    v_xor_b32 v6, v6, v5
    v_xor_b32 v5, 4, v6
    v_lshl_add_u32 v8, v6, 4, v3
    v_lshl_add_u32 v5, v5, 4, v3
    v_add_u32 v9, 15360, v5
    v_add_u32 v10, 30720, v8
    v_add_u32 v11, 46080, v5
    s_lshl_b32 s72, s38, 12
    s_lshl_b32 s73, s38, 11
    s_lshl_b32 s74, s39, 7
    s_mul_i32 s75, s39, 393216
    s_mov_b32 s76, s75
    s_waitcnt lgkmcnt(0)
    s_mov_b32 s8, s42
    s_mov_b32 s9, s43
    s_mov_b32 s10, 6291456
    s_mov_b32 s11, 0x00020000
    s_mov_b32 s4, s40
    s_mov_b32 s5, s41
    s_mov_b32 s6, 4194304
    s_mov_b32 s7, 0x00020000
    s_cmp_ge_u32 s38, 2
    s_cbranch_scc1 L_xw
    s_add_u32 s3, s75, 196608
    s_add_u32 m0, s73, 65536
    s_nop 0
    buffer_load_dwordx4 v12, s[8:11], s75 offen offset:0  lds
    buffer_load_dwordx4 v13, s[8:11], s75 offen offset:1024  lds
    s_add_u32 m0, s73, 73728
    s_nop 0
    buffer_load_dwordx4 v14, s[8:11], s75 offen offset:0  lds
    buffer_load_dwordx4 v15, s[8:11], s75 offen offset:1024  lds
    s_add_u32 m0, s73, 69632
    s_nop 0
    buffer_load_dwordx4 v12, s[8:11], s3 offen offset:0  lds
    buffer_load_dwordx4 v13, s[8:11], s3 offen offset:1024  lds
    s_add_u32 m0, s73, 77824
    s_nop 0
    buffer_load_dwordx4 v14, s[8:11], s3 offen offset:0  lds
    buffer_load_dwordx4 v15, s[8:11], s3 offen offset:1024  lds
    s_add_u32 s75, s75, 393216
    s_cmp_eq_u32 s75, 6291456
    s_cselect_b32 s75, 0, s75
    s_add_u32 m0, s72, 0
    s_nop 0
    buffer_load_dwordx4 v8, s[4:7], s74 offen offset:0  lds
    buffer_load_dwordx4 v9, s[4:7], s74 offen offset:1024  lds
    buffer_load_dwordx4 v10, s[4:7], s74 offen offset:2048  lds
    buffer_load_dwordx4 v11, s[4:7], s74 offen offset:3072  lds
    s_add_u32 m0, s72, 8192
    s_add_u32 s3, s74, 131072
    buffer_load_dwordx4 v8, s[4:7], s3 offen offset:0  lds
    buffer_load_dwordx4 v9, s[4:7], s3 offen offset:1024  lds
    buffer_load_dwordx4 v10, s[4:7], s3 offen offset:2048  lds
    buffer_load_dwordx4 v11, s[4:7], s3 offen offset:3072  lds
    s_add_u32 s74, s74, 128
    s_and_b32 s74, s74, 2047
    v_lshlrev_b32 v3, 4, v1
    s_mov_b32 s12, s62
    s_mov_b32 s13, s63
    s_mov_b32 s14, 268435456
    s_mov_b32 s15, 0x00020000
    s_and_b32 s30, s2, 7
    s_lshl_b32 s30, s30, 1
    s_bfe_u32 s3, s2, 0x10003
    s_add_u32 s30, s30, s3
    s_lshr_b32 s31, s2, 4
    s_mov_b32 s88, 0
    s_mov_b32 s70, 0
    s_mov_b32 s80, s52
    s_mov_b32 s81, s53
    s_mov_b32 s82, 7340032
    s_mov_b32 s83, 0x00020000
    s_mov_b32 s84, s54
    s_mov_b32 s85, s55
    s_mov_b32 s86, 7340032
    s_mov_b32 s87, 0x00020000
    s_cmp_lt_u32 s2, 224
    s_cselect_b32 s82, s82, 0
    s_cselect_b32 s86, s86, 0
    s_and_b32 s3, s2, 15
    s_lshl_b32 s3, s3, 6
    v_and_b32 v5, 0x38, v1
    v_add_u32 v5, s3, v5
    v_mul_u32_u24 v5, 7168, v5
    v_and_b32 v6, 7, v1
    v_lshl_add_u32 v2, v6, 4, v5
    s_lshr_b32 s77, s2, 4
    s_lshl_b32 s77, s77, 2
    s_add_u32 s77, s77, s38
    s_lshl_b32 s77, s77, 7
    v_and_b32 v5, 1, v1
    v_cmp_eq_u32 vcc, 0, v5
    v_mov_b32 v6, 0xffff0000
    v_mov_b32 v7, 0xffff
    v_cndmask_b32 v6, v6, v7, vcc
    v_bfe_u32 v5, v1, 1, 2
    v_cmp_eq_u32 vcc, 0, v5
    s_nop 1
    v_cndmask_b32 v88, 0, v6, vcc
    v_cmp_eq_u32 vcc, 1, v5
    s_nop 1
    v_cndmask_b32 v89, 0, v6, vcc
    v_cmp_eq_u32 vcc, 2, v5
    s_nop 1
    v_cndmask_b32 v90, 0, v6, vcc
    v_cmp_eq_u32 vcc, 3, v5
    s_nop 1
    v_cndmask_b32 v91, 0, v6, vcc
    v_and_b32 v20, 0x3f803f80, v88
    v_and_b32 v21, 0x3f803f80, v89
    v_and_b32 v22, 0x3f803f80, v90
    v_and_b32 v23, 0x3f803f80, v91
    s_add_u32 s3, s75, 196608
    s_add_u32 m0, s73, 81920
    s_nop 0
    buffer_load_dwordx4 v12, s[8:11], s75 offen offset:0  lds
    buffer_load_dwordx4 v13, s[8:11], s75 offen offset:1024  lds
    s_add_u32 m0, s73, 90112
    s_nop 0
    buffer_load_dwordx4 v14, s[8:11], s75 offen offset:0  lds
    buffer_load_dwordx4 v15, s[8:11], s75 offen offset:1024  lds
    s_add_u32 m0, s73, 86016
    s_nop 0
    buffer_load_dwordx4 v12, s[8:11], s3 offen offset:0  lds
    buffer_load_dwordx4 v13, s[8:11], s3 offen offset:1024  lds
    s_add_u32 m0, s73, 94208
    s_nop 0
    buffer_load_dwordx4 v14, s[8:11], s3 offen offset:0  lds
    buffer_load_dwordx4 v15, s[8:11], s3 offen offset:1024  lds
    s_add_u32 s75, s75, 393216
    s_cmp_eq_u32 s75, 6291456
    s_cselect_b32 s75, 0, s75
    s_waitcnt vmcnt(8)
    s_barrier
    s_add_u32 m0, s72, 16384
    s_nop 0
    buffer_load_dwordx4 v8, s[4:7], s74 offen offset:0  lds
    buffer_load_dwordx4 v9, s[4:7], s74 offen offset:1024  lds
    buffer_load_dwordx4 v10, s[4:7], s74 offen offset:2048  lds
    buffer_load_dwordx4 v11, s[4:7], s74 offen offset:3072  lds
    s_add_u32 m0, s72, 24576
    s_add_u32 s3, s74, 131072
    buffer_load_dwordx4 v8, s[4:7], s3 offen offset:0  lds
    buffer_load_dwordx4 v9, s[4:7], s3 offen offset:1024  lds
    buffer_load_dwordx4 v10, s[4:7], s3 offen offset:2048  lds
    buffer_load_dwordx4 v11, s[4:7], s3 offen offset:3072  lds
    s_add_u32 s74, s74, 128
    s_and_b32 s74, s74, 2047
    s_add_u32 s3, s75, 196608
    s_add_u32 m0, s73, 98304
    s_nop 0
    buffer_load_dwordx4 v12, s[8:11], s75 offen offset:0  lds
    buffer_load_dwordx4 v13, s[8:11], s75 offen offset:1024  lds
    s_add_u32 m0, s73, 106496
    s_nop 0
    buffer_load_dwordx4 v14, s[8:11], s75 offen offset:0  lds
    buffer_load_dwordx4 v15, s[8:11], s75 offen offset:1024  lds
    s_add_u32 m0, s73, 102400
    s_nop 0
    buffer_load_dwordx4 v12, s[8:11], s3 offen offset:0  lds
    buffer_load_dwordx4 v13, s[8:11], s3 offen offset:1024  lds
    s_add_u32 m0, s73, 110592
    s_nop 0
    buffer_load_dwordx4 v14, s[8:11], s3 offen offset:0  lds
    buffer_load_dwordx4 v15, s[8:11], s3 offen offset:1024  lds
    s_add_u32 s75, s75, 393216
    s_cmp_eq_u32 s75, 6291456
    s_cselect_b32 s75, 0, s75
    s_waitcnt vmcnt(8)
    s_barrier
    s_add_u32 m0, s72, 32768
    s_nop 0
    buffer_load_dwordx4 v8, s[4:7], s74 offen offset:0  lds
    buffer_load_dwordx4 v9, s[4:7], s74 offen offset:1024  lds
    buffer_load_dwordx4 v10, s[4:7], s74 offen offset:2048  lds
    buffer_load_dwordx4 v11, s[4:7], s74 offen offset:3072  lds
    s_add_u32 m0, s72, 40960
    s_add_u32 s3, s74, 131072
    buffer_load_dwordx4 v8, s[4:7], s3 offen offset:0  lds
    buffer_load_dwordx4 v9, s[4:7], s3 offen offset:1024  lds
    buffer_load_dwordx4 v10, s[4:7], s3 offen offset:2048  lds
    buffer_load_dwordx4 v11, s[4:7], s3 offen offset:3072  lds
    s_add_u32 s74, s74, 128
    s_and_b32 s74, s74, 2047
    s_add_u32 m0, s72, 49152
    s_nop 0
    buffer_load_dwordx4 v8, s[4:7], s74 offen offset:0  lds
    buffer_load_dwordx4 v9, s[4:7], s74 offen offset:1024  lds
    buffer_load_dwordx4 v10, s[4:7], s74 offen offset:2048  lds
    buffer_load_dwordx4 v11, s[4:7], s74 offen offset:3072  lds
    s_add_u32 m0, s72, 57344
    s_add_u32 s3, s74, 131072
    buffer_load_dwordx4 v8, s[4:7], s3 offen offset:0  lds
    buffer_load_dwordx4 v9, s[4:7], s3 offen offset:1024  lds
    buffer_load_dwordx4 v10, s[4:7], s3 offen offset:2048  lds
    buffer_load_dwordx4 v11, s[4:7], s3 offen offset:3072  lds
    s_add_u32 s74, s74, 128
    s_and_b32 s74, s74, 2047
    s_add_u32 s3, s75, 196608
    s_add_u32 m0, s73, 114688
    s_nop 0
    buffer_load_dwordx4 v12, s[8:11], s75 offen offset:0  lds
    buffer_load_dwordx4 v13, s[8:11], s75 offen offset:1024  lds
    s_add_u32 m0, s73, 122880
    s_nop 0
    buffer_load_dwordx4 v14, s[8:11], s75 offen offset:0  lds
    buffer_load_dwordx4 v15, s[8:11], s75 offen offset:1024  lds
    s_add_u32 m0, s73, 118784
    s_nop 0
    buffer_load_dwordx4 v12, s[8:11], s3 offen offset:0  lds
    buffer_load_dwordx4 v13, s[8:11], s3 offen offset:1024  lds
    s_add_u32 m0, s73, 126976
    s_nop 0
    buffer_load_dwordx4 v14, s[8:11], s3 offen offset:0  lds
    buffer_load_dwordx4 v15, s[8:11], s3 offen offset:1024  lds
    s_add_u32 s75, s75, 393216
    s_cmp_eq_u32 s75, 6291456
    s_cselect_b32 s75, 0, s75
    s_waitcnt vmcnt(16)
    s_barrier
    s_add_u32 m0, s72, 0
    s_nop 0
    buffer_load_dwordx4 v8, s[4:7], s74 offen offset:0  lds
    buffer_load_dwordx4 v9, s[4:7], s74 offen offset:1024  lds
    buffer_load_dwordx4 v10, s[4:7], s74 offen offset:2048  lds
    buffer_load_dwordx4 v11, s[4:7], s74 offen offset:3072  lds
    s_add_u32 m0, s72, 8192
    s_add_u32 s3, s74, 131072
    buffer_load_dwordx4 v8, s[4:7], s3 offen offset:0  lds
    buffer_load_dwordx4 v9, s[4:7], s3 offen offset:1024  lds
    buffer_load_dwordx4 v10, s[4:7], s3 offen offset:2048  lds
    buffer_load_dwordx4 v11, s[4:7], s3 offen offset:3072  lds
    s_add_u32 s74, s74, 128
    s_and_b32 s74, s74, 2047
    s_add_u32 s3, s75, 196608
    s_add_u32 m0, s73, 65536
    s_nop 0
    buffer_load_dwordx4 v12, s[8:11], s75 offen offset:0  lds
    buffer_load_dwordx4 v13, s[8:11], s75 offen offset:1024  lds
    s_add_u32 m0, s73, 73728
    s_nop 0
    buffer_load_dwordx4 v14, s[8:11], s75 offen offset:0  lds
    buffer_load_dwordx4 v15, s[8:11], s75 offen offset:1024  lds
    s_add_u32 m0, s73, 69632
    s_nop 0
    buffer_load_dwordx4 v12, s[8:11], s3 offen offset:0  lds
    buffer_load_dwordx4 v13, s[8:11], s3 offen offset:1024  lds
    s_add_u32 m0, s73, 77824
    s_nop 0
    buffer_load_dwordx4 v14, s[8:11], s3 offen offset:0  lds
    buffer_load_dwordx4 v15, s[8:11], s3 offen offset:1024  lds
    s_add_u32 s75, s75, 393216
    s_cmp_eq_u32 s75, 6291456
    s_cselect_b32 s75, 0, s75
    s_add_u32 m0, s72, 16384
    s_nop 0
    buffer_load_dwordx4 v8, s[4:7], s74 offen offset:0  lds
    buffer_load_dwordx4 v9, s[4:7], s74 offen offset:1024  lds
    buffer_load_dwordx4 v10, s[4:7], s74 offen offset:2048  lds
    buffer_load_dwordx4 v11, s[4:7], s74 offen offset:3072  lds
    s_add_u32 m0, s72, 24576
    s_add_u32 s3, s74, 131072
    buffer_load_dwordx4 v8, s[4:7], s3 offen offset:0  lds
    buffer_load_dwordx4 v9, s[4:7], s3 offen offset:1024  lds
    buffer_load_dwordx4 v10, s[4:7], s3 offen offset:2048  lds
    buffer_load_dwordx4 v11, s[4:7], s3 offen offset:3072  lds
    s_add_u32 s74, s74, 128
    s_and_b32 s74, s74, 2047
    s_waitcnt vmcnt(24)
    s_barrier
    s_add_u32 s3, s75, 196608
    s_add_u32 m0, s73, 81920
    s_nop 0
    buffer_load_dwordx4 v12, s[8:11], s75 offen offset:0  lds
    buffer_load_dwordx4 v13, s[8:11], s75 offen offset:1024  lds
    s_add_u32 m0, s73, 90112
    s_nop 0
    buffer_load_dwordx4 v14, s[8:11], s75 offen offset:0  lds
    buffer_load_dwordx4 v15, s[8:11], s75 offen offset:1024  lds
    s_add_u32 m0, s73, 86016
    s_nop 0
    buffer_load_dwordx4 v12, s[8:11], s3 offen offset:0  lds
    buffer_load_dwordx4 v13, s[8:11], s3 offen offset:1024  lds
    s_add_u32 m0, s73, 94208
    s_nop 0
    buffer_load_dwordx4 v14, s[8:11], s3 offen offset:0  lds
    buffer_load_dwordx4 v15, s[8:11], s3 offen offset:1024  lds
    s_add_u32 s75, s75, 393216
    s_cmp_eq_u32 s75, 6291456
    s_cselect_b32 s75, 0, s75
    s_add_u32 m0, s72, 32768
    s_nop 0
    buffer_load_dwordx4 v8, s[4:7], s74 offen offset:0  lds
    buffer_load_dwordx4 v9, s[4:7], s74 offen offset:1024  lds
    buffer_load_dwordx4 v10, s[4:7], s74 offen offset:2048  lds
    buffer_load_dwordx4 v11, s[4:7], s74 offen offset:3072  lds
    s_add_u32 m0, s72, 40960
    s_add_u32 s3, s74, 131072
    buffer_load_dwordx4 v8, s[4:7], s3 offen offset:0  lds
    buffer_load_dwordx4 v9, s[4:7], s3 offen offset:1024  lds
    buffer_load_dwordx4 v10, s[4:7], s3 offen offset:2048  lds
    buffer_load_dwordx4 v11, s[4:7], s3 offen offset:3072  lds
    s_add_u32 s74, s74, 128
    s_and_b32 s74, s74, 2047
    s_add_u32 s3, s75, 196608
    s_add_u32 m0, s73, 98304
    s_nop 0
    buffer_load_dwordx4 v12, s[8:11], s75 offen offset:0  lds
    buffer_load_dwordx4 v13, s[8:11], s75 offen offset:1024  lds
    s_add_u32 m0, s73, 106496
    s_nop 0
    buffer_load_dwordx4 v14, s[8:11], s75 offen offset:0  lds
    buffer_load_dwordx4 v15, s[8:11], s75 offen offset:1024  lds
    s_add_u32 m0, s73, 102400
    s_nop 0
    buffer_load_dwordx4 v12, s[8:11], s3 offen offset:0  lds
    buffer_load_dwordx4 v13, s[8:11], s3 offen offset:1024  lds
    s_add_u32 m0, s73, 110592
    s_nop 0
    buffer_load_dwordx4 v14, s[8:11], s3 offen offset:0  lds
    buffer_load_dwordx4 v15, s[8:11], s3 offen offset:1024  lds
    s_add_u32 s75, s75, 393216
    s_cmp_eq_u32 s75, 6291456
    s_cselect_b32 s75, 0, s75
    s_waitcnt vmcnt(32)
    s_barrier
    s_add_u32 m0, s72, 49152
    s_nop 0
    buffer_load_dwordx4 v8, s[4:7], s74 offen offset:0  lds
    buffer_load_dwordx4 v9, s[4:7], s74 offen offset:1024  lds
    buffer_load_dwordx4 v10, s[4:7], s74 offen offset:2048  lds
    buffer_load_dwordx4 v11, s[4:7], s74 offen offset:3072  lds
    s_add_u32 m0, s72, 57344
    s_add_u32 s3, s74, 131072
    buffer_load_dwordx4 v8, s[4:7], s3 offen offset:0  lds
    buffer_load_dwordx4 v9, s[4:7], s3 offen offset:1024  lds
    buffer_load_dwordx4 v10, s[4:7], s3 offen offset:2048  lds
    buffer_load_dwordx4 v11, s[4:7], s3 offen offset:3072  lds
    s_add_u32 s74, s74, 128
    s_and_b32 s74, s74, 2047
    s_add_u32 s3, s75, 196608
    s_add_u32 m0, s73, 114688
    s_nop 0
    buffer_load_dwordx4 v12, s[8:11], s75 offen offset:0  lds
    buffer_load_dwordx4 v13, s[8:11], s75 offen offset:1024  lds
    s_add_u32 m0, s73, 122880
    s_nop 0
    buffer_load_dwordx4 v14, s[8:11], s75 offen offset:0  lds
    buffer_load_dwordx4 v15, s[8:11], s75 offen offset:1024  lds
    s_add_u32 m0, s73, 118784
    s_nop 0
    buffer_load_dwordx4 v12, s[8:11], s3 offen offset:0  lds
    buffer_load_dwordx4 v13, s[8:11], s3 offen offset:1024  lds
    s_add_u32 m0, s73, 126976
    s_nop 0
    buffer_load_dwordx4 v14, s[8:11], s3 offen offset:0  lds
    buffer_load_dwordx4 v15, s[8:11], s3 offen offset:1024  lds
    s_add_u32 s75, s75, 393216
    s_cmp_eq_u32 s75, 6291456
    s_cselect_b32 s75, 0, s75
    s_waitcnt vmcnt(32)
    s_barrier
    s_add_u32 m0, s72, 0
    s_nop 0
    buffer_load_dwordx4 v8, s[4:7], s74 offen offset:0  lds
    buffer_load_dwordx4 v9, s[4:7], s74 offen offset:1024  lds
    buffer_load_dwordx4 v10, s[4:7], s74 offen offset:2048  lds
    buffer_load_dwordx4 v11, s[4:7], s74 offen offset:3072  lds
    s_add_u32 m0, s72, 8192
    s_add_u32 s3, s74, 131072
    buffer_load_dwordx4 v8, s[4:7], s3 offen offset:0  lds
    buffer_load_dwordx4 v9, s[4:7], s3 offen offset:1024  lds
    buffer_load_dwordx4 v10, s[4:7], s3 offen offset:2048  lds
    buffer_load_dwordx4 v11, s[4:7], s3 offen offset:3072  lds
    s_add_u32 s74, s74, 128
    s_and_b32 s74, s74, 2047
    s_add_u32 s3, s75, 196608
    s_add_u32 m0, s73, 65536
    s_nop 0
    buffer_load_dwordx4 v12, s[8:11], s75 offen offset:0  lds
    buffer_load_dwordx4 v13, s[8:11], s75 offen offset:1024  lds
    s_add_u32 m0, s73, 73728
    s_nop 0
    buffer_load_dwordx4 v14, s[8:11], s75 offen offset:0  lds
    buffer_load_dwordx4 v15, s[8:11], s75 offen offset:1024  lds
    s_add_u32 m0, s73, 69632
    s_nop 0
    buffer_load_dwordx4 v12, s[8:11], s3 offen offset:0  lds
    buffer_load_dwordx4 v13, s[8:11], s3 offen offset:1024  lds
    s_add_u32 m0, s73, 77824
    s_nop 0
    buffer_load_dwordx4 v14, s[8:11], s3 offen offset:0  lds
    buffer_load_dwordx4 v15, s[8:11], s3 offen offset:1024  lds
    s_add_u32 s75, s75, 393216
    s_cmp_eq_u32 s75, 6291456
    s_cselect_b32 s75, 0, s75
    s_waitcnt vmcnt(32)
    s_barrier
    s_add_u32 m0, s72, 16384
    s_nop 0
    buffer_load_dwordx4 v8, s[4:7], s74 offen offset:0  lds
    buffer_load_dwordx4 v9, s[4:7], s74 offen offset:1024  lds
    buffer_load_dwordx4 v10, s[4:7], s74 offen offset:2048  lds
    buffer_load_dwordx4 v11, s[4:7], s74 offen offset:3072  lds
    s_add_u32 m0, s72, 24576
    s_add_u32 s3, s74, 131072
    buffer_load_dwordx4 v8, s[4:7], s3 offen offset:0  lds
    buffer_load_dwordx4 v9, s[4:7], s3 offen offset:1024  lds
    buffer_load_dwordx4 v10, s[4:7], s3 offen offset:2048  lds
    buffer_load_dwordx4 v11, s[4:7], s3 offen offset:3072  lds
    s_add_u32 s74, s74, 128
    s_and_b32 s74, s74, 2047
    s_add_u32 s3, s75, 196608
    s_add_u32 m0, s73, 81920
    s_nop 0
    buffer_load_dwordx4 v12, s[8:11], s75 offen offset:0  lds
    buffer_load_dwordx4 v13, s[8:11], s75 offen offset:1024  lds
    s_add_u32 m0, s73, 90112
    s_nop 0
    buffer_load_dwordx4 v14, s[8:11], s75 offen offset:0  lds
    buffer_load_dwordx4 v15, s[8:11], s75 offen offset:1024  lds
    s_add_u32 m0, s73, 86016
    s_nop 0
    buffer_load_dwordx4 v12, s[8:11], s3 offen offset:0  lds
    buffer_load_dwordx4 v13, s[8:11], s3 offen offset:1024  lds
    s_add_u32 m0, s73, 94208
    s_nop 0
    buffer_load_dwordx4 v14, s[8:11], s3 offen offset:0  lds
    buffer_load_dwordx4 v15, s[8:11], s3 offen offset:1024  lds
    s_add_u32 s75, s75, 393216
    s_cmp_eq_u32 s75, 6291456
    s_cselect_b32 s75, 0, s75
    s_waitcnt vmcnt(32)
    s_barrier
    s_add_u32 m0, s72, 32768
    s_nop 0
    buffer_load_dwordx4 v8, s[4:7], s74 offen offset:0  lds
    buffer_load_dwordx4 v9, s[4:7], s74 offen offset:1024  lds
    buffer_load_dwordx4 v10, s[4:7], s74 offen offset:2048  lds
    buffer_load_dwordx4 v11, s[4:7], s74 offen offset:3072  lds
    s_add_u32 m0, s72, 40960
    s_add_u32 s3, s74, 131072
    buffer_load_dwordx4 v8, s[4:7], s3 offen offset:0  lds
    buffer_load_dwordx4 v9, s[4:7], s3 offen offset:1024  lds
    buffer_load_dwordx4 v10, s[4:7], s3 offen offset:2048  lds
    buffer_load_dwordx4 v11, s[4:7], s3 offen offset:3072  lds
    s_add_u32 s74, s74, 128
    s_and_b32 s74, s74, 2047
    s_add_u32 s3, s75, 196608
    s_add_u32 m0, s73, 98304
    s_nop 0
    buffer_load_dwordx4 v12, s[8:11], s75 offen offset:0  lds
    buffer_load_dwordx4 v13, s[8:11], s75 offen offset:1024  lds
    s_add_u32 m0, s73, 106496
    s_nop 0
    buffer_load_dwordx4 v14, s[8:11], s75 offen offset:0  lds
    buffer_load_dwordx4 v15, s[8:11], s75 offen offset:1024  lds
    s_add_u32 m0, s73, 102400
    s_nop 0
    buffer_load_dwordx4 v12, s[8:11], s3 offen offset:0  lds
    buffer_load_dwordx4 v13, s[8:11], s3 offen offset:1024  lds
    s_add_u32 m0, s73, 110592
    s_nop 0
    buffer_load_dwordx4 v14, s[8:11], s3 offen offset:0  lds
    buffer_load_dwordx4 v15, s[8:11], s3 offen offset:1024  lds
    s_add_u32 s75, s75, 393216
    s_cmp_eq_u32 s75, 6291456
    s_cselect_b32 s75, 0, s75
    s_waitcnt vmcnt(32)
    s_barrier
    s_add_u32 m0, s72, 49152
    s_nop 0
    buffer_load_dwordx4 v8, s[4:7], s74 offen offset:0  lds
    buffer_load_dwordx4 v9, s[4:7], s74 offen offset:1024  lds
    buffer_load_dwordx4 v10, s[4:7], s74 offen offset:2048  lds
    buffer_load_dwordx4 v11, s[4:7], s74 offen offset:3072  lds
    s_add_u32 m0, s72, 57344
    s_add_u32 s3, s74, 131072
    buffer_load_dwordx4 v8, s[4:7], s3 offen offset:0  lds
    buffer_load_dwordx4 v9, s[4:7], s3 offen offset:1024  lds
    buffer_load_dwordx4 v10, s[4:7], s3 offen offset:2048  lds
    buffer_load_dwordx4 v11, s[4:7], s3 offen offset:3072  lds
    s_add_u32 s74, s74, 128
    s_and_b32 s74, s74, 2047
    s_add_u32 s3, s75, 196608
    s_add_u32 m0, s73, 114688
    s_nop 0
    buffer_load_dwordx4 v12, s[8:11], s75 offen offset:0  lds
    buffer_load_dwordx4 v13, s[8:11], s75 offen offset:1024  lds
    s_add_u32 m0, s73, 122880
    s_nop 0
    buffer_load_dwordx4 v14, s[8:11], s75 offen offset:0  lds
    buffer_load_dwordx4 v15, s[8:11], s75 offen offset:1024  lds
    s_add_u32 m0, s73, 118784
    s_nop 0
    buffer_load_dwordx4 v12, s[8:11], s3 offen offset:0  lds
    buffer_load_dwordx4 v13, s[8:11], s3 offen offset:1024  lds
    s_add_u32 m0, s73, 126976
    s_nop 0
    buffer_load_dwordx4 v14, s[8:11], s3 offen offset:0  lds
    buffer_load_dwordx4 v15, s[8:11], s3 offen offset:1024  lds
    s_add_u32 s75, s75, 393216
    s_cmp_eq_u32 s75, 6291456
    s_cselect_b32 s75, 0, s75
    s_waitcnt vmcnt(32)
    s_barrier
    s_add_u32 m0, s72, 0
    s_nop 0
    buffer_load_dwordx4 v8, s[4:7], s74 offen offset:0  lds
    buffer_load_dwordx4 v9, s[4:7], s74 offen offset:1024  lds
    buffer_load_dwordx4 v10, s[4:7], s74 offen offset:2048  lds
    buffer_load_dwordx4 v11, s[4:7], s74 offen offset:3072  lds
    s_add_u32 m0, s72, 8192
    s_add_u32 s3, s74, 131072
    buffer_load_dwordx4 v8, s[4:7], s3 offen offset:0  lds
    buffer_load_dwordx4 v9, s[4:7], s3 offen offset:1024  lds
    buffer_load_dwordx4 v10, s[4:7], s3 offen offset:2048  lds
    buffer_load_dwordx4 v11, s[4:7], s3 offen offset:3072  lds
    s_add_u32 s74, s74, 128
    s_and_b32 s74, s74, 2047
    s_add_u32 s3, s75, 196608
    s_add_u32 m0, s73, 65536
    s_nop 0
    buffer_load_dwordx4 v12, s[8:11], s75 offen offset:0  lds
    buffer_load_dwordx4 v13, s[8:11], s75 offen offset:1024  lds
    s_add_u32 m0, s73, 73728
    s_nop 0
    buffer_load_dwordx4 v14, s[8:11], s75 offen offset:0  lds
    buffer_load_dwordx4 v15, s[8:11], s75 offen offset:1024  lds
    s_add_u32 m0, s73, 69632
    s_nop 0
    buffer_load_dwordx4 v12, s[8:11], s3 offen offset:0  lds
    buffer_load_dwordx4 v13, s[8:11], s3 offen offset:1024  lds
    s_add_u32 m0, s73, 77824
    s_nop 0
    buffer_load_dwordx4 v14, s[8:11], s3 offen offset:0  lds
    buffer_load_dwordx4 v15, s[8:11], s3 offen offset:1024  lds
    s_add_u32 s75, s75, 393216
    s_cmp_eq_u32 s75, 6291456
    s_cselect_b32 s75, 0, s75
    s_waitcnt vmcnt(32)
    s_barrier
    s_getpc_b64 s[66:67]
L_pc2:
    s_add_u32 s66, s66, L_c1-L_pc2
    s_addc_u32 s67, s67, 0
    s_lshr_b32 s3, s2, 3
    s_lshl_b32 s3, s3, 1
    s_add_u32 s3, s3, s38
    s_lshl_b32 s3, s3, 6
    s_add_u32 s66, s66, s3
    s_addc_u32 s67, s67, 0
    s_load_dword s65, s[66:67], 0
    s_load_dword s65, s[66:67], 4096
    s_load_dword s65, s[66:67], 8192
    s_load_dword s65, s[66:67], 12288
    s_load_dword s65, s[66:67], 16384
    s_load_dword s65, s[66:67], 20480
    s_add_u32 m0, s72, 16384
    s_nop 0
    buffer_load_dwordx4 v8, s[4:7], s74 offen offset:0  lds
    buffer_load_dwordx4 v9, s[4:7], s74 offen offset:1024  lds
    buffer_load_dwordx4 v10, s[4:7], s74 offen offset:2048  lds
    buffer_load_dwordx4 v11, s[4:7], s74 offen offset:3072  lds
    s_add_u32 m0, s72, 24576
    s_add_u32 s3, s74, 131072
    buffer_load_dwordx4 v8, s[4:7], s3 offen offset:0  lds
    buffer_load_dwordx4 v9, s[4:7], s3 offen offset:1024  lds
    buffer_load_dwordx4 v10, s[4:7], s3 offen offset:2048  lds
    buffer_load_dwordx4 v11, s[4:7], s3 offen offset:3072  lds
    s_add_u32 s74, s74, 128
    s_and_b32 s74, s74, 2047
    s_add_u32 s3, s75, 196608
    s_add_u32 m0, s73, 81920
    s_nop 0
    buffer_load_dwordx4 v12, s[8:11], s75 offen offset:0  lds
    buffer_load_dwordx4 v13, s[8:11], s75 offen offset:1024  lds
    s_add_u32 m0, s73, 90112
    s_nop 0
    buffer_load_dwordx4 v14, s[8:11], s75 offen offset:0  lds
    buffer_load_dwordx4 v15, s[8:11], s75 offen offset:1024  lds
    s_add_u32 m0, s73, 86016
    s_nop 0
    buffer_load_dwordx4 v12, s[8:11], s3 offen offset:0  lds
    buffer_load_dwordx4 v13, s[8:11], s3 offen offset:1024  lds
    s_add_u32 m0, s73, 94208
    s_nop 0
    buffer_load_dwordx4 v14, s[8:11], s3 offen offset:0  lds
    buffer_load_dwordx4 v15, s[8:11], s3 offen offset:1024  lds
    s_add_u32 s75, s75, 393216
    s_cmp_eq_u32 s75, 6291456
    s_cselect_b32 s75, 0, s75
    s_waitcnt vmcnt(32)
    s_barrier
    s_add_u32 m0, s72, 32768
    s_nop 0
    buffer_load_dwordx4 v8, s[4:7], s74 offen offset:0  lds
    buffer_load_dwordx4 v9, s[4:7], s74 offen offset:1024  lds
    buffer_load_dwordx4 v10, s[4:7], s74 offen offset:2048  lds
    buffer_load_dwordx4 v11, s[4:7], s74 offen offset:3072  lds
    s_add_u32 m0, s72, 40960
    s_add_u32 s3, s74, 131072
    buffer_load_dwordx4 v8, s[4:7], s3 offen offset:0  lds
    buffer_load_dwordx4 v9, s[4:7], s3 offen offset:1024  lds
    buffer_load_dwordx4 v10, s[4:7], s3 offen offset:2048  lds
    buffer_load_dwordx4 v11, s[4:7], s3 offen offset:3072  lds
    s_add_u32 s74, s74, 128
    s_and_b32 s74, s74, 2047
    s_add_u32 s3, s75, 196608
    s_add_u32 m0, s73, 98304
    s_nop 0
    buffer_load_dwordx4 v12, s[8:11], s75 offen offset:0  lds
    buffer_load_dwordx4 v13, s[8:11], s75 offen offset:1024  lds
    s_add_u32 m0, s73, 106496
    s_nop 0
    buffer_load_dwordx4 v14, s[8:11], s75 offen offset:0  lds
    buffer_load_dwordx4 v15, s[8:11], s75 offen offset:1024  lds
    s_add_u32 m0, s73, 102400
    s_nop 0
    buffer_load_dwordx4 v12, s[8:11], s3 offen offset:0  lds
    buffer_load_dwordx4 v13, s[8:11], s3 offen offset:1024  lds
    s_add_u32 m0, s73, 110592
    s_nop 0
    buffer_load_dwordx4 v14, s[8:11], s3 offen offset:0  lds
    buffer_load_dwordx4 v15, s[8:11], s3 offen offset:1024  lds
    s_add_u32 s75, s75, 393216
    s_cmp_eq_u32 s75, 6291456
    s_cselect_b32 s75, 0, s75
    s_waitcnt vmcnt(32)
    s_barrier
    s_add_u32 m0, s72, 49152
    s_nop 0
    buffer_load_dwordx4 v8, s[4:7], s74 offen offset:0  lds
    buffer_load_dwordx4 v9, s[4:7], s74 offen offset:1024  lds
    buffer_load_dwordx4 v10, s[4:7], s74 offen offset:2048  lds
    buffer_load_dwordx4 v11, s[4:7], s74 offen offset:3072  lds
    s_add_u32 m0, s72, 57344
    s_add_u32 s3, s74, 131072
    buffer_load_dwordx4 v8, s[4:7], s3 offen offset:0  lds
    buffer_load_dwordx4 v9, s[4:7], s3 offen offset:1024  lds
    buffer_load_dwordx4 v10, s[4:7], s3 offen offset:2048  lds
    buffer_load_dwordx4 v11, s[4:7], s3 offen offset:3072  lds
    s_add_u32 s74, s74, 128
    s_and_b32 s74, s74, 2047
    s_add_u32 s3, s75, 196608
    s_add_u32 m0, s73, 114688
    s_nop 0
    buffer_load_dwordx4 v12, s[8:11], s75 offen offset:0  lds
    buffer_load_dwordx4 v13, s[8:11], s75 offen offset:1024  lds
    s_add_u32 m0, s73, 122880
    s_nop 0
    buffer_load_dwordx4 v14, s[8:11], s75 offen offset:0  lds
    buffer_load_dwordx4 v15, s[8:11], s75 offen offset:1024  lds
    s_add_u32 m0, s73, 118784
    s_nop 0
    buffer_load_dwordx4 v12, s[8:11], s3 offen offset:0  lds
    buffer_load_dwordx4 v13, s[8:11], s3 offen offset:1024  lds
    s_add_u32 m0, s73, 126976
    s_nop 0
    buffer_load_dwordx4 v14, s[8:11], s3 offen offset:0  lds
    buffer_load_dwordx4 v15, s[8:11], s3 offen offset:1024  lds
    s_add_u32 s75, s75, 393216
    s_cmp_eq_u32 s75, 6291456
    s_cselect_b32 s75, 0, s75
    s_waitcnt vmcnt(32)
    s_barrier
    s_waitcnt lgkmcnt(0)
    s_branch L_join
L_xw:
    s_mov_b32 s16, s60
    s_mov_b32 s17, s61
    s_mov_b32 s18, 256
    s_mov_b32 s19, 0x00020000
    s_mov_b32 s20, s44
    s_mov_b32 s21, s45
    s_mov_b32 s22, 65536
    s_mov_b32 s23, 0x00020000
    v_lshlrev_b32 v3, 4, v1
    s_mov_b32 s12, s62
    s_mov_b32 s13, s63
    s_mov_b32 s14, 268435456
    s_mov_b32 s15, 0x00020000
    s_and_b32 s30, s2, 7
    s_lshl_b32 s30, s30, 1
    s_bfe_u32 s3, s2, 0x10003
    s_add_u32 s30, s30, s3
    s_lshr_b32 s31, s2, 4
    s_mov_b32 s88, 0
    s_mov_b32 s70, 0
    s_mov_b32 s80, s52
    s_mov_b32 s81, s53
    s_mov_b32 s82, 7340032
    s_mov_b32 s83, 0x00020000
    s_mov_b32 s84, s54
    s_mov_b32 s85, s55
    s_mov_b32 s86, 7340032
    s_mov_b32 s87, 0x00020000
    s_cmp_lt_u32 s2, 224
    s_cselect_b32 s82, s82, 0
    s_cselect_b32 s86, s86, 0
    s_and_b32 s3, s2, 15
    s_lshl_b32 s3, s3, 6
    v_and_b32 v5, 0x38, v1
    v_add_u32 v5, s3, v5
    v_mul_u32_u24 v5, 7168, v5
    v_and_b32 v6, 7, v1
    v_lshl_add_u32 v2, v6, 4, v5
    s_lshr_b32 s77, s2, 4
    s_lshl_b32 s77, s77, 2
    s_add_u32 s77, s77, s38
    s_lshl_b32 s77, s77, 7
    v_and_b32 v5, 1, v1
    v_cmp_eq_u32 vcc, 0, v5
    v_mov_b32 v6, 0xffff0000
    v_mov_b32 v7, 0xffff
    v_cndmask_b32 v6, v6, v7, vcc
    v_bfe_u32 v5, v1, 1, 2
    v_cmp_eq_u32 vcc, 0, v5
    s_nop 1
    v_cndmask_b32 v88, 0, v6, vcc
    v_cmp_eq_u32 vcc, 1, v5
    s_nop 1
    v_cndmask_b32 v89, 0, v6, vcc
    v_cmp_eq_u32 vcc, 2, v5
    s_nop 1
    v_cndmask_b32 v90, 0, v6, vcc
    v_cmp_eq_u32 vcc, 3, v5
    s_nop 1
    v_cndmask_b32 v91, 0, v6, vcc
    v_and_b32 v20, 0x3f803f80, v88
    v_and_b32 v21, 0x3f803f80, v89
    v_and_b32 v22, 0x3f803f80, v90
    v_and_b32 v23, 0x3f803f80, v91
    v_mov_b32 v28, 0x3f803f80
    v_mov_b32 v29, 0x3f803f80
    v_mov_b32 v30, 0x3f803f80
    v_mov_b32 v31, 0x3f803f80
    v_lshrrev_b32 v5, 4, v1
    v_lshlrev_b32 v4, 3, v5
    v_bfe_u32 v6, v1, 2, 2
    v_add_u32 v4, v4, v6
    v_lshlrev_b32 v4, 7, v4
    v_and_b32 v5, 3, v1
    v_lshl_add_u32 v4, v5, 3, v4
    v_add_u32 v4, 65536, v4
    s_and_b32 s3, s38, 1
    s_lshl_b32 s3, s3, 1
    v_bfe_u32 v6, v1, 3, 2
    v_xor_b32 v6, s3, v6
    v_lshl_add_u32 v26, v6, 5, v4
    v_xor_b32 v6, 1, v6
    v_lshl_add_u32 v27, v6, 5, v4
    v_add_u32 v32, 75264, v26
    v_add_u32 v33, 75264, v27
    s_lshl_b32 s3, s37, 4
    s_add_u32 s3, s3, s36
    s_lshl_b32 s3, s3, 10
    s_and_b32 s65, s38, 1
    s_lshl_b32 s65, s65, 9
    s_add_u32 s3, s3, s65
    s_add_u32 s68, s3, 1048576
    v_subrev_u32 v4, 196608, v16
    v_subrev_u32 v5, 196608, v17
    s_add_u32 m0, s73, 140800
    s_nop 0
    buffer_load_dwordx4 v16, s[8:11], s76 offen offset:0  lds
    buffer_load_dwordx4 v17, s[8:11], s76 offen offset:1024  lds
    s_add_u32 m0, s73, 136704
    s_nop 0
    buffer_load_dwordx4 v4, s[8:11], s76 offen offset:0  lds
    buffer_load_dwordx4 v5, s[8:11], s76 offen offset:1024  lds
    v_lshlrev_b32 v3, 4, v1
    s_add_u32 m0, s73, 126976
    s_lshl_b32 s65, s37, 12
    s_add_u32 s65, s65, s73
    s_sub_u32 s65, s65, 4096
    buffer_load_dwordx4 v3, s[20:23], s65 offen offset:0 lds
    buffer_load_dwordx4 v3, s[20:23], s65 offen offset:1024 lds
    s_mov_b32 s79, 0
    v_mov_b32 v34, 0
    v_mov_b32 v35, 0
    v_mov_b32 v5, 139136
    ds_write_b64 v5, v[34:35]
    ds_write_b64 v5, v[34:35] offset:8
    ds_write_b64 v5, v[34:35] offset:16
    ds_write_b64 v5, v[34:35] offset:24
    ds_write_b64 v5, v[34:35] offset:32
    ds_write_b64 v5, v[34:35] offset:40
    ds_write_b64 v5, v[34:35] offset:48
    ds_write_b64 v5, v[34:35] offset:56
    s_barrier
    s_add_u32 s79, s79, 1
    ds_read_b64_tr_b16 v[144:145], v26 offset:0
    ds_read_b64_tr_b16 v[146:147], v26 offset:512
    ds_read_b64_tr_b16 v[148:149], v26 offset:4096
    ds_read_b64_tr_b16 v[150:151], v26 offset:4608
    ds_read_b64_tr_b16 v[168:169], v27 offset:0
    ds_read_b64_tr_b16 v[170:171], v27 offset:512
    ds_read_b64_tr_b16 v[172:173], v27 offset:4096
    ds_read_b64_tr_b16 v[174:175], v27 offset:4608
    s_waitcnt lgkmcnt(4)
    ds_read_b64_tr_b16 v[152:153], v26 offset:8192
    ds_read_b64_tr_b16 v[154:155], v26 offset:8704
    ds_read_b64_tr_b16 v[156:157], v26 offset:12288
    ds_read_b64_tr_b16 v[158:159], v26 offset:12800
    ds_read_b64_tr_b16 v[176:177], v27 offset:8192
    ds_read_b64_tr_b16 v[178:179], v27 offset:8704
    ds_read_b64_tr_b16 v[180:181], v27 offset:12288
    ds_read_b64_tr_b16 v[182:183], v27 offset:12800
    s_waitcnt vmcnt(0) lgkmcnt(0)
    s_barrier
    s_add_u32 s79, s79, 1
    ds_read_b64_tr_b16 v[136:137], v32 offset:0
    ds_read_b64_tr_b16 v[138:139], v32 offset:512
    ds_read_b64_tr_b16 v[140:141], v32 offset:4096
    ds_read_b64_tr_b16 v[142:143], v32 offset:4608
    ds_read_b64_tr_b16 v[160:161], v33 offset:0
    ds_read_b64_tr_b16 v[162:163], v33 offset:512
    ds_read_b64_tr_b16 v[164:165], v33 offset:4096
    ds_read_b64_tr_b16 v[166:167], v33 offset:4608
    v_mfma_f32_16x16x32_bf16 v[116:119], v[28:31], v[144:147], 0
    v_mfma_f32_16x16x32_bf16 v[120:123], v[28:31], v[152:155], 0
    v_mfma_f32_16x16x32_bf16 v[128:131], v[28:31], v[168:171], 0
    v_mfma_f32_16x16x32_bf16 v[132:135], v[28:31], v[176:179], 0
    v_mfma_f32_16x16x32_bf16 v[116:119], v[28:31], v[148:151], v[116:119]
    v_mfma_f32_16x16x32_bf16 v[120:123], v[28:31], v[156:159], v[120:123]
    v_mfma_f32_16x16x32_bf16 v[128:131], v[28:31], v[172:175], v[128:131]
    v_mfma_f32_16x16x32_bf16 v[132:135], v[28:31], v[180:183], v[132:135]
    s_waitcnt lgkmcnt(0)
    v_mfma_f32_16x16x32_bf16 v[112:115], v[28:31], v[136:139], 0
    v_mfma_f32_16x16x32_bf16 v[124:127], v[28:31], v[160:163], 0
    v_mfma_f32_16x16x32_bf16 v[112:115], v[28:31], v[140:143], v[112:115]
    v_mfma_f32_16x16x32_bf16 v[124:127], v[28:31], v[164:167], v[124:127]
L_non:
    buffer_load_dword v18, v34, s[16:19], 0 offen sc1
    s_cmp_lt_u32 s79, 14
    s_cbranch_scc0 L_xb3
    s_barrier
    s_add_u32 s79, s79, 1
L_xb3:
    s_cmp_lt_u32 s79, 14
    s_cbranch_scc0 L_xb4
    s_barrier
    s_add_u32 s79, s79, 1
L_xb4:
    s_waitcnt vmcnt(0)
    v_cmp_eq_u32 vcc, 0, v18
    s_nop 1
    v_cndmask_b32 v6, 0, 1, vcc
    v_cmp_ne_u32 vcc, 0, v6
    s_add_u32 s70, s70, 1
    s_cmp_ge_u32 s70, 200000
    s_cbranch_scc1 L_nonok
    s_cmp_lg_u64 vcc, 0
    s_cbranch_scc1 L_non
L_nonok:
    v_and_b32 v5, 16, v1
    v_cmp_eq_u32 vcc, 0, v5
    v_mov_b32 v139, v18
    s_nop 0
    v_cndmask_b32 v136, v124, v112, vcc
    v_cndmask_b32 v137, v128, v116, vcc
    v_cndmask_b32 v138, v132, v120, vcc
    s_mov_b64 exec, 0xffffffff
    buffer_store_dwordx4 v[136:139], v3, s[12:15], s68 offen sc1
    s_mov_b64 exec, -1
    s_cmp_eq_u32 s38, 3
    s_cbranch_scc1 L_xbw
L_xu5:
    s_cmp_ge_u32 s79, 8
    s_cbranch_scc1 L_xe5
    s_barrier
    s_add_u32 s79, s79, 1
    s_branch L_xu5
L_xe5:
    s_lshl_b32 s68, s37, 14
    s_add_u32 s68, s68, 1048576
L_cs:
    s_mov_b32 s3, s68
    buffer_load_dwordx4 v[112:115], v3, s[12:15], s3 offen offset:0 sc1
    buffer_load_dwordx4 v[116:119], v3, s[12:15], s3 offen offset:1024 sc1
    buffer_load_dwordx4 v[120:123], v3, s[12:15], s3 offen offset:2048 sc1
    buffer_load_dwordx4 v[124:127], v3, s[12:15], s3 offen offset:3072 sc1
    s_add_u32 s3, s3, 4096
    buffer_load_dwordx4 v[128:131], v3, s[12:15], s3 offen offset:0 sc1
    buffer_load_dwordx4 v[132:135], v3, s[12:15], s3 offen offset:1024 sc1
    buffer_load_dwordx4 v[136:139], v3, s[12:15], s3 offen offset:2048 sc1
    buffer_load_dwordx4 v[140:143], v3, s[12:15], s3 offen offset:3072 sc1
    s_add_u32 s3, s3, 4096
    s_cmp_lt_u32 s79, 14
    s_cbranch_scc0 L_xb6
    s_barrier
    s_add_u32 s79, s79, 1
L_xb6:
    buffer_load_dwordx4 v[144:147], v3, s[12:15], s3 offen offset:0 sc1
    buffer_load_dwordx4 v[148:151], v3, s[12:15], s3 offen offset:1024 sc1
    buffer_load_dwordx4 v[152:155], v3, s[12:15], s3 offen offset:2048 sc1
    buffer_load_dwordx4 v[156:159], v3, s[12:15], s3 offen offset:3072 sc1
    s_add_u32 s3, s3, 4096
    buffer_load_dwordx4 v[160:163], v3, s[12:15], s3 offen offset:0 sc1
    buffer_load_dwordx4 v[164:167], v3, s[12:15], s3 offen offset:1024 sc1
    buffer_load_dwordx4 v[168:171], v3, s[12:15], s3 offen offset:2048 sc1
    buffer_load_dwordx4 v[172:175], v3, s[12:15], s3 offen offset:3072 sc1
    s_cmp_lt_u32 s79, 14
    s_cbranch_scc0 L_xb7
    s_barrier
    s_add_u32 s79, s79, 1
L_xb7:
    s_cmp_lt_u32 s79, 14
    s_cbranch_scc0 L_xb8
    s_barrier
    s_add_u32 s79, s79, 1
L_xb8:
    s_waitcnt vmcnt(0)
    v_and_b32 v6, v115, v119
    v_or_b32 v7, v115, v119
    v_min3_u32 v6, v6, v123, v127
    v_max3_u32 v7, v7, v123, v127
    v_min3_u32 v6, v6, v131, v135
    v_max3_u32 v7, v7, v131, v135
    v_min3_u32 v6, v6, v139, v143
    v_max3_u32 v7, v7, v139, v143
    v_min3_u32 v6, v6, v147, v151
    v_max3_u32 v7, v7, v147, v151
    v_min3_u32 v6, v6, v155, v159
    v_max3_u32 v7, v7, v155, v159
    v_min3_u32 v6, v6, v163, v167
    v_max3_u32 v7, v7, v163, v167
    v_min3_u32 v6, v6, v171, v175
    v_max3_u32 v7, v7, v171, v175
    v_xor_b32 v6, v6, v18
    v_xor_b32 v7, v7, v18
    v_or_b32 v6, v6, v7
    v_cmp_ne_u32 vcc, 0, v6
    s_add_u32 s70, s70, 1
    s_cmp_ge_u32 s70, 200000
    s_cbranch_scc1 L_csok
    s_cmp_lg_u64 vcc, 0
    s_cbranch_scc1 L_cs
L_csok:
    s_cmp_lt_u32 s79, 14
    s_cbranch_scc0 L_xb9
    s_barrier
    s_add_u32 s79, s79, 1
L_xb9:
    v_pk_add_f32 v[112:113], v[112:113], v[144:145]
    v_add_f32 v114, v114, v146
    v_pk_add_f32 v[116:117], v[116:117], v[148:149]
    v_add_f32 v118, v118, v150
    v_pk_add_f32 v[120:121], v[120:121], v[152:153]
    v_add_f32 v122, v122, v154
    v_pk_add_f32 v[124:125], v[124:125], v[156:157]
    v_add_f32 v126, v126, v158
    v_pk_add_f32 v[128:129], v[128:129], v[160:161]
    v_add_f32 v130, v130, v162
    v_pk_add_f32 v[132:133], v[132:133], v[164:165]
    v_add_f32 v134, v134, v166
    v_pk_add_f32 v[136:137], v[136:137], v[168:169]
    v_add_f32 v138, v138, v170
    v_pk_add_f32 v[140:141], v[140:141], v[172:173]
    v_add_f32 v142, v142, v174
    v_pk_add_f32 v[112:113], v[112:113], v[128:129]
    v_add_f32 v114, v114, v130
    v_pk_add_f32 v[116:117], v[116:117], v[132:133]
    v_add_f32 v118, v118, v134
    v_pk_add_f32 v[120:121], v[120:121], v[136:137]
    v_add_f32 v122, v122, v138
    v_pk_add_f32 v[124:125], v[124:125], v[140:141]
    v_add_f32 v126, v126, v142
    s_cmp_lt_u32 s79, 14
    s_cbranch_scc0 L_xb10
    s_barrier
    s_add_u32 s79, s79, 1
L_xb10:
    v_pk_add_f32 v[112:113], v[112:113], v[120:121]
    v_add_f32 v114, v114, v122
    v_pk_add_f32 v[116:117], v[116:117], v[124:125]
    v_add_f32 v118, v118, v126
    v_pk_add_f32 v[112:113], v[112:113], v[116:117]
    v_add_f32 v114, v114, v118
    v_lshlrev_b32 v5, 2, v1
    v_add_u32 v5, 138240, v5
    ds_write_b32 v5, v112
    ds_write_b32 v5, v113 offset:256
    ds_write_b32 v5, v114 offset:512
    s_branch L_xend
L_xbw:
    s_cmp_lt_u32 s79, 14
    s_cbranch_scc0 L_xb11
    s_barrier
    s_add_u32 s79, s79, 1
L_xb11:
    v_and_b32 v5, 7, v1
    v_lshlrev_b32 v5, 3, v5
    v_add_u32 v6, 139008, v5
    ds_read_b64 v[140:141], v6
    s_lshl_b32 s65, s36, 4
    s_add_u32 s65, s65, s37
    s_lshl_b32 s65, s65, 6
    s_add_u32 s65, s65, 0
    s_lshl_b32 s3, s2, 4
    s_add_u32 s3, s3, 65536
    v_mov_b32 v146, v18
    v_mov_b32 v147, v18
    s_waitcnt lgkmcnt(0)
    v_mov_b32 v144, v141
    v_mov_b32 v145, v140
    s_nop 0
    v_max_u32 v144, v144, v144 quad_perm:[1,0,3,2] row_mask:0xf bank_mask:0xf
    s_nop 1
    v_max_u32 v144, v144, v144 quad_perm:[2,3,0,1] row_mask:0xf bank_mask:0xf
    s_nop 1
    v_max_u32 v144, v144, v144 row_half_mirror row_mask:0xf bank_mask:0xf
    v_cmp_eq_u32 vcc, v144, v141
    v_mov_b32 v141, v18
    s_mov_b64 exec, 0xff
    buffer_store_dwordx2 v[140:141], v5, s[12:15], s65 offen sc1
    s_and_b64 exec, exec, vcc
    buffer_store_dwordx4 v[144:147], v34, s[12:15], s3 offen sc1
    s_mov_b64 exec, -1
L_xu12:
    s_cmp_ge_u32 s79, 8
    s_cbranch_scc1 L_xe12
    s_barrier
    s_add_u32 s79, s79, 1
    s_branch L_xu12
L_xe12:
    s_mov_b32 s68, 65536
    s_lshl_b32 s66, s36, 10
    s_lshl_b32 s67, s30, 10
L_st:
    buffer_load_dwordx4 v[112:115], v3, s[12:15], s68 offen offset:0 sc1
    buffer_load_dwordx4 v[116:119], v3, s[12:15], s68 offen offset:1024 sc1
    buffer_load_dwordx4 v[120:123], v3, s[12:15], s68 offen offset:2048 sc1
    buffer_load_dwordx4 v[124:127], v3, s[12:15], s68 offen offset:3072 sc1
    buffer_load_dwordx4 v[128:131], v3, s[12:15], s66 offen offset:0 sc1
    buffer_load_dwordx4 v[132:135], v3, s[12:15], s67 offen offset:0 sc1
    s_cmp_lt_u32 s79, 14
    s_cbranch_scc0 L_xb13
    s_barrier
    s_add_u32 s79, s79, 1
L_xb13:
    s_cmp_lt_u32 s79, 14
    s_cbranch_scc0 L_xb14
    s_barrier
    s_add_u32 s79, s79, 1
L_xb14:
    s_waitcnt vmcnt(0)
    v_and_b32 v6, v114, v118
    v_or_b32 v7, v114, v118
    v_min3_u32 v6, v6, v122, v126
    v_max3_u32 v7, v7, v122, v126
    v_min3_u32 v6, v6, v129, v131
    v_max3_u32 v7, v7, v129, v131
    v_min3_u32 v6, v6, v133, v135
    v_max3_u32 v7, v7, v133, v135
    v_xor_b32 v6, v6, v18
    v_xor_b32 v7, v7, v18
    v_or_b32 v6, v6, v7
    v_cmp_ne_u32 vcc, 0, v6
    s_add_u32 s70, s70, 1
    s_cmp_ge_u32 s70, 200000
    s_cbranch_scc1 L_stok
    s_cmp_lg_u64 vcc, 0
    s_cbranch_scc1 L_st
L_stok:
    s_cmp_lt_u32 s79, 14
    s_cbranch_scc0 L_xb15
    s_barrier
    s_add_u32 s79, s79, 1
L_xb15:
    v_and_b32 v140, 0xffff0000, v128
    v_and_b32 v141, 0xffff0000, v130
    v_and_b32 v142, 0xffff0000, v132
    v_and_b32 v143, 0xffff0000, v134
    v_rcp_f32 v144, v140
    v_rcp_f32 v145, v141
    v_rcp_f32 v146, v142
    v_rcp_f32 v147, v143
    v_lshlrev_b32 v136, 16, v128
    v_lshlrev_b32 v137, 16, v130
    v_lshlrev_b32 v138, 16, v132
    v_lshlrev_b32 v139, 16, v134
    v_lshrrev_b32 v7, 16, v128
    v_or_b32 v7, v7, v141
    v_lshlrev_b32 v5, 3, v1
    v_add_u32 v5, 135168, v5
    v_lshlrev_b32 v4, 2, v1
    v_add_u32 v4, 136192, v4
    v_fma_f32 v140, -v144, v140, 1.0
    v_fma_f32 v141, -v145, v141, 1.0
    v_fma_f32 v142, -v146, v142, 1.0
    v_fma_f32 v143, -v147, v143, 1.0
    v_fmac_f32 v144, v140, v144
    v_fmac_f32 v145, v141, v145
    v_fmac_f32 v146, v142, v146
    v_fmac_f32 v147, v143, v147
    s_cmp_lt_u32 s79, 14
    s_cbranch_scc0 L_xb16
    s_barrier
    s_add_u32 s79, s79, 1
L_xb16:
    ds_write_b64 v5, v[136:137]
    ds_write_b64 v5, v[144:145] offset:512
    ds_write_b64 v5, v[138:139] offset:1536
    ds_write_b64 v5, v[146:147] offset:2048
    ds_write_b32 v4, v7
    v_cmp_gt_u32 vcc, v116, v112
    s_nop 1
    v_cndmask_b32 v112, v112, v116, vcc
    v_cndmask_b32 v113, v113, v117, vcc
    v_cmp_gt_u32 vcc, v124, v120
    s_nop 1
    v_cndmask_b32 v120, v120, v124, vcc
    v_cndmask_b32 v121, v121, v125, vcc
    v_cmp_gt_u32 vcc, v120, v112
    s_nop 1
    v_cndmask_b32 v112, v112, v120, vcc
    v_cndmask_b32 v113, v113, v121, vcc
    v_mov_b32 v6, v112
    s_cmp_lt_u32 s79, 14
    s_cbranch_scc0 L_xb17
    s_barrier
    s_add_u32 s79, s79, 1
L_xb17:
    v_max_u32 v6, v6, v6 quad_perm:[1,0,3,2] row_mask:0xf bank_mask:0xf
    s_nop 1
    v_max_u32 v6, v6, v6 quad_perm:[2,3,0,1] row_mask:0xf bank_mask:0xf
    s_nop 1
    v_max_u32 v6, v6, v6 row_half_mirror row_mask:0xf bank_mask:0xf
    s_nop 1
    v_max_u32 v6, v6, v6 row_mirror row_mask:0xf bank_mask:0xf
    v_mov_b32 v7, v6
    s_nop 1
    v_permlane16_swap_b32 v6, v7
    v_max_u32 v6, v6, v7
    v_mov_b32 v7, v6
    s_nop 1
    v_permlane32_swap_b32 v6, v7
    v_max_u32 v6, v6, v7
    v_cmp_eq_u32 vcc, v6, v112
    v_mov_b32 v5, 139072
    s_mov_b64 exec, vcc
    ds_write_b128 v5, v[112:115]
    s_mov_b64 exec, -1
L_xend:
    s_waitcnt lgkmcnt(0)
L_xu18:
    s_cmp_ge_u32 s79, 14
    s_cbranch_scc1 L_xe18
    s_barrier
    s_add_u32 s79, s79, 1
    s_branch L_xu18
L_xe18:
L_join:
    s_add_u32 s76, s39, 12
    s_and_b32 s76, s76, 15
    s_mul_i32 s76, s76, 393216
    s_add_u32 m0, s73, 65536
    s_nop 0
    buffer_load_dwordx4 v16, s[8:11], s76 offen offset:0  lds
    buffer_load_dwordx4 v17, s[8:11], s76 offen offset:1024  lds
    s_add_u32 s76, s76, 393216
    s_cmp_eq_u32 s76, 6291456
    s_cselect_b32 s76, 0, s76
    s_add_u32 m0, s73, 73728
    s_nop 0
    buffer_load_dwordx4 v16, s[8:11], s76 offen offset:0  lds
    buffer_load_dwordx4 v17, s[8:11], s76 offen offset:1024  lds
    s_add_u32 s76, s76, 393216
    s_cmp_eq_u32 s76, 6291456
    s_cselect_b32 s76, 0, s76
    s_mov_b32 s16, s46
    s_mov_b32 s17, s47
    s_mov_b32 s18, 2097152
    s_mov_b32 s19, 0x00020000
    v_lshrrev_b32 v5, 3, v1
    v_lshlrev_b32 v5, 11, v5
    v_lshrrev_b32 v6, 4, v1
    v_lshlrev_b32 v6, 1, v6
    v_and_b32 v7, 7, v1
    v_xor_b32 v6, v6, v7
    v_lshl_add_u32 v5, v6, 4, v5
    s_lshl_b32 s3, s31, 7
    s_lshl_b32 s65, s38, 15
    s_add_u32 s3, s3, s65
    v_add_u32 v110, s3, v5
    v_add_u32 v111, 15360, v110
    s_lshl_b32 s3, s2, 2
    s_add_u32 s3, s3, s38
    s_lshl_b32 s3, s3, 11
    v_lshlrev_b32 v5, 7, v1
    s_mov_b64 exec, 0xffff
    buffer_load_dword v0, v5, s[16:19], s3 offen
    s_mov_b64 exec, -1
    s_waitcnt vmcnt(5)
    s_barrier
    s_add_u32 m0, s73, 81920
    s_nop 0
    buffer_load_dwordx4 v16, s[8:11], s76 offen offset:0  lds
    buffer_load_dwordx4 v17, s[8:11], s76 offen offset:1024  lds
    s_add_u32 s76, s76, 393216
    s_cmp_eq_u32 s76, 6291456
    s_cselect_b32 s76, 0, s76
    s_add_u32 m0, s73, 90112
    s_nop 0
    buffer_load_dwordx4 v16, s[8:11], s76 offen offset:0  lds
    buffer_load_dwordx4 v17, s[8:11], s76 offen offset:1024  lds
    s_add_u32 s76, s76, 393216
    s_cmp_eq_u32 s76, 6291456
    s_cselect_b32 s76, 0, s76
    v_mov_b32 v5, 139072
    ds_read_b128 v[80:83], v5
    s_and_b32 s65, s2, 15
    s_lshl_b32 s65, s65, 7
    v_lshrrev_b32 v5, 3, v1
    v_lshlrev_b32 v5, 4, v5
    s_waitcnt lgkmcnt(0)
    v_readfirstlane_b32 s33, v80
    v_readfirstlane_b32 s64, v81
    v_mov_b32 v18, v82
    s_and_b32 s34, s33, 0x7ff
    s_sub_u32 s34, 2047, s34
    s_lshl_b32 s3, s34, 11
    s_add_u32 s3, s3, s65
    buffer_load_dwordx4 v[76:79], v5, s[4:7], s3 offen
    s_lshr_b32 s3, s34, 7
    s_cmp_eq_u32 s3, s30
    s_cselect_b32 s35, 1, 0
    s_mov_b32 s20, s56
    s_mov_b32 s21, s57
    s_mov_b32 s22, 7340032
    s_mov_b32 s23, 0x00020000
    s_mov_b32 s24, s58
    s_mov_b32 s25, s59
    s_mov_b32 s26, 4194304
    s_mov_b32 s27, 0x00020000
    s_cmp_lt_u32 s2, 224
    s_cselect_b32 s22, s22, 0
    v_lshrrev_b32 v5, 4, v1
    v_lshlrev_b32 v5, 11, v5
    v_and_b32 v6, 15, v1
    v_lshl_add_u32 v109, v6, 4, v5
    s_lshl_b32 s93, s2, 15
    s_lshl_b32 s65, s38, 9
    s_add_u32 s93, s93, s65
    buffer_load_dwordx4 v[128:131], v2, s[80:83], s77 offen nt
    buffer_load_dwordx4 v[160:163], v2, s[84:87], s77 offen nt
    s_add_u32 s77, s77, 7168
    buffer_load_dwordx4 v[132:135], v2, s[80:83], s77 offen nt
    buffer_load_dwordx4 v[164:167], v2, s[84:87], s77 offen nt
    s_add_u32 s77, s77, 7168
    buffer_load_dwordx4 v[136:139], v2, s[80:83], s77 offen nt
    buffer_load_dwordx4 v[168:171], v2, s[84:87], s77 offen nt
    s_add_u32 s77, s77, 7168
    buffer_load_dwordx4 v[140:143], v2, s[80:83], s77 offen nt
    buffer_load_dwordx4 v[172:175], v2, s[84:87], s77 offen nt
    s_add_u32 s77, s77, 7168
    buffer_load_dwordx4 v[144:147], v2, s[80:83], s77 offen nt
    buffer_load_dwordx4 v[176:179], v2, s[84:87], s77 offen nt
    s_add_u32 s77, s77, 7168
    buffer_load_dwordx4 v[148:151], v2, s[80:83], s77 offen nt
    buffer_load_dwordx4 v[180:183], v2, s[84:87], s77 offen nt
    s_add_u32 s77, s77, 7168
    buffer_load_dwordx4 v[152:155], v2, s[80:83], s77 offen nt
    buffer_load_dwordx4 v[184:187], v2, s[84:87], s77 offen nt
    s_add_u32 s77, s77, 7168
    buffer_load_dwordx4 v[156:159], v2, s[80:83], s77 offen nt
    buffer_load_dwordx4 v[188:191], v2, s[84:87], s77 offen nt
    s_add_u32 s77, s77, 7168
    v_mov_b32 v5, 139136
L_t1:
    ds_read_b128 v[224:227], v5 offset:16
    s_waitcnt lgkmcnt(0)
    v_and_b32 v224, v224, v225
    v_and_b32 v226, v226, v227
    v_and_b32 v224, v224, v226
    s_nop 0
    v_readfirstlane_b32 s3, v224
    s_nop 0
    s_cmp_eq_u32 s3, 1
    s_cbranch_scc1 L_t1d
    s_sleep 1
    s_branch L_t1
L_t1d:
    s_add_u32 m0, s73, 98304
    s_nop 0
    buffer_load_dwordx4 v16, s[8:11], s76 offen offset:0  lds
    buffer_load_dwordx4 v17, s[8:11], s76 offen offset:1024  lds
    s_add_u32 s76, s76, 393216
    s_cmp_eq_u32 s76, 6291456
    s_cselect_b32 s76, 0, s76
    s_add_u32 m0, s73, 106496
    s_nop 0
    buffer_load_dwordx4 v16, s[8:11], s76 offen offset:0  lds
    buffer_load_dwordx4 v17, s[8:11], s76 offen offset:1024  lds
    s_add_u32 s76, s76, 393216
    s_cmp_eq_u32 s76, 6291456
    s_cselect_b32 s76, 0, s76
    s_add_u32 m0, s73, 114688
    s_nop 0
    buffer_load_dwordx4 v16, s[8:11], s76 offen offset:0  lds
    buffer_load_dwordx4 v17, s[8:11], s76 offen offset:1024  lds
    s_add_u32 s76, s76, 393216
    s_cmp_eq_u32 s76, 6291456
    s_cselect_b32 s76, 0, s76
    s_add_u32 m0, s73, 122880
    s_nop 0
    buffer_load_dwordx4 v16, s[8:11], s76 offen offset:0  lds
    buffer_load_dwordx4 v17, s[8:11], s76 offen offset:1024  lds
    s_add_u32 s76, s76, 393216
    s_cmp_eq_u32 s76, 6291456
    s_cselect_b32 s76, 0, s76
    s_waitcnt vmcnt(24)
    s_lshl_b32 s65, s64, 16
    s_and_b32 s66, s64, 0xffff0000
    v_rcp_f32 v6, s66
    v_lshlrev_b32 v80, 16, v76
    v_and_b32 v81, 0xffff0000, v76
    v_lshlrev_b32 v82, 16, v77
    v_and_b32 v83, 0xffff0000, v77
    v_lshlrev_b32 v84, 16, v78
    v_and_b32 v85, 0xffff0000, v78
    v_lshlrev_b32 v86, 16, v79
    v_and_b32 v87, 0xffff0000, v79
    v_fma_f32 v4, -v6, s66, 1.0
    v_fmac_f32 v6, v4, v6
    v_subrev_f32 v80, s65, v80
    v_subrev_f32 v81, s65, v81
    v_subrev_f32 v82, s65, v82
    v_subrev_f32 v83, s65, v83
    v_subrev_f32 v84, s65, v84
    v_subrev_f32 v85, s65, v85
    v_subrev_f32 v86, s65, v86
    v_subrev_f32 v87, s65, v87
    v_cvt_pk_bf16_f32 v80, v80, v80
    v_cvt_pk_bf16_f32 v81, v81, v81
    v_cvt_pk_bf16_f32 v82, v82, v82
    v_cvt_pk_bf16_f32 v83, v83, v83
    v_cvt_pk_bf16_f32 v84, v84, v84
    v_cvt_pk_bf16_f32 v85, v85, v85
    v_cvt_pk_bf16_f32 v86, v86, v86
    v_cvt_pk_bf16_f32 v87, v87, v87
    v_lshlrev_b32 v80, 16, v80
    v_lshlrev_b32 v81, 16, v81
    v_lshlrev_b32 v82, 16, v82
    v_lshlrev_b32 v83, 16, v83
    v_lshlrev_b32 v84, 16, v84
    v_lshlrev_b32 v85, 16, v85
    v_lshlrev_b32 v86, 16, v86
    v_lshlrev_b32 v87, 16, v87
    v_mul_f32 v80, v80, v6
    v_mul_f32 v81, v81, v6
    v_mul_f32 v82, v82, v6
    v_mul_f32 v83, v83, v6
    v_mul_f32 v84, v84, v6
    v_mul_f32 v85, v85, v6
    v_mul_f32 v86, v86, v6
    v_mul_f32 v87, v87, v6
    v_cvt_pk_bf16_f32 v80, v80, v80
    v_cvt_pk_bf16_f32 v81, v81, v81
    v_cvt_pk_bf16_f32 v82, v82, v82
    v_cvt_pk_bf16_f32 v83, v83, v83
    v_cvt_pk_bf16_f32 v84, v84, v84
    v_cvt_pk_bf16_f32 v85, v85, v85
    v_cvt_pk_bf16_f32 v86, v86, v86
    v_cvt_pk_bf16_f32 v87, v87, v87
    v_and_b32 v36, v80, v88
    v_and_b32 v37, v80, v89
    v_and_b32 v38, v80, v90
    v_and_b32 v39, v80, v91
    v_and_b32 v40, v81, v88
    v_and_b32 v41, v81, v89
    v_and_b32 v42, v81, v90
    v_and_b32 v43, v81, v91
    v_and_b32 v44, v82, v88
    v_and_b32 v45, v82, v89
    v_and_b32 v46, v82, v90
    v_and_b32 v47, v82, v91
    v_and_b32 v48, v83, v88
    v_and_b32 v49, v83, v89
    v_and_b32 v50, v83, v90
    v_and_b32 v51, v83, v91
    v_and_b32 v52, v84, v88
    v_and_b32 v53, v84, v89
    v_and_b32 v54, v84, v90
    v_and_b32 v55, v84, v91
    v_and_b32 v56, v85, v88
    v_and_b32 v57, v85, v89
    v_and_b32 v58, v85, v90
    v_and_b32 v59, v85, v91
    v_and_b32 v60, v86, v88
    v_and_b32 v61, v86, v89
    v_and_b32 v62, v86, v90
    v_and_b32 v63, v86, v91
    v_and_b32 v64, v87, v88
    v_and_b32 v65, v87, v89
    v_and_b32 v66, v87, v90
    v_and_b32 v67, v87, v91
    v_lshrrev_b32 v5, 5, v1
    v_and_b32 v6, 7, v1
    v_lshlrev_b32 v6, 1, v6
    v_lshl_add_u32 v6, v5, 4, v6
    v_bfe_u32 v5, v1, 4, 1
    v_add_u32 v6, v6, v5
    v_lshlrev_b32 v108, 4, v6
    s_lshr_b32 s3, s2, 4
    s_lshl_b32 s3, s3, 2
    s_add_u32 s3, s3, s38
    s_lshl_b32 s3, s3, 4
    s_and_b32 s65, s2, 15
    s_add_u32 s3, s3, s65
    s_lshl_b32 s3, s3, 10
    s_add_u32 s78, s3, 6291456
    s_mov_b32 s66, 0x00ff00ff
    s_mov_b32 s67, 0x00ff00ff
    v_mov_b32 v93, v18
    v_mov_b32 v95, v18
    v_mov_b32 v97, v18
    v_mov_b32 v99, v18
    s_lshl_b32 s65, s37, 1
    s_add_u32 s65, s65, s38
    s_sub_u32 s65, s65, 2
    s_lshl_b32 s68, s65, 17
    s_lshl_b32 s3, s36, 9
    s_add_u32 s68, s68, s3
    s_add_u32 s68, s68, 2097152
    s_lshl_b32 s69, s65, 13
    s_add_u32 s69, s69, 524288
    s_add_u32 s71, s69, s3
    s_lshl_b32 s3, s36, 8
    s_add_u32 s3, s3, s65
    s_lshl_b32 s3, s3, 10
    s_add_u32 s92, s3, 12582912
    v_lshrrev_b32 v5, 4, v1
    v_and_b32 v6, 15, v1
    v_lshlrev_b32 v6, 4, v6
    v_lshl_add_u32 v28, v5, 13, v6
    v_lshrrev_b32 v7, 5, v1
    v_lshl_add_u32 v29, v7, 8, v6
    s_lshl_b32 s3, s38, 12
    s_add_u32 s3, s3, 132608
    v_add_u32 v30, s3, v3
    s_lshl_b32 s3, s38, 7
    s_add_u32 s3, s3, 148736
    v_lshl_add_u32 v31, v5, 3, s3
    s_mov_b32 s90, -1
    s_mov_b32 s91, 0
    s_mov_b32 s94, 0xffff
    s_mov_b32 s95, 0xffff
    v_mov_b32 v32, -1
    v_mov_b32 v33, -1
    v_mov_b32 v34, -1
    v_mov_b32 v35, -1
    buffer_load_dwordx4 v[192:195], v109, s[20:23], s93 offen offset:0 nt
    buffer_load_dwordx4 v[196:199], v109, s[20:23], s93 offen offset:256 nt
    s_add_u32 s93, s93, 8192
    buffer_load_dwordx4 v[200:203], v109, s[20:23], s93 offen offset:0 nt
    buffer_load_dwordx4 v[204:207], v109, s[20:23], s93 offen offset:256 nt
    s_add_u32 s93, s93, 8192
    buffer_load_dwordx4 v[208:211], v109, s[20:23], s93 offen offset:0 nt
    buffer_load_dwordx4 v[212:215], v109, s[20:23], s93 offen offset:256 nt
    s_add_u32 s93, s93, 8192
    buffer_load_dwordx4 v[216:219], v109, s[20:23], s93 offen offset:0 nt
    buffer_load_dwordx4 v[220:223], v109, s[20:23], s93 offen offset:256 nt
    s_waitcnt vmcnt(30)
    v_mfma_f32_16x16x32_bf16 v[100:103], v[36:39], v[128:131], 0
    v_mfma_f32_16x16x32_bf16 v[104:107], v[36:39], v[160:163], 0
    s_waitcnt vmcnt(28)
    v_mfma_f32_16x16x32_bf16 v[100:103], v[40:43], v[132:135], v[100:103]
    v_mfma_f32_16x16x32_bf16 v[104:107], v[40:43], v[164:167], v[104:107]
    s_waitcnt vmcnt(26)
    v_mfma_f32_16x16x32_bf16 v[100:103], v[44:47], v[136:139], v[100:103]
    v_mfma_f32_16x16x32_bf16 v[104:107], v[44:47], v[168:171], v[104:107]
    s_barrier
    s_barrier
    s_add_u32 m0, s72, 0
    s_nop 0
    buffer_load_dwordx4 v8, s[4:7], s74 offen offset:0  lds
    buffer_load_dwordx4 v9, s[4:7], s74 offen offset:1024  lds
    buffer_load_dwordx4 v10, s[4:7], s74 offen offset:2048  lds
    buffer_load_dwordx4 v11, s[4:7], s74 offen offset:3072  lds
    s_add_u32 s74, s74, 128
    s_and_b32 s74, s74, 2047
    s_add_u32 m0, s73, 65536
    s_nop 0
    buffer_load_dwordx4 v16, s[8:11], s76 offen offset:0  lds
    buffer_load_dwordx4 v17, s[8:11], s76 offen offset:1024  lds
    s_add_u32 s76, s76, 393216
    s_cmp_eq_u32 s76, 6291456
    s_cselect_b32 s76, 0, s76
    s_barrier
    s_add_u32 m0, s72, 16384
    s_nop 0
    buffer_load_dwordx4 v8, s[4:7], s74 offen offset:0  lds
    buffer_load_dwordx4 v9, s[4:7], s74 offen offset:1024  lds
    buffer_load_dwordx4 v10, s[4:7], s74 offen offset:2048  lds
    buffer_load_dwordx4 v11, s[4:7], s74 offen offset:3072  lds
    s_add_u32 s74, s74, 128
    s_and_b32 s74, s74, 2047
    s_add_u32 m0, s73, 73728
    s_nop 0
    buffer_load_dwordx4 v16, s[8:11], s76 offen offset:0  lds
    buffer_load_dwordx4 v17, s[8:11], s76 offen offset:1024  lds
    s_add_u32 s76, s76, 393216
    s_cmp_eq_u32 s76, 6291456
    s_cselect_b32 s76, 0, s76
    s_barrier
    s_add_u32 m0, s72, 32768
    s_nop 0
    buffer_load_dwordx4 v8, s[4:7], s74 offen offset:0  lds
    buffer_load_dwordx4 v9, s[4:7], s74 offen offset:1024  lds
    buffer_load_dwordx4 v10, s[4:7], s74 offen offset:2048  lds
    buffer_load_dwordx4 v11, s[4:7], s74 offen offset:3072  lds
    s_add_u32 s74, s74, 128
    s_and_b32 s74, s74, 2047
    s_add_u32 m0, s73, 81920
    s_nop 0
    buffer_load_dwordx4 v16, s[8:11], s76 offen offset:0  lds
    buffer_load_dwordx4 v17, s[8:11], s76 offen offset:1024  lds
    s_add_u32 s76, s76, 393216
    s_cmp_eq_u32 s76, 6291456
    s_cselect_b32 s76, 0, s76
    s_waitcnt vmcnt(14)
    s_barrier
    v_mfma_f32_16x16x32_bf16 v[100:103], v[48:51], v[140:143], v[100:103]
    v_mfma_f32_16x16x32_bf16 v[104:107], v[48:51], v[172:175], v[104:107]
    s_add_u32 m0, s72, 49152
    s_nop 0
    buffer_load_dwordx4 v8, s[4:7], s74 offen offset:0  lds
    buffer_load_dwordx4 v9, s[4:7], s74 offen offset:1024  lds
    buffer_load_dwordx4 v10, s[4:7], s74 offen offset:2048  lds
    buffer_load_dwordx4 v11, s[4:7], s74 offen offset:3072  lds
    s_add_u32 s74, s74, 128
    s_and_b32 s74, s74, 2047
    s_add_u32 m0, s73, 90112
    s_nop 0
    buffer_load_dwordx4 v16, s[8:11], s76 offen offset:0  lds
    buffer_load_dwordx4 v17, s[8:11], s76 offen offset:1024  lds
    s_add_u32 s76, s76, 393216
    s_cmp_eq_u32 s76, 6291456
    s_cselect_b32 s76, 0, s76
    s_waitcnt vmcnt(14)
    s_barrier
    v_mfma_f32_16x16x32_bf16 v[100:103], v[52:55], v[144:147], v[100:103]
    v_mfma_f32_16x16x32_bf16 v[104:107], v[52:55], v[176:179], v[104:107]
    s_add_u32 m0, s72, 0
    s_nop 0
    buffer_load_dwordx4 v8, s[4:7], s74 offen offset:0  lds
    buffer_load_dwordx4 v9, s[4:7], s74 offen offset:1024  lds
    buffer_load_dwordx4 v10, s[4:7], s74 offen offset:2048  lds
    buffer_load_dwordx4 v11, s[4:7], s74 offen offset:3072  lds
    s_add_u32 s74, s74, 128
    s_and_b32 s74, s74, 2047
    s_add_u32 m0, s73, 98304
    s_nop 0
    buffer_load_dwordx4 v16, s[8:11], s76 offen offset:0  lds
    buffer_load_dwordx4 v17, s[8:11], s76 offen offset:1024  lds
    s_add_u32 s76, s76, 393216
    s_cmp_eq_u32 s76, 6291456
    s_cselect_b32 s76, 0, s76
    s_waitcnt vmcnt(14)
    s_barrier
    v_mfma_f32_16x16x32_bf16 v[100:103], v[56:59], v[148:151], v[100:103]
    v_mfma_f32_16x16x32_bf16 v[104:107], v[56:59], v[180:183], v[104:107]
    s_add_u32 m0, s72, 16384
    s_nop 0
    buffer_load_dwordx4 v8, s[4:7], s74 offen offset:0  lds
    buffer_load_dwordx4 v9, s[4:7], s74 offen offset:1024  lds
    buffer_load_dwordx4 v10, s[4:7], s74 offen offset:2048  lds
    buffer_load_dwordx4 v11, s[4:7], s74 offen offset:3072  lds
    s_add_u32 s74, s74, 128
    s_and_b32 s74, s74, 2047
    s_add_u32 m0, s73, 106496
    s_nop 0
    buffer_load_dwordx4 v16, s[8:11], s76 offen offset:0  lds
    buffer_load_dwordx4 v17, s[8:11], s76 offen offset:1024  lds
    s_add_u32 s76, s76, 393216
    s_cmp_eq_u32 s76, 6291456
    s_cselect_b32 s76, 0, s76
    s_waitcnt vmcnt(14)
    s_barrier
    v_mfma_f32_16x16x32_bf16 v[100:103], v[60:63], v[152:155], v[100:103]
    v_mfma_f32_16x16x32_bf16 v[104:107], v[60:63], v[184:187], v[104:107]
    s_add_u32 m0, s72, 32768
    s_nop 0
    buffer_load_dwordx4 v8, s[4:7], s74 offen offset:0  lds
    buffer_load_dwordx4 v9, s[4:7], s74 offen offset:1024  lds
    buffer_load_dwordx4 v10, s[4:7], s74 offen offset:2048  lds
    buffer_load_dwordx4 v11, s[4:7], s74 offen offset:3072  lds
    s_add_u32 s74, s74, 128
    s_and_b32 s74, s74, 2047
    s_add_u32 m0, s73, 114688
    s_nop 0
    buffer_load_dwordx4 v16, s[8:11], s76 offen offset:0  lds
    buffer_load_dwordx4 v17, s[8:11], s76 offen offset:1024  lds
    s_add_u32 s76, s76, 393216
    s_cmp_eq_u32 s76, 6291456
    s_cselect_b32 s76, 0, s76
    s_waitcnt vmcnt(14)
    s_barrier
    v_mfma_f32_16x16x32_bf16 v[100:103], v[64:67], v[156:159], v[100:103]
    v_mfma_f32_16x16x32_bf16 v[104:107], v[64:67], v[188:191], v[104:107]
    s_add_u32 m0, s72, 49152
    s_nop 0
    buffer_load_dwordx4 v8, s[4:7], s74 offen offset:0  lds
    buffer_load_dwordx4 v9, s[4:7], s74 offen offset:1024  lds
    buffer_load_dwordx4 v10, s[4:7], s74 offen offset:2048  lds
    buffer_load_dwordx4 v11, s[4:7], s74 offen offset:3072  lds
    s_add_u32 s74, s74, 128
    s_and_b32 s74, s74, 2047
    s_add_u32 m0, s73, 122880
    s_nop 0
    buffer_load_dwordx4 v16, s[8:11], s76 offen offset:0  lds
    buffer_load_dwordx4 v17, s[8:11], s76 offen offset:1024  lds
    s_add_u32 s76, s76, 393216
    s_cmp_eq_u32 s76, 6291456
    s_cselect_b32 s76, 0, s76
    s_waitcnt vmcnt(14)
    s_barrier
    s_add_u32 m0, s72, 0
    s_nop 0
    buffer_load_dwordx4 v8, s[4:7], s74 offen offset:0  lds
    buffer_load_dwordx4 v9, s[4:7], s74 offen offset:1024  lds
    buffer_load_dwordx4 v10, s[4:7], s74 offen offset:2048  lds
    buffer_load_dwordx4 v11, s[4:7], s74 offen offset:3072  lds
    s_add_u32 s74, s74, 128
    s_and_b32 s74, s74, 2047
    s_cmp_lt_u32 s38, 2
    s_cbranch_scc1 L_nfa
    s_mov_b32 s3, s68
    buffer_load_dwordx4 v[128:131], v28, s[12:15], s3 offen offset:0 sc1
    buffer_load_dwordx4 v[132:135], v28, s[12:15], s3 offen offset:256 sc1
    s_add_u32 s3, s3, 32768
    buffer_load_dwordx4 v[136:139], v28, s[12:15], s3 offen offset:0 sc1
    buffer_load_dwordx4 v[140:143], v28, s[12:15], s3 offen offset:256 sc1
    s_add_u32 s3, s3, 32768
    buffer_load_dwordx4 v[144:147], v28, s[12:15], s3 offen offset:0 sc1
    buffer_load_dwordx4 v[148:151], v28, s[12:15], s3 offen offset:256 sc1
    s_add_u32 s3, s3, 32768
    buffer_load_dwordx4 v[152:155], v28, s[12:15], s3 offen offset:0 sc1
    buffer_load_dwordx4 v[156:159], v28, s[12:15], s3 offen offset:256 sc1
L_nfa:
    s_waitcnt vmcnt(12)
    s_barrier
    s_add_u32 m0, s72, 16384
    s_nop 0
    buffer_load_dwordx4 v8, s[4:7], s74 offen offset:0  lds
    buffer_load_dwordx4 v9, s[4:7], s74 offen offset:1024  lds
    buffer_load_dwordx4 v10, s[4:7], s74 offen offset:2048  lds
    buffer_load_dwordx4 v11, s[4:7], s74 offen offset:3072  lds
    s_add_u32 s74, s74, 128
    s_and_b32 s74, s74, 2047
    s_add_u32 m0, s72, 65536
    s_nop 0
    buffer_load_dwordx4 v8, s[4:7], s74 offen offset:0  lds
    buffer_load_dwordx4 v9, s[4:7], s74 offen offset:1024  lds
    buffer_load_dwordx4 v10, s[4:7], s74 offen offset:2048  lds
    buffer_load_dwordx4 v11, s[4:7], s74 offen offset:3072  lds
    s_add_u32 s74, s74, 128
    s_and_b32 s74, s74, 2047
    s_waitcnt vmcnt(14)
    s_waitcnt vmcnt(8)
    s_barrier
    s_add_u32 m0, s72, 32768
    s_nop 0
    buffer_load_dwordx4 v8, s[4:7], s74 offen offset:0  lds
    buffer_load_dwordx4 v9, s[4:7], s74 offen offset:1024  lds
    buffer_load_dwordx4 v10, s[4:7], s74 offen offset:2048  lds
    buffer_load_dwordx4 v11, s[4:7], s74 offen offset:3072  lds
    s_add_u32 s74, s74, 128
    s_and_b32 s74, s74, 2047
    s_cmp_ge_u32 s38, 2
    s_cbranch_scc1 L_xw2
    s_add_u32 m0, s73, 81920
    s_add_u32 s3, s88, 10
    s_and_b32 s3, s3, 15
    s_lshl_b32 s3, s3, 17
    buffer_load_dwordx4 v110, s[16:19], s3 offen offset:0  lds
    buffer_load_dwordx4 v111, s[16:19], s3 offen offset:1024  lds
    s_add_u32 m0, s73, 86016
    s_add_u32 s3, s3, 65536
    buffer_load_dwordx4 v110, s[16:19], s3 offen offset:0  lds
    buffer_load_dwordx4 v111, s[16:19], s3 offen offset:1024  lds
    v_permlane32_swap_b32 v100, v104
    v_permlane32_swap_b32 v101, v105
    v_permlane32_swap_b32 v102, v106
    v_permlane32_swap_b32 v103, v107
    v_add_f32 v92, v104, v100 row_ror:8 row_mask:0xf bank_mask:0xf
    v_add_f32 v94, v105, v101 row_ror:8 row_mask:0xf bank_mask:0xf
    v_add_f32 v96, v106, v102 row_ror:8 row_mask:0xf bank_mask:0xf
    v_add_f32 v98, v107, v103 row_ror:8 row_mask:0xf bank_mask:0xf
    s_mov_b64 exec, s[66:67]
    buffer_store_dwordx4 v[92:95], v108, s[12:15], s78 offen offset:0 sc1
    buffer_store_dwordx4 v[96:99], v108, s[12:15], s78 offen offset:512 sc1
    s_mov_b64 exec, -1
    s_waitcnt vmcnt(6)
    s_lshl_b32 s3, s38, 2
    s_add_u32 s3, s3, 139168
    v_mov_b32 v5, s3
    v_mov_b32 v6, 1
    ds_write_b32 v5, v6
    v_mov_b32 v4, 139136
L_pe12:
    ds_read_b128 v[224:227], v4 offset:48
    s_waitcnt lgkmcnt(0)
    v_min_u32 v224, v224, v225
    v_min3_u32 v224, v224, v226, v227
    s_nop 0
    v_readfirstlane_b32 s3, v224
    s_nop 0
    s_cmp_lt_u32 s3, 12
    s_cbranch_scc1 L_pe12
    s_add_u32 m0, s73, 49152
    s_add_u32 s3, s88, 6
    s_and_b32 s3, s3, 15
    s_lshl_b32 s3, s3, 17
    buffer_load_dwordx4 v110, s[16:19], s3 offen offset:0  lds
    buffer_load_dwordx4 v111, s[16:19], s3 offen offset:1024  lds
    s_add_u32 m0, s73, 53248
    s_add_u32 s3, s3, 65536
    buffer_load_dwordx4 v110, s[16:19], s3 offen offset:0  lds
    buffer_load_dwordx4 v111, s[16:19], s3 offen offset:1024  lds
    s_add_u32 m0, s73, 57344
    s_add_u32 s3, s88, 7
    s_and_b32 s3, s3, 15
    s_lshl_b32 s3, s3, 17
    buffer_load_dwordx4 v110, s[16:19], s3 offen offset:0  lds
    buffer_load_dwordx4 v111, s[16:19], s3 offen offset:1024  lds
    s_add_u32 m0, s73, 61440
    s_add_u32 s3, s3, 65536
    buffer_load_dwordx4 v110, s[16:19], s3 offen offset:0  lds
    buffer_load_dwordx4 v111, s[16:19], s3 offen offset:1024  lds
    s_add_u32 m0, s73, 90112
    s_add_u32 s3, s88, 11
    s_and_b32 s3, s3, 15
    s_lshl_b32 s3, s3, 17
    buffer_load_dwordx4 v110, s[16:19], s3 offen offset:0  lds
    buffer_load_dwordx4 v111, s[16:19], s3 offen offset:1024  lds
    s_add_u32 m0, s73, 94208
    s_add_u32 s3, s3, 65536
    buffer_load_dwordx4 v110, s[16:19], s3 offen offset:0  lds
    buffer_load_dwordx4 v111, s[16:19], s3 offen offset:1024  lds
L_pe13:
    ds_read_b128 v[224:227], v4 offset:48
    s_waitcnt lgkmcnt(0)
    v_min_u32 v224, v224, v225
    v_min3_u32 v224, v224, v226, v227
    s_nop 0
    v_readfirstlane_b32 s3, v224
    s_nop 0
    s_cmp_lt_u32 s3, 13
    s_cbranch_scc1 L_pe13
    s_add_u32 m0, s73, 0
    s_add_u32 s3, s88, 0
    s_and_b32 s3, s3, 15
    s_lshl_b32 s3, s3, 17
    buffer_load_dwordx4 v110, s[16:19], s3 offen offset:0  lds
    buffer_load_dwordx4 v111, s[16:19], s3 offen offset:1024  lds
    s_add_u32 m0, s73, 4096
    s_add_u32 s3, s3, 65536
    buffer_load_dwordx4 v110, s[16:19], s3 offen offset:0  lds
    buffer_load_dwordx4 v111, s[16:19], s3 offen offset:1024  lds
    s_add_u32 m0, s73, 8192
    s_add_u32 s3, s88, 1
    s_and_b32 s3, s3, 15
    s_lshl_b32 s3, s3, 17
    buffer_load_dwordx4 v110, s[16:19], s3 offen offset:0  lds
    buffer_load_dwordx4 v111, s[16:19], s3 offen offset:1024  lds
    s_add_u32 m0, s73, 12288
    s_add_u32 s3, s3, 65536
    buffer_load_dwordx4 v110, s[16:19], s3 offen offset:0  lds
    buffer_load_dwordx4 v111, s[16:19], s3 offen offset:1024  lds
    s_add_u32 m0, s73, 98304
    s_add_u32 s3, s88, 12
    s_and_b32 s3, s3, 15
    s_lshl_b32 s3, s3, 17
    buffer_load_dwordx4 v110, s[16:19], s3 offen offset:0  lds
    buffer_load_dwordx4 v111, s[16:19], s3 offen offset:1024  lds
    s_add_u32 m0, s73, 102400
    s_add_u32 s3, s3, 65536
    buffer_load_dwordx4 v110, s[16:19], s3 offen offset:0  lds
    buffer_load_dwordx4 v111, s[16:19], s3 offen offset:1024  lds
L_pe14:
    ds_read_b128 v[224:227], v4 offset:48
    s_waitcnt lgkmcnt(0)
    v_min_u32 v224, v224, v225
    v_min3_u32 v224, v224, v226, v227
    s_nop 0
    v_readfirstlane_b32 s3, v224
    s_nop 0
    s_cmp_lt_u32 s3, 14
    s_cbranch_scc1 L_pe14
    s_add_u32 m0, s73, 16384
    s_add_u32 s3, s88, 2
    s_and_b32 s3, s3, 15
    s_lshl_b32 s3, s3, 17
    buffer_load_dwordx4 v110, s[16:19], s3 offen offset:0  lds
    buffer_load_dwordx4 v111, s[16:19], s3 offen offset:1024  lds
    s_add_u32 m0, s73, 20480
    s_add_u32 s3, s3, 65536
    buffer_load_dwordx4 v110, s[16:19], s3 offen offset:0  lds
    buffer_load_dwordx4 v111, s[16:19], s3 offen offset:1024  lds
    s_add_u32 m0, s73, 24576
    s_add_u32 s3, s88, 3
    s_and_b32 s3, s3, 15
    s_lshl_b32 s3, s3, 17
    buffer_load_dwordx4 v110, s[16:19], s3 offen offset:0  lds
    buffer_load_dwordx4 v111, s[16:19], s3 offen offset:1024  lds
    s_add_u32 m0, s73, 28672
    s_add_u32 s3, s3, 65536
    buffer_load_dwordx4 v110, s[16:19], s3 offen offset:0  lds
    buffer_load_dwordx4 v111, s[16:19], s3 offen offset:1024  lds
    s_add_u32 m0, s73, 106496
    s_add_u32 s3, s88, 13
    s_and_b32 s3, s3, 15
    s_lshl_b32 s3, s3, 17
    buffer_load_dwordx4 v110, s[16:19], s3 offen offset:0  lds
    buffer_load_dwordx4 v111, s[16:19], s3 offen offset:1024  lds
    s_add_u32 m0, s73, 110592
    s_add_u32 s3, s3, 65536
    buffer_load_dwordx4 v110, s[16:19], s3 offen offset:0  lds
    buffer_load_dwordx4 v111, s[16:19], s3 offen offset:1024  lds
L_pe15:
    ds_read_b128 v[224:227], v4 offset:48
    s_waitcnt lgkmcnt(0)
    v_min_u32 v224, v224, v225
    v_min3_u32 v224, v224, v226, v227
    s_nop 0
    v_readfirstlane_b32 s3, v224
    s_nop 0
    s_cmp_lt_u32 s3, 15
    s_cbranch_scc1 L_pe15
    s_add_u32 m0, s73, 65536
    s_add_u32 s3, s88, 8
    s_and_b32 s3, s3, 15
    s_lshl_b32 s3, s3, 17
    buffer_load_dwordx4 v110, s[16:19], s3 offen offset:0  lds
    buffer_load_dwordx4 v111, s[16:19], s3 offen offset:1024  lds
    s_add_u32 m0, s73, 69632
    s_add_u32 s3, s3, 65536
    buffer_load_dwordx4 v110, s[16:19], s3 offen offset:0  lds
    buffer_load_dwordx4 v111, s[16:19], s3 offen offset:1024  lds
    s_add_u32 m0, s73, 73728
    s_add_u32 s3, s88, 9
    s_and_b32 s3, s3, 15
    s_lshl_b32 s3, s3, 17
    buffer_load_dwordx4 v110, s[16:19], s3 offen offset:0  lds
    buffer_load_dwordx4 v111, s[16:19], s3 offen offset:1024  lds
    s_add_u32 m0, s73, 77824
    s_add_u32 s3, s3, 65536
    buffer_load_dwordx4 v110, s[16:19], s3 offen offset:0  lds
    buffer_load_dwordx4 v111, s[16:19], s3 offen offset:1024  lds
    s_add_u32 m0, s73, 114688
    s_add_u32 s3, s88, 14
    s_and_b32 s3, s3, 15
    s_lshl_b32 s3, s3, 17
    buffer_load_dwordx4 v110, s[16:19], s3 offen offset:0  lds
    buffer_load_dwordx4 v111, s[16:19], s3 offen offset:1024  lds
    s_add_u32 m0, s73, 118784
    s_add_u32 s3, s3, 65536
    buffer_load_dwordx4 v110, s[16:19], s3 offen offset:0  lds
    buffer_load_dwordx4 v111, s[16:19], s3 offen offset:1024  lds
L_pe16:
    ds_read_b128 v[224:227], v4 offset:48
    s_waitcnt lgkmcnt(0)
    v_min_u32 v224, v224, v225
    v_min3_u32 v224, v224, v226, v227
    s_nop 0
    v_readfirstlane_b32 s3, v224
    s_nop 0
    s_cmp_lt_u32 s3, 16
    s_cbranch_scc1 L_pe16
    s_add_u32 m0, s73, 32768
    s_add_u32 s3, s88, 4
    s_and_b32 s3, s3, 15
    s_lshl_b32 s3, s3, 17
    buffer_load_dwordx4 v110, s[16:19], s3 offen offset:0  lds
    buffer_load_dwordx4 v111, s[16:19], s3 offen offset:1024  lds
    s_add_u32 m0, s73, 36864
    s_add_u32 s3, s3, 65536
    buffer_load_dwordx4 v110, s[16:19], s3 offen offset:0  lds
    buffer_load_dwordx4 v111, s[16:19], s3 offen offset:1024  lds
    s_add_u32 m0, s73, 40960
    s_add_u32 s3, s88, 5
    s_and_b32 s3, s3, 15
    s_lshl_b32 s3, s3, 17
    buffer_load_dwordx4 v110, s[16:19], s3 offen offset:0  lds
    buffer_load_dwordx4 v111, s[16:19], s3 offen offset:1024  lds
    s_add_u32 m0, s73, 45056
    s_add_u32 s3, s3, 65536
    buffer_load_dwordx4 v110, s[16:19], s3 offen offset:0  lds
    buffer_load_dwordx4 v111, s[16:19], s3 offen offset:1024  lds
    s_add_u32 m0, s73, 122880
    s_add_u32 s3, s88, 15
    s_and_b32 s3, s3, 15
    s_lshl_b32 s3, s3, 17
    buffer_load_dwordx4 v110, s[16:19], s3 offen offset:0  lds
    buffer_load_dwordx4 v111, s[16:19], s3 offen offset:1024  lds
    s_add_u32 m0, s73, 126976
    s_add_u32 s3, s3, 65536
    buffer_load_dwordx4 v110, s[16:19], s3 offen offset:0  lds
    buffer_load_dwordx4 v111, s[16:19], s3 offen offset:1024  lds
    s_branch L_join2
L_xw2:
    s_waitcnt vmcnt(12)
L_ha:
    v_and_b32 v6, v131, v135
    v_or_b32 v7, v131, v135
    v_min3_u32 v6, v6, v139, v143
    v_max3_u32 v7, v7, v139, v143
    v_min3_u32 v6, v6, v147, v151
    v_max3_u32 v7, v7, v147, v151
    v_min3_u32 v6, v6, v155, v159
    v_max3_u32 v7, v7, v155, v159
    v_xor_b32 v6, v6, v18
    v_xor_b32 v7, v7, v18
    v_or_b32 v6, v6, v7
    v_cmp_ne_u32 vcc, 0, v6
    s_nop 0
    s_cmp_eq_u64 vcc, 0
    s_cbranch_scc1 L_haok
    s_add_u32 s70, s70, 1
    s_cmp_ge_u32 s70, 200000
    s_cbranch_scc1 L_haok
    s_sleep 2
    s_waitcnt vmcnt(0)
    s_lshl_b32 s3, s38, 2
    s_add_u32 s3, s3, 139168
    v_mov_b32 v5, s3
    v_mov_b32 v6, 1
    ds_write_b32 v5, v6
    s_mov_b32 s3, s68
    buffer_load_dwordx4 v[128:131], v28, s[12:15], s3 offen offset:0 sc1
    buffer_load_dwordx4 v[132:135], v28, s[12:15], s3 offen offset:256 sc1
    s_add_u32 s3, s3, 32768
    buffer_load_dwordx4 v[136:139], v28, s[12:15], s3 offen offset:0 sc1
    buffer_load_dwordx4 v[140:143], v28, s[12:15], s3 offen offset:256 sc1
    s_add_u32 s3, s3, 32768
    buffer_load_dwordx4 v[144:147], v28, s[12:15], s3 offen offset:0 sc1
    buffer_load_dwordx4 v[148:151], v28, s[12:15], s3 offen offset:256 sc1
    s_add_u32 s3, s3, 32768
    buffer_load_dwordx4 v[152:155], v28, s[12:15], s3 offen offset:0 sc1
    buffer_load_dwordx4 v[156:159], v28, s[12:15], s3 offen offset:256 sc1
    s_waitcnt vmcnt(0)
    s_branch L_ha
L_haok:
    v_mfma_f32_16x16x32_bf16 v[160:163], v[20:23], v[128:131], 0
    v_mfma_f32_16x16x32_bf16 v[164:167], v[20:23], v[132:135], 0
    v_mfma_f32_16x16x32_bf16 v[160:163], v[20:23], v[136:139], v[160:163]
    v_mfma_f32_16x16x32_bf16 v[164:167], v[20:23], v[140:143], v[164:167]
    v_mfma_f32_16x16x32_bf16 v[160:163], v[20:23], v[144:147], v[160:163]
    v_mfma_f32_16x16x32_bf16 v[164:167], v[20:23], v[148:151], v[164:167]
    v_mfma_f32_16x16x32_bf16 v[160:163], v[20:23], v[152:155], v[160:163]
    v_mfma_f32_16x16x32_bf16 v[164:167], v[20:23], v[156:159], v[164:167]
    s_nop 7
    v_cndmask_b32 v160, v164, v160, s[90:91]
    v_cndmask_b32 v161, v165, v161, s[90:91]
    v_cndmask_b32 v162, v166, v162, s[90:91]
    v_cndmask_b32 v163, v167, v163, s[90:91]
    v_cvt_pk_bf16_f32 v164, v160, v161
    v_cvt_pk_bf16_f32 v6, v160, v161
    v_cvt_pk_bf16_f32 v165, v162, v163
    v_mov_b32 v167, v18
    v_permlane16_swap_b32 v6, v166
    s_mov_b64 exec, s[94:95]
    buffer_store_dwordx4 v[164:167], v29, s[12:15], s71 offen sc1
    s_mov_b64 exec, -1
    s_add_u32 s71, s69, 4096
    s_waitcnt vmcnt(1)
    s_lshl_b32 s3, s38, 2
    s_add_u32 s3, s3, 139168
    v_mov_b32 v5, s3
    v_mov_b32 v6, 1
    ds_write_b32 v5, v6
    v_permlane32_swap_b32 v100, v104
    v_permlane32_swap_b32 v101, v105
    v_permlane32_swap_b32 v102, v106
    v_permlane32_swap_b32 v103, v107
    v_add_f32 v92, v104, v100 row_ror:8 row_mask:0xf bank_mask:0xf
    v_add_f32 v94, v105, v101 row_ror:8 row_mask:0xf bank_mask:0xf
    v_add_f32 v96, v106, v102 row_ror:8 row_mask:0xf bank_mask:0xf
    v_add_f32 v98, v107, v103 row_ror:8 row_mask:0xf bank_mask:0xf
    s_mov_b64 exec, s[66:67]
    buffer_store_dwordx4 v[92:95], v108, s[12:15], s78 offen offset:0 sc1
    buffer_store_dwordx4 v[96:99], v108, s[12:15], s78 offen offset:512 sc1
    s_mov_b64 exec, -1
    buffer_store_dwordx4 v[32:35], v3, s[12:15], s92 offen sc1
    s_add_u32 s92, s92, 32768
    buffer_store_dwordx4 v[32:35], v3, s[12:15], s92 offen sc1
    s_add_u32 s92, s92, 32768
    buffer_store_dwordx4 v[32:35], v3, s[12:15], s92 offen sc1
    s_add_u32 s92, s92, 32768
    buffer_store_dwordx4 v[32:35], v3, s[12:15], s92 offen sc1
    s_add_u32 s92, s92, 32768
    buffer_store_dwordx4 v[32:35], v3, s[12:15], s92 offen sc1
    s_add_u32 s92, s92, 32768
    buffer_store_dwordx4 v[32:35], v3, s[12:15], s92 offen sc1
    s_add_u32 s92, s92, 32768
    buffer_store_dwordx4 v[32:35], v3, s[12:15], s92 offen sc1
    s_add_u32 s92, s92, 32768
    buffer_store_dwordx4 v[32:35], v3, s[12:15], s92 offen sc1
    s_add_u32 s92, s92, 32768
    s_lshl_b32 s3, s2, 12
    s_add_u32 s3, s3, s73
    s_add_u32 s3, s3, 8384512
    buffer_store_dwordx4 v[32:35], v3, s[12:15], s3 offen offset:0 sc1
    buffer_store_dwordx4 v[32:35], v3, s[12:15], s3 offen offset:1024 sc1
    buffer_load_dwordx4 v[128:131], v3, s[12:15], s69 offen offset:0 sc1
    buffer_load_dwordx4 v[132:135], v3, s[12:15], s69 offen offset:1024 sc1
    buffer_load_dwordx4 v[136:139], v3, s[12:15], s69 offen offset:2048 sc1
    buffer_load_dwordx4 v[140:143], v3, s[12:15], s69 offen offset:3072 sc1
    buffer_load_dwordx4 v[144:147], v3, s[12:15], s71 offen offset:0 sc1
    buffer_load_dwordx4 v[148:151], v3, s[12:15], s71 offen offset:1024 sc1
    buffer_load_dwordx4 v[152:155], v3, s[12:15], s71 offen offset:2048 sc1
    buffer_load_dwordx4 v[156:159], v3, s[12:15], s71 offen offset:3072 sc1
    s_waitcnt vmcnt(8)
    s_lshl_b32 s3, s36, 4
    s_add_u32 s3, s3, s37
    s_lshl_b32 s3, s3, 1
    s_add_u32 s3, s3, s38
    s_lshl_b32 s3, s3, 2
    s_add_u32 s3, s3, 131064
    v_mov_b32 v5, 0
    s_mov_b64 exec, 1
    buffer_store_dword v18, v5, s[12:15], s3 offen sc1
    s_mov_b64 exec, -1
    s_waitcnt vmcnt(1)
L_hb:
    v_and_b32 v6, v131, v135
    v_or_b32 v7, v131, v135
    v_min3_u32 v6, v6, v139, v143
    v_max3_u32 v7, v7, v139, v143
    v_min3_u32 v6, v6, v147, v151
    v_max3_u32 v7, v7, v147, v151
    v_min3_u32 v6, v6, v155, v159
    v_max3_u32 v7, v7, v155, v159
    v_xor_b32 v6, v6, v18
    v_xor_b32 v7, v7, v18
    v_or_b32 v6, v6, v7
    v_cmp_ne_u32 vcc, 0, v6
    s_nop 0
    s_cmp_eq_u64 vcc, 0
    s_cbranch_scc1 L_hbok
    s_add_u32 s70, s70, 1
    s_cmp_ge_u32 s70, 200000
    s_cbranch_scc1 L_hbok
    s_sleep 2
    buffer_load_dwordx4 v[128:131], v3, s[12:15], s69 offen offset:0 sc1
    buffer_load_dwordx4 v[132:135], v3, s[12:15], s69 offen offset:1024 sc1
    buffer_load_dwordx4 v[136:139], v3, s[12:15], s69 offen offset:2048 sc1
    buffer_load_dwordx4 v[140:143], v3, s[12:15], s69 offen offset:3072 sc1
    buffer_load_dwordx4 v[144:147], v3, s[12:15], s71 offen offset:0 sc1
    buffer_load_dwordx4 v[148:151], v3, s[12:15], s71 offen offset:1024 sc1
    buffer_load_dwordx4 v[152:155], v3, s[12:15], s71 offen offset:2048 sc1
    buffer_load_dwordx4 v[156:159], v3, s[12:15], s71 offen offset:3072 sc1
    s_waitcnt vmcnt(0)
    s_branch L_hb
L_hbok:
    ds_write_b64 v30, v[128:129] offset:0
    ds_write_b64 v30, v[132:133] offset:8
    ds_write_b64 v30, v[136:137] offset:1024
    ds_write_b64 v30, v[140:141] offset:1032
    ds_write_b64 v30, v[144:145] offset:2048
    ds_write_b64 v30, v[148:149] offset:2056
    ds_write_b64 v30, v[152:153] offset:3072
    ds_write_b64 v30, v[156:157] offset:3080
    ds_write_b32 v31, v130 offset:0
    ds_write_b32 v31, v134 offset:32
    ds_write_b32 v31, v138 offset:4
    ds_write_b32 v31, v142 offset:36
    ds_write_b32 v31, v146 offset:64
    ds_write_b32 v31, v150 offset:96
    ds_write_b32 v31, v154 offset:68
    ds_write_b32 v31, v158 offset:100
    s_lshl_b32 s3, s38, 2
    s_add_u32 s3, s3, 139128
    v_mov_b32 v5, s3
    v_mov_b32 v6, 1
    ds_write_b32 v5, v6
L_join2:
    v_lshrrev_b32 v5, 2, v1
    v_lshlrev_b32 v5, 10, v5
    v_and_b32 v6, 3, v1
    v_lshl_add_u32 v5, v6, 4, v5
    s_lshr_b32 s3, s2, 2
    s_lshl_b32 s3, s3, 14
    s_and_b32 s65, s2, 3
    s_lshl_b32 s65, s65, 6
    s_add_u32 s3, s3, s65
    s_add_u32 s3, s3, 6291456
    buffer_load_dwordx4 v[52:55], v5, s[12:15], s3 offen offset:0 sc1
    buffer_load_dwordx4 v[56:59], v5, s[12:15], s3 offen offset:512 sc1
    buffer_load_dwordx4 v[60:63], v5, s[12:15], s3 offen offset:256 sc1
    buffer_load_dwordx4 v[64:67], v5, s[12:15], s3 offen offset:768 sc1
    s_waitcnt vmcnt(0)
L_gu:
    v_xor_b32 v6, v53, v18
    v_xor_b32 v7, v55, v18
    v_or_b32 v6, v6, v7
    v_xor_b32 v7, v57, v18
    v_or_b32 v6, v6, v7
    v_xor_b32 v7, v59, v18
    v_or_b32 v6, v6, v7
    v_xor_b32 v7, v61, v18
    v_or_b32 v6, v6, v7
    v_xor_b32 v7, v63, v18
    v_or_b32 v6, v6, v7
    v_xor_b32 v7, v65, v18
    v_or_b32 v6, v6, v7
    v_xor_b32 v7, v67, v18
    v_or_b32 v6, v6, v7
    v_cmp_ne_u32 vcc, 0, v6
    s_nop 0
    s_cmp_eq_u64 vcc, 0
    s_cbranch_scc1 L_guok
    s_add_u32 s70, s70, 1
    s_cmp_ge_u32 s70, 200000
    s_cbranch_scc1 L_guok
    s_sleep 8
    v_lshrrev_b32 v5, 2, v1
    v_lshlrev_b32 v5, 10, v5
    v_and_b32 v6, 3, v1
    v_lshl_add_u32 v5, v6, 4, v5
    s_lshr_b32 s3, s2, 2
    s_lshl_b32 s3, s3, 14
    s_and_b32 s65, s2, 3
    s_lshl_b32 s65, s65, 6
    s_add_u32 s3, s3, s65
    s_add_u32 s3, s3, 6291456
    buffer_load_dwordx4 v[52:55], v5, s[12:15], s3 offen offset:0 sc1
    buffer_load_dwordx4 v[56:59], v5, s[12:15], s3 offen offset:512 sc1
    buffer_load_dwordx4 v[60:63], v5, s[12:15], s3 offen offset:256 sc1
    buffer_load_dwordx4 v[64:67], v5, s[12:15], s3 offen offset:768 sc1
    s_waitcnt vmcnt(0)
    s_branch L_gu
L_guok:
    v_permlane32_swap_b32 v52, v56
    v_permlane32_swap_b32 v54, v58
    v_permlane32_swap_b32 v60, v64
    v_permlane32_swap_b32 v62, v66
    v_add_f32 v52, v52, v56
    v_add_f32 v54, v54, v58
    v_add_f32 v60, v60, v64
    v_add_f32 v62, v62, v66
    v_permlane16_swap_b32 v52, v54
    s_nop 0
    v_permlane16_swap_b32 v60, v62
    v_add_f32 v52, v52, v54
    v_add_f32 v60, v60, v62
    s_nop 0
    v_add_f32 v52, v52, v52 row_ror:4 row_mask:0xf bank_mask:0xf
    v_add_f32 v60, v60, v60 row_ror:4 row_mask:0xf bank_mask:0xf
    s_nop 0
    v_add_f32 v52, v52, v52 row_ror:8 row_mask:0xf bank_mask:0xf
    v_add_f32 v60, v60, v60 row_ror:8 row_mask:0xf bank_mask:0xf
    v_cvt_pk_bf16_f32 v52, v52, v52
    v_lshlrev_b32 v52, 16, v52
    v_cvt_pk_bf16_f32 v60, v60, v60
    v_lshlrev_b32 v60, 16, v60
    v_mul_f32 v53, 0xbfb8aa3b, v52
    v_exp_f32 v53, v53
    s_nop 0
    v_add_f32 v53, 1.0, v53
    v_rcp_f32 v53, v53
    s_nop 0
    v_mul_f32 v52, v52, v53
    v_cvt_pk_bf16_f32 v52, v52, v52
    v_lshlrev_b32 v52, 16, v52
    v_mul_f32 v52, v52, v60
    v_cvt_pk_bf16_f32 v52, v52, v52
    s_nop 1
    v_mov_b32 v80, v52 quad_perm:[0,0,0,0] row_mask:0xf bank_mask:0xf
    v_mov_b32 v81, v52 quad_perm:[1,1,1,1] row_mask:0xf bank_mask:0xf
    v_mov_b32 v82, v52 quad_perm:[2,2,2,2] row_mask:0xf bank_mask:0xf
    v_mov_b32 v83, v52 quad_perm:[3,3,3,3] row_mask:0xf bank_mask:0xf
    s_waitcnt lgkmcnt(0)
    v_and_b32 v92, v80, v88
    v_and_b32 v93, v80, v89
    v_and_b32 v94, v80, v90
    v_and_b32 v95, v80, v91
    s_nop 1
    v_mfma_f32_16x16x32_bf16 v[100:103], v[92:95], v[192:195], 0
    v_mfma_f32_16x16x32_bf16 v[104:107], v[92:95], v[196:199], 0
    v_and_b32 v96, v81, v88
    v_and_b32 v97, v81, v89
    v_and_b32 v98, v81, v90
    v_and_b32 v99, v81, v91
    s_nop 1
    v_mfma_f32_16x16x32_bf16 v[100:103], v[96:99], v[200:203], v[100:103]
    v_mfma_f32_16x16x32_bf16 v[104:107], v[96:99], v[204:207], v[104:107]
    v_and_b32 v92, v82, v88
    v_and_b32 v93, v82, v89
    v_and_b32 v94, v82, v90
    v_and_b32 v95, v82, v91
    s_nop 1
    v_mfma_f32_16x16x32_bf16 v[100:103], v[92:95], v[208:211], v[100:103]
    v_mfma_f32_16x16x32_bf16 v[104:107], v[92:95], v[212:215], v[104:107]
    v_and_b32 v96, v83, v88
    v_and_b32 v97, v83, v89
    v_and_b32 v98, v83, v90
    v_and_b32 v99, v83, v91
    s_nop 1
    v_mfma_f32_16x16x32_bf16 v[100:103], v[96:99], v[216:219], v[100:103]
    v_mfma_f32_16x16x32_bf16 v[104:107], v[96:99], v[220:223], v[104:107]
    v_and_b32 v5, 15, v1
    v_lshlrev_b32 v5, 5, v5
    v_bfe_u32 v6, v1, 4, 1
    v_lshl_add_u32 v5, v6, 4, v5
    v_lshrrev_b32 v6, 5, v1
    v_lshl_add_u32 v5, v6, 9, v5
    v_cmp_eq_u32 vcc, 0, v6
    s_lshl_b32 s3, s2, 12
    s_lshl_b32 s65, s38, 10
    s_add_u32 s3, s3, s65
    s_add_u32 s3, s3, 8388608
    v_cndmask_b32 v100, v104, v100, vcc
    v_cndmask_b32 v101, v105, v101, vcc
    v_cndmask_b32 v102, v106, v102, vcc
    v_cndmask_b32 v103, v107, v103, vcc
    v_mov_b32 v6, 139136
L_yw:
    ds_read_b64 v[8:9], v6
    s_waitcnt lgkmcnt(0)
    v_and_b32 v8, v8, v9
    s_nop 0
    v_readfirstlane_b32 s65, v8
    s_nop 0
    s_cmp_eq_u32 s65, 1
    s_cbranch_scc0 L_yw
    s_cmp_ge_u32 s2, 224
    s_cbranch_scc1 L_noy
    buffer_store_dwordx4 v[100:103], v5, s[12:15], s3 offen sc1
L_noy:
    s_barrier
    s_cmp_eq_u32 s35, 0
    s_cbranch_scc1 L_done
    s_lshl_b32 s65, s38, 2
    v_lshrrev_b32 v5, 4, v1
    v_add_u32 v5, s65, v5
    v_lshlrev_b32 v5, 12, v5
    v_and_b32 v6, 15, v1
    v_lshl_add_u32 v11, v6, 4, v5
    s_mov_b32 s89, 131072
    s_sleep 20
    buffer_load_dwordx4 v[224:227], v3, s[12:15], s89 offen offset:0 sc1
    buffer_load_dwordx4 v[228:231], v3, s[12:15], s89 offen offset:1024 sc1
    s_waitcnt vmcnt(0)
L_clr:
    v_and_b32 v6, v224, v225
    v_or_b32 v7, v224, v225
    v_min3_u32 v6, v6, v226, v227
    v_max3_u32 v7, v7, v226, v227
    v_min3_u32 v6, v6, v228, v229
    v_max3_u32 v7, v7, v228, v229
    v_min3_u32 v6, v6, v230, v231
    v_max3_u32 v7, v7, v230, v231
    v_xor_b32 v6, v6, v18
    v_xor_b32 v7, v7, v18
    v_or_b32 v6, v6, v7
    v_cmp_ne_u32 vcc, 0, v6
    s_nop 0
    s_cmp_eq_u64 vcc, 0
    s_cbranch_scc1 L_clrok
    s_add_u32 s70, s70, 1
    s_cmp_ge_u32 s70, 200000
    s_cbranch_scc1 L_clrok
    s_sleep 8
    buffer_load_dwordx4 v[224:227], v3, s[12:15], s89 offen offset:0 sc1
    buffer_load_dwordx4 v[228:231], v3, s[12:15], s89 offen offset:1024 sc1
    s_waitcnt vmcnt(0)
    s_branch L_clr
L_clrok:
    s_lshl_b32 s3, s31, 8
    s_add_u32 s3, s3, 8388608
    buffer_load_dwordx4 v[128:131], v11, s[12:15], s3 offen sc1
    s_add_u32 s3, s3, 65536
    buffer_load_dwordx4 v[132:135], v11, s[12:15], s3 offen sc1
    s_add_u32 s3, s3, 65536
    buffer_load_dwordx4 v[136:139], v11, s[12:15], s3 offen sc1
    s_add_u32 s3, s3, 65536
    buffer_load_dwordx4 v[140:143], v11, s[12:15], s3 offen sc1
    s_add_u32 s3, s3, 65536
    buffer_load_dwordx4 v[144:147], v11, s[12:15], s3 offen sc1
    s_add_u32 s3, s3, 65536
    buffer_load_dwordx4 v[148:151], v11, s[12:15], s3 offen sc1
    s_add_u32 s3, s3, 65536
    buffer_load_dwordx4 v[152:155], v11, s[12:15], s3 offen sc1
    s_add_u32 s3, s3, 65536
    buffer_load_dwordx4 v[156:159], v11, s[12:15], s3 offen sc1
    s_add_u32 s3, s3, 65536
    buffer_load_dwordx4 v[160:163], v11, s[12:15], s3 offen sc1
    s_add_u32 s3, s3, 65536
    buffer_load_dwordx4 v[164:167], v11, s[12:15], s3 offen sc1
    s_add_u32 s3, s3, 65536
    buffer_load_dwordx4 v[168:171], v11, s[12:15], s3 offen sc1
    s_add_u32 s3, s3, 65536
    buffer_load_dwordx4 v[172:175], v11, s[12:15], s3 offen sc1
    s_add_u32 s3, s3, 65536
    buffer_load_dwordx4 v[176:179], v11, s[12:15], s3 offen sc1
    s_add_u32 s3, s3, 65536
    buffer_load_dwordx4 v[180:183], v11, s[12:15], s3 offen sc1
    s_lshl_b32 s68, s34, 11
    s_lshl_b32 s3, s31, 7
    s_add_u32 s68, s68, s3
    v_lshlrev_b32 v7, 1, v1
    buffer_load_ushort v8, v7, s[4:7], s68 offen
    s_and_b32 s3, s33, 0xfffff800
    s_xor_b32 s65, s3, 0x80000000
    s_not_b32 s66, s3
    s_and_b32 s66, s66, 0xfffff800
    s_bitcmp1_b32 s3, 31
    s_cselect_b32 s3, s65, s66
    v_mov_b32 v5, s3
    v_cvt_pk_bf16_f32 v5, v5, v5
    v_lshlrev_b32 v5, 16, v5
    v_mul_f32 v5, 0xbfb8aa3b, v5
    v_exp_f32 v5, v5
    s_nop 0
    v_add_f32 v5, 1.0, v5
    v_rcp_f32 v5, v5
    s_nop 0
    v_cvt_pk_bf16_f32 v5, v5, v5
    v_lshlrev_b32 v5, 16, v5
    s_lshl_b32 s65, s64, 16
    s_and_b32 s66, s64, 0xffff0000
    v_rcp_f32 v10, s66
    s_nop 0
    v_fma_f32 v4, -v10, s66, 1.0
    v_fmac_f32 v10, v4, v10
    s_waitcnt vmcnt(0)
L_yf:
    v_max_u32 v6, v128, v132
    v_max3_u32 v6, v6, v136, v140
    v_max3_u32 v6, v6, v144, v148
    v_max3_u32 v6, v6, v152, v156
    v_max3_u32 v6, v6, v160, v164
    v_max3_u32 v6, v6, v168, v172
    v_max3_u32 v6, v6, v176, v180
    v_cmp_eq_u32 vcc, -1, v6
    s_nop 1
    v_cndmask_b32 v6, 0, 1, vcc
    v_cmp_ne_u32 vcc, 0, v6
    s_nop 0
    s_cmp_eq_u64 vcc, 0
    s_cbranch_scc1 L_yfok
    s_add_u32 s70, s70, 1
    s_cmp_ge_u32 s70, 200000
    s_cbranch_scc1 L_yfok
    s_sleep 16
    s_lshl_b32 s3, s31, 8
    s_add_u32 s3, s3, 8388608
    buffer_load_dwordx4 v[128:131], v11, s[12:15], s3 offen sc1
    s_add_u32 s3, s3, 65536
    buffer_load_dwordx4 v[132:135], v11, s[12:15], s3 offen sc1
    s_add_u32 s3, s3, 65536
    buffer_load_dwordx4 v[136:139], v11, s[12:15], s3 offen sc1
    s_add_u32 s3, s3, 65536
    buffer_load_dwordx4 v[140:143], v11, s[12:15], s3 offen sc1
    s_add_u32 s3, s3, 65536
    buffer_load_dwordx4 v[144:147], v11, s[12:15], s3 offen sc1
    s_add_u32 s3, s3, 65536
    buffer_load_dwordx4 v[148:151], v11, s[12:15], s3 offen sc1
    s_add_u32 s3, s3, 65536
    buffer_load_dwordx4 v[152:155], v11, s[12:15], s3 offen sc1
    s_add_u32 s3, s3, 65536
    buffer_load_dwordx4 v[156:159], v11, s[12:15], s3 offen sc1
    s_add_u32 s3, s3, 65536
    buffer_load_dwordx4 v[160:163], v11, s[12:15], s3 offen sc1
    s_add_u32 s3, s3, 65536
    buffer_load_dwordx4 v[164:167], v11, s[12:15], s3 offen sc1
    s_add_u32 s3, s3, 65536
    buffer_load_dwordx4 v[168:171], v11, s[12:15], s3 offen sc1
    s_add_u32 s3, s3, 65536
    buffer_load_dwordx4 v[172:175], v11, s[12:15], s3 offen sc1
    s_add_u32 s3, s3, 65536
    buffer_load_dwordx4 v[176:179], v11, s[12:15], s3 offen sc1
    s_add_u32 s3, s3, 65536
    buffer_load_dwordx4 v[180:183], v11, s[12:15], s3 offen sc1
    s_waitcnt vmcnt(0)
    s_branch L_yf
L_yfok:
    v_and_b32 v6, 15, v1
    v_pk_add_f32 v[128:129], v[128:129], v[136:137]
    v_pk_add_f32 v[130:131], v[130:131], v[138:139]
    v_pk_add_f32 v[132:133], v[132:133], v[140:141]
    v_pk_add_f32 v[134:135], v[134:135], v[142:143]
    v_pk_add_f32 v[128:129], v[128:129], v[144:145]
    v_pk_add_f32 v[130:131], v[130:131], v[146:147]
    v_pk_add_f32 v[132:133], v[132:133], v[148:149]
    v_pk_add_f32 v[134:135], v[134:135], v[150:151]
    v_pk_add_f32 v[128:129], v[128:129], v[152:153]
    v_pk_add_f32 v[130:131], v[130:131], v[154:155]
    v_pk_add_f32 v[132:133], v[132:133], v[156:157]
    v_pk_add_f32 v[134:135], v[134:135], v[158:159]
    v_pk_add_f32 v[128:129], v[128:129], v[160:161]
    v_pk_add_f32 v[130:131], v[130:131], v[162:163]
    v_pk_add_f32 v[132:133], v[132:133], v[164:165]
    v_pk_add_f32 v[134:135], v[134:135], v[166:167]
    v_pk_add_f32 v[128:129], v[128:129], v[168:169]
    v_pk_add_f32 v[130:131], v[130:131], v[170:171]
    v_pk_add_f32 v[132:133], v[132:133], v[172:173]
    v_pk_add_f32 v[134:135], v[134:135], v[174:175]
    v_pk_add_f32 v[128:129], v[128:129], v[176:177]
    v_pk_add_f32 v[130:131], v[130:131], v[178:179]
    v_pk_add_f32 v[132:133], v[132:133], v[180:181]
    v_pk_add_f32 v[134:135], v[134:135], v[182:183]
    v_pk_add_f32 v[128:129], v[128:129], v[132:133]
    v_pk_add_f32 v[130:131], v[130:131], v[134:135]
    v_mov_b32 v132, v128
    v_mov_b32 v133, v129
    v_mov_b32 v134, v130
    v_mov_b32 v135, v131
    v_permlane16_swap_b32 v128, v132
    v_permlane16_swap_b32 v129, v133
    v_permlane16_swap_b32 v130, v134
    v_permlane16_swap_b32 v131, v135
    v_pk_add_f32 v[128:129], v[128:129], v[132:133]
    v_pk_add_f32 v[130:131], v[130:131], v[134:135]
    v_mov_b32 v132, v128
    v_mov_b32 v133, v129
    v_mov_b32 v134, v130
    v_mov_b32 v135, v131
    v_permlane32_swap_b32 v128, v132
    v_permlane32_swap_b32 v129, v133
    v_permlane32_swap_b32 v130, v134
    v_permlane32_swap_b32 v131, v135
    v_pk_add_f32 v[128:129], v[128:129], v[132:133]
    v_pk_add_f32 v[130:131], v[130:131], v[134:135]
    s_lshl_b32 s3, s38, 8
    s_add_u32 s3, s3, 139264
    v_lshl_add_u32 v6, v6, 4, s3
    ds_write_b128 v6, v[128:131]
    v_lshlrev_b32 v8, 16, v8
    v_subrev_f32 v9, s65, v8
    v_cvt_pk_bf16_f32 v9, v9, v9
    v_lshlrev_b32 v9, 16, v9
    v_mul_f32 v9, v9, v10
    v_cvt_pk_bf16_f32 v9, v9, v9
    v_lshlrev_b32 v9, 16, v9
    v_lshlrev_b32 v6, 2, v1
    v_add_u32 v6, 139264, v6
    s_waitcnt lgkmcnt(0)
    s_barrier
    s_cmp_lg_u32 s38, 0
    s_cbranch_scc1 L_done
    ds_read_b32 v12, v6 offset:0
    ds_read_b32 v13, v6 offset:256
    ds_read_b32 v14, v6 offset:512
    ds_read_b32 v15, v6 offset:768
    s_and_b32 s3, s34, 127
    s_mul_i32 s3, s3, 144
    s_add_u32 s3, s3, 140800
    v_add_u32 v16, s3, v7
    ds_read_u16 v16, v16
    s_waitcnt lgkmcnt(0)
    v_lshlrev_b32 v16, 16, v16
    v_add_f32 v12, v12, v13
    v_add_f32 v14, v14, v15
    v_add_f32 v12, v12, v14
    v_cvt_pk_bf16_f32 v12, v12, v12
    v_lshlrev_b32 v12, 16, v12
    v_mul_f32 v12, v12, v5
    v_cvt_pk_bf16_f32 v12, v12, v12
    v_lshlrev_b32 v12, 16, v12
    v_add_f32 v12, v12, v9
    v_cvt_pk_bf16_f32 v12, v12, v12
    v_lshlrev_b32 v12, 16, v12
    v_mul_f32 v13, 0xbfb8aa3b, v12
    v_exp_f32 v13, v13
    s_nop 0
    v_add_f32 v13, 1.0, v13
    v_rcp_f32 v13, v13
    s_nop 0
    v_mul_f32 v12, v12, v13
    v_fmac_f32 v8, v12, v16
    v_cvt_pk_bf16_f32 v8, v8, v8
    buffer_store_short v8, v7, s[24:27], s68 offen
L_done:
    s_endpgm
L_g1:
    s_and_b32 s28, s38, 1
    s_lshr_b32 s29, s38, 1
    s_lshl_b32 s3, s36, 7
    s_lshl_b32 s65, s37, 3
    s_add_u32 s3, s3, s65
    s_lshl_b32 s65, s38, 1
    s_add_u32 s68, s3, s65
    s_lshl_b32 s3, s68, 11
    v_and_b32 v3, 31, v1
    v_lshlrev_b32 v3, 4, v3
    v_lshrrev_b32 v4, 5, v1
    v_lshl_add_u32 v5, v4, 11, v3
    s_waitcnt lgkmcnt(0)
    s_mov_b32 s4, s40
    s_mov_b32 s5, s41
    s_mov_b32 s6, 4194304
    s_mov_b32 s7, 0x00020000
    s_mov_b32 s16, s50
    s_mov_b32 s17, s51
    s_mov_b32 s18, 2048
    s_mov_b32 s19, 0x00020000
    buffer_load_dwordx4 v[200:203], v5, s[4:7], s3 offen offset:0
    buffer_load_dwordx4 v[204:207], v5, s[4:7], s3 offen offset:512
    buffer_load_dwordx4 v[208:211], v5, s[4:7], s3 offen offset:1024
    buffer_load_dwordx4 v[212:215], v5, s[4:7], s3 offen offset:1536
    buffer_load_dwordx4 v[216:219], v3, s[16:19], 0 offen offset:0
    buffer_load_dwordx4 v[220:223], v3, s[16:19], 0 offen offset:512
    buffer_load_dwordx4 v[224:227], v3, s[16:19], 0 offen offset:1024
    buffer_load_dwordx4 v[228:231], v3, s[16:19], 0 offen offset:1536
    s_or_b32 s3, s2, s38
    s_cmp_lg_u32 s3, 0
    s_cbranch_scc1 L_nn
    s_mov_b32 s20, s60
    s_mov_b32 s21, s61
    s_mov_b32 s22, 256
    s_mov_b32 s23, 0x00020000
    s_memrealtime s[66:67]
    s_memtime s[70:71]
    s_waitcnt lgkmcnt(0)
    s_lshl_b32 s70, s70, 20
    s_xor_b32 s66, s66, s70
    s_or_b32 s66, s66, 1
    s_and_b32 s66, s66, 0xbfffbfff
    v_mov_b32 v6, s66
    v_mov_b32 v7, 0
    s_mov_b64 exec, 1
    buffer_store_dword v6, v7, s[20:23], 0 offen sc1
    s_mov_b64 exec, -1
L_nn:
    s_getpc_b64 s[66:67]
L_pc:
    s_sub_u32 s66, s66, L_pc-recurrent_scan__linear_kernel_hedgehog__moe_arch_mod__prompt_kernel
    s_subb_u32 s67, s67, 0
    s_lshr_b32 s3, s2, 3
    s_lshl_b32 s3, s3, 2
    s_add_u32 s3, s3, s38
    s_lshl_b32 s3, s3, 6
    s_add_u32 s66, s66, s3
    s_addc_u32 s67, s67, 0
    s_load_dword s71, s[66:67], 0
    s_load_dword s71, s[66:67], 8192
    s_load_dword s71, s[66:67], 16384
    s_load_dword s71, s[66:67], 24576
    s_load_dword s71, s[66:67], 32768
    s_load_dword s71, s[66:67], 40960
    s_mov_b32 s12, s62
    s_mov_b32 s13, s63
    s_mov_b32 s14, 268435456
    s_mov_b32 s15, 0x00020000
    s_and_b32 s30, s2, 7
    s_lshl_b32 s30, s30, 1
    s_bfe_u32 s3, s2, 0x10003
    s_add_u32 s30, s30, s3
    s_lshr_b32 s31, s2, 4
    s_mov_b32 s88, 0
    s_mov_b32 s70, 0
    v_and_b32 v3, 15, v1
    v_lshlrev_b32 v6, 7, v3
    s_lshl_b32 s3, s28, 13
    v_add_u32 v6, s3, v6
    v_lshrrev_b32 v3, 1, v3
    v_lshrrev_b32 v2, 4, v1
    v_xor_b32 v3, v3, v2
    v_lshl_add_u32 v168, v3, 4, v6
    v_xor_b32 v3, 4, v3
    v_lshl_add_u32 v169, v3, 4, v6
    v_lshlrev_b32 v6, 3, v2
    v_bfe_u32 v7, v1, 2, 2
    v_add_u32 v6, v6, v7
    v_lshlrev_b32 v6, 7, v6
    v_and_b32 v7, 3, v1
    v_lshl_add_u32 v6, v7, 3, v6
    v_bfe_u32 v7, v1, 3, 2
    s_lshl_b32 s3, s29, 1
    v_xor_b32 v7, s3, v7
    v_add_u32 v6, 65536, v6
    v_lshl_add_u32 v170, v7, 5, v6
    v_xor_b32 v7, 1, v7
    v_lshl_add_u32 v171, v7, 5, v6
    v_mov_b64 v[8:9], 0
    v_mov_b64 v[10:11], 0
    v_mov_b64 v[12:13], 0
    v_mov_b64 v[14:15], 0
    v_mov_b64 v[16:17], 0
    v_mov_b64 v[18:19], 0
    v_mov_b64 v[20:21], 0
    v_mov_b64 v[22:23], 0
    v_mov_b64 v[24:25], 0
    v_mov_b64 v[26:27], 0
    v_mov_b64 v[28:29], 0
    v_mov_b64 v[30:31], 0
    v_mov_b64 v[32:33], 0
    v_mov_b64 v[34:35], 0
    v_mov_b64 v[36:37], 0
    v_mov_b64 v[38:39], 0
    v_mov_b64 v[40:41], 0
    v_mov_b64 v[42:43], 0
    v_mov_b64 v[44:45], 0
    v_mov_b64 v[46:47], 0
    v_mov_b64 v[48:49], 0
    v_mov_b64 v[50:51], 0
    v_mov_b64 v[52:53], 0
    v_mov_b64 v[54:55], 0
    v_mov_b64 v[56:57], 0
    v_mov_b64 v[58:59], 0
    v_mov_b64 v[60:61], 0
    v_mov_b64 v[62:63], 0
    v_mov_b64 v[64:65], 0
    v_mov_b64 v[66:67], 0
    v_mov_b64 v[68:69], 0
    v_mov_b64 v[70:71], 0
    v_mov_b64 v[72:73], 0
    v_mov_b64 v[74:75], 0
    v_mov_b64 v[76:77], 0
    v_mov_b64 v[78:79], 0
    v_mov_b64 v[80:81], 0
    v_mov_b64 v[82:83], 0
    v_mov_b64 v[84:85], 0
    v_mov_b64 v[86:87], 0
    v_mov_b64 v[88:89], 0
    v_mov_b64 v[90:91], 0
    v_mov_b64 v[92:93], 0
    v_mov_b64 v[94:95], 0
    v_mov_b64 v[96:97], 0
    v_mov_b64 v[98:99], 0
    v_mov_b64 v[100:101], 0
    v_mov_b64 v[102:103], 0
    v_mov_b64 v[136:137], 0
    v_mov_b64 v[138:139], 0
    v_mov_b64 v[140:141], 0
    v_mov_b64 v[142:143], 0
    v_mov_b64 v[144:145], 0
    v_mov_b64 v[146:147], 0
    v_mov_b64 v[148:149], 0
    v_mov_b64 v[150:151], 0
    v_mov_b64 v[152:153], 0
    v_mov_b64 v[154:155], 0
    v_mov_b64 v[156:157], 0
    v_mov_b64 v[158:159], 0
    v_mov_b64 v[160:161], 0
    v_mov_b64 v[162:163], 0
    v_mov_b64 v[164:165], 0
    v_mov_b64 v[166:167], 0
    v_mov_b32 v236, 0x3f803f80
    v_mov_b32 v232, 0
    v_mov_b32 v233, 0
    v_mov_b32 v234, 0
    v_mov_b32 v235, 0
    s_waitcnt vmcnt(0)
    v_dot2_f32_bf16 v232, v200, v236, v232
    v_dot2_f32_bf16 v233, v200, v200, v233
    v_dot2_f32_bf16 v234, v200, v216, v234
    v_dot2_f32_bf16 v235, v216, v236, v235
    v_dot2_f32_bf16 v232, v201, v236, v232
    v_dot2_f32_bf16 v233, v201, v201, v233
    v_dot2_f32_bf16 v234, v201, v217, v234
    v_dot2_f32_bf16 v235, v217, v236, v235
    v_dot2_f32_bf16 v232, v202, v236, v232
    v_dot2_f32_bf16 v233, v202, v202, v233
    v_dot2_f32_bf16 v234, v202, v218, v234
    v_dot2_f32_bf16 v235, v218, v236, v235
    v_dot2_f32_bf16 v232, v203, v236, v232
    v_dot2_f32_bf16 v233, v203, v203, v233
    v_dot2_f32_bf16 v234, v203, v219, v234
    v_dot2_f32_bf16 v235, v219, v236, v235
    v_dot2_f32_bf16 v232, v204, v236, v232
    v_dot2_f32_bf16 v233, v204, v204, v233
    v_dot2_f32_bf16 v234, v204, v220, v234
    v_dot2_f32_bf16 v235, v220, v236, v235
    v_dot2_f32_bf16 v232, v205, v236, v232
    v_dot2_f32_bf16 v233, v205, v205, v233
    v_dot2_f32_bf16 v234, v205, v221, v234
    v_dot2_f32_bf16 v235, v221, v236, v235
    v_dot2_f32_bf16 v232, v206, v236, v232
    v_dot2_f32_bf16 v233, v206, v206, v233
    v_dot2_f32_bf16 v234, v206, v222, v234
    v_dot2_f32_bf16 v235, v222, v236, v235
    v_dot2_f32_bf16 v232, v207, v236, v232
    v_dot2_f32_bf16 v233, v207, v207, v233
    v_dot2_f32_bf16 v234, v207, v223, v234
    v_dot2_f32_bf16 v235, v223, v236, v235
    v_dot2_f32_bf16 v232, v208, v236, v232
    v_dot2_f32_bf16 v233, v208, v208, v233
    v_dot2_f32_bf16 v234, v208, v224, v234
    v_dot2_f32_bf16 v235, v224, v236, v235
    v_dot2_f32_bf16 v232, v209, v236, v232
    v_dot2_f32_bf16 v233, v209, v209, v233
    v_dot2_f32_bf16 v234, v209, v225, v234
    v_dot2_f32_bf16 v235, v225, v236, v235
    v_dot2_f32_bf16 v232, v210, v236, v232
    v_dot2_f32_bf16 v233, v210, v210, v233
    v_dot2_f32_bf16 v234, v210, v226, v234
    v_dot2_f32_bf16 v235, v226, v236, v235
    v_dot2_f32_bf16 v232, v211, v236, v232
    v_dot2_f32_bf16 v233, v211, v211, v233
    v_dot2_f32_bf16 v234, v211, v227, v234
    v_dot2_f32_bf16 v235, v227, v236, v235
    v_dot2_f32_bf16 v232, v212, v236, v232
    v_dot2_f32_bf16 v233, v212, v212, v233
    v_dot2_f32_bf16 v234, v212, v228, v234
    v_dot2_f32_bf16 v235, v228, v236, v235
    v_dot2_f32_bf16 v232, v213, v236, v232
    v_dot2_f32_bf16 v233, v213, v213, v233
    v_dot2_f32_bf16 v234, v213, v229, v234
    v_dot2_f32_bf16 v235, v229, v236, v235
    v_dot2_f32_bf16 v232, v214, v236, v232
    v_dot2_f32_bf16 v233, v214, v214, v233
    v_dot2_f32_bf16 v234, v214, v230, v234
    v_dot2_f32_bf16 v235, v230, v236, v235
    v_dot2_f32_bf16 v232, v215, v236, v232
    v_dot2_f32_bf16 v233, v215, v215, v233
    v_dot2_f32_bf16 v234, v215, v231, v234
    v_dot2_f32_bf16 v235, v231, v236, v235
    v_add_f32 v232, v232, v232 quad_perm:[1,0,3,2] row_mask:0xf bank_mask:0xf
    v_add_f32 v233, v233, v233 quad_perm:[1,0,3,2] row_mask:0xf bank_mask:0xf
    v_add_f32 v234, v234, v234 quad_perm:[1,0,3,2] row_mask:0xf bank_mask:0xf
    v_add_f32 v235, v235, v235 quad_perm:[1,0,3,2] row_mask:0xf bank_mask:0xf
    v_add_f32 v232, v232, v232 quad_perm:[2,3,0,1] row_mask:0xf bank_mask:0xf
    v_add_f32 v233, v233, v233 quad_perm:[2,3,0,1] row_mask:0xf bank_mask:0xf
    v_add_f32 v234, v234, v234 quad_perm:[2,3,0,1] row_mask:0xf bank_mask:0xf
    v_add_f32 v235, v235, v235 quad_perm:[2,3,0,1] row_mask:0xf bank_mask:0xf
    v_add_f32 v232, v232, v232 row_half_mirror row_mask:0xf bank_mask:0xf
    v_add_f32 v233, v233, v233 row_half_mirror row_mask:0xf bank_mask:0xf
    v_add_f32 v234, v234, v234 row_half_mirror row_mask:0xf bank_mask:0xf
    v_add_f32 v235, v235, v235 row_half_mirror row_mask:0xf bank_mask:0xf
    v_add_f32 v232, v232, v232 row_mirror row_mask:0xf bank_mask:0xf
    v_add_f32 v233, v233, v233 row_mirror row_mask:0xf bank_mask:0xf
    v_add_f32 v234, v234, v234 row_mirror row_mask:0xf bank_mask:0xf
    v_add_f32 v235, v235, v235 row_mirror row_mask:0xf bank_mask:0xf
    v_mov_b32 v236, v232
    v_mov_b32 v237, v233
    v_mov_b32 v238, v234
    v_mov_b32 v239, v235
    v_permlane16_swap_b32 v232, v236
    v_permlane16_swap_b32 v233, v237
    v_permlane16_swap_b32 v234, v238
    v_permlane16_swap_b32 v235, v239
    v_add_f32 v232, v232, v236
    v_add_f32 v233, v233, v237
    v_add_f32 v234, v234, v238
    v_add_f32 v235, v235, v239
    v_mul_f32 v232, 0x3a800000, v232
    v_mul_f32 v233, 0x3a800000, v233
    v_fma_f32 v233, -v232, v232, v233
    v_max_f32 v233, 0, v233
    v_cvt_pk_bf16_f32 v232, v232, v232
    v_lshlrev_b32 v232, 16, v232
    v_cvt_pk_bf16_f32 v233, v233, v233
    v_lshlrev_b32 v233, 16, v233
    v_add_f32 v233, 0x3727c5ac, v233
    v_cvt_pk_bf16_f32 v233, v233, v233
    v_lshlrev_b32 v233, 16, v233
    v_sqrt_f32 v233, v233
    v_fma_f32 v234, -v232, v235, v234
    v_cvt_pk_bf16_f32 v233, v233, v233
    v_lshlrev_b32 v233, 16, v233
    v_rcp_f32 v235, v233
    v_lshrrev_b32 v232, 16, v232
    v_or_b32 v232, v232, v233
    v_mul_f32 v234, v234, v235
    v_ashrrev_i32 v235, 31, v234
    v_or_b32 v235, 0x80000000, v235
    v_xor_b32 v234, v234, v235
    v_and_b32 v234, 0xfffff800, v234
    s_sub_u32 s3, 2047, s68
    v_sub_u32 v235, s3, v4
    v_or_b32 v233, v234, v235
    s_lshl_b32 s3, s38, 4
    s_add_u32 s3, s3, 139008
    v_lshl_add_u32 v235, v4, 3, s3
    ds_write_b64 v235, v[232:233]
    s_mov_b32 s69, 0
.p2align 6
L_c1:
    s_waitcnt lgkmcnt(0)
    s_barrier
    v_mfma_f32_16x16x32_bf16 v[8:11], v[152:155], v[136:139], v[8:11]
    ds_read_b128 v[104:107], v168 offset:0
    v_mfma_f32_16x16x32_bf16 v[12:15], v[156:159], v[136:139], v[12:15]
    ds_read_b64_tr_b16 v[120:121], v170 offset:0
    v_mfma_f32_16x16x32_bf16 v[16:19], v[136:139], v[160:163], v[16:19]
    ds_read_b64_tr_b16 v[122:123], v170 offset:512
    v_mfma_f32_16x16x32_bf16 v[20:23], v[136:139], v[164:167], v[20:23]
    ds_read_b64_tr_b16 v[124:125], v171 offset:0
    v_mfma_f32_16x16x32_bf16 v[24:27], v[152:155], v[140:143], v[24:27]
    ds_read_b64_tr_b16 v[126:127], v171 offset:512
    v_mfma_f32_16x16x32_bf16 v[28:31], v[156:159], v[140:143], v[28:31]
    ds_read_b128 v[108:111], v168 offset:2048
    v_mfma_f32_16x16x32_bf16 v[32:35], v[140:143], v[160:163], v[32:35]
    ds_read_b64_tr_b16 v[128:129], v170 offset:8192
    v_mfma_f32_16x16x32_bf16 v[36:39], v[140:143], v[164:167], v[36:39]
    ds_read_b64_tr_b16 v[130:131], v170 offset:8704
    v_mfma_f32_16x16x32_bf16 v[40:43], v[152:155], v[144:147], v[40:43]
    ds_read_b64_tr_b16 v[132:133], v171 offset:8192
    v_mfma_f32_16x16x32_bf16 v[44:47], v[156:159], v[144:147], v[44:47]
    ds_read_b64_tr_b16 v[134:135], v171 offset:8704
    v_mfma_f32_16x16x32_bf16 v[48:51], v[144:147], v[160:163], v[48:51]
    ds_read_b128 v[112:115], v168 offset:4096
    v_mfma_f32_16x16x32_bf16 v[52:55], v[144:147], v[164:167], v[52:55]
    ds_read_b128 v[116:119], v168 offset:6144
    v_mfma_f32_16x16x32_bf16 v[56:59], v[152:155], v[148:151], v[56:59]
    v_mfma_f32_16x16x32_bf16 v[60:63], v[156:159], v[148:151], v[60:63]
    v_mfma_f32_16x16x32_bf16 v[64:67], v[148:151], v[160:163], v[64:67]
    v_mfma_f32_16x16x32_bf16 v[68:71], v[148:151], v[164:167], v[68:71]
    s_waitcnt lgkmcnt(0)
    v_mfma_f32_16x16x32_bf16 v[8:11], v[120:123], v[104:107], v[8:11]
    ds_read_b128 v[136:139], v169 offset:0
    v_mfma_f32_16x16x32_bf16 v[12:15], v[124:127], v[104:107], v[12:15]
    ds_read_b64_tr_b16 v[152:153], v170 offset:4096
    v_mfma_f32_16x16x32_bf16 v[16:19], v[104:107], v[128:131], v[16:19]
    ds_read_b64_tr_b16 v[154:155], v170 offset:4608
    v_mfma_f32_16x16x32_bf16 v[20:23], v[104:107], v[132:135], v[20:23]
    ds_read_b64_tr_b16 v[156:157], v171 offset:4096
    v_mfma_f32_16x16x32_bf16 v[24:27], v[120:123], v[108:111], v[24:27]
    ds_read_b64_tr_b16 v[158:159], v171 offset:4608
    v_mfma_f32_16x16x32_bf16 v[28:31], v[124:127], v[108:111], v[28:31]
    ds_read_b128 v[140:143], v169 offset:2048
    v_mfma_f32_16x16x32_bf16 v[32:35], v[108:111], v[128:131], v[32:35]
    ds_read_b64_tr_b16 v[160:161], v170 offset:12288
    v_mfma_f32_16x16x32_bf16 v[36:39], v[108:111], v[132:135], v[36:39]
    ds_read_b64_tr_b16 v[162:163], v170 offset:12800
    v_mfma_f32_16x16x32_bf16 v[40:43], v[120:123], v[112:115], v[40:43]
    ds_read_b64_tr_b16 v[164:165], v171 offset:12288
    v_mfma_f32_16x16x32_bf16 v[44:47], v[124:127], v[112:115], v[44:47]
    ds_read_b64_tr_b16 v[166:167], v171 offset:12800
    v_mfma_f32_16x16x32_bf16 v[48:51], v[112:115], v[128:131], v[48:51]
    ds_read_b128 v[144:147], v169 offset:4096
    v_mfma_f32_16x16x32_bf16 v[52:55], v[112:115], v[132:135], v[52:55]
    ds_read_b128 v[148:151], v169 offset:6144
    v_mfma_f32_16x16x32_bf16 v[56:59], v[120:123], v[116:119], v[56:59]
    v_mfma_f32_16x16x32_bf16 v[60:63], v[124:127], v[116:119], v[60:63]
    v_mfma_f32_16x16x32_bf16 v[64:67], v[116:119], v[128:131], v[64:67]
    v_mfma_f32_16x16x32_bf16 v[68:71], v[116:119], v[132:135], v[68:71]
    s_waitcnt lgkmcnt(0)
    s_barrier
    v_mfma_f32_16x16x32_bf16 v[8:11], v[152:155], v[136:139], v[8:11]
    ds_read_b128 v[104:107], v168 offset:16384
    v_mfma_f32_16x16x32_bf16 v[12:15], v[156:159], v[136:139], v[12:15]
    ds_read_b64_tr_b16 v[120:121], v170 offset:16384
    v_mfma_f32_16x16x32_bf16 v[16:19], v[136:139], v[160:163], v[16:19]
    ds_read_b64_tr_b16 v[122:123], v170 offset:16896
    v_mfma_f32_16x16x32_bf16 v[20:23], v[136:139], v[164:167], v[20:23]
    ds_read_b64_tr_b16 v[124:125], v171 offset:16384
    v_mfma_f32_16x16x32_bf16 v[24:27], v[152:155], v[140:143], v[24:27]
    ds_read_b64_tr_b16 v[126:127], v171 offset:16896
    v_mfma_f32_16x16x32_bf16 v[28:31], v[156:159], v[140:143], v[28:31]
    ds_read_b128 v[108:111], v168 offset:18432
    v_mfma_f32_16x16x32_bf16 v[32:35], v[140:143], v[160:163], v[32:35]
    ds_read_b64_tr_b16 v[128:129], v170 offset:24576
    v_mfma_f32_16x16x32_bf16 v[36:39], v[140:143], v[164:167], v[36:39]
    ds_read_b64_tr_b16 v[130:131], v170 offset:25088
    v_mfma_f32_16x16x32_bf16 v[40:43], v[152:155], v[144:147], v[40:43]
    ds_read_b64_tr_b16 v[132:133], v171 offset:24576
    v_mfma_f32_16x16x32_bf16 v[44:47], v[156:159], v[144:147], v[44:47]
    ds_read_b64_tr_b16 v[134:135], v171 offset:25088
    v_mfma_f32_16x16x32_bf16 v[48:51], v[144:147], v[160:163], v[48:51]
    ds_read_b128 v[112:115], v168 offset:20480
    v_mfma_f32_16x16x32_bf16 v[52:55], v[144:147], v[164:167], v[52:55]
    ds_read_b128 v[116:119], v168 offset:22528
    v_mfma_f32_16x16x32_bf16 v[56:59], v[152:155], v[148:151], v[56:59]
    v_mfma_f32_16x16x32_bf16 v[60:63], v[156:159], v[148:151], v[60:63]
    v_mfma_f32_16x16x32_bf16 v[64:67], v[148:151], v[160:163], v[64:67]
    v_mfma_f32_16x16x32_bf16 v[68:71], v[148:151], v[164:167], v[68:71]
    s_waitcnt lgkmcnt(0)
    v_mfma_f32_16x16x32_bf16 v[8:11], v[120:123], v[104:107], v[8:11]
    ds_read_b128 v[136:139], v169 offset:16384
    v_mfma_f32_16x16x32_bf16 v[12:15], v[124:127], v[104:107], v[12:15]
    ds_read_b64_tr_b16 v[152:153], v170 offset:20480
    v_mfma_f32_16x16x32_bf16 v[16:19], v[104:107], v[128:131], v[16:19]
    ds_read_b64_tr_b16 v[154:155], v170 offset:20992
    v_mfma_f32_16x16x32_bf16 v[20:23], v[104:107], v[132:135], v[20:23]
    ds_read_b64_tr_b16 v[156:157], v171 offset:20480
    v_mfma_f32_16x16x32_bf16 v[24:27], v[120:123], v[108:111], v[24:27]
    ds_read_b64_tr_b16 v[158:159], v171 offset:20992
    v_mfma_f32_16x16x32_bf16 v[28:31], v[124:127], v[108:111], v[28:31]
    ds_read_b128 v[140:143], v169 offset:18432
    v_mfma_f32_16x16x32_bf16 v[32:35], v[108:111], v[128:131], v[32:35]
    ds_read_b64_tr_b16 v[160:161], v170 offset:28672
    v_mfma_f32_16x16x32_bf16 v[36:39], v[108:111], v[132:135], v[36:39]
    ds_read_b64_tr_b16 v[162:163], v170 offset:29184
    v_mfma_f32_16x16x32_bf16 v[40:43], v[120:123], v[112:115], v[40:43]
    ds_read_b64_tr_b16 v[164:165], v171 offset:28672
    v_mfma_f32_16x16x32_bf16 v[44:47], v[124:127], v[112:115], v[44:47]
    ds_read_b64_tr_b16 v[166:167], v171 offset:29184
    v_mfma_f32_16x16x32_bf16 v[48:51], v[112:115], v[128:131], v[48:51]
    ds_read_b128 v[144:147], v169 offset:20480
    v_mfma_f32_16x16x32_bf16 v[52:55], v[112:115], v[132:135], v[52:55]
    ds_read_b128 v[148:151], v169 offset:22528
    v_mfma_f32_16x16x32_bf16 v[56:59], v[120:123], v[116:119], v[56:59]
    v_mfma_f32_16x16x32_bf16 v[60:63], v[124:127], v[116:119], v[60:63]
    v_mfma_f32_16x16x32_bf16 v[64:67], v[116:119], v[128:131], v[64:67]
    v_mfma_f32_16x16x32_bf16 v[68:71], v[116:119], v[132:135], v[68:71]
    s_waitcnt lgkmcnt(0)
    s_barrier
    v_mfma_f32_16x16x32_bf16 v[8:11], v[152:155], v[136:139], v[8:11]
    ds_read_b128 v[104:107], v168 offset:32768
    v_mfma_f32_16x16x32_bf16 v[12:15], v[156:159], v[136:139], v[12:15]
    ds_read_b64_tr_b16 v[120:121], v170 offset:32768
    v_mfma_f32_16x16x32_bf16 v[16:19], v[136:139], v[160:163], v[16:19]
    ds_read_b64_tr_b16 v[122:123], v170 offset:33280
    v_mfma_f32_16x16x32_bf16 v[20:23], v[136:139], v[164:167], v[20:23]
    ds_read_b64_tr_b16 v[124:125], v171 offset:32768
    v_mfma_f32_16x16x32_bf16 v[24:27], v[152:155], v[140:143], v[24:27]
    ds_read_b64_tr_b16 v[126:127], v171 offset:33280
    v_mfma_f32_16x16x32_bf16 v[28:31], v[156:159], v[140:143], v[28:31]
    ds_read_b128 v[108:111], v168 offset:34816
    v_mfma_f32_16x16x32_bf16 v[32:35], v[140:143], v[160:163], v[32:35]
    ds_read_b64_tr_b16 v[128:129], v170 offset:40960
    v_mfma_f32_16x16x32_bf16 v[36:39], v[140:143], v[164:167], v[36:39]
    ds_read_b64_tr_b16 v[130:131], v170 offset:41472
    v_mfma_f32_16x16x32_bf16 v[40:43], v[152:155], v[144:147], v[40:43]
    ds_read_b64_tr_b16 v[132:133], v171 offset:40960
    v_mfma_f32_16x16x32_bf16 v[44:47], v[156:159], v[144:147], v[44:47]
    ds_read_b64_tr_b16 v[134:135], v171 offset:41472
    v_mfma_f32_16x16x32_bf16 v[48:51], v[144:147], v[160:163], v[48:51]
    ds_read_b128 v[112:115], v168 offset:36864
    v_mfma_f32_16x16x32_bf16 v[52:55], v[144:147], v[164:167], v[52:55]
    ds_read_b128 v[116:119], v168 offset:38912
    v_mfma_f32_16x16x32_bf16 v[56:59], v[152:155], v[148:151], v[56:59]
    v_mfma_f32_16x16x32_bf16 v[60:63], v[156:159], v[148:151], v[60:63]
    v_mfma_f32_16x16x32_bf16 v[64:67], v[148:151], v[160:163], v[64:67]
    v_mfma_f32_16x16x32_bf16 v[68:71], v[148:151], v[164:167], v[68:71]
    s_waitcnt lgkmcnt(0)
    v_mfma_f32_16x16x32_bf16 v[8:11], v[120:123], v[104:107], v[8:11]
    ds_read_b128 v[136:139], v169 offset:32768
    v_mfma_f32_16x16x32_bf16 v[12:15], v[124:127], v[104:107], v[12:15]
    ds_read_b64_tr_b16 v[152:153], v170 offset:36864
    v_mfma_f32_16x16x32_bf16 v[16:19], v[104:107], v[128:131], v[16:19]
    ds_read_b64_tr_b16 v[154:155], v170 offset:37376
    v_mfma_f32_16x16x32_bf16 v[20:23], v[104:107], v[132:135], v[20:23]
    ds_read_b64_tr_b16 v[156:157], v171 offset:36864
    v_mfma_f32_16x16x32_bf16 v[24:27], v[120:123], v[108:111], v[24:27]
    ds_read_b64_tr_b16 v[158:159], v171 offset:37376
    v_mfma_f32_16x16x32_bf16 v[28:31], v[124:127], v[108:111], v[28:31]
    ds_read_b128 v[140:143], v169 offset:34816
    v_mfma_f32_16x16x32_bf16 v[32:35], v[108:111], v[128:131], v[32:35]
    ds_read_b64_tr_b16 v[160:161], v170 offset:45056
    v_mfma_f32_16x16x32_bf16 v[36:39], v[108:111], v[132:135], v[36:39]
    ds_read_b64_tr_b16 v[162:163], v170 offset:45568
    v_mfma_f32_16x16x32_bf16 v[40:43], v[120:123], v[112:115], v[40:43]
    ds_read_b64_tr_b16 v[164:165], v171 offset:45056
    v_mfma_f32_16x16x32_bf16 v[44:47], v[124:127], v[112:115], v[44:47]
    ds_read_b64_tr_b16 v[166:167], v171 offset:45568
    v_mfma_f32_16x16x32_bf16 v[48:51], v[112:115], v[128:131], v[48:51]
    ds_read_b128 v[144:147], v169 offset:36864
    v_mfma_f32_16x16x32_bf16 v[52:55], v[112:115], v[132:135], v[52:55]
    ds_read_b128 v[148:151], v169 offset:38912
    v_mfma_f32_16x16x32_bf16 v[56:59], v[120:123], v[116:119], v[56:59]
    v_mfma_f32_16x16x32_bf16 v[60:63], v[124:127], v[116:119], v[60:63]
    v_mfma_f32_16x16x32_bf16 v[64:67], v[116:119], v[128:131], v[64:67]
    v_mfma_f32_16x16x32_bf16 v[68:71], v[116:119], v[132:135], v[68:71]
    s_waitcnt lgkmcnt(0)
    s_barrier
    v_mfma_f32_16x16x32_bf16 v[8:11], v[152:155], v[136:139], v[8:11]
    ds_read_b128 v[104:107], v168 offset:49152
    v_mfma_f32_16x16x32_bf16 v[12:15], v[156:159], v[136:139], v[12:15]
    ds_read_b64_tr_b16 v[120:121], v170 offset:49152
    v_mfma_f32_16x16x32_bf16 v[16:19], v[136:139], v[160:163], v[16:19]
    ds_read_b64_tr_b16 v[122:123], v170 offset:49664
    v_mfma_f32_16x16x32_bf16 v[20:23], v[136:139], v[164:167], v[20:23]
    ds_read_b64_tr_b16 v[124:125], v171 offset:49152
    v_mfma_f32_16x16x32_bf16 v[24:27], v[152:155], v[140:143], v[24:27]
    ds_read_b64_tr_b16 v[126:127], v171 offset:49664
    v_mfma_f32_16x16x32_bf16 v[28:31], v[156:159], v[140:143], v[28:31]
    ds_read_b128 v[108:111], v168 offset:51200
    v_mfma_f32_16x16x32_bf16 v[32:35], v[140:143], v[160:163], v[32:35]
    ds_read_b64_tr_b16 v[128:129], v170 offset:57344
    v_mfma_f32_16x16x32_bf16 v[36:39], v[140:143], v[164:167], v[36:39]
    ds_read_b64_tr_b16 v[130:131], v170 offset:57856
    v_mfma_f32_16x16x32_bf16 v[40:43], v[152:155], v[144:147], v[40:43]
    ds_read_b64_tr_b16 v[132:133], v171 offset:57344
    v_mfma_f32_16x16x32_bf16 v[44:47], v[156:159], v[144:147], v[44:47]
    ds_read_b64_tr_b16 v[134:135], v171 offset:57856
    v_mfma_f32_16x16x32_bf16 v[48:51], v[144:147], v[160:163], v[48:51]
    ds_read_b128 v[112:115], v168 offset:53248
    v_mfma_f32_16x16x32_bf16 v[52:55], v[144:147], v[164:167], v[52:55]
    ds_read_b128 v[116:119], v168 offset:55296
    v_mfma_f32_16x16x32_bf16 v[56:59], v[152:155], v[148:151], v[56:59]
    v_mfma_f32_16x16x32_bf16 v[60:63], v[156:159], v[148:151], v[60:63]
    v_mfma_f32_16x16x32_bf16 v[64:67], v[148:151], v[160:163], v[64:67]
    v_mfma_f32_16x16x32_bf16 v[68:71], v[148:151], v[164:167], v[68:71]
    s_waitcnt lgkmcnt(0)
    v_mfma_f32_16x16x32_bf16 v[8:11], v[120:123], v[104:107], v[8:11]
    ds_read_b128 v[136:139], v169 offset:49152
    v_mfma_f32_16x16x32_bf16 v[12:15], v[124:127], v[104:107], v[12:15]
    ds_read_b64_tr_b16 v[152:153], v170 offset:53248
    v_mfma_f32_16x16x32_bf16 v[16:19], v[104:107], v[128:131], v[16:19]
    ds_read_b64_tr_b16 v[154:155], v170 offset:53760
    v_mfma_f32_16x16x32_bf16 v[20:23], v[104:107], v[132:135], v[20:23]
    ds_read_b64_tr_b16 v[156:157], v171 offset:53248
    v_mfma_f32_16x16x32_bf16 v[24:27], v[120:123], v[108:111], v[24:27]
    ds_read_b64_tr_b16 v[158:159], v171 offset:53760
    v_mfma_f32_16x16x32_bf16 v[28:31], v[124:127], v[108:111], v[28:31]
    ds_read_b128 v[140:143], v169 offset:51200
    v_mfma_f32_16x16x32_bf16 v[32:35], v[108:111], v[128:131], v[32:35]
    ds_read_b64_tr_b16 v[160:161], v170 offset:61440
    v_mfma_f32_16x16x32_bf16 v[36:39], v[108:111], v[132:135], v[36:39]
    ds_read_b64_tr_b16 v[162:163], v170 offset:61952
    v_mfma_f32_16x16x32_bf16 v[40:43], v[120:123], v[112:115], v[40:43]
    ds_read_b64_tr_b16 v[164:165], v171 offset:61440
    v_mfma_f32_16x16x32_bf16 v[44:47], v[124:127], v[112:115], v[44:47]
    ds_read_b64_tr_b16 v[166:167], v171 offset:61952
    v_mfma_f32_16x16x32_bf16 v[48:51], v[112:115], v[128:131], v[48:51]
    ds_read_b128 v[144:147], v169 offset:53248
    v_mfma_f32_16x16x32_bf16 v[52:55], v[112:115], v[132:135], v[52:55]
    ds_read_b128 v[148:151], v169 offset:55296
    v_mfma_f32_16x16x32_bf16 v[56:59], v[120:123], v[116:119], v[56:59]
    v_mfma_f32_16x16x32_bf16 v[60:63], v[124:127], v[116:119], v[60:63]
    v_mfma_f32_16x16x32_bf16 v[64:67], v[116:119], v[128:131], v[64:67]
    v_mfma_f32_16x16x32_bf16 v[68:71], v[116:119], v[132:135], v[68:71]
    s_add_u32 s69, s69, 1
    s_cmp_lt_u32 s69, 3
    s_cbranch_scc1 L_c1
    s_waitcnt lgkmcnt(0)
    s_barrier
    v_mfma_f32_16x16x32_bf16 v[8:11], v[152:155], v[136:139], v[8:11]
    ds_read_b128 v[104:107], v168 offset:0
    v_mfma_f32_16x16x32_bf16 v[12:15], v[156:159], v[136:139], v[12:15]
    ds_read_b64_tr_b16 v[120:121], v170 offset:0
    v_mfma_f32_16x16x32_bf16 v[16:19], v[136:139], v[160:163], v[16:19]
    ds_read_b64_tr_b16 v[122:123], v170 offset:512
    v_mfma_f32_16x16x32_bf16 v[20:23], v[136:139], v[164:167], v[20:23]
    ds_read_b64_tr_b16 v[124:125], v171 offset:0
    v_mfma_f32_16x16x32_bf16 v[24:27], v[152:155], v[140:143], v[24:27]
    ds_read_b64_tr_b16 v[126:127], v171 offset:512
    v_mfma_f32_16x16x32_bf16 v[28:31], v[156:159], v[140:143], v[28:31]
    ds_read_b128 v[108:111], v168 offset:2048
    v_mfma_f32_16x16x32_bf16 v[32:35], v[140:143], v[160:163], v[32:35]
    ds_read_b64_tr_b16 v[128:129], v170 offset:8192
    v_mfma_f32_16x16x32_bf16 v[36:39], v[140:143], v[164:167], v[36:39]
    ds_read_b64_tr_b16 v[130:131], v170 offset:8704
    v_mfma_f32_16x16x32_bf16 v[40:43], v[152:155], v[144:147], v[40:43]
    ds_read_b64_tr_b16 v[132:133], v171 offset:8192
    v_mfma_f32_16x16x32_bf16 v[44:47], v[156:159], v[144:147], v[44:47]
    ds_read_b64_tr_b16 v[134:135], v171 offset:8704
    v_mfma_f32_16x16x32_bf16 v[48:51], v[144:147], v[160:163], v[48:51]
    ds_read_b128 v[112:115], v168 offset:4096
    v_mfma_f32_16x16x32_bf16 v[52:55], v[144:147], v[164:167], v[52:55]
    ds_read_b128 v[116:119], v168 offset:6144
    v_mfma_f32_16x16x32_bf16 v[56:59], v[152:155], v[148:151], v[56:59]
    v_mfma_f32_16x16x32_bf16 v[60:63], v[156:159], v[148:151], v[60:63]
    v_mfma_f32_16x16x32_bf16 v[64:67], v[148:151], v[160:163], v[64:67]
    v_mfma_f32_16x16x32_bf16 v[68:71], v[148:151], v[164:167], v[68:71]
    s_waitcnt lgkmcnt(0)
    v_mfma_f32_16x16x32_bf16 v[8:11], v[120:123], v[104:107], v[8:11]
    ds_read_b128 v[136:139], v169 offset:0
    v_mfma_f32_16x16x32_bf16 v[12:15], v[124:127], v[104:107], v[12:15]
    ds_read_b64_tr_b16 v[152:153], v170 offset:4096
    v_mfma_f32_16x16x32_bf16 v[16:19], v[104:107], v[128:131], v[16:19]
    ds_read_b64_tr_b16 v[154:155], v170 offset:4608
    v_mfma_f32_16x16x32_bf16 v[20:23], v[104:107], v[132:135], v[20:23]
    ds_read_b64_tr_b16 v[156:157], v171 offset:4096
    v_mfma_f32_16x16x32_bf16 v[24:27], v[120:123], v[108:111], v[24:27]
    ds_read_b64_tr_b16 v[158:159], v171 offset:4608
    v_mfma_f32_16x16x32_bf16 v[28:31], v[124:127], v[108:111], v[28:31]
    ds_read_b128 v[140:143], v169 offset:2048
    v_mfma_f32_16x16x32_bf16 v[32:35], v[108:111], v[128:131], v[32:35]
    ds_read_b64_tr_b16 v[160:161], v170 offset:12288
    v_mfma_f32_16x16x32_bf16 v[36:39], v[108:111], v[132:135], v[36:39]
    ds_read_b64_tr_b16 v[162:163], v170 offset:12800
    v_mfma_f32_16x16x32_bf16 v[40:43], v[120:123], v[112:115], v[40:43]
    ds_read_b64_tr_b16 v[164:165], v171 offset:12288
    v_mfma_f32_16x16x32_bf16 v[44:47], v[124:127], v[112:115], v[44:47]
    ds_read_b64_tr_b16 v[166:167], v171 offset:12800
    v_mfma_f32_16x16x32_bf16 v[48:51], v[112:115], v[128:131], v[48:51]
    ds_read_b128 v[144:147], v169 offset:4096
    v_mfma_f32_16x16x32_bf16 v[52:55], v[112:115], v[132:135], v[52:55]
    ds_read_b128 v[148:151], v169 offset:6144
    v_mfma_f32_16x16x32_bf16 v[56:59], v[120:123], v[116:119], v[56:59]
    v_mfma_f32_16x16x32_bf16 v[60:63], v[124:127], v[116:119], v[60:63]
    v_mfma_f32_16x16x32_bf16 v[64:67], v[116:119], v[128:131], v[64:67]
    v_mfma_f32_16x16x32_bf16 v[68:71], v[116:119], v[132:135], v[68:71]
    s_waitcnt lgkmcnt(0)
    s_barrier
    v_mfma_f32_16x16x32_bf16 v[8:11], v[152:155], v[136:139], v[8:11]
    ds_read_b128 v[104:107], v168 offset:16384
    v_mfma_f32_16x16x32_bf16 v[12:15], v[156:159], v[136:139], v[12:15]
    ds_read_b64_tr_b16 v[120:121], v170 offset:16384
    v_mfma_f32_16x16x32_bf16 v[16:19], v[136:139], v[160:163], v[16:19]
    ds_read_b64_tr_b16 v[122:123], v170 offset:16896
    v_mfma_f32_16x16x32_bf16 v[20:23], v[136:139], v[164:167], v[20:23]
    ds_read_b64_tr_b16 v[124:125], v171 offset:16384
    v_mfma_f32_16x16x32_bf16 v[24:27], v[152:155], v[140:143], v[24:27]
    ds_read_b64_tr_b16 v[126:127], v171 offset:16896
    v_mfma_f32_16x16x32_bf16 v[28:31], v[156:159], v[140:143], v[28:31]
    ds_read_b128 v[108:111], v168 offset:18432
    v_mfma_f32_16x16x32_bf16 v[32:35], v[140:143], v[160:163], v[32:35]
    ds_read_b64_tr_b16 v[128:129], v170 offset:24576
    v_mfma_f32_16x16x32_bf16 v[36:39], v[140:143], v[164:167], v[36:39]
    ds_read_b64_tr_b16 v[130:131], v170 offset:25088
    v_mfma_f32_16x16x32_bf16 v[40:43], v[152:155], v[144:147], v[40:43]
    ds_read_b64_tr_b16 v[132:133], v171 offset:24576
    v_mfma_f32_16x16x32_bf16 v[44:47], v[156:159], v[144:147], v[44:47]
    ds_read_b64_tr_b16 v[134:135], v171 offset:25088
    v_mfma_f32_16x16x32_bf16 v[48:51], v[144:147], v[160:163], v[48:51]
    ds_read_b128 v[112:115], v168 offset:20480
    v_mfma_f32_16x16x32_bf16 v[52:55], v[144:147], v[164:167], v[52:55]
    ds_read_b128 v[116:119], v168 offset:22528
    v_mfma_f32_16x16x32_bf16 v[56:59], v[152:155], v[148:151], v[56:59]
    v_mfma_f32_16x16x32_bf16 v[60:63], v[156:159], v[148:151], v[60:63]
    v_mfma_f32_16x16x32_bf16 v[64:67], v[148:151], v[160:163], v[64:67]
    v_mfma_f32_16x16x32_bf16 v[68:71], v[148:151], v[164:167], v[68:71]
    s_waitcnt lgkmcnt(0)
    v_mfma_f32_16x16x32_bf16 v[8:11], v[120:123], v[104:107], v[8:11]
    ds_read_b128 v[136:139], v169 offset:16384
    v_mfma_f32_16x16x32_bf16 v[12:15], v[124:127], v[104:107], v[12:15]
    ds_read_b64_tr_b16 v[152:153], v170 offset:20480
    v_mfma_f32_16x16x32_bf16 v[16:19], v[104:107], v[128:131], v[16:19]
    ds_read_b64_tr_b16 v[154:155], v170 offset:20992
    v_mfma_f32_16x16x32_bf16 v[20:23], v[104:107], v[132:135], v[20:23]
    ds_read_b64_tr_b16 v[156:157], v171 offset:20480
    v_mfma_f32_16x16x32_bf16 v[24:27], v[120:123], v[108:111], v[24:27]
    ds_read_b64_tr_b16 v[158:159], v171 offset:20992
    v_mfma_f32_16x16x32_bf16 v[28:31], v[124:127], v[108:111], v[28:31]
    ds_read_b128 v[140:143], v169 offset:18432
    v_mfma_f32_16x16x32_bf16 v[32:35], v[108:111], v[128:131], v[32:35]
    ds_read_b64_tr_b16 v[160:161], v170 offset:28672
    v_mfma_f32_16x16x32_bf16 v[36:39], v[108:111], v[132:135], v[36:39]
    ds_read_b64_tr_b16 v[162:163], v170 offset:29184
    v_mfma_f32_16x16x32_bf16 v[40:43], v[120:123], v[112:115], v[40:43]
    ds_read_b64_tr_b16 v[164:165], v171 offset:28672
    v_mfma_f32_16x16x32_bf16 v[44:47], v[124:127], v[112:115], v[44:47]
    ds_read_b64_tr_b16 v[166:167], v171 offset:29184
    v_mfma_f32_16x16x32_bf16 v[48:51], v[112:115], v[128:131], v[48:51]
    ds_read_b128 v[144:147], v169 offset:20480
    v_mfma_f32_16x16x32_bf16 v[52:55], v[112:115], v[132:135], v[52:55]
    ds_read_b128 v[148:151], v169 offset:22528
    v_mfma_f32_16x16x32_bf16 v[56:59], v[120:123], v[116:119], v[56:59]
    v_mfma_f32_16x16x32_bf16 v[60:63], v[124:127], v[116:119], v[60:63]
    v_mfma_f32_16x16x32_bf16 v[64:67], v[116:119], v[128:131], v[64:67]
    v_mfma_f32_16x16x32_bf16 v[68:71], v[116:119], v[132:135], v[68:71]
    s_waitcnt lgkmcnt(0)
    s_barrier
    v_mfma_f32_16x16x32_bf16 v[8:11], v[152:155], v[136:139], v[8:11]
    ds_read_b128 v[104:107], v168 offset:32768
    v_mfma_f32_16x16x32_bf16 v[12:15], v[156:159], v[136:139], v[12:15]
    ds_read_b64_tr_b16 v[120:121], v170 offset:32768
    v_mfma_f32_16x16x32_bf16 v[16:19], v[136:139], v[160:163], v[16:19]
    ds_read_b64_tr_b16 v[122:123], v170 offset:33280
    v_mfma_f32_16x16x32_bf16 v[20:23], v[136:139], v[164:167], v[20:23]
    ds_read_b64_tr_b16 v[124:125], v171 offset:32768
    v_mfma_f32_16x16x32_bf16 v[24:27], v[152:155], v[140:143], v[24:27]
    ds_read_b64_tr_b16 v[126:127], v171 offset:33280
    v_mfma_f32_16x16x32_bf16 v[28:31], v[156:159], v[140:143], v[28:31]
    ds_read_b128 v[108:111], v168 offset:34816
    v_mfma_f32_16x16x32_bf16 v[32:35], v[140:143], v[160:163], v[32:35]
    ds_read_b64_tr_b16 v[128:129], v170 offset:40960
    v_mfma_f32_16x16x32_bf16 v[36:39], v[140:143], v[164:167], v[36:39]
    ds_read_b64_tr_b16 v[130:131], v170 offset:41472
    v_mfma_f32_16x16x32_bf16 v[40:43], v[152:155], v[144:147], v[40:43]
    ds_read_b64_tr_b16 v[132:133], v171 offset:40960
    v_mfma_f32_16x16x32_bf16 v[44:47], v[156:159], v[144:147], v[44:47]
    ds_read_b64_tr_b16 v[134:135], v171 offset:41472
    v_mfma_f32_16x16x32_bf16 v[48:51], v[144:147], v[160:163], v[48:51]
    ds_read_b128 v[112:115], v168 offset:36864
    v_mfma_f32_16x16x32_bf16 v[52:55], v[144:147], v[164:167], v[52:55]
    ds_read_b128 v[116:119], v168 offset:38912
    v_mfma_f32_16x16x32_bf16 v[56:59], v[152:155], v[148:151], v[56:59]
    v_mfma_f32_16x16x32_bf16 v[60:63], v[156:159], v[148:151], v[60:63]
    v_mfma_f32_16x16x32_bf16 v[64:67], v[148:151], v[160:163], v[64:67]
    v_mfma_f32_16x16x32_bf16 v[68:71], v[148:151], v[164:167], v[68:71]
    s_waitcnt lgkmcnt(0)
    v_mfma_f32_16x16x32_bf16 v[8:11], v[120:123], v[104:107], v[8:11]
    ds_read_b128 v[136:139], v169 offset:32768
    v_mfma_f32_16x16x32_bf16 v[12:15], v[124:127], v[104:107], v[12:15]
    ds_read_b64_tr_b16 v[152:153], v170 offset:36864
    v_mfma_f32_16x16x32_bf16 v[16:19], v[104:107], v[128:131], v[16:19]
    ds_read_b64_tr_b16 v[154:155], v170 offset:37376
    v_mfma_f32_16x16x32_bf16 v[20:23], v[104:107], v[132:135], v[20:23]
    ds_read_b64_tr_b16 v[156:157], v171 offset:36864
    v_mfma_f32_16x16x32_bf16 v[24:27], v[120:123], v[108:111], v[24:27]
    ds_read_b64_tr_b16 v[158:159], v171 offset:37376
    v_mfma_f32_16x16x32_bf16 v[28:31], v[124:127], v[108:111], v[28:31]
    ds_read_b128 v[140:143], v169 offset:34816
    v_mfma_f32_16x16x32_bf16 v[32:35], v[108:111], v[128:131], v[32:35]
    ds_read_b64_tr_b16 v[160:161], v170 offset:45056
    v_mfma_f32_16x16x32_bf16 v[36:39], v[108:111], v[132:135], v[36:39]
    ds_read_b64_tr_b16 v[162:163], v170 offset:45568
    v_mfma_f32_16x16x32_bf16 v[40:43], v[120:123], v[112:115], v[40:43]
    ds_read_b64_tr_b16 v[164:165], v171 offset:45056
    v_mfma_f32_16x16x32_bf16 v[44:47], v[124:127], v[112:115], v[44:47]
    ds_read_b64_tr_b16 v[166:167], v171 offset:45568
    v_mfma_f32_16x16x32_bf16 v[48:51], v[112:115], v[128:131], v[48:51]
    ds_read_b128 v[144:147], v169 offset:36864
    v_mfma_f32_16x16x32_bf16 v[52:55], v[112:115], v[132:135], v[52:55]
    ds_read_b128 v[148:151], v169 offset:38912
    v_mfma_f32_16x16x32_bf16 v[56:59], v[120:123], v[116:119], v[56:59]
    v_mfma_f32_16x16x32_bf16 v[60:63], v[124:127], v[116:119], v[60:63]
    v_mfma_f32_16x16x32_bf16 v[64:67], v[116:119], v[128:131], v[64:67]
    v_mfma_f32_16x16x32_bf16 v[68:71], v[116:119], v[132:135], v[68:71]
    s_waitcnt lgkmcnt(0)
    v_mfma_f32_16x16x32_bf16 v[8:11], v[152:155], v[136:139], v[8:11]
    ds_read_b128 v[104:107], v168 offset:49152
    v_mfma_f32_16x16x32_bf16 v[12:15], v[156:159], v[136:139], v[12:15]
    ds_read_b64_tr_b16 v[120:121], v170 offset:49152
    v_mfma_f32_16x16x32_bf16 v[16:19], v[136:139], v[160:163], v[16:19]
    ds_read_b64_tr_b16 v[122:123], v170 offset:49664
    v_mfma_f32_16x16x32_bf16 v[20:23], v[136:139], v[164:167], v[20:23]
    ds_read_b64_tr_b16 v[124:125], v171 offset:49152
    v_mfma_f32_16x16x32_bf16 v[24:27], v[152:155], v[140:143], v[24:27]
    ds_read_b64_tr_b16 v[126:127], v171 offset:49664
    v_mfma_f32_16x16x32_bf16 v[28:31], v[156:159], v[140:143], v[28:31]
    ds_read_b128 v[108:111], v168 offset:51200
    v_mfma_f32_16x16x32_bf16 v[32:35], v[140:143], v[160:163], v[32:35]
    ds_read_b64_tr_b16 v[128:129], v170 offset:57344
    v_mfma_f32_16x16x32_bf16 v[36:39], v[140:143], v[164:167], v[36:39]
    ds_read_b64_tr_b16 v[130:131], v170 offset:57856
    v_mfma_f32_16x16x32_bf16 v[40:43], v[152:155], v[144:147], v[40:43]
    ds_read_b64_tr_b16 v[132:133], v171 offset:57344
    v_mfma_f32_16x16x32_bf16 v[44:47], v[156:159], v[144:147], v[44:47]
    ds_read_b64_tr_b16 v[134:135], v171 offset:57856
    v_mfma_f32_16x16x32_bf16 v[48:51], v[144:147], v[160:163], v[48:51]
    ds_read_b128 v[112:115], v168 offset:53248
    v_mfma_f32_16x16x32_bf16 v[52:55], v[144:147], v[164:167], v[52:55]
    ds_read_b128 v[116:119], v168 offset:55296
    v_mfma_f32_16x16x32_bf16 v[56:59], v[152:155], v[148:151], v[56:59]
    v_mfma_f32_16x16x32_bf16 v[60:63], v[156:159], v[148:151], v[60:63]
    v_mfma_f32_16x16x32_bf16 v[64:67], v[148:151], v[160:163], v[64:67]
    v_mfma_f32_16x16x32_bf16 v[68:71], v[148:151], v[164:167], v[68:71]
    s_waitcnt lgkmcnt(0)
    v_mfma_f32_16x16x32_bf16 v[8:11], v[120:123], v[104:107], v[8:11]
    ds_read_b128 v[136:139], v169 offset:49152
    v_mfma_f32_16x16x32_bf16 v[12:15], v[124:127], v[104:107], v[12:15]
    ds_read_b64_tr_b16 v[152:153], v170 offset:53248
    v_mfma_f32_16x16x32_bf16 v[16:19], v[104:107], v[128:131], v[16:19]
    ds_read_b64_tr_b16 v[154:155], v170 offset:53760
    v_mfma_f32_16x16x32_bf16 v[20:23], v[104:107], v[132:135], v[20:23]
    ds_read_b64_tr_b16 v[156:157], v171 offset:53248
    v_mfma_f32_16x16x32_bf16 v[24:27], v[120:123], v[108:111], v[24:27]
    ds_read_b64_tr_b16 v[158:159], v171 offset:53760
    v_mfma_f32_16x16x32_bf16 v[28:31], v[124:127], v[108:111], v[28:31]
    ds_read_b128 v[140:143], v169 offset:51200
    v_mfma_f32_16x16x32_bf16 v[32:35], v[108:111], v[128:131], v[32:35]
    ds_read_b64_tr_b16 v[160:161], v170 offset:61440
    v_mfma_f32_16x16x32_bf16 v[36:39], v[108:111], v[132:135], v[36:39]
    ds_read_b64_tr_b16 v[162:163], v170 offset:61952
    v_mfma_f32_16x16x32_bf16 v[40:43], v[120:123], v[112:115], v[40:43]
    ds_read_b64_tr_b16 v[164:165], v171 offset:61440
    v_mfma_f32_16x16x32_bf16 v[44:47], v[124:127], v[112:115], v[44:47]
    ds_read_b64_tr_b16 v[166:167], v171 offset:61952
    v_mfma_f32_16x16x32_bf16 v[48:51], v[112:115], v[128:131], v[48:51]
    ds_read_b128 v[144:147], v169 offset:53248
    v_mfma_f32_16x16x32_bf16 v[52:55], v[112:115], v[132:135], v[52:55]
    ds_read_b128 v[148:151], v169 offset:55296
    v_mfma_f32_16x16x32_bf16 v[56:59], v[120:123], v[116:119], v[56:59]
    v_mfma_f32_16x16x32_bf16 v[60:63], v[124:127], v[116:119], v[60:63]
    v_mfma_f32_16x16x32_bf16 v[64:67], v[116:119], v[128:131], v[64:67]
    v_mfma_f32_16x16x32_bf16 v[68:71], v[116:119], v[132:135], v[68:71]
    s_waitcnt lgkmcnt(0)
    s_lshl_b32 s3, s38, 2
    s_add_u32 s3, s3, 139152
    v_mov_b32 v6, s3
    v_mov_b32 v7, 1
    ds_write_b32 v6, v7
    v_and_b32 v3, 15, v1
    s_lshl_b32 s3, s28, 8
    s_add_u32 s3, s3, 135168
    v_lshl_add_u32 v240, v3, 2, s3
    v_lshl_add_u32 v241, v1, 2, s3
    v_lshl_add_u32 v242, v2, 4, s3
    s_lshl_b32 s3, s29, 7
    s_add_u32 s3, s3, 138240
    v_lshl_add_u32 v243, v2, 4, s3
    v_lshl_add_u32 v244, v3, 2, s3
    s_lshl_b32 s3, s28, 7
    s_add_u32 s3, s3, 136192
    v_lshl_add_u32 v245, v2, 3, s3
    v_lshrrev_b32 v6, 2, v1
    v_lshlrev_b32 v6, 6, v6
    v_and_b32 v7, 3, v1
    v_lshl_add_u32 v6, v7, 3, v6
    s_lshl_b32 s3, s29, 11
    s_add_u32 s3, s3, 131072
    v_add_u32 v246, s3, v6
    v_mfma_f32_16x16x32_bf16 v[8:11], v[152:155], v[136:139], v[8:11]
    ds_read_b32 v180, v240 offset:0
    v_mfma_f32_16x16x32_bf16 v[12:15], v[156:159], v[136:139], v[12:15]
    ds_read_b32 v182, v240 offset:64
    v_mfma_f32_16x16x32_bf16 v[16:19], v[136:139], v[160:163], v[16:19]
    ds_read_b32 v184, v240 offset:128
    v_mfma_f32_16x16x32_bf16 v[20:23], v[136:139], v[164:167], v[20:23]
    ds_read_b32 v186, v240 offset:192
    v_mfma_f32_16x16x32_bf16 v[24:27], v[152:155], v[140:143], v[24:27]
    ds_read_b128 v[192:195], v243 offset:256
    v_mfma_f32_16x16x32_bf16 v[28:31], v[156:159], v[140:143], v[28:31]
    ds_read_b128 v[196:199], v243 offset:320
    v_mfma_f32_16x16x32_bf16 v[32:35], v[140:143], v[160:163], v[32:35]
    ds_read_b64_tr_b16 v[172:173], v246 offset:0
    v_mfma_f32_16x16x32_bf16 v[36:39], v[140:143], v[164:167], v[36:39]
    ds_read_b64_tr_b16 v[174:175], v246 offset:1024
    v_mfma_f32_16x16x32_bf16 v[40:43], v[152:155], v[144:147], v[40:43]
    ds_read_b64_tr_b16 v[176:177], v246 offset:32
    v_mfma_f32_16x16x32_bf16 v[44:47], v[156:159], v[144:147], v[44:47]
    ds_read_b64_tr_b16 v[178:179], v246 offset:1056
    v_mfma_f32_16x16x32_bf16 v[48:51], v[144:147], v[160:163], v[48:51]
    ds_read_b32 v248, v240 offset:512
    v_mfma_f32_16x16x32_bf16 v[52:55], v[144:147], v[164:167], v[52:55]
    ds_read_b32 v250, v240 offset:576
    v_mfma_f32_16x16x32_bf16 v[56:59], v[152:155], v[148:151], v[56:59]
    ds_read_b32 v252, v240 offset:640
    v_mfma_f32_16x16x32_bf16 v[60:63], v[156:159], v[148:151], v[60:63]
    ds_read_b32 v254, v240 offset:704
    v_mfma_f32_16x16x32_bf16 v[64:67], v[148:151], v[160:163], v[64:67]
    ds_read_b32 v183, v241 offset:512
    v_mfma_f32_16x16x32_bf16 v[68:71], v[148:151], v[164:167], v[68:71]
    v_mov_b32 v247, 139072
    ds_read_b32 v185, v247
    ds_read_b32 v187, v247 offset:8
    ds_read_b32 v188, v244 offset:512
    ds_read_b32 v190, v244 offset:576
    ds_read_b128 v[200:203], v242 offset:0
    ds_read_b128 v[204:207], v242 offset:64
    ds_read_b128 v[208:211], v242 offset:128
    ds_read_b128 v[212:215], v242 offset:192
    ds_read_b64 v[216:217], v245 offset:0
    ds_read_b64 v[218:219], v245 offset:32
    ds_read_b64 v[220:221], v245 offset:64
    ds_read_b64 v[222:223], v245 offset:96
    s_mov_b32 s71, 1069066811
    s_waitcnt lgkmcnt(12)
    v_pk_fma_f32 v[8:9], v[180:181], v[192:193], v[8:9] op_sel_hi:[0,1,1] neg_lo:[1,0,0] neg_hi:[1,0,0]
    v_pk_fma_f32 v[10:11], v[180:181], v[194:195], v[10:11] op_sel_hi:[0,1,1] neg_lo:[1,0,0] neg_hi:[1,0,0]
    v_pk_fma_f32 v[12:13], v[180:181], v[196:197], v[12:13] op_sel_hi:[0,1,1] neg_lo:[1,0,0] neg_hi:[1,0,0]
    v_pk_fma_f32 v[14:15], v[180:181], v[198:199], v[14:15] op_sel_hi:[0,1,1] neg_lo:[1,0,0] neg_hi:[1,0,0]
    v_cvt_pk_bf16_f32 v104, v8, v9
    v_cvt_pk_bf16_f32 v105, v10, v11
    v_cvt_pk_bf16_f32 v106, v12, v13
    v_cvt_pk_bf16_f32 v107, v14, v15
    v_pk_fma_f32 v[24:25], v[182:183], v[192:193], v[24:25] op_sel_hi:[0,1,1] neg_lo:[1,0,0] neg_hi:[1,0,0]
    v_pk_fma_f32 v[26:27], v[182:183], v[194:195], v[26:27] op_sel_hi:[0,1,1] neg_lo:[1,0,0] neg_hi:[1,0,0]
    v_pk_fma_f32 v[28:29], v[182:183], v[196:197], v[28:29] op_sel_hi:[0,1,1] neg_lo:[1,0,0] neg_hi:[1,0,0]
    v_pk_fma_f32 v[30:31], v[182:183], v[198:199], v[30:31] op_sel_hi:[0,1,1] neg_lo:[1,0,0] neg_hi:[1,0,0]
    v_cvt_pk_bf16_f32 v108, v24, v25
    v_cvt_pk_bf16_f32 v109, v26, v27
    v_cvt_pk_bf16_f32 v110, v28, v29
    v_cvt_pk_bf16_f32 v111, v30, v31
    v_pk_fma_f32 v[40:41], v[184:185], v[192:193], v[40:41] op_sel_hi:[0,1,1] neg_lo:[1,0,0] neg_hi:[1,0,0]
    v_pk_fma_f32 v[42:43], v[184:185], v[194:195], v[42:43] op_sel_hi:[0,1,1] neg_lo:[1,0,0] neg_hi:[1,0,0]
    v_pk_fma_f32 v[44:45], v[184:185], v[196:197], v[44:45] op_sel_hi:[0,1,1] neg_lo:[1,0,0] neg_hi:[1,0,0]
    v_pk_fma_f32 v[46:47], v[184:185], v[198:199], v[46:47] op_sel_hi:[0,1,1] neg_lo:[1,0,0] neg_hi:[1,0,0]
    v_cvt_pk_bf16_f32 v112, v40, v41
    v_cvt_pk_bf16_f32 v113, v42, v43
    v_cvt_pk_bf16_f32 v114, v44, v45
    v_cvt_pk_bf16_f32 v115, v46, v47
    v_pk_fma_f32 v[56:57], v[186:187], v[192:193], v[56:57] op_sel_hi:[0,1,1] neg_lo:[1,0,0] neg_hi:[1,0,0]
    v_pk_fma_f32 v[58:59], v[186:187], v[194:195], v[58:59] op_sel_hi:[0,1,1] neg_lo:[1,0,0] neg_hi:[1,0,0]
    v_pk_fma_f32 v[60:61], v[186:187], v[196:197], v[60:61] op_sel_hi:[0,1,1] neg_lo:[1,0,0] neg_hi:[1,0,0]
    v_pk_fma_f32 v[62:63], v[186:187], v[198:199], v[62:63] op_sel_hi:[0,1,1] neg_lo:[1,0,0] neg_hi:[1,0,0]
    v_cvt_pk_bf16_f32 v116, v56, v57
    v_cvt_pk_bf16_f32 v117, v58, v59
    v_cvt_pk_bf16_f32 v118, v60, v61
    v_cvt_pk_bf16_f32 v119, v62, v63
    v_mul_f32 v248, s71, v248
    v_mul_f32 v250, s71, v250
    v_mul_f32 v252, s71, v252
    v_mul_f32 v254, s71, v254
    v_mul_f32 v181, s71, v183
    s_waitcnt lgkmcnt(0)
    v_readfirstlane_b32 s33, v185
    v_readfirstlane_b32 s32, v187
    v_pk_fma_f32 v[16:17], v[200:201], v[188:189], v[16:17] op_sel_hi:[1,0,1] neg_lo:[1,0,0] neg_hi:[1,0,0]
    v_pk_fma_f32 v[18:19], v[202:203], v[188:189], v[18:19] op_sel_hi:[1,0,1] neg_lo:[1,0,0] neg_hi:[1,0,0]
    v_cvt_pk_bf16_f32 v152, v16, v17
    v_cvt_pk_bf16_f32 v153, v18, v19
    v_pk_fma_f32 v[20:21], v[200:201], v[190:191], v[20:21] op_sel_hi:[1,0,1] neg_lo:[1,0,0] neg_hi:[1,0,0]
    v_pk_fma_f32 v[22:23], v[202:203], v[190:191], v[22:23] op_sel_hi:[1,0,1] neg_lo:[1,0,0] neg_hi:[1,0,0]
    v_cvt_pk_bf16_f32 v156, v20, v21
    v_cvt_pk_bf16_f32 v157, v22, v23
    v_pk_fma_f32 v[32:33], v[204:205], v[188:189], v[32:33] op_sel_hi:[1,0,1] neg_lo:[1,0,0] neg_hi:[1,0,0]
    v_pk_fma_f32 v[34:35], v[206:207], v[188:189], v[34:35] op_sel_hi:[1,0,1] neg_lo:[1,0,0] neg_hi:[1,0,0]
    v_cvt_pk_bf16_f32 v154, v32, v33
    v_cvt_pk_bf16_f32 v155, v34, v35
    v_pk_fma_f32 v[36:37], v[204:205], v[190:191], v[36:37] op_sel_hi:[1,0,1] neg_lo:[1,0,0] neg_hi:[1,0,0]
    v_pk_fma_f32 v[38:39], v[206:207], v[190:191], v[38:39] op_sel_hi:[1,0,1] neg_lo:[1,0,0] neg_hi:[1,0,0]
    v_cvt_pk_bf16_f32 v158, v36, v37
    v_cvt_pk_bf16_f32 v159, v38, v39
    v_pk_fma_f32 v[48:49], v[208:209], v[188:189], v[48:49] op_sel_hi:[1,0,1] neg_lo:[1,0,0] neg_hi:[1,0,0]
    v_pk_fma_f32 v[50:51], v[210:211], v[188:189], v[50:51] op_sel_hi:[1,0,1] neg_lo:[1,0,0] neg_hi:[1,0,0]
    v_cvt_pk_bf16_f32 v160, v48, v49
    v_cvt_pk_bf16_f32 v161, v50, v51
    v_pk_fma_f32 v[52:53], v[208:209], v[190:191], v[52:53] op_sel_hi:[1,0,1] neg_lo:[1,0,0] neg_hi:[1,0,0]
    v_pk_fma_f32 v[54:55], v[210:211], v[190:191], v[54:55] op_sel_hi:[1,0,1] neg_lo:[1,0,0] neg_hi:[1,0,0]
    v_cvt_pk_bf16_f32 v164, v52, v53
    v_cvt_pk_bf16_f32 v165, v54, v55
    v_pk_fma_f32 v[64:65], v[212:213], v[188:189], v[64:65] op_sel_hi:[1,0,1] neg_lo:[1,0,0] neg_hi:[1,0,0]
    v_pk_fma_f32 v[66:67], v[214:215], v[188:189], v[66:67] op_sel_hi:[1,0,1] neg_lo:[1,0,0] neg_hi:[1,0,0]
    v_cvt_pk_bf16_f32 v162, v64, v65
    v_cvt_pk_bf16_f32 v163, v66, v67
    v_pk_fma_f32 v[68:69], v[212:213], v[190:191], v[68:69] op_sel_hi:[1,0,1] neg_lo:[1,0,0] neg_hi:[1,0,0]
    v_pk_fma_f32 v[70:71], v[214:215], v[190:191], v[70:71] op_sel_hi:[1,0,1] neg_lo:[1,0,0] neg_hi:[1,0,0]
    v_cvt_pk_bf16_f32 v166, v68, v69
    v_cvt_pk_bf16_f32 v167, v70, v71
    v_mfma_f32_16x16x32_bf16 v[120:123], v[172:175], v[104:107], 0
    v_mfma_f32_16x16x32_bf16 v[124:127], v[176:179], v[104:107], 0
    v_mfma_f32_16x16x32_bf16 v[128:131], v[172:175], v[108:111], 0
    v_mfma_f32_16x16x32_bf16 v[132:135], v[176:179], v[108:111], 0
    v_mfma_f32_16x16x32_bf16 v[136:139], v[172:175], v[112:115], 0
    v_mfma_f32_16x16x32_bf16 v[140:143], v[176:179], v[112:115], 0
    v_mfma_f32_16x16x32_bf16 v[144:147], v[172:175], v[116:119], 0
    v_mfma_f32_16x16x32_bf16 v[148:151], v[176:179], v[116:119], 0
    s_nop 0
    v_max3_f32 v224, v120, v121, v122
    v_min3_f32 v232, v120, v121, v122
    v_max3_f32 v224, v224, v123, v124
    v_min3_f32 v232, v232, v123, v124
    v_max3_f32 v224, v224, v125, v126
    v_min3_f32 v232, v232, v125, v126
    v_max_f32 v224, v224, v127
    v_min_f32 v232, v232, v127
    v_max3_f32 v226, v128, v129, v130
    v_min3_f32 v234, v128, v129, v130
    v_max3_f32 v226, v226, v131, v132
    v_min3_f32 v234, v234, v131, v132
    v_max3_f32 v226, v226, v133, v134
    v_min3_f32 v234, v234, v133, v134
    v_max_f32 v226, v226, v135
    v_min_f32 v234, v234, v135
    v_max3_f32 v228, v136, v137, v138
    v_min3_f32 v236, v136, v137, v138
    v_max3_f32 v228, v228, v139, v140
    v_min3_f32 v236, v236, v139, v140
    v_max3_f32 v228, v228, v141, v142
    v_min3_f32 v236, v236, v141, v142
    v_max_f32 v228, v228, v143
    v_min_f32 v236, v236, v143
    v_max3_f32 v230, v144, v145, v146
    v_min3_f32 v238, v144, v145, v146
    v_max3_f32 v230, v230, v147, v148
    v_min3_f32 v238, v238, v147, v148
    v_max3_f32 v230, v230, v149, v150
    v_min3_f32 v238, v238, v149, v150
    v_max_f32 v230, v230, v151
    v_min_f32 v238, v238, v151
    v_permlane32_swap_b32 v224, v228
    v_permlane32_swap_b32 v226, v230
    v_permlane32_swap_b32 v232, v236
    v_permlane32_swap_b32 v234, v238
    v_max_f32 v224, v224, v228
    v_max_f32 v226, v226, v230
    v_min_f32 v232, v232, v236
    v_min_f32 v234, v234, v238
    v_permlane16_swap_b32 v224, v226
    s_nop 0
    v_permlane16_swap_b32 v232, v234
    v_max_f32 v224, v224, v226
    v_min_f32 v232, v232, v234
    v_mul_f32 v224, v224, v181
    v_mul_f32 v232, v232, v181
    v_mov_b32 v226, v224
    v_mov_b32 v234, v232
    s_nop 0
    v_permlane16_swap_b32 v224, v226
    v_permlane16_swap_b32 v232, v234
    v_mov_b32 v228, v224
    v_mov_b32 v230, v226
    v_mov_b32 v236, v232
    v_mov_b32 v238, v234
    v_permlane32_swap_b32 v224, v228
    v_permlane32_swap_b32 v226, v230
    v_permlane32_swap_b32 v232, v236
    v_permlane32_swap_b32 v234, v238
    v_pk_fma_f32 v[8:9], v[120:121], v[248:249], v[224:225] op_sel_hi:[1,0,0] neg_lo:[0,0,1] neg_hi:[0,0,1]
    v_pk_fma_f32 v[16:17], v[120:121], v[248:249], v[232:233] op_sel_hi:[1,0,0] neg_lo:[1,0,0] neg_hi:[1,0,0]
    v_pk_fma_f32 v[10:11], v[122:123], v[248:249], v[224:225] op_sel_hi:[1,0,0] neg_lo:[0,0,1] neg_hi:[0,0,1]
    v_pk_fma_f32 v[18:19], v[122:123], v[248:249], v[232:233] op_sel_hi:[1,0,0] neg_lo:[1,0,0] neg_hi:[1,0,0]
    v_pk_fma_f32 v[12:13], v[124:125], v[248:249], v[224:225] op_sel_hi:[1,0,0] neg_lo:[0,0,1] neg_hi:[0,0,1]
    v_pk_fma_f32 v[20:21], v[124:125], v[248:249], v[232:233] op_sel_hi:[1,0,0] neg_lo:[1,0,0] neg_hi:[1,0,0]
    v_pk_fma_f32 v[14:15], v[126:127], v[248:249], v[224:225] op_sel_hi:[1,0,0] neg_lo:[0,0,1] neg_hi:[0,0,1]
    v_pk_fma_f32 v[22:23], v[126:127], v[248:249], v[232:233] op_sel_hi:[1,0,0] neg_lo:[1,0,0] neg_hi:[1,0,0]
    v_exp_f32 v8, v8
    v_exp_f32 v9, v9
    v_exp_f32 v10, v10
    v_exp_f32 v11, v11
    v_exp_f32 v12, v12
    v_exp_f32 v13, v13
    v_exp_f32 v14, v14
    v_exp_f32 v15, v15
    v_exp_f32 v16, v16
    v_exp_f32 v17, v17
    v_exp_f32 v18, v18
    v_exp_f32 v19, v19
    v_exp_f32 v20, v20
    v_exp_f32 v21, v21
    v_exp_f32 v22, v22
    v_exp_f32 v23, v23
    v_pk_fma_f32 v[24:25], v[128:129], v[250:251], v[226:227] op_sel_hi:[1,0,0] neg_lo:[0,0,1] neg_hi:[0,0,1]
    v_pk_fma_f32 v[32:33], v[128:129], v[250:251], v[234:235] op_sel_hi:[1,0,0] neg_lo:[1,0,0] neg_hi:[1,0,0]
    v_pk_fma_f32 v[26:27], v[130:131], v[250:251], v[226:227] op_sel_hi:[1,0,0] neg_lo:[0,0,1] neg_hi:[0,0,1]
    v_pk_fma_f32 v[34:35], v[130:131], v[250:251], v[234:235] op_sel_hi:[1,0,0] neg_lo:[1,0,0] neg_hi:[1,0,0]
    v_pk_fma_f32 v[28:29], v[132:133], v[250:251], v[226:227] op_sel_hi:[1,0,0] neg_lo:[0,0,1] neg_hi:[0,0,1]
    v_pk_fma_f32 v[36:37], v[132:133], v[250:251], v[234:235] op_sel_hi:[1,0,0] neg_lo:[1,0,0] neg_hi:[1,0,0]
    v_pk_fma_f32 v[30:31], v[134:135], v[250:251], v[226:227] op_sel_hi:[1,0,0] neg_lo:[0,0,1] neg_hi:[0,0,1]
    v_pk_fma_f32 v[38:39], v[134:135], v[250:251], v[234:235] op_sel_hi:[1,0,0] neg_lo:[1,0,0] neg_hi:[1,0,0]
    v_exp_f32 v24, v24
    v_exp_f32 v25, v25
    v_exp_f32 v26, v26
    v_exp_f32 v27, v27
    v_exp_f32 v28, v28
    v_exp_f32 v29, v29
    v_exp_f32 v30, v30
    v_exp_f32 v31, v31
    v_exp_f32 v32, v32
    v_exp_f32 v33, v33
    v_exp_f32 v34, v34
    v_exp_f32 v35, v35
    v_exp_f32 v36, v36
    v_exp_f32 v37, v37
    v_exp_f32 v38, v38
    v_exp_f32 v39, v39
    v_pk_fma_f32 v[40:41], v[136:137], v[252:253], v[228:229] op_sel_hi:[1,0,0] neg_lo:[0,0,1] neg_hi:[0,0,1]
    v_pk_fma_f32 v[48:49], v[136:137], v[252:253], v[236:237] op_sel_hi:[1,0,0] neg_lo:[1,0,0] neg_hi:[1,0,0]
    v_pk_fma_f32 v[42:43], v[138:139], v[252:253], v[228:229] op_sel_hi:[1,0,0] neg_lo:[0,0,1] neg_hi:[0,0,1]
    v_pk_fma_f32 v[50:51], v[138:139], v[252:253], v[236:237] op_sel_hi:[1,0,0] neg_lo:[1,0,0] neg_hi:[1,0,0]
    v_pk_fma_f32 v[44:45], v[140:141], v[252:253], v[228:229] op_sel_hi:[1,0,0] neg_lo:[0,0,1] neg_hi:[0,0,1]
    v_pk_fma_f32 v[52:53], v[140:141], v[252:253], v[236:237] op_sel_hi:[1,0,0] neg_lo:[1,0,0] neg_hi:[1,0,0]
    v_pk_fma_f32 v[46:47], v[142:143], v[252:253], v[228:229] op_sel_hi:[1,0,0] neg_lo:[0,0,1] neg_hi:[0,0,1]
    v_pk_fma_f32 v[54:55], v[142:143], v[252:253], v[236:237] op_sel_hi:[1,0,0] neg_lo:[1,0,0] neg_hi:[1,0,0]
    v_exp_f32 v40, v40
    v_exp_f32 v41, v41
    v_exp_f32 v42, v42
    v_exp_f32 v43, v43
    v_exp_f32 v44, v44
    v_exp_f32 v45, v45
    v_exp_f32 v46, v46
    v_exp_f32 v47, v47
    v_exp_f32 v48, v48
    v_exp_f32 v49, v49
    v_exp_f32 v50, v50
    v_exp_f32 v51, v51
    v_exp_f32 v52, v52
    v_exp_f32 v53, v53
    v_exp_f32 v54, v54
    v_exp_f32 v55, v55
    v_pk_fma_f32 v[56:57], v[144:145], v[254:255], v[230:231] op_sel_hi:[1,0,0] neg_lo:[0,0,1] neg_hi:[0,0,1]
    v_pk_fma_f32 v[64:65], v[144:145], v[254:255], v[238:239] op_sel_hi:[1,0,0] neg_lo:[1,0,0] neg_hi:[1,0,0]
    v_pk_fma_f32 v[58:59], v[146:147], v[254:255], v[230:231] op_sel_hi:[1,0,0] neg_lo:[0,0,1] neg_hi:[0,0,1]
    v_pk_fma_f32 v[66:67], v[146:147], v[254:255], v[238:239] op_sel_hi:[1,0,0] neg_lo:[1,0,0] neg_hi:[1,0,0]
    v_pk_fma_f32 v[60:61], v[148:149], v[254:255], v[230:231] op_sel_hi:[1,0,0] neg_lo:[0,0,1] neg_hi:[0,0,1]
    v_pk_fma_f32 v[68:69], v[148:149], v[254:255], v[238:239] op_sel_hi:[1,0,0] neg_lo:[1,0,0] neg_hi:[1,0,0]
    v_pk_fma_f32 v[62:63], v[150:151], v[254:255], v[230:231] op_sel_hi:[1,0,0] neg_lo:[0,0,1] neg_hi:[0,0,1]
    v_pk_fma_f32 v[70:71], v[150:151], v[254:255], v[238:239] op_sel_hi:[1,0,0] neg_lo:[1,0,0] neg_hi:[1,0,0]
    v_exp_f32 v56, v56
    v_exp_f32 v57, v57
    v_exp_f32 v58, v58
    v_exp_f32 v59, v59
    v_exp_f32 v60, v60
    v_exp_f32 v61, v61
    v_exp_f32 v62, v62
    v_exp_f32 v63, v63
    v_exp_f32 v64, v64
    v_exp_f32 v65, v65
    v_exp_f32 v66, v66
    v_exp_f32 v67, v67
    v_exp_f32 v68, v68
    v_exp_f32 v69, v69
    v_exp_f32 v70, v70
    v_exp_f32 v71, v71
    v_pk_add_f32 v[120:121], v[8:9], v[10:11]
    v_pk_add_f32 v[122:123], v[12:13], v[14:15]
    v_pk_add_f32 v[124:125], v[16:17], v[18:19]
    v_pk_add_f32 v[126:127], v[20:21], v[22:23]
    v_pk_add_f32 v[128:129], v[24:25], v[26:27]
    v_pk_add_f32 v[130:131], v[28:29], v[30:31]
    v_pk_add_f32 v[132:133], v[32:33], v[34:35]
    v_pk_add_f32 v[134:135], v[36:37], v[38:39]
    v_pk_add_f32 v[136:137], v[40:41], v[42:43]
    v_pk_add_f32 v[138:139], v[44:45], v[46:47]
    v_pk_add_f32 v[140:141], v[48:49], v[50:51]
    v_pk_add_f32 v[142:143], v[52:53], v[54:55]
    v_pk_add_f32 v[144:145], v[56:57], v[58:59]
    v_pk_add_f32 v[146:147], v[60:61], v[62:63]
    v_pk_add_f32 v[148:149], v[64:65], v[66:67]
    v_pk_add_f32 v[150:151], v[68:69], v[70:71]
    v_pk_add_f32 v[120:121], v[120:121], v[122:123]
    v_pk_add_f32 v[124:125], v[124:125], v[126:127]
    v_pk_add_f32 v[128:129], v[128:129], v[130:131]
    v_pk_add_f32 v[132:133], v[132:133], v[134:135]
    v_pk_add_f32 v[136:137], v[136:137], v[138:139]
    v_pk_add_f32 v[140:141], v[140:141], v[142:143]
    v_pk_add_f32 v[144:145], v[144:145], v[146:147]
    v_pk_add_f32 v[148:149], v[148:149], v[150:151]
    v_add_f32 v224, v120, v121
    v_add_f32 v232, v124, v125
    v_add_f32 v226, v128, v129
    v_add_f32 v234, v132, v133
    v_add_f32 v228, v136, v137
    v_add_f32 v236, v140, v141
    v_add_f32 v230, v144, v145
    v_add_f32 v238, v148, v149
    v_permlane32_swap_b32 v224, v228
    v_permlane32_swap_b32 v226, v230
    v_permlane32_swap_b32 v232, v236
    v_permlane32_swap_b32 v234, v238
    v_add_f32 v224, v224, v228
    v_add_f32 v226, v226, v230
    v_add_f32 v232, v232, v236
    v_add_f32 v234, v234, v238
    v_permlane16_swap_b32 v224, v226
    s_nop 0
    v_permlane16_swap_b32 v232, v234
    v_add_f32 v224, v224, v226
    v_add_f32 v232, v232, v234
    v_rcp_f32 v224, v224
    v_rcp_f32 v232, v232
    s_mul_i32 s3, s38, 4352
    s_add_u32 s3, s3, 140800
    v_mul_u32_u24 v6, 136, v3
    v_lshl_add_u32 v6, v2, 3, v6
    v_add_u32 v240, s3, v6
    v_mul_f32 v224, v224, v183
    v_mul_f32 v232, v232, v183
    v_lshrrev_b32 v6, 2, v1
    v_mul_u32_u24 v6, 136, v6
    v_lshl_add_u32 v6, v7, 3, v6
    v_add_u32 v6, s3, v6
    s_lshl_b32 s65, s28, 6
    v_add_u32 v241, s65, v6
    s_xor_b32 s65, s65, 64
    v_add_u32 v242, s65, v6
    v_mov_b32 v226, v224
    v_mov_b32 v234, v232
    s_nop 0
    v_permlane16_swap_b32 v224, v226
    v_permlane16_swap_b32 v232, v234
    v_mov_b32 v228, v224
    v_mov_b32 v230, v226
    v_mov_b32 v236, v232
    v_mov_b32 v238, v234
    v_permlane32_swap_b32 v224, v228
    v_permlane32_swap_b32 v226, v230
    v_permlane32_swap_b32 v232, v236
    v_permlane32_swap_b32 v234, v238
    v_pk_mul_f32 v[8:9], v[8:9], v[224:225] op_sel_hi:[1,0]
    v_pk_mul_f32 v[10:11], v[10:11], v[224:225] op_sel_hi:[1,0]
    v_pk_mul_f32 v[12:13], v[12:13], v[224:225] op_sel_hi:[1,0]
    v_pk_mul_f32 v[14:15], v[14:15], v[224:225] op_sel_hi:[1,0]
    v_cvt_pk_bf16_f32 v104, v8, v9
    v_cvt_pk_bf16_f32 v105, v10, v11
    v_cvt_pk_bf16_f32 v106, v12, v13
    v_cvt_pk_bf16_f32 v107, v14, v15
    ds_write_b64 v240, v[104:105] offset:0
    ds_write_b64 v240, v[106:107] offset:32
    v_pk_mul_f32 v[16:17], v[16:17], v[232:233] op_sel_hi:[1,0]
    v_pk_mul_f32 v[18:19], v[18:19], v[232:233] op_sel_hi:[1,0]
    v_pk_mul_f32 v[20:21], v[20:21], v[232:233] op_sel_hi:[1,0]
    v_pk_mul_f32 v[22:23], v[22:23], v[232:233] op_sel_hi:[1,0]
    v_cvt_pk_bf16_f32 v108, v16, v17
    v_cvt_pk_bf16_f32 v109, v18, v19
    v_cvt_pk_bf16_f32 v110, v20, v21
    v_cvt_pk_bf16_f32 v111, v22, v23
    ds_write_b64 v240, v[108:109] offset:64
    ds_write_b64 v240, v[110:111] offset:96
    v_pk_mul_f32 v[24:25], v[24:25], v[226:227] op_sel_hi:[1,0]
    v_pk_mul_f32 v[26:27], v[26:27], v[226:227] op_sel_hi:[1,0]
    v_pk_mul_f32 v[28:29], v[28:29], v[226:227] op_sel_hi:[1,0]
    v_pk_mul_f32 v[30:31], v[30:31], v[226:227] op_sel_hi:[1,0]
    v_cvt_pk_bf16_f32 v112, v24, v25
    v_cvt_pk_bf16_f32 v113, v26, v27
    v_cvt_pk_bf16_f32 v114, v28, v29
    v_cvt_pk_bf16_f32 v115, v30, v31
    ds_write_b64 v240, v[112:113] offset:2176
    ds_write_b64 v240, v[114:115] offset:2208
    v_pk_mul_f32 v[32:33], v[32:33], v[234:235] op_sel_hi:[1,0]
    v_pk_mul_f32 v[34:35], v[34:35], v[234:235] op_sel_hi:[1,0]
    v_pk_mul_f32 v[36:37], v[36:37], v[234:235] op_sel_hi:[1,0]
    v_pk_mul_f32 v[38:39], v[38:39], v[234:235] op_sel_hi:[1,0]
    v_cvt_pk_bf16_f32 v116, v32, v33
    v_cvt_pk_bf16_f32 v117, v34, v35
    v_cvt_pk_bf16_f32 v118, v36, v37
    v_cvt_pk_bf16_f32 v119, v38, v39
    ds_write_b64 v240, v[116:117] offset:2240
    ds_write_b64 v240, v[118:119] offset:2272
    ds_read_b64_tr_b16 v[120:121], v241 offset:0
    ds_read_b64_tr_b16 v[122:123], v241 offset:2176
    ds_read_b64_tr_b16 v[124:125], v241 offset:32
    ds_read_b64_tr_b16 v[126:127], v241 offset:2208
    ds_read_b64_tr_b16 v[128:129], v242 offset:0
    ds_read_b64_tr_b16 v[130:131], v242 offset:2176
    ds_read_b64_tr_b16 v[132:133], v242 offset:32
    ds_read_b64_tr_b16 v[134:135], v242 offset:2208
    v_pk_mul_f32 v[40:41], v[40:41], v[228:229] op_sel_hi:[1,0]
    v_pk_mul_f32 v[42:43], v[42:43], v[228:229] op_sel_hi:[1,0]
    v_pk_mul_f32 v[44:45], v[44:45], v[228:229] op_sel_hi:[1,0]
    v_pk_mul_f32 v[46:47], v[46:47], v[228:229] op_sel_hi:[1,0]
    v_cvt_pk_bf16_f32 v104, v40, v41
    v_cvt_pk_bf16_f32 v105, v42, v43
    v_cvt_pk_bf16_f32 v106, v44, v45
    v_cvt_pk_bf16_f32 v107, v46, v47
    ds_write_b64 v240, v[104:105] offset:0
    ds_write_b64 v240, v[106:107] offset:32
    v_pk_mul_f32 v[48:49], v[48:49], v[236:237] op_sel_hi:[1,0]
    v_pk_mul_f32 v[50:51], v[50:51], v[236:237] op_sel_hi:[1,0]
    v_pk_mul_f32 v[52:53], v[52:53], v[236:237] op_sel_hi:[1,0]
    v_pk_mul_f32 v[54:55], v[54:55], v[236:237] op_sel_hi:[1,0]
    v_cvt_pk_bf16_f32 v108, v48, v49
    v_cvt_pk_bf16_f32 v109, v50, v51
    v_cvt_pk_bf16_f32 v110, v52, v53
    v_cvt_pk_bf16_f32 v111, v54, v55
    ds_write_b64 v240, v[108:109] offset:64
    ds_write_b64 v240, v[110:111] offset:96
    v_pk_mul_f32 v[56:57], v[56:57], v[230:231] op_sel_hi:[1,0]
    v_pk_mul_f32 v[58:59], v[58:59], v[230:231] op_sel_hi:[1,0]
    v_pk_mul_f32 v[60:61], v[60:61], v[230:231] op_sel_hi:[1,0]
    v_pk_mul_f32 v[62:63], v[62:63], v[230:231] op_sel_hi:[1,0]
    v_cvt_pk_bf16_f32 v112, v56, v57
    v_cvt_pk_bf16_f32 v113, v58, v59
    v_cvt_pk_bf16_f32 v114, v60, v61
    v_cvt_pk_bf16_f32 v115, v62, v63
    ds_write_b64 v240, v[112:113] offset:2176
    ds_write_b64 v240, v[114:115] offset:2208
    v_pk_mul_f32 v[64:65], v[64:65], v[238:239] op_sel_hi:[1,0]
    v_pk_mul_f32 v[66:67], v[66:67], v[238:239] op_sel_hi:[1,0]
    v_pk_mul_f32 v[68:69], v[68:69], v[238:239] op_sel_hi:[1,0]
    v_pk_mul_f32 v[70:71], v[70:71], v[238:239] op_sel_hi:[1,0]
    v_cvt_pk_bf16_f32 v116, v64, v65
    v_cvt_pk_bf16_f32 v117, v66, v67
    v_cvt_pk_bf16_f32 v118, v68, v69
    v_cvt_pk_bf16_f32 v119, v70, v71
    ds_write_b64 v240, v[116:117] offset:2240
    ds_write_b64 v240, v[118:119] offset:2272
    ds_read_b64_tr_b16 v[136:137], v241 offset:0
    ds_read_b64_tr_b16 v[138:139], v241 offset:2176
    ds_read_b64_tr_b16 v[140:141], v241 offset:32
    ds_read_b64_tr_b16 v[142:143], v241 offset:2208
    ds_read_b64_tr_b16 v[144:145], v242 offset:0
    ds_read_b64_tr_b16 v[146:147], v242 offset:2176
    ds_read_b64_tr_b16 v[148:149], v242 offset:32
    ds_read_b64_tr_b16 v[150:151], v242 offset:2208
    s_waitcnt lgkmcnt(0)
    v_mfma_f32_16x16x32_bf16 v[24:27], v[128:131], v[152:155], 0
    v_mfma_f32_16x16x32_bf16 v[28:31], v[128:131], v[156:159], 0
    v_mfma_f32_16x16x32_bf16 v[48:51], v[128:131], v[216:219], 0
    v_mfma_f32_16x16x32_bf16 v[24:27], v[144:147], v[160:163], v[24:27]
    v_mfma_f32_16x16x32_bf16 v[28:31], v[144:147], v[164:167], v[28:31]
    v_mfma_f32_16x16x32_bf16 v[48:51], v[144:147], v[220:223], v[48:51]
    v_mfma_f32_16x16x32_bf16 v[32:35], v[132:135], v[152:155], 0
    v_mfma_f32_16x16x32_bf16 v[36:39], v[132:135], v[156:159], 0
    v_mfma_f32_16x16x32_bf16 v[52:55], v[132:135], v[216:219], 0
    v_mfma_f32_16x16x32_bf16 v[32:35], v[148:151], v[160:163], v[32:35]
    v_mfma_f32_16x16x32_bf16 v[36:39], v[148:151], v[164:167], v[36:39]
    v_mfma_f32_16x16x32_bf16 v[52:55], v[148:151], v[220:223], v[52:55]
    v_mfma_f32_16x16x32_bf16 v[8:11], v[120:123], v[152:155], 0
    v_mfma_f32_16x16x32_bf16 v[12:15], v[120:123], v[156:159], 0
    v_mfma_f32_16x16x32_bf16 v[40:43], v[120:123], v[216:219], 0
    v_mfma_f32_16x16x32_bf16 v[8:11], v[136:139], v[160:163], v[8:11]
    v_mfma_f32_16x16x32_bf16 v[12:15], v[136:139], v[164:167], v[12:15]
    v_mfma_f32_16x16x32_bf16 v[40:43], v[136:139], v[220:223], v[40:43]
    v_mfma_f32_16x16x32_bf16 v[16:19], v[124:127], v[152:155], 0
    v_mfma_f32_16x16x32_bf16 v[20:23], v[124:127], v[156:159], 0
    v_mfma_f32_16x16x32_bf16 v[44:47], v[124:127], v[216:219], 0
    v_mfma_f32_16x16x32_bf16 v[16:19], v[140:143], v[160:163], v[16:19]
    v_mfma_f32_16x16x32_bf16 v[20:23], v[140:143], v[164:167], v[20:23]
    v_mfma_f32_16x16x32_bf16 v[44:47], v[140:143], v[220:223], v[44:47]
    v_lshlrev_b32 v5, 4, v1
    v_add_u32 v240, s3, v5
    v_lshl_add_u32 v241, v2, 5, s3
    s_xor_b32 s65, s38, 1
    s_mul_i32 s65, s65, 4352
    s_add_u32 s65, s65, 140800
    v_add_u32 v242, s65, v5
    v_lshl_add_u32 v243, v2, 5, s65
    ds_write_b128 v240, v[24:27] offset:0
    ds_write_b128 v240, v[28:31] offset:1024
    ds_write_b128 v240, v[32:35] offset:2048
    ds_write_b128 v240, v[36:39] offset:3072
    ds_write_b128 v241, v[48:51] offset:4096
    ds_write_b128 v241, v[52:55] offset:4112
    s_lshl_b32 s3, s37, 1
    s_add_u32 s3, s3, s29
    s_lshl_b32 s3, s3, 4
    s_add_u32 s3, s3, s36
    s_lshl_b32 s3, s3, 1
    s_add_u32 s3, s3, s28
    s_lshl_b32 s3, s3, 12
    s_add_u32 s3, s3, 2097152
    v_mov_b32 v59, s32
    v_mov_b32 v63, s32
    v_mov_b32 v67, s32
    v_mov_b32 v71, s32
    s_waitcnt lgkmcnt(0)
    s_barrier
    ds_read_b128 v[192:195], v242 offset:0
    ds_read_b128 v[196:199], v242 offset:1024
    ds_read_b128 v[200:203], v242 offset:2048
    ds_read_b128 v[204:207], v242 offset:3072
    ds_read_b128 v[208:211], v243 offset:4096
    ds_read_b128 v[212:215], v243 offset:4112
    ds_read_b128 v[104:107], v168 offset:0
    ds_read_b64_tr_b16 v[120:121], v170 offset:0
    ds_read_b64_tr_b16 v[122:123], v170 offset:512
    ds_read_b64_tr_b16 v[124:125], v171 offset:0
    ds_read_b64_tr_b16 v[126:127], v171 offset:512
    ds_read_b128 v[108:111], v168 offset:2048
    ds_read_b128 v[112:115], v168 offset:4096
    ds_read_b128 v[116:119], v168 offset:6144
    s_waitcnt lgkmcnt(8)
    v_pk_add_f32 v[8:9], v[8:9], v[192:193]
    v_pk_add_f32 v[10:11], v[10:11], v[194:195]
    v_pk_add_f32 v[12:13], v[12:13], v[196:197]
    v_pk_add_f32 v[14:15], v[14:15], v[198:199]
    v_pk_add_f32 v[16:17], v[16:17], v[200:201]
    v_pk_add_f32 v[18:19], v[18:19], v[202:203]
    v_pk_add_f32 v[20:21], v[20:21], v[204:205]
    v_pk_add_f32 v[22:23], v[22:23], v[206:207]
    v_pk_add_f32 v[40:41], v[40:41], v[208:209]
    v_pk_add_f32 v[42:43], v[42:43], v[210:211]
    v_pk_add_f32 v[44:45], v[44:45], v[212:213]
    v_pk_add_f32 v[46:47], v[46:47], v[214:215]
    v_cvt_pk_bf16_f32 v56, v8, v9
    v_cvt_pk_bf16_f32 v57, v10, v11
    v_cvt_pk_bf16_f32 v58, v40, v41
    buffer_store_dwordx4 v[56:59], v5, s[12:15], s3 offen offset:0 sc1
    v_cvt_pk_bf16_f32 v60, v16, v17
    v_cvt_pk_bf16_f32 v61, v18, v19
    v_cvt_pk_bf16_f32 v62, v44, v45
    buffer_store_dwordx4 v[60:63], v5, s[12:15], s3 offen offset:1024 sc1
    v_cvt_pk_bf16_f32 v64, v12, v13
    v_cvt_pk_bf16_f32 v65, v14, v15
    v_cvt_pk_bf16_f32 v66, v42, v43
    buffer_store_dwordx4 v[64:67], v5, s[12:15], s3 offen offset:2048 sc1
    v_cvt_pk_bf16_f32 v68, v20, v21
    v_cvt_pk_bf16_f32 v69, v22, v23
    v_cvt_pk_bf16_f32 v70, v46, v47
    buffer_store_dwordx4 v[68:71], v5, s[12:15], s3 offen offset:3072 sc1
    s_lshl_b32 s3, s30, 7
    s_lshl_b32 s65, s38, 5
    s_add_u32 s3, s3, s65
    v_lshrrev_b32 v6, 3, v1
    v_add_u32 v6, s3, v6
    v_lshlrev_b32 v6, 11, v6
    v_and_b32 v7, 7, v1
    v_lshl_add_u32 v6, v7, 4, v6
    s_lshl_b32 s3, s31, 7
    v_add_u32 v246, s3, v6
    s_mov_b32 s77, 16384
    s_mov_b32 s78, 32768
    s_mov_b32 s79, 49152
    s_lshl_b32 s3, s38, 2
    s_add_u32 s3, s3, 139184
    v_mov_b32 v6, s3
    v_mov_b32 v247, 139136
    s_waitcnt lgkmcnt(0)
    v_mfma_f32_16x16x32_bf16 v[72:75], v[120:123], v[104:107], v[72:75]
    ds_read_b128 v[136:139], v169 offset:0
    v_mfma_f32_16x16x32_bf16 v[76:79], v[124:127], v[104:107], v[76:79]
    ds_read_b64_tr_b16 v[152:153], v170 offset:4096
    v_mfma_f32_16x16x32_bf16 v[80:83], v[120:123], v[108:111], v[80:83]
    ds_read_b64_tr_b16 v[154:155], v170 offset:4608
    v_mfma_f32_16x16x32_bf16 v[84:87], v[124:127], v[108:111], v[84:87]
    ds_read_b64_tr_b16 v[156:157], v171 offset:4096
    v_mfma_f32_16x16x32_bf16 v[88:91], v[120:123], v[112:115], v[88:91]
    ds_read_b64_tr_b16 v[158:159], v171 offset:4608
    v_mfma_f32_16x16x32_bf16 v[92:95], v[124:127], v[112:115], v[92:95]
    ds_read_b128 v[140:143], v169 offset:2048
    v_mfma_f32_16x16x32_bf16 v[96:99], v[120:123], v[116:119], v[96:99]
    ds_read_b128 v[144:147], v169 offset:4096
    v_mfma_f32_16x16x32_bf16 v[100:103], v[124:127], v[116:119], v[100:103]
    ds_read_b128 v[148:151], v169 offset:6144
    s_waitcnt lgkmcnt(0)
    s_barrier
    v_mfma_f32_16x16x32_bf16 v[72:75], v[152:155], v[136:139], v[72:75]
    ds_read_b128 v[104:107], v168 offset:16384
    v_mfma_f32_16x16x32_bf16 v[76:79], v[156:159], v[136:139], v[76:79]
    ds_read_b64_tr_b16 v[120:121], v170 offset:8192
    v_mfma_f32_16x16x32_bf16 v[80:83], v[152:155], v[140:143], v[80:83]
    ds_read_b64_tr_b16 v[122:123], v170 offset:8704
    v_mfma_f32_16x16x32_bf16 v[84:87], v[156:159], v[140:143], v[84:87]
    ds_read_b64_tr_b16 v[124:125], v171 offset:8192
    v_mfma_f32_16x16x32_bf16 v[88:91], v[152:155], v[144:147], v[88:91]
    ds_read_b64_tr_b16 v[126:127], v171 offset:8704
    v_mfma_f32_16x16x32_bf16 v[92:95], v[156:159], v[144:147], v[92:95]
    ds_read_b128 v[108:111], v168 offset:18432
    v_mfma_f32_16x16x32_bf16 v[96:99], v[152:155], v[148:151], v[96:99]
    ds_read_b128 v[112:115], v168 offset:20480
    v_mfma_f32_16x16x32_bf16 v[100:103], v[156:159], v[148:151], v[100:103]
    ds_read_b128 v[116:119], v168 offset:22528
    s_waitcnt lgkmcnt(0)
    v_mfma_f32_16x16x32_bf16 v[72:75], v[120:123], v[104:107], v[72:75]
    ds_read_b128 v[136:139], v169 offset:16384
    v_mfma_f32_16x16x32_bf16 v[76:79], v[124:127], v[104:107], v[76:79]
    ds_read_b64_tr_b16 v[152:153], v170 offset:12288
    v_mfma_f32_16x16x32_bf16 v[80:83], v[120:123], v[108:111], v[80:83]
    ds_read_b64_tr_b16 v[154:155], v170 offset:12800
    v_mfma_f32_16x16x32_bf16 v[84:87], v[124:127], v[108:111], v[84:87]
    ds_read_b64_tr_b16 v[156:157], v171 offset:12288
    v_mfma_f32_16x16x32_bf16 v[88:91], v[120:123], v[112:115], v[88:91]
    ds_read_b64_tr_b16 v[158:159], v171 offset:12800
    v_mfma_f32_16x16x32_bf16 v[92:95], v[124:127], v[112:115], v[92:95]
    ds_read_b128 v[140:143], v169 offset:18432
    v_mfma_f32_16x16x32_bf16 v[96:99], v[120:123], v[116:119], v[96:99]
    ds_read_b128 v[144:147], v169 offset:20480
    v_mfma_f32_16x16x32_bf16 v[100:103], v[124:127], v[116:119], v[100:103]
    ds_read_b128 v[148:151], v169 offset:22528
    s_waitcnt lgkmcnt(0)
    s_barrier
    v_mfma_f32_16x16x32_bf16 v[72:75], v[152:155], v[136:139], v[72:75]
    ds_read_b128 v[104:107], v168 offset:32768
    v_mfma_f32_16x16x32_bf16 v[76:79], v[156:159], v[136:139], v[76:79]
    ds_read_b64_tr_b16 v[120:121], v170 offset:16384
    v_mfma_f32_16x16x32_bf16 v[80:83], v[152:155], v[140:143], v[80:83]
    ds_read_b64_tr_b16 v[122:123], v170 offset:16896
    v_mfma_f32_16x16x32_bf16 v[84:87], v[156:159], v[140:143], v[84:87]
    ds_read_b64_tr_b16 v[124:125], v171 offset:16384
    v_mfma_f32_16x16x32_bf16 v[88:91], v[152:155], v[144:147], v[88:91]
    ds_read_b64_tr_b16 v[126:127], v171 offset:16896
    v_mfma_f32_16x16x32_bf16 v[92:95], v[156:159], v[144:147], v[92:95]
    ds_read_b128 v[108:111], v168 offset:34816
    v_mfma_f32_16x16x32_bf16 v[96:99], v[152:155], v[148:151], v[96:99]
    ds_read_b128 v[112:115], v168 offset:36864
    v_mfma_f32_16x16x32_bf16 v[100:103], v[156:159], v[148:151], v[100:103]
    ds_read_b128 v[116:119], v168 offset:38912
    s_waitcnt lgkmcnt(0)
    v_mfma_f32_16x16x32_bf16 v[72:75], v[120:123], v[104:107], v[72:75]
    ds_read_b128 v[136:139], v169 offset:32768
    v_mfma_f32_16x16x32_bf16 v[76:79], v[124:127], v[104:107], v[76:79]
    ds_read_b64_tr_b16 v[152:153], v170 offset:20480
    v_mfma_f32_16x16x32_bf16 v[80:83], v[120:123], v[108:111], v[80:83]
    ds_read_b64_tr_b16 v[154:155], v170 offset:20992
    v_mfma_f32_16x16x32_bf16 v[84:87], v[124:127], v[108:111], v[84:87]
    ds_read_b64_tr_b16 v[156:157], v171 offset:20480
    v_mfma_f32_16x16x32_bf16 v[88:91], v[120:123], v[112:115], v[88:91]
    ds_read_b64_tr_b16 v[158:159], v171 offset:20992
    v_mfma_f32_16x16x32_bf16 v[92:95], v[124:127], v[112:115], v[92:95]
    ds_read_b128 v[140:143], v169 offset:34816
    v_mfma_f32_16x16x32_bf16 v[96:99], v[120:123], v[116:119], v[96:99]
    ds_read_b128 v[144:147], v169 offset:36864
    v_mfma_f32_16x16x32_bf16 v[100:103], v[124:127], v[116:119], v[100:103]
    ds_read_b128 v[148:151], v169 offset:38912
    s_waitcnt lgkmcnt(0)
    s_barrier
    v_mfma_f32_16x16x32_bf16 v[72:75], v[152:155], v[136:139], v[72:75]
    ds_read_b128 v[104:107], v168 offset:49152
    v_mfma_f32_16x16x32_bf16 v[76:79], v[156:159], v[136:139], v[76:79]
    ds_read_b64_tr_b16 v[120:121], v170 offset:24576
    v_mfma_f32_16x16x32_bf16 v[80:83], v[152:155], v[140:143], v[80:83]
    ds_read_b64_tr_b16 v[122:123], v170 offset:25088
    v_mfma_f32_16x16x32_bf16 v[84:87], v[156:159], v[140:143], v[84:87]
    ds_read_b64_tr_b16 v[124:125], v171 offset:24576
    v_mfma_f32_16x16x32_bf16 v[88:91], v[152:155], v[144:147], v[88:91]
    ds_read_b64_tr_b16 v[126:127], v171 offset:25088
    v_mfma_f32_16x16x32_bf16 v[92:95], v[156:159], v[144:147], v[92:95]
    ds_read_b128 v[108:111], v168 offset:51200
    v_mfma_f32_16x16x32_bf16 v[96:99], v[152:155], v[148:151], v[96:99]
    ds_read_b128 v[112:115], v168 offset:53248
    v_mfma_f32_16x16x32_bf16 v[100:103], v[156:159], v[148:151], v[100:103]
    ds_read_b128 v[116:119], v168 offset:55296
    s_waitcnt lgkmcnt(0)
    v_mfma_f32_16x16x32_bf16 v[72:75], v[120:123], v[104:107], v[72:75]
    ds_read_b128 v[136:139], v169 offset:49152
    v_mfma_f32_16x16x32_bf16 v[76:79], v[124:127], v[104:107], v[76:79]
    ds_read_b64_tr_b16 v[152:153], v170 offset:28672
    v_mfma_f32_16x16x32_bf16 v[80:83], v[120:123], v[108:111], v[80:83]
    ds_read_b64_tr_b16 v[154:155], v170 offset:29184
    v_mfma_f32_16x16x32_bf16 v[84:87], v[124:127], v[108:111], v[84:87]
    ds_read_b64_tr_b16 v[156:157], v171 offset:28672
    v_mfma_f32_16x16x32_bf16 v[88:91], v[120:123], v[112:115], v[88:91]
    ds_read_b64_tr_b16 v[158:159], v171 offset:29184
    v_mfma_f32_16x16x32_bf16 v[92:95], v[124:127], v[112:115], v[92:95]
    ds_read_b128 v[140:143], v169 offset:51200
    v_mfma_f32_16x16x32_bf16 v[96:99], v[120:123], v[116:119], v[96:99]
    ds_read_b128 v[144:147], v169 offset:53248
    v_mfma_f32_16x16x32_bf16 v[100:103], v[124:127], v[116:119], v[100:103]
    ds_read_b128 v[148:151], v169 offset:55296
    s_waitcnt lgkmcnt(0)
    s_barrier
    v_mfma_f32_16x16x32_bf16 v[72:75], v[152:155], v[136:139], v[72:75]
    ds_read_b128 v[104:107], v168 offset:0
    v_mfma_f32_16x16x32_bf16 v[76:79], v[156:159], v[136:139], v[76:79]
    ds_read_b64_tr_b16 v[120:121], v170 offset:32768
    v_mfma_f32_16x16x32_bf16 v[80:83], v[152:155], v[140:143], v[80:83]
    ds_read_b64_tr_b16 v[122:123], v170 offset:33280
    v_mfma_f32_16x16x32_bf16 v[84:87], v[156:159], v[140:143], v[84:87]
    ds_read_b64_tr_b16 v[124:125], v171 offset:32768
    v_mfma_f32_16x16x32_bf16 v[88:91], v[152:155], v[144:147], v[88:91]
    ds_read_b64_tr_b16 v[126:127], v171 offset:33280
    v_mfma_f32_16x16x32_bf16 v[92:95], v[156:159], v[144:147], v[92:95]
    ds_read_b128 v[108:111], v168 offset:2048
    v_mfma_f32_16x16x32_bf16 v[96:99], v[152:155], v[148:151], v[96:99]
    ds_read_b128 v[112:115], v168 offset:4096
    v_mfma_f32_16x16x32_bf16 v[100:103], v[156:159], v[148:151], v[100:103]
    ds_read_b128 v[116:119], v168 offset:6144
    s_waitcnt lgkmcnt(0)
    v_mfma_f32_16x16x32_bf16 v[72:75], v[120:123], v[104:107], v[72:75]
    ds_read_b128 v[136:139], v169 offset:0
    v_mfma_f32_16x16x32_bf16 v[76:79], v[124:127], v[104:107], v[76:79]
    ds_read_b64_tr_b16 v[152:153], v170 offset:36864
    v_mfma_f32_16x16x32_bf16 v[80:83], v[120:123], v[108:111], v[80:83]
    ds_read_b64_tr_b16 v[154:155], v170 offset:37376
    v_mfma_f32_16x16x32_bf16 v[84:87], v[124:127], v[108:111], v[84:87]
    ds_read_b64_tr_b16 v[156:157], v171 offset:36864
    v_mfma_f32_16x16x32_bf16 v[88:91], v[120:123], v[112:115], v[88:91]
    ds_read_b64_tr_b16 v[158:159], v171 offset:37376
    v_mfma_f32_16x16x32_bf16 v[92:95], v[124:127], v[112:115], v[92:95]
    ds_read_b128 v[140:143], v169 offset:2048
    v_mfma_f32_16x16x32_bf16 v[96:99], v[120:123], v[116:119], v[96:99]
    ds_read_b128 v[144:147], v169 offset:4096
    v_mfma_f32_16x16x32_bf16 v[100:103], v[124:127], v[116:119], v[100:103]
    ds_read_b128 v[148:151], v169 offset:6144
    s_waitcnt lgkmcnt(0)
    s_barrier
    v_mfma_f32_16x16x32_bf16 v[72:75], v[152:155], v[136:139], v[72:75]
    ds_read_b128 v[104:107], v168 offset:16384
    v_mfma_f32_16x16x32_bf16 v[76:79], v[156:159], v[136:139], v[76:79]
    ds_read_b64_tr_b16 v[120:121], v170 offset:40960
    v_mfma_f32_16x16x32_bf16 v[80:83], v[152:155], v[140:143], v[80:83]
    ds_read_b64_tr_b16 v[122:123], v170 offset:41472
    v_mfma_f32_16x16x32_bf16 v[84:87], v[156:159], v[140:143], v[84:87]
    ds_read_b64_tr_b16 v[124:125], v171 offset:40960
    v_mfma_f32_16x16x32_bf16 v[88:91], v[152:155], v[144:147], v[88:91]
    ds_read_b64_tr_b16 v[126:127], v171 offset:41472
    v_mfma_f32_16x16x32_bf16 v[92:95], v[156:159], v[144:147], v[92:95]
    ds_read_b128 v[108:111], v168 offset:18432
    v_mfma_f32_16x16x32_bf16 v[96:99], v[152:155], v[148:151], v[96:99]
    ds_read_b128 v[112:115], v168 offset:20480
    v_mfma_f32_16x16x32_bf16 v[100:103], v[156:159], v[148:151], v[100:103]
    ds_read_b128 v[116:119], v168 offset:22528
    s_waitcnt lgkmcnt(0)
    v_mfma_f32_16x16x32_bf16 v[72:75], v[120:123], v[104:107], v[72:75]
    ds_read_b128 v[136:139], v169 offset:16384
    v_mfma_f32_16x16x32_bf16 v[76:79], v[124:127], v[104:107], v[76:79]
    ds_read_b64_tr_b16 v[152:153], v170 offset:45056
    v_mfma_f32_16x16x32_bf16 v[80:83], v[120:123], v[108:111], v[80:83]
    ds_read_b64_tr_b16 v[154:155], v170 offset:45568
    v_mfma_f32_16x16x32_bf16 v[84:87], v[124:127], v[108:111], v[84:87]
    ds_read_b64_tr_b16 v[156:157], v171 offset:45056
    v_mfma_f32_16x16x32_bf16 v[88:91], v[120:123], v[112:115], v[88:91]
    ds_read_b64_tr_b16 v[158:159], v171 offset:45568
    v_mfma_f32_16x16x32_bf16 v[92:95], v[124:127], v[112:115], v[92:95]
    ds_read_b128 v[140:143], v169 offset:18432
    v_mfma_f32_16x16x32_bf16 v[96:99], v[120:123], v[116:119], v[96:99]
    ds_read_b128 v[144:147], v169 offset:20480
    v_mfma_f32_16x16x32_bf16 v[100:103], v[124:127], v[116:119], v[100:103]
    ds_read_b128 v[148:151], v169 offset:22528
    s_waitcnt lgkmcnt(0)
    s_barrier
    v_mfma_f32_16x16x32_bf16 v[72:75], v[152:155], v[136:139], v[72:75]
    ds_read_b128 v[104:107], v168 offset:32768
    v_mfma_f32_16x16x32_bf16 v[76:79], v[156:159], v[136:139], v[76:79]
    ds_read_b64_tr_b16 v[120:121], v170 offset:49152
    v_mfma_f32_16x16x32_bf16 v[80:83], v[152:155], v[140:143], v[80:83]
    ds_read_b64_tr_b16 v[122:123], v170 offset:49664
    v_mfma_f32_16x16x32_bf16 v[84:87], v[156:159], v[140:143], v[84:87]
    ds_read_b64_tr_b16 v[124:125], v171 offset:49152
    v_mfma_f32_16x16x32_bf16 v[88:91], v[152:155], v[144:147], v[88:91]
    ds_read_b64_tr_b16 v[126:127], v171 offset:49664
    v_mfma_f32_16x16x32_bf16 v[92:95], v[156:159], v[144:147], v[92:95]
    ds_read_b128 v[108:111], v168 offset:34816
    v_mfma_f32_16x16x32_bf16 v[96:99], v[152:155], v[148:151], v[96:99]
    ds_read_b128 v[112:115], v168 offset:36864
    v_mfma_f32_16x16x32_bf16 v[100:103], v[156:159], v[148:151], v[100:103]
    ds_read_b128 v[116:119], v168 offset:38912
    s_waitcnt lgkmcnt(0)
    v_mfma_f32_16x16x32_bf16 v[72:75], v[120:123], v[104:107], v[72:75]
    ds_read_b128 v[136:139], v169 offset:32768
    v_mfma_f32_16x16x32_bf16 v[76:79], v[124:127], v[104:107], v[76:79]
    ds_read_b64_tr_b16 v[152:153], v170 offset:53248
    v_mfma_f32_16x16x32_bf16 v[80:83], v[120:123], v[108:111], v[80:83]
    ds_read_b64_tr_b16 v[154:155], v170 offset:53760
    v_mfma_f32_16x16x32_bf16 v[84:87], v[124:127], v[108:111], v[84:87]
    ds_read_b64_tr_b16 v[156:157], v171 offset:53248
    v_mfma_f32_16x16x32_bf16 v[88:91], v[120:123], v[112:115], v[88:91]
    ds_read_b64_tr_b16 v[158:159], v171 offset:53760
    v_mfma_f32_16x16x32_bf16 v[92:95], v[124:127], v[112:115], v[92:95]
    ds_read_b128 v[140:143], v169 offset:34816
    v_mfma_f32_16x16x32_bf16 v[96:99], v[120:123], v[116:119], v[96:99]
    ds_read_b128 v[144:147], v169 offset:36864
    v_mfma_f32_16x16x32_bf16 v[100:103], v[124:127], v[116:119], v[100:103]
    ds_read_b128 v[148:151], v169 offset:38912
    s_waitcnt lgkmcnt(0)
    s_barrier
    v_mfma_f32_16x16x32_bf16 v[72:75], v[152:155], v[136:139], v[72:75]
    ds_read_b128 v[104:107], v168 offset:49152
    v_mfma_f32_16x16x32_bf16 v[76:79], v[156:159], v[136:139], v[76:79]
    ds_read_b64_tr_b16 v[120:121], v170 offset:57344
    v_mfma_f32_16x16x32_bf16 v[80:83], v[152:155], v[140:143], v[80:83]
    ds_read_b64_tr_b16 v[122:123], v170 offset:57856
    v_mfma_f32_16x16x32_bf16 v[84:87], v[156:159], v[140:143], v[84:87]
    ds_read_b64_tr_b16 v[124:125], v171 offset:57344
    v_mfma_f32_16x16x32_bf16 v[88:91], v[152:155], v[144:147], v[88:91]
    ds_read_b64_tr_b16 v[126:127], v171 offset:57856
    v_mfma_f32_16x16x32_bf16 v[92:95], v[156:159], v[144:147], v[92:95]
    ds_read_b128 v[108:111], v168 offset:51200
    v_mfma_f32_16x16x32_bf16 v[96:99], v[152:155], v[148:151], v[96:99]
    ds_read_b128 v[112:115], v168 offset:53248
    v_mfma_f32_16x16x32_bf16 v[100:103], v[156:159], v[148:151], v[100:103]
    ds_read_b128 v[116:119], v168 offset:55296
    s_waitcnt lgkmcnt(0)
    v_mfma_f32_16x16x32_bf16 v[72:75], v[120:123], v[104:107], v[72:75]
    ds_read_b128 v[136:139], v169 offset:49152
    v_mfma_f32_16x16x32_bf16 v[76:79], v[124:127], v[104:107], v[76:79]
    ds_read_b64_tr_b16 v[152:153], v170 offset:61440
    v_mfma_f32_16x16x32_bf16 v[80:83], v[120:123], v[108:111], v[80:83]
    ds_read_b64_tr_b16 v[154:155], v170 offset:61952
    v_mfma_f32_16x16x32_bf16 v[84:87], v[124:127], v[108:111], v[84:87]
    ds_read_b64_tr_b16 v[156:157], v171 offset:61440
    v_mfma_f32_16x16x32_bf16 v[88:91], v[120:123], v[112:115], v[88:91]
    ds_read_b64_tr_b16 v[158:159], v171 offset:61952
    v_mfma_f32_16x16x32_bf16 v[92:95], v[124:127], v[112:115], v[92:95]
    ds_read_b128 v[140:143], v169 offset:51200
    v_mfma_f32_16x16x32_bf16 v[96:99], v[120:123], v[116:119], v[96:99]
    ds_read_b128 v[144:147], v169 offset:53248
    v_mfma_f32_16x16x32_bf16 v[100:103], v[124:127], v[116:119], v[100:103]
    ds_read_b128 v[148:151], v169 offset:55296
    s_waitcnt lgkmcnt(0)
    s_barrier
    v_mfma_f32_16x16x32_bf16 v[72:75], v[152:155], v[136:139], v[72:75]
    ds_read_b128 v[104:107], v168 offset:0
    v_mfma_f32_16x16x32_bf16 v[76:79], v[156:159], v[136:139], v[76:79]
    ds_read_b64_tr_b16 v[120:121], v170 offset:0
    v_mfma_f32_16x16x32_bf16 v[80:83], v[152:155], v[140:143], v[80:83]
    ds_read_b64_tr_b16 v[122:123], v170 offset:512
    v_mfma_f32_16x16x32_bf16 v[84:87], v[156:159], v[140:143], v[84:87]
    ds_read_b64_tr_b16 v[124:125], v171 offset:0
    v_mfma_f32_16x16x32_bf16 v[88:91], v[152:155], v[144:147], v[88:91]
    ds_read_b64_tr_b16 v[126:127], v171 offset:512
    v_mfma_f32_16x16x32_bf16 v[92:95], v[156:159], v[144:147], v[92:95]
    ds_read_b128 v[108:111], v168 offset:2048
    v_mfma_f32_16x16x32_bf16 v[96:99], v[152:155], v[148:151], v[96:99]
    ds_read_b128 v[112:115], v168 offset:4096
    v_mfma_f32_16x16x32_bf16 v[100:103], v[156:159], v[148:151], v[100:103]
    ds_read_b128 v[116:119], v168 offset:6144
    s_waitcnt lgkmcnt(0)
    v_mfma_f32_16x16x32_bf16 v[72:75], v[120:123], v[104:107], v[72:75]
    ds_read_b128 v[136:139], v169 offset:0
    v_mfma_f32_16x16x32_bf16 v[76:79], v[124:127], v[104:107], v[76:79]
    ds_read_b64_tr_b16 v[152:153], v170 offset:4096
    v_mfma_f32_16x16x32_bf16 v[80:83], v[120:123], v[108:111], v[80:83]
    ds_read_b64_tr_b16 v[154:155], v170 offset:4608
    v_mfma_f32_16x16x32_bf16 v[84:87], v[124:127], v[108:111], v[84:87]
    ds_read_b64_tr_b16 v[156:157], v171 offset:4096
    v_mfma_f32_16x16x32_bf16 v[88:91], v[120:123], v[112:115], v[88:91]
    ds_read_b64_tr_b16 v[158:159], v171 offset:4608
    v_mfma_f32_16x16x32_bf16 v[92:95], v[124:127], v[112:115], v[92:95]
    ds_read_b128 v[140:143], v169 offset:2048
    v_mfma_f32_16x16x32_bf16 v[96:99], v[120:123], v[116:119], v[96:99]
    ds_read_b128 v[144:147], v169 offset:4096
    v_mfma_f32_16x16x32_bf16 v[100:103], v[124:127], v[116:119], v[100:103]
    ds_read_b128 v[148:151], v169 offset:6144
    s_waitcnt lgkmcnt(0)
    s_barrier
    v_mfma_f32_16x16x32_bf16 v[72:75], v[152:155], v[136:139], v[72:75]
    ds_read_b128 v[104:107], v168 offset:16384
    v_mfma_f32_16x16x32_bf16 v[76:79], v[156:159], v[136:139], v[76:79]
    ds_read_b64_tr_b16 v[120:121], v170 offset:8192
    v_mfma_f32_16x16x32_bf16 v[80:83], v[152:155], v[140:143], v[80:83]
    ds_read_b64_tr_b16 v[122:123], v170 offset:8704
    v_mfma_f32_16x16x32_bf16 v[84:87], v[156:159], v[140:143], v[84:87]
    ds_read_b64_tr_b16 v[124:125], v171 offset:8192
    v_mfma_f32_16x16x32_bf16 v[88:91], v[152:155], v[144:147], v[88:91]
    ds_read_b64_tr_b16 v[126:127], v171 offset:8704
    v_mfma_f32_16x16x32_bf16 v[92:95], v[156:159], v[144:147], v[92:95]
    ds_read_b128 v[108:111], v168 offset:18432
    v_mfma_f32_16x16x32_bf16 v[96:99], v[152:155], v[148:151], v[96:99]
    ds_read_b128 v[112:115], v168 offset:20480
    v_mfma_f32_16x16x32_bf16 v[100:103], v[156:159], v[148:151], v[100:103]
    ds_read_b128 v[116:119], v168 offset:22528
    s_waitcnt lgkmcnt(0)
    v_mfma_f32_16x16x32_bf16 v[72:75], v[120:123], v[104:107], v[72:75]
    ds_read_b128 v[136:139], v169 offset:16384
    v_mfma_f32_16x16x32_bf16 v[76:79], v[124:127], v[104:107], v[76:79]
    ds_read_b64_tr_b16 v[152:153], v170 offset:12288
    v_mfma_f32_16x16x32_bf16 v[80:83], v[120:123], v[108:111], v[80:83]
    ds_read_b64_tr_b16 v[154:155], v170 offset:12800
    v_mfma_f32_16x16x32_bf16 v[84:87], v[124:127], v[108:111], v[84:87]
    ds_read_b64_tr_b16 v[156:157], v171 offset:12288
    v_mfma_f32_16x16x32_bf16 v[88:91], v[120:123], v[112:115], v[88:91]
    ds_read_b64_tr_b16 v[158:159], v171 offset:12800
    v_mfma_f32_16x16x32_bf16 v[92:95], v[124:127], v[112:115], v[92:95]
    ds_read_b128 v[140:143], v169 offset:18432
    v_mfma_f32_16x16x32_bf16 v[96:99], v[120:123], v[116:119], v[96:99]
    ds_read_b128 v[144:147], v169 offset:20480
    v_mfma_f32_16x16x32_bf16 v[100:103], v[124:127], v[116:119], v[100:103]
    ds_read_b128 v[148:151], v169 offset:22528
    s_waitcnt lgkmcnt(0)
    s_barrier
    v_mfma_f32_16x16x32_bf16 v[72:75], v[152:155], v[136:139], v[72:75]
    ds_read_b128 v[104:107], v168 offset:32768
    v_mfma_f32_16x16x32_bf16 v[76:79], v[156:159], v[136:139], v[76:79]
    ds_read_b64_tr_b16 v[120:121], v170 offset:16384
    v_mfma_f32_16x16x32_bf16 v[80:83], v[152:155], v[140:143], v[80:83]
    ds_read_b64_tr_b16 v[122:123], v170 offset:16896
    v_mfma_f32_16x16x32_bf16 v[84:87], v[156:159], v[140:143], v[84:87]
    ds_read_b64_tr_b16 v[124:125], v171 offset:16384
    v_mfma_f32_16x16x32_bf16 v[88:91], v[152:155], v[144:147], v[88:91]
    ds_read_b64_tr_b16 v[126:127], v171 offset:16896
    v_mfma_f32_16x16x32_bf16 v[92:95], v[156:159], v[144:147], v[92:95]
    ds_read_b128 v[108:111], v168 offset:34816
    v_mfma_f32_16x16x32_bf16 v[96:99], v[152:155], v[148:151], v[96:99]
    ds_read_b128 v[112:115], v168 offset:36864
    v_mfma_f32_16x16x32_bf16 v[100:103], v[156:159], v[148:151], v[100:103]
    ds_read_b128 v[116:119], v168 offset:38912
    s_waitcnt lgkmcnt(0)
    v_mfma_f32_16x16x32_bf16 v[72:75], v[120:123], v[104:107], v[72:75]
    ds_read_b128 v[136:139], v169 offset:32768
    v_mfma_f32_16x16x32_bf16 v[76:79], v[124:127], v[104:107], v[76:79]
    ds_read_b64_tr_b16 v[152:153], v170 offset:20480
    v_mfma_f32_16x16x32_bf16 v[80:83], v[120:123], v[108:111], v[80:83]
    ds_read_b64_tr_b16 v[154:155], v170 offset:20992
    v_mfma_f32_16x16x32_bf16 v[84:87], v[124:127], v[108:111], v[84:87]
    ds_read_b64_tr_b16 v[156:157], v171 offset:20480
    v_mfma_f32_16x16x32_bf16 v[88:91], v[120:123], v[112:115], v[88:91]
    ds_read_b64_tr_b16 v[158:159], v171 offset:20992
    v_mfma_f32_16x16x32_bf16 v[92:95], v[124:127], v[112:115], v[92:95]
    ds_read_b128 v[140:143], v169 offset:34816
    v_mfma_f32_16x16x32_bf16 v[96:99], v[120:123], v[116:119], v[96:99]
    ds_read_b128 v[144:147], v169 offset:36864
    v_mfma_f32_16x16x32_bf16 v[100:103], v[124:127], v[116:119], v[100:103]
    ds_read_b128 v[148:151], v169 offset:38912
    s_waitcnt lgkmcnt(0)
    s_barrier
    v_mfma_f32_16x16x32_bf16 v[72:75], v[152:155], v[136:139], v[72:75]
    ds_read_b128 v[104:107], v168 offset:49152
    v_mfma_f32_16x16x32_bf16 v[76:79], v[156:159], v[136:139], v[76:79]
    ds_read_b64_tr_b16 v[120:121], v170 offset:24576
    v_mfma_f32_16x16x32_bf16 v[80:83], v[152:155], v[140:143], v[80:83]
    ds_read_b64_tr_b16 v[122:123], v170 offset:25088
    v_mfma_f32_16x16x32_bf16 v[84:87], v[156:159], v[140:143], v[84:87]
    ds_read_b64_tr_b16 v[124:125], v171 offset:24576
    v_mfma_f32_16x16x32_bf16 v[88:91], v[152:155], v[144:147], v[88:91]
    ds_read_b64_tr_b16 v[126:127], v171 offset:25088
    v_mfma_f32_16x16x32_bf16 v[92:95], v[156:159], v[144:147], v[92:95]
    ds_read_b128 v[108:111], v168 offset:51200
    v_mfma_f32_16x16x32_bf16 v[96:99], v[152:155], v[148:151], v[96:99]
    ds_read_b128 v[112:115], v168 offset:53248
    v_mfma_f32_16x16x32_bf16 v[100:103], v[156:159], v[148:151], v[100:103]
    ds_read_b128 v[116:119], v168 offset:55296
    s_waitcnt lgkmcnt(0)
    v_mfma_f32_16x16x32_bf16 v[72:75], v[120:123], v[104:107], v[72:75]
    ds_read_b128 v[136:139], v169 offset:49152
    v_mfma_f32_16x16x32_bf16 v[76:79], v[124:127], v[104:107], v[76:79]
    ds_read_b64_tr_b16 v[152:153], v170 offset:28672
    v_mfma_f32_16x16x32_bf16 v[80:83], v[120:123], v[108:111], v[80:83]
    ds_read_b64_tr_b16 v[154:155], v170 offset:29184
    v_mfma_f32_16x16x32_bf16 v[84:87], v[124:127], v[108:111], v[84:87]
    ds_read_b64_tr_b16 v[156:157], v171 offset:28672
    v_mfma_f32_16x16x32_bf16 v[88:91], v[120:123], v[112:115], v[88:91]
    ds_read_b64_tr_b16 v[158:159], v171 offset:29184
    v_mfma_f32_16x16x32_bf16 v[92:95], v[124:127], v[112:115], v[92:95]
    ds_read_b128 v[140:143], v169 offset:51200
    v_mfma_f32_16x16x32_bf16 v[96:99], v[120:123], v[116:119], v[96:99]
    ds_read_b128 v[144:147], v169 offset:53248
    v_mfma_f32_16x16x32_bf16 v[100:103], v[124:127], v[116:119], v[100:103]
    ds_read_b128 v[148:151], v169 offset:55296
    s_waitcnt lgkmcnt(0)
    v_mov_b32 v7, 12
    ds_write_b32 v6, v7
    v_mfma_f32_16x16x32_bf16 v[72:75], v[152:155], v[136:139], v[72:75]
    ds_read_b128 v[104:107], v168 offset:0
    v_mfma_f32_16x16x32_bf16 v[76:79], v[156:159], v[136:139], v[76:79]
    ds_read_b64_tr_b16 v[120:121], v170 offset:32768
    v_mfma_f32_16x16x32_bf16 v[80:83], v[152:155], v[140:143], v[80:83]
    ds_read_b64_tr_b16 v[122:123], v170 offset:33280
    v_mfma_f32_16x16x32_bf16 v[84:87], v[156:159], v[140:143], v[84:87]
    ds_read_b64_tr_b16 v[124:125], v171 offset:32768
    v_mfma_f32_16x16x32_bf16 v[88:91], v[152:155], v[144:147], v[88:91]
    ds_read_b64_tr_b16 v[126:127], v171 offset:33280
    v_mfma_f32_16x16x32_bf16 v[92:95], v[156:159], v[144:147], v[92:95]
    ds_read_b128 v[108:111], v168 offset:2048
    v_mfma_f32_16x16x32_bf16 v[96:99], v[152:155], v[148:151], v[96:99]
    ds_read_b128 v[112:115], v168 offset:4096
    v_mfma_f32_16x16x32_bf16 v[100:103], v[156:159], v[148:151], v[100:103]
    ds_read_b128 v[116:119], v168 offset:6144
    s_waitcnt lgkmcnt(0)
    v_mfma_f32_16x16x32_bf16 v[72:75], v[120:123], v[104:107], v[72:75]
    ds_read_b128 v[136:139], v169 offset:0
    v_mfma_f32_16x16x32_bf16 v[76:79], v[124:127], v[104:107], v[76:79]
    ds_read_b64_tr_b16 v[152:153], v170 offset:36864
    v_mfma_f32_16x16x32_bf16 v[80:83], v[120:123], v[108:111], v[80:83]
    ds_read_b64_tr_b16 v[154:155], v170 offset:37376
    v_mfma_f32_16x16x32_bf16 v[84:87], v[124:127], v[108:111], v[84:87]
    ds_read_b64_tr_b16 v[156:157], v171 offset:36864
    v_mfma_f32_16x16x32_bf16 v[88:91], v[120:123], v[112:115], v[88:91]
    ds_read_b64_tr_b16 v[158:159], v171 offset:37376
    v_mfma_f32_16x16x32_bf16 v[92:95], v[124:127], v[112:115], v[92:95]
    ds_read_b128 v[140:143], v169 offset:2048
    v_mfma_f32_16x16x32_bf16 v[96:99], v[120:123], v[116:119], v[96:99]
    ds_read_b128 v[144:147], v169 offset:4096
    v_mfma_f32_16x16x32_bf16 v[100:103], v[124:127], v[116:119], v[100:103]
    ds_read_b128 v[148:151], v169 offset:6144
    ds_read_b128 v[8:11], v247 offset:32
    s_waitcnt lgkmcnt(0)
    v_mov_b32 v7, 13
    ds_write_b32 v6, v7
L_la:
    v_and_b32 v8, v8, v9
    v_and_b32 v10, v10, v11
    v_and_b32 v8, v8, v10
    s_nop 0
    v_readfirstlane_b32 s3, v8
    s_nop 0
    s_cmp_eq_u32 s3, 1
    s_cbranch_scc1 L_lad
    ds_read_b128 v[8:11], v247 offset:32
    s_waitcnt lgkmcnt(0)
    s_branch L_la
L_lad:
    v_mfma_f32_16x16x32_bf16 v[72:75], v[152:155], v[136:139], v[72:75]
    ds_read_b128 v[104:107], v168 offset:16384
    v_mfma_f32_16x16x32_bf16 v[76:79], v[156:159], v[136:139], v[76:79]
    ds_read_b64_tr_b16 v[120:121], v170 offset:40960
    v_mfma_f32_16x16x32_bf16 v[80:83], v[152:155], v[140:143], v[80:83]
    ds_read_b64_tr_b16 v[122:123], v170 offset:41472
    v_mfma_f32_16x16x32_bf16 v[84:87], v[156:159], v[140:143], v[84:87]
    ds_read_b64_tr_b16 v[124:125], v171 offset:40960
    v_mfma_f32_16x16x32_bf16 v[88:91], v[152:155], v[144:147], v[88:91]
    ds_read_b64_tr_b16 v[126:127], v171 offset:41472
    v_mfma_f32_16x16x32_bf16 v[92:95], v[156:159], v[144:147], v[92:95]
    ds_read_b128 v[108:111], v168 offset:18432
    v_mfma_f32_16x16x32_bf16 v[96:99], v[152:155], v[148:151], v[96:99]
    ds_read_b128 v[112:115], v168 offset:20480
    v_mfma_f32_16x16x32_bf16 v[100:103], v[156:159], v[148:151], v[100:103]
    ds_read_b128 v[116:119], v168 offset:22528
    s_waitcnt lgkmcnt(0)
    v_mfma_f32_16x16x32_bf16 v[72:75], v[120:123], v[104:107], v[72:75]
    ds_read_b128 v[136:139], v169 offset:16384
    v_mfma_f32_16x16x32_bf16 v[76:79], v[124:127], v[104:107], v[76:79]
    ds_read_b64_tr_b16 v[152:153], v170 offset:45056
    v_mfma_f32_16x16x32_bf16 v[80:83], v[120:123], v[108:111], v[80:83]
    ds_read_b64_tr_b16 v[154:155], v170 offset:45568
    v_mfma_f32_16x16x32_bf16 v[84:87], v[124:127], v[108:111], v[84:87]
    ds_read_b64_tr_b16 v[156:157], v171 offset:45056
    v_mfma_f32_16x16x32_bf16 v[88:91], v[120:123], v[112:115], v[88:91]
    ds_read_b64_tr_b16 v[158:159], v171 offset:45568
    v_mfma_f32_16x16x32_bf16 v[92:95], v[124:127], v[112:115], v[92:95]
    ds_read_b128 v[140:143], v169 offset:18432
    v_mfma_f32_16x16x32_bf16 v[96:99], v[120:123], v[116:119], v[96:99]
    ds_read_b128 v[144:147], v169 offset:20480
    v_mfma_f32_16x16x32_bf16 v[100:103], v[124:127], v[116:119], v[100:103]
    ds_read_b128 v[148:151], v169 offset:22528
    v_add_u32 v168, 0x10000, v168
    v_add_u32 v169, 0x10000, v169
    s_waitcnt lgkmcnt(0)
    v_mov_b32 v7, 14
    ds_write_b32 v6, v7
    v_mfma_f32_16x16x32_bf16 v[72:75], v[152:155], v[136:139], v[72:75]
    ds_read_b128 v[104:107], v168 offset:0
    v_mfma_f32_16x16x32_bf16 v[76:79], v[156:159], v[136:139], v[76:79]
    ds_read_b64_tr_b16 v[120:121], v170 offset:49152
    v_mfma_f32_16x16x32_bf16 v[80:83], v[152:155], v[140:143], v[80:83]
    ds_read_b64_tr_b16 v[122:123], v170 offset:49664
    v_mfma_f32_16x16x32_bf16 v[84:87], v[156:159], v[140:143], v[84:87]
    ds_read_b64_tr_b16 v[124:125], v171 offset:49152
    v_mfma_f32_16x16x32_bf16 v[88:91], v[152:155], v[144:147], v[88:91]
    ds_read_b64_tr_b16 v[126:127], v171 offset:49664
    v_mfma_f32_16x16x32_bf16 v[92:95], v[156:159], v[144:147], v[92:95]
    ds_read_b128 v[108:111], v168 offset:2048
    v_mfma_f32_16x16x32_bf16 v[96:99], v[152:155], v[148:151], v[96:99]
    ds_read_b128 v[112:115], v168 offset:4096
    v_mfma_f32_16x16x32_bf16 v[100:103], v[156:159], v[148:151], v[100:103]
    ds_read_b128 v[116:119], v168 offset:6144
    s_waitcnt lgkmcnt(0)
    v_mfma_f32_16x16x32_bf16 v[72:75], v[120:123], v[104:107], v[72:75]
    ds_read_b128 v[136:139], v169 offset:0
    v_mfma_f32_16x16x32_bf16 v[76:79], v[124:127], v[104:107], v[76:79]
    ds_read_b64_tr_b16 v[152:153], v170 offset:53248
    v_mfma_f32_16x16x32_bf16 v[80:83], v[120:123], v[108:111], v[80:83]
    ds_read_b64_tr_b16 v[154:155], v170 offset:53760
    v_mfma_f32_16x16x32_bf16 v[84:87], v[124:127], v[108:111], v[84:87]
    ds_read_b64_tr_b16 v[156:157], v171 offset:53248
    v_mfma_f32_16x16x32_bf16 v[88:91], v[120:123], v[112:115], v[88:91]
    ds_read_b64_tr_b16 v[158:159], v171 offset:53760
    v_mfma_f32_16x16x32_bf16 v[92:95], v[124:127], v[112:115], v[92:95]
    ds_read_b128 v[140:143], v169 offset:2048
    v_mfma_f32_16x16x32_bf16 v[96:99], v[120:123], v[116:119], v[96:99]
    ds_read_b128 v[144:147], v169 offset:4096
    v_mfma_f32_16x16x32_bf16 v[100:103], v[124:127], v[116:119], v[100:103]
    ds_read_b128 v[148:151], v169 offset:6144
    v_subrev_u32 v168, 0x10000, v168
    v_subrev_u32 v169, 0x10000, v169
    s_waitcnt lgkmcnt(0)
    v_mov_b32 v7, 15
    ds_write_b32 v6, v7
    v_mfma_f32_16x16x32_bf16 v[72:75], v[152:155], v[136:139], v[72:75]
    ds_read_b128 v[104:107], v168 offset:32768
    v_mfma_f32_16x16x32_bf16 v[76:79], v[156:159], v[136:139], v[76:79]
    ds_read_b64_tr_b16 v[120:121], v170 offset:57344
    v_mfma_f32_16x16x32_bf16 v[80:83], v[152:155], v[140:143], v[80:83]
    ds_read_b64_tr_b16 v[122:123], v170 offset:57856
    v_mfma_f32_16x16x32_bf16 v[84:87], v[156:159], v[140:143], v[84:87]
    ds_read_b64_tr_b16 v[124:125], v171 offset:57344
    v_mfma_f32_16x16x32_bf16 v[88:91], v[152:155], v[144:147], v[88:91]
    ds_read_b64_tr_b16 v[126:127], v171 offset:57856
    v_mfma_f32_16x16x32_bf16 v[92:95], v[156:159], v[144:147], v[92:95]
    ds_read_b128 v[108:111], v168 offset:34816
    v_mfma_f32_16x16x32_bf16 v[96:99], v[152:155], v[148:151], v[96:99]
    ds_read_b128 v[112:115], v168 offset:36864
    v_mfma_f32_16x16x32_bf16 v[100:103], v[156:159], v[148:151], v[100:103]
    ds_read_b128 v[116:119], v168 offset:38912
    s_waitcnt lgkmcnt(0)
    v_mfma_f32_16x16x32_bf16 v[72:75], v[120:123], v[104:107], v[72:75]
    ds_read_b128 v[136:139], v169 offset:32768
    v_mfma_f32_16x16x32_bf16 v[76:79], v[124:127], v[104:107], v[76:79]
    ds_read_b64_tr_b16 v[152:153], v170 offset:61440
    v_mfma_f32_16x16x32_bf16 v[80:83], v[120:123], v[108:111], v[80:83]
    ds_read_b64_tr_b16 v[154:155], v170 offset:61952
    v_mfma_f32_16x16x32_bf16 v[84:87], v[124:127], v[108:111], v[84:87]
    ds_read_b64_tr_b16 v[156:157], v171 offset:61440
    v_mfma_f32_16x16x32_bf16 v[88:91], v[120:123], v[112:115], v[88:91]
    ds_read_b64_tr_b16 v[158:159], v171 offset:61952
    v_mfma_f32_16x16x32_bf16 v[92:95], v[124:127], v[112:115], v[92:95]
    ds_read_b128 v[140:143], v169 offset:34816
    v_mfma_f32_16x16x32_bf16 v[96:99], v[120:123], v[116:119], v[96:99]
    ds_read_b128 v[144:147], v169 offset:36864
    v_mfma_f32_16x16x32_bf16 v[100:103], v[124:127], v[116:119], v[100:103]
    ds_read_b128 v[148:151], v169 offset:38912
    s_waitcnt lgkmcnt(0)
    v_mov_b32 v7, 16
    ds_write_b32 v6, v7
    s_lshl_b32 s3, s29, 7
    s_add_u32 s3, s3, 138240
    v_lshl_add_u32 v243, v2, 4, s3
    v_mfma_f32_16x16x32_bf16 v[72:75], v[152:155], v[136:139], v[72:75]
    ds_read_b128 v[192:195], v243 offset:0
    v_mfma_f32_16x16x32_bf16 v[76:79], v[156:159], v[136:139], v[76:79]
    ds_read_b128 v[196:199], v243 offset:64
    v_mfma_f32_16x16x32_bf16 v[80:83], v[152:155], v[140:143], v[80:83]
    buffer_load_dwordx4 v[200:203], v246, s[4:7], 0 offen
    v_mfma_f32_16x16x32_bf16 v[84:87], v[156:159], v[140:143], v[84:87]
    buffer_load_dwordx4 v[204:207], v246, s[4:7], s77 offen
    v_mfma_f32_16x16x32_bf16 v[88:91], v[152:155], v[144:147], v[88:91]
    buffer_load_dwordx4 v[208:211], v246, s[4:7], s78 offen
    v_mfma_f32_16x16x32_bf16 v[92:95], v[156:159], v[144:147], v[92:95]
    buffer_load_dwordx4 v[212:215], v246, s[4:7], s79 offen
    v_mfma_f32_16x16x32_bf16 v[96:99], v[152:155], v[148:151], v[96:99]
    v_mfma_f32_16x16x32_bf16 v[100:103], v[156:159], v[148:151], v[100:103]
    s_waitcnt lgkmcnt(0)
    v_pk_fma_f32 v[72:73], v[180:181], v[192:193], v[72:73] op_sel_hi:[0,1,1] neg_lo:[1,0,0] neg_hi:[1,0,0]
    v_pk_fma_f32 v[74:75], v[180:181], v[194:195], v[74:75] op_sel_hi:[0,1,1] neg_lo:[1,0,0] neg_hi:[1,0,0]
    v_pk_fma_f32 v[76:77], v[180:181], v[196:197], v[76:77] op_sel_hi:[0,1,1] neg_lo:[1,0,0] neg_hi:[1,0,0]
    v_pk_fma_f32 v[78:79], v[180:181], v[198:199], v[78:79] op_sel_hi:[0,1,1] neg_lo:[1,0,0] neg_hi:[1,0,0]
    v_cvt_pk_bf16_f32 v104, v72, v73
    v_cvt_pk_bf16_f32 v105, v74, v75
    v_cvt_pk_bf16_f32 v106, v76, v77
    v_cvt_pk_bf16_f32 v107, v78, v79
    v_pk_fma_f32 v[80:81], v[182:183], v[192:193], v[80:81] op_sel_hi:[0,1,1] neg_lo:[1,0,0] neg_hi:[1,0,0]
    v_pk_fma_f32 v[82:83], v[182:183], v[194:195], v[82:83] op_sel_hi:[0,1,1] neg_lo:[1,0,0] neg_hi:[1,0,0]
    v_pk_fma_f32 v[84:85], v[182:183], v[196:197], v[84:85] op_sel_hi:[0,1,1] neg_lo:[1,0,0] neg_hi:[1,0,0]
    v_pk_fma_f32 v[86:87], v[182:183], v[198:199], v[86:87] op_sel_hi:[0,1,1] neg_lo:[1,0,0] neg_hi:[1,0,0]
    v_cvt_pk_bf16_f32 v108, v80, v81
    v_cvt_pk_bf16_f32 v109, v82, v83
    v_cvt_pk_bf16_f32 v110, v84, v85
    v_cvt_pk_bf16_f32 v111, v86, v87
    v_pk_fma_f32 v[88:89], v[184:185], v[192:193], v[88:89] op_sel_hi:[0,1,1] neg_lo:[1,0,0] neg_hi:[1,0,0]
    v_pk_fma_f32 v[90:91], v[184:185], v[194:195], v[90:91] op_sel_hi:[0,1,1] neg_lo:[1,0,0] neg_hi:[1,0,0]
    v_pk_fma_f32 v[92:93], v[184:185], v[196:197], v[92:93] op_sel_hi:[0,1,1] neg_lo:[1,0,0] neg_hi:[1,0,0]
    v_pk_fma_f32 v[94:95], v[184:185], v[198:199], v[94:95] op_sel_hi:[0,1,1] neg_lo:[1,0,0] neg_hi:[1,0,0]
    v_cvt_pk_bf16_f32 v112, v88, v89
    v_cvt_pk_bf16_f32 v113, v90, v91
    v_cvt_pk_bf16_f32 v114, v92, v93
    v_cvt_pk_bf16_f32 v115, v94, v95
    v_pk_fma_f32 v[96:97], v[186:187], v[192:193], v[96:97] op_sel_hi:[0,1,1] neg_lo:[1,0,0] neg_hi:[1,0,0]
    v_pk_fma_f32 v[98:99], v[186:187], v[194:195], v[98:99] op_sel_hi:[0,1,1] neg_lo:[1,0,0] neg_hi:[1,0,0]
    v_pk_fma_f32 v[100:101], v[186:187], v[196:197], v[100:101] op_sel_hi:[0,1,1] neg_lo:[1,0,0] neg_hi:[1,0,0]
    v_pk_fma_f32 v[102:103], v[186:187], v[198:199], v[102:103] op_sel_hi:[0,1,1] neg_lo:[1,0,0] neg_hi:[1,0,0]
    v_cvt_pk_bf16_f32 v116, v96, v97
    v_cvt_pk_bf16_f32 v117, v98, v99
    v_cvt_pk_bf16_f32 v118, v100, v101
    v_cvt_pk_bf16_f32 v119, v102, v103
    v_mfma_f32_16x16x32_bf16 v[120:123], v[172:175], v[104:107], 0
    v_mfma_f32_16x16x32_bf16 v[124:127], v[176:179], v[104:107], 0
    v_mfma_f32_16x16x32_bf16 v[128:131], v[172:175], v[108:111], 0
    v_mfma_f32_16x16x32_bf16 v[132:135], v[176:179], v[108:111], 0
    v_mfma_f32_16x16x32_bf16 v[136:139], v[172:175], v[112:115], 0
    v_mfma_f32_16x16x32_bf16 v[140:143], v[176:179], v[112:115], 0
    v_mfma_f32_16x16x32_bf16 v[144:147], v[172:175], v[116:119], 0
    v_mfma_f32_16x16x32_bf16 v[148:151], v[176:179], v[116:119], 0
    s_nop 0
    v_max3_f32 v224, v120, v121, v122
    v_min3_f32 v232, v120, v121, v122
    v_max3_f32 v224, v224, v123, v124
    v_min3_f32 v232, v232, v123, v124
    v_max3_f32 v224, v224, v125, v126
    v_min3_f32 v232, v232, v125, v126
    v_max_f32 v224, v224, v127
    v_min_f32 v232, v232, v127
    v_max3_f32 v226, v128, v129, v130
    v_min3_f32 v234, v128, v129, v130
    v_max3_f32 v226, v226, v131, v132
    v_min3_f32 v234, v234, v131, v132
    v_max3_f32 v226, v226, v133, v134
    v_min3_f32 v234, v234, v133, v134
    v_max_f32 v226, v226, v135
    v_min_f32 v234, v234, v135
    v_max3_f32 v228, v136, v137, v138
    v_min3_f32 v236, v136, v137, v138
    v_max3_f32 v228, v228, v139, v140
    v_min3_f32 v236, v236, v139, v140
    v_max3_f32 v228, v228, v141, v142
    v_min3_f32 v236, v236, v141, v142
    v_max_f32 v228, v228, v143
    v_min_f32 v236, v236, v143
    v_max3_f32 v230, v144, v145, v146
    v_min3_f32 v238, v144, v145, v146
    v_max3_f32 v230, v230, v147, v148
    v_min3_f32 v238, v238, v147, v148
    v_max3_f32 v230, v230, v149, v150
    v_min3_f32 v238, v238, v149, v150
    v_max_f32 v230, v230, v151
    v_min_f32 v238, v238, v151
    v_permlane32_swap_b32 v224, v228
    v_permlane32_swap_b32 v226, v230
    v_permlane32_swap_b32 v232, v236
    v_permlane32_swap_b32 v234, v238
    v_max_f32 v224, v224, v228
    v_max_f32 v226, v226, v230
    v_min_f32 v232, v232, v236
    v_min_f32 v234, v234, v238
    v_permlane16_swap_b32 v224, v226
    s_nop 0
    v_permlane16_swap_b32 v232, v234
    v_max_f32 v224, v224, v226
    v_min_f32 v232, v232, v234
    v_mul_f32 v224, v224, v181
    v_mul_f32 v232, v232, v181
    v_mov_b32 v226, v224
    v_mov_b32 v234, v232
    s_nop 0
    v_permlane16_swap_b32 v224, v226
    v_permlane16_swap_b32 v232, v234
    v_mov_b32 v228, v224
    v_mov_b32 v230, v226
    v_mov_b32 v236, v232
    v_mov_b32 v238, v234
    v_permlane32_swap_b32 v224, v228
    v_permlane32_swap_b32 v226, v230
    v_permlane32_swap_b32 v232, v236
    v_permlane32_swap_b32 v234, v238
    v_pk_fma_f32 v[8:9], v[120:121], v[248:249], v[224:225] op_sel_hi:[1,0,0] neg_lo:[0,0,1] neg_hi:[0,0,1]
    v_pk_fma_f32 v[16:17], v[120:121], v[248:249], v[232:233] op_sel_hi:[1,0,0] neg_lo:[1,0,0] neg_hi:[1,0,0]
    v_pk_fma_f32 v[10:11], v[122:123], v[248:249], v[224:225] op_sel_hi:[1,0,0] neg_lo:[0,0,1] neg_hi:[0,0,1]
    v_pk_fma_f32 v[18:19], v[122:123], v[248:249], v[232:233] op_sel_hi:[1,0,0] neg_lo:[1,0,0] neg_hi:[1,0,0]
    v_pk_fma_f32 v[12:13], v[124:125], v[248:249], v[224:225] op_sel_hi:[1,0,0] neg_lo:[0,0,1] neg_hi:[0,0,1]
    v_pk_fma_f32 v[20:21], v[124:125], v[248:249], v[232:233] op_sel_hi:[1,0,0] neg_lo:[1,0,0] neg_hi:[1,0,0]
    v_pk_fma_f32 v[14:15], v[126:127], v[248:249], v[224:225] op_sel_hi:[1,0,0] neg_lo:[0,0,1] neg_hi:[0,0,1]
    v_pk_fma_f32 v[22:23], v[126:127], v[248:249], v[232:233] op_sel_hi:[1,0,0] neg_lo:[1,0,0] neg_hi:[1,0,0]
    v_exp_f32 v8, v8
    v_exp_f32 v9, v9
    v_exp_f32 v10, v10
    v_exp_f32 v11, v11
    v_exp_f32 v12, v12
    v_exp_f32 v13, v13
    v_exp_f32 v14, v14
    v_exp_f32 v15, v15
    v_exp_f32 v16, v16
    v_exp_f32 v17, v17
    v_exp_f32 v18, v18
    v_exp_f32 v19, v19
    v_exp_f32 v20, v20
    v_exp_f32 v21, v21
    v_exp_f32 v22, v22
    v_exp_f32 v23, v23
    v_pk_fma_f32 v[24:25], v[128:129], v[250:251], v[226:227] op_sel_hi:[1,0,0] neg_lo:[0,0,1] neg_hi:[0,0,1]
    v_pk_fma_f32 v[32:33], v[128:129], v[250:251], v[234:235] op_sel_hi:[1,0,0] neg_lo:[1,0,0] neg_hi:[1,0,0]
    v_pk_fma_f32 v[26:27], v[130:131], v[250:251], v[226:227] op_sel_hi:[1,0,0] neg_lo:[0,0,1] neg_hi:[0,0,1]
    v_pk_fma_f32 v[34:35], v[130:131], v[250:251], v[234:235] op_sel_hi:[1,0,0] neg_lo:[1,0,0] neg_hi:[1,0,0]
    v_pk_fma_f32 v[28:29], v[132:133], v[250:251], v[226:227] op_sel_hi:[1,0,0] neg_lo:[0,0,1] neg_hi:[0,0,1]
    v_pk_fma_f32 v[36:37], v[132:133], v[250:251], v[234:235] op_sel_hi:[1,0,0] neg_lo:[1,0,0] neg_hi:[1,0,0]
    v_pk_fma_f32 v[30:31], v[134:135], v[250:251], v[226:227] op_sel_hi:[1,0,0] neg_lo:[0,0,1] neg_hi:[0,0,1]
    v_pk_fma_f32 v[38:39], v[134:135], v[250:251], v[234:235] op_sel_hi:[1,0,0] neg_lo:[1,0,0] neg_hi:[1,0,0]
    v_exp_f32 v24, v24
    v_exp_f32 v25, v25
    v_exp_f32 v26, v26
    v_exp_f32 v27, v27
    v_exp_f32 v28, v28
    v_exp_f32 v29, v29
    v_exp_f32 v30, v30
    v_exp_f32 v31, v31
    v_exp_f32 v32, v32
    v_exp_f32 v33, v33
    v_exp_f32 v34, v34
    v_exp_f32 v35, v35
    v_exp_f32 v36, v36
    v_exp_f32 v37, v37
    v_exp_f32 v38, v38
    v_exp_f32 v39, v39
    v_pk_fma_f32 v[40:41], v[136:137], v[252:253], v[228:229] op_sel_hi:[1,0,0] neg_lo:[0,0,1] neg_hi:[0,0,1]
    v_pk_fma_f32 v[48:49], v[136:137], v[252:253], v[236:237] op_sel_hi:[1,0,0] neg_lo:[1,0,0] neg_hi:[1,0,0]
    v_pk_fma_f32 v[42:43], v[138:139], v[252:253], v[228:229] op_sel_hi:[1,0,0] neg_lo:[0,0,1] neg_hi:[0,0,1]
    v_pk_fma_f32 v[50:51], v[138:139], v[252:253], v[236:237] op_sel_hi:[1,0,0] neg_lo:[1,0,0] neg_hi:[1,0,0]
    v_pk_fma_f32 v[44:45], v[140:141], v[252:253], v[228:229] op_sel_hi:[1,0,0] neg_lo:[0,0,1] neg_hi:[0,0,1]
    v_pk_fma_f32 v[52:53], v[140:141], v[252:253], v[236:237] op_sel_hi:[1,0,0] neg_lo:[1,0,0] neg_hi:[1,0,0]
    v_pk_fma_f32 v[46:47], v[142:143], v[252:253], v[228:229] op_sel_hi:[1,0,0] neg_lo:[0,0,1] neg_hi:[0,0,1]
    v_pk_fma_f32 v[54:55], v[142:143], v[252:253], v[236:237] op_sel_hi:[1,0,0] neg_lo:[1,0,0] neg_hi:[1,0,0]
    v_exp_f32 v40, v40
    v_exp_f32 v41, v41
    v_exp_f32 v42, v42
    v_exp_f32 v43, v43
    v_exp_f32 v44, v44
    v_exp_f32 v45, v45
    v_exp_f32 v46, v46
    v_exp_f32 v47, v47
    v_exp_f32 v48, v48
    v_exp_f32 v49, v49
    v_exp_f32 v50, v50
    v_exp_f32 v51, v51
    v_exp_f32 v52, v52
    v_exp_f32 v53, v53
    v_exp_f32 v54, v54
    v_exp_f32 v55, v55
    v_pk_fma_f32 v[56:57], v[144:145], v[254:255], v[230:231] op_sel_hi:[1,0,0] neg_lo:[0,0,1] neg_hi:[0,0,1]
    v_pk_fma_f32 v[64:65], v[144:145], v[254:255], v[238:239] op_sel_hi:[1,0,0] neg_lo:[1,0,0] neg_hi:[1,0,0]
    v_pk_fma_f32 v[58:59], v[146:147], v[254:255], v[230:231] op_sel_hi:[1,0,0] neg_lo:[0,0,1] neg_hi:[0,0,1]
    v_pk_fma_f32 v[66:67], v[146:147], v[254:255], v[238:239] op_sel_hi:[1,0,0] neg_lo:[1,0,0] neg_hi:[1,0,0]
    v_pk_fma_f32 v[60:61], v[148:149], v[254:255], v[230:231] op_sel_hi:[1,0,0] neg_lo:[0,0,1] neg_hi:[0,0,1]
    v_pk_fma_f32 v[68:69], v[148:149], v[254:255], v[238:239] op_sel_hi:[1,0,0] neg_lo:[1,0,0] neg_hi:[1,0,0]
    v_pk_fma_f32 v[62:63], v[150:151], v[254:255], v[230:231] op_sel_hi:[1,0,0] neg_lo:[0,0,1] neg_hi:[0,0,1]
    v_pk_fma_f32 v[70:71], v[150:151], v[254:255], v[238:239] op_sel_hi:[1,0,0] neg_lo:[1,0,0] neg_hi:[1,0,0]
    v_exp_f32 v56, v56
    v_exp_f32 v57, v57
    v_exp_f32 v58, v58
    v_exp_f32 v59, v59
    v_exp_f32 v60, v60
    v_exp_f32 v61, v61
    v_exp_f32 v62, v62
    v_exp_f32 v63, v63
    v_exp_f32 v64, v64
    v_exp_f32 v65, v65
    v_exp_f32 v66, v66
    v_exp_f32 v67, v67
    v_exp_f32 v68, v68
    v_exp_f32 v69, v69
    v_exp_f32 v70, v70
    v_exp_f32 v71, v71
    v_pk_add_f32 v[120:121], v[8:9], v[10:11]
    v_pk_add_f32 v[122:123], v[12:13], v[14:15]
    v_pk_add_f32 v[124:125], v[16:17], v[18:19]
    v_pk_add_f32 v[126:127], v[20:21], v[22:23]
    v_pk_add_f32 v[128:129], v[24:25], v[26:27]
    v_pk_add_f32 v[130:131], v[28:29], v[30:31]
    v_pk_add_f32 v[132:133], v[32:33], v[34:35]
    v_pk_add_f32 v[134:135], v[36:37], v[38:39]
    v_pk_add_f32 v[136:137], v[40:41], v[42:43]
    v_pk_add_f32 v[138:139], v[44:45], v[46:47]
    v_pk_add_f32 v[140:141], v[48:49], v[50:51]
    v_pk_add_f32 v[142:143], v[52:53], v[54:55]
    v_pk_add_f32 v[144:145], v[56:57], v[58:59]
    v_pk_add_f32 v[146:147], v[60:61], v[62:63]
    v_pk_add_f32 v[148:149], v[64:65], v[66:67]
    v_pk_add_f32 v[150:151], v[68:69], v[70:71]
    v_pk_add_f32 v[120:121], v[120:121], v[122:123]
    v_pk_add_f32 v[124:125], v[124:125], v[126:127]
    v_pk_add_f32 v[128:129], v[128:129], v[130:131]
    v_pk_add_f32 v[132:133], v[132:133], v[134:135]
    v_pk_add_f32 v[136:137], v[136:137], v[138:139]
    v_pk_add_f32 v[140:141], v[140:141], v[142:143]
    v_pk_add_f32 v[144:145], v[144:145], v[146:147]
    v_pk_add_f32 v[148:149], v[148:149], v[150:151]
    v_add_f32 v224, v120, v121
    v_add_f32 v232, v124, v125
    v_add_f32 v226, v128, v129
    v_add_f32 v234, v132, v133
    v_add_f32 v228, v136, v137
    v_add_f32 v236, v140, v141
    v_add_f32 v230, v144, v145
    v_add_f32 v238, v148, v149
    v_permlane32_swap_b32 v224, v228
    v_permlane32_swap_b32 v226, v230
    v_permlane32_swap_b32 v232, v236
    v_permlane32_swap_b32 v234, v238
    v_add_f32 v224, v224, v228
    v_add_f32 v226, v226, v230
    v_add_f32 v232, v232, v236
    v_add_f32 v234, v234, v238
    v_permlane16_swap_b32 v224, v226
    s_nop 0
    v_permlane16_swap_b32 v232, v234
    v_add_f32 v224, v224, v226
    v_add_f32 v232, v232, v234
    v_rcp_f32 v232, v232
    s_lshl_b32 s3, s29, 12
    s_add_u32 s3, s3, 140800
    v_add_u32 v240, s3, v5
    s_lshl_b32 s3, s29, 7
    s_add_u32 s3, s3, 148992
    v_lshl_add_u32 v241, v2, 3, s3
    v_mul_f32 v232, v232, v224
    v_mul_f32 v224, 0x358637bd, v224
    v_mov_b32 v226, v224
    v_mov_b32 v234, v232
    s_nop 0
    v_permlane16_swap_b32 v224, v226
    v_permlane16_swap_b32 v232, v234
    v_mov_b32 v228, v224
    v_mov_b32 v230, v226
    v_mov_b32 v236, v232
    v_mov_b32 v238, v234
    v_permlane32_swap_b32 v224, v228
    v_permlane32_swap_b32 v226, v230
    v_permlane32_swap_b32 v232, v236
    v_permlane32_swap_b32 v234, v238
    v_pk_mul_f32 v[16:17], v[16:17], v[232:233] op_sel_hi:[1,0]
    v_pk_mul_f32 v[18:19], v[18:19], v[232:233] op_sel_hi:[1,0]
    v_pk_mul_f32 v[20:21], v[20:21], v[232:233] op_sel_hi:[1,0]
    v_pk_mul_f32 v[22:23], v[22:23], v[232:233] op_sel_hi:[1,0]
    v_cvt_pk_bf16_f32 v72, v8, v9
    v_cvt_pk_bf16_f32 v73, v10, v11
    v_cvt_pk_bf16_f32 v74, v12, v13
    v_cvt_pk_bf16_f32 v75, v14, v15
    v_cvt_pk_bf16_f32 v76, v16, v17
    v_cvt_pk_bf16_f32 v77, v18, v19
    v_cvt_pk_bf16_f32 v78, v20, v21
    v_cvt_pk_bf16_f32 v79, v22, v23
    v_pk_mul_f32 v[32:33], v[32:33], v[234:235] op_sel_hi:[1,0]
    v_pk_mul_f32 v[34:35], v[34:35], v[234:235] op_sel_hi:[1,0]
    v_pk_mul_f32 v[36:37], v[36:37], v[234:235] op_sel_hi:[1,0]
    v_pk_mul_f32 v[38:39], v[38:39], v[234:235] op_sel_hi:[1,0]
    v_cvt_pk_bf16_f32 v80, v24, v25
    v_cvt_pk_bf16_f32 v81, v26, v27
    v_cvt_pk_bf16_f32 v82, v28, v29
    v_cvt_pk_bf16_f32 v83, v30, v31
    v_cvt_pk_bf16_f32 v84, v32, v33
    v_cvt_pk_bf16_f32 v85, v34, v35
    v_cvt_pk_bf16_f32 v86, v36, v37
    v_cvt_pk_bf16_f32 v87, v38, v39
    v_pk_mul_f32 v[48:49], v[48:49], v[236:237] op_sel_hi:[1,0]
    v_pk_mul_f32 v[50:51], v[50:51], v[236:237] op_sel_hi:[1,0]
    v_pk_mul_f32 v[52:53], v[52:53], v[236:237] op_sel_hi:[1,0]
    v_pk_mul_f32 v[54:55], v[54:55], v[236:237] op_sel_hi:[1,0]
    v_cvt_pk_bf16_f32 v88, v40, v41
    v_cvt_pk_bf16_f32 v89, v42, v43
    v_cvt_pk_bf16_f32 v90, v44, v45
    v_cvt_pk_bf16_f32 v91, v46, v47
    v_cvt_pk_bf16_f32 v92, v48, v49
    v_cvt_pk_bf16_f32 v93, v50, v51
    v_cvt_pk_bf16_f32 v94, v52, v53
    v_cvt_pk_bf16_f32 v95, v54, v55
    v_pk_mul_f32 v[64:65], v[64:65], v[238:239] op_sel_hi:[1,0]
    v_pk_mul_f32 v[66:67], v[66:67], v[238:239] op_sel_hi:[1,0]
    v_pk_mul_f32 v[68:69], v[68:69], v[238:239] op_sel_hi:[1,0]
    v_pk_mul_f32 v[70:71], v[70:71], v[238:239] op_sel_hi:[1,0]
    v_cvt_pk_bf16_f32 v96, v56, v57
    v_cvt_pk_bf16_f32 v97, v58, v59
    v_cvt_pk_bf16_f32 v98, v60, v61
    v_cvt_pk_bf16_f32 v99, v62, v63
    v_cvt_pk_bf16_f32 v100, v64, v65
    v_cvt_pk_bf16_f32 v101, v66, v67
    v_cvt_pk_bf16_f32 v102, v68, v69
    v_cvt_pk_bf16_f32 v103, v70, v71
    s_and_b32 s34, s33, 0x7ff
    s_sub_u32 s34, 2047, s34
    s_lshr_b32 s3, s34, 7
    s_cmp_eq_u32 s3, s30
    s_cselect_b32 s35, 1, 0
    s_lshl_b32 s3, s36, 3
    s_lshl_b32 s65, s28, 2
    s_add_u32 s3, s3, s65
    s_lshl_b32 s3, s3, 5
    s_lshl_b32 s65, s37, 1
    s_add_u32 s65, s65, s29
    s_add_u32 s3, s3, s65
    s_lshl_b32 s3, s3, 10
    s_add_u32 s3, s3, 12582912
    v_mov_b32 v6, 139136
L_kv:
    ds_read_b64 v[104:105], v6
    s_waitcnt lgkmcnt(0)
    v_and_b32 v104, v104, v105
    s_nop 0
    v_readfirstlane_b32 s65, v104
    s_nop 0
    s_cmp_eq_u32 s65, 1
    s_cbranch_scc0 L_kv
    ds_read_b128 v[104:107], v240 offset:0
    ds_read_b128 v[108:111], v240 offset:1024
    ds_read_b128 v[112:115], v240 offset:2048
    ds_read_b128 v[116:119], v240 offset:3072
    ds_read_b64 v[120:121], v241 offset:0
    ds_read_b64 v[122:123], v241 offset:32
    ds_read_b64 v[124:125], v241 offset:64
    ds_read_b64 v[126:127], v241 offset:96
    s_waitcnt lgkmcnt(0)
    v_mfma_f32_16x16x32_bf16 v[40:43], v[120:123], v[72:75], 0
    v_mfma_f32_16x16x32_bf16 v[40:43], v[124:127], v[76:79], v[40:43]
    v_mfma_f32_16x16x32_bf16 v[44:47], v[120:123], v[80:83], 0
    v_mfma_f32_16x16x32_bf16 v[44:47], v[124:127], v[84:87], v[44:47]
    v_mfma_f32_16x16x32_bf16 v[48:51], v[120:123], v[88:91], 0
    v_mfma_f32_16x16x32_bf16 v[48:51], v[124:127], v[92:95], v[48:51]
    v_mfma_f32_16x16x32_bf16 v[52:55], v[120:123], v[96:99], 0
    v_mfma_f32_16x16x32_bf16 v[52:55], v[124:127], v[100:103], v[52:55]
    v_mfma_f32_16x16x32_bf16 v[8:11], v[104:107], v[72:75], 0
    v_mfma_f32_16x16x32_bf16 v[8:11], v[112:115], v[76:79], v[8:11]
    v_mfma_f32_16x16x32_bf16 v[12:15], v[108:111], v[72:75], 0
    v_mfma_f32_16x16x32_bf16 v[12:15], v[116:119], v[76:79], v[12:15]
    v_add_f32 v40, v40, v224
    v_add_f32 v44, v44, v226
    v_add_f32 v48, v48, v228
    s_nop 0
    v_add_f32 v52, v52, v230
    v_mfma_f32_16x16x32_bf16 v[16:19], v[104:107], v[80:83], 0
    v_mfma_f32_16x16x32_bf16 v[16:19], v[112:115], v[84:87], v[16:19]
    v_mfma_f32_16x16x32_bf16 v[20:23], v[108:111], v[80:83], 0
    v_mfma_f32_16x16x32_bf16 v[20:23], v[116:119], v[84:87], v[20:23]
    v_rcp_f32 v40, v40
    v_rcp_f32 v44, v44
    v_rcp_f32 v48, v48
    v_rcp_f32 v52, v52
    v_mfma_f32_16x16x32_bf16 v[24:27], v[104:107], v[88:91], 0
    v_mfma_f32_16x16x32_bf16 v[24:27], v[112:115], v[92:95], v[24:27]
    v_mfma_f32_16x16x32_bf16 v[28:31], v[108:111], v[88:91], 0
    v_mfma_f32_16x16x32_bf16 v[28:31], v[116:119], v[92:95], v[28:31]
    v_mfma_f32_16x16x32_bf16 v[32:35], v[104:107], v[96:99], 0
    v_mfma_f32_16x16x32_bf16 v[32:35], v[112:115], v[100:103], v[32:35]
    v_mfma_f32_16x16x32_bf16 v[36:39], v[108:111], v[96:99], 0
    v_mfma_f32_16x16x32_bf16 v[36:39], v[116:119], v[100:103], v[36:39]
    v_pk_mul_f32 v[8:9], v[8:9], v[40:41] op_sel_hi:[1,0]
    v_pk_mul_f32 v[10:11], v[10:11], v[40:41] op_sel_hi:[1,0]
    v_pk_mul_f32 v[12:13], v[12:13], v[40:41] op_sel_hi:[1,0]
    v_pk_mul_f32 v[14:15], v[14:15], v[40:41] op_sel_hi:[1,0]
    v_cvt_pk_bf16_f32 v128, v8, v9
    v_cvt_pk_bf16_f32 v129, v10, v11
    v_cvt_pk_bf16_f32 v130, v12, v13
    v_cvt_pk_bf16_f32 v131, v14, v15
    buffer_store_dwordx4 v[128:131], v5, s[12:15], s3 offen sc1
    s_add_u32 s3, s3, 32768
    v_pk_mul_f32 v[16:17], v[16:17], v[44:45] op_sel_hi:[1,0]
    v_pk_mul_f32 v[18:19], v[18:19], v[44:45] op_sel_hi:[1,0]
    v_pk_mul_f32 v[20:21], v[20:21], v[44:45] op_sel_hi:[1,0]
    v_pk_mul_f32 v[22:23], v[22:23], v[44:45] op_sel_hi:[1,0]
    v_cvt_pk_bf16_f32 v132, v16, v17
    v_cvt_pk_bf16_f32 v133, v18, v19
    v_cvt_pk_bf16_f32 v134, v20, v21
    v_cvt_pk_bf16_f32 v135, v22, v23
    buffer_store_dwordx4 v[132:135], v5, s[12:15], s3 offen sc1
    s_add_u32 s3, s3, 32768
    v_pk_mul_f32 v[24:25], v[24:25], v[48:49] op_sel_hi:[1,0]
    v_pk_mul_f32 v[26:27], v[26:27], v[48:49] op_sel_hi:[1,0]
    v_pk_mul_f32 v[28:29], v[28:29], v[48:49] op_sel_hi:[1,0]
    v_pk_mul_f32 v[30:31], v[30:31], v[48:49] op_sel_hi:[1,0]
    v_cvt_pk_bf16_f32 v136, v24, v25
    v_cvt_pk_bf16_f32 v137, v26, v27
    v_cvt_pk_bf16_f32 v138, v28, v29
    v_cvt_pk_bf16_f32 v139, v30, v31
    buffer_store_dwordx4 v[136:139], v5, s[12:15], s3 offen sc1
    s_add_u32 s3, s3, 32768
    v_pk_mul_f32 v[32:33], v[32:33], v[52:53] op_sel_hi:[1,0]
    v_pk_mul_f32 v[34:35], v[34:35], v[52:53] op_sel_hi:[1,0]
    v_pk_mul_f32 v[36:37], v[36:37], v[52:53] op_sel_hi:[1,0]
    v_pk_mul_f32 v[38:39], v[38:39], v[52:53] op_sel_hi:[1,0]
    v_cvt_pk_bf16_f32 v140, v32, v33
    v_cvt_pk_bf16_f32 v141, v34, v35
    v_cvt_pk_bf16_f32 v142, v36, v37
    v_cvt_pk_bf16_f32 v143, v38, v39
    buffer_store_dwordx4 v[140:143], v5, s[12:15], s3 offen sc1
    s_lshl_b32 s73, s30, 7
    s_add_u32 s73, s73, 131072
    v_and_b32 v161, 31, v1
    v_lshlrev_b32 v161, 2, v161
    buffer_load_dword v160, v161, s[12:15], s73 offen sc1
    s_mov_b32 s24, s58
    s_mov_b32 s25, s59
    s_mov_b32 s26, 4194304
    s_mov_b32 s27, 0x00020000
    s_lshl_b32 s3, s38, 7
    s_add_u32 s3, s3, 136704
    v_lshrrev_b32 v6, 3, v1
    v_lshl_add_u32 v6, v6, 2, s3
    ds_read_b32 v144, v6 offset:0
    ds_read_b32 v152, v6 offset:512
    ds_read_b32 v146, v6 offset:32
    ds_read_b32 v154, v6 offset:544
    ds_read_b32 v148, v6 offset:64
    ds_read_b32 v156, v6 offset:576
    ds_read_b32 v150, v6 offset:96
    ds_read_b32 v158, v6 offset:608
    v_lshrrev_b32 v6, 2, v1
    v_lshlrev_b32 v6, 7, v6
    v_and_b32 v7, 3, v1
    v_lshl_add_u32 v6, v7, 3, v6
    v_bfe_u32 v7, v1, 3, 2
    v_xor_b32 v4, 0, v7
    v_lshl_add_u32 v250, v4, 5, v6
    v_xor_b32 v4, 1, v7
    v_lshl_add_u32 v251, v4, 5, v6
    v_xor_b32 v4, 2, v7
    v_lshl_add_u32 v252, v4, 5, v6
    v_xor_b32 v4, 3, v7
    v_lshl_add_u32 v253, v4, 5, v6
    s_lshl_b32 s72, s30, 3
    s_lshl_b32 s3, s38, 1
    s_add_u32 s72, s72, s3
    s_lshl_b32 s72, s72, 15
    s_add_u32 s72, s72, 12582912
    v_add_u32 v4, 32768, v5
    s_mul_i32 s3, s38, 4608
    s_add_u32 s3, s3, 140800
    v_mul_u32_u24 v6, 144, v3
    v_lshl_add_u32 v6, v2, 3, v6
    v_add_u32 v240, s3, v6
    v_lshrrev_b32 v6, 3, v1
    v_mul_u32_u24 v6, 144, v6
    v_and_b32 v7, 7, v1
    v_lshl_add_u32 v6, v7, 4, v6
    v_add_u32 v241, s3, v6
    s_bfe_u32 s3, s34, 0x20005
    s_cmp_eq_u32 s3, s38
    s_cselect_b32 s3, s35, 0
    s_and_b32 s65, s34, 7
    s_lshl_b32 s65, s65, 3
    s_lshl_b64 s[66:67], 0xff, s65
    s_cmp_eq_u32 s3, 0
    s_cselect_b64 s[66:67], 0, s[66:67]
    s_bfe_u32 s65, s34, 0x20003
    s_mov_b32 s71, 0xbfb8aa3b
    s_waitcnt vmcnt(5) lgkmcnt(0)
    v_lshlrev_b32 v176, 16, v200
    v_and_b32 v177, 0xffff0000, v200
    v_lshlrev_b32 v178, 16, v201
    v_and_b32 v179, 0xffff0000, v201
    v_lshlrev_b32 v180, 16, v202
    v_and_b32 v181, 0xffff0000, v202
    v_lshlrev_b32 v182, 16, v203
    v_and_b32 v183, 0xffff0000, v203
    v_lshlrev_b32 v184, 16, v204
    v_and_b32 v185, 0xffff0000, v204
    v_lshlrev_b32 v186, 16, v205
    v_and_b32 v187, 0xffff0000, v205
    v_lshlrev_b32 v188, 16, v206
    v_and_b32 v189, 0xffff0000, v206
    v_lshlrev_b32 v190, 16, v207
    v_and_b32 v191, 0xffff0000, v207
    v_lshlrev_b32 v192, 16, v208
    v_and_b32 v193, 0xffff0000, v208
    v_lshlrev_b32 v194, 16, v209
    v_and_b32 v195, 0xffff0000, v209
    v_lshlrev_b32 v196, 16, v210
    v_and_b32 v197, 0xffff0000, v210
    v_lshlrev_b32 v198, 16, v211
    v_and_b32 v199, 0xffff0000, v211
    v_lshlrev_b32 v200, 16, v212
    v_and_b32 v201, 0xffff0000, v212
    v_lshlrev_b32 v202, 16, v213
    v_and_b32 v203, 0xffff0000, v213
    v_lshlrev_b32 v204, 16, v214
    v_and_b32 v205, 0xffff0000, v214
    v_lshlrev_b32 v206, 16, v215
    v_and_b32 v207, 0xffff0000, v215
    v_pk_add_f32 v[208:209], v[176:177], v[144:145] op_sel_hi:[1,0] neg_lo:[0,1] neg_hi:[0,1]
    v_pk_add_f32 v[210:211], v[178:179], v[144:145] op_sel_hi:[1,0] neg_lo:[0,1] neg_hi:[0,1]
    v_pk_add_f32 v[212:213], v[180:181], v[144:145] op_sel_hi:[1,0] neg_lo:[0,1] neg_hi:[0,1]
    v_pk_add_f32 v[214:215], v[182:183], v[144:145] op_sel_hi:[1,0] neg_lo:[0,1] neg_hi:[0,1]
    v_pk_add_f32 v[216:217], v[184:185], v[146:147] op_sel_hi:[1,0] neg_lo:[0,1] neg_hi:[0,1]
    v_pk_add_f32 v[218:219], v[186:187], v[146:147] op_sel_hi:[1,0] neg_lo:[0,1] neg_hi:[0,1]
    v_pk_add_f32 v[220:221], v[188:189], v[146:147] op_sel_hi:[1,0] neg_lo:[0,1] neg_hi:[0,1]
    v_pk_add_f32 v[222:223], v[190:191], v[146:147] op_sel_hi:[1,0] neg_lo:[0,1] neg_hi:[0,1]
    v_pk_add_f32 v[224:225], v[192:193], v[148:149] op_sel_hi:[1,0] neg_lo:[0,1] neg_hi:[0,1]
    v_pk_add_f32 v[226:227], v[194:195], v[148:149] op_sel_hi:[1,0] neg_lo:[0,1] neg_hi:[0,1]
    v_pk_add_f32 v[228:229], v[196:197], v[148:149] op_sel_hi:[1,0] neg_lo:[0,1] neg_hi:[0,1]
    v_pk_add_f32 v[230:231], v[198:199], v[148:149] op_sel_hi:[1,0] neg_lo:[0,1] neg_hi:[0,1]
    v_pk_add_f32 v[232:233], v[200:201], v[150:151] op_sel_hi:[1,0] neg_lo:[0,1] neg_hi:[0,1]
    v_pk_add_f32 v[234:235], v[202:203], v[150:151] op_sel_hi:[1,0] neg_lo:[0,1] neg_hi:[0,1]
    v_pk_add_f32 v[236:237], v[204:205], v[150:151] op_sel_hi:[1,0] neg_lo:[0,1] neg_hi:[0,1]
    v_pk_add_f32 v[238:239], v[206:207], v[150:151] op_sel_hi:[1,0] neg_lo:[0,1] neg_hi:[0,1]
    v_cvt_pk_bf16_f32 v72, v208, v209
    v_cvt_pk_bf16_f32 v73, v210, v211
    v_cvt_pk_bf16_f32 v74, v212, v213
    v_cvt_pk_bf16_f32 v75, v214, v215
    v_cvt_pk_bf16_f32 v76, v216, v217
    v_cvt_pk_bf16_f32 v77, v218, v219
    v_cvt_pk_bf16_f32 v78, v220, v221
    v_cvt_pk_bf16_f32 v79, v222, v223
    v_cvt_pk_bf16_f32 v80, v224, v225
    v_cvt_pk_bf16_f32 v81, v226, v227
    v_cvt_pk_bf16_f32 v82, v228, v229
    v_cvt_pk_bf16_f32 v83, v230, v231
    v_cvt_pk_bf16_f32 v84, v232, v233
    v_cvt_pk_bf16_f32 v85, v234, v235
    v_cvt_pk_bf16_f32 v86, v236, v237
    v_cvt_pk_bf16_f32 v87, v238, v239
    v_lshlrev_b32 v208, 16, v72
    v_and_b32 v209, 0xffff0000, v72
    v_lshlrev_b32 v210, 16, v73
    v_and_b32 v211, 0xffff0000, v73
    v_lshlrev_b32 v212, 16, v74
    v_and_b32 v213, 0xffff0000, v74
    v_lshlrev_b32 v214, 16, v75
    v_and_b32 v215, 0xffff0000, v75
    v_lshlrev_b32 v216, 16, v76
    v_and_b32 v217, 0xffff0000, v76
    v_lshlrev_b32 v218, 16, v77
    v_and_b32 v219, 0xffff0000, v77
    v_lshlrev_b32 v220, 16, v78
    v_and_b32 v221, 0xffff0000, v78
    v_lshlrev_b32 v222, 16, v79
    v_and_b32 v223, 0xffff0000, v79
    v_lshlrev_b32 v224, 16, v80
    v_and_b32 v225, 0xffff0000, v80
    v_lshlrev_b32 v226, 16, v81
    v_and_b32 v227, 0xffff0000, v81
    v_lshlrev_b32 v228, 16, v82
    v_and_b32 v229, 0xffff0000, v82
    v_lshlrev_b32 v230, 16, v83
    v_and_b32 v231, 0xffff0000, v83
    v_lshlrev_b32 v232, 16, v84
    v_and_b32 v233, 0xffff0000, v84
    v_lshlrev_b32 v234, 16, v85
    v_and_b32 v235, 0xffff0000, v85
    v_lshlrev_b32 v236, 16, v86
    v_and_b32 v237, 0xffff0000, v86
    v_lshlrev_b32 v238, 16, v87
    v_and_b32 v239, 0xffff0000, v87
    v_pk_mul_f32 v[208:209], v[208:209], v[152:153] op_sel_hi:[1,0]
    v_pk_mul_f32 v[210:211], v[210:211], v[152:153] op_sel_hi:[1,0]
    v_pk_mul_f32 v[212:213], v[212:213], v[152:153] op_sel_hi:[1,0]
    v_pk_mul_f32 v[214:215], v[214:215], v[152:153] op_sel_hi:[1,0]
    v_pk_mul_f32 v[216:217], v[216:217], v[154:155] op_sel_hi:[1,0]
    v_pk_mul_f32 v[218:219], v[218:219], v[154:155] op_sel_hi:[1,0]
    v_pk_mul_f32 v[220:221], v[220:221], v[154:155] op_sel_hi:[1,0]
    v_pk_mul_f32 v[222:223], v[222:223], v[154:155] op_sel_hi:[1,0]
    v_pk_mul_f32 v[224:225], v[224:225], v[156:157] op_sel_hi:[1,0]
    v_pk_mul_f32 v[226:227], v[226:227], v[156:157] op_sel_hi:[1,0]
    v_pk_mul_f32 v[228:229], v[228:229], v[156:157] op_sel_hi:[1,0]
    v_pk_mul_f32 v[230:231], v[230:231], v[156:157] op_sel_hi:[1,0]
    v_pk_mul_f32 v[232:233], v[232:233], v[158:159] op_sel_hi:[1,0]
    v_pk_mul_f32 v[234:235], v[234:235], v[158:159] op_sel_hi:[1,0]
    v_pk_mul_f32 v[236:237], v[236:237], v[158:159] op_sel_hi:[1,0]
    v_pk_mul_f32 v[238:239], v[238:239], v[158:159] op_sel_hi:[1,0]
    v_cvt_pk_bf16_f32 v72, v208, v209
    v_cvt_pk_bf16_f32 v73, v210, v211
    v_cvt_pk_bf16_f32 v74, v212, v213
    v_cvt_pk_bf16_f32 v75, v214, v215
    v_cvt_pk_bf16_f32 v76, v216, v217
    v_cvt_pk_bf16_f32 v77, v218, v219
    v_cvt_pk_bf16_f32 v78, v220, v221
    v_cvt_pk_bf16_f32 v79, v222, v223
    v_cvt_pk_bf16_f32 v80, v224, v225
    v_cvt_pk_bf16_f32 v81, v226, v227
    v_cvt_pk_bf16_f32 v82, v228, v229
    v_cvt_pk_bf16_f32 v83, v230, v231
    v_cvt_pk_bf16_f32 v84, v232, v233
    v_cvt_pk_bf16_f32 v85, v234, v235
    v_cvt_pk_bf16_f32 v86, v236, v237
    v_cvt_pk_bf16_f32 v87, v238, v239
    v_lshlrev_b32 v208, 16, v72
    v_and_b32 v209, 0xffff0000, v72
    v_lshlrev_b32 v210, 16, v73
    v_and_b32 v211, 0xffff0000, v73
    v_lshlrev_b32 v212, 16, v74
    v_and_b32 v213, 0xffff0000, v74
    v_lshlrev_b32 v214, 16, v75
    v_and_b32 v215, 0xffff0000, v75
    v_lshlrev_b32 v216, 16, v76
    v_and_b32 v217, 0xffff0000, v76
    v_lshlrev_b32 v218, 16, v77
    v_and_b32 v219, 0xffff0000, v77
    v_lshlrev_b32 v220, 16, v78
    v_and_b32 v221, 0xffff0000, v78
    v_lshlrev_b32 v222, 16, v79
    v_and_b32 v223, 0xffff0000, v79
    v_lshlrev_b32 v224, 16, v80
    v_and_b32 v225, 0xffff0000, v80
    v_lshlrev_b32 v226, 16, v81
    v_and_b32 v227, 0xffff0000, v81
    v_lshlrev_b32 v228, 16, v82
    v_and_b32 v229, 0xffff0000, v82
    v_lshlrev_b32 v230, 16, v83
    v_and_b32 v231, 0xffff0000, v83
    v_lshlrev_b32 v232, 16, v84
    v_and_b32 v233, 0xffff0000, v84
    v_lshlrev_b32 v234, 16, v85
    v_and_b32 v235, 0xffff0000, v85
    v_lshlrev_b32 v236, 16, v86
    v_and_b32 v237, 0xffff0000, v86
    v_lshlrev_b32 v238, 16, v87
    v_and_b32 v239, 0xffff0000, v87
    v_mul_f32 v72, s71, v208
    v_mul_f32 v73, s71, v209
    v_mul_f32 v74, s71, v210
    v_mul_f32 v75, s71, v211
    v_mul_f32 v76, s71, v212
    v_mul_f32 v77, s71, v213
    v_mul_f32 v78, s71, v214
    v_mul_f32 v79, s71, v215
    v_mul_f32 v80, s71, v216
    v_mul_f32 v81, s71, v217
    v_mul_f32 v82, s71, v218
    v_mul_f32 v83, s71, v219
    v_mul_f32 v84, s71, v220
    v_mul_f32 v85, s71, v221
    v_mul_f32 v86, s71, v222
    v_mul_f32 v87, s71, v223
    v_mul_f32 v88, s71, v224
    v_mul_f32 v89, s71, v225
    v_mul_f32 v90, s71, v226
    v_mul_f32 v91, s71, v227
    v_mul_f32 v92, s71, v228
    v_mul_f32 v93, s71, v229
    v_mul_f32 v94, s71, v230
    v_mul_f32 v95, s71, v231
    v_mul_f32 v96, s71, v232
    v_mul_f32 v97, s71, v233
    v_mul_f32 v98, s71, v234
    v_mul_f32 v99, s71, v235
    v_mul_f32 v100, s71, v236
    v_mul_f32 v101, s71, v237
    v_mul_f32 v102, s71, v238
    v_mul_f32 v103, s71, v239
    v_exp_f32 v72, v72
    v_exp_f32 v73, v73
    v_exp_f32 v74, v74
    v_exp_f32 v75, v75
    v_exp_f32 v76, v76
    v_exp_f32 v77, v77
    v_exp_f32 v78, v78
    v_exp_f32 v79, v79
    v_exp_f32 v80, v80
    v_exp_f32 v81, v81
    v_exp_f32 v82, v82
    v_exp_f32 v83, v83
    v_exp_f32 v84, v84
    v_exp_f32 v85, v85
    v_exp_f32 v86, v86
    v_exp_f32 v87, v87
    v_exp_f32 v88, v88
    v_exp_f32 v89, v89
    v_exp_f32 v90, v90
    v_exp_f32 v91, v91
    v_exp_f32 v92, v92
    v_exp_f32 v93, v93
    v_exp_f32 v94, v94
    v_exp_f32 v95, v95
    v_exp_f32 v96, v96
    v_exp_f32 v97, v97
    v_exp_f32 v98, v98
    v_exp_f32 v99, v99
    v_exp_f32 v100, v100
    v_exp_f32 v101, v101
    v_exp_f32 v102, v102
    v_exp_f32 v103, v103
    v_add_f32 v72, 1.0, v72
    v_add_f32 v73, 1.0, v73
    v_add_f32 v74, 1.0, v74
    v_add_f32 v75, 1.0, v75
    v_add_f32 v76, 1.0, v76
    v_add_f32 v77, 1.0, v77
    v_add_f32 v78, 1.0, v78
    v_add_f32 v79, 1.0, v79
    v_add_f32 v80, 1.0, v80
    v_add_f32 v81, 1.0, v81
    v_add_f32 v82, 1.0, v82
    v_add_f32 v83, 1.0, v83
    v_add_f32 v84, 1.0, v84
    v_add_f32 v85, 1.0, v85
    v_add_f32 v86, 1.0, v86
    v_add_f32 v87, 1.0, v87
    v_add_f32 v88, 1.0, v88
    v_add_f32 v89, 1.0, v89
    v_add_f32 v90, 1.0, v90
    v_add_f32 v91, 1.0, v91
    v_add_f32 v92, 1.0, v92
    v_add_f32 v93, 1.0, v93
    v_add_f32 v94, 1.0, v94
    v_add_f32 v95, 1.0, v95
    v_add_f32 v96, 1.0, v96
    v_add_f32 v97, 1.0, v97
    v_add_f32 v98, 1.0, v98
    v_add_f32 v99, 1.0, v99
    v_add_f32 v100, 1.0, v100
    v_add_f32 v101, 1.0, v101
    v_add_f32 v102, 1.0, v102
    v_add_f32 v103, 1.0, v103
    v_rcp_f32 v72, v72
    v_rcp_f32 v73, v73
    v_rcp_f32 v74, v74
    v_rcp_f32 v75, v75
    v_rcp_f32 v76, v76
    v_rcp_f32 v77, v77
    v_rcp_f32 v78, v78
    v_rcp_f32 v79, v79
    v_rcp_f32 v80, v80
    v_rcp_f32 v81, v81
    v_rcp_f32 v82, v82
    v_rcp_f32 v83, v83
    v_rcp_f32 v84, v84
    v_rcp_f32 v85, v85
    v_rcp_f32 v86, v86
    v_rcp_f32 v87, v87
    v_rcp_f32 v88, v88
    v_rcp_f32 v89, v89
    v_rcp_f32 v90, v90
    v_rcp_f32 v91, v91
    v_rcp_f32 v92, v92
    v_rcp_f32 v93, v93
    v_rcp_f32 v94, v94
    v_rcp_f32 v95, v95
    v_rcp_f32 v96, v96
    v_rcp_f32 v97, v97
    v_rcp_f32 v98, v98
    v_rcp_f32 v99, v99
    v_rcp_f32 v100, v100
    v_rcp_f32 v101, v101
    v_rcp_f32 v102, v102
    v_rcp_f32 v103, v103
    v_pk_mul_f32 v[208:209], v[208:209], v[72:73]
    v_pk_mul_f32 v[210:211], v[210:211], v[74:75]
    v_pk_mul_f32 v[212:213], v[212:213], v[76:77]
    v_pk_mul_f32 v[214:215], v[214:215], v[78:79]
    v_pk_mul_f32 v[216:217], v[216:217], v[80:81]
    v_pk_mul_f32 v[218:219], v[218:219], v[82:83]
    v_pk_mul_f32 v[220:221], v[220:221], v[84:85]
    v_pk_mul_f32 v[222:223], v[222:223], v[86:87]
    v_pk_mul_f32 v[224:225], v[224:225], v[88:89]
    v_pk_mul_f32 v[226:227], v[226:227], v[90:91]
    v_pk_mul_f32 v[228:229], v[228:229], v[92:93]
    v_pk_mul_f32 v[230:231], v[230:231], v[94:95]
    v_pk_mul_f32 v[232:233], v[232:233], v[96:97]
    v_pk_mul_f32 v[234:235], v[234:235], v[98:99]
    v_pk_mul_f32 v[236:237], v[236:237], v[100:101]
    v_pk_mul_f32 v[238:239], v[238:239], v[102:103]
    s_waitcnt vmcnt(0)
L_cp:
    v_xor_b32 v7, s32, v160
    v_cmp_ne_u32 vcc, 0, v7
    s_nop 0
    s_cmp_eq_u64 vcc, 0
    s_cbranch_scc1 L_cpok
    s_add_u32 s70, s70, 1
    s_cmp_ge_u32 s70, 200000
    s_cbranch_scc1 L_cpok
    s_sleep 2
    buffer_load_dword v160, v161, s[12:15], s73 offen sc1
    s_waitcnt vmcnt(0)
    s_branch L_cp
L_cpok:
    s_barrier
    ds_read_b64_tr_b16 v[40:41], v250 offset:0
    ds_read_b64_tr_b16 v[42:43], v250 offset:2048
    ds_read_b64_tr_b16 v[44:45], v251 offset:0
    ds_read_b64_tr_b16 v[46:47], v251 offset:2048
    ds_read_b64_tr_b16 v[48:49], v252 offset:0
    ds_read_b64_tr_b16 v[50:51], v252 offset:2048
    ds_read_b64_tr_b16 v[52:53], v253 offset:0
    ds_read_b64_tr_b16 v[54:55], v253 offset:2048
    v_lshlrev_b32 v6, 10, v1
    buffer_load_dword v7, v6, s[12:15], s72 offen offset:1008 sc1
    s_waitcnt vmcnt(0)
L_op:
    v_cmp_eq_u32 vcc, -1, v7
    s_nop 1
    v_cndmask_b32 v7, 0, 1, vcc
    v_cmp_ne_u32 vcc, 0, v7
    s_nop 0
    s_cmp_eq_u64 vcc, 0
    s_cbranch_scc1 L_opok
    s_add_u32 s70, s70, 1
    s_cmp_ge_u32 s70, 200000
    s_cbranch_scc1 L_opok
    s_sleep 2
    buffer_load_dword v7, v6, s[12:15], s72 offen offset:1008 sc1
    s_waitcnt vmcnt(0)
    s_branch L_op
L_opok:
    s_add_u32 s3, s88, 0
    s_and_b32 s3, s3, 15
    s_lshl_b32 s3, s3, 11
    s_add_u32 s3, s3, s72
    buffer_load_dwordx4 v[72:75], v5, s[12:15], s3 offen offset:0 sc1
    buffer_load_dwordx4 v[76:79], v4, s[12:15], s3 offen offset:0 sc1
    buffer_load_dwordx4 v[80:83], v5, s[12:15], s3 offen offset:1024 sc1
    buffer_load_dwordx4 v[84:87], v4, s[12:15], s3 offen offset:1024 sc1
    s_add_u32 s3, s88, 1
    s_and_b32 s3, s3, 15
    s_lshl_b32 s3, s3, 11
    s_add_u32 s3, s3, s72
    buffer_load_dwordx4 v[88:91], v5, s[12:15], s3 offen offset:0 sc1
    buffer_load_dwordx4 v[92:95], v4, s[12:15], s3 offen offset:0 sc1
    buffer_load_dwordx4 v[96:99], v5, s[12:15], s3 offen offset:1024 sc1
    buffer_load_dwordx4 v[100:103], v4, s[12:15], s3 offen offset:1024 sc1
    s_add_u32 s3, s88, 2
    s_and_b32 s3, s3, 15
    s_lshl_b32 s3, s3, 11
    s_add_u32 s3, s3, s72
    buffer_load_dwordx4 v[104:107], v5, s[12:15], s3 offen offset:0 sc1
    buffer_load_dwordx4 v[108:111], v4, s[12:15], s3 offen offset:0 sc1
    buffer_load_dwordx4 v[112:115], v5, s[12:15], s3 offen offset:1024 sc1
    buffer_load_dwordx4 v[116:119], v4, s[12:15], s3 offen offset:1024 sc1
    s_add_u32 s3, s88, 3
    s_and_b32 s3, s3, 15
    s_lshl_b32 s3, s3, 11
    s_add_u32 s3, s3, s72
    buffer_load_dwordx4 v[120:123], v5, s[12:15], s3 offen offset:0 sc1
    buffer_load_dwordx4 v[124:127], v4, s[12:15], s3 offen offset:0 sc1
    buffer_load_dwordx4 v[128:131], v5, s[12:15], s3 offen offset:1024 sc1
    buffer_load_dwordx4 v[132:135], v4, s[12:15], s3 offen offset:1024 sc1
    s_add_u32 s3, s88, 4
    s_and_b32 s3, s3, 15
    s_lshl_b32 s3, s3, 11
    s_add_u32 s3, s3, s72
    buffer_load_dwordx4 v[136:139], v5, s[12:15], s3 offen offset:0 sc1
    buffer_load_dwordx4 v[140:143], v4, s[12:15], s3 offen offset:0 sc1
    buffer_load_dwordx4 v[144:147], v5, s[12:15], s3 offen offset:1024 sc1
    buffer_load_dwordx4 v[148:151], v4, s[12:15], s3 offen offset:1024 sc1
    s_add_u32 s3, s88, 5
    s_and_b32 s3, s3, 15
    s_lshl_b32 s3, s3, 11
    s_add_u32 s3, s3, s72
    buffer_load_dwordx4 v[152:155], v5, s[12:15], s3 offen offset:0 sc1
    buffer_load_dwordx4 v[156:159], v4, s[12:15], s3 offen offset:0 sc1
    s_waitcnt vmcnt(20)
    v_max_u32 v7, v72, v76
    v_cmp_eq_u32 vcc, -1, v7
    s_nop 3
    s_cbranch_vccnz L_r0
L_b0:
    buffer_load_dwordx4 v[160:163], v5, s[12:15], s3 offen offset:1024 sc1
    buffer_load_dwordx4 v[164:167], v4, s[12:15], s3 offen offset:1024 sc1
    s_waitcnt lgkmcnt(0)
    v_mfma_f32_16x16x32_bf16 v[8:11], v[40:43], v[72:75], 0
    ds_read_b64_tr_b16 v[56:57], v250 offset:4096
    v_mfma_f32_16x16x32_bf16 v[12:15], v[44:47], v[72:75], 0
    ds_read_b64_tr_b16 v[58:59], v250 offset:6144
    v_mfma_f32_16x16x32_bf16 v[16:19], v[48:51], v[72:75], 0
    ds_read_b64_tr_b16 v[60:61], v251 offset:4096
    v_mfma_f32_16x16x32_bf16 v[20:23], v[52:55], v[72:75], 0
    ds_read_b64_tr_b16 v[62:63], v251 offset:6144
    v_mfma_f32_16x16x32_bf16 v[24:27], v[40:43], v[76:79], 0
    ds_read_b64_tr_b16 v[64:65], v252 offset:4096
    s_waitcnt vmcnt(20)
    v_max_u32 v7, v80, v84
    v_cmp_eq_u32 vcc, -1, v7
    v_mfma_f32_16x16x32_bf16 v[28:31], v[44:47], v[76:79], 0
    ds_read_b64_tr_b16 v[66:67], v252 offset:6144
    v_mfma_f32_16x16x32_bf16 v[32:35], v[48:51], v[76:79], 0
    ds_read_b64_tr_b16 v[68:69], v253 offset:4096
    v_mfma_f32_16x16x32_bf16 v[36:39], v[52:55], v[76:79], 0
    ds_read_b64_tr_b16 v[70:71], v253 offset:6144
    s_cbranch_vccnz L_r1
L_b1:
    s_add_u32 s3, s88, 6
    s_and_b32 s3, s3, 15
    s_lshl_b32 s3, s3, 11
    s_add_u32 s3, s3, s72
    buffer_load_dwordx4 v[72:75], v5, s[12:15], s3 offen offset:0 sc1
    buffer_load_dwordx4 v[76:79], v4, s[12:15], s3 offen offset:0 sc1
    s_waitcnt lgkmcnt(0)
    v_mfma_f32_16x16x32_bf16 v[8:11], v[56:59], v[80:83], v[8:11]
    ds_read_b64_tr_b16 v[40:41], v250 offset:8192
    v_mfma_f32_16x16x32_bf16 v[12:15], v[60:63], v[80:83], v[12:15]
    ds_read_b64_tr_b16 v[42:43], v250 offset:10240
    v_mfma_f32_16x16x32_bf16 v[16:19], v[64:67], v[80:83], v[16:19]
    ds_read_b64_tr_b16 v[44:45], v251 offset:8192
    v_mfma_f32_16x16x32_bf16 v[20:23], v[68:71], v[80:83], v[20:23]
    ds_read_b64_tr_b16 v[46:47], v251 offset:10240
    v_mfma_f32_16x16x32_bf16 v[24:27], v[56:59], v[84:87], v[24:27]
    ds_read_b64_tr_b16 v[48:49], v252 offset:8192
    s_waitcnt vmcnt(20)
    v_max_u32 v7, v88, v92
    v_cmp_eq_u32 vcc, -1, v7
    v_mfma_f32_16x16x32_bf16 v[28:31], v[60:63], v[84:87], v[28:31]
    ds_read_b64_tr_b16 v[50:51], v252 offset:10240
    v_mfma_f32_16x16x32_bf16 v[32:35], v[64:67], v[84:87], v[32:35]
    ds_read_b64_tr_b16 v[52:53], v253 offset:8192
    v_mfma_f32_16x16x32_bf16 v[36:39], v[68:71], v[84:87], v[36:39]
    ds_read_b64_tr_b16 v[54:55], v253 offset:10240
    s_cbranch_vccnz L_r2
L_b2:
    buffer_load_dwordx4 v[80:83], v5, s[12:15], s3 offen offset:1024 sc1
    buffer_load_dwordx4 v[84:87], v4, s[12:15], s3 offen offset:1024 sc1
    s_waitcnt lgkmcnt(0)
    v_mfma_f32_16x16x32_bf16 v[8:11], v[40:43], v[88:91], v[8:11]
    ds_read_b64_tr_b16 v[56:57], v250 offset:12288
    v_mfma_f32_16x16x32_bf16 v[12:15], v[44:47], v[88:91], v[12:15]
    ds_read_b64_tr_b16 v[58:59], v250 offset:14336
    v_mfma_f32_16x16x32_bf16 v[16:19], v[48:51], v[88:91], v[16:19]
    ds_read_b64_tr_b16 v[60:61], v251 offset:12288
    v_mfma_f32_16x16x32_bf16 v[20:23], v[52:55], v[88:91], v[20:23]
    ds_read_b64_tr_b16 v[62:63], v251 offset:14336
    v_mfma_f32_16x16x32_bf16 v[24:27], v[40:43], v[92:95], v[24:27]
    ds_read_b64_tr_b16 v[64:65], v252 offset:12288
    s_waitcnt vmcnt(20)
    v_max_u32 v7, v96, v100
    v_cmp_eq_u32 vcc, -1, v7
    v_mfma_f32_16x16x32_bf16 v[28:31], v[44:47], v[92:95], v[28:31]
    ds_read_b64_tr_b16 v[66:67], v252 offset:14336
    v_mfma_f32_16x16x32_bf16 v[32:35], v[48:51], v[92:95], v[32:35]
    ds_read_b64_tr_b16 v[68:69], v253 offset:12288
    v_mfma_f32_16x16x32_bf16 v[36:39], v[52:55], v[92:95], v[36:39]
    ds_read_b64_tr_b16 v[70:71], v253 offset:14336
    s_cbranch_vccnz L_r3
L_b3:
    s_add_u32 s3, s88, 7
    s_and_b32 s3, s3, 15
    s_lshl_b32 s3, s3, 11
    s_add_u32 s3, s3, s72
    buffer_load_dwordx4 v[88:91], v5, s[12:15], s3 offen offset:0 sc1
    buffer_load_dwordx4 v[92:95], v4, s[12:15], s3 offen offset:0 sc1
    s_waitcnt lgkmcnt(0)
    v_mfma_f32_16x16x32_bf16 v[8:11], v[56:59], v[96:99], v[8:11]
    ds_read_b64_tr_b16 v[40:41], v250 offset:16384
    v_mfma_f32_16x16x32_bf16 v[12:15], v[60:63], v[96:99], v[12:15]
    ds_read_b64_tr_b16 v[42:43], v250 offset:18432
    v_mfma_f32_16x16x32_bf16 v[16:19], v[64:67], v[96:99], v[16:19]
    ds_read_b64_tr_b16 v[44:45], v251 offset:16384
    v_mfma_f32_16x16x32_bf16 v[20:23], v[68:71], v[96:99], v[20:23]
    ds_read_b64_tr_b16 v[46:47], v251 offset:18432
    v_mfma_f32_16x16x32_bf16 v[24:27], v[56:59], v[100:103], v[24:27]
    ds_read_b64_tr_b16 v[48:49], v252 offset:16384
    s_waitcnt vmcnt(20)
    v_max_u32 v7, v104, v108
    v_cmp_eq_u32 vcc, -1, v7
    v_mfma_f32_16x16x32_bf16 v[28:31], v[60:63], v[100:103], v[28:31]
    ds_read_b64_tr_b16 v[50:51], v252 offset:18432
    v_mfma_f32_16x16x32_bf16 v[32:35], v[64:67], v[100:103], v[32:35]
    ds_read_b64_tr_b16 v[52:53], v253 offset:16384
    v_mfma_f32_16x16x32_bf16 v[36:39], v[68:71], v[100:103], v[36:39]
    ds_read_b64_tr_b16 v[54:55], v253 offset:18432
    s_cbranch_vccnz L_r4
L_b4:
    buffer_load_dwordx4 v[96:99], v5, s[12:15], s3 offen offset:1024 sc1
    buffer_load_dwordx4 v[100:103], v4, s[12:15], s3 offen offset:1024 sc1
    s_waitcnt lgkmcnt(0)
    v_mfma_f32_16x16x32_bf16 v[8:11], v[40:43], v[104:107], v[8:11]
    ds_read_b64_tr_b16 v[56:57], v250 offset:20480
    v_mfma_f32_16x16x32_bf16 v[12:15], v[44:47], v[104:107], v[12:15]
    ds_read_b64_tr_b16 v[58:59], v250 offset:22528
    v_mfma_f32_16x16x32_bf16 v[16:19], v[48:51], v[104:107], v[16:19]
    ds_read_b64_tr_b16 v[60:61], v251 offset:20480
    v_mfma_f32_16x16x32_bf16 v[20:23], v[52:55], v[104:107], v[20:23]
    ds_read_b64_tr_b16 v[62:63], v251 offset:22528
    v_mfma_f32_16x16x32_bf16 v[24:27], v[40:43], v[108:111], v[24:27]
    ds_read_b64_tr_b16 v[64:65], v252 offset:20480
    s_waitcnt vmcnt(20)
    v_max_u32 v7, v112, v116
    v_cmp_eq_u32 vcc, -1, v7
    v_mfma_f32_16x16x32_bf16 v[28:31], v[44:47], v[108:111], v[28:31]
    ds_read_b64_tr_b16 v[66:67], v252 offset:22528
    v_mfma_f32_16x16x32_bf16 v[32:35], v[48:51], v[108:111], v[32:35]
    ds_read_b64_tr_b16 v[68:69], v253 offset:20480
    v_mfma_f32_16x16x32_bf16 v[36:39], v[52:55], v[108:111], v[36:39]
    ds_read_b64_tr_b16 v[70:71], v253 offset:22528
    s_cbranch_vccnz L_r5
L_b5:
    s_add_u32 s3, s88, 8
    s_and_b32 s3, s3, 15
    s_lshl_b32 s3, s3, 11
    s_add_u32 s3, s3, s72
    buffer_load_dwordx4 v[104:107], v5, s[12:15], s3 offen offset:0 sc1
    buffer_load_dwordx4 v[108:111], v4, s[12:15], s3 offen offset:0 sc1
    s_waitcnt lgkmcnt(0)
    v_mfma_f32_16x16x32_bf16 v[8:11], v[56:59], v[112:115], v[8:11]
    ds_read_b64_tr_b16 v[40:41], v250 offset:24576
    v_mfma_f32_16x16x32_bf16 v[12:15], v[60:63], v[112:115], v[12:15]
    ds_read_b64_tr_b16 v[42:43], v250 offset:26624
    v_mfma_f32_16x16x32_bf16 v[16:19], v[64:67], v[112:115], v[16:19]
    ds_read_b64_tr_b16 v[44:45], v251 offset:24576
    v_mfma_f32_16x16x32_bf16 v[20:23], v[68:71], v[112:115], v[20:23]
    ds_read_b64_tr_b16 v[46:47], v251 offset:26624
    v_mfma_f32_16x16x32_bf16 v[24:27], v[56:59], v[116:119], v[24:27]
    ds_read_b64_tr_b16 v[48:49], v252 offset:24576
    s_waitcnt vmcnt(20)
    v_max_u32 v7, v120, v124
    v_cmp_eq_u32 vcc, -1, v7
    v_mfma_f32_16x16x32_bf16 v[28:31], v[60:63], v[116:119], v[28:31]
    ds_read_b64_tr_b16 v[50:51], v252 offset:26624
    v_mfma_f32_16x16x32_bf16 v[32:35], v[64:67], v[116:119], v[32:35]
    ds_read_b64_tr_b16 v[52:53], v253 offset:24576
    v_mfma_f32_16x16x32_bf16 v[36:39], v[68:71], v[116:119], v[36:39]
    ds_read_b64_tr_b16 v[54:55], v253 offset:26624
    s_cbranch_vccnz L_r6
L_b6:
    buffer_load_dwordx4 v[112:115], v5, s[12:15], s3 offen offset:1024 sc1
    buffer_load_dwordx4 v[116:119], v4, s[12:15], s3 offen offset:1024 sc1
    s_waitcnt lgkmcnt(0)
    v_mfma_f32_16x16x32_bf16 v[8:11], v[40:43], v[120:123], v[8:11]
    ds_read_b64_tr_b16 v[56:57], v250 offset:28672
    v_mfma_f32_16x16x32_bf16 v[12:15], v[44:47], v[120:123], v[12:15]
    ds_read_b64_tr_b16 v[58:59], v250 offset:30720
    v_mfma_f32_16x16x32_bf16 v[16:19], v[48:51], v[120:123], v[16:19]
    ds_read_b64_tr_b16 v[60:61], v251 offset:28672
    v_mfma_f32_16x16x32_bf16 v[20:23], v[52:55], v[120:123], v[20:23]
    ds_read_b64_tr_b16 v[62:63], v251 offset:30720
    v_mfma_f32_16x16x32_bf16 v[24:27], v[40:43], v[124:127], v[24:27]
    ds_read_b64_tr_b16 v[64:65], v252 offset:28672
    s_waitcnt vmcnt(20)
    v_max_u32 v7, v128, v132
    v_cmp_eq_u32 vcc, -1, v7
    v_mfma_f32_16x16x32_bf16 v[28:31], v[44:47], v[124:127], v[28:31]
    ds_read_b64_tr_b16 v[66:67], v252 offset:30720
    v_mfma_f32_16x16x32_bf16 v[32:35], v[48:51], v[124:127], v[32:35]
    ds_read_b64_tr_b16 v[68:69], v253 offset:28672
    v_mfma_f32_16x16x32_bf16 v[36:39], v[52:55], v[124:127], v[36:39]
    ds_read_b64_tr_b16 v[70:71], v253 offset:30720
    s_cbranch_vccnz L_r7
L_b7:
    s_add_u32 s3, s88, 9
    s_and_b32 s3, s3, 15
    s_lshl_b32 s3, s3, 11
    s_add_u32 s3, s3, s72
    buffer_load_dwordx4 v[120:123], v5, s[12:15], s3 offen offset:0 sc1
    buffer_load_dwordx4 v[124:127], v4, s[12:15], s3 offen offset:0 sc1
    s_waitcnt lgkmcnt(0)
    v_mfma_f32_16x16x32_bf16 v[8:11], v[56:59], v[128:131], v[8:11]
    ds_read_b64_tr_b16 v[40:41], v250 offset:32768
    v_mfma_f32_16x16x32_bf16 v[12:15], v[60:63], v[128:131], v[12:15]
    ds_read_b64_tr_b16 v[42:43], v250 offset:34816
    v_mfma_f32_16x16x32_bf16 v[16:19], v[64:67], v[128:131], v[16:19]
    ds_read_b64_tr_b16 v[44:45], v251 offset:32768
    v_mfma_f32_16x16x32_bf16 v[20:23], v[68:71], v[128:131], v[20:23]
    ds_read_b64_tr_b16 v[46:47], v251 offset:34816
    v_mfma_f32_16x16x32_bf16 v[24:27], v[56:59], v[132:135], v[24:27]
    ds_read_b64_tr_b16 v[48:49], v252 offset:32768
    s_waitcnt vmcnt(20)
    v_max_u32 v7, v136, v140
    v_cmp_eq_u32 vcc, -1, v7
    v_mfma_f32_16x16x32_bf16 v[28:31], v[60:63], v[132:135], v[28:31]
    ds_read_b64_tr_b16 v[50:51], v252 offset:34816
    v_mfma_f32_16x16x32_bf16 v[32:35], v[64:67], v[132:135], v[32:35]
    ds_read_b64_tr_b16 v[52:53], v253 offset:32768
    v_mfma_f32_16x16x32_bf16 v[36:39], v[68:71], v[132:135], v[36:39]
    ds_read_b64_tr_b16 v[54:55], v253 offset:34816
    s_cbranch_vccnz L_r8
L_b8:
    buffer_load_dwordx4 v[128:131], v5, s[12:15], s3 offen offset:1024 sc1
    buffer_load_dwordx4 v[132:135], v4, s[12:15], s3 offen offset:1024 sc1
    s_waitcnt lgkmcnt(0)
    v_mfma_f32_16x16x32_bf16 v[8:11], v[40:43], v[136:139], v[8:11]
    ds_read_b64_tr_b16 v[56:57], v250 offset:36864
    v_mfma_f32_16x16x32_bf16 v[12:15], v[44:47], v[136:139], v[12:15]
    ds_read_b64_tr_b16 v[58:59], v250 offset:38912
    v_mfma_f32_16x16x32_bf16 v[16:19], v[48:51], v[136:139], v[16:19]
    ds_read_b64_tr_b16 v[60:61], v251 offset:36864
    v_mfma_f32_16x16x32_bf16 v[20:23], v[52:55], v[136:139], v[20:23]
    ds_read_b64_tr_b16 v[62:63], v251 offset:38912
    v_mfma_f32_16x16x32_bf16 v[24:27], v[40:43], v[140:143], v[24:27]
    ds_read_b64_tr_b16 v[64:65], v252 offset:36864
    s_waitcnt vmcnt(20)
    v_max_u32 v7, v144, v148
    v_cmp_eq_u32 vcc, -1, v7
    v_mfma_f32_16x16x32_bf16 v[28:31], v[44:47], v[140:143], v[28:31]
    ds_read_b64_tr_b16 v[66:67], v252 offset:38912
    v_mfma_f32_16x16x32_bf16 v[32:35], v[48:51], v[140:143], v[32:35]
    ds_read_b64_tr_b16 v[68:69], v253 offset:36864
    v_mfma_f32_16x16x32_bf16 v[36:39], v[52:55], v[140:143], v[36:39]
    ds_read_b64_tr_b16 v[70:71], v253 offset:38912
    s_cbranch_vccnz L_r9
L_b9:
    s_add_u32 s3, s88, 10
    s_and_b32 s3, s3, 15
    s_lshl_b32 s3, s3, 11
    s_add_u32 s3, s3, s72
    buffer_load_dwordx4 v[136:139], v5, s[12:15], s3 offen offset:0 sc1
    buffer_load_dwordx4 v[140:143], v4, s[12:15], s3 offen offset:0 sc1
    s_waitcnt lgkmcnt(0)
    v_mfma_f32_16x16x32_bf16 v[8:11], v[56:59], v[144:147], v[8:11]
    ds_read_b64_tr_b16 v[40:41], v250 offset:40960
    v_mfma_f32_16x16x32_bf16 v[12:15], v[60:63], v[144:147], v[12:15]
    ds_read_b64_tr_b16 v[42:43], v250 offset:43008
    v_mfma_f32_16x16x32_bf16 v[16:19], v[64:67], v[144:147], v[16:19]
    ds_read_b64_tr_b16 v[44:45], v251 offset:40960
    v_mfma_f32_16x16x32_bf16 v[20:23], v[68:71], v[144:147], v[20:23]
    ds_read_b64_tr_b16 v[46:47], v251 offset:43008
    v_mfma_f32_16x16x32_bf16 v[24:27], v[56:59], v[148:151], v[24:27]
    ds_read_b64_tr_b16 v[48:49], v252 offset:40960
    s_waitcnt vmcnt(20)
    v_max_u32 v7, v152, v156
    v_cmp_eq_u32 vcc, -1, v7
    v_mfma_f32_16x16x32_bf16 v[28:31], v[60:63], v[148:151], v[28:31]
    ds_read_b64_tr_b16 v[50:51], v252 offset:43008
    v_mfma_f32_16x16x32_bf16 v[32:35], v[64:67], v[148:151], v[32:35]
    ds_read_b64_tr_b16 v[52:53], v253 offset:40960
    v_mfma_f32_16x16x32_bf16 v[36:39], v[68:71], v[148:151], v[36:39]
    ds_read_b64_tr_b16 v[54:55], v253 offset:43008
    s_cbranch_vccnz L_r10
L_b10:
    buffer_load_dwordx4 v[144:147], v5, s[12:15], s3 offen offset:1024 sc1
    buffer_load_dwordx4 v[148:151], v4, s[12:15], s3 offen offset:1024 sc1
    s_waitcnt lgkmcnt(0)
    v_mfma_f32_16x16x32_bf16 v[8:11], v[40:43], v[152:155], v[8:11]
    ds_read_b64_tr_b16 v[56:57], v250 offset:45056
    v_mfma_f32_16x16x32_bf16 v[12:15], v[44:47], v[152:155], v[12:15]
    ds_read_b64_tr_b16 v[58:59], v250 offset:47104
    v_mfma_f32_16x16x32_bf16 v[16:19], v[48:51], v[152:155], v[16:19]
    ds_read_b64_tr_b16 v[60:61], v251 offset:45056
    v_mfma_f32_16x16x32_bf16 v[20:23], v[52:55], v[152:155], v[20:23]
    ds_read_b64_tr_b16 v[62:63], v251 offset:47104
    v_mfma_f32_16x16x32_bf16 v[24:27], v[40:43], v[156:159], v[24:27]
    ds_read_b64_tr_b16 v[64:65], v252 offset:45056
    s_waitcnt vmcnt(20)
    v_max_u32 v7, v160, v164
    v_cmp_eq_u32 vcc, -1, v7
    v_mfma_f32_16x16x32_bf16 v[28:31], v[44:47], v[156:159], v[28:31]
    ds_read_b64_tr_b16 v[66:67], v252 offset:47104
    v_mfma_f32_16x16x32_bf16 v[32:35], v[48:51], v[156:159], v[32:35]
    ds_read_b64_tr_b16 v[68:69], v253 offset:45056
    v_mfma_f32_16x16x32_bf16 v[36:39], v[52:55], v[156:159], v[36:39]
    ds_read_b64_tr_b16 v[70:71], v253 offset:47104
    s_cbranch_vccnz L_r11
L_b11:
    s_add_u32 s3, s88, 11
    s_and_b32 s3, s3, 15
    s_lshl_b32 s3, s3, 11
    s_add_u32 s3, s3, s72
    buffer_load_dwordx4 v[152:155], v5, s[12:15], s3 offen offset:0 sc1
    buffer_load_dwordx4 v[156:159], v4, s[12:15], s3 offen offset:0 sc1
    s_waitcnt lgkmcnt(0)
    v_mfma_f32_16x16x32_bf16 v[8:11], v[56:59], v[160:163], v[8:11]
    ds_read_b64_tr_b16 v[40:41], v250 offset:49152
    v_mfma_f32_16x16x32_bf16 v[12:15], v[60:63], v[160:163], v[12:15]
    ds_read_b64_tr_b16 v[42:43], v250 offset:51200
    v_mfma_f32_16x16x32_bf16 v[16:19], v[64:67], v[160:163], v[16:19]
    ds_read_b64_tr_b16 v[44:45], v251 offset:49152
    v_mfma_f32_16x16x32_bf16 v[20:23], v[68:71], v[160:163], v[20:23]
    ds_read_b64_tr_b16 v[46:47], v251 offset:51200
    v_mfma_f32_16x16x32_bf16 v[24:27], v[56:59], v[164:167], v[24:27]
    ds_read_b64_tr_b16 v[48:49], v252 offset:49152
    s_waitcnt vmcnt(20)
    v_max_u32 v7, v72, v76
    v_cmp_eq_u32 vcc, -1, v7
    v_mfma_f32_16x16x32_bf16 v[28:31], v[60:63], v[164:167], v[28:31]
    ds_read_b64_tr_b16 v[50:51], v252 offset:51200
    v_mfma_f32_16x16x32_bf16 v[32:35], v[64:67], v[164:167], v[32:35]
    ds_read_b64_tr_b16 v[52:53], v253 offset:49152
    v_mfma_f32_16x16x32_bf16 v[36:39], v[68:71], v[164:167], v[36:39]
    ds_read_b64_tr_b16 v[54:55], v253 offset:51200
    s_cbranch_vccnz L_r12
L_b12:
    buffer_load_dwordx4 v[160:163], v5, s[12:15], s3 offen offset:1024 sc1
    buffer_load_dwordx4 v[164:167], v4, s[12:15], s3 offen offset:1024 sc1
    s_waitcnt lgkmcnt(0)
    v_mfma_f32_16x16x32_bf16 v[8:11], v[40:43], v[72:75], v[8:11]
    ds_read_b64_tr_b16 v[56:57], v250 offset:53248
    v_mfma_f32_16x16x32_bf16 v[12:15], v[44:47], v[72:75], v[12:15]
    ds_read_b64_tr_b16 v[58:59], v250 offset:55296
    v_mfma_f32_16x16x32_bf16 v[16:19], v[48:51], v[72:75], v[16:19]
    ds_read_b64_tr_b16 v[60:61], v251 offset:53248
    v_mfma_f32_16x16x32_bf16 v[20:23], v[52:55], v[72:75], v[20:23]
    ds_read_b64_tr_b16 v[62:63], v251 offset:55296
    v_mfma_f32_16x16x32_bf16 v[24:27], v[40:43], v[76:79], v[24:27]
    ds_read_b64_tr_b16 v[64:65], v252 offset:53248
    s_waitcnt vmcnt(20)
    v_max_u32 v7, v80, v84
    v_cmp_eq_u32 vcc, -1, v7
    v_mfma_f32_16x16x32_bf16 v[28:31], v[44:47], v[76:79], v[28:31]
    ds_read_b64_tr_b16 v[66:67], v252 offset:55296
    v_mfma_f32_16x16x32_bf16 v[32:35], v[48:51], v[76:79], v[32:35]
    ds_read_b64_tr_b16 v[68:69], v253 offset:53248
    v_mfma_f32_16x16x32_bf16 v[36:39], v[52:55], v[76:79], v[36:39]
    ds_read_b64_tr_b16 v[70:71], v253 offset:55296
    s_cbranch_vccnz L_r13
L_b13:
    s_add_u32 s3, s88, 12
    s_and_b32 s3, s3, 15
    s_lshl_b32 s3, s3, 11
    s_add_u32 s3, s3, s72
    buffer_load_dwordx4 v[72:75], v5, s[12:15], s3 offen offset:0 sc1
    buffer_load_dwordx4 v[76:79], v4, s[12:15], s3 offen offset:0 sc1
    s_waitcnt lgkmcnt(0)
    v_mfma_f32_16x16x32_bf16 v[8:11], v[56:59], v[80:83], v[8:11]
    ds_read_b64_tr_b16 v[40:41], v250 offset:57344
    v_mfma_f32_16x16x32_bf16 v[12:15], v[60:63], v[80:83], v[12:15]
    ds_read_b64_tr_b16 v[42:43], v250 offset:59392
    v_mfma_f32_16x16x32_bf16 v[16:19], v[64:67], v[80:83], v[16:19]
    ds_read_b64_tr_b16 v[44:45], v251 offset:57344
    v_mfma_f32_16x16x32_bf16 v[20:23], v[68:71], v[80:83], v[20:23]
    ds_read_b64_tr_b16 v[46:47], v251 offset:59392
    v_mfma_f32_16x16x32_bf16 v[24:27], v[56:59], v[84:87], v[24:27]
    ds_read_b64_tr_b16 v[48:49], v252 offset:57344
    s_waitcnt vmcnt(20)
    v_max_u32 v7, v88, v92
    v_cmp_eq_u32 vcc, -1, v7
    v_mfma_f32_16x16x32_bf16 v[28:31], v[60:63], v[84:87], v[28:31]
    ds_read_b64_tr_b16 v[50:51], v252 offset:59392
    v_mfma_f32_16x16x32_bf16 v[32:35], v[64:67], v[84:87], v[32:35]
    ds_read_b64_tr_b16 v[52:53], v253 offset:57344
    v_mfma_f32_16x16x32_bf16 v[36:39], v[68:71], v[84:87], v[36:39]
    ds_read_b64_tr_b16 v[54:55], v253 offset:59392
    s_cbranch_vccnz L_r14
L_b14:
    buffer_load_dwordx4 v[80:83], v5, s[12:15], s3 offen offset:1024 sc1
    buffer_load_dwordx4 v[84:87], v4, s[12:15], s3 offen offset:1024 sc1
    s_waitcnt lgkmcnt(0)
    v_mfma_f32_16x16x32_bf16 v[8:11], v[40:43], v[88:91], v[8:11]
    ds_read_b64_tr_b16 v[56:57], v250 offset:61440
    v_mfma_f32_16x16x32_bf16 v[12:15], v[44:47], v[88:91], v[12:15]
    ds_read_b64_tr_b16 v[58:59], v250 offset:63488
    v_mfma_f32_16x16x32_bf16 v[16:19], v[48:51], v[88:91], v[16:19]
    ds_read_b64_tr_b16 v[60:61], v251 offset:61440
    v_mfma_f32_16x16x32_bf16 v[20:23], v[52:55], v[88:91], v[20:23]
    ds_read_b64_tr_b16 v[62:63], v251 offset:63488
    v_mfma_f32_16x16x32_bf16 v[24:27], v[40:43], v[92:95], v[24:27]
    ds_read_b64_tr_b16 v[64:65], v252 offset:61440
    s_waitcnt vmcnt(20)
    v_max_u32 v7, v96, v100
    v_cmp_eq_u32 vcc, -1, v7
    v_mfma_f32_16x16x32_bf16 v[28:31], v[44:47], v[92:95], v[28:31]
    ds_read_b64_tr_b16 v[66:67], v252 offset:63488
    v_mfma_f32_16x16x32_bf16 v[32:35], v[48:51], v[92:95], v[32:35]
    ds_read_b64_tr_b16 v[68:69], v253 offset:61440
    v_mfma_f32_16x16x32_bf16 v[36:39], v[52:55], v[92:95], v[36:39]
    ds_read_b64_tr_b16 v[70:71], v253 offset:63488
    s_cbranch_vccnz L_r15
L_b15:
    s_add_u32 s3, s88, 13
    s_and_b32 s3, s3, 15
    s_lshl_b32 s3, s3, 11
    s_add_u32 s3, s3, s72
    buffer_load_dwordx4 v[88:91], v5, s[12:15], s3 offen offset:0 sc1
    buffer_load_dwordx4 v[92:95], v4, s[12:15], s3 offen offset:0 sc1
    s_waitcnt lgkmcnt(0)
    v_add_u32 v250, 0x10000, v250
    v_add_u32 v251, 0x10000, v251
    v_add_u32 v252, 0x10000, v252
    v_add_u32 v253, 0x10000, v253
    v_mfma_f32_16x16x32_bf16 v[8:11], v[56:59], v[96:99], v[8:11]
    ds_read_b64_tr_b16 v[40:41], v250 offset:0
    v_mfma_f32_16x16x32_bf16 v[12:15], v[60:63], v[96:99], v[12:15]
    ds_read_b64_tr_b16 v[42:43], v250 offset:2048
    v_mfma_f32_16x16x32_bf16 v[16:19], v[64:67], v[96:99], v[16:19]
    ds_read_b64_tr_b16 v[44:45], v251 offset:0
    v_mfma_f32_16x16x32_bf16 v[20:23], v[68:71], v[96:99], v[20:23]
    ds_read_b64_tr_b16 v[46:47], v251 offset:2048
    v_mfma_f32_16x16x32_bf16 v[24:27], v[56:59], v[100:103], v[24:27]
    ds_read_b64_tr_b16 v[48:49], v252 offset:0
    s_waitcnt vmcnt(20)
    v_max_u32 v7, v104, v108
    v_cmp_eq_u32 vcc, -1, v7
    v_mfma_f32_16x16x32_bf16 v[28:31], v[60:63], v[100:103], v[28:31]
    ds_read_b64_tr_b16 v[50:51], v252 offset:2048
    v_mfma_f32_16x16x32_bf16 v[32:35], v[64:67], v[100:103], v[32:35]
    ds_read_b64_tr_b16 v[52:53], v253 offset:0
    v_mfma_f32_16x16x32_bf16 v[36:39], v[68:71], v[100:103], v[36:39]
    ds_read_b64_tr_b16 v[54:55], v253 offset:2048
    s_cbranch_vccnz L_r16
L_b16:
    buffer_load_dwordx4 v[96:99], v5, s[12:15], s3 offen offset:1024 sc1
    buffer_load_dwordx4 v[100:103], v4, s[12:15], s3 offen offset:1024 sc1
    s_waitcnt lgkmcnt(0)
    v_mfma_f32_16x16x32_bf16 v[8:11], v[40:43], v[104:107], v[8:11]
    ds_read_b64_tr_b16 v[56:57], v250 offset:4096
    v_mfma_f32_16x16x32_bf16 v[12:15], v[44:47], v[104:107], v[12:15]
    ds_read_b64_tr_b16 v[58:59], v250 offset:6144
    v_mfma_f32_16x16x32_bf16 v[16:19], v[48:51], v[104:107], v[16:19]
    ds_read_b64_tr_b16 v[60:61], v251 offset:4096
    v_mfma_f32_16x16x32_bf16 v[20:23], v[52:55], v[104:107], v[20:23]
    ds_read_b64_tr_b16 v[62:63], v251 offset:6144
    v_mfma_f32_16x16x32_bf16 v[24:27], v[40:43], v[108:111], v[24:27]
    ds_read_b64_tr_b16 v[64:65], v252 offset:4096
    s_waitcnt vmcnt(20)
    v_max_u32 v7, v112, v116
    v_cmp_eq_u32 vcc, -1, v7
    v_mfma_f32_16x16x32_bf16 v[28:31], v[44:47], v[108:111], v[28:31]
    ds_read_b64_tr_b16 v[66:67], v252 offset:6144
    v_mfma_f32_16x16x32_bf16 v[32:35], v[48:51], v[108:111], v[32:35]
    ds_read_b64_tr_b16 v[68:69], v253 offset:4096
    v_mfma_f32_16x16x32_bf16 v[36:39], v[52:55], v[108:111], v[36:39]
    ds_read_b64_tr_b16 v[70:71], v253 offset:6144
    s_cbranch_vccnz L_r17
L_b17:
    s_add_u32 s3, s88, 14
    s_and_b32 s3, s3, 15
    s_lshl_b32 s3, s3, 11
    s_add_u32 s3, s3, s72
    buffer_load_dwordx4 v[104:107], v5, s[12:15], s3 offen offset:0 sc1
    buffer_load_dwordx4 v[108:111], v4, s[12:15], s3 offen offset:0 sc1
    s_waitcnt lgkmcnt(0)
    v_mfma_f32_16x16x32_bf16 v[8:11], v[56:59], v[112:115], v[8:11]
    ds_read_b64_tr_b16 v[40:41], v250 offset:8192
    v_mfma_f32_16x16x32_bf16 v[12:15], v[60:63], v[112:115], v[12:15]
    ds_read_b64_tr_b16 v[42:43], v250 offset:10240
    v_mfma_f32_16x16x32_bf16 v[16:19], v[64:67], v[112:115], v[16:19]
    ds_read_b64_tr_b16 v[44:45], v251 offset:8192
    v_mfma_f32_16x16x32_bf16 v[20:23], v[68:71], v[112:115], v[20:23]
    ds_read_b64_tr_b16 v[46:47], v251 offset:10240
    v_mfma_f32_16x16x32_bf16 v[24:27], v[56:59], v[116:119], v[24:27]
    ds_read_b64_tr_b16 v[48:49], v252 offset:8192
    s_waitcnt vmcnt(20)
    v_max_u32 v7, v120, v124
    v_cmp_eq_u32 vcc, -1, v7
    v_mfma_f32_16x16x32_bf16 v[28:31], v[60:63], v[116:119], v[28:31]
    ds_read_b64_tr_b16 v[50:51], v252 offset:10240
    v_mfma_f32_16x16x32_bf16 v[32:35], v[64:67], v[116:119], v[32:35]
    ds_read_b64_tr_b16 v[52:53], v253 offset:8192
    v_mfma_f32_16x16x32_bf16 v[36:39], v[68:71], v[116:119], v[36:39]
    ds_read_b64_tr_b16 v[54:55], v253 offset:10240
    s_cbranch_vccnz L_r18
L_b18:
    buffer_load_dwordx4 v[112:115], v5, s[12:15], s3 offen offset:1024 sc1
    buffer_load_dwordx4 v[116:119], v4, s[12:15], s3 offen offset:1024 sc1
    s_waitcnt lgkmcnt(0)
    v_mfma_f32_16x16x32_bf16 v[8:11], v[40:43], v[120:123], v[8:11]
    ds_read_b64_tr_b16 v[56:57], v250 offset:12288
    v_mfma_f32_16x16x32_bf16 v[12:15], v[44:47], v[120:123], v[12:15]
    ds_read_b64_tr_b16 v[58:59], v250 offset:14336
    v_mfma_f32_16x16x32_bf16 v[16:19], v[48:51], v[120:123], v[16:19]
    ds_read_b64_tr_b16 v[60:61], v251 offset:12288
    v_mfma_f32_16x16x32_bf16 v[20:23], v[52:55], v[120:123], v[20:23]
    ds_read_b64_tr_b16 v[62:63], v251 offset:14336
    v_mfma_f32_16x16x32_bf16 v[24:27], v[40:43], v[124:127], v[24:27]
    ds_read_b64_tr_b16 v[64:65], v252 offset:12288
    s_waitcnt vmcnt(20)
    v_max_u32 v7, v128, v132
    v_cmp_eq_u32 vcc, -1, v7
    v_mfma_f32_16x16x32_bf16 v[28:31], v[44:47], v[124:127], v[28:31]
    ds_read_b64_tr_b16 v[66:67], v252 offset:14336
    v_mfma_f32_16x16x32_bf16 v[32:35], v[48:51], v[124:127], v[32:35]
    ds_read_b64_tr_b16 v[68:69], v253 offset:12288
    v_mfma_f32_16x16x32_bf16 v[36:39], v[52:55], v[124:127], v[36:39]
    ds_read_b64_tr_b16 v[70:71], v253 offset:14336
    s_cbranch_vccnz L_r19
L_b19:
    s_add_u32 s3, s88, 15
    s_and_b32 s3, s3, 15
    s_lshl_b32 s3, s3, 11
    s_add_u32 s3, s3, s72
    buffer_load_dwordx4 v[120:123], v5, s[12:15], s3 offen offset:0 sc1
    buffer_load_dwordx4 v[124:127], v4, s[12:15], s3 offen offset:0 sc1
    s_waitcnt lgkmcnt(0)
    v_mfma_f32_16x16x32_bf16 v[8:11], v[56:59], v[128:131], v[8:11]
    ds_read_b64_tr_b16 v[40:41], v250 offset:16384
    v_mfma_f32_16x16x32_bf16 v[12:15], v[60:63], v[128:131], v[12:15]
    ds_read_b64_tr_b16 v[42:43], v250 offset:18432
    v_mfma_f32_16x16x32_bf16 v[16:19], v[64:67], v[128:131], v[16:19]
    ds_read_b64_tr_b16 v[44:45], v251 offset:16384
    v_mfma_f32_16x16x32_bf16 v[20:23], v[68:71], v[128:131], v[20:23]
    ds_read_b64_tr_b16 v[46:47], v251 offset:18432
    v_mfma_f32_16x16x32_bf16 v[24:27], v[56:59], v[132:135], v[24:27]
    ds_read_b64_tr_b16 v[48:49], v252 offset:16384
    s_waitcnt vmcnt(20)
    v_max_u32 v7, v136, v140
    v_cmp_eq_u32 vcc, -1, v7
    v_mfma_f32_16x16x32_bf16 v[28:31], v[60:63], v[132:135], v[28:31]
    ds_read_b64_tr_b16 v[50:51], v252 offset:18432
    v_mfma_f32_16x16x32_bf16 v[32:35], v[64:67], v[132:135], v[32:35]
    ds_read_b64_tr_b16 v[52:53], v253 offset:16384
    v_mfma_f32_16x16x32_bf16 v[36:39], v[68:71], v[132:135], v[36:39]
    ds_read_b64_tr_b16 v[54:55], v253 offset:18432
    s_cbranch_vccnz L_r20
L_b20:
    buffer_load_dwordx4 v[128:131], v5, s[12:15], s3 offen offset:1024 sc1
    buffer_load_dwordx4 v[132:135], v4, s[12:15], s3 offen offset:1024 sc1
    s_waitcnt lgkmcnt(0)
    v_mfma_f32_16x16x32_bf16 v[8:11], v[40:43], v[136:139], v[8:11]
    ds_read_b64_tr_b16 v[56:57], v250 offset:20480
    v_mfma_f32_16x16x32_bf16 v[12:15], v[44:47], v[136:139], v[12:15]
    ds_read_b64_tr_b16 v[58:59], v250 offset:22528
    v_mfma_f32_16x16x32_bf16 v[16:19], v[48:51], v[136:139], v[16:19]
    ds_read_b64_tr_b16 v[60:61], v251 offset:20480
    v_mfma_f32_16x16x32_bf16 v[20:23], v[52:55], v[136:139], v[20:23]
    ds_read_b64_tr_b16 v[62:63], v251 offset:22528
    v_mfma_f32_16x16x32_bf16 v[24:27], v[40:43], v[140:143], v[24:27]
    ds_read_b64_tr_b16 v[64:65], v252 offset:20480
    s_waitcnt vmcnt(20)
    v_max_u32 v7, v144, v148
    v_cmp_eq_u32 vcc, -1, v7
    v_mfma_f32_16x16x32_bf16 v[28:31], v[44:47], v[140:143], v[28:31]
    ds_read_b64_tr_b16 v[66:67], v252 offset:22528
    v_mfma_f32_16x16x32_bf16 v[32:35], v[48:51], v[140:143], v[32:35]
    ds_read_b64_tr_b16 v[68:69], v253 offset:20480
    v_mfma_f32_16x16x32_bf16 v[36:39], v[52:55], v[140:143], v[36:39]
    ds_read_b64_tr_b16 v[70:71], v253 offset:22528
    s_cbranch_vccnz L_r21
L_b21:
    s_waitcnt lgkmcnt(0)
    v_mfma_f32_16x16x32_bf16 v[8:11], v[56:59], v[144:147], v[8:11]
    ds_read_b64_tr_b16 v[40:41], v250 offset:24576
    v_mfma_f32_16x16x32_bf16 v[12:15], v[60:63], v[144:147], v[12:15]
    ds_read_b64_tr_b16 v[42:43], v250 offset:26624
    v_mfma_f32_16x16x32_bf16 v[16:19], v[64:67], v[144:147], v[16:19]
    ds_read_b64_tr_b16 v[44:45], v251 offset:24576
    v_mfma_f32_16x16x32_bf16 v[20:23], v[68:71], v[144:147], v[20:23]
    ds_read_b64_tr_b16 v[46:47], v251 offset:26624
    v_mfma_f32_16x16x32_bf16 v[24:27], v[56:59], v[148:151], v[24:27]
    ds_read_b64_tr_b16 v[48:49], v252 offset:24576
    s_waitcnt vmcnt(18)
    v_max_u32 v7, v152, v156
    v_cmp_eq_u32 vcc, -1, v7
    v_mfma_f32_16x16x32_bf16 v[28:31], v[60:63], v[148:151], v[28:31]
    ds_read_b64_tr_b16 v[50:51], v252 offset:26624
    v_mfma_f32_16x16x32_bf16 v[32:35], v[64:67], v[148:151], v[32:35]
    ds_read_b64_tr_b16 v[52:53], v253 offset:24576
    v_mfma_f32_16x16x32_bf16 v[36:39], v[68:71], v[148:151], v[36:39]
    ds_read_b64_tr_b16 v[54:55], v253 offset:26624
    s_cbranch_vccnz L_r22
L_b22:
    s_waitcnt lgkmcnt(0)
    v_mfma_f32_16x16x32_bf16 v[8:11], v[40:43], v[152:155], v[8:11]
    ds_read_b64_tr_b16 v[56:57], v250 offset:28672
    v_mfma_f32_16x16x32_bf16 v[12:15], v[44:47], v[152:155], v[12:15]
    ds_read_b64_tr_b16 v[58:59], v250 offset:30720
    v_mfma_f32_16x16x32_bf16 v[16:19], v[48:51], v[152:155], v[16:19]
    ds_read_b64_tr_b16 v[60:61], v251 offset:28672
    v_mfma_f32_16x16x32_bf16 v[20:23], v[52:55], v[152:155], v[20:23]
    ds_read_b64_tr_b16 v[62:63], v251 offset:30720
    v_mfma_f32_16x16x32_bf16 v[24:27], v[40:43], v[156:159], v[24:27]
    ds_read_b64_tr_b16 v[64:65], v252 offset:28672
    s_waitcnt vmcnt(16)
    v_max_u32 v7, v160, v164
    v_cmp_eq_u32 vcc, -1, v7
    v_mfma_f32_16x16x32_bf16 v[28:31], v[44:47], v[156:159], v[28:31]
    ds_read_b64_tr_b16 v[66:67], v252 offset:30720
    v_mfma_f32_16x16x32_bf16 v[32:35], v[48:51], v[156:159], v[32:35]
    ds_read_b64_tr_b16 v[68:69], v253 offset:28672
    v_mfma_f32_16x16x32_bf16 v[36:39], v[52:55], v[156:159], v[36:39]
    ds_read_b64_tr_b16 v[70:71], v253 offset:30720
    s_cbranch_vccnz L_r23
L_b23:
    s_waitcnt lgkmcnt(0)
    v_mfma_f32_16x16x32_bf16 v[8:11], v[56:59], v[160:163], v[8:11]
    ds_read_b64_tr_b16 v[40:41], v250 offset:32768
    v_mfma_f32_16x16x32_bf16 v[12:15], v[60:63], v[160:163], v[12:15]
    ds_read_b64_tr_b16 v[42:43], v250 offset:34816
    v_mfma_f32_16x16x32_bf16 v[16:19], v[64:67], v[160:163], v[16:19]
    ds_read_b64_tr_b16 v[44:45], v251 offset:32768
    v_mfma_f32_16x16x32_bf16 v[20:23], v[68:71], v[160:163], v[20:23]
    ds_read_b64_tr_b16 v[46:47], v251 offset:34816
    v_mfma_f32_16x16x32_bf16 v[24:27], v[56:59], v[164:167], v[24:27]
    ds_read_b64_tr_b16 v[48:49], v252 offset:32768
    s_waitcnt vmcnt(14)
    v_max_u32 v7, v72, v76
    v_cmp_eq_u32 vcc, -1, v7
    v_mfma_f32_16x16x32_bf16 v[28:31], v[60:63], v[164:167], v[28:31]
    ds_read_b64_tr_b16 v[50:51], v252 offset:34816
    v_mfma_f32_16x16x32_bf16 v[32:35], v[64:67], v[164:167], v[32:35]
    ds_read_b64_tr_b16 v[52:53], v253 offset:32768
    v_mfma_f32_16x16x32_bf16 v[36:39], v[68:71], v[164:167], v[36:39]
    ds_read_b64_tr_b16 v[54:55], v253 offset:34816
    s_cbranch_vccnz L_r24
L_b24:
    s_waitcnt lgkmcnt(0)
    v_mfma_f32_16x16x32_bf16 v[8:11], v[40:43], v[72:75], v[8:11]
    ds_read_b64_tr_b16 v[56:57], v250 offset:36864
    v_mfma_f32_16x16x32_bf16 v[12:15], v[44:47], v[72:75], v[12:15]
    ds_read_b64_tr_b16 v[58:59], v250 offset:38912
    v_mfma_f32_16x16x32_bf16 v[16:19], v[48:51], v[72:75], v[16:19]
    ds_read_b64_tr_b16 v[60:61], v251 offset:36864
    v_mfma_f32_16x16x32_bf16 v[20:23], v[52:55], v[72:75], v[20:23]
    ds_read_b64_tr_b16 v[62:63], v251 offset:38912
    v_mfma_f32_16x16x32_bf16 v[24:27], v[40:43], v[76:79], v[24:27]
    ds_read_b64_tr_b16 v[64:65], v252 offset:36864
    s_waitcnt vmcnt(12)
    v_max_u32 v7, v80, v84
    v_cmp_eq_u32 vcc, -1, v7
    v_mfma_f32_16x16x32_bf16 v[28:31], v[44:47], v[76:79], v[28:31]
    ds_read_b64_tr_b16 v[66:67], v252 offset:38912
    v_mfma_f32_16x16x32_bf16 v[32:35], v[48:51], v[76:79], v[32:35]
    ds_read_b64_tr_b16 v[68:69], v253 offset:36864
    v_mfma_f32_16x16x32_bf16 v[36:39], v[52:55], v[76:79], v[36:39]
    ds_read_b64_tr_b16 v[70:71], v253 offset:38912
    s_cbranch_vccnz L_r25
L_b25:
    s_waitcnt lgkmcnt(0)
    v_mfma_f32_16x16x32_bf16 v[8:11], v[56:59], v[80:83], v[8:11]
    ds_read_b64_tr_b16 v[40:41], v250 offset:40960
    v_mfma_f32_16x16x32_bf16 v[12:15], v[60:63], v[80:83], v[12:15]
    ds_read_b64_tr_b16 v[42:43], v250 offset:43008
    v_mfma_f32_16x16x32_bf16 v[16:19], v[64:67], v[80:83], v[16:19]
    ds_read_b64_tr_b16 v[44:45], v251 offset:40960
    v_mfma_f32_16x16x32_bf16 v[20:23], v[68:71], v[80:83], v[20:23]
    ds_read_b64_tr_b16 v[46:47], v251 offset:43008
    v_mfma_f32_16x16x32_bf16 v[24:27], v[56:59], v[84:87], v[24:27]
    ds_read_b64_tr_b16 v[48:49], v252 offset:40960
    s_waitcnt vmcnt(10)
    v_max_u32 v7, v88, v92
    v_cmp_eq_u32 vcc, -1, v7
    v_mfma_f32_16x16x32_bf16 v[28:31], v[60:63], v[84:87], v[28:31]
    ds_read_b64_tr_b16 v[50:51], v252 offset:43008
    v_mfma_f32_16x16x32_bf16 v[32:35], v[64:67], v[84:87], v[32:35]
    ds_read_b64_tr_b16 v[52:53], v253 offset:40960
    v_mfma_f32_16x16x32_bf16 v[36:39], v[68:71], v[84:87], v[36:39]
    ds_read_b64_tr_b16 v[54:55], v253 offset:43008
    s_cbranch_vccnz L_r26
L_b26:
    s_waitcnt lgkmcnt(0)
    v_mfma_f32_16x16x32_bf16 v[8:11], v[40:43], v[88:91], v[8:11]
    ds_read_b64_tr_b16 v[56:57], v250 offset:45056
    v_mfma_f32_16x16x32_bf16 v[12:15], v[44:47], v[88:91], v[12:15]
    ds_read_b64_tr_b16 v[58:59], v250 offset:47104
    v_mfma_f32_16x16x32_bf16 v[16:19], v[48:51], v[88:91], v[16:19]
    ds_read_b64_tr_b16 v[60:61], v251 offset:45056
    v_mfma_f32_16x16x32_bf16 v[20:23], v[52:55], v[88:91], v[20:23]
    ds_read_b64_tr_b16 v[62:63], v251 offset:47104
    v_mfma_f32_16x16x32_bf16 v[24:27], v[40:43], v[92:95], v[24:27]
    ds_read_b64_tr_b16 v[64:65], v252 offset:45056
    s_waitcnt vmcnt(8)
    v_max_u32 v7, v96, v100
    v_cmp_eq_u32 vcc, -1, v7
    v_mfma_f32_16x16x32_bf16 v[28:31], v[44:47], v[92:95], v[28:31]
    ds_read_b64_tr_b16 v[66:67], v252 offset:47104
    v_mfma_f32_16x16x32_bf16 v[32:35], v[48:51], v[92:95], v[32:35]
    ds_read_b64_tr_b16 v[68:69], v253 offset:45056
    v_mfma_f32_16x16x32_bf16 v[36:39], v[52:55], v[92:95], v[36:39]
    ds_read_b64_tr_b16 v[70:71], v253 offset:47104
    s_cbranch_vccnz L_r27
L_b27:
    s_waitcnt lgkmcnt(0)
    v_mfma_f32_16x16x32_bf16 v[8:11], v[56:59], v[96:99], v[8:11]
    ds_read_b64_tr_b16 v[40:41], v250 offset:49152
    v_mfma_f32_16x16x32_bf16 v[12:15], v[60:63], v[96:99], v[12:15]
    ds_read_b64_tr_b16 v[42:43], v250 offset:51200
    v_mfma_f32_16x16x32_bf16 v[16:19], v[64:67], v[96:99], v[16:19]
    ds_read_b64_tr_b16 v[44:45], v251 offset:49152
    v_mfma_f32_16x16x32_bf16 v[20:23], v[68:71], v[96:99], v[20:23]
    ds_read_b64_tr_b16 v[46:47], v251 offset:51200
    v_mfma_f32_16x16x32_bf16 v[24:27], v[56:59], v[100:103], v[24:27]
    ds_read_b64_tr_b16 v[48:49], v252 offset:49152
    s_waitcnt vmcnt(6)
    v_max_u32 v7, v104, v108
    v_cmp_eq_u32 vcc, -1, v7
    v_mfma_f32_16x16x32_bf16 v[28:31], v[60:63], v[100:103], v[28:31]
    ds_read_b64_tr_b16 v[50:51], v252 offset:51200
    v_mfma_f32_16x16x32_bf16 v[32:35], v[64:67], v[100:103], v[32:35]
    ds_read_b64_tr_b16 v[52:53], v253 offset:49152
    v_mfma_f32_16x16x32_bf16 v[36:39], v[68:71], v[100:103], v[36:39]
    ds_read_b64_tr_b16 v[54:55], v253 offset:51200
    s_cbranch_vccnz L_r28
L_b28:
    s_waitcnt lgkmcnt(0)
    v_mfma_f32_16x16x32_bf16 v[8:11], v[40:43], v[104:107], v[8:11]
    ds_read_b64_tr_b16 v[56:57], v250 offset:53248
    v_mfma_f32_16x16x32_bf16 v[12:15], v[44:47], v[104:107], v[12:15]
    ds_read_b64_tr_b16 v[58:59], v250 offset:55296
    v_mfma_f32_16x16x32_bf16 v[16:19], v[48:51], v[104:107], v[16:19]
    ds_read_b64_tr_b16 v[60:61], v251 offset:53248
    v_mfma_f32_16x16x32_bf16 v[20:23], v[52:55], v[104:107], v[20:23]
    ds_read_b64_tr_b16 v[62:63], v251 offset:55296
    v_mfma_f32_16x16x32_bf16 v[24:27], v[40:43], v[108:111], v[24:27]
    ds_read_b64_tr_b16 v[64:65], v252 offset:53248
    s_waitcnt vmcnt(4)
    v_max_u32 v7, v112, v116
    v_cmp_eq_u32 vcc, -1, v7
    v_mfma_f32_16x16x32_bf16 v[28:31], v[44:47], v[108:111], v[28:31]
    ds_read_b64_tr_b16 v[66:67], v252 offset:55296
    v_mfma_f32_16x16x32_bf16 v[32:35], v[48:51], v[108:111], v[32:35]
    ds_read_b64_tr_b16 v[68:69], v253 offset:53248
    v_mfma_f32_16x16x32_bf16 v[36:39], v[52:55], v[108:111], v[36:39]
    ds_read_b64_tr_b16 v[70:71], v253 offset:55296
    s_cbranch_vccnz L_r29
L_b29:
    s_waitcnt lgkmcnt(0)
    v_mfma_f32_16x16x32_bf16 v[8:11], v[56:59], v[112:115], v[8:11]
    ds_read_b64_tr_b16 v[40:41], v250 offset:57344
    v_mfma_f32_16x16x32_bf16 v[12:15], v[60:63], v[112:115], v[12:15]
    ds_read_b64_tr_b16 v[42:43], v250 offset:59392
    v_mfma_f32_16x16x32_bf16 v[16:19], v[64:67], v[112:115], v[16:19]
    ds_read_b64_tr_b16 v[44:45], v251 offset:57344
    v_mfma_f32_16x16x32_bf16 v[20:23], v[68:71], v[112:115], v[20:23]
    ds_read_b64_tr_b16 v[46:47], v251 offset:59392
    v_mfma_f32_16x16x32_bf16 v[24:27], v[56:59], v[116:119], v[24:27]
    ds_read_b64_tr_b16 v[48:49], v252 offset:57344
    s_waitcnt vmcnt(2)
    v_max_u32 v7, v120, v124
    v_cmp_eq_u32 vcc, -1, v7
    v_mfma_f32_16x16x32_bf16 v[28:31], v[60:63], v[116:119], v[28:31]
    ds_read_b64_tr_b16 v[50:51], v252 offset:59392
    v_mfma_f32_16x16x32_bf16 v[32:35], v[64:67], v[116:119], v[32:35]
    ds_read_b64_tr_b16 v[52:53], v253 offset:57344
    v_mfma_f32_16x16x32_bf16 v[36:39], v[68:71], v[116:119], v[36:39]
    ds_read_b64_tr_b16 v[54:55], v253 offset:59392
    s_cbranch_vccnz L_r30
L_b30:
    s_waitcnt lgkmcnt(0)
    v_mfma_f32_16x16x32_bf16 v[8:11], v[40:43], v[120:123], v[8:11]
    ds_read_b64_tr_b16 v[56:57], v250 offset:61440
    v_mfma_f32_16x16x32_bf16 v[12:15], v[44:47], v[120:123], v[12:15]
    ds_read_b64_tr_b16 v[58:59], v250 offset:63488
    v_mfma_f32_16x16x32_bf16 v[16:19], v[48:51], v[120:123], v[16:19]
    ds_read_b64_tr_b16 v[60:61], v251 offset:61440
    v_mfma_f32_16x16x32_bf16 v[20:23], v[52:55], v[120:123], v[20:23]
    ds_read_b64_tr_b16 v[62:63], v251 offset:63488
    v_mfma_f32_16x16x32_bf16 v[24:27], v[40:43], v[124:127], v[24:27]
    ds_read_b64_tr_b16 v[64:65], v252 offset:61440
    s_waitcnt vmcnt(0)
    v_max_u32 v7, v128, v132
    v_cmp_eq_u32 vcc, -1, v7
    v_mfma_f32_16x16x32_bf16 v[28:31], v[44:47], v[124:127], v[28:31]
    ds_read_b64_tr_b16 v[66:67], v252 offset:63488
    v_mfma_f32_16x16x32_bf16 v[32:35], v[48:51], v[124:127], v[32:35]
    ds_read_b64_tr_b16 v[68:69], v253 offset:61440
    v_mfma_f32_16x16x32_bf16 v[36:39], v[52:55], v[124:127], v[36:39]
    ds_read_b64_tr_b16 v[70:71], v253 offset:63488
    s_cbranch_vccnz L_r31
L_b31:
    s_waitcnt lgkmcnt(0)
    v_mfma_f32_16x16x32_bf16 v[8:11], v[56:59], v[128:131], v[8:11]
    v_mfma_f32_16x16x32_bf16 v[12:15], v[60:63], v[128:131], v[12:15]
    v_mfma_f32_16x16x32_bf16 v[16:19], v[64:67], v[128:131], v[16:19]
    v_mfma_f32_16x16x32_bf16 v[20:23], v[68:71], v[128:131], v[20:23]
    v_mfma_f32_16x16x32_bf16 v[24:27], v[56:59], v[132:135], v[24:27]
    v_mfma_f32_16x16x32_bf16 v[28:31], v[60:63], v[132:135], v[28:31]
    v_mfma_f32_16x16x32_bf16 v[32:35], v[64:67], v[132:135], v[32:35]
    v_mfma_f32_16x16x32_bf16 v[36:39], v[68:71], v[132:135], v[36:39]
    s_nop 0
    v_cvt_pk_bf16_f32 v72, v8, v9
    v_cvt_pk_bf16_f32 v73, v10, v11
    ds_write_b64 v240, v[72:73] offset:0
    v_cvt_pk_bf16_f32 v74, v12, v13
    v_cvt_pk_bf16_f32 v75, v14, v15
    ds_write_b64 v240, v[74:75] offset:32
    v_cvt_pk_bf16_f32 v76, v16, v17
    v_cvt_pk_bf16_f32 v77, v18, v19
    ds_write_b64 v240, v[76:77] offset:64
    v_cvt_pk_bf16_f32 v78, v20, v21
    v_cvt_pk_bf16_f32 v79, v22, v23
    ds_write_b64 v240, v[78:79] offset:96
    ds_read_b128 v[88:91], v241 offset:0
    ds_read_b128 v[92:95], v241 offset:1152
    v_cvt_pk_bf16_f32 v80, v24, v25
    v_cvt_pk_bf16_f32 v81, v26, v27
    ds_write_b64 v240, v[80:81] offset:2304
    v_cvt_pk_bf16_f32 v82, v28, v29
    v_cvt_pk_bf16_f32 v83, v30, v31
    ds_write_b64 v240, v[82:83] offset:2336
    v_cvt_pk_bf16_f32 v84, v32, v33
    v_cvt_pk_bf16_f32 v85, v34, v35
    ds_write_b64 v240, v[84:85] offset:2368
    v_cvt_pk_bf16_f32 v86, v36, v37
    v_cvt_pk_bf16_f32 v87, v38, v39
    ds_write_b64 v240, v[86:87] offset:2400
    ds_read_b128 v[96:99], v241 offset:2304
    ds_read_b128 v[100:103], v241 offset:3456
    s_waitcnt lgkmcnt(7)
    v_lshlrev_b32 v104, 16, v88
    v_and_b32 v105, 0xffff0000, v88
    v_lshlrev_b32 v106, 16, v89
    v_and_b32 v107, 0xffff0000, v89
    v_lshlrev_b32 v108, 16, v90
    v_and_b32 v109, 0xffff0000, v90
    v_lshlrev_b32 v110, 16, v91
    v_and_b32 v111, 0xffff0000, v91
    v_pk_fma_f32 v[176:177], v[104:105], v[208:209], v[176:177]
    v_pk_fma_f32 v[178:179], v[106:107], v[210:211], v[178:179]
    v_pk_fma_f32 v[180:181], v[108:109], v[212:213], v[180:181]
    v_pk_fma_f32 v[182:183], v[110:111], v[214:215], v[182:183]
    s_cmp_eq_u32 s65, 0
    s_cselect_b64 s[74:75], s[66:67], 0
    v_cvt_pk_bf16_f32 v72, v176, v177
    v_cvt_pk_bf16_f32 v73, v178, v179
    v_cvt_pk_bf16_f32 v74, v180, v181
    v_cvt_pk_bf16_f32 v75, v182, v183
    s_andn2_b64 exec, -1, s[74:75]
    buffer_store_dwordx4 v[72:75], v246, s[24:27], 0 offen nt
    s_mov_b64 exec, -1
    s_waitcnt lgkmcnt(6)
    v_lshlrev_b32 v112, 16, v92
    v_and_b32 v113, 0xffff0000, v92
    v_lshlrev_b32 v114, 16, v93
    v_and_b32 v115, 0xffff0000, v93
    v_lshlrev_b32 v116, 16, v94
    v_and_b32 v117, 0xffff0000, v94
    v_lshlrev_b32 v118, 16, v95
    v_and_b32 v119, 0xffff0000, v95
    v_pk_fma_f32 v[184:185], v[112:113], v[216:217], v[184:185]
    v_pk_fma_f32 v[186:187], v[114:115], v[218:219], v[186:187]
    v_pk_fma_f32 v[188:189], v[116:117], v[220:221], v[188:189]
    v_pk_fma_f32 v[190:191], v[118:119], v[222:223], v[190:191]
    s_cmp_eq_u32 s65, 1
    s_cselect_b64 s[74:75], s[66:67], 0
    v_cvt_pk_bf16_f32 v76, v184, v185
    v_cvt_pk_bf16_f32 v77, v186, v187
    v_cvt_pk_bf16_f32 v78, v188, v189
    v_cvt_pk_bf16_f32 v79, v190, v191
    s_andn2_b64 exec, -1, s[74:75]
    buffer_store_dwordx4 v[76:79], v246, s[24:27], s77 offen nt
    s_mov_b64 exec, -1
    s_waitcnt lgkmcnt(1)
    v_lshlrev_b32 v120, 16, v96
    v_and_b32 v121, 0xffff0000, v96
    v_lshlrev_b32 v122, 16, v97
    v_and_b32 v123, 0xffff0000, v97
    v_lshlrev_b32 v124, 16, v98
    v_and_b32 v125, 0xffff0000, v98
    v_lshlrev_b32 v126, 16, v99
    v_and_b32 v127, 0xffff0000, v99
    v_pk_fma_f32 v[192:193], v[120:121], v[224:225], v[192:193]
    v_pk_fma_f32 v[194:195], v[122:123], v[226:227], v[194:195]
    v_pk_fma_f32 v[196:197], v[124:125], v[228:229], v[196:197]
    v_pk_fma_f32 v[198:199], v[126:127], v[230:231], v[198:199]
    s_cmp_eq_u32 s65, 2
    s_cselect_b64 s[74:75], s[66:67], 0
    v_cvt_pk_bf16_f32 v80, v192, v193
    v_cvt_pk_bf16_f32 v81, v194, v195
    v_cvt_pk_bf16_f32 v82, v196, v197
    v_cvt_pk_bf16_f32 v83, v198, v199
    s_andn2_b64 exec, -1, s[74:75]
    buffer_store_dwordx4 v[80:83], v246, s[24:27], s78 offen nt
    s_mov_b64 exec, -1
    s_waitcnt lgkmcnt(0)
    v_lshlrev_b32 v128, 16, v100
    v_and_b32 v129, 0xffff0000, v100
    v_lshlrev_b32 v130, 16, v101
    v_and_b32 v131, 0xffff0000, v101
    v_lshlrev_b32 v132, 16, v102
    v_and_b32 v133, 0xffff0000, v102
    v_lshlrev_b32 v134, 16, v103
    v_and_b32 v135, 0xffff0000, v103
    v_pk_fma_f32 v[200:201], v[128:129], v[232:233], v[200:201]
    v_pk_fma_f32 v[202:203], v[130:131], v[234:235], v[202:203]
    v_pk_fma_f32 v[204:205], v[132:133], v[236:237], v[204:205]
    v_pk_fma_f32 v[206:207], v[134:135], v[238:239], v[206:207]
    s_cmp_eq_u32 s65, 3
    s_cselect_b64 s[74:75], s[66:67], 0
    v_cvt_pk_bf16_f32 v84, v200, v201
    v_cvt_pk_bf16_f32 v85, v202, v203
    v_cvt_pk_bf16_f32 v86, v204, v205
    v_cvt_pk_bf16_f32 v87, v206, v207
    s_andn2_b64 exec, -1, s[74:75]
    buffer_store_dwordx4 v[84:87], v246, s[24:27], s79 offen nt
    s_mov_b64 exec, -1
    s_cmp_eq_u32 s35, 0
    s_cbranch_scc1 L_g1end
    s_waitcnt lgkmcnt(0)
    s_barrier
L_g1end:
    s_endpgm
L_r0:
    s_add_u32 s70, s70, 1
    s_cmp_ge_u32 s70, 200000
    s_cbranch_scc1 L_b0
    s_add_u32 s76, s88, 0
    s_and_b32 s76, s76, 15
    s_lshl_b32 s76, s76, 11
    s_add_u32 s76, s76, s72
    buffer_load_dwordx4 v[72:75], v5, s[12:15], s76 offen offset:0 sc1
    buffer_load_dwordx4 v[76:79], v4, s[12:15], s76 offen offset:0 sc1
    s_waitcnt vmcnt(0)
    v_max_u32 v7, v72, v76
    v_cmp_eq_u32 vcc, -1, v7
    s_nop 3
    s_cbranch_vccnz L_r0
    s_branch L_b0
L_r1:
    s_add_u32 s70, s70, 1
    s_cmp_ge_u32 s70, 200000
    s_cbranch_scc1 L_b1
    s_add_u32 s76, s88, 0
    s_and_b32 s76, s76, 15
    s_lshl_b32 s76, s76, 11
    s_add_u32 s76, s76, s72
    buffer_load_dwordx4 v[80:83], v5, s[12:15], s76 offen offset:1024 sc1
    buffer_load_dwordx4 v[84:87], v4, s[12:15], s76 offen offset:1024 sc1
    s_waitcnt vmcnt(0)
    v_max_u32 v7, v80, v84
    v_cmp_eq_u32 vcc, -1, v7
    s_nop 3
    s_cbranch_vccnz L_r1
    s_branch L_b1
L_r2:
    s_add_u32 s70, s70, 1
    s_cmp_ge_u32 s70, 200000
    s_cbranch_scc1 L_b2
    s_add_u32 s76, s88, 1
    s_and_b32 s76, s76, 15
    s_lshl_b32 s76, s76, 11
    s_add_u32 s76, s76, s72
    buffer_load_dwordx4 v[88:91], v5, s[12:15], s76 offen offset:0 sc1
    buffer_load_dwordx4 v[92:95], v4, s[12:15], s76 offen offset:0 sc1
    s_waitcnt vmcnt(0)
    v_max_u32 v7, v88, v92
    v_cmp_eq_u32 vcc, -1, v7
    s_nop 3
    s_cbranch_vccnz L_r2
    s_branch L_b2
L_r3:
    s_add_u32 s70, s70, 1
    s_cmp_ge_u32 s70, 200000
    s_cbranch_scc1 L_b3
    s_add_u32 s76, s88, 1
    s_and_b32 s76, s76, 15
    s_lshl_b32 s76, s76, 11
    s_add_u32 s76, s76, s72
    buffer_load_dwordx4 v[96:99], v5, s[12:15], s76 offen offset:1024 sc1
    buffer_load_dwordx4 v[100:103], v4, s[12:15], s76 offen offset:1024 sc1
    s_waitcnt vmcnt(0)
    v_max_u32 v7, v96, v100
    v_cmp_eq_u32 vcc, -1, v7
    s_nop 3
    s_cbranch_vccnz L_r3
    s_branch L_b3
L_r4:
    s_add_u32 s70, s70, 1
    s_cmp_ge_u32 s70, 200000
    s_cbranch_scc1 L_b4
    s_add_u32 s76, s88, 2
    s_and_b32 s76, s76, 15
    s_lshl_b32 s76, s76, 11
    s_add_u32 s76, s76, s72
    buffer_load_dwordx4 v[104:107], v5, s[12:15], s76 offen offset:0 sc1
    buffer_load_dwordx4 v[108:111], v4, s[12:15], s76 offen offset:0 sc1
    s_waitcnt vmcnt(0)
    v_max_u32 v7, v104, v108
    v_cmp_eq_u32 vcc, -1, v7
    s_nop 3
    s_cbranch_vccnz L_r4
    s_branch L_b4
L_r5:
    s_add_u32 s70, s70, 1
    s_cmp_ge_u32 s70, 200000
    s_cbranch_scc1 L_b5
    s_add_u32 s76, s88, 2
    s_and_b32 s76, s76, 15
    s_lshl_b32 s76, s76, 11
    s_add_u32 s76, s76, s72
    buffer_load_dwordx4 v[112:115], v5, s[12:15], s76 offen offset:1024 sc1
    buffer_load_dwordx4 v[116:119], v4, s[12:15], s76 offen offset:1024 sc1
    s_waitcnt vmcnt(0)
    v_max_u32 v7, v112, v116
    v_cmp_eq_u32 vcc, -1, v7
    s_nop 3
    s_cbranch_vccnz L_r5
    s_branch L_b5
L_r6:
    s_add_u32 s70, s70, 1
    s_cmp_ge_u32 s70, 200000
    s_cbranch_scc1 L_b6
    s_add_u32 s76, s88, 3
    s_and_b32 s76, s76, 15
    s_lshl_b32 s76, s76, 11
    s_add_u32 s76, s76, s72
    buffer_load_dwordx4 v[120:123], v5, s[12:15], s76 offen offset:0 sc1
    buffer_load_dwordx4 v[124:127], v4, s[12:15], s76 offen offset:0 sc1
    s_waitcnt vmcnt(0)
    v_max_u32 v7, v120, v124
    v_cmp_eq_u32 vcc, -1, v7
    s_nop 3
    s_cbranch_vccnz L_r6
    s_branch L_b6
L_r7:
    s_add_u32 s70, s70, 1
    s_cmp_ge_u32 s70, 200000
    s_cbranch_scc1 L_b7
    s_add_u32 s76, s88, 3
    s_and_b32 s76, s76, 15
    s_lshl_b32 s76, s76, 11
    s_add_u32 s76, s76, s72
    buffer_load_dwordx4 v[128:131], v5, s[12:15], s76 offen offset:1024 sc1
    buffer_load_dwordx4 v[132:135], v4, s[12:15], s76 offen offset:1024 sc1
    s_waitcnt vmcnt(0)
    v_max_u32 v7, v128, v132
    v_cmp_eq_u32 vcc, -1, v7
    s_nop 3
    s_cbranch_vccnz L_r7
    s_branch L_b7
L_r8:
    s_add_u32 s70, s70, 1
    s_cmp_ge_u32 s70, 200000
    s_cbranch_scc1 L_b8
    s_add_u32 s76, s88, 4
    s_and_b32 s76, s76, 15
    s_lshl_b32 s76, s76, 11
    s_add_u32 s76, s76, s72
    buffer_load_dwordx4 v[136:139], v5, s[12:15], s76 offen offset:0 sc1
    buffer_load_dwordx4 v[140:143], v4, s[12:15], s76 offen offset:0 sc1
    s_waitcnt vmcnt(0)
    v_max_u32 v7, v136, v140
    v_cmp_eq_u32 vcc, -1, v7
    s_nop 3
    s_cbranch_vccnz L_r8
    s_branch L_b8
L_r9:
    s_add_u32 s70, s70, 1
    s_cmp_ge_u32 s70, 200000
    s_cbranch_scc1 L_b9
    s_add_u32 s76, s88, 4
    s_and_b32 s76, s76, 15
    s_lshl_b32 s76, s76, 11
    s_add_u32 s76, s76, s72
    buffer_load_dwordx4 v[144:147], v5, s[12:15], s76 offen offset:1024 sc1
    buffer_load_dwordx4 v[148:151], v4, s[12:15], s76 offen offset:1024 sc1
    s_waitcnt vmcnt(0)
    v_max_u32 v7, v144, v148
    v_cmp_eq_u32 vcc, -1, v7
    s_nop 3
    s_cbranch_vccnz L_r9
    s_branch L_b9
L_r10:
    s_add_u32 s70, s70, 1
    s_cmp_ge_u32 s70, 200000
    s_cbranch_scc1 L_b10
    s_add_u32 s76, s88, 5
    s_and_b32 s76, s76, 15
    s_lshl_b32 s76, s76, 11
    s_add_u32 s76, s76, s72
    buffer_load_dwordx4 v[152:155], v5, s[12:15], s76 offen offset:0 sc1
    buffer_load_dwordx4 v[156:159], v4, s[12:15], s76 offen offset:0 sc1
    s_waitcnt vmcnt(0)
    v_max_u32 v7, v152, v156
    v_cmp_eq_u32 vcc, -1, v7
    s_nop 3
    s_cbranch_vccnz L_r10
    s_branch L_b10
L_r11:
    s_add_u32 s70, s70, 1
    s_cmp_ge_u32 s70, 200000
    s_cbranch_scc1 L_b11
    s_add_u32 s76, s88, 5
    s_and_b32 s76, s76, 15
    s_lshl_b32 s76, s76, 11
    s_add_u32 s76, s76, s72
    buffer_load_dwordx4 v[160:163], v5, s[12:15], s76 offen offset:1024 sc1
    buffer_load_dwordx4 v[164:167], v4, s[12:15], s76 offen offset:1024 sc1
    s_waitcnt vmcnt(0)
    v_max_u32 v7, v160, v164
    v_cmp_eq_u32 vcc, -1, v7
    s_nop 3
    s_cbranch_vccnz L_r11
    s_branch L_b11
L_r12:
    s_add_u32 s70, s70, 1
    s_cmp_ge_u32 s70, 200000
    s_cbranch_scc1 L_b12
    s_add_u32 s76, s88, 6
    s_and_b32 s76, s76, 15
    s_lshl_b32 s76, s76, 11
    s_add_u32 s76, s76, s72
    buffer_load_dwordx4 v[72:75], v5, s[12:15], s76 offen offset:0 sc1
    buffer_load_dwordx4 v[76:79], v4, s[12:15], s76 offen offset:0 sc1
    s_waitcnt vmcnt(0)
    v_max_u32 v7, v72, v76
    v_cmp_eq_u32 vcc, -1, v7
    s_nop 3
    s_cbranch_vccnz L_r12
    s_branch L_b12
L_r13:
    s_add_u32 s70, s70, 1
    s_cmp_ge_u32 s70, 200000
    s_cbranch_scc1 L_b13
    s_add_u32 s76, s88, 6
    s_and_b32 s76, s76, 15
    s_lshl_b32 s76, s76, 11
    s_add_u32 s76, s76, s72
    buffer_load_dwordx4 v[80:83], v5, s[12:15], s76 offen offset:1024 sc1
    buffer_load_dwordx4 v[84:87], v4, s[12:15], s76 offen offset:1024 sc1
    s_waitcnt vmcnt(0)
    v_max_u32 v7, v80, v84
    v_cmp_eq_u32 vcc, -1, v7
    s_nop 3
    s_cbranch_vccnz L_r13
    s_branch L_b13
L_r14:
    s_add_u32 s70, s70, 1
    s_cmp_ge_u32 s70, 200000
    s_cbranch_scc1 L_b14
    s_add_u32 s76, s88, 7
    s_and_b32 s76, s76, 15
    s_lshl_b32 s76, s76, 11
    s_add_u32 s76, s76, s72
    buffer_load_dwordx4 v[88:91], v5, s[12:15], s76 offen offset:0 sc1
    buffer_load_dwordx4 v[92:95], v4, s[12:15], s76 offen offset:0 sc1
    s_waitcnt vmcnt(0)
    v_max_u32 v7, v88, v92
    v_cmp_eq_u32 vcc, -1, v7
    s_nop 3
    s_cbranch_vccnz L_r14
    s_branch L_b14
L_r15:
    s_add_u32 s70, s70, 1
    s_cmp_ge_u32 s70, 200000
    s_cbranch_scc1 L_b15
    s_add_u32 s76, s88, 7
    s_and_b32 s76, s76, 15
    s_lshl_b32 s76, s76, 11
    s_add_u32 s76, s76, s72
    buffer_load_dwordx4 v[96:99], v5, s[12:15], s76 offen offset:1024 sc1
    buffer_load_dwordx4 v[100:103], v4, s[12:15], s76 offen offset:1024 sc1
    s_waitcnt vmcnt(0)
    v_max_u32 v7, v96, v100
    v_cmp_eq_u32 vcc, -1, v7
    s_nop 3
    s_cbranch_vccnz L_r15
    s_branch L_b15
L_r16:
    s_add_u32 s70, s70, 1
    s_cmp_ge_u32 s70, 200000
    s_cbranch_scc1 L_b16
    s_add_u32 s76, s88, 8
    s_and_b32 s76, s76, 15
    s_lshl_b32 s76, s76, 11
    s_add_u32 s76, s76, s72
    buffer_load_dwordx4 v[104:107], v5, s[12:15], s76 offen offset:0 sc1
    buffer_load_dwordx4 v[108:111], v4, s[12:15], s76 offen offset:0 sc1
    s_waitcnt vmcnt(0)
    v_max_u32 v7, v104, v108
    v_cmp_eq_u32 vcc, -1, v7
    s_nop 3
    s_cbranch_vccnz L_r16
    s_branch L_b16
L_r17:
    s_add_u32 s70, s70, 1
    s_cmp_ge_u32 s70, 200000
    s_cbranch_scc1 L_b17
    s_add_u32 s76, s88, 8
    s_and_b32 s76, s76, 15
    s_lshl_b32 s76, s76, 11
    s_add_u32 s76, s76, s72
    buffer_load_dwordx4 v[112:115], v5, s[12:15], s76 offen offset:1024 sc1
    buffer_load_dwordx4 v[116:119], v4, s[12:15], s76 offen offset:1024 sc1
    s_waitcnt vmcnt(0)
    v_max_u32 v7, v112, v116
    v_cmp_eq_u32 vcc, -1, v7
    s_nop 3
    s_cbranch_vccnz L_r17
    s_branch L_b17
L_r18:
    s_add_u32 s70, s70, 1
    s_cmp_ge_u32 s70, 200000
    s_cbranch_scc1 L_b18
    s_add_u32 s76, s88, 9
    s_and_b32 s76, s76, 15
    s_lshl_b32 s76, s76, 11
    s_add_u32 s76, s76, s72
    buffer_load_dwordx4 v[120:123], v5, s[12:15], s76 offen offset:0 sc1
    buffer_load_dwordx4 v[124:127], v4, s[12:15], s76 offen offset:0 sc1
    s_waitcnt vmcnt(0)
    v_max_u32 v7, v120, v124
    v_cmp_eq_u32 vcc, -1, v7
    s_nop 3
    s_cbranch_vccnz L_r18
    s_branch L_b18
L_r19:
    s_add_u32 s70, s70, 1
    s_cmp_ge_u32 s70, 200000
    s_cbranch_scc1 L_b19
    s_add_u32 s76, s88, 9
    s_and_b32 s76, s76, 15
    s_lshl_b32 s76, s76, 11
    s_add_u32 s76, s76, s72
    buffer_load_dwordx4 v[128:131], v5, s[12:15], s76 offen offset:1024 sc1
    buffer_load_dwordx4 v[132:135], v4, s[12:15], s76 offen offset:1024 sc1
    s_waitcnt vmcnt(0)
    v_max_u32 v7, v128, v132
    v_cmp_eq_u32 vcc, -1, v7
    s_nop 3
    s_cbranch_vccnz L_r19
    s_branch L_b19
L_r20:
    s_add_u32 s70, s70, 1
    s_cmp_ge_u32 s70, 200000
    s_cbranch_scc1 L_b20
    s_add_u32 s76, s88, 10
    s_and_b32 s76, s76, 15
    s_lshl_b32 s76, s76, 11
    s_add_u32 s76, s76, s72
    buffer_load_dwordx4 v[136:139], v5, s[12:15], s76 offen offset:0 sc1
    buffer_load_dwordx4 v[140:143], v4, s[12:15], s76 offen offset:0 sc1
    s_waitcnt vmcnt(0)
    v_max_u32 v7, v136, v140
    v_cmp_eq_u32 vcc, -1, v7
    s_nop 3
    s_cbranch_vccnz L_r20
    s_branch L_b20
L_r21:
    s_add_u32 s70, s70, 1
    s_cmp_ge_u32 s70, 200000
    s_cbranch_scc1 L_b21
    s_add_u32 s76, s88, 10
    s_and_b32 s76, s76, 15
    s_lshl_b32 s76, s76, 11
    s_add_u32 s76, s76, s72
    buffer_load_dwordx4 v[144:147], v5, s[12:15], s76 offen offset:1024 sc1
    buffer_load_dwordx4 v[148:151], v4, s[12:15], s76 offen offset:1024 sc1
    s_waitcnt vmcnt(0)
    v_max_u32 v7, v144, v148
    v_cmp_eq_u32 vcc, -1, v7
    s_nop 3
    s_cbranch_vccnz L_r21
    s_branch L_b21
L_r22:
    s_add_u32 s70, s70, 1
    s_cmp_ge_u32 s70, 200000
    s_cbranch_scc1 L_b22
    s_add_u32 s76, s88, 11
    s_and_b32 s76, s76, 15
    s_lshl_b32 s76, s76, 11
    s_add_u32 s76, s76, s72
    buffer_load_dwordx4 v[152:155], v5, s[12:15], s76 offen offset:0 sc1
    buffer_load_dwordx4 v[156:159], v4, s[12:15], s76 offen offset:0 sc1
    s_waitcnt vmcnt(0)
    v_max_u32 v7, v152, v156
    v_cmp_eq_u32 vcc, -1, v7
    s_nop 3
    s_cbranch_vccnz L_r22
    s_branch L_b22
L_r23:
    s_add_u32 s70, s70, 1
    s_cmp_ge_u32 s70, 200000
    s_cbranch_scc1 L_b23
    s_add_u32 s76, s88, 11
    s_and_b32 s76, s76, 15
    s_lshl_b32 s76, s76, 11
    s_add_u32 s76, s76, s72
    buffer_load_dwordx4 v[160:163], v5, s[12:15], s76 offen offset:1024 sc1
    buffer_load_dwordx4 v[164:167], v4, s[12:15], s76 offen offset:1024 sc1
    s_waitcnt vmcnt(0)
    v_max_u32 v7, v160, v164
    v_cmp_eq_u32 vcc, -1, v7
    s_nop 3
    s_cbranch_vccnz L_r23
    s_branch L_b23
L_r24:
    s_add_u32 s70, s70, 1
    s_cmp_ge_u32 s70, 200000
    s_cbranch_scc1 L_b24
    s_add_u32 s76, s88, 12
    s_and_b32 s76, s76, 15
    s_lshl_b32 s76, s76, 11
    s_add_u32 s76, s76, s72
    buffer_load_dwordx4 v[72:75], v5, s[12:15], s76 offen offset:0 sc1
    buffer_load_dwordx4 v[76:79], v4, s[12:15], s76 offen offset:0 sc1
    s_waitcnt vmcnt(0)
    v_max_u32 v7, v72, v76
    v_cmp_eq_u32 vcc, -1, v7
    s_nop 3
    s_cbranch_vccnz L_r24
    s_branch L_b24
L_r25:
    s_add_u32 s70, s70, 1
    s_cmp_ge_u32 s70, 200000
    s_cbranch_scc1 L_b25
    s_add_u32 s76, s88, 12
    s_and_b32 s76, s76, 15
    s_lshl_b32 s76, s76, 11
    s_add_u32 s76, s76, s72
    buffer_load_dwordx4 v[80:83], v5, s[12:15], s76 offen offset:1024 sc1
    buffer_load_dwordx4 v[84:87], v4, s[12:15], s76 offen offset:1024 sc1
    s_waitcnt vmcnt(0)
    v_max_u32 v7, v80, v84
    v_cmp_eq_u32 vcc, -1, v7
    s_nop 3
    s_cbranch_vccnz L_r25
    s_branch L_b25
L_r26:
    s_add_u32 s70, s70, 1
    s_cmp_ge_u32 s70, 200000
    s_cbranch_scc1 L_b26
    s_add_u32 s76, s88, 13
    s_and_b32 s76, s76, 15
    s_lshl_b32 s76, s76, 11
    s_add_u32 s76, s76, s72
    buffer_load_dwordx4 v[88:91], v5, s[12:15], s76 offen offset:0 sc1
    buffer_load_dwordx4 v[92:95], v4, s[12:15], s76 offen offset:0 sc1
    s_waitcnt vmcnt(0)
    v_max_u32 v7, v88, v92
    v_cmp_eq_u32 vcc, -1, v7
    s_nop 3
    s_cbranch_vccnz L_r26
    s_branch L_b26
L_r27:
    s_add_u32 s70, s70, 1
    s_cmp_ge_u32 s70, 200000
    s_cbranch_scc1 L_b27
    s_add_u32 s76, s88, 13
    s_and_b32 s76, s76, 15
    s_lshl_b32 s76, s76, 11
    s_add_u32 s76, s76, s72
    buffer_load_dwordx4 v[96:99], v5, s[12:15], s76 offen offset:1024 sc1
    buffer_load_dwordx4 v[100:103], v4, s[12:15], s76 offen offset:1024 sc1
    s_waitcnt vmcnt(0)
    v_max_u32 v7, v96, v100
    v_cmp_eq_u32 vcc, -1, v7
    s_nop 3
    s_cbranch_vccnz L_r27
    s_branch L_b27
L_r28:
    s_add_u32 s70, s70, 1
    s_cmp_ge_u32 s70, 200000
    s_cbranch_scc1 L_b28
    s_add_u32 s76, s88, 14
    s_and_b32 s76, s76, 15
    s_lshl_b32 s76, s76, 11
    s_add_u32 s76, s76, s72
    buffer_load_dwordx4 v[104:107], v5, s[12:15], s76 offen offset:0 sc1
    buffer_load_dwordx4 v[108:111], v4, s[12:15], s76 offen offset:0 sc1
    s_waitcnt vmcnt(0)
    v_max_u32 v7, v104, v108
    v_cmp_eq_u32 vcc, -1, v7
    s_nop 3
    s_cbranch_vccnz L_r28
    s_branch L_b28
L_r29:
    s_add_u32 s70, s70, 1
    s_cmp_ge_u32 s70, 200000
    s_cbranch_scc1 L_b29
    s_add_u32 s76, s88, 14
    s_and_b32 s76, s76, 15
    s_lshl_b32 s76, s76, 11
    s_add_u32 s76, s76, s72
    buffer_load_dwordx4 v[112:115], v5, s[12:15], s76 offen offset:1024 sc1
    buffer_load_dwordx4 v[116:119], v4, s[12:15], s76 offen offset:1024 sc1
    s_waitcnt vmcnt(0)
    v_max_u32 v7, v112, v116
    v_cmp_eq_u32 vcc, -1, v7
    s_nop 3
    s_cbranch_vccnz L_r29
    s_branch L_b29
L_r30:
    s_add_u32 s70, s70, 1
    s_cmp_ge_u32 s70, 200000
    s_cbranch_scc1 L_b30
    s_add_u32 s76, s88, 15
    s_and_b32 s76, s76, 15
    s_lshl_b32 s76, s76, 11
    s_add_u32 s76, s76, s72
    buffer_load_dwordx4 v[120:123], v5, s[12:15], s76 offen offset:0 sc1
    buffer_load_dwordx4 v[124:127], v4, s[12:15], s76 offen offset:0 sc1
    s_waitcnt vmcnt(0)
    v_max_u32 v7, v120, v124
    v_cmp_eq_u32 vcc, -1, v7
    s_nop 3
    s_cbranch_vccnz L_r30
    s_branch L_b30
L_r31:
    s_add_u32 s70, s70, 1
    s_cmp_ge_u32 s70, 200000
    s_cbranch_scc1 L_b31
    s_add_u32 s76, s88, 15
    s_and_b32 s76, s76, 15
    s_lshl_b32 s76, s76, 11
    s_add_u32 s76, s76, s72
    buffer_load_dwordx4 v[128:131], v5, s[12:15], s76 offen offset:1024 sc1
    buffer_load_dwordx4 v[132:135], v4, s[12:15], s76 offen offset:1024 sc1
    s_waitcnt vmcnt(0)
    v_max_u32 v7, v128, v132
    v_cmp_eq_u32 vcc, -1, v7
    s_nop 3
    s_cbranch_vccnz L_r31
    s_branch L_b31
.p2align 8
L_code_end:
.fill 2048, 4, 0xbf800000
.section .rodata,"a"
.p2align 6
.amdhsa_kernel recurrent_scan__linear_kernel_hedgehog__moe_arch_mod__prompt_kernel
  .amdhsa_next_free_vgpr 256
  .amdhsa_next_free_sgpr 102
  .amdhsa_accum_offset 256
  .amdhsa_group_segment_fixed_size 0
  .amdhsa_kernarg_size 96
  .amdhsa_user_sgpr_count 2
  .amdhsa_user_sgpr_kernarg_segment_ptr 1
  .amdhsa_system_sgpr_workgroup_id_x 1
.end_amdhsa_kernel
```

```asm
; @launch grid=(256,1,1) block=(512,1,1) lds=163840
.amdgcn_target "amdgcn-amd-amdhsa--gfx950"
.text
.globl recurrent_scan__linear_kernel_hedgehog__moe_arch_mod__prompt_kernel
.p2align 8
.type recurrent_scan__linear_kernel_hedgehog__moe_arch_mod__prompt_kernel,@function
recurrent_scan__linear_kernel_hedgehog__moe_arch_mod__prompt_kernel:
    s_cmp_ge_u32 s2, 256
    s_cbranch_scc1 L_done
    s_load_dwordx16 s[40:55], s[0:1], 0
    s_load_dwordx8 s[56:63], s[0:1], 64
    v_and_b32 v1, 63, v0
    v_lshrrev_b32 v2, 6, v0
    s_nop 0
    v_readfirstlane_b32 s38, v2
    s_and_b32 s65, s2, 1
    s_bfe_u32 s66, s2, 0x30003
    s_bfe_u32 s67, s2, 0x20001
    s_lshl_b32 s67, s67, 2
    s_lshl_b32 s36, s65, 3
    s_add_u32 s36, s36, s66
    s_lshr_b32 s3, s2, 6
    s_add_u32 s37, s67, s3
    s_lshr_b32 s39, s66, 0
    s_lshl_b32 s39, s39, 1
    s_add_u32 s39, s39, s65
    s_lshl_b32 s39, s39, 0
    s_and_b32 s101, s66, 0
    s_add_u32 s39, s39, s67
    s_and_b32 s39, s39, 15
    s_cmp_lt_u32 s38, 4
    s_cbranch_scc1 L_g1
    s_sub_u32 s38, s38, 4
    s_lshl_b32 s3, s38, 4
    v_lshrrev_b32 v7, 3, v1
    v_add_u32 v3, s3, v7
    v_mul_u32_u24 v3, 6144, v3
    s_lshl_b32 s3, s37, 7
    v_add_u32 v3, s3, v3
    v_and_b32 v6, 7, v1
    v_bfe_u32 v5, v1, 4, 1
    v_lshlrev_b32 v5, 1, v5
    v_xor_b32 v5, v6, v5
    v_lshl_add_u32 v16, v5, 4, v3
    v_xor_b32 v5, 4, v5
    v_lshl_add_u32 v5, v5, 4, v3
    v_add_u32 v17, 48128, v5
    v_add_u32 v12, 2048, v16
    v_add_u32 v13, 2048, v17
    v_add_u32 v14, 4096, v16
    v_add_u32 v15, 4096, v17
    s_lshl_b32 s3, s36, 7
    s_lshl_b32 s65, s38, 5
    s_add_u32 s3, s3, s65
    v_add_u32 v3, s3, v7
    v_lshlrev_b32 v3, 11, v3
    v_lshrrev_b32 v5, 4, v1
    v_xor_b32 v6, v6, v5
    v_xor_b32 v5, 4, v6
    v_lshl_add_u32 v8, v6, 4, v3
    v_lshl_add_u32 v5, v5, 4, v3
    v_add_u32 v9, 15360, v5
    v_add_u32 v10, 30720, v8
    v_add_u32 v11, 46080, v5
    s_lshl_b32 s72, s38, 12
    s_lshl_b32 s73, s38, 11
    s_lshl_b32 s74, s39, 7
    s_mul_i32 s75, s39, 393216
    s_mov_b32 s76, s75
    s_waitcnt lgkmcnt(0)
    s_mov_b32 s8, s42
    s_mov_b32 s9, s43
    s_mov_b32 s10, 6291456
    s_mov_b32 s11, 0x00020000
    s_mov_b32 s4, s40
    s_mov_b32 s5, s41
    s_mov_b32 s6, 4194304
    s_mov_b32 s7, 0x00020000
    s_cmp_ge_u32 s38, 2
    s_cbranch_scc1 L_xw
    s_add_u32 s3, s75, 196608
    s_add_u32 m0, s73, 65536
    s_nop 0
    buffer_load_dwordx4 v12, s[8:11], s75 offen offset:0  lds
    buffer_load_dwordx4 v13, s[8:11], s75 offen offset:1024  lds
    s_add_u32 m0, s73, 73728
    s_nop 0
    buffer_load_dwordx4 v14, s[8:11], s75 offen offset:0  lds
    buffer_load_dwordx4 v15, s[8:11], s75 offen offset:1024  lds
    s_add_u32 m0, s73, 69632
    s_nop 0
    buffer_load_dwordx4 v12, s[8:11], s3 offen offset:0  lds
    buffer_load_dwordx4 v13, s[8:11], s3 offen offset:1024  lds
    s_add_u32 m0, s73, 77824
    s_nop 0
    buffer_load_dwordx4 v14, s[8:11], s3 offen offset:0  lds
    buffer_load_dwordx4 v15, s[8:11], s3 offen offset:1024  lds
    s_add_u32 s75, s75, 393216
    s_cmp_eq_u32 s75, 6291456
    s_cselect_b32 s75, 0, s75
    s_add_u32 m0, s72, 0
    s_nop 0
    buffer_load_dwordx4 v8, s[4:7], s74 offen offset:0  lds
    buffer_load_dwordx4 v9, s[4:7], s74 offen offset:1024  lds
    buffer_load_dwordx4 v10, s[4:7], s74 offen offset:2048  lds
    buffer_load_dwordx4 v11, s[4:7], s74 offen offset:3072  lds
    s_add_u32 m0, s72, 8192
    s_add_u32 s3, s74, 131072
    buffer_load_dwordx4 v8, s[4:7], s3 offen offset:0  lds
    buffer_load_dwordx4 v9, s[4:7], s3 offen offset:1024  lds
    buffer_load_dwordx4 v10, s[4:7], s3 offen offset:2048  lds
    buffer_load_dwordx4 v11, s[4:7], s3 offen offset:3072  lds
    s_add_u32 s74, s74, 128
    s_and_b32 s74, s74, 2047
    s_add_u32 m0, s73, 131072
    s_nop 0
    buffer_load_dwordx4 v16, s[8:11], s76 offen offset:0  lds
    buffer_load_dwordx4 v17, s[8:11], s76 offen offset:1024  lds
    s_add_u32 m0, s73, 135168
    s_add_u32 s3, s76, 196608
    buffer_load_dwordx4 v16, s[8:11], s3 offen offset:0  lds
    buffer_load_dwordx4 v17, s[8:11], s3 offen offset:1024  lds
    s_add_u32 s76, s76, 393216
    s_cmp_eq_u32 s76, 6291456
    s_cselect_b32 s76, 0, s76
    v_lshlrev_b32 v3, 4, v1
    s_mov_b32 s12, s62
    s_mov_b32 s13, s63
    s_mov_b32 s14, 268435456
    s_mov_b32 s15, 0x00020000
    s_and_b32 s30, s2, 3
    s_lshl_b32 s30, s30, 2
    s_bfe_u32 s3, s2, 0x20003
    s_add_u32 s30, s30, s3
    s_bfe_u32 s31, s2, 0x10002
    s_lshl_b32 s31, s31, 3
    s_lshr_b32 s3, s2, 5
    s_add_u32 s31, s31, s3
    s_mov_b32 s88, 0
    s_mov_b32 s70, 0
    s_mov_b32 s80, s52
    s_mov_b32 s81, s53
    s_mov_b32 s82, 7340032
    s_mov_b32 s83, 0x00020000
    s_mov_b32 s84, s54
    s_mov_b32 s85, s55
    s_mov_b32 s86, 7340032
    s_mov_b32 s87, 0x00020000
    s_cmp_lt_u32 s2, 224
    s_cselect_b32 s82, s82, 0
    s_cselect_b32 s86, s86, 0
    s_and_b32 s3, s2, 15
    s_lshl_b32 s3, s3, 6
    v_and_b32 v5, 0x38, v1
    v_add_u32 v5, s3, v5
    v_mul_u32_u24 v5, 7168, v5
    v_and_b32 v6, 7, v1
    v_lshl_add_u32 v2, v6, 4, v5
    s_lshr_b32 s77, s2, 4
    s_lshl_b32 s77, s77, 2
    s_add_u32 s77, s77, s38
    s_lshl_b32 s77, s77, 7
    v_and_b32 v5, 1, v1
    v_cmp_eq_u32 vcc, 0, v5
    v_mov_b32 v6, 0xffff0000
    v_mov_b32 v7, 0xffff
    v_cndmask_b32 v6, v6, v7, vcc
    v_bfe_u32 v5, v1, 1, 2
    v_cmp_eq_u32 vcc, 0, v5
    s_nop 1
    v_cndmask_b32 v88, 0, v6, vcc
    v_cmp_eq_u32 vcc, 1, v5
    s_nop 1
    v_cndmask_b32 v89, 0, v6, vcc
    v_cmp_eq_u32 vcc, 2, v5
    s_nop 1
    v_cndmask_b32 v90, 0, v6, vcc
    v_cmp_eq_u32 vcc, 3, v5
    s_nop 1
    v_cndmask_b32 v91, 0, v6, vcc
    v_and_b32 v20, 0x3f803f80, v88
    v_and_b32 v21, 0x3f803f80, v89
    v_and_b32 v22, 0x3f803f80, v90
    v_and_b32 v23, 0x3f803f80, v91
    s_lshl_b32 s3, s30, 7
    s_lshl_b32 s65, s38, 5
    s_add_u32 s3, s3, s65
    v_lshrrev_b32 v249, 3, v1
    v_add_u32 v6, s3, v249
    v_lshlrev_b32 v6, 11, v6
    v_and_b32 v250, 7, v1
    v_lshl_add_u32 v6, v250, 4, v6
    s_lshl_b32 s3, s31, 7
    v_add_u32 v248, s3, v6
    s_mov_b32 s48, 16384
    s_mov_b32 s49, 32768
    s_mov_b32 s100, 49152
    s_add_u32 s3, s75, 196608
    s_add_u32 m0, s73, 81920
    s_nop 0
    buffer_load_dwordx4 v12, s[8:11], s75 offen offset:0  lds
    buffer_load_dwordx4 v13, s[8:11], s75 offen offset:1024  lds
    s_add_u32 m0, s73, 90112
    s_nop 0
    buffer_load_dwordx4 v14, s[8:11], s75 offen offset:0  lds
    buffer_load_dwordx4 v15, s[8:11], s75 offen offset:1024  lds
    s_add_u32 m0, s73, 86016
    s_nop 0
    buffer_load_dwordx4 v12, s[8:11], s3 offen offset:0  lds
    buffer_load_dwordx4 v13, s[8:11], s3 offen offset:1024  lds
    s_add_u32 m0, s73, 94208
    s_nop 0
    buffer_load_dwordx4 v14, s[8:11], s3 offen offset:0  lds
    buffer_load_dwordx4 v15, s[8:11], s3 offen offset:1024  lds
    s_add_u32 s75, s75, 393216
    s_cmp_eq_u32 s75, 6291456
    s_cselect_b32 s75, 0, s75
    s_waitcnt vmcnt(8)
    s_barrier
    s_add_u32 m0, s73, 142592
    s_nop 0
    buffer_load_dwordx4 v16, s[8:11], s76 offen offset:0  lds
    buffer_load_dwordx4 v17, s[8:11], s76 offen offset:1024  lds
    s_add_u32 m0, s73, 146688
    s_add_u32 s3, s76, 196608
    buffer_load_dwordx4 v16, s[8:11], s3 offen offset:0  lds
    buffer_load_dwordx4 v17, s[8:11], s3 offen offset:1024  lds
    s_add_u32 s76, s76, 393216
    s_cmp_eq_u32 s76, 6291456
    s_cselect_b32 s76, 0, s76
    s_add_u32 m0, s72, 16384
    s_nop 0
    buffer_load_dwordx4 v8, s[4:7], s74 offen offset:0  lds
    buffer_load_dwordx4 v9, s[4:7], s74 offen offset:1024  lds
    buffer_load_dwordx4 v10, s[4:7], s74 offen offset:2048  lds
    buffer_load_dwordx4 v11, s[4:7], s74 offen offset:3072  lds
    s_add_u32 m0, s72, 24576
    s_add_u32 s3, s74, 131072
    buffer_load_dwordx4 v8, s[4:7], s3 offen offset:0  lds
    buffer_load_dwordx4 v9, s[4:7], s3 offen offset:1024  lds
    buffer_load_dwordx4 v10, s[4:7], s3 offen offset:2048  lds
    buffer_load_dwordx4 v11, s[4:7], s3 offen offset:3072  lds
    s_add_u32 s74, s74, 128
    s_and_b32 s74, s74, 2047
    s_add_u32 s3, s75, 196608
    s_add_u32 m0, s73, 98304
    s_nop 0
    buffer_load_dwordx4 v12, s[8:11], s75 offen offset:0  lds
    buffer_load_dwordx4 v13, s[8:11], s75 offen offset:1024  lds
    s_add_u32 m0, s73, 106496
    s_nop 0
    buffer_load_dwordx4 v14, s[8:11], s75 offen offset:0  lds
    buffer_load_dwordx4 v15, s[8:11], s75 offen offset:1024  lds
    s_add_u32 m0, s73, 102400
    s_nop 0
    buffer_load_dwordx4 v12, s[8:11], s3 offen offset:0  lds
    buffer_load_dwordx4 v13, s[8:11], s3 offen offset:1024  lds
    s_add_u32 m0, s73, 110592
    s_nop 0
    buffer_load_dwordx4 v14, s[8:11], s3 offen offset:0  lds
    buffer_load_dwordx4 v15, s[8:11], s3 offen offset:1024  lds
    s_add_u32 s75, s75, 393216
    s_cmp_eq_u32 s75, 6291456
    s_cselect_b32 s75, 0, s75
    s_add_u32 m0, s73, 150784
    s_nop 0
    buffer_load_dwordx4 v16, s[8:11], s76 offen offset:0  lds
    buffer_load_dwordx4 v17, s[8:11], s76 offen offset:1024  lds
    s_add_u32 m0, s73, 154880
    s_add_u32 s3, s76, 196608
    buffer_load_dwordx4 v16, s[8:11], s3 offen offset:0  lds
    buffer_load_dwordx4 v17, s[8:11], s3 offen offset:1024  lds
    s_add_u32 s76, s76, 393216
    s_cmp_eq_u32 s76, 6291456
    s_cselect_b32 s76, 0, s76
    s_waitcnt vmcnt(12)
    s_barrier
    s_add_u32 m0, s72, 32768
    s_nop 0
    buffer_load_dwordx4 v8, s[4:7], s74 offen offset:0  lds
    buffer_load_dwordx4 v9, s[4:7], s74 offen offset:1024  lds
    buffer_load_dwordx4 v10, s[4:7], s74 offen offset:2048  lds
    buffer_load_dwordx4 v11, s[4:7], s74 offen offset:3072  lds
    s_add_u32 m0, s72, 40960
    s_add_u32 s3, s74, 131072
    buffer_load_dwordx4 v8, s[4:7], s3 offen offset:0  lds
    buffer_load_dwordx4 v9, s[4:7], s3 offen offset:1024  lds
    buffer_load_dwordx4 v10, s[4:7], s3 offen offset:2048  lds
    buffer_load_dwordx4 v11, s[4:7], s3 offen offset:3072  lds
    s_add_u32 s74, s74, 128
    s_and_b32 s74, s74, 2047
    s_add_u32 m0, s73, 131072
    s_nop 0
    buffer_load_dwordx4 v16, s[8:11], s76 offen offset:0  lds
    buffer_load_dwordx4 v17, s[8:11], s76 offen offset:1024  lds
    s_add_u32 m0, s73, 135168
    s_add_u32 s3, s76, 196608
    buffer_load_dwordx4 v16, s[8:11], s3 offen offset:0  lds
    buffer_load_dwordx4 v17, s[8:11], s3 offen offset:1024  lds
    s_add_u32 s76, s76, 393216
    s_cmp_eq_u32 s76, 6291456
    s_cselect_b32 s76, 0, s76
    s_add_u32 m0, s72, 49152
    s_nop 0
    buffer_load_dwordx4 v8, s[4:7], s74 offen offset:0  lds
    buffer_load_dwordx4 v9, s[4:7], s74 offen offset:1024  lds
    buffer_load_dwordx4 v10, s[4:7], s74 offen offset:2048  lds
    buffer_load_dwordx4 v11, s[4:7], s74 offen offset:3072  lds
    s_add_u32 m0, s72, 57344
    s_add_u32 s3, s74, 131072
    buffer_load_dwordx4 v8, s[4:7], s3 offen offset:0  lds
    buffer_load_dwordx4 v9, s[4:7], s3 offen offset:1024  lds
    buffer_load_dwordx4 v10, s[4:7], s3 offen offset:2048  lds
    buffer_load_dwordx4 v11, s[4:7], s3 offen offset:3072  lds
    s_add_u32 s74, s74, 128
    s_and_b32 s74, s74, 2047
    s_add_u32 s3, s75, 196608
    s_add_u32 m0, s73, 114688
    s_nop 0
    buffer_load_dwordx4 v12, s[8:11], s75 offen offset:0  lds
    buffer_load_dwordx4 v13, s[8:11], s75 offen offset:1024  lds
    s_add_u32 m0, s73, 122880
    s_nop 0
    buffer_load_dwordx4 v14, s[8:11], s75 offen offset:0  lds
    buffer_load_dwordx4 v15, s[8:11], s75 offen offset:1024  lds
    s_add_u32 m0, s73, 118784
    s_nop 0
    buffer_load_dwordx4 v12, s[8:11], s3 offen offset:0  lds
    buffer_load_dwordx4 v13, s[8:11], s3 offen offset:1024  lds
    s_add_u32 m0, s73, 126976
    s_nop 0
    buffer_load_dwordx4 v14, s[8:11], s3 offen offset:0  lds
    buffer_load_dwordx4 v15, s[8:11], s3 offen offset:1024  lds
    s_add_u32 s75, s75, 393216
    s_cmp_eq_u32 s75, 6291456
    s_cselect_b32 s75, 0, s75
    s_waitcnt vmcnt(20)
    s_barrier
    s_add_u32 m0, s73, 142592
    s_nop 0
    buffer_load_dwordx4 v16, s[8:11], s76 offen offset:0  lds
    buffer_load_dwordx4 v17, s[8:11], s76 offen offset:1024  lds
    s_add_u32 m0, s73, 146688
    s_add_u32 s3, s76, 196608
    buffer_load_dwordx4 v16, s[8:11], s3 offen offset:0  lds
    buffer_load_dwordx4 v17, s[8:11], s3 offen offset:1024  lds
    s_add_u32 s76, s76, 393216
    s_cmp_eq_u32 s76, 6291456
    s_cselect_b32 s76, 0, s76
    s_add_u32 m0, s72, 0
    s_nop 0
    buffer_load_dwordx4 v8, s[4:7], s74 offen offset:0  lds
    buffer_load_dwordx4 v9, s[4:7], s74 offen offset:1024  lds
    buffer_load_dwordx4 v10, s[4:7], s74 offen offset:2048  lds
    buffer_load_dwordx4 v11, s[4:7], s74 offen offset:3072  lds
    s_add_u32 m0, s72, 8192
    s_add_u32 s3, s74, 131072
    buffer_load_dwordx4 v8, s[4:7], s3 offen offset:0  lds
    buffer_load_dwordx4 v9, s[4:7], s3 offen offset:1024  lds
    buffer_load_dwordx4 v10, s[4:7], s3 offen offset:2048  lds
    buffer_load_dwordx4 v11, s[4:7], s3 offen offset:3072  lds
    s_add_u32 s74, s74, 128
    s_and_b32 s74, s74, 2047
    s_add_u32 s3, s75, 196608
    s_add_u32 m0, s73, 65536
    s_nop 0
    buffer_load_dwordx4 v12, s[8:11], s75 offen offset:0  lds
    buffer_load_dwordx4 v13, s[8:11], s75 offen offset:1024  lds
    s_add_u32 m0, s73, 73728
    s_nop 0
    buffer_load_dwordx4 v14, s[8:11], s75 offen offset:0  lds
    buffer_load_dwordx4 v15, s[8:11], s75 offen offset:1024  lds
    s_add_u32 m0, s73, 69632
    s_nop 0
    buffer_load_dwordx4 v12, s[8:11], s3 offen offset:0  lds
    buffer_load_dwordx4 v13, s[8:11], s3 offen offset:1024  lds
    s_add_u32 m0, s73, 77824
    s_nop 0
    buffer_load_dwordx4 v14, s[8:11], s3 offen offset:0  lds
    buffer_load_dwordx4 v15, s[8:11], s3 offen offset:1024  lds
    s_add_u32 s75, s75, 393216
    s_cmp_eq_u32 s75, 6291456
    s_cselect_b32 s75, 0, s75
    s_add_u32 m0, s72, 16384
    s_nop 0
    buffer_load_dwordx4 v8, s[4:7], s74 offen offset:0  lds
    buffer_load_dwordx4 v9, s[4:7], s74 offen offset:1024  lds
    buffer_load_dwordx4 v10, s[4:7], s74 offen offset:2048  lds
    buffer_load_dwordx4 v11, s[4:7], s74 offen offset:3072  lds
    s_add_u32 m0, s72, 24576
    s_add_u32 s3, s74, 131072
    buffer_load_dwordx4 v8, s[4:7], s3 offen offset:0  lds
    buffer_load_dwordx4 v9, s[4:7], s3 offen offset:1024  lds
    buffer_load_dwordx4 v10, s[4:7], s3 offen offset:2048  lds
    buffer_load_dwordx4 v11, s[4:7], s3 offen offset:3072  lds
    s_add_u32 s74, s74, 128
    s_and_b32 s74, s74, 2047
    s_waitcnt vmcnt(28)
    s_barrier
    s_add_u32 m0, s73, 150784
    s_nop 0
    buffer_load_dwordx4 v16, s[8:11], s76 offen offset:0  lds
    buffer_load_dwordx4 v17, s[8:11], s76 offen offset:1024  lds
    s_add_u32 m0, s73, 154880
    s_add_u32 s3, s76, 196608
    buffer_load_dwordx4 v16, s[8:11], s3 offen offset:0  lds
    buffer_load_dwordx4 v17, s[8:11], s3 offen offset:1024  lds
    s_add_u32 s76, s76, 393216
    s_cmp_eq_u32 s76, 6291456
    s_cselect_b32 s76, 0, s76
    s_add_u32 s3, s75, 196608
    s_add_u32 m0, s73, 81920
    s_nop 0
    buffer_load_dwordx4 v12, s[8:11], s75 offen offset:0  lds
    buffer_load_dwordx4 v13, s[8:11], s75 offen offset:1024  lds
    s_add_u32 m0, s73, 90112
    s_nop 0
    buffer_load_dwordx4 v14, s[8:11], s75 offen offset:0  lds
    buffer_load_dwordx4 v15, s[8:11], s75 offen offset:1024  lds
    s_add_u32 m0, s73, 86016
    s_nop 0
    buffer_load_dwordx4 v12, s[8:11], s3 offen offset:0  lds
    buffer_load_dwordx4 v13, s[8:11], s3 offen offset:1024  lds
    s_add_u32 m0, s73, 94208
    s_nop 0
    buffer_load_dwordx4 v14, s[8:11], s3 offen offset:0  lds
    buffer_load_dwordx4 v15, s[8:11], s3 offen offset:1024  lds
    s_add_u32 s75, s75, 393216
    s_cmp_eq_u32 s75, 6291456
    s_cselect_b32 s75, 0, s75
    s_add_u32 m0, s72, 32768
    s_nop 0
    buffer_load_dwordx4 v8, s[4:7], s74 offen offset:0  lds
    buffer_load_dwordx4 v9, s[4:7], s74 offen offset:1024  lds
    buffer_load_dwordx4 v10, s[4:7], s74 offen offset:2048  lds
    buffer_load_dwordx4 v11, s[4:7], s74 offen offset:3072  lds
    s_add_u32 m0, s72, 40960
    s_add_u32 s3, s74, 131072
    buffer_load_dwordx4 v8, s[4:7], s3 offen offset:0  lds
    buffer_load_dwordx4 v9, s[4:7], s3 offen offset:1024  lds
    buffer_load_dwordx4 v10, s[4:7], s3 offen offset:2048  lds
    buffer_load_dwordx4 v11, s[4:7], s3 offen offset:3072  lds
    s_add_u32 s74, s74, 128
    s_and_b32 s74, s74, 2047
    s_add_u32 s3, s75, 196608
    s_add_u32 m0, s73, 98304
    s_nop 0
    buffer_load_dwordx4 v12, s[8:11], s75 offen offset:0  lds
    buffer_load_dwordx4 v13, s[8:11], s75 offen offset:1024  lds
    s_add_u32 m0, s73, 106496
    s_nop 0
    buffer_load_dwordx4 v14, s[8:11], s75 offen offset:0  lds
    buffer_load_dwordx4 v15, s[8:11], s75 offen offset:1024  lds
    s_add_u32 m0, s73, 102400
    s_nop 0
    buffer_load_dwordx4 v12, s[8:11], s3 offen offset:0  lds
    buffer_load_dwordx4 v13, s[8:11], s3 offen offset:1024  lds
    s_add_u32 m0, s73, 110592
    s_nop 0
    buffer_load_dwordx4 v14, s[8:11], s3 offen offset:0  lds
    buffer_load_dwordx4 v15, s[8:11], s3 offen offset:1024  lds
    s_add_u32 s75, s75, 393216
    s_cmp_eq_u32 s75, 6291456
    s_cselect_b32 s75, 0, s75
    s_waitcnt vmcnt(36)
    s_barrier
    s_add_u32 m0, s72, 49152
    s_nop 0
    buffer_load_dwordx4 v8, s[4:7], s74 offen offset:0  lds
    buffer_load_dwordx4 v9, s[4:7], s74 offen offset:1024  lds
    buffer_load_dwordx4 v10, s[4:7], s74 offen offset:2048  lds
    buffer_load_dwordx4 v11, s[4:7], s74 offen offset:3072  lds
    s_add_u32 m0, s72, 57344
    s_add_u32 s3, s74, 131072
    buffer_load_dwordx4 v8, s[4:7], s3 offen offset:0  lds
    buffer_load_dwordx4 v9, s[4:7], s3 offen offset:1024  lds
    buffer_load_dwordx4 v10, s[4:7], s3 offen offset:2048  lds
    buffer_load_dwordx4 v11, s[4:7], s3 offen offset:3072  lds
    s_add_u32 s74, s74, 128
    s_and_b32 s74, s74, 2047
    s_add_u32 s3, s75, 196608
    s_add_u32 m0, s73, 114688
    s_nop 0
    buffer_load_dwordx4 v12, s[8:11], s75 offen offset:0  lds
    buffer_load_dwordx4 v13, s[8:11], s75 offen offset:1024  lds
    s_add_u32 m0, s73, 122880
    s_nop 0
    buffer_load_dwordx4 v14, s[8:11], s75 offen offset:0  lds
    buffer_load_dwordx4 v15, s[8:11], s75 offen offset:1024  lds
    s_add_u32 m0, s73, 118784
    s_nop 0
    buffer_load_dwordx4 v12, s[8:11], s3 offen offset:0  lds
    buffer_load_dwordx4 v13, s[8:11], s3 offen offset:1024  lds
    s_add_u32 m0, s73, 126976
    s_nop 0
    buffer_load_dwordx4 v14, s[8:11], s3 offen offset:0  lds
    buffer_load_dwordx4 v15, s[8:11], s3 offen offset:1024  lds
    s_add_u32 s75, s75, 393216
    s_cmp_eq_u32 s75, 6291456
    s_cselect_b32 s75, 0, s75
    s_waitcnt vmcnt(32)
    s_barrier
    s_add_u32 m0, s72, 0
    s_nop 0
    buffer_load_dwordx4 v8, s[4:7], s74 offen offset:0  lds
    buffer_load_dwordx4 v9, s[4:7], s74 offen offset:1024  lds
    buffer_load_dwordx4 v10, s[4:7], s74 offen offset:2048  lds
    buffer_load_dwordx4 v11, s[4:7], s74 offen offset:3072  lds
    s_add_u32 m0, s72, 8192
    s_add_u32 s3, s74, 131072
    buffer_load_dwordx4 v8, s[4:7], s3 offen offset:0  lds
    buffer_load_dwordx4 v9, s[4:7], s3 offen offset:1024  lds
    buffer_load_dwordx4 v10, s[4:7], s3 offen offset:2048  lds
    buffer_load_dwordx4 v11, s[4:7], s3 offen offset:3072  lds
    s_add_u32 s74, s74, 128
    s_and_b32 s74, s74, 2047
    s_add_u32 s3, s75, 196608
    s_add_u32 m0, s73, 65536
    s_nop 0
    buffer_load_dwordx4 v12, s[8:11], s75 offen offset:0  lds
    buffer_load_dwordx4 v13, s[8:11], s75 offen offset:1024  lds
    s_add_u32 m0, s73, 73728
    s_nop 0
    buffer_load_dwordx4 v14, s[8:11], s75 offen offset:0  lds
    buffer_load_dwordx4 v15, s[8:11], s75 offen offset:1024  lds
    s_add_u32 m0, s73, 69632
    s_nop 0
    buffer_load_dwordx4 v12, s[8:11], s3 offen offset:0  lds
    buffer_load_dwordx4 v13, s[8:11], s3 offen offset:1024  lds
    s_add_u32 m0, s73, 77824
    s_nop 0
    buffer_load_dwordx4 v14, s[8:11], s3 offen offset:0  lds
    buffer_load_dwordx4 v15, s[8:11], s3 offen offset:1024  lds
    s_add_u32 s75, s75, 393216
    s_cmp_eq_u32 s75, 6291456
    s_cselect_b32 s75, 0, s75
    s_waitcnt vmcnt(32)
    s_barrier
    s_add_u32 m0, s72, 16384
    s_nop 0
    buffer_load_dwordx4 v8, s[4:7], s74 offen offset:0  lds
    buffer_load_dwordx4 v9, s[4:7], s74 offen offset:1024  lds
    buffer_load_dwordx4 v10, s[4:7], s74 offen offset:2048  lds
    buffer_load_dwordx4 v11, s[4:7], s74 offen offset:3072  lds
    s_add_u32 m0, s72, 24576
    s_add_u32 s3, s74, 131072
    buffer_load_dwordx4 v8, s[4:7], s3 offen offset:0  lds
    buffer_load_dwordx4 v9, s[4:7], s3 offen offset:1024  lds
    buffer_load_dwordx4 v10, s[4:7], s3 offen offset:2048  lds
    buffer_load_dwordx4 v11, s[4:7], s3 offen offset:3072  lds
    s_add_u32 s74, s74, 128
    s_and_b32 s74, s74, 2047
    s_add_u32 s3, s75, 196608
    s_add_u32 m0, s73, 81920
    s_nop 0
    buffer_load_dwordx4 v12, s[8:11], s75 offen offset:0  lds
    buffer_load_dwordx4 v13, s[8:11], s75 offen offset:1024  lds
    s_add_u32 m0, s73, 90112
    s_nop 0
    buffer_load_dwordx4 v14, s[8:11], s75 offen offset:0  lds
    buffer_load_dwordx4 v15, s[8:11], s75 offen offset:1024  lds
    s_add_u32 m0, s73, 86016
    s_nop 0
    buffer_load_dwordx4 v12, s[8:11], s3 offen offset:0  lds
    buffer_load_dwordx4 v13, s[8:11], s3 offen offset:1024  lds
    s_add_u32 m0, s73, 94208
    s_nop 0
    buffer_load_dwordx4 v14, s[8:11], s3 offen offset:0  lds
    buffer_load_dwordx4 v15, s[8:11], s3 offen offset:1024  lds
    s_add_u32 s75, s75, 393216
    s_cmp_eq_u32 s75, 6291456
    s_cselect_b32 s75, 0, s75
    buffer_load_dwordx4 v[232:235], v248, s[4:7], 0 offen
    buffer_load_dwordx4 v[236:239], v248, s[4:7], s48 offen
    buffer_load_dwordx4 v[240:243], v248, s[4:7], s49 offen
    buffer_load_dwordx4 v[244:247], v248, s[4:7], s100 offen
    s_waitcnt vmcnt(36)
    s_barrier
    s_add_u32 m0, s72, 32768
    s_nop 0
    buffer_load_dwordx4 v8, s[4:7], s74 offen offset:0  lds
    buffer_load_dwordx4 v9, s[4:7], s74 offen offset:1024  lds
    buffer_load_dwordx4 v10, s[4:7], s74 offen offset:2048  lds
    buffer_load_dwordx4 v11, s[4:7], s74 offen offset:3072  lds
    s_add_u32 m0, s72, 40960
    s_add_u32 s3, s74, 131072
    buffer_load_dwordx4 v8, s[4:7], s3 offen offset:0  lds
    buffer_load_dwordx4 v9, s[4:7], s3 offen offset:1024  lds
    buffer_load_dwordx4 v10, s[4:7], s3 offen offset:2048  lds
    buffer_load_dwordx4 v11, s[4:7], s3 offen offset:3072  lds
    s_add_u32 s74, s74, 128
    s_and_b32 s74, s74, 2047
    s_add_u32 s3, s75, 196608
    s_add_u32 m0, s73, 98304
    s_nop 0
    buffer_load_dwordx4 v12, s[8:11], s75 offen offset:0  lds
    buffer_load_dwordx4 v13, s[8:11], s75 offen offset:1024  lds
    s_add_u32 m0, s73, 106496
    s_nop 0
    buffer_load_dwordx4 v14, s[8:11], s75 offen offset:0  lds
    buffer_load_dwordx4 v15, s[8:11], s75 offen offset:1024  lds
    s_add_u32 m0, s73, 102400
    s_nop 0
    buffer_load_dwordx4 v12, s[8:11], s3 offen offset:0  lds
    buffer_load_dwordx4 v13, s[8:11], s3 offen offset:1024  lds
    s_add_u32 m0, s73, 110592
    s_nop 0
    buffer_load_dwordx4 v14, s[8:11], s3 offen offset:0  lds
    buffer_load_dwordx4 v15, s[8:11], s3 offen offset:1024  lds
    s_add_u32 s75, s75, 393216
    s_cmp_eq_u32 s75, 6291456
    s_cselect_b32 s75, 0, s75
    s_waitcnt vmcnt(36)
    s_barrier
    s_add_u32 m0, s72, 49152
    s_nop 0
    buffer_load_dwordx4 v8, s[4:7], s74 offen offset:0  lds
    buffer_load_dwordx4 v9, s[4:7], s74 offen offset:1024  lds
    buffer_load_dwordx4 v10, s[4:7], s74 offen offset:2048  lds
    buffer_load_dwordx4 v11, s[4:7], s74 offen offset:3072  lds
    s_add_u32 m0, s72, 57344
    s_add_u32 s3, s74, 131072
    buffer_load_dwordx4 v8, s[4:7], s3 offen offset:0  lds
    buffer_load_dwordx4 v9, s[4:7], s3 offen offset:1024  lds
    buffer_load_dwordx4 v10, s[4:7], s3 offen offset:2048  lds
    buffer_load_dwordx4 v11, s[4:7], s3 offen offset:3072  lds
    s_add_u32 s74, s74, 128
    s_and_b32 s74, s74, 2047
    s_add_u32 s3, s75, 196608
    s_add_u32 m0, s73, 114688
    s_nop 0
    buffer_load_dwordx4 v12, s[8:11], s75 offen offset:0  lds
    buffer_load_dwordx4 v13, s[8:11], s75 offen offset:1024  lds
    s_add_u32 m0, s73, 122880
    s_nop 0
    buffer_load_dwordx4 v14, s[8:11], s75 offen offset:0  lds
    buffer_load_dwordx4 v15, s[8:11], s75 offen offset:1024  lds
    s_add_u32 m0, s73, 118784
    s_nop 0
    buffer_load_dwordx4 v12, s[8:11], s3 offen offset:0  lds
    buffer_load_dwordx4 v13, s[8:11], s3 offen offset:1024  lds
    s_add_u32 m0, s73, 126976
    s_nop 0
    buffer_load_dwordx4 v14, s[8:11], s3 offen offset:0  lds
    buffer_load_dwordx4 v15, s[8:11], s3 offen offset:1024  lds
    s_add_u32 s75, s75, 393216
    s_cmp_eq_u32 s75, 6291456
    s_cselect_b32 s75, 0, s75
    s_waitcnt vmcnt(36)
    s_barrier
    s_add_u32 m0, s72, 0
    s_nop 0
    buffer_load_dwordx4 v8, s[4:7], s74 offen offset:0  lds
    buffer_load_dwordx4 v9, s[4:7], s74 offen offset:1024  lds
    buffer_load_dwordx4 v10, s[4:7], s74 offen offset:2048  lds
    buffer_load_dwordx4 v11, s[4:7], s74 offen offset:3072  lds
    s_add_u32 m0, s72, 8192
    s_add_u32 s3, s74, 131072
    buffer_load_dwordx4 v8, s[4:7], s3 offen offset:0  lds
    buffer_load_dwordx4 v9, s[4:7], s3 offen offset:1024  lds
    buffer_load_dwordx4 v10, s[4:7], s3 offen offset:2048  lds
    buffer_load_dwordx4 v11, s[4:7], s3 offen offset:3072  lds
    s_add_u32 s74, s74, 128
    s_and_b32 s74, s74, 2047
    s_add_u32 s3, s75, 196608
    s_add_u32 m0, s73, 65536
    s_nop 0
    buffer_load_dwordx4 v12, s[8:11], s75 offen offset:0  lds
    buffer_load_dwordx4 v13, s[8:11], s75 offen offset:1024  lds
    s_add_u32 m0, s73, 73728
    s_nop 0
    buffer_load_dwordx4 v14, s[8:11], s75 offen offset:0  lds
    buffer_load_dwordx4 v15, s[8:11], s75 offen offset:1024  lds
    s_add_u32 m0, s73, 69632
    s_nop 0
    buffer_load_dwordx4 v12, s[8:11], s3 offen offset:0  lds
    buffer_load_dwordx4 v13, s[8:11], s3 offen offset:1024  lds
    s_add_u32 m0, s73, 77824
    s_nop 0
    buffer_load_dwordx4 v14, s[8:11], s3 offen offset:0  lds
    buffer_load_dwordx4 v15, s[8:11], s3 offen offset:1024  lds
    s_add_u32 s75, s75, 393216
    s_cmp_eq_u32 s75, 6291456
    s_cselect_b32 s75, 0, s75
    s_waitcnt vmcnt(32)
    s_barrier
    s_getpc_b64 s[66:67]
L_pc2:
    s_add_u32 s66, s66, L_c1-L_pc2
    s_addc_u32 s67, s67, 0
    s_lshr_b32 s3, s2, 3
    s_lshl_b32 s3, s3, 1
    s_add_u32 s3, s3, s38
    s_lshl_b32 s3, s3, 6
    s_add_u32 s66, s66, s3
    s_addc_u32 s67, s67, 0
    s_load_dword s65, s[66:67], 0
    s_load_dword s65, s[66:67], 4096
    s_load_dword s65, s[66:67], 8192
    s_load_dword s65, s[66:67], 12288
    s_load_dword s65, s[66:67], 16384
    s_load_dword s65, s[66:67], 20480
    s_add_u32 m0, s72, 16384
    s_nop 0
    buffer_load_dwordx4 v8, s[4:7], s74 offen offset:0  lds
    buffer_load_dwordx4 v9, s[4:7], s74 offen offset:1024  lds
    buffer_load_dwordx4 v10, s[4:7], s74 offen offset:2048  lds
    buffer_load_dwordx4 v11, s[4:7], s74 offen offset:3072  lds
    s_add_u32 m0, s72, 24576
    s_add_u32 s3, s74, 131072
    buffer_load_dwordx4 v8, s[4:7], s3 offen offset:0  lds
    buffer_load_dwordx4 v9, s[4:7], s3 offen offset:1024  lds
    buffer_load_dwordx4 v10, s[4:7], s3 offen offset:2048  lds
    buffer_load_dwordx4 v11, s[4:7], s3 offen offset:3072  lds
    s_add_u32 s74, s74, 128
    s_and_b32 s74, s74, 2047
    s_add_u32 s3, s75, 196608
    s_add_u32 m0, s73, 81920
    s_nop 0
    buffer_load_dwordx4 v12, s[8:11], s75 offen offset:0  lds
    buffer_load_dwordx4 v13, s[8:11], s75 offen offset:1024  lds
    s_add_u32 m0, s73, 90112
    s_nop 0
    buffer_load_dwordx4 v14, s[8:11], s75 offen offset:0  lds
    buffer_load_dwordx4 v15, s[8:11], s75 offen offset:1024  lds
    s_add_u32 m0, s73, 86016
    s_nop 0
    buffer_load_dwordx4 v12, s[8:11], s3 offen offset:0  lds
    buffer_load_dwordx4 v13, s[8:11], s3 offen offset:1024  lds
    s_add_u32 m0, s73, 94208
    s_nop 0
    buffer_load_dwordx4 v14, s[8:11], s3 offen offset:0  lds
    buffer_load_dwordx4 v15, s[8:11], s3 offen offset:1024  lds
    s_add_u32 s75, s75, 393216
    s_cmp_eq_u32 s75, 6291456
    s_cselect_b32 s75, 0, s75
    s_waitcnt vmcnt(32)
    s_barrier
    s_add_u32 m0, s72, 32768
    s_nop 0
    buffer_load_dwordx4 v8, s[4:7], s74 offen offset:0  lds
    buffer_load_dwordx4 v9, s[4:7], s74 offen offset:1024  lds
    buffer_load_dwordx4 v10, s[4:7], s74 offen offset:2048  lds
    buffer_load_dwordx4 v11, s[4:7], s74 offen offset:3072  lds
    s_add_u32 m0, s72, 40960
    s_add_u32 s3, s74, 131072
    buffer_load_dwordx4 v8, s[4:7], s3 offen offset:0  lds
    buffer_load_dwordx4 v9, s[4:7], s3 offen offset:1024  lds
    buffer_load_dwordx4 v10, s[4:7], s3 offen offset:2048  lds
    buffer_load_dwordx4 v11, s[4:7], s3 offen offset:3072  lds
    s_add_u32 s74, s74, 128
    s_and_b32 s74, s74, 2047
    s_add_u32 s3, s75, 196608
    s_add_u32 m0, s73, 98304
    s_nop 0
    buffer_load_dwordx4 v12, s[8:11], s75 offen offset:0  lds
    buffer_load_dwordx4 v13, s[8:11], s75 offen offset:1024  lds
    s_add_u32 m0, s73, 106496
    s_nop 0
    buffer_load_dwordx4 v14, s[8:11], s75 offen offset:0  lds
    buffer_load_dwordx4 v15, s[8:11], s75 offen offset:1024  lds
    s_add_u32 m0, s73, 102400
    s_nop 0
    buffer_load_dwordx4 v12, s[8:11], s3 offen offset:0  lds
    buffer_load_dwordx4 v13, s[8:11], s3 offen offset:1024  lds
    s_add_u32 m0, s73, 110592
    s_nop 0
    buffer_load_dwordx4 v14, s[8:11], s3 offen offset:0  lds
    buffer_load_dwordx4 v15, s[8:11], s3 offen offset:1024  lds
    s_add_u32 s75, s75, 393216
    s_cmp_eq_u32 s75, 6291456
    s_cselect_b32 s75, 0, s75
    s_waitcnt vmcnt(32)
    s_barrier
    s_add_u32 m0, s72, 49152
    s_nop 0
    buffer_load_dwordx4 v8, s[4:7], s74 offen offset:0  lds
    buffer_load_dwordx4 v9, s[4:7], s74 offen offset:1024  lds
    buffer_load_dwordx4 v10, s[4:7], s74 offen offset:2048  lds
    buffer_load_dwordx4 v11, s[4:7], s74 offen offset:3072  lds
    s_add_u32 m0, s72, 57344
    s_add_u32 s3, s74, 131072
    buffer_load_dwordx4 v8, s[4:7], s3 offen offset:0  lds
    buffer_load_dwordx4 v9, s[4:7], s3 offen offset:1024  lds
    buffer_load_dwordx4 v10, s[4:7], s3 offen offset:2048  lds
    buffer_load_dwordx4 v11, s[4:7], s3 offen offset:3072  lds
    s_add_u32 s74, s74, 128
    s_and_b32 s74, s74, 2047
    s_add_u32 s3, s75, 196608
    s_add_u32 m0, s73, 114688
    s_nop 0
    buffer_load_dwordx4 v12, s[8:11], s75 offen offset:0  lds
    buffer_load_dwordx4 v13, s[8:11], s75 offen offset:1024  lds
    s_add_u32 m0, s73, 122880
    s_nop 0
    buffer_load_dwordx4 v14, s[8:11], s75 offen offset:0  lds
    buffer_load_dwordx4 v15, s[8:11], s75 offen offset:1024  lds
    s_add_u32 m0, s73, 118784
    s_nop 0
    buffer_load_dwordx4 v12, s[8:11], s3 offen offset:0  lds
    buffer_load_dwordx4 v13, s[8:11], s3 offen offset:1024  lds
    s_add_u32 m0, s73, 126976
    s_nop 0
    buffer_load_dwordx4 v14, s[8:11], s3 offen offset:0  lds
    buffer_load_dwordx4 v15, s[8:11], s3 offen offset:1024  lds
    s_add_u32 s75, s75, 393216
    s_cmp_eq_u32 s75, 6291456
    s_cselect_b32 s75, 0, s75
    s_waitcnt vmcnt(32)
    s_barrier
    s_waitcnt lgkmcnt(0)
    s_branch L_join
L_xw:
    s_mov_b32 s16, s60
    s_mov_b32 s17, s61
    s_mov_b32 s18, 256
    s_mov_b32 s19, 0x00020000
    s_mov_b32 s20, s44
    s_mov_b32 s21, s45
    s_mov_b32 s22, 65536
    s_mov_b32 s23, 0x00020000
    v_lshlrev_b32 v3, 4, v1
    s_mov_b32 s12, s62
    s_mov_b32 s13, s63
    s_mov_b32 s14, 268435456
    s_mov_b32 s15, 0x00020000
    s_and_b32 s30, s2, 3
    s_lshl_b32 s30, s30, 2
    s_bfe_u32 s3, s2, 0x20003
    s_add_u32 s30, s30, s3
    s_bfe_u32 s31, s2, 0x10002
    s_lshl_b32 s31, s31, 3
    s_lshr_b32 s3, s2, 5
    s_add_u32 s31, s31, s3
    s_mov_b32 s88, 0
    s_mov_b32 s70, 0
    s_mov_b32 s80, s52
    s_mov_b32 s81, s53
    s_mov_b32 s82, 7340032
    s_mov_b32 s83, 0x00020000
    s_mov_b32 s84, s54
    s_mov_b32 s85, s55
    s_mov_b32 s86, 7340032
    s_mov_b32 s87, 0x00020000
    s_cmp_lt_u32 s2, 224
    s_cselect_b32 s82, s82, 0
    s_cselect_b32 s86, s86, 0
    s_and_b32 s3, s2, 15
    s_lshl_b32 s3, s3, 6
    v_and_b32 v5, 0x38, v1
    v_add_u32 v5, s3, v5
    v_mul_u32_u24 v5, 7168, v5
    v_and_b32 v6, 7, v1
    v_lshl_add_u32 v2, v6, 4, v5
    s_lshr_b32 s77, s2, 4
    s_lshl_b32 s77, s77, 2
    s_add_u32 s77, s77, s38
    s_lshl_b32 s77, s77, 7
    v_and_b32 v5, 1, v1
    v_cmp_eq_u32 vcc, 0, v5
    v_mov_b32 v6, 0xffff0000
    v_mov_b32 v7, 0xffff
    v_cndmask_b32 v6, v6, v7, vcc
    v_bfe_u32 v5, v1, 1, 2
    v_cmp_eq_u32 vcc, 0, v5
    s_nop 1
    v_cndmask_b32 v88, 0, v6, vcc
    v_cmp_eq_u32 vcc, 1, v5
    s_nop 1
    v_cndmask_b32 v89, 0, v6, vcc
    v_cmp_eq_u32 vcc, 2, v5
    s_nop 1
    v_cndmask_b32 v90, 0, v6, vcc
    v_cmp_eq_u32 vcc, 3, v5
    s_nop 1
    v_cndmask_b32 v91, 0, v6, vcc
    v_and_b32 v20, 0x3f803f80, v88
    v_and_b32 v21, 0x3f803f80, v89
    v_and_b32 v22, 0x3f803f80, v90
    v_and_b32 v23, 0x3f803f80, v91
    s_lshl_b32 s3, s30, 7
    s_lshl_b32 s65, s38, 5
    s_add_u32 s3, s3, s65
    v_lshrrev_b32 v249, 3, v1
    v_add_u32 v6, s3, v249
    v_lshlrev_b32 v6, 11, v6
    v_and_b32 v250, 7, v1
    v_lshl_add_u32 v6, v250, 4, v6
    s_lshl_b32 s3, s31, 7
    v_add_u32 v248, s3, v6
    s_mov_b32 s48, 16384
    s_mov_b32 s49, 32768
    s_mov_b32 s100, 49152
    v_mov_b32 v28, 0x3f803f80
    v_mov_b32 v29, 0x3f803f80
    v_mov_b32 v30, 0x3f803f80
    v_mov_b32 v31, 0x3f803f80
    v_lshrrev_b32 v5, 4, v1
    v_lshlrev_b32 v4, 3, v5
    v_bfe_u32 v6, v1, 2, 2
    v_add_u32 v4, v4, v6
    v_lshlrev_b32 v4, 7, v4
    v_and_b32 v5, 3, v1
    v_lshl_add_u32 v4, v5, 3, v4
    v_add_u32 v4, 65536, v4
    s_and_b32 s3, s38, 1
    s_lshl_b32 s3, s3, 1
    v_bfe_u32 v6, v1, 3, 2
    v_xor_b32 v6, s3, v6
    v_lshl_add_u32 v26, v6, 5, v4
    v_xor_b32 v6, 1, v6
    v_lshl_add_u32 v27, v6, 5, v4
    s_mul_i32 s3, s101, 43
    s_lshr_b32 s3, s3, 7
    s_mul_i32 s3, s3, 3
    s_sub_u32 s3, s101, s3
    s_lshl_b32 s65, s3, 13
    s_add_u32 s65, s65, 68864
    s_cmp_eq_u32 s3, 0
    s_cselect_b32 s65, 65536, s65
    v_add_u32 v32, s65, v26
    v_add_u32 v33, s65, v27
    s_and_b32 s3, s101, 3
    s_lshl_b32 s3, s3, 14
    v_add_u32 v26, s3, v26
    v_add_u32 v27, s3, v27
    s_lshl_b32 s3, s37, 4
    s_add_u32 s3, s3, s36
    s_lshl_b32 s3, s3, 10
    s_and_b32 s65, s38, 1
    s_lshl_b32 s65, s65, 9
    s_add_u32 s3, s3, s65
    s_add_u32 s68, s3, 1048576
    s_mov_b32 s79, 0
    v_mov_b32 v34, 0
    v_mov_b32 v35, 0
    v_mov_b32 v5, 141376
    ds_write_b64 v5, v[34:35]
    ds_write_b64 v5, v[34:35] offset:8
    ds_write_b64 v5, v[34:35] offset:16
    ds_write_b64 v5, v[34:35] offset:24
    ds_write_b64 v5, v[34:35] offset:32
    ds_write_b64 v5, v[34:35] offset:40
    ds_write_b64 v5, v[34:35] offset:48
    ds_write_b64 v5, v[34:35] offset:56
    ds_write_b64 v5, v[34:35] offset:64
    ds_write_b64 v5, v[34:35] offset:72
    ds_write_b64 v5, v[34:35] offset:80
    ds_write_b64 v5, v[34:35] offset:88
    ds_write_b64 v5, v[34:35] offset:96
L_x0:
    s_barrier
    s_add_u32 s79, s79, 1
    s_cmp_le_u32 s79, s101
    s_cbranch_scc1 L_x0
    ds_read_b64_tr_b16 v[144:145], v26 offset:0
    ds_read_b64_tr_b16 v[146:147], v26 offset:512
    ds_read_b64_tr_b16 v[148:149], v26 offset:4096
    ds_read_b64_tr_b16 v[150:151], v26 offset:4608
    ds_read_b64_tr_b16 v[168:169], v27 offset:0
    ds_read_b64_tr_b16 v[170:171], v27 offset:512
    ds_read_b64_tr_b16 v[172:173], v27 offset:4096
    ds_read_b64_tr_b16 v[174:175], v27 offset:4608
    s_waitcnt lgkmcnt(4)
    ds_read_b64_tr_b16 v[152:153], v26 offset:8192
    ds_read_b64_tr_b16 v[154:155], v26 offset:8704
    ds_read_b64_tr_b16 v[156:157], v26 offset:12288
    ds_read_b64_tr_b16 v[158:159], v26 offset:12800
    ds_read_b64_tr_b16 v[176:177], v27 offset:8192
    ds_read_b64_tr_b16 v[178:179], v27 offset:8704
    ds_read_b64_tr_b16 v[180:181], v27 offset:12288
    ds_read_b64_tr_b16 v[182:183], v27 offset:12800
    s_waitcnt lgkmcnt(4)
    ds_read_b64_tr_b16 v[136:137], v32 offset:0
    ds_read_b64_tr_b16 v[138:139], v32 offset:512
    ds_read_b64_tr_b16 v[140:141], v32 offset:4096
    ds_read_b64_tr_b16 v[142:143], v32 offset:4608
    ds_read_b64_tr_b16 v[160:161], v33 offset:0
    ds_read_b64_tr_b16 v[162:163], v33 offset:512
    ds_read_b64_tr_b16 v[164:165], v33 offset:4096
    ds_read_b64_tr_b16 v[166:167], v33 offset:4608
    s_waitcnt lgkmcnt(0)
    v_mfma_f32_16x16x32_bf16 v[116:119], v[28:31], v[144:147], 0
    v_mfma_f32_16x16x32_bf16 v[120:123], v[28:31], v[152:155], 0
    v_mfma_f32_16x16x32_bf16 v[112:115], v[28:31], v[136:139], 0
    v_mfma_f32_16x16x32_bf16 v[128:131], v[28:31], v[168:171], 0
    v_mfma_f32_16x16x32_bf16 v[132:135], v[28:31], v[176:179], 0
    v_mfma_f32_16x16x32_bf16 v[124:127], v[28:31], v[160:163], 0
    v_mfma_f32_16x16x32_bf16 v[116:119], v[28:31], v[148:151], v[116:119]
    v_mfma_f32_16x16x32_bf16 v[120:123], v[28:31], v[156:159], v[120:123]
    v_mfma_f32_16x16x32_bf16 v[112:115], v[28:31], v[140:143], v[112:115]
    v_mfma_f32_16x16x32_bf16 v[128:131], v[28:31], v[172:175], v[128:131]
    v_mfma_f32_16x16x32_bf16 v[132:135], v[28:31], v[180:183], v[132:135]
    v_mfma_f32_16x16x32_bf16 v[124:127], v[28:31], v[164:167], v[124:127]
L_non:
    buffer_load_dword v18, v34, s[16:19], 0 offen sc1
    s_cmp_lt_u32 s79, 14
    s_cbranch_scc0 L_xb1
    s_barrier
    s_add_u32 s79, s79, 1
L_xb1:
    s_cmp_lt_u32 s79, 14
    s_cbranch_scc0 L_xb2
    s_barrier
    s_add_u32 s79, s79, 1
L_xb2:
    s_waitcnt vmcnt(0)
    v_cmp_eq_u32 vcc, 0, v18
    s_nop 1
    v_cndmask_b32 v6, 0, 1, vcc
    v_cmp_ne_u32 vcc, 0, v6
    s_add_u32 s70, s70, 1
    s_cmp_ge_u32 s70, 200000
    s_cbranch_scc1 L_nonok
    s_cmp_lg_u64 vcc, 0
    s_cbranch_scc1 L_non
L_nonok:
    v_and_b32 v5, 16, v1
    v_cmp_eq_u32 vcc, 0, v5
    v_mov_b32 v139, v18
    s_nop 0
    v_cndmask_b32 v136, v124, v112, vcc
    v_cndmask_b32 v137, v128, v116, vcc
    v_cndmask_b32 v138, v132, v120, vcc
    s_mov_b64 exec, 0xffffffff
    buffer_store_dwordx4 v[136:139], v3, s[12:15], s68 offen sc1
    s_mov_b64 exec, -1
    s_cmp_eq_u32 s38, 3
    s_cbranch_scc1 L_xbw
L_xu3:
    s_cmp_ge_u32 s79, 8
    s_cbranch_scc1 L_xe3
    s_barrier
    s_add_u32 s79, s79, 1
    s_branch L_xu3
L_xe3:
    buffer_load_dwordx4 v[232:235], v248, s[4:7], 0 offen
    buffer_load_dwordx4 v[236:239], v248, s[4:7], s48 offen
    buffer_load_dwordx4 v[240:243], v248, s[4:7], s49 offen
    buffer_load_dwordx4 v[244:247], v248, s[4:7], s100 offen
L_xu4:
    s_cmp_ge_u32 s79, 9
    s_cbranch_scc1 L_xe4
    s_barrier
    s_add_u32 s79, s79, 1
    s_branch L_xu4
L_xe4:
    s_add_u32 m0, s73, 126976
    s_lshl_b32 s65, s37, 12
    s_add_u32 s65, s65, s73
    s_sub_u32 s65, s65, 4096
    buffer_load_dwordx4 v3, s[20:23], s65 offen offset:0 lds
    buffer_load_dwordx4 v3, s[20:23], s65 offen offset:1024 lds
    s_lshl_b32 s68, s37, 14
    s_add_u32 s68, s68, 1048576
L_cs:
    s_mov_b32 s3, s68
    buffer_load_dwordx4 v[112:115], v3, s[12:15], s3 offen offset:0 sc1
    buffer_load_dwordx4 v[116:119], v3, s[12:15], s3 offen offset:1024 sc1
    buffer_load_dwordx4 v[120:123], v3, s[12:15], s3 offen offset:2048 sc1
    buffer_load_dwordx4 v[124:127], v3, s[12:15], s3 offen offset:3072 sc1
    s_add_u32 s3, s3, 4096
    buffer_load_dwordx4 v[128:131], v3, s[12:15], s3 offen offset:0 sc1
    buffer_load_dwordx4 v[132:135], v3, s[12:15], s3 offen offset:1024 sc1
    buffer_load_dwordx4 v[136:139], v3, s[12:15], s3 offen offset:2048 sc1
    buffer_load_dwordx4 v[140:143], v3, s[12:15], s3 offen offset:3072 sc1
    s_add_u32 s3, s3, 4096
    s_cmp_lt_u32 s79, 14
    s_cbranch_scc0 L_xb5
    s_barrier
    s_add_u32 s79, s79, 1
L_xb5:
    buffer_load_dwordx4 v[144:147], v3, s[12:15], s3 offen offset:0 sc1
    buffer_load_dwordx4 v[148:151], v3, s[12:15], s3 offen offset:1024 sc1
    buffer_load_dwordx4 v[152:155], v3, s[12:15], s3 offen offset:2048 sc1
    buffer_load_dwordx4 v[156:159], v3, s[12:15], s3 offen offset:3072 sc1
    s_add_u32 s3, s3, 4096
    buffer_load_dwordx4 v[160:163], v3, s[12:15], s3 offen offset:0 sc1
    buffer_load_dwordx4 v[164:167], v3, s[12:15], s3 offen offset:1024 sc1
    buffer_load_dwordx4 v[168:171], v3, s[12:15], s3 offen offset:2048 sc1
    buffer_load_dwordx4 v[172:175], v3, s[12:15], s3 offen offset:3072 sc1
    s_cmp_lt_u32 s79, 14
    s_cbranch_scc0 L_xb6
    s_barrier
    s_add_u32 s79, s79, 1
L_xb6:
    s_cmp_lt_u32 s79, 14
    s_cbranch_scc0 L_xb7
    s_barrier
    s_add_u32 s79, s79, 1
L_xb7:
    s_waitcnt vmcnt(0)
    v_and_b32 v6, v115, v119
    v_or_b32 v7, v115, v119
    v_min3_u32 v6, v6, v123, v127
    v_max3_u32 v7, v7, v123, v127
    v_min3_u32 v6, v6, v131, v135
    v_max3_u32 v7, v7, v131, v135
    v_min3_u32 v6, v6, v139, v143
    v_max3_u32 v7, v7, v139, v143
    v_min3_u32 v6, v6, v147, v151
    v_max3_u32 v7, v7, v147, v151
    v_min3_u32 v6, v6, v155, v159
    v_max3_u32 v7, v7, v155, v159
    v_min3_u32 v6, v6, v163, v167
    v_max3_u32 v7, v7, v163, v167
    v_min3_u32 v6, v6, v171, v175
    v_max3_u32 v7, v7, v171, v175
    v_xor_b32 v6, v6, v18
    v_xor_b32 v7, v7, v18
    v_or_b32 v6, v6, v7
    v_cmp_ne_u32 vcc, 0, v6
    s_add_u32 s70, s70, 1
    s_cmp_ge_u32 s70, 200000
    s_cbranch_scc1 L_csok
    s_cmp_lg_u64 vcc, 0
    s_cbranch_scc1 L_cs
L_csok:
    s_cmp_lt_u32 s79, 14
    s_cbranch_scc0 L_xb8
    s_barrier
    s_add_u32 s79, s79, 1
L_xb8:
    v_pk_add_f32 v[112:113], v[112:113], v[144:145]
    v_add_f32 v114, v114, v146
    v_pk_add_f32 v[116:117], v[116:117], v[148:149]
    v_add_f32 v118, v118, v150
    v_pk_add_f32 v[120:121], v[120:121], v[152:153]
    v_add_f32 v122, v122, v154
    v_pk_add_f32 v[124:125], v[124:125], v[156:157]
    v_add_f32 v126, v126, v158
    v_pk_add_f32 v[128:129], v[128:129], v[160:161]
    v_add_f32 v130, v130, v162
    v_pk_add_f32 v[132:133], v[132:133], v[164:165]
    v_add_f32 v134, v134, v166
    v_pk_add_f32 v[136:137], v[136:137], v[168:169]
    v_add_f32 v138, v138, v170
    v_pk_add_f32 v[140:141], v[140:141], v[172:173]
    v_add_f32 v142, v142, v174
    v_pk_add_f32 v[112:113], v[112:113], v[128:129]
    v_add_f32 v114, v114, v130
    v_pk_add_f32 v[116:117], v[116:117], v[132:133]
    v_add_f32 v118, v118, v134
    v_pk_add_f32 v[120:121], v[120:121], v[136:137]
    v_add_f32 v122, v122, v138
    v_pk_add_f32 v[124:125], v[124:125], v[140:141]
    v_add_f32 v126, v126, v142
    s_cmp_lt_u32 s79, 14
    s_cbranch_scc0 L_xb9
    s_barrier
    s_add_u32 s79, s79, 1
L_xb9:
    v_pk_add_f32 v[112:113], v[112:113], v[120:121]
    v_add_f32 v114, v114, v122
    v_pk_add_f32 v[116:117], v[116:117], v[124:125]
    v_add_f32 v118, v118, v126
    v_pk_add_f32 v[112:113], v[112:113], v[116:117]
    v_add_f32 v114, v114, v118
    v_lshlrev_b32 v5, 2, v1
    v_add_u32 v5, 140544, v5
    ds_write_b32 v5, v112
    ds_write_b32 v5, v113 offset:256
    ds_write_b32 v5, v114 offset:512
    s_branch L_xend
L_xbw:
    s_cmp_lt_u32 s79, 14
    s_cbranch_scc0 L_xb10
    s_barrier
    s_add_u32 s79, s79, 1
L_xb10:
    v_and_b32 v5, 7, v1
    v_lshlrev_b32 v5, 3, v5
    v_add_u32 v6, 141504, v5
    ds_read_b64 v[140:141], v6
    s_lshl_b32 s65, s36, 4
    s_add_u32 s65, s65, s37
    s_lshl_b32 s65, s65, 6
    s_add_u32 s65, s65, 0
    s_lshl_b32 s3, s2, 4
    s_add_u32 s3, s3, 65536
    v_mov_b32 v146, v18
    v_mov_b32 v147, v18
    s_waitcnt lgkmcnt(0)
    v_mov_b32 v144, v141
    v_mov_b32 v145, v140
    s_nop 0
    v_max_u32 v144, v144, v144 quad_perm:[1,0,3,2] row_mask:0xf bank_mask:0xf
    s_nop 1
    v_max_u32 v144, v144, v144 quad_perm:[2,3,0,1] row_mask:0xf bank_mask:0xf
    s_nop 1
    v_max_u32 v144, v144, v144 row_half_mirror row_mask:0xf bank_mask:0xf
    v_cmp_eq_u32 vcc, v144, v141
    v_mov_b32 v141, v18
    s_mov_b64 exec, 0xff
    buffer_store_dwordx2 v[140:141], v5, s[12:15], s65 offen sc1
    s_and_b64 exec, exec, vcc
    buffer_store_dwordx4 v[144:147], v34, s[12:15], s3 offen sc1
    s_mov_b64 exec, -1
L_xu11:
    s_cmp_ge_u32 s79, 8
    s_cbranch_scc1 L_xe11
    s_barrier
    s_add_u32 s79, s79, 1
    s_branch L_xu11
L_xe11:
    buffer_load_dwordx4 v[232:235], v248, s[4:7], 0 offen
    buffer_load_dwordx4 v[236:239], v248, s[4:7], s48 offen
    buffer_load_dwordx4 v[240:243], v248, s[4:7], s49 offen
    buffer_load_dwordx4 v[244:247], v248, s[4:7], s100 offen
L_xu12:
    s_cmp_ge_u32 s79, 9
    s_cbranch_scc1 L_xe12
    s_barrier
    s_add_u32 s79, s79, 1
    s_branch L_xu12
L_xe12:
    s_add_u32 m0, s73, 126976
    s_lshl_b32 s65, s37, 12
    s_add_u32 s65, s65, s73
    s_sub_u32 s65, s65, 4096
    buffer_load_dwordx4 v3, s[20:23], s65 offen offset:0 lds
    buffer_load_dwordx4 v3, s[20:23], s65 offen offset:1024 lds
    s_mov_b32 s68, 65536
    s_lshl_b32 s66, s36, 10
    s_lshl_b32 s67, s30, 10
L_st:
    buffer_load_dwordx4 v[112:115], v3, s[12:15], s68 offen offset:0 sc1
    buffer_load_dwordx4 v[116:119], v3, s[12:15], s68 offen offset:1024 sc1
    buffer_load_dwordx4 v[120:123], v3, s[12:15], s68 offen offset:2048 sc1
    buffer_load_dwordx4 v[124:127], v3, s[12:15], s68 offen offset:3072 sc1
    buffer_load_dwordx4 v[128:131], v3, s[12:15], s66 offen offset:0 sc1
    buffer_load_dwordx4 v[132:135], v3, s[12:15], s67 offen offset:0 sc1
    s_cmp_lt_u32 s79, 14
    s_cbranch_scc0 L_xb13
    s_barrier
    s_add_u32 s79, s79, 1
L_xb13:
    s_cmp_lt_u32 s79, 14
    s_cbranch_scc0 L_xb14
    s_barrier
    s_add_u32 s79, s79, 1
L_xb14:
    s_waitcnt vmcnt(0)
    v_and_b32 v6, v114, v118
    v_or_b32 v7, v114, v118
    v_min3_u32 v6, v6, v122, v126
    v_max3_u32 v7, v7, v122, v126
    v_min3_u32 v6, v6, v129, v131
    v_max3_u32 v7, v7, v129, v131
    v_min3_u32 v6, v6, v133, v135
    v_max3_u32 v7, v7, v133, v135
    v_xor_b32 v6, v6, v18
    v_xor_b32 v7, v7, v18
    v_or_b32 v6, v6, v7
    v_cmp_ne_u32 vcc, 0, v6
    s_add_u32 s70, s70, 1
    s_cmp_ge_u32 s70, 200000
    s_cbranch_scc1 L_stok
    s_cmp_lg_u64 vcc, 0
    s_cbranch_scc1 L_st
L_stok:
    s_cmp_lt_u32 s79, 14
    s_cbranch_scc0 L_xb15
    s_barrier
    s_add_u32 s79, s79, 1
L_xb15:
    v_and_b32 v140, 0xffff0000, v128
    v_and_b32 v141, 0xffff0000, v130
    v_and_b32 v142, 0xffff0000, v132
    v_and_b32 v143, 0xffff0000, v134
    v_rcp_f32 v144, v140
    v_rcp_f32 v145, v141
    v_rcp_f32 v146, v142
    v_rcp_f32 v147, v143
    v_lshlrev_b32 v136, 16, v128
    v_lshlrev_b32 v137, 16, v130
    v_lshlrev_b32 v138, 16, v132
    v_lshlrev_b32 v139, 16, v134
    v_lshrrev_b32 v7, 16, v128
    v_or_b32 v7, v7, v141
    v_lshlrev_b32 v5, 3, v1
    v_add_u32 v5, 137984, v5
    v_lshlrev_b32 v4, 2, v1
    v_add_u32 v4, 139008, v4
    v_fma_f32 v140, -v144, v140, 1.0
    v_fma_f32 v141, -v145, v141, 1.0
    v_fma_f32 v142, -v146, v142, 1.0
    v_fma_f32 v143, -v147, v143, 1.0
    v_fmac_f32 v144, v140, v144
    v_fmac_f32 v145, v141, v145
    v_fmac_f32 v146, v142, v146
    v_fmac_f32 v147, v143, v147
    s_cmp_lt_u32 s79, 14
    s_cbranch_scc0 L_xb16
    s_barrier
    s_add_u32 s79, s79, 1
L_xb16:
    ds_write_b64 v5, v[136:137]
    ds_write_b64 v5, v[144:145] offset:512
    ds_write_b64 v5, v[138:139] offset:1536
    ds_write_b64 v5, v[146:147] offset:2048
    ds_write_b32 v4, v7
    v_cmp_gt_u32 vcc, v116, v112
    s_nop 1
    v_cndmask_b32 v112, v112, v116, vcc
    v_cndmask_b32 v113, v113, v117, vcc
    v_cmp_gt_u32 vcc, v124, v120
    s_nop 1
    v_cndmask_b32 v120, v120, v124, vcc
    v_cndmask_b32 v121, v121, v125, vcc
    v_cmp_gt_u32 vcc, v120, v112
    s_nop 1
    v_cndmask_b32 v112, v112, v120, vcc
    v_cndmask_b32 v113, v113, v121, vcc
    v_mov_b32 v6, v112
    s_cmp_lt_u32 s79, 14
    s_cbranch_scc0 L_xb17
    s_barrier
    s_add_u32 s79, s79, 1
L_xb17:
    v_max_u32 v6, v6, v6 quad_perm:[1,0,3,2] row_mask:0xf bank_mask:0xf
    s_nop 1
    v_max_u32 v6, v6, v6 quad_perm:[2,3,0,1] row_mask:0xf bank_mask:0xf
    s_nop 1
    v_max_u32 v6, v6, v6 row_half_mirror row_mask:0xf bank_mask:0xf
    s_nop 1
    v_max_u32 v6, v6, v6 row_mirror row_mask:0xf bank_mask:0xf
    v_mov_b32 v7, v6
    s_nop 1
    v_permlane16_swap_b32 v6, v7
    v_max_u32 v6, v6, v7
    v_mov_b32 v7, v6
    s_nop 1
    v_permlane32_swap_b32 v6, v7
    v_max_u32 v6, v6, v7
    v_cmp_eq_u32 vcc, v6, v112
    v_mov_b32 v5, 141312
    s_mov_b64 exec, vcc
    ds_write_b128 v5, v[112:115]
    s_mov_b64 exec, -1
L_xend:
    s_waitcnt lgkmcnt(0)
L_xu18:
    s_cmp_ge_u32 s79, 14
    s_cbranch_scc1 L_xe18
    s_barrier
    s_add_u32 s79, s79, 1
    s_branch L_xu18
L_xe18:
L_join:
    s_add_u32 s76, s39, 12
    s_and_b32 s76, s76, 15
    s_mul_i32 s76, s76, 393216
    s_add_u32 m0, s73, 65536
    s_nop 0
    buffer_load_dwordx4 v16, s[8:11], s76 offen offset:0  lds
    buffer_load_dwordx4 v17, s[8:11], s76 offen offset:1024  lds
    s_add_u32 s76, s76, 393216
    s_cmp_eq_u32 s76, 6291456
    s_cselect_b32 s76, 0, s76
    s_add_u32 m0, s73, 73728
    s_nop 0
    buffer_load_dwordx4 v16, s[8:11], s76 offen offset:0  lds
    buffer_load_dwordx4 v17, s[8:11], s76 offen offset:1024  lds
    s_add_u32 s76, s76, 393216
    s_cmp_eq_u32 s76, 6291456
    s_cselect_b32 s76, 0, s76
    s_add_u32 s75, s39, 6
    s_and_b32 s75, s75, 15
    s_lshl_b32 s74, s75, 7
    s_mul_i32 s75, s75, 393216
    buffer_load_dwordx4 v[36:39], v16, s[8:11], s75 offen offset:0
    buffer_load_dwordx4 v[40:43], v17, s[8:11], s75 offen offset:1024
    s_add_u32 s75, s75, 393216
    s_cmp_eq_u32 s75, 6291456
    s_cselect_b32 s75, 0, s75
    buffer_load_dwordx4 v[44:47], v16, s[8:11], s75 offen offset:0
    buffer_load_dwordx4 v[48:51], v17, s[8:11], s75 offen offset:1024
    s_add_u32 s75, s75, 393216
    s_cmp_eq_u32 s75, 6291456
    s_cselect_b32 s75, 0, s75
    buffer_load_dwordx4 v[52:55], v16, s[8:11], s75 offen offset:0
    buffer_load_dwordx4 v[56:59], v17, s[8:11], s75 offen offset:1024
    s_add_u32 s75, s75, 393216
    s_cmp_eq_u32 s75, 6291456
    s_cselect_b32 s75, 0, s75
    buffer_load_dwordx4 v[60:63], v16, s[8:11], s75 offen offset:0
    buffer_load_dwordx4 v[64:67], v17, s[8:11], s75 offen offset:1024
    s_add_u32 s75, s75, 393216
    s_cmp_eq_u32 s75, 6291456
    s_cselect_b32 s75, 0, s75
    s_mov_b32 s16, s46
    s_mov_b32 s17, s47
    s_mov_b32 s18, 2097152
    s_mov_b32 s19, 0x00020000
    v_lshrrev_b32 v5, 3, v1
    v_lshlrev_b32 v5, 11, v5
    v_lshrrev_b32 v6, 4, v1
    v_lshlrev_b32 v6, 1, v6
    v_and_b32 v7, 7, v1
    v_xor_b32 v6, v6, v7
    v_lshl_add_u32 v5, v6, 4, v5
    s_lshl_b32 s3, s31, 7
    s_lshl_b32 s65, s38, 15
    s_add_u32 s3, s3, s65
    v_add_u32 v110, s3, v5
    v_add_u32 v111, 15360, v110
    s_lshl_b32 s3, s2, 2
    s_add_u32 s3, s3, s38
    s_lshl_b32 s3, s3, 11
    v_lshlrev_b32 v5, 7, v1
    s_mov_b64 exec, 0xffff
    buffer_load_dword v0, v5, s[16:19], s3 offen
    s_mov_b64 exec, -1
    buffer_load_dwordx4 v[128:131], v2, s[80:83], s77 offen nt
    buffer_load_dwordx4 v[160:163], v2, s[84:87], s77 offen nt
    s_add_u32 s77, s77, 7168
    s_waitcnt vmcnt(15)
    s_barrier
    s_add_u32 m0, s73, 81920
    s_nop 0
    buffer_load_dwordx4 v16, s[8:11], s76 offen offset:0  lds
    buffer_load_dwordx4 v17, s[8:11], s76 offen offset:1024  lds
    s_add_u32 s76, s76, 393216
    s_cmp_eq_u32 s76, 6291456
    s_cselect_b32 s76, 0, s76
    s_add_u32 m0, s73, 90112
    s_nop 0
    buffer_load_dwordx4 v16, s[8:11], s76 offen offset:0  lds
    buffer_load_dwordx4 v17, s[8:11], s76 offen offset:1024  lds
    s_add_u32 s76, s76, 393216
    s_cmp_eq_u32 s76, 6291456
    s_cselect_b32 s76, 0, s76
    s_mov_b32 s76, s75
    v_mov_b32 v5, 141312
    ds_read_b128 v[80:83], v5
    s_and_b32 s65, s2, 15
    s_lshl_b32 s65, s65, 7
    v_lshrrev_b32 v5, 3, v1
    v_lshlrev_b32 v5, 4, v5
    s_waitcnt lgkmcnt(0)
    v_readfirstlane_b32 s33, v80
    v_readfirstlane_b32 s64, v81
    v_mov_b32 v18, v82
    s_and_b32 s34, s33, 0x7ff
    s_sub_u32 s34, 2047, s34
    s_lshl_b32 s3, s34, 11
    s_add_u32 s3, s3, s65
    buffer_load_dwordx4 v[76:79], v5, s[4:7], s3 offen
    s_lshr_b32 s3, s34, 7
    s_cmp_eq_u32 s3, s30
    s_cselect_b32 s35, 1, 0
    buffer_load_dwordx4 v[132:135], v2, s[80:83], s77 offen nt
    buffer_load_dwordx4 v[164:167], v2, s[84:87], s77 offen nt
    s_add_u32 s77, s77, 7168
    s_mov_b32 s20, s56
    s_mov_b32 s21, s57
    s_mov_b32 s22, 7340032
    s_mov_b32 s23, 0x00020000
    s_mov_b32 s24, s58
    s_mov_b32 s25, s59
    s_mov_b32 s26, 4194304
    s_mov_b32 s27, 0x00020000
    s_cmp_lt_u32 s2, 224
    s_cselect_b32 s22, s22, 0
    v_lshrrev_b32 v5, 4, v1
    v_lshlrev_b32 v5, 11, v5
    v_and_b32 v6, 15, v1
    v_lshl_add_u32 v109, v6, 4, v5
    s_lshl_b32 s93, s2, 15
    s_lshl_b32 s65, s38, 9
    s_add_u32 s93, s93, s65
    buffer_load_dwordx4 v[136:139], v2, s[80:83], s77 offen nt
    buffer_load_dwordx4 v[168:171], v2, s[84:87], s77 offen nt
    s_add_u32 s77, s77, 7168
    buffer_load_dwordx4 v[140:143], v2, s[80:83], s77 offen nt
    buffer_load_dwordx4 v[172:175], v2, s[84:87], s77 offen nt
    s_add_u32 s77, s77, 7168
    buffer_load_dwordx4 v[144:147], v2, s[80:83], s77 offen nt
    buffer_load_dwordx4 v[176:179], v2, s[84:87], s77 offen nt
    s_add_u32 s77, s77, 7168
    buffer_load_dwordx4 v[148:151], v2, s[80:83], s77 offen nt
    buffer_load_dwordx4 v[180:183], v2, s[84:87], s77 offen nt
    s_add_u32 s77, s77, 7168
    buffer_load_dwordx4 v[152:155], v2, s[80:83], s77 offen nt
    buffer_load_dwordx4 v[184:187], v2, s[84:87], s77 offen nt
    s_add_u32 s77, s77, 7168
    buffer_load_dwordx4 v[156:159], v2, s[80:83], s77 offen nt
    buffer_load_dwordx4 v[188:191], v2, s[84:87], s77 offen nt
    s_add_u32 s77, s77, 7168
    s_lshl_b32 s65, s37, 1
    s_and_b32 s3, s38, 1
    s_add_u32 s65, s65, s3
    s_lshl_b32 s3, s36, 1
    s_lshr_b32 s68, s38, 1
    s_add_u32 s3, s3, s68
    s_lshl_b32 s3, s3, 8
    s_lshl_b32 s89, s65, 17
    s_add_u32 s89, s89, s3
    s_add_u32 s89, s89, 2097152
    s_add_u32 s90, s89, 32768
    s_add_u32 s91, s89, 65536
    s_add_u32 s92, s89, 98304
    s_lshl_b32 s69, s65, 13
    s_add_u32 s69, s69, 524288
    s_add_u32 s68, s69, s3
    s_add_u32 s71, s69, 4096
    v_mov_b32 v19, 1
    s_lshl_b32 s3, s38, 2
    s_add_u32 s3, s3, 141408
    v_mov_b32 v27, s3
    v_mov_b32 v26, 3
    v_add_u32 v24, s72, v3
    v_lshrrev_b32 v5, 4, v1
    v_and_b32 v6, 15, v1
    v_lshlrev_b32 v6, 4, v6
    v_lshl_add_u32 v28, v5, 13, v6
    s_lshl_b32 s3, s38, 12
    s_add_u32 s3, s3, 122880
    v_add_u32 v30, s3, v3
    s_lshl_b32 s3, s38, 7
    s_add_u32 s3, s3, 139008
    v_lshl_add_u32 v31, v5, 3, s3
    s_waitcnt vmcnt(14)
    s_lshl_b32 s65, s64, 16
    s_and_b32 s66, s64, 0xffff0000
    v_rcp_f32 v6, s66
    v_lshlrev_b32 v80, 16, v76
    v_and_b32 v81, 0xffff0000, v76
    v_lshlrev_b32 v82, 16, v77
    v_and_b32 v83, 0xffff0000, v77
    v_lshlrev_b32 v84, 16, v78
    v_and_b32 v85, 0xffff0000, v78
    v_lshlrev_b32 v86, 16, v79
    v_and_b32 v87, 0xffff0000, v79
    v_fma_f32 v4, -v6, s66, 1.0
    v_fmac_f32 v6, v4, v6
    v_subrev_f32 v80, s65, v80
    v_subrev_f32 v81, s65, v81
    v_subrev_f32 v82, s65, v82
    v_subrev_f32 v83, s65, v83
    v_subrev_f32 v84, s65, v84
    v_subrev_f32 v85, s65, v85
    v_subrev_f32 v86, s65, v86
    v_subrev_f32 v87, s65, v87
    v_cvt_pk_bf16_f32 v80, v80, v80
    v_cvt_pk_bf16_f32 v81, v81, v81
    v_cvt_pk_bf16_f32 v82, v82, v82
    v_cvt_pk_bf16_f32 v83, v83, v83
    v_cvt_pk_bf16_f32 v84, v84, v84
    v_cvt_pk_bf16_f32 v85, v85, v85
    v_cvt_pk_bf16_f32 v86, v86, v86
    v_cvt_pk_bf16_f32 v87, v87, v87
    v_lshlrev_b32 v80, 16, v80
    v_lshlrev_b32 v81, 16, v81
    v_lshlrev_b32 v82, 16, v82
    v_lshlrev_b32 v83, 16, v83
    v_lshlrev_b32 v84, 16, v84
    v_lshlrev_b32 v85, 16, v85
    v_lshlrev_b32 v86, 16, v86
    v_lshlrev_b32 v87, 16, v87
    v_mul_f32 v80, v80, v6
    v_mul_f32 v81, v81, v6
    v_mul_f32 v82, v82, v6
    v_mul_f32 v83, v83, v6
    v_mul_f32 v84, v84, v6
    v_mul_f32 v85, v85, v6
    v_mul_f32 v86, v86, v6
    v_mul_f32 v87, v87, v6
    v_cvt_pk_bf16_f32 v80, v80, v80
    v_cvt_pk_bf16_f32 v81, v81, v81
    v_cvt_pk_bf16_f32 v82, v82, v82
    v_cvt_pk_bf16_f32 v83, v83, v83
    v_cvt_pk_bf16_f32 v84, v84, v84
    v_cvt_pk_bf16_f32 v85, v85, v85
    v_cvt_pk_bf16_f32 v86, v86, v86
    v_cvt_pk_bf16_f32 v87, v87, v87
    v_lshrrev_b32 v5, 5, v1
    v_and_b32 v6, 7, v1
    v_lshlrev_b32 v6, 1, v6
    v_lshl_add_u32 v6, v5, 4, v6
    v_bfe_u32 v5, v1, 4, 1
    v_add_u32 v6, v6, v5
    v_lshlrev_b32 v108, 4, v6
    s_lshr_b32 s3, s2, 4
    s_lshl_b32 s3, s3, 2
    s_add_u32 s3, s3, s38
    s_lshl_b32 s3, s3, 4
    s_and_b32 s65, s2, 15
    s_add_u32 s3, s3, s65
    s_lshl_b32 s3, s3, 10
    s_add_u32 s78, s3, 6291456
    s_mov_b32 s66, 0x00ff00ff
    s_mov_b32 s67, 0x00ff00ff
    v_mov_b32 v93, v18
    v_mov_b32 v95, v18
    v_mov_b32 v97, v18
    v_mov_b32 v99, v18
    v_mov_b32 v5, 141376
L_t1:
    ds_read_b128 v[68:71], v5 offset:16
    s_waitcnt lgkmcnt(0)
    v_and_b32 v68, v68, v69
    v_and_b32 v70, v70, v71
    v_and_b32 v68, v68, v70
    s_nop 0
    v_readfirstlane_b32 s3, v68
    s_nop 0
    s_cmp_eq_u32 s3, 1
    s_cbranch_scc1 L_t1d
    s_sleep 1
    s_branch L_t1
L_t1d:
    s_add_u32 s3, s73, 65536
    v_add_u32 v5, s3, v3
    ds_write_b128 v5, v[36:39] offset:32768
    ds_write_b128 v5, v[40:43] offset:33792
    ds_write_b128 v5, v[44:47] offset:40960
    ds_write_b128 v5, v[48:51] offset:41984
    ds_write_b128 v5, v[52:55] offset:49152
    ds_write_b128 v5, v[56:59] offset:50176
    ds_write_b128 v5, v[60:63] offset:57344
    ds_write_b128 v5, v[64:67] offset:58368
    v_and_b32 v68, v80, v88
    v_and_b32 v69, v80, v89
    v_and_b32 v70, v80, v90
    v_and_b32 v71, v80, v91
    s_nop 1
    v_mfma_f32_16x16x32_bf16 v[100:103], v[68:71], v[128:131], 0
    v_mfma_f32_16x16x32_bf16 v[104:107], v[68:71], v[160:163], 0
    s_waitcnt vmcnt(12)
    v_and_b32 v72, v81, v88
    v_and_b32 v73, v81, v89
    v_and_b32 v74, v81, v90
    v_and_b32 v75, v81, v91
    s_nop 1
    v_mfma_f32_16x16x32_bf16 v[100:103], v[72:75], v[132:135], v[100:103]
    v_mfma_f32_16x16x32_bf16 v[104:107], v[72:75], v[164:167], v[104:107]
    s_waitcnt vmcnt(10)
    v_and_b32 v68, v82, v88
    v_and_b32 v69, v82, v89
    v_and_b32 v70, v82, v90
    v_and_b32 v71, v82, v91
    s_nop 1
    v_mfma_f32_16x16x32_bf16 v[100:103], v[68:71], v[136:139], v[100:103]
    v_mfma_f32_16x16x32_bf16 v[104:107], v[68:71], v[168:171], v[104:107]
    s_waitcnt vmcnt(8)
    v_and_b32 v72, v83, v88
    v_and_b32 v73, v83, v89
    v_and_b32 v74, v83, v90
    v_and_b32 v75, v83, v91
    s_nop 1
    v_mfma_f32_16x16x32_bf16 v[100:103], v[72:75], v[140:143], v[100:103]
    v_mfma_f32_16x16x32_bf16 v[104:107], v[72:75], v[172:175], v[104:107]
    s_waitcnt lgkmcnt(0)
    s_sub_u32 s74, s74, 128
    s_sub_u32 s76, s76, 393216
    s_barrier
    s_barrier
    s_add_u32 m0, s72, 0
    s_add_u32 s74, s74, 128
    s_and_b32 s74, s74, 2047
    buffer_load_dwordx4 v8, s[4:7], s74 offen offset:0 lds
    buffer_load_dwordx4 v9, s[4:7], s74 offen offset:1024 lds
    buffer_load_dwordx4 v10, s[4:7], s74 offen offset:2048 lds
    buffer_load_dwordx4 v11, s[4:7], s74 offen offset:3072 lds
    s_add_u32 m0, s73, 65536
    s_add_u32 s76, s76, 393216
    s_cmp_eq_u32 s76, 6291456
    s_cselect_b32 s76, 0, s76
    buffer_load_dwordx4 v16, s[8:11], s76 offen offset:0 lds
    buffer_load_dwordx4 v17, s[8:11], s76 offen offset:1024 lds
    s_barrier
    s_add_u32 m0, s72, 16384
    s_add_u32 s74, s74, 128
    s_and_b32 s74, s74, 2047
    buffer_load_dwordx4 v8, s[4:7], s74 offen offset:0 lds
    buffer_load_dwordx4 v9, s[4:7], s74 offen offset:1024 lds
    buffer_load_dwordx4 v10, s[4:7], s74 offen offset:2048 lds
    buffer_load_dwordx4 v11, s[4:7], s74 offen offset:3072 lds
    s_add_u32 m0, s73, 73728
    s_add_u32 s76, s76, 393216
    s_cmp_eq_u32 s76, 6291456
    s_cselect_b32 s76, 0, s76
    buffer_load_dwordx4 v16, s[8:11], s76 offen offset:0 lds
    buffer_load_dwordx4 v17, s[8:11], s76 offen offset:1024 lds
    s_barrier
    s_add_u32 m0, s72, 32768
    s_add_u32 s74, s74, 128
    s_and_b32 s74, s74, 2047
    buffer_load_dwordx4 v8, s[4:7], s74 offen offset:0 lds
    buffer_load_dwordx4 v9, s[4:7], s74 offen offset:1024 lds
    buffer_load_dwordx4 v10, s[4:7], s74 offen offset:2048 lds
    buffer_load_dwordx4 v11, s[4:7], s74 offen offset:3072 lds
    s_waitcnt vmcnt(12)
    s_barrier
    s_add_u32 m0, s72, 49152
    s_add_u32 s74, s74, 128
    s_and_b32 s74, s74, 2047
    buffer_load_dwordx4 v8, s[4:7], s74 offen offset:0 lds
    buffer_load_dwordx4 v9, s[4:7], s74 offen offset:1024 lds
    buffer_load_dwordx4 v10, s[4:7], s74 offen offset:2048 lds
    buffer_load_dwordx4 v11, s[4:7], s74 offen offset:3072 lds
    s_waitcnt vmcnt(10)
    s_barrier
    s_add_u32 m0, s72, 0
    s_add_u32 s74, s74, 128
    s_and_b32 s74, s74, 2047
    buffer_load_dwordx4 v8, s[4:7], s74 offen offset:0 lds
    buffer_load_dwordx4 v9, s[4:7], s74 offen offset:1024 lds
    buffer_load_dwordx4 v10, s[4:7], s74 offen offset:2048 lds
    buffer_load_dwordx4 v11, s[4:7], s74 offen offset:3072 lds
    buffer_load_dwordx4 v[36:39], v28, s[12:15], s89 offen sc1
    buffer_load_dwordx4 v[40:43], v28, s[12:15], s90 offen sc1
    buffer_load_dwordx4 v[44:47], v28, s[12:15], s91 offen sc1
    buffer_load_dwordx4 v[48:51], v28, s[12:15], s92 offen sc1
    s_waitcnt vmcnt(12)
    s_waitcnt vmcnt(8)
    s_barrier
    s_add_u32 m0, s72, 16384
    s_add_u32 s74, s74, 128
    s_and_b32 s74, s74, 2047
    buffer_load_dwordx4 v8, s[4:7], s74 offen offset:0 lds
    buffer_load_dwordx4 v9, s[4:7], s74 offen offset:1024 lds
    buffer_load_dwordx4 v10, s[4:7], s74 offen offset:2048 lds
    buffer_load_dwordx4 v11, s[4:7], s74 offen offset:3072 lds
    s_waitcnt vmcnt(8)
    ds_write_b32 v27, v19
    s_waitcnt vmcnt(4)
L_ha:
    v_mfma_f32_16x16x32_bf16 v[52:55], v[20:23], v[36:39], 0
    v_mfma_f32_16x16x32_bf16 v[52:55], v[20:23], v[40:43], v[52:55]
    v_mfma_f32_16x16x32_bf16 v[52:55], v[20:23], v[44:47], v[52:55]
    v_mfma_f32_16x16x32_bf16 v[52:55], v[20:23], v[48:51], v[52:55]
    v_and_b32 v6, v39, v43
    v_or_b32 v7, v39, v43
    v_min3_u32 v6, v6, v47, v51
    v_max3_u32 v7, v7, v47, v51
    v_xor_b32 v6, v6, v18
    v_xor_b32 v7, v7, v18
    v_or_b32 v6, v6, v7
    v_cmp_ne_u32 vcc, 0, v6
    s_nop 0
    s_cmp_eq_u64 vcc, 0
    s_cbranch_scc1 L_haok
    s_add_u32 s70, s70, 1
    s_cmp_ge_u32 s70, 200000
    s_cbranch_scc1 L_haok
    s_sleep 6
    s_waitcnt vmcnt(0)
    ds_write_b32 v27, v26
    buffer_load_dwordx4 v[36:39], v28, s[12:15], s89 offen sc1
    buffer_load_dwordx4 v[40:43], v28, s[12:15], s90 offen sc1
    buffer_load_dwordx4 v[44:47], v28, s[12:15], s91 offen sc1
    buffer_load_dwordx4 v[48:51], v28, s[12:15], s92 offen sc1
    s_waitcnt vmcnt(0)
    s_branch L_ha
L_haok:
    v_cvt_pk_bf16_f32 v6, v52, v53
    v_cvt_pk_bf16_f32 v56, v52, v53
    v_cvt_pk_bf16_f32 v57, v54, v55
    v_mov_b32 v59, v18
    v_permlane16_swap_b32 v6, v58
    s_mov_b64 exec, 0xffff
    buffer_store_dwordx4 v[56:59], v3, s[12:15], s68 offen sc1
    s_mov_b64 exec, -1
    s_waitcnt vmcnt(1)
    ds_write_b32 v27, v26
    buffer_load_dwordx4 v[192:195], v109, s[20:23], s93 offen offset:0 nt
    buffer_load_dwordx4 v[196:199], v109, s[20:23], s93 offen offset:256 nt
    s_add_u32 s93, s93, 8192
    buffer_load_dwordx4 v[200:203], v109, s[20:23], s93 offen offset:0 nt
    buffer_load_dwordx4 v[204:207], v109, s[20:23], s93 offen offset:256 nt
    s_add_u32 s93, s93, 8192
    buffer_load_dwordx4 v[208:211], v109, s[20:23], s93 offen offset:0 nt
    buffer_load_dwordx4 v[212:215], v109, s[20:23], s93 offen offset:256 nt
    s_add_u32 s93, s93, 8192
    buffer_load_dwordx4 v[216:219], v109, s[20:23], s93 offen offset:0 nt
    buffer_load_dwordx4 v[220:223], v109, s[20:23], s93 offen offset:256 nt
    v_and_b32 v68, v84, v88
    v_and_b32 v69, v84, v89
    v_and_b32 v70, v84, v90
    v_and_b32 v71, v84, v91
    s_nop 1
    v_mfma_f32_16x16x32_bf16 v[100:103], v[68:71], v[144:147], v[100:103]
    v_mfma_f32_16x16x32_bf16 v[104:107], v[68:71], v[176:179], v[104:107]
    v_and_b32 v72, v85, v88
    v_and_b32 v73, v85, v89
    v_and_b32 v74, v85, v90
    v_and_b32 v75, v85, v91
    s_nop 1
    v_mfma_f32_16x16x32_bf16 v[100:103], v[72:75], v[148:151], v[100:103]
    v_mfma_f32_16x16x32_bf16 v[104:107], v[72:75], v[180:183], v[104:107]
    v_and_b32 v68, v86, v88
    v_and_b32 v69, v86, v89
    v_and_b32 v70, v86, v90
    v_and_b32 v71, v86, v91
    s_nop 1
    v_mfma_f32_16x16x32_bf16 v[100:103], v[68:71], v[152:155], v[100:103]
    v_mfma_f32_16x16x32_bf16 v[104:107], v[68:71], v[184:187], v[104:107]
    v_and_b32 v72, v87, v88
    v_and_b32 v73, v87, v89
    v_and_b32 v74, v87, v90
    v_and_b32 v75, v87, v91
    s_nop 1
    v_mfma_f32_16x16x32_bf16 v[100:103], v[72:75], v[156:159], v[100:103]
    v_mfma_f32_16x16x32_bf16 v[104:107], v[72:75], v[188:191], v[104:107]
    s_nop 7
    v_permlane32_swap_b32 v100, v104
    v_permlane32_swap_b32 v101, v105
    v_permlane32_swap_b32 v102, v106
    v_permlane32_swap_b32 v103, v107
    v_add_f32 v92, v104, v100 row_ror:8 row_mask:0xf bank_mask:0xf
    v_add_f32 v94, v105, v101 row_ror:8 row_mask:0xf bank_mask:0xf
    v_add_f32 v96, v106, v102 row_ror:8 row_mask:0xf bank_mask:0xf
    v_add_f32 v98, v107, v103 row_ror:8 row_mask:0xf bank_mask:0xf
    s_mov_b64 exec, s[66:67]
    buffer_store_dwordx4 v[92:95], v108, s[12:15], s78 offen offset:0 sc1
    buffer_store_dwordx4 v[96:99], v108, s[12:15], s78 offen offset:512 sc1
    s_mov_b64 exec, -1
    s_cmp_ge_u32 s38, 2
    s_cbranch_scc1 L_xw2
    s_waitcnt vmcnt(8)
    s_add_u32 m0, s73, 81920
    s_mov_b32 s3, 1310720
    buffer_load_dwordx4 v110, s[16:19], s3 offen offset:0  lds
    buffer_load_dwordx4 v111, s[16:19], s3 offen offset:1024  lds
    s_add_u32 m0, s73, 86016
    s_add_u32 s3, s3, 65536
    buffer_load_dwordx4 v110, s[16:19], s3 offen offset:0  lds
    buffer_load_dwordx4 v111, s[16:19], s3 offen offset:1024  lds
    s_waitcnt vmcnt(8)
    s_add_u32 m0, s73, 90112
    s_mov_b32 s3, 1441792
    buffer_load_dwordx4 v110, s[16:19], s3 offen offset:0  lds
    buffer_load_dwordx4 v111, s[16:19], s3 offen offset:1024  lds
    s_add_u32 m0, s73, 94208
    s_add_u32 s3, s3, 65536
    buffer_load_dwordx4 v110, s[16:19], s3 offen offset:0  lds
    buffer_load_dwordx4 v111, s[16:19], s3 offen offset:1024  lds
    s_waitcnt vmcnt(8)
    s_add_u32 m0, s73, 98304
    s_mov_b32 s3, 1572864
    buffer_load_dwordx4 v110, s[16:19], s3 offen offset:0  lds
    buffer_load_dwordx4 v111, s[16:19], s3 offen offset:1024  lds
    s_add_u32 m0, s73, 102400
    s_add_u32 s3, s3, 65536
    buffer_load_dwordx4 v110, s[16:19], s3 offen offset:0  lds
    buffer_load_dwordx4 v111, s[16:19], s3 offen offset:1024  lds
    s_waitcnt vmcnt(8)
    s_add_u32 m0, s73, 106496
    s_mov_b32 s3, 1703936
    buffer_load_dwordx4 v110, s[16:19], s3 offen offset:0  lds
    buffer_load_dwordx4 v111, s[16:19], s3 offen offset:1024  lds
    s_add_u32 m0, s73, 110592
    s_add_u32 s3, s3, 65536
    buffer_load_dwordx4 v110, s[16:19], s3 offen offset:0  lds
    buffer_load_dwordx4 v111, s[16:19], s3 offen offset:1024  lds
    v_mov_b32 v4, 141376
L_pe7:
    ds_read_b128 v[224:227], v4 offset:48
    s_waitcnt lgkmcnt(0)
    v_min_u32 v224, v224, v225
    v_min3_u32 v224, v224, v226, v227
    s_nop 0
    v_readfirstlane_b32 s3, v224
    s_nop 0
    s_cmp_lt_u32 s3, 7
    s_cbranch_scc1 L_pe7
    s_waitcnt vmcnt(8)
    s_add_u32 m0, s73, 114688
    s_mov_b32 s3, 1835008
    buffer_load_dwordx4 v110, s[16:19], s3 offen offset:0  lds
    buffer_load_dwordx4 v111, s[16:19], s3 offen offset:1024  lds
    s_add_u32 m0, s73, 118784
    s_add_u32 s3, s3, 65536
    buffer_load_dwordx4 v110, s[16:19], s3 offen offset:0  lds
    buffer_load_dwordx4 v111, s[16:19], s3 offen offset:1024  lds
    s_waitcnt vmcnt(8)
    s_add_u32 m0, s73, 32768
    s_mov_b32 s3, 524288
    buffer_load_dwordx4 v110, s[16:19], s3 offen offset:0  lds
    buffer_load_dwordx4 v111, s[16:19], s3 offen offset:1024  lds
    s_add_u32 m0, s73, 36864
    s_add_u32 s3, s3, 65536
    buffer_load_dwordx4 v110, s[16:19], s3 offen offset:0  lds
    buffer_load_dwordx4 v111, s[16:19], s3 offen offset:1024  lds
    s_waitcnt vmcnt(8)
    s_add_u32 m0, s73, 40960
    s_mov_b32 s3, 655360
    buffer_load_dwordx4 v110, s[16:19], s3 offen offset:0  lds
    buffer_load_dwordx4 v111, s[16:19], s3 offen offset:1024  lds
    s_add_u32 m0, s73, 45056
    s_add_u32 s3, s3, 65536
    buffer_load_dwordx4 v110, s[16:19], s3 offen offset:0  lds
    buffer_load_dwordx4 v111, s[16:19], s3 offen offset:1024  lds
L_pe8:
    ds_read_b128 v[224:227], v4 offset:48
    s_waitcnt lgkmcnt(0)
    v_min_u32 v224, v224, v225
    v_min3_u32 v224, v224, v226, v227
    s_nop 0
    v_readfirstlane_b32 s3, v224
    s_nop 0
    s_cmp_lt_u32 s3, 8
    s_cbranch_scc1 L_pe8
    s_waitcnt vmcnt(8)
    s_add_u32 m0, s73, 122880
    s_mov_b32 s3, 1966080
    buffer_load_dwordx4 v110, s[16:19], s3 offen offset:0  lds
    buffer_load_dwordx4 v111, s[16:19], s3 offen offset:1024  lds
    s_add_u32 m0, s73, 126976
    s_add_u32 s3, s3, 65536
    buffer_load_dwordx4 v110, s[16:19], s3 offen offset:0  lds
    buffer_load_dwordx4 v111, s[16:19], s3 offen offset:1024  lds
    s_waitcnt vmcnt(8)
    s_add_u32 m0, s73, 49152
    s_mov_b32 s3, 786432
    buffer_load_dwordx4 v110, s[16:19], s3 offen offset:0  lds
    buffer_load_dwordx4 v111, s[16:19], s3 offen offset:1024  lds
    s_add_u32 m0, s73, 53248
    s_add_u32 s3, s3, 65536
    buffer_load_dwordx4 v110, s[16:19], s3 offen offset:0  lds
    buffer_load_dwordx4 v111, s[16:19], s3 offen offset:1024  lds
    s_waitcnt vmcnt(8)
    s_add_u32 m0, s73, 57344
    s_mov_b32 s3, 917504
    buffer_load_dwordx4 v110, s[16:19], s3 offen offset:0  lds
    buffer_load_dwordx4 v111, s[16:19], s3 offen offset:1024  lds
    s_add_u32 m0, s73, 61440
    s_add_u32 s3, s3, 65536
    buffer_load_dwordx4 v110, s[16:19], s3 offen offset:0  lds
    buffer_load_dwordx4 v111, s[16:19], s3 offen offset:1024  lds
L_pe9:
    ds_read_b128 v[224:227], v4 offset:48
    s_waitcnt lgkmcnt(0)
    v_min_u32 v224, v224, v225
    v_min3_u32 v224, v224, v226, v227
    s_nop 0
    v_readfirstlane_b32 s3, v224
    s_nop 0
    s_cmp_lt_u32 s3, 9
    s_cbranch_scc1 L_pe9
    s_waitcnt vmcnt(8)
    s_add_u32 m0, s73, 65536
    s_mov_b32 s3, 1048576
    buffer_load_dwordx4 v110, s[16:19], s3 offen offset:0  lds
    buffer_load_dwordx4 v111, s[16:19], s3 offen offset:1024  lds
    s_add_u32 m0, s73, 69632
    s_add_u32 s3, s3, 65536
    buffer_load_dwordx4 v110, s[16:19], s3 offen offset:0  lds
    buffer_load_dwordx4 v111, s[16:19], s3 offen offset:1024  lds
    s_waitcnt vmcnt(8)
    s_add_u32 m0, s73, 0
    s_mov_b32 s3, 0
    buffer_load_dwordx4 v110, s[16:19], s3 offen offset:0  lds
    buffer_load_dwordx4 v111, s[16:19], s3 offen offset:1024  lds
    s_add_u32 m0, s73, 4096
    s_add_u32 s3, s3, 65536
    buffer_load_dwordx4 v110, s[16:19], s3 offen offset:0  lds
    buffer_load_dwordx4 v111, s[16:19], s3 offen offset:1024  lds
    s_waitcnt vmcnt(8)
    s_add_u32 m0, s73, 8192
    s_mov_b32 s3, 131072
    buffer_load_dwordx4 v110, s[16:19], s3 offen offset:0  lds
    buffer_load_dwordx4 v111, s[16:19], s3 offen offset:1024  lds
    s_add_u32 m0, s73, 12288
    s_add_u32 s3, s3, 65536
    buffer_load_dwordx4 v110, s[16:19], s3 offen offset:0  lds
    buffer_load_dwordx4 v111, s[16:19], s3 offen offset:1024  lds
L_pe10:
    ds_read_b128 v[224:227], v4 offset:48
    s_waitcnt lgkmcnt(0)
    v_min_u32 v224, v224, v225
    v_min3_u32 v224, v224, v226, v227
    s_nop 0
    v_readfirstlane_b32 s3, v224
    s_nop 0
    s_cmp_lt_u32 s3, 10
    s_cbranch_scc1 L_pe10
    s_waitcnt vmcnt(8)
    s_add_u32 m0, s73, 73728
    s_mov_b32 s3, 1179648
    buffer_load_dwordx4 v110, s[16:19], s3 offen offset:0  lds
    buffer_load_dwordx4 v111, s[16:19], s3 offen offset:1024  lds
    s_add_u32 m0, s73, 77824
    s_add_u32 s3, s3, 65536
    buffer_load_dwordx4 v110, s[16:19], s3 offen offset:0  lds
    buffer_load_dwordx4 v111, s[16:19], s3 offen offset:1024  lds
    s_waitcnt vmcnt(8)
    s_add_u32 m0, s73, 16384
    s_mov_b32 s3, 262144
    buffer_load_dwordx4 v110, s[16:19], s3 offen offset:0  lds
    buffer_load_dwordx4 v111, s[16:19], s3 offen offset:1024  lds
    s_add_u32 m0, s73, 20480
    s_add_u32 s3, s3, 65536
    buffer_load_dwordx4 v110, s[16:19], s3 offen offset:0  lds
    buffer_load_dwordx4 v111, s[16:19], s3 offen offset:1024  lds
    s_waitcnt vmcnt(8)
    s_add_u32 m0, s73, 24576
    s_mov_b32 s3, 393216
    buffer_load_dwordx4 v110, s[16:19], s3 offen offset:0  lds
    buffer_load_dwordx4 v111, s[16:19], s3 offen offset:1024  lds
    s_add_u32 m0, s73, 28672
    s_add_u32 s3, s3, 65536
    buffer_load_dwordx4 v110, s[16:19], s3 offen offset:0  lds
    buffer_load_dwordx4 v111, s[16:19], s3 offen offset:1024  lds
    s_branch L_join2
L_xw2:
    s_sleep 8
    buffer_load_dwordx4 v[36:39], v3, s[12:15], s69 offen offset:0 sc1
    buffer_load_dwordx4 v[40:43], v3, s[12:15], s69 offen offset:1024 sc1
    buffer_load_dwordx4 v[44:47], v3, s[12:15], s69 offen offset:2048 sc1
    buffer_load_dwordx4 v[48:51], v3, s[12:15], s69 offen offset:3072 sc1
    buffer_load_dwordx4 v[52:55], v3, s[12:15], s71 offen offset:0 sc1
    buffer_load_dwordx4 v[56:59], v3, s[12:15], s71 offen offset:1024 sc1
    buffer_load_dwordx4 v[60:63], v3, s[12:15], s71 offen offset:2048 sc1
    buffer_load_dwordx4 v[64:67], v3, s[12:15], s71 offen offset:3072 sc1
    s_waitcnt vmcnt(0)
L_hb:
    v_and_b32 v6, v39, v43
    v_or_b32 v7, v39, v43
    v_min3_u32 v6, v6, v47, v51
    v_max3_u32 v7, v7, v47, v51
    v_min3_u32 v6, v6, v55, v59
    v_max3_u32 v7, v7, v55, v59
    v_min3_u32 v6, v6, v63, v67
    v_max3_u32 v7, v7, v63, v67
    v_xor_b32 v6, v6, v18
    v_xor_b32 v7, v7, v18
    v_or_b32 v6, v6, v7
    v_cmp_ne_u32 vcc, 0, v6
    s_nop 0
    s_cmp_eq_u64 vcc, 0
    s_cbranch_scc1 L_hbok
    s_add_u32 s70, s70, 1
    s_cmp_ge_u32 s70, 200000
    s_cbranch_scc1 L_hbok
    s_sleep 8
    buffer_load_dwordx4 v[36:39], v3, s[12:15], s69 offen offset:0 sc1
    buffer_load_dwordx4 v[40:43], v3, s[12:15], s69 offen offset:1024 sc1
    buffer_load_dwordx4 v[44:47], v3, s[12:15], s69 offen offset:2048 sc1
    buffer_load_dwordx4 v[48:51], v3, s[12:15], s69 offen offset:3072 sc1
    buffer_load_dwordx4 v[52:55], v3, s[12:15], s71 offen offset:0 sc1
    buffer_load_dwordx4 v[56:59], v3, s[12:15], s71 offen offset:1024 sc1
    buffer_load_dwordx4 v[60:63], v3, s[12:15], s71 offen offset:2048 sc1
    buffer_load_dwordx4 v[64:67], v3, s[12:15], s71 offen offset:3072 sc1
    s_waitcnt vmcnt(0)
    s_branch L_hb
L_hbok:
    ds_write_b64 v30, v[36:37] offset:0
    ds_write_b64 v30, v[40:41] offset:8
    ds_write_b64 v30, v[44:45] offset:1024
    ds_write_b64 v30, v[48:49] offset:1032
    ds_write_b64 v30, v[52:53] offset:2048
    ds_write_b64 v30, v[56:57] offset:2056
    ds_write_b64 v30, v[60:61] offset:3072
    ds_write_b64 v30, v[64:65] offset:3080
    ds_write_b32 v31, v38 offset:0
    ds_write_b32 v31, v42 offset:32
    ds_write_b32 v31, v46 offset:4
    ds_write_b32 v31, v50 offset:36
    ds_write_b32 v31, v54 offset:64
    ds_write_b32 v31, v58 offset:96
    ds_write_b32 v31, v62 offset:68
    ds_write_b32 v31, v66 offset:100
    s_lshl_b32 s3, s38, 2
    s_add_u32 s3, s3, 141368
    v_mov_b32 v5, s3
    v_mov_b32 v6, 1
    ds_write_b32 v5, v6
L_join2:
    v_lshrrev_b32 v5, 2, v1
    v_lshlrev_b32 v5, 10, v5
    v_and_b32 v6, 3, v1
    v_lshl_add_u32 v5, v6, 4, v5
    s_lshr_b32 s3, s2, 2
    s_lshl_b32 s3, s3, 14
    s_and_b32 s65, s2, 3
    s_lshl_b32 s65, s65, 6
    s_add_u32 s3, s3, s65
    s_add_u32 s3, s3, 6291456
    buffer_load_dwordx4 v[52:55], v5, s[12:15], s3 offen offset:0 sc1
    buffer_load_dwordx4 v[56:59], v5, s[12:15], s3 offen offset:512 sc1
    buffer_load_dwordx4 v[60:63], v5, s[12:15], s3 offen offset:256 sc1
    buffer_load_dwordx4 v[64:67], v5, s[12:15], s3 offen offset:768 sc1
    s_waitcnt vmcnt(4)
    s_cmp_ge_u32 s38, 2
    s_cbranch_scc1 L_nwf
    s_lshl_b32 s3, s38, 2
    s_add_u32 s3, s3, 141384
    v_mov_b32 v5, s3
    v_mov_b32 v6, 1
    ds_write_b32 v5, v6
L_nwf:
    s_waitcnt vmcnt(0)
L_gu:
    v_xor_b32 v6, v53, v18
    v_xor_b32 v7, v55, v18
    v_or_b32 v6, v6, v7
    v_xor_b32 v7, v57, v18
    v_or_b32 v6, v6, v7
    v_xor_b32 v7, v59, v18
    v_or_b32 v6, v6, v7
    v_xor_b32 v7, v61, v18
    v_or_b32 v6, v6, v7
    v_xor_b32 v7, v63, v18
    v_or_b32 v6, v6, v7
    v_xor_b32 v7, v65, v18
    v_or_b32 v6, v6, v7
    v_xor_b32 v7, v67, v18
    v_or_b32 v6, v6, v7
    v_cmp_ne_u32 vcc, 0, v6
    s_nop 0
    s_cmp_eq_u64 vcc, 0
    s_cbranch_scc1 L_guok
    s_add_u32 s70, s70, 1
    s_cmp_ge_u32 s70, 200000
    s_cbranch_scc1 L_guok
    s_sleep 8
    v_lshrrev_b32 v5, 2, v1
    v_lshlrev_b32 v5, 10, v5
    v_and_b32 v6, 3, v1
    v_lshl_add_u32 v5, v6, 4, v5
    s_lshr_b32 s3, s2, 2
    s_lshl_b32 s3, s3, 14
    s_and_b32 s65, s2, 3
    s_lshl_b32 s65, s65, 6
    s_add_u32 s3, s3, s65
    s_add_u32 s3, s3, 6291456
    buffer_load_dwordx4 v[52:55], v5, s[12:15], s3 offen offset:0 sc1
    buffer_load_dwordx4 v[56:59], v5, s[12:15], s3 offen offset:512 sc1
    buffer_load_dwordx4 v[60:63], v5, s[12:15], s3 offen offset:256 sc1
    buffer_load_dwordx4 v[64:67], v5, s[12:15], s3 offen offset:768 sc1
    s_waitcnt vmcnt(0)
    s_branch L_gu
L_guok:
    v_permlane32_swap_b32 v52, v56
    v_permlane32_swap_b32 v54, v58
    v_permlane32_swap_b32 v60, v64
    v_permlane32_swap_b32 v62, v66
    v_add_f32 v52, v52, v56
    v_add_f32 v54, v54, v58
    v_add_f32 v60, v60, v64
    v_add_f32 v62, v62, v66
    v_permlane16_swap_b32 v52, v54
    s_nop 0
    v_permlane16_swap_b32 v60, v62
    v_add_f32 v52, v52, v54
    v_add_f32 v60, v60, v62
    s_nop 0
    v_add_f32 v52, v52, v52 row_ror:4 row_mask:0xf bank_mask:0xf
    v_add_f32 v60, v60, v60 row_ror:4 row_mask:0xf bank_mask:0xf
    s_nop 0
    v_add_f32 v52, v52, v52 row_ror:8 row_mask:0xf bank_mask:0xf
    v_add_f32 v60, v60, v60 row_ror:8 row_mask:0xf bank_mask:0xf
    v_cvt_pk_bf16_f32 v52, v52, v52
    v_lshlrev_b32 v52, 16, v52
    v_cvt_pk_bf16_f32 v60, v60, v60
    v_lshlrev_b32 v60, 16, v60
    v_mul_f32 v53, 0xbfb8aa3b, v52
    v_exp_f32 v53, v53
    s_nop 0
    v_add_f32 v53, 1.0, v53
    v_rcp_f32 v53, v53
    s_nop 0
    v_mul_f32 v52, v52, v53
    v_cvt_pk_bf16_f32 v52, v52, v52
    v_lshlrev_b32 v52, 16, v52
    v_mul_f32 v52, v52, v60
    v_cvt_pk_bf16_f32 v52, v52, v52
    s_nop 1
    v_mov_b32 v80, v52 quad_perm:[0,0,0,0] row_mask:0xf bank_mask:0xf
    v_mov_b32 v81, v52 quad_perm:[1,1,1,1] row_mask:0xf bank_mask:0xf
    v_mov_b32 v82, v52 quad_perm:[2,2,2,2] row_mask:0xf bank_mask:0xf
    v_mov_b32 v83, v52 quad_perm:[3,3,3,3] row_mask:0xf bank_mask:0xf
    s_waitcnt lgkmcnt(0)
    v_and_b32 v92, v80, v88
    v_and_b32 v93, v80, v89
    v_and_b32 v94, v80, v90
    v_and_b32 v95, v80, v91
    s_nop 1
    v_mfma_f32_16x16x32_bf16 v[100:103], v[92:95], v[192:195], 0
    v_mfma_f32_16x16x32_bf16 v[104:107], v[92:95], v[196:199], 0
    v_and_b32 v96, v81, v88
    v_and_b32 v97, v81, v89
    v_and_b32 v98, v81, v90
    v_and_b32 v99, v81, v91
    s_nop 1
    v_mfma_f32_16x16x32_bf16 v[100:103], v[96:99], v[200:203], v[100:103]
    v_mfma_f32_16x16x32_bf16 v[104:107], v[96:99], v[204:207], v[104:107]
    v_and_b32 v92, v82, v88
    v_and_b32 v93, v82, v89
    v_and_b32 v94, v82, v90
    v_and_b32 v95, v82, v91
    s_nop 1
    v_mfma_f32_16x16x32_bf16 v[100:103], v[92:95], v[208:211], v[100:103]
    v_mfma_f32_16x16x32_bf16 v[104:107], v[92:95], v[212:215], v[104:107]
    v_and_b32 v96, v83, v88
    v_and_b32 v97, v83, v89
    v_and_b32 v98, v83, v90
    v_and_b32 v99, v83, v91
    s_nop 1
    v_mfma_f32_16x16x32_bf16 v[100:103], v[96:99], v[216:219], v[100:103]
    v_mfma_f32_16x16x32_bf16 v[104:107], v[96:99], v[220:223], v[104:107]
    v_and_b32 v5, 15, v1
    v_lshlrev_b32 v5, 5, v5
    v_bfe_u32 v6, v1, 4, 1
    v_lshl_add_u32 v5, v6, 4, v5
    v_lshrrev_b32 v6, 5, v1
    v_lshl_add_u32 v5, v6, 9, v5
    v_cmp_eq_u32 vcc, 0, v6
    s_lshl_b32 s3, s2, 12
    s_lshl_b32 s65, s38, 10
    s_add_u32 s3, s3, s65
    s_add_u32 s3, s3, 8388608
    v_cndmask_b32 v100, v104, v100, vcc
    v_cndmask_b32 v101, v105, v101, vcc
    v_cndmask_b32 v102, v106, v102, vcc
    v_cndmask_b32 v103, v107, v103, vcc
    v_mov_b32 v28, v18
    v_lshrrev_b32 v29, 8, v18
    v_lshrrev_b32 v30, 16, v18
    v_lshrrev_b32 v31, 24, v18
    v_mov_b32 v6, 0xff
    v_bfi_b32 v100, v6, v28, v100
    v_bfi_b32 v101, v6, v29, v101
    v_bfi_b32 v102, v6, v30, v102
    v_bfi_b32 v103, v6, v31, v103
    s_cmp_ge_u32 s2, 224
    s_cbranch_scc1 L_noy
    buffer_store_dwordx4 v[100:103], v5, s[12:15], s3 offen sc1
L_noy:
    s_lshl_b32 s3, s38, 7
    s_add_u32 s3, s3, 139520
    v_lshl_add_u32 v6, v249, 2, s3
    ds_read_b32 v112, v6 offset:0
    ds_read_b32 v120, v6 offset:512
    ds_read_b32 v114, v6 offset:32
    ds_read_b32 v122, v6 offset:544
    ds_read_b32 v116, v6 offset:64
    ds_read_b32 v124, v6 offset:576
    ds_read_b32 v118, v6 offset:96
    ds_read_b32 v126, v6 offset:608
    s_mul_i32 s3, s38, 4608
    s_add_u32 s3, s3, 142592
    v_mul_u32_u24 v6, 144, v249
    v_lshl_add_u32 v6, v250, 4, v6
    v_add_u32 v15, s3, v6
    s_mov_b32 s71, 0xbfb8aa3b
    s_waitcnt lgkmcnt(0)
    v_lshlrev_b32 v36, 16, v232
    v_and_b32 v37, 0xffff0000, v232
    v_lshlrev_b32 v38, 16, v233
    v_and_b32 v39, 0xffff0000, v233
    v_lshlrev_b32 v40, 16, v234
    v_and_b32 v41, 0xffff0000, v234
    v_lshlrev_b32 v42, 16, v235
    v_and_b32 v43, 0xffff0000, v235
    v_lshlrev_b32 v44, 16, v236
    v_and_b32 v45, 0xffff0000, v236
    v_lshlrev_b32 v46, 16, v237
    v_and_b32 v47, 0xffff0000, v237
    v_lshlrev_b32 v48, 16, v238
    v_and_b32 v49, 0xffff0000, v238
    v_lshlrev_b32 v50, 16, v239
    v_and_b32 v51, 0xffff0000, v239
    v_lshlrev_b32 v52, 16, v240
    v_and_b32 v53, 0xffff0000, v240
    v_lshlrev_b32 v54, 16, v241
    v_and_b32 v55, 0xffff0000, v241
    v_lshlrev_b32 v56, 16, v242
    v_and_b32 v57, 0xffff0000, v242
    v_lshlrev_b32 v58, 16, v243
    v_and_b32 v59, 0xffff0000, v243
    v_lshlrev_b32 v60, 16, v244
    v_and_b32 v61, 0xffff0000, v244
    v_lshlrev_b32 v62, 16, v245
    v_and_b32 v63, 0xffff0000, v245
    v_lshlrev_b32 v64, 16, v246
    v_and_b32 v65, 0xffff0000, v246
    v_lshlrev_b32 v66, 16, v247
    v_and_b32 v67, 0xffff0000, v247
    v_pk_add_f32 v[68:69], v[36:37], v[112:113] op_sel_hi:[1,0] neg_lo:[0,1] neg_hi:[0,1]
    v_pk_add_f32 v[70:71], v[38:39], v[112:113] op_sel_hi:[1,0] neg_lo:[0,1] neg_hi:[0,1]
    v_pk_add_f32 v[72:73], v[40:41], v[112:113] op_sel_hi:[1,0] neg_lo:[0,1] neg_hi:[0,1]
    v_pk_add_f32 v[74:75], v[42:43], v[112:113] op_sel_hi:[1,0] neg_lo:[0,1] neg_hi:[0,1]
    v_pk_add_f32 v[76:77], v[44:45], v[114:115] op_sel_hi:[1,0] neg_lo:[0,1] neg_hi:[0,1]
    v_pk_add_f32 v[78:79], v[46:47], v[114:115] op_sel_hi:[1,0] neg_lo:[0,1] neg_hi:[0,1]
    v_pk_add_f32 v[80:81], v[48:49], v[114:115] op_sel_hi:[1,0] neg_lo:[0,1] neg_hi:[0,1]
    v_pk_add_f32 v[82:83], v[50:51], v[114:115] op_sel_hi:[1,0] neg_lo:[0,1] neg_hi:[0,1]
    v_pk_add_f32 v[84:85], v[52:53], v[116:117] op_sel_hi:[1,0] neg_lo:[0,1] neg_hi:[0,1]
    v_pk_add_f32 v[86:87], v[54:55], v[116:117] op_sel_hi:[1,0] neg_lo:[0,1] neg_hi:[0,1]
    v_pk_add_f32 v[88:89], v[56:57], v[116:117] op_sel_hi:[1,0] neg_lo:[0,1] neg_hi:[0,1]
    v_pk_add_f32 v[90:91], v[58:59], v[116:117] op_sel_hi:[1,0] neg_lo:[0,1] neg_hi:[0,1]
    v_pk_add_f32 v[92:93], v[60:61], v[118:119] op_sel_hi:[1,0] neg_lo:[0,1] neg_hi:[0,1]
    v_pk_add_f32 v[94:95], v[62:63], v[118:119] op_sel_hi:[1,0] neg_lo:[0,1] neg_hi:[0,1]
    v_pk_add_f32 v[96:97], v[64:65], v[118:119] op_sel_hi:[1,0] neg_lo:[0,1] neg_hi:[0,1]
    v_pk_add_f32 v[98:99], v[66:67], v[118:119] op_sel_hi:[1,0] neg_lo:[0,1] neg_hi:[0,1]
    v_cvt_pk_bf16_f32 v192, v68, v69
    v_cvt_pk_bf16_f32 v193, v70, v71
    v_cvt_pk_bf16_f32 v194, v72, v73
    v_cvt_pk_bf16_f32 v195, v74, v75
    v_cvt_pk_bf16_f32 v196, v76, v77
    v_cvt_pk_bf16_f32 v197, v78, v79
    v_cvt_pk_bf16_f32 v198, v80, v81
    v_cvt_pk_bf16_f32 v199, v82, v83
    v_cvt_pk_bf16_f32 v200, v84, v85
    v_cvt_pk_bf16_f32 v201, v86, v87
    v_cvt_pk_bf16_f32 v202, v88, v89
    v_cvt_pk_bf16_f32 v203, v90, v91
    v_cvt_pk_bf16_f32 v204, v92, v93
    v_cvt_pk_bf16_f32 v205, v94, v95
    v_cvt_pk_bf16_f32 v206, v96, v97
    v_cvt_pk_bf16_f32 v207, v98, v99
    v_lshlrev_b32 v68, 16, v192
    v_and_b32 v69, 0xffff0000, v192
    v_lshlrev_b32 v70, 16, v193
    v_and_b32 v71, 0xffff0000, v193
    v_lshlrev_b32 v72, 16, v194
    v_and_b32 v73, 0xffff0000, v194
    v_lshlrev_b32 v74, 16, v195
    v_and_b32 v75, 0xffff0000, v195
    v_lshlrev_b32 v76, 16, v196
    v_and_b32 v77, 0xffff0000, v196
    v_lshlrev_b32 v78, 16, v197
    v_and_b32 v79, 0xffff0000, v197
    v_lshlrev_b32 v80, 16, v198
    v_and_b32 v81, 0xffff0000, v198
    v_lshlrev_b32 v82, 16, v199
    v_and_b32 v83, 0xffff0000, v199
    v_lshlrev_b32 v84, 16, v200
    v_and_b32 v85, 0xffff0000, v200
    v_lshlrev_b32 v86, 16, v201
    v_and_b32 v87, 0xffff0000, v201
    v_lshlrev_b32 v88, 16, v202
    v_and_b32 v89, 0xffff0000, v202
    v_lshlrev_b32 v90, 16, v203
    v_and_b32 v91, 0xffff0000, v203
    v_lshlrev_b32 v92, 16, v204
    v_and_b32 v93, 0xffff0000, v204
    v_lshlrev_b32 v94, 16, v205
    v_and_b32 v95, 0xffff0000, v205
    v_lshlrev_b32 v96, 16, v206
    v_and_b32 v97, 0xffff0000, v206
    v_lshlrev_b32 v98, 16, v207
    v_and_b32 v99, 0xffff0000, v207
    v_pk_mul_f32 v[68:69], v[68:69], v[120:121] op_sel_hi:[1,0]
    v_pk_mul_f32 v[70:71], v[70:71], v[120:121] op_sel_hi:[1,0]
    v_pk_mul_f32 v[72:73], v[72:73], v[120:121] op_sel_hi:[1,0]
    v_pk_mul_f32 v[74:75], v[74:75], v[120:121] op_sel_hi:[1,0]
    v_pk_mul_f32 v[76:77], v[76:77], v[122:123] op_sel_hi:[1,0]
    v_pk_mul_f32 v[78:79], v[78:79], v[122:123] op_sel_hi:[1,0]
    v_pk_mul_f32 v[80:81], v[80:81], v[122:123] op_sel_hi:[1,0]
    v_pk_mul_f32 v[82:83], v[82:83], v[122:123] op_sel_hi:[1,0]
    v_pk_mul_f32 v[84:85], v[84:85], v[124:125] op_sel_hi:[1,0]
    v_pk_mul_f32 v[86:87], v[86:87], v[124:125] op_sel_hi:[1,0]
    v_pk_mul_f32 v[88:89], v[88:89], v[124:125] op_sel_hi:[1,0]
    v_pk_mul_f32 v[90:91], v[90:91], v[124:125] op_sel_hi:[1,0]
    v_pk_mul_f32 v[92:93], v[92:93], v[126:127] op_sel_hi:[1,0]
    v_pk_mul_f32 v[94:95], v[94:95], v[126:127] op_sel_hi:[1,0]
    v_pk_mul_f32 v[96:97], v[96:97], v[126:127] op_sel_hi:[1,0]
    v_pk_mul_f32 v[98:99], v[98:99], v[126:127] op_sel_hi:[1,0]
    v_cvt_pk_bf16_f32 v192, v68, v69
    v_cvt_pk_bf16_f32 v193, v70, v71
    v_cvt_pk_bf16_f32 v194, v72, v73
    v_cvt_pk_bf16_f32 v195, v74, v75
    v_cvt_pk_bf16_f32 v196, v76, v77
    v_cvt_pk_bf16_f32 v197, v78, v79
    v_cvt_pk_bf16_f32 v198, v80, v81
    v_cvt_pk_bf16_f32 v199, v82, v83
    v_cvt_pk_bf16_f32 v200, v84, v85
    v_cvt_pk_bf16_f32 v201, v86, v87
    v_cvt_pk_bf16_f32 v202, v88, v89
    v_cvt_pk_bf16_f32 v203, v90, v91
    v_cvt_pk_bf16_f32 v204, v92, v93
    v_cvt_pk_bf16_f32 v205, v94, v95
    v_cvt_pk_bf16_f32 v206, v96, v97
    v_cvt_pk_bf16_f32 v207, v98, v99
    v_lshlrev_b32 v68, 16, v192
    v_and_b32 v69, 0xffff0000, v192
    v_lshlrev_b32 v70, 16, v193
    v_and_b32 v71, 0xffff0000, v193
    v_lshlrev_b32 v72, 16, v194
    v_and_b32 v73, 0xffff0000, v194
    v_lshlrev_b32 v74, 16, v195
    v_and_b32 v75, 0xffff0000, v195
    v_lshlrev_b32 v76, 16, v196
    v_and_b32 v77, 0xffff0000, v196
    v_lshlrev_b32 v78, 16, v197
    v_and_b32 v79, 0xffff0000, v197
    v_lshlrev_b32 v80, 16, v198
    v_and_b32 v81, 0xffff0000, v198
    v_lshlrev_b32 v82, 16, v199
    v_and_b32 v83, 0xffff0000, v199
    v_lshlrev_b32 v84, 16, v200
    v_and_b32 v85, 0xffff0000, v200
    v_lshlrev_b32 v86, 16, v201
    v_and_b32 v87, 0xffff0000, v201
    v_lshlrev_b32 v88, 16, v202
    v_and_b32 v89, 0xffff0000, v202
    v_lshlrev_b32 v90, 16, v203
    v_and_b32 v91, 0xffff0000, v203
    v_lshlrev_b32 v92, 16, v204
    v_and_b32 v93, 0xffff0000, v204
    v_lshlrev_b32 v94, 16, v205
    v_and_b32 v95, 0xffff0000, v205
    v_lshlrev_b32 v96, 16, v206
    v_and_b32 v97, 0xffff0000, v206
    v_lshlrev_b32 v98, 16, v207
    v_and_b32 v99, 0xffff0000, v207
    v_mul_f32 v192, s71, v68
    v_mul_f32 v193, s71, v69
    v_mul_f32 v194, s71, v70
    v_mul_f32 v195, s71, v71
    v_mul_f32 v196, s71, v72
    v_mul_f32 v197, s71, v73
    v_mul_f32 v198, s71, v74
    v_mul_f32 v199, s71, v75
    v_mul_f32 v200, s71, v76
    v_mul_f32 v201, s71, v77
    v_mul_f32 v202, s71, v78
    v_mul_f32 v203, s71, v79
    v_mul_f32 v204, s71, v80
    v_mul_f32 v205, s71, v81
    v_mul_f32 v206, s71, v82
    v_mul_f32 v207, s71, v83
    v_mul_f32 v208, s71, v84
    v_mul_f32 v209, s71, v85
    v_mul_f32 v210, s71, v86
    v_mul_f32 v211, s71, v87
    v_mul_f32 v212, s71, v88
    v_mul_f32 v213, s71, v89
    v_mul_f32 v214, s71, v90
    v_mul_f32 v215, s71, v91
    v_mul_f32 v216, s71, v92
    v_mul_f32 v217, s71, v93
    v_mul_f32 v218, s71, v94
    v_mul_f32 v219, s71, v95
    v_mul_f32 v220, s71, v96
    v_mul_f32 v221, s71, v97
    v_mul_f32 v222, s71, v98
    v_mul_f32 v223, s71, v99
    v_exp_f32 v192, v192
    v_exp_f32 v193, v193
    v_exp_f32 v194, v194
    v_exp_f32 v195, v195
    v_exp_f32 v196, v196
    v_exp_f32 v197, v197
    v_exp_f32 v198, v198
    v_exp_f32 v199, v199
    v_exp_f32 v200, v200
    v_exp_f32 v201, v201
    v_exp_f32 v202, v202
    v_exp_f32 v203, v203
    v_exp_f32 v204, v204
    v_exp_f32 v205, v205
    v_exp_f32 v206, v206
    v_exp_f32 v207, v207
    v_exp_f32 v208, v208
    v_exp_f32 v209, v209
    v_exp_f32 v210, v210
    v_exp_f32 v211, v211
    v_exp_f32 v212, v212
    v_exp_f32 v213, v213
    v_exp_f32 v214, v214
    v_exp_f32 v215, v215
    v_exp_f32 v216, v216
    v_exp_f32 v217, v217
    v_exp_f32 v218, v218
    v_exp_f32 v219, v219
    v_exp_f32 v220, v220
    v_exp_f32 v221, v221
    v_exp_f32 v222, v222
    v_exp_f32 v223, v223
    v_add_f32 v192, 1.0, v192
    v_add_f32 v193, 1.0, v193
    v_add_f32 v194, 1.0, v194
    v_add_f32 v195, 1.0, v195
    v_add_f32 v196, 1.0, v196
    v_add_f32 v197, 1.0, v197
    v_add_f32 v198, 1.0, v198
    v_add_f32 v199, 1.0, v199
    v_add_f32 v200, 1.0, v200
    v_add_f32 v201, 1.0, v201
    v_add_f32 v202, 1.0, v202
    v_add_f32 v203, 1.0, v203
    v_add_f32 v204, 1.0, v204
    v_add_f32 v205, 1.0, v205
    v_add_f32 v206, 1.0, v206
    v_add_f32 v207, 1.0, v207
    v_add_f32 v208, 1.0, v208
    v_add_f32 v209, 1.0, v209
    v_add_f32 v210, 1.0, v210
    v_add_f32 v211, 1.0, v211
    v_add_f32 v212, 1.0, v212
    v_add_f32 v213, 1.0, v213
    v_add_f32 v214, 1.0, v214
    v_add_f32 v215, 1.0, v215
    v_add_f32 v216, 1.0, v216
    v_add_f32 v217, 1.0, v217
    v_add_f32 v218, 1.0, v218
    v_add_f32 v219, 1.0, v219
    v_add_f32 v220, 1.0, v220
    v_add_f32 v221, 1.0, v221
    v_add_f32 v222, 1.0, v222
    v_add_f32 v223, 1.0, v223
    v_rcp_f32 v192, v192
    v_rcp_f32 v193, v193
    v_rcp_f32 v194, v194
    v_rcp_f32 v195, v195
    v_rcp_f32 v196, v196
    v_rcp_f32 v197, v197
    v_rcp_f32 v198, v198
    v_rcp_f32 v199, v199
    v_rcp_f32 v200, v200
    v_rcp_f32 v201, v201
    v_rcp_f32 v202, v202
    v_rcp_f32 v203, v203
    v_rcp_f32 v204, v204
    v_rcp_f32 v205, v205
    v_rcp_f32 v206, v206
    v_rcp_f32 v207, v207
    v_rcp_f32 v208, v208
    v_rcp_f32 v209, v209
    v_rcp_f32 v210, v210
    v_rcp_f32 v211, v211
    v_rcp_f32 v212, v212
    v_rcp_f32 v213, v213
    v_rcp_f32 v214, v214
    v_rcp_f32 v215, v215
    v_rcp_f32 v216, v216
    v_rcp_f32 v217, v217
    v_rcp_f32 v218, v218
    v_rcp_f32 v219, v219
    v_rcp_f32 v220, v220
    v_rcp_f32 v221, v221
    v_rcp_f32 v222, v222
    v_rcp_f32 v223, v223
    v_pk_mul_f32 v[68:69], v[68:69], v[192:193]
    v_pk_mul_f32 v[70:71], v[70:71], v[194:195]
    v_pk_mul_f32 v[72:73], v[72:73], v[196:197]
    v_pk_mul_f32 v[74:75], v[74:75], v[198:199]
    v_pk_mul_f32 v[76:77], v[76:77], v[200:201]
    v_pk_mul_f32 v[78:79], v[78:79], v[202:203]
    v_pk_mul_f32 v[80:81], v[80:81], v[204:205]
    v_pk_mul_f32 v[82:83], v[82:83], v[206:207]
    v_pk_mul_f32 v[84:85], v[84:85], v[208:209]
    v_pk_mul_f32 v[86:87], v[86:87], v[210:211]
    v_pk_mul_f32 v[88:89], v[88:89], v[212:213]
    v_pk_mul_f32 v[90:91], v[90:91], v[214:215]
    v_pk_mul_f32 v[92:93], v[92:93], v[216:217]
    v_pk_mul_f32 v[94:95], v[94:95], v[218:219]
    v_pk_mul_f32 v[96:97], v[96:97], v[220:221]
    v_pk_mul_f32 v[98:99], v[98:99], v[222:223]
    s_cmp_eq_u32 s35, 0
    s_cbranch_scc1 L_fin
    s_lshl_b32 s65, s38, 2
    v_lshrrev_b32 v5, 4, v1
    v_add_u32 v5, s65, v5
    v_lshlrev_b32 v5, 12, v5
    v_and_b32 v6, 15, v1
    v_lshl_add_u32 v11, v6, 4, v5
    v_mov_b32 v5, 141376
L_yg:
    ds_read_b32 v6, v5 offset:100
    s_waitcnt lgkmcnt(0)
    v_readfirstlane_b32 s3, v6
    s_nop 0
    s_cmp_eq_u32 s3, 1
    s_cbranch_scc1 L_ygd
    s_sleep 2
    s_branch L_yg
L_ygd:
    s_lshl_b32 s3, s31, 8
    s_add_u32 s3, s3, 8388608
    buffer_load_dwordx4 v[128:131], v11, s[12:15], s3 offen sc1
    s_add_u32 s3, s3, 65536
    buffer_load_dwordx4 v[132:135], v11, s[12:15], s3 offen sc1
    s_add_u32 s3, s3, 65536
    buffer_load_dwordx4 v[136:139], v11, s[12:15], s3 offen sc1
    s_add_u32 s3, s3, 65536
    buffer_load_dwordx4 v[140:143], v11, s[12:15], s3 offen sc1
    s_add_u32 s3, s3, 65536
    buffer_load_dwordx4 v[144:147], v11, s[12:15], s3 offen sc1
    s_add_u32 s3, s3, 65536
    buffer_load_dwordx4 v[148:151], v11, s[12:15], s3 offen sc1
    s_add_u32 s3, s3, 65536
    buffer_load_dwordx4 v[152:155], v11, s[12:15], s3 offen sc1
    s_add_u32 s3, s3, 65536
    buffer_load_dwordx4 v[156:159], v11, s[12:15], s3 offen sc1
    s_add_u32 s3, s3, 65536
    buffer_load_dwordx4 v[160:163], v11, s[12:15], s3 offen sc1
    s_add_u32 s3, s3, 65536
    buffer_load_dwordx4 v[164:167], v11, s[12:15], s3 offen sc1
    s_add_u32 s3, s3, 65536
    buffer_load_dwordx4 v[168:171], v11, s[12:15], s3 offen sc1
    s_add_u32 s3, s3, 65536
    buffer_load_dwordx4 v[172:175], v11, s[12:15], s3 offen sc1
    s_add_u32 s3, s3, 65536
    buffer_load_dwordx4 v[176:179], v11, s[12:15], s3 offen sc1
    s_add_u32 s3, s3, 65536
    buffer_load_dwordx4 v[180:183], v11, s[12:15], s3 offen sc1
    s_lshl_b32 s68, s34, 11
    s_lshl_b32 s3, s31, 7
    s_add_u32 s68, s68, s3
    v_lshlrev_b32 v7, 1, v1
    buffer_load_ushort v8, v7, s[4:7], s68 offen
    s_and_b32 s3, s33, 0xfffff800
    s_xor_b32 s65, s3, 0x80000000
    s_not_b32 s66, s3
    s_and_b32 s66, s66, 0xfffff800
    s_bitcmp1_b32 s3, 31
    s_cselect_b32 s3, s65, s66
    v_mov_b32 v5, s3
    v_cvt_pk_bf16_f32 v5, v5, v5
    v_lshlrev_b32 v5, 16, v5
    v_mul_f32 v5, 0xbfb8aa3b, v5
    v_exp_f32 v5, v5
    s_nop 0
    v_add_f32 v5, 1.0, v5
    v_rcp_f32 v5, v5
    s_nop 0
    v_cvt_pk_bf16_f32 v5, v5, v5
    v_lshlrev_b32 v5, 16, v5
    s_lshl_b32 s65, s64, 16
    s_and_b32 s66, s64, 0xffff0000
    v_rcp_f32 v10, s66
    s_nop 0
    v_fma_f32 v4, -v10, s66, 1.0
    v_fmac_f32 v10, v4, v10
    s_waitcnt vmcnt(0)
L_yf:
    v_and_b32 v184, v128, v132
    v_or_b32 v188, v128, v132
    v_and_b32 v185, v129, v133
    v_or_b32 v189, v129, v133
    v_and_b32 v186, v130, v134
    v_or_b32 v190, v130, v134
    v_and_b32 v187, v131, v135
    v_or_b32 v191, v131, v135
    v_bitop3_b32 v184, v184, v136, v140 bitop3:0x80
    v_or3_b32 v188, v188, v136, v140
    v_bitop3_b32 v185, v185, v137, v141 bitop3:0x80
    v_or3_b32 v189, v189, v137, v141
    v_bitop3_b32 v186, v186, v138, v142 bitop3:0x80
    v_or3_b32 v190, v190, v138, v142
    v_bitop3_b32 v187, v187, v139, v143 bitop3:0x80
    v_or3_b32 v191, v191, v139, v143
    v_bitop3_b32 v184, v184, v144, v148 bitop3:0x80
    v_or3_b32 v188, v188, v144, v148
    v_bitop3_b32 v185, v185, v145, v149 bitop3:0x80
    v_or3_b32 v189, v189, v145, v149
    v_bitop3_b32 v186, v186, v146, v150 bitop3:0x80
    v_or3_b32 v190, v190, v146, v150
    v_bitop3_b32 v187, v187, v147, v151 bitop3:0x80
    v_or3_b32 v191, v191, v147, v151
    v_bitop3_b32 v184, v184, v152, v156 bitop3:0x80
    v_or3_b32 v188, v188, v152, v156
    v_bitop3_b32 v185, v185, v153, v157 bitop3:0x80
    v_or3_b32 v189, v189, v153, v157
    v_bitop3_b32 v186, v186, v154, v158 bitop3:0x80
    v_or3_b32 v190, v190, v154, v158
    v_bitop3_b32 v187, v187, v155, v159 bitop3:0x80
    v_or3_b32 v191, v191, v155, v159
    v_bitop3_b32 v184, v184, v160, v164 bitop3:0x80
    v_or3_b32 v188, v188, v160, v164
    v_bitop3_b32 v185, v185, v161, v165 bitop3:0x80
    v_or3_b32 v189, v189, v161, v165
    v_bitop3_b32 v186, v186, v162, v166 bitop3:0x80
    v_or3_b32 v190, v190, v162, v166
    v_bitop3_b32 v187, v187, v163, v167 bitop3:0x80
    v_or3_b32 v191, v191, v163, v167
    v_bitop3_b32 v184, v184, v168, v172 bitop3:0x80
    v_or3_b32 v188, v188, v168, v172
    v_bitop3_b32 v185, v185, v169, v173 bitop3:0x80
    v_or3_b32 v189, v189, v169, v173
    v_bitop3_b32 v186, v186, v170, v174 bitop3:0x80
    v_or3_b32 v190, v190, v170, v174
    v_bitop3_b32 v187, v187, v171, v175 bitop3:0x80
    v_or3_b32 v191, v191, v171, v175
    v_bitop3_b32 v184, v184, v176, v180 bitop3:0x80
    v_or3_b32 v188, v188, v176, v180
    v_bitop3_b32 v185, v185, v177, v181 bitop3:0x80
    v_or3_b32 v189, v189, v177, v181
    v_bitop3_b32 v186, v186, v178, v182 bitop3:0x80
    v_or3_b32 v190, v190, v178, v182
    v_bitop3_b32 v187, v187, v179, v183 bitop3:0x80
    v_or3_b32 v191, v191, v179, v183
    v_xor_b32 v184, v184, v28
    v_xor_b32 v188, v188, v28
    v_xor_b32 v185, v185, v29
    v_xor_b32 v189, v189, v29
    v_xor_b32 v186, v186, v30
    v_xor_b32 v190, v190, v30
    v_xor_b32 v187, v187, v31
    v_xor_b32 v191, v191, v31
    v_or3_b32 v6, v184, v185, v186
    v_or3_b32 v6, v6, v187, v188
    v_or3_b32 v6, v6, v189, v190
    v_or_b32 v6, v6, v191
    v_and_b32 v6, 0xff, v6
    v_cmp_ne_u32 vcc, 0, v6
    s_nop 0
    s_cmp_eq_u64 vcc, 0
    s_cbranch_scc1 L_yfok
    s_add_u32 s70, s70, 1
    s_cmp_ge_u32 s70, 200000
    s_cbranch_scc1 L_yfok
    s_sleep 16
    s_lshl_b32 s3, s31, 8
    s_add_u32 s3, s3, 8388608
    buffer_load_dwordx4 v[128:131], v11, s[12:15], s3 offen sc1
    s_add_u32 s3, s3, 65536
    buffer_load_dwordx4 v[132:135], v11, s[12:15], s3 offen sc1
    s_add_u32 s3, s3, 65536
    buffer_load_dwordx4 v[136:139], v11, s[12:15], s3 offen sc1
    s_add_u32 s3, s3, 65536
    buffer_load_dwordx4 v[140:143], v11, s[12:15], s3 offen sc1
    s_add_u32 s3, s3, 65536
    buffer_load_dwordx4 v[144:147], v11, s[12:15], s3 offen sc1
    s_add_u32 s3, s3, 65536
    buffer_load_dwordx4 v[148:151], v11, s[12:15], s3 offen sc1
    s_add_u32 s3, s3, 65536
    buffer_load_dwordx4 v[152:155], v11, s[12:15], s3 offen sc1
    s_add_u32 s3, s3, 65536
    buffer_load_dwordx4 v[156:159], v11, s[12:15], s3 offen sc1
    s_add_u32 s3, s3, 65536
    buffer_load_dwordx4 v[160:163], v11, s[12:15], s3 offen sc1
    s_add_u32 s3, s3, 65536
    buffer_load_dwordx4 v[164:167], v11, s[12:15], s3 offen sc1
    s_add_u32 s3, s3, 65536
    buffer_load_dwordx4 v[168:171], v11, s[12:15], s3 offen sc1
    s_add_u32 s3, s3, 65536
    buffer_load_dwordx4 v[172:175], v11, s[12:15], s3 offen sc1
    s_add_u32 s3, s3, 65536
    buffer_load_dwordx4 v[176:179], v11, s[12:15], s3 offen sc1
    s_add_u32 s3, s3, 65536
    buffer_load_dwordx4 v[180:183], v11, s[12:15], s3 offen sc1
    s_waitcnt vmcnt(0)
    s_branch L_yf
L_yfok:
    v_and_b32 v6, 15, v1
    s_mov_b32 s3, 0xffffff00
    v_and_b32 v128, s3, v128
    v_and_b32 v129, s3, v129
    v_and_b32 v130, s3, v130
    v_and_b32 v131, s3, v131
    v_and_b32 v132, s3, v132
    v_and_b32 v133, s3, v133
    v_and_b32 v134, s3, v134
    v_and_b32 v135, s3, v135
    v_and_b32 v136, s3, v136
    v_and_b32 v137, s3, v137
    v_and_b32 v138, s3, v138
    v_and_b32 v139, s3, v139
    v_and_b32 v140, s3, v140
    v_and_b32 v141, s3, v141
    v_and_b32 v142, s3, v142
    v_and_b32 v143, s3, v143
    v_and_b32 v144, s3, v144
    v_and_b32 v145, s3, v145
    v_and_b32 v146, s3, v146
    v_and_b32 v147, s3, v147
    v_and_b32 v148, s3, v148
    v_and_b32 v149, s3, v149
    v_and_b32 v150, s3, v150
    v_and_b32 v151, s3, v151
    v_and_b32 v152, s3, v152
    v_and_b32 v153, s3, v153
    v_and_b32 v154, s3, v154
    v_and_b32 v155, s3, v155
    v_and_b32 v156, s3, v156
    v_and_b32 v157, s3, v157
    v_and_b32 v158, s3, v158
    v_and_b32 v159, s3, v159
    v_and_b32 v160, s3, v160
    v_and_b32 v161, s3, v161
    v_and_b32 v162, s3, v162
    v_and_b32 v163, s3, v163
    v_and_b32 v164, s3, v164
    v_and_b32 v165, s3, v165
    v_and_b32 v166, s3, v166
    v_and_b32 v167, s3, v167
    v_and_b32 v168, s3, v168
    v_and_b32 v169, s3, v169
    v_and_b32 v170, s3, v170
    v_and_b32 v171, s3, v171
    v_and_b32 v172, s3, v172
    v_and_b32 v173, s3, v173
    v_and_b32 v174, s3, v174
    v_and_b32 v175, s3, v175
    v_and_b32 v176, s3, v176
    v_and_b32 v177, s3, v177
    v_and_b32 v178, s3, v178
    v_and_b32 v179, s3, v179
    v_and_b32 v180, s3, v180
    v_and_b32 v181, s3, v181
    v_and_b32 v182, s3, v182
    v_and_b32 v183, s3, v183
    v_pk_add_f32 v[128:129], v[128:129], v[136:137]
    v_pk_add_f32 v[130:131], v[130:131], v[138:139]
    v_pk_add_f32 v[132:133], v[132:133], v[140:141]
    v_pk_add_f32 v[134:135], v[134:135], v[142:143]
    v_pk_add_f32 v[128:129], v[128:129], v[144:145]
    v_pk_add_f32 v[130:131], v[130:131], v[146:147]
    v_pk_add_f32 v[132:133], v[132:133], v[148:149]
    v_pk_add_f32 v[134:135], v[134:135], v[150:151]
    v_pk_add_f32 v[128:129], v[128:129], v[152:153]
    v_pk_add_f32 v[130:131], v[130:131], v[154:155]
    v_pk_add_f32 v[132:133], v[132:133], v[156:157]
    v_pk_add_f32 v[134:135], v[134:135], v[158:159]
    v_pk_add_f32 v[128:129], v[128:129], v[160:161]
    v_pk_add_f32 v[130:131], v[130:131], v[162:163]
    v_pk_add_f32 v[132:133], v[132:133], v[164:165]
    v_pk_add_f32 v[134:135], v[134:135], v[166:167]
    v_pk_add_f32 v[128:129], v[128:129], v[168:169]
    v_pk_add_f32 v[130:131], v[130:131], v[170:171]
    v_pk_add_f32 v[132:133], v[132:133], v[172:173]
    v_pk_add_f32 v[134:135], v[134:135], v[174:175]
    v_pk_add_f32 v[128:129], v[128:129], v[176:177]
    v_pk_add_f32 v[130:131], v[130:131], v[178:179]
    v_pk_add_f32 v[132:133], v[132:133], v[180:181]
    v_pk_add_f32 v[134:135], v[134:135], v[182:183]
    v_pk_add_f32 v[128:129], v[128:129], v[132:133]
    v_pk_add_f32 v[130:131], v[130:131], v[134:135]
    v_mov_b32 v132, v128
    v_mov_b32 v133, v129
    v_mov_b32 v134, v130
    v_mov_b32 v135, v131
    v_permlane16_swap_b32 v128, v132
    v_permlane16_swap_b32 v129, v133
    v_permlane16_swap_b32 v130, v134
    v_permlane16_swap_b32 v131, v135
    v_pk_add_f32 v[128:129], v[128:129], v[132:133]
    v_pk_add_f32 v[130:131], v[130:131], v[134:135]
    v_mov_b32 v132, v128
    v_mov_b32 v133, v129
    v_mov_b32 v134, v130
    v_mov_b32 v135, v131
    v_permlane32_swap_b32 v128, v132
    v_permlane32_swap_b32 v129, v133
    v_permlane32_swap_b32 v130, v134
    v_permlane32_swap_b32 v131, v135
    v_pk_add_f32 v[128:129], v[128:129], v[132:133]
    v_pk_add_f32 v[130:131], v[130:131], v[134:135]
    s_lshl_b32 s3, s38, 8
    s_add_u32 s3, s3, 141568
    v_lshl_add_u32 v6, v6, 4, s3
    ds_write_b128 v6, v[128:131]
    v_lshlrev_b32 v8, 16, v8
    v_subrev_f32 v9, s65, v8
    v_cvt_pk_bf16_f32 v9, v9, v9
    v_lshlrev_b32 v9, 16, v9
    v_mul_f32 v9, v9, v10
    v_cvt_pk_bf16_f32 v9, v9, v9
    v_lshlrev_b32 v9, 16, v9
    v_mov_b32 v16, v5
    s_lshl_b32 s3, s38, 2
    s_add_u32 s3, s3, 141440
    v_mov_b32 v5, s3
    v_mov_b32 v6, 1
    ds_write_b32 v5, v6
    v_mov_b32 v5, 141376
L_yr:
    ds_read_b128 v[20:23], v5 offset:64
    s_waitcnt lgkmcnt(0)
    v_and_b32 v20, v20, v21
    v_and_b32 v22, v22, v23
    v_and_b32 v20, v20, v22
    s_nop 0
    v_readfirstlane_b32 s3, v20
    s_nop 0
    s_cmp_eq_u32 s3, 1
    s_cbranch_scc1 L_yrd
    s_sleep 1
    s_branch L_yr
L_yrd:
    v_lshlrev_b32 v6, 2, v1
    v_add_u32 v6, 141568, v6
    ds_read_b32 v20, v6 offset:0
    ds_read_b32 v21, v6 offset:256
    ds_read_b32 v22, v6 offset:512
    ds_read_b32 v23, v6 offset:768
    s_bfe_u32 s3, s34, 0x20005
    s_and_b32 s65, s34, 7
    s_lshl_b32 s65, s65, 3
    s_lshl_b64 s[66:67], 0xff, s65
    s_bfe_u32 s65, s34, 0x20003
    s_cmp_lg_u32 s3, s38
    s_cbranch_scc1 L_fin
    s_waitcnt lgkmcnt(0)
    v_add_f32 v20, v20, v21
    v_add_f32 v22, v22, v23
    v_add_f32 v20, v20, v22
    v_cvt_pk_bf16_f32 v20, v20, v20
    v_lshlrev_b32 v20, 16, v20
    v_mul_f32 v20, v20, v16
    v_cvt_pk_bf16_f32 v20, v20, v20
    v_lshlrev_b32 v20, 16, v20
    v_add_f32 v20, v20, v9
    v_cvt_pk_bf16_f32 v20, v20, v20
    v_lshlrev_b32 v20, 16, v20
    v_mul_f32 v21, 0xbfb8aa3b, v20
    v_exp_f32 v21, v21
    s_nop 0
    v_add_f32 v21, 1.0, v21
    v_rcp_f32 v21, v21
    s_nop 0
    v_mul_f32 v20, v20, v21
    ds_write_b32 v6, v20 offset:19456
    v_lshlrev_b32 v6, 5, v250
    v_add_u32 v6, 161024, v6
    s_mov_b64 exec, s[66:67]
    s_cmp_lg_u32 s65, 0
    s_cbranch_scc1 L_gr0
    ds_read_b128 v[68:71], v6
    ds_read_b128 v[72:75], v6 offset:16
L_gr0:
    s_cmp_lg_u32 s65, 1
    s_cbranch_scc1 L_gr1
    ds_read_b128 v[76:79], v6
    ds_read_b128 v[80:83], v6 offset:16
L_gr1:
    s_cmp_lg_u32 s65, 2
    s_cbranch_scc1 L_gr2
    ds_read_b128 v[84:87], v6
    ds_read_b128 v[88:91], v6 offset:16
L_gr2:
    s_cmp_lg_u32 s65, 3
    s_cbranch_scc1 L_gr3
    ds_read_b128 v[92:95], v6
    ds_read_b128 v[96:99], v6 offset:16
L_gr3:
    s_mov_b64 exec, -1
L_fin:
    s_waitcnt lgkmcnt(0)
    s_barrier
    ds_read_b128 v[232:235], v15 offset:0
    ds_read_b128 v[236:239], v15 offset:1152
    ds_read_b128 v[240:243], v15 offset:2304
    ds_read_b128 v[244:247], v15 offset:3456
    s_waitcnt lgkmcnt(3)
    v_lshlrev_b32 v192, 16, v232
    v_and_b32 v193, 0xffff0000, v232
    v_lshlrev_b32 v194, 16, v233
    v_and_b32 v195, 0xffff0000, v233
    v_lshlrev_b32 v196, 16, v234
    v_and_b32 v197, 0xffff0000, v234
    v_lshlrev_b32 v198, 16, v235
    v_and_b32 v199, 0xffff0000, v235
    v_pk_fma_f32 v[36:37], v[192:193], v[68:69], v[36:37]
    v_pk_fma_f32 v[38:39], v[194:195], v[70:71], v[38:39]
    v_pk_fma_f32 v[40:41], v[196:197], v[72:73], v[40:41]
    v_pk_fma_f32 v[42:43], v[198:199], v[74:75], v[42:43]
    v_cvt_pk_bf16_f32 v232, v36, v37
    v_cvt_pk_bf16_f32 v233, v38, v39
    v_cvt_pk_bf16_f32 v234, v40, v41
    v_cvt_pk_bf16_f32 v235, v42, v43
    buffer_store_dwordx4 v[232:235], v248, s[24:27], 0 offen nt
    s_waitcnt lgkmcnt(2)
    v_lshlrev_b32 v200, 16, v236
    v_and_b32 v201, 0xffff0000, v236
    v_lshlrev_b32 v202, 16, v237
    v_and_b32 v203, 0xffff0000, v237
    v_lshlrev_b32 v204, 16, v238
    v_and_b32 v205, 0xffff0000, v238
    v_lshlrev_b32 v206, 16, v239
    v_and_b32 v207, 0xffff0000, v239
    v_pk_fma_f32 v[44:45], v[200:201], v[76:77], v[44:45]
    v_pk_fma_f32 v[46:47], v[202:203], v[78:79], v[46:47]
    v_pk_fma_f32 v[48:49], v[204:205], v[80:81], v[48:49]
    v_pk_fma_f32 v[50:51], v[206:207], v[82:83], v[50:51]
    v_cvt_pk_bf16_f32 v236, v44, v45
    v_cvt_pk_bf16_f32 v237, v46, v47
    v_cvt_pk_bf16_f32 v238, v48, v49
    v_cvt_pk_bf16_f32 v239, v50, v51
    buffer_store_dwordx4 v[236:239], v248, s[24:27], s48 offen nt
    s_waitcnt lgkmcnt(1)
    v_lshlrev_b32 v208, 16, v240
    v_and_b32 v209, 0xffff0000, v240
    v_lshlrev_b32 v210, 16, v241
    v_and_b32 v211, 0xffff0000, v241
    v_lshlrev_b32 v212, 16, v242
    v_and_b32 v213, 0xffff0000, v242
    v_lshlrev_b32 v214, 16, v243
    v_and_b32 v215, 0xffff0000, v243
    v_pk_fma_f32 v[52:53], v[208:209], v[84:85], v[52:53]
    v_pk_fma_f32 v[54:55], v[210:211], v[86:87], v[54:55]
    v_pk_fma_f32 v[56:57], v[212:213], v[88:89], v[56:57]
    v_pk_fma_f32 v[58:59], v[214:215], v[90:91], v[58:59]
    v_cvt_pk_bf16_f32 v240, v52, v53
    v_cvt_pk_bf16_f32 v241, v54, v55
    v_cvt_pk_bf16_f32 v242, v56, v57
    v_cvt_pk_bf16_f32 v243, v58, v59
    buffer_store_dwordx4 v[240:243], v248, s[24:27], s49 offen nt
    s_waitcnt lgkmcnt(0)
    v_lshlrev_b32 v216, 16, v244
    v_and_b32 v217, 0xffff0000, v244
    v_lshlrev_b32 v218, 16, v245
    v_and_b32 v219, 0xffff0000, v245
    v_lshlrev_b32 v220, 16, v246
    v_and_b32 v221, 0xffff0000, v246
    v_lshlrev_b32 v222, 16, v247
    v_and_b32 v223, 0xffff0000, v247
    v_pk_fma_f32 v[60:61], v[216:217], v[92:93], v[60:61]
    v_pk_fma_f32 v[62:63], v[218:219], v[94:95], v[62:63]
    v_pk_fma_f32 v[64:65], v[220:221], v[96:97], v[64:65]
    v_pk_fma_f32 v[66:67], v[222:223], v[98:99], v[66:67]
    v_cvt_pk_bf16_f32 v244, v60, v61
    v_cvt_pk_bf16_f32 v245, v62, v63
    v_cvt_pk_bf16_f32 v246, v64, v65
    v_cvt_pk_bf16_f32 v247, v66, v67
    buffer_store_dwordx4 v[244:247], v248, s[24:27], s100 offen nt
L_done:
    s_endpgm
L_g1:
    s_and_b32 s28, s38, 1
    s_lshr_b32 s29, s38, 1
    s_lshl_b32 s3, s36, 7
    s_lshl_b32 s65, s37, 3
    s_add_u32 s3, s3, s65
    s_lshl_b32 s65, s38, 1
    s_add_u32 s68, s3, s65
    s_lshl_b32 s3, s68, 11
    v_and_b32 v3, 31, v1
    v_lshlrev_b32 v3, 4, v3
    v_lshrrev_b32 v4, 5, v1
    v_lshl_add_u32 v5, v4, 11, v3
    s_waitcnt lgkmcnt(0)
    s_mov_b32 s4, s40
    s_mov_b32 s5, s41
    s_mov_b32 s6, 4194304
    s_mov_b32 s7, 0x00020000
    s_mov_b32 s16, s50
    s_mov_b32 s17, s51
    s_mov_b32 s18, 2048
    s_mov_b32 s19, 0x00020000
    buffer_load_dwordx4 v[200:203], v5, s[4:7], s3 offen offset:0
    buffer_load_dwordx4 v[204:207], v5, s[4:7], s3 offen offset:512
    buffer_load_dwordx4 v[208:211], v5, s[4:7], s3 offen offset:1024
    buffer_load_dwordx4 v[212:215], v5, s[4:7], s3 offen offset:1536
    buffer_load_dwordx4 v[216:219], v3, s[16:19], 0 offen offset:0
    buffer_load_dwordx4 v[220:223], v3, s[16:19], 0 offen offset:512
    buffer_load_dwordx4 v[224:227], v3, s[16:19], 0 offen offset:1024
    buffer_load_dwordx4 v[228:231], v3, s[16:19], 0 offen offset:1536
    s_or_b32 s3, s2, s38
    s_cmp_lg_u32 s3, 0
    s_cbranch_scc1 L_nn
    s_mov_b32 s20, s60
    s_mov_b32 s21, s61
    s_mov_b32 s22, 256
    s_mov_b32 s23, 0x00020000
    s_memrealtime s[66:67]
    s_memtime s[70:71]
    s_waitcnt lgkmcnt(0)
    s_lshl_b32 s70, s70, 20
    s_xor_b32 s66, s66, s70
    s_or_b32 s66, s66, 1
    s_and_b32 s66, s66, 0xbfffbfff
    v_mov_b32 v6, s66
    v_mov_b32 v7, 0
    s_mov_b64 exec, 1
    buffer_store_dword v6, v7, s[20:23], 0 offen sc1
    s_mov_b64 exec, -1
L_nn:
    s_getpc_b64 s[66:67]
L_pc:
    s_sub_u32 s66, s66, L_pc-recurrent_scan__linear_kernel_hedgehog__moe_arch_mod__prompt_kernel
    s_subb_u32 s67, s67, 0
    s_lshr_b32 s3, s2, 3
    s_lshl_b32 s3, s3, 2
    s_add_u32 s3, s3, s38
    s_lshl_b32 s3, s3, 6
    s_add_u32 s66, s66, s3
    s_addc_u32 s67, s67, 0
    s_load_dword s71, s[66:67], 0
    s_load_dword s71, s[66:67], 8192
    s_load_dword s71, s[66:67], 16384
    s_load_dword s71, s[66:67], 24576
    s_load_dword s71, s[66:67], 32768
    s_load_dword s71, s[66:67], 40960
    s_mov_b32 s12, s62
    s_mov_b32 s13, s63
    s_mov_b32 s14, 268435456
    s_mov_b32 s15, 0x00020000
    s_and_b32 s30, s2, 3
    s_lshl_b32 s30, s30, 2
    s_bfe_u32 s3, s2, 0x20003
    s_add_u32 s30, s30, s3
    s_bfe_u32 s31, s2, 0x10002
    s_lshl_b32 s31, s31, 3
    s_lshr_b32 s3, s2, 5
    s_add_u32 s31, s31, s3
    s_mov_b32 s88, 0
    s_mov_b32 s70, 0
    v_and_b32 v3, 15, v1
    v_lshlrev_b32 v6, 7, v3
    s_lshl_b32 s3, s28, 13
    v_add_u32 v6, s3, v6
    v_lshrrev_b32 v3, 1, v3
    v_lshrrev_b32 v2, 4, v1
    v_xor_b32 v3, v3, v2
    v_lshl_add_u32 v168, v3, 4, v6
    v_xor_b32 v3, 4, v3
    v_lshl_add_u32 v169, v3, 4, v6
    v_lshlrev_b32 v6, 3, v2
    v_bfe_u32 v7, v1, 2, 2
    v_add_u32 v6, v6, v7
    v_lshlrev_b32 v6, 7, v6
    v_and_b32 v7, 3, v1
    v_lshl_add_u32 v6, v7, 3, v6
    v_bfe_u32 v7, v1, 3, 2
    s_lshl_b32 s3, s29, 1
    v_xor_b32 v7, s3, v7
    v_add_u32 v6, 65536, v6
    v_lshl_add_u32 v170, v7, 5, v6
    v_xor_b32 v7, 1, v7
    v_lshl_add_u32 v171, v7, 5, v6
    v_add_u32 v188, 65536, v170
    v_add_u32 v189, 65536, v171
    v_mov_b64 v[8:9], 0
    v_mov_b64 v[10:11], 0
    v_mov_b64 v[12:13], 0
    v_mov_b64 v[14:15], 0
    v_mov_b64 v[16:17], 0
    v_mov_b64 v[18:19], 0
    v_mov_b64 v[20:21], 0
    v_mov_b64 v[22:23], 0
    v_mov_b64 v[24:25], 0
    v_mov_b64 v[26:27], 0
    v_mov_b64 v[28:29], 0
    v_mov_b64 v[30:31], 0
    v_mov_b64 v[32:33], 0
    v_mov_b64 v[34:35], 0
    v_mov_b64 v[36:37], 0
    v_mov_b64 v[38:39], 0
    v_mov_b64 v[40:41], 0
    v_mov_b64 v[42:43], 0
    v_mov_b64 v[44:45], 0
    v_mov_b64 v[46:47], 0
    v_mov_b64 v[48:49], 0
    v_mov_b64 v[50:51], 0
    v_mov_b64 v[52:53], 0
    v_mov_b64 v[54:55], 0
    v_mov_b64 v[56:57], 0
    v_mov_b64 v[58:59], 0
    v_mov_b64 v[60:61], 0
    v_mov_b64 v[62:63], 0
    v_mov_b64 v[64:65], 0
    v_mov_b64 v[66:67], 0
    v_mov_b64 v[68:69], 0
    v_mov_b64 v[70:71], 0
    v_mov_b64 v[72:73], 0
    v_mov_b64 v[74:75], 0
    v_mov_b64 v[76:77], 0
    v_mov_b64 v[78:79], 0
    v_mov_b64 v[80:81], 0
    v_mov_b64 v[82:83], 0
    v_mov_b64 v[84:85], 0
    v_mov_b64 v[86:87], 0
    v_mov_b64 v[88:89], 0
    v_mov_b64 v[90:91], 0
    v_mov_b64 v[92:93], 0
    v_mov_b64 v[94:95], 0
    v_mov_b64 v[96:97], 0
    v_mov_b64 v[98:99], 0
    v_mov_b64 v[100:101], 0
    v_mov_b64 v[102:103], 0
    v_mov_b32 v236, 0x3f803f80
    v_mov_b32 v232, 0
    v_mov_b32 v233, 0
    v_mov_b32 v234, 0
    v_mov_b32 v235, 0
    s_waitcnt vmcnt(0)
    v_dot2_f32_bf16 v232, v200, v236, v232
    v_dot2_f32_bf16 v233, v200, v200, v233
    v_dot2_f32_bf16 v234, v200, v216, v234
    v_dot2_f32_bf16 v235, v216, v236, v235
    v_dot2_f32_bf16 v232, v201, v236, v232
    v_dot2_f32_bf16 v233, v201, v201, v233
    v_dot2_f32_bf16 v234, v201, v217, v234
    v_dot2_f32_bf16 v235, v217, v236, v235
    v_dot2_f32_bf16 v232, v202, v236, v232
    v_dot2_f32_bf16 v233, v202, v202, v233
    v_dot2_f32_bf16 v234, v202, v218, v234
    v_dot2_f32_bf16 v235, v218, v236, v235
    v_dot2_f32_bf16 v232, v203, v236, v232
    v_dot2_f32_bf16 v233, v203, v203, v233
    v_dot2_f32_bf16 v234, v203, v219, v234
    v_dot2_f32_bf16 v235, v219, v236, v235
    v_dot2_f32_bf16 v232, v204, v236, v232
    v_dot2_f32_bf16 v233, v204, v204, v233
    v_dot2_f32_bf16 v234, v204, v220, v234
    v_dot2_f32_bf16 v235, v220, v236, v235
    v_dot2_f32_bf16 v232, v205, v236, v232
    v_dot2_f32_bf16 v233, v205, v205, v233
    v_dot2_f32_bf16 v234, v205, v221, v234
    v_dot2_f32_bf16 v235, v221, v236, v235
    v_dot2_f32_bf16 v232, v206, v236, v232
    v_dot2_f32_bf16 v233, v206, v206, v233
    v_dot2_f32_bf16 v234, v206, v222, v234
    v_dot2_f32_bf16 v235, v222, v236, v235
    v_dot2_f32_bf16 v232, v207, v236, v232
    v_dot2_f32_bf16 v233, v207, v207, v233
    v_dot2_f32_bf16 v234, v207, v223, v234
    v_dot2_f32_bf16 v235, v223, v236, v235
    v_dot2_f32_bf16 v232, v208, v236, v232
    v_dot2_f32_bf16 v233, v208, v208, v233
    v_dot2_f32_bf16 v234, v208, v224, v234
    v_dot2_f32_bf16 v235, v224, v236, v235
    v_dot2_f32_bf16 v232, v209, v236, v232
    v_dot2_f32_bf16 v233, v209, v209, v233
    v_dot2_f32_bf16 v234, v209, v225, v234
    v_dot2_f32_bf16 v235, v225, v236, v235
    v_dot2_f32_bf16 v232, v210, v236, v232
    v_dot2_f32_bf16 v233, v210, v210, v233
    v_dot2_f32_bf16 v234, v210, v226, v234
    v_dot2_f32_bf16 v235, v226, v236, v235
    v_dot2_f32_bf16 v232, v211, v236, v232
    v_dot2_f32_bf16 v233, v211, v211, v233
    v_dot2_f32_bf16 v234, v211, v227, v234
    v_dot2_f32_bf16 v235, v227, v236, v235
    v_dot2_f32_bf16 v232, v212, v236, v232
    v_dot2_f32_bf16 v233, v212, v212, v233
    v_dot2_f32_bf16 v234, v212, v228, v234
    v_dot2_f32_bf16 v235, v228, v236, v235
    v_dot2_f32_bf16 v232, v213, v236, v232
    v_dot2_f32_bf16 v233, v213, v213, v233
    v_dot2_f32_bf16 v234, v213, v229, v234
    v_dot2_f32_bf16 v235, v229, v236, v235
    v_dot2_f32_bf16 v232, v214, v236, v232
    v_dot2_f32_bf16 v233, v214, v214, v233
    v_dot2_f32_bf16 v234, v214, v230, v234
    v_dot2_f32_bf16 v235, v230, v236, v235
    v_dot2_f32_bf16 v232, v215, v236, v232
    v_dot2_f32_bf16 v233, v215, v215, v233
    v_dot2_f32_bf16 v234, v215, v231, v234
    v_dot2_f32_bf16 v235, v231, v236, v235
    v_add_f32 v232, v232, v232 quad_perm:[1,0,3,2] row_mask:0xf bank_mask:0xf
    v_add_f32 v233, v233, v233 quad_perm:[1,0,3,2] row_mask:0xf bank_mask:0xf
    v_add_f32 v234, v234, v234 quad_perm:[1,0,3,2] row_mask:0xf bank_mask:0xf
    v_add_f32 v235, v235, v235 quad_perm:[1,0,3,2] row_mask:0xf bank_mask:0xf
    v_add_f32 v232, v232, v232 quad_perm:[2,3,0,1] row_mask:0xf bank_mask:0xf
    v_add_f32 v233, v233, v233 quad_perm:[2,3,0,1] row_mask:0xf bank_mask:0xf
    v_add_f32 v234, v234, v234 quad_perm:[2,3,0,1] row_mask:0xf bank_mask:0xf
    v_add_f32 v235, v235, v235 quad_perm:[2,3,0,1] row_mask:0xf bank_mask:0xf
    v_add_f32 v232, v232, v232 row_half_mirror row_mask:0xf bank_mask:0xf
    v_add_f32 v233, v233, v233 row_half_mirror row_mask:0xf bank_mask:0xf
    v_add_f32 v234, v234, v234 row_half_mirror row_mask:0xf bank_mask:0xf
    v_add_f32 v235, v235, v235 row_half_mirror row_mask:0xf bank_mask:0xf
    v_add_f32 v232, v232, v232 row_mirror row_mask:0xf bank_mask:0xf
    v_add_f32 v233, v233, v233 row_mirror row_mask:0xf bank_mask:0xf
    v_add_f32 v234, v234, v234 row_mirror row_mask:0xf bank_mask:0xf
    v_add_f32 v235, v235, v235 row_mirror row_mask:0xf bank_mask:0xf
    v_mov_b32 v236, v232
    v_mov_b32 v237, v233
    v_mov_b32 v238, v234
    v_mov_b32 v239, v235
    v_permlane16_swap_b32 v232, v236
    v_permlane16_swap_b32 v233, v237
    v_permlane16_swap_b32 v234, v238
    v_permlane16_swap_b32 v235, v239
    v_add_f32 v232, v232, v236
    v_add_f32 v233, v233, v237
    v_add_f32 v234, v234, v238
    v_add_f32 v235, v235, v239
    v_mul_f32 v232, 0x3a800000, v232
    v_mul_f32 v233, 0x3a800000, v233
    v_fma_f32 v233, -v232, v232, v233
    v_max_f32 v233, 0, v233
    v_cvt_pk_bf16_f32 v232, v232, v232
    v_lshlrev_b32 v232, 16, v232
    v_cvt_pk_bf16_f32 v233, v233, v233
    v_lshlrev_b32 v233, 16, v233
    v_add_f32 v233, 0x3727c5ac, v233
    v_cvt_pk_bf16_f32 v233, v233, v233
    v_lshlrev_b32 v233, 16, v233
    v_sqrt_f32 v233, v233
    v_fma_f32 v234, -v232, v235, v234
    v_cvt_pk_bf16_f32 v233, v233, v233
    v_lshlrev_b32 v233, 16, v233
    v_rcp_f32 v235, v233
    v_lshrrev_b32 v232, 16, v232
    v_or_b32 v232, v232, v233
    v_mul_f32 v234, v234, v235
    v_ashrrev_i32 v235, 31, v234
    v_or_b32 v235, 0x80000000, v235
    v_xor_b32 v234, v234, v235
    v_and_b32 v234, 0xfffff800, v234
    s_sub_u32 s3, 2047, s68
    v_sub_u32 v235, s3, v4
    v_or_b32 v233, v234, v235
    s_lshl_b32 s3, s38, 4
    s_add_u32 s3, s3, 141504
    v_lshl_add_u32 v235, v4, 3, s3
    ds_write_b64 v235, v[232:233]
L_c1:
    s_waitcnt lgkmcnt(0)
    s_barrier
    ds_read_b128 v[104:107], v168 offset:0
    ds_read_b64_tr_b16 v[120:121], v170 offset:0
    ds_read_b64_tr_b16 v[122:123], v170 offset:512
    ds_read_b64_tr_b16 v[124:125], v171 offset:0
    ds_read_b64_tr_b16 v[126:127], v171 offset:512
    ds_read_b128 v[108:111], v168 offset:2048
    ds_read_b64_tr_b16 v[128:129], v170 offset:8192
    ds_read_b64_tr_b16 v[130:131], v170 offset:8704
    ds_read_b64_tr_b16 v[132:133], v171 offset:8192
    ds_read_b64_tr_b16 v[134:135], v171 offset:8704
    ds_read_b64_tr_b16 v[172:173], v188 offset:0
    ds_read_b64_tr_b16 v[174:175], v188 offset:512
    s_waitcnt lgkmcnt(8)
    ds_read_b64_tr_b16 v[176:177], v189 offset:0
    ds_read_b64_tr_b16 v[178:179], v189 offset:512
    ds_read_b128 v[112:115], v168 offset:4096
    ds_read_b128 v[116:119], v168 offset:6144
    s_waitcnt lgkmcnt(0)
    v_mfma_f32_16x16x32_bf16 v[8:11], v[120:123], v[104:107], v[8:11]
    ds_read_b128 v[136:139], v169 offset:0
    v_mfma_f32_16x16x32_bf16 v[12:15], v[124:127], v[104:107], v[12:15]
    ds_read_b64_tr_b16 v[152:153], v170 offset:4096
    v_mfma_f32_16x16x32_bf16 v[16:19], v[104:107], v[128:131], v[16:19]
    ds_read_b64_tr_b16 v[154:155], v170 offset:4608
    v_mfma_f32_16x16x32_bf16 v[20:23], v[104:107], v[132:135], v[20:23]
    ds_read_b64_tr_b16 v[156:157], v171 offset:4096
    v_mfma_f32_16x16x32_bf16 v[72:75], v[172:175], v[104:107], v[72:75]
    ds_read_b64_tr_b16 v[158:159], v171 offset:4608
    v_mfma_f32_16x16x32_bf16 v[76:79], v[176:179], v[104:107], v[76:79]
    ds_read_b128 v[140:143], v169 offset:2048
    v_mfma_f32_16x16x32_bf16 v[24:27], v[120:123], v[108:111], v[24:27]
    ds_read_b64_tr_b16 v[160:161], v170 offset:12288
    v_mfma_f32_16x16x32_bf16 v[28:31], v[124:127], v[108:111], v[28:31]
    ds_read_b64_tr_b16 v[162:163], v170 offset:12800
    v_mfma_f32_16x16x32_bf16 v[32:35], v[108:111], v[128:131], v[32:35]
    ds_read_b64_tr_b16 v[164:165], v171 offset:12288
    v_mfma_f32_16x16x32_bf16 v[36:39], v[108:111], v[132:135], v[36:39]
    ds_read_b64_tr_b16 v[166:167], v171 offset:12800
    v_mfma_f32_16x16x32_bf16 v[80:83], v[172:175], v[108:111], v[80:83]
    ds_read_b64_tr_b16 v[180:181], v188 offset:4096
    v_mfma_f32_16x16x32_bf16 v[84:87], v[176:179], v[108:111], v[84:87]
    ds_read_b64_tr_b16 v[182:183], v188 offset:4608
    v_mfma_f32_16x16x32_bf16 v[40:43], v[120:123], v[112:115], v[40:43]
    ds_read_b64_tr_b16 v[184:185], v189 offset:4096
    v_mfma_f32_16x16x32_bf16 v[44:47], v[124:127], v[112:115], v[44:47]
    ds_read_b64_tr_b16 v[186:187], v189 offset:4608
    v_mfma_f32_16x16x32_bf16 v[48:51], v[112:115], v[128:131], v[48:51]
    ds_read_b128 v[144:147], v169 offset:4096
    v_mfma_f32_16x16x32_bf16 v[52:55], v[112:115], v[132:135], v[52:55]
    ds_read_b128 v[148:151], v169 offset:6144
    v_mfma_f32_16x16x32_bf16 v[88:91], v[172:175], v[112:115], v[88:91]
    v_mfma_f32_16x16x32_bf16 v[92:95], v[176:179], v[112:115], v[92:95]
    v_mfma_f32_16x16x32_bf16 v[56:59], v[120:123], v[116:119], v[56:59]
    v_mfma_f32_16x16x32_bf16 v[60:63], v[124:127], v[116:119], v[60:63]
    v_mfma_f32_16x16x32_bf16 v[64:67], v[116:119], v[128:131], v[64:67]
    v_mfma_f32_16x16x32_bf16 v[68:71], v[116:119], v[132:135], v[68:71]
    v_mfma_f32_16x16x32_bf16 v[96:99], v[172:175], v[116:119], v[96:99]
    v_mfma_f32_16x16x32_bf16 v[100:103], v[176:179], v[116:119], v[100:103]
    s_waitcnt lgkmcnt(0)
    s_barrier
    v_mfma_f32_16x16x32_bf16 v[8:11], v[152:155], v[136:139], v[8:11]
    ds_read_b128 v[104:107], v168 offset:16384
    v_mfma_f32_16x16x32_bf16 v[12:15], v[156:159], v[136:139], v[12:15]
    ds_read_b64_tr_b16 v[120:121], v170 offset:16384
    v_mfma_f32_16x16x32_bf16 v[16:19], v[136:139], v[160:163], v[16:19]
    ds_read_b64_tr_b16 v[122:123], v170 offset:16896
    v_mfma_f32_16x16x32_bf16 v[20:23], v[136:139], v[164:167], v[20:23]
    ds_read_b64_tr_b16 v[124:125], v171 offset:16384
    v_mfma_f32_16x16x32_bf16 v[72:75], v[180:183], v[136:139], v[72:75]
    ds_read_b64_tr_b16 v[126:127], v171 offset:16896
    v_mfma_f32_16x16x32_bf16 v[76:79], v[184:187], v[136:139], v[76:79]
    ds_read_b128 v[108:111], v168 offset:18432
    v_mfma_f32_16x16x32_bf16 v[24:27], v[152:155], v[140:143], v[24:27]
    ds_read_b64_tr_b16 v[128:129], v170 offset:24576
    v_mfma_f32_16x16x32_bf16 v[28:31], v[156:159], v[140:143], v[28:31]
    ds_read_b64_tr_b16 v[130:131], v170 offset:25088
    v_mfma_f32_16x16x32_bf16 v[32:35], v[140:143], v[160:163], v[32:35]
    ds_read_b64_tr_b16 v[132:133], v171 offset:24576
    v_mfma_f32_16x16x32_bf16 v[36:39], v[140:143], v[164:167], v[36:39]
    ds_read_b64_tr_b16 v[134:135], v171 offset:25088
    v_mfma_f32_16x16x32_bf16 v[80:83], v[180:183], v[140:143], v[80:83]
    ds_read_b64_tr_b16 v[172:173], v188 offset:11520
    v_mfma_f32_16x16x32_bf16 v[84:87], v[184:187], v[140:143], v[84:87]
    ds_read_b64_tr_b16 v[174:175], v188 offset:12032
    v_mfma_f32_16x16x32_bf16 v[40:43], v[152:155], v[144:147], v[40:43]
    ds_read_b64_tr_b16 v[176:177], v189 offset:11520
    v_mfma_f32_16x16x32_bf16 v[44:47], v[156:159], v[144:147], v[44:47]
    ds_read_b64_tr_b16 v[178:179], v189 offset:12032
    v_mfma_f32_16x16x32_bf16 v[48:51], v[144:147], v[160:163], v[48:51]
    ds_read_b128 v[112:115], v168 offset:20480
    v_mfma_f32_16x16x32_bf16 v[52:55], v[144:147], v[164:167], v[52:55]
    ds_read_b128 v[116:119], v168 offset:22528
    v_mfma_f32_16x16x32_bf16 v[88:91], v[180:183], v[144:147], v[88:91]
    v_mfma_f32_16x16x32_bf16 v[92:95], v[184:187], v[144:147], v[92:95]
    v_mfma_f32_16x16x32_bf16 v[56:59], v[152:155], v[148:151], v[56:59]
    v_mfma_f32_16x16x32_bf16 v[60:63], v[156:159], v[148:151], v[60:63]
    v_mfma_f32_16x16x32_bf16 v[64:67], v[148:151], v[160:163], v[64:67]
    v_mfma_f32_16x16x32_bf16 v[68:71], v[148:151], v[164:167], v[68:71]
    v_mfma_f32_16x16x32_bf16 v[96:99], v[180:183], v[148:151], v[96:99]
    v_mfma_f32_16x16x32_bf16 v[100:103], v[184:187], v[148:151], v[100:103]
    s_waitcnt lgkmcnt(0)
    v_mfma_f32_16x16x32_bf16 v[8:11], v[120:123], v[104:107], v[8:11]
    ds_read_b128 v[136:139], v169 offset:16384
    v_mfma_f32_16x16x32_bf16 v[12:15], v[124:127], v[104:107], v[12:15]
    ds_read_b64_tr_b16 v[152:153], v170 offset:20480
    v_mfma_f32_16x16x32_bf16 v[16:19], v[104:107], v[128:131], v[16:19]
    ds_read_b64_tr_b16 v[154:155], v170 offset:20992
    v_mfma_f32_16x16x32_bf16 v[20:23], v[104:107], v[132:135], v[20:23]
    ds_read_b64_tr_b16 v[156:157], v171 offset:20480
    v_mfma_f32_16x16x32_bf16 v[72:75], v[172:175], v[104:107], v[72:75]
    ds_read_b64_tr_b16 v[158:159], v171 offset:20992
    v_mfma_f32_16x16x32_bf16 v[76:79], v[176:179], v[104:107], v[76:79]
    ds_read_b128 v[140:143], v169 offset:18432
    v_mfma_f32_16x16x32_bf16 v[24:27], v[120:123], v[108:111], v[24:27]
    ds_read_b64_tr_b16 v[160:161], v170 offset:28672
    v_mfma_f32_16x16x32_bf16 v[28:31], v[124:127], v[108:111], v[28:31]
    ds_read_b64_tr_b16 v[162:163], v170 offset:29184
    v_mfma_f32_16x16x32_bf16 v[32:35], v[108:111], v[128:131], v[32:35]
    ds_read_b64_tr_b16 v[164:165], v171 offset:28672
    v_mfma_f32_16x16x32_bf16 v[36:39], v[108:111], v[132:135], v[36:39]
    ds_read_b64_tr_b16 v[166:167], v171 offset:29184
    v_mfma_f32_16x16x32_bf16 v[80:83], v[172:175], v[108:111], v[80:83]
    ds_read_b64_tr_b16 v[180:181], v188 offset:15616
    v_mfma_f32_16x16x32_bf16 v[84:87], v[176:179], v[108:111], v[84:87]
    ds_read_b64_tr_b16 v[182:183], v188 offset:16128
    v_mfma_f32_16x16x32_bf16 v[40:43], v[120:123], v[112:115], v[40:43]
    ds_read_b64_tr_b16 v[184:185], v189 offset:15616
    v_mfma_f32_16x16x32_bf16 v[44:47], v[124:127], v[112:115], v[44:47]
    ds_read_b64_tr_b16 v[186:187], v189 offset:16128
    v_mfma_f32_16x16x32_bf16 v[48:51], v[112:115], v[128:131], v[48:51]
    ds_read_b128 v[144:147], v169 offset:20480
    v_mfma_f32_16x16x32_bf16 v[52:55], v[112:115], v[132:135], v[52:55]
    ds_read_b128 v[148:151], v169 offset:22528
    v_mfma_f32_16x16x32_bf16 v[88:91], v[172:175], v[112:115], v[88:91]
    v_mfma_f32_16x16x32_bf16 v[92:95], v[176:179], v[112:115], v[92:95]
    v_mfma_f32_16x16x32_bf16 v[56:59], v[120:123], v[116:119], v[56:59]
    v_mfma_f32_16x16x32_bf16 v[60:63], v[124:127], v[116:119], v[60:63]
    v_mfma_f32_16x16x32_bf16 v[64:67], v[116:119], v[128:131], v[64:67]
    v_mfma_f32_16x16x32_bf16 v[68:71], v[116:119], v[132:135], v[68:71]
    v_mfma_f32_16x16x32_bf16 v[96:99], v[172:175], v[116:119], v[96:99]
    v_mfma_f32_16x16x32_bf16 v[100:103], v[176:179], v[116:119], v[100:103]
    s_waitcnt lgkmcnt(0)
    s_barrier
    v_mfma_f32_16x16x32_bf16 v[8:11], v[152:155], v[136:139], v[8:11]
    ds_read_b128 v[104:107], v168 offset:32768
    v_mfma_f32_16x16x32_bf16 v[12:15], v[156:159], v[136:139], v[12:15]
    ds_read_b64_tr_b16 v[120:121], v170 offset:32768
    v_mfma_f32_16x16x32_bf16 v[16:19], v[136:139], v[160:163], v[16:19]
    ds_read_b64_tr_b16 v[122:123], v170 offset:33280
    v_mfma_f32_16x16x32_bf16 v[20:23], v[136:139], v[164:167], v[20:23]
    ds_read_b64_tr_b16 v[124:125], v171 offset:32768
    v_mfma_f32_16x16x32_bf16 v[72:75], v[180:183], v[136:139], v[72:75]
    ds_read_b64_tr_b16 v[126:127], v171 offset:33280
    v_mfma_f32_16x16x32_bf16 v[76:79], v[184:187], v[136:139], v[76:79]
    ds_read_b128 v[108:111], v168 offset:34816
    v_mfma_f32_16x16x32_bf16 v[24:27], v[152:155], v[140:143], v[24:27]
    ds_read_b64_tr_b16 v[128:129], v170 offset:40960
    v_mfma_f32_16x16x32_bf16 v[28:31], v[156:159], v[140:143], v[28:31]
    ds_read_b64_tr_b16 v[130:131], v170 offset:41472
    v_mfma_f32_16x16x32_bf16 v[32:35], v[140:143], v[160:163], v[32:35]
    ds_read_b64_tr_b16 v[132:133], v171 offset:40960
    v_mfma_f32_16x16x32_bf16 v[36:39], v[140:143], v[164:167], v[36:39]
    ds_read_b64_tr_b16 v[134:135], v171 offset:41472
    v_mfma_f32_16x16x32_bf16 v[80:83], v[180:183], v[140:143], v[80:83]
    ds_read_b64_tr_b16 v[172:173], v188 offset:19712
    v_mfma_f32_16x16x32_bf16 v[84:87], v[184:187], v[140:143], v[84:87]
    ds_read_b64_tr_b16 v[174:175], v188 offset:20224
    v_mfma_f32_16x16x32_bf16 v[40:43], v[152:155], v[144:147], v[40:43]
    ds_read_b64_tr_b16 v[176:177], v189 offset:19712
    v_mfma_f32_16x16x32_bf16 v[44:47], v[156:159], v[144:147], v[44:47]
    ds_read_b64_tr_b16 v[178:179], v189 offset:20224
    v_mfma_f32_16x16x32_bf16 v[48:51], v[144:147], v[160:163], v[48:51]
    ds_read_b128 v[112:115], v168 offset:36864
    v_mfma_f32_16x16x32_bf16 v[52:55], v[144:147], v[164:167], v[52:55]
    ds_read_b128 v[116:119], v168 offset:38912
    v_mfma_f32_16x16x32_bf16 v[88:91], v[180:183], v[144:147], v[88:91]
    v_mfma_f32_16x16x32_bf16 v[92:95], v[184:187], v[144:147], v[92:95]
    v_mfma_f32_16x16x32_bf16 v[56:59], v[152:155], v[148:151], v[56:59]
    v_mfma_f32_16x16x32_bf16 v[60:63], v[156:159], v[148:151], v[60:63]
    v_mfma_f32_16x16x32_bf16 v[64:67], v[148:151], v[160:163], v[64:67]
    v_mfma_f32_16x16x32_bf16 v[68:71], v[148:151], v[164:167], v[68:71]
    v_mfma_f32_16x16x32_bf16 v[96:99], v[180:183], v[148:151], v[96:99]
    v_mfma_f32_16x16x32_bf16 v[100:103], v[184:187], v[148:151], v[100:103]
    s_waitcnt lgkmcnt(0)
    v_mfma_f32_16x16x32_bf16 v[8:11], v[120:123], v[104:107], v[8:11]
    ds_read_b128 v[136:139], v169 offset:32768
    v_mfma_f32_16x16x32_bf16 v[12:15], v[124:127], v[104:107], v[12:15]
    ds_read_b64_tr_b16 v[152:153], v170 offset:36864
    v_mfma_f32_16x16x32_bf16 v[16:19], v[104:107], v[128:131], v[16:19]
    ds_read_b64_tr_b16 v[154:155], v170 offset:37376
    v_mfma_f32_16x16x32_bf16 v[20:23], v[104:107], v[132:135], v[20:23]
    ds_read_b64_tr_b16 v[156:157], v171 offset:36864
    v_mfma_f32_16x16x32_bf16 v[72:75], v[172:175], v[104:107], v[72:75]
    ds_read_b64_tr_b16 v[158:159], v171 offset:37376
    v_mfma_f32_16x16x32_bf16 v[76:79], v[176:179], v[104:107], v[76:79]
    ds_read_b128 v[140:143], v169 offset:34816
    v_mfma_f32_16x16x32_bf16 v[24:27], v[120:123], v[108:111], v[24:27]
    ds_read_b64_tr_b16 v[160:161], v170 offset:45056
    v_mfma_f32_16x16x32_bf16 v[28:31], v[124:127], v[108:111], v[28:31]
    ds_read_b64_tr_b16 v[162:163], v170 offset:45568
    v_mfma_f32_16x16x32_bf16 v[32:35], v[108:111], v[128:131], v[32:35]
    ds_read_b64_tr_b16 v[164:165], v171 offset:45056
    v_mfma_f32_16x16x32_bf16 v[36:39], v[108:111], v[132:135], v[36:39]
    ds_read_b64_tr_b16 v[166:167], v171 offset:45568
    v_mfma_f32_16x16x32_bf16 v[80:83], v[172:175], v[108:111], v[80:83]
    ds_read_b64_tr_b16 v[180:181], v188 offset:23808
    v_mfma_f32_16x16x32_bf16 v[84:87], v[176:179], v[108:111], v[84:87]
    ds_read_b64_tr_b16 v[182:183], v188 offset:24320
    v_mfma_f32_16x16x32_bf16 v[40:43], v[120:123], v[112:115], v[40:43]
    ds_read_b64_tr_b16 v[184:185], v189 offset:23808
    v_mfma_f32_16x16x32_bf16 v[44:47], v[124:127], v[112:115], v[44:47]
    ds_read_b64_tr_b16 v[186:187], v189 offset:24320
    v_mfma_f32_16x16x32_bf16 v[48:51], v[112:115], v[128:131], v[48:51]
    ds_read_b128 v[144:147], v169 offset:36864
    v_mfma_f32_16x16x32_bf16 v[52:55], v[112:115], v[132:135], v[52:55]
    ds_read_b128 v[148:151], v169 offset:38912
    v_mfma_f32_16x16x32_bf16 v[88:91], v[172:175], v[112:115], v[88:91]
    v_mfma_f32_16x16x32_bf16 v[92:95], v[176:179], v[112:115], v[92:95]
    v_mfma_f32_16x16x32_bf16 v[56:59], v[120:123], v[116:119], v[56:59]
    v_mfma_f32_16x16x32_bf16 v[60:63], v[124:127], v[116:119], v[60:63]
    v_mfma_f32_16x16x32_bf16 v[64:67], v[116:119], v[128:131], v[64:67]
    v_mfma_f32_16x16x32_bf16 v[68:71], v[116:119], v[132:135], v[68:71]
    v_mfma_f32_16x16x32_bf16 v[96:99], v[172:175], v[116:119], v[96:99]
    v_mfma_f32_16x16x32_bf16 v[100:103], v[176:179], v[116:119], v[100:103]
    s_waitcnt lgkmcnt(0)
    s_barrier
    v_mfma_f32_16x16x32_bf16 v[8:11], v[152:155], v[136:139], v[8:11]
    ds_read_b128 v[104:107], v168 offset:49152
    v_mfma_f32_16x16x32_bf16 v[12:15], v[156:159], v[136:139], v[12:15]
    ds_read_b64_tr_b16 v[120:121], v170 offset:49152
    v_mfma_f32_16x16x32_bf16 v[16:19], v[136:139], v[160:163], v[16:19]
    ds_read_b64_tr_b16 v[122:123], v170 offset:49664
    v_mfma_f32_16x16x32_bf16 v[20:23], v[136:139], v[164:167], v[20:23]
    ds_read_b64_tr_b16 v[124:125], v171 offset:49152
    v_mfma_f32_16x16x32_bf16 v[72:75], v[180:183], v[136:139], v[72:75]
    ds_read_b64_tr_b16 v[126:127], v171 offset:49664
    v_mfma_f32_16x16x32_bf16 v[76:79], v[184:187], v[136:139], v[76:79]
    ds_read_b128 v[108:111], v168 offset:51200
    v_mfma_f32_16x16x32_bf16 v[24:27], v[152:155], v[140:143], v[24:27]
    ds_read_b64_tr_b16 v[128:129], v170 offset:57344
    v_mfma_f32_16x16x32_bf16 v[28:31], v[156:159], v[140:143], v[28:31]
    ds_read_b64_tr_b16 v[130:131], v170 offset:57856
    v_mfma_f32_16x16x32_bf16 v[32:35], v[140:143], v[160:163], v[32:35]
    ds_read_b64_tr_b16 v[132:133], v171 offset:57344
    v_mfma_f32_16x16x32_bf16 v[36:39], v[140:143], v[164:167], v[36:39]
    ds_read_b64_tr_b16 v[134:135], v171 offset:57856
    v_mfma_f32_16x16x32_bf16 v[80:83], v[180:183], v[140:143], v[80:83]
    ds_read_b64_tr_b16 v[172:173], v188 offset:0
    v_mfma_f32_16x16x32_bf16 v[84:87], v[184:187], v[140:143], v[84:87]
    ds_read_b64_tr_b16 v[174:175], v188 offset:512
    v_mfma_f32_16x16x32_bf16 v[40:43], v[152:155], v[144:147], v[40:43]
    ds_read_b64_tr_b16 v[176:177], v189 offset:0
    v_mfma_f32_16x16x32_bf16 v[44:47], v[156:159], v[144:147], v[44:47]
    ds_read_b64_tr_b16 v[178:179], v189 offset:512
    v_mfma_f32_16x16x32_bf16 v[48:51], v[144:147], v[160:163], v[48:51]
    ds_read_b128 v[112:115], v168 offset:53248
    v_mfma_f32_16x16x32_bf16 v[52:55], v[144:147], v[164:167], v[52:55]
    ds_read_b128 v[116:119], v168 offset:55296
    v_mfma_f32_16x16x32_bf16 v[88:91], v[180:183], v[144:147], v[88:91]
    v_mfma_f32_16x16x32_bf16 v[92:95], v[184:187], v[144:147], v[92:95]
    v_mfma_f32_16x16x32_bf16 v[56:59], v[152:155], v[148:151], v[56:59]
    v_mfma_f32_16x16x32_bf16 v[60:63], v[156:159], v[148:151], v[60:63]
    v_mfma_f32_16x16x32_bf16 v[64:67], v[148:151], v[160:163], v[64:67]
    v_mfma_f32_16x16x32_bf16 v[68:71], v[148:151], v[164:167], v[68:71]
    v_mfma_f32_16x16x32_bf16 v[96:99], v[180:183], v[148:151], v[96:99]
    v_mfma_f32_16x16x32_bf16 v[100:103], v[184:187], v[148:151], v[100:103]
    s_waitcnt lgkmcnt(0)
    v_mfma_f32_16x16x32_bf16 v[8:11], v[120:123], v[104:107], v[8:11]
    ds_read_b128 v[136:139], v169 offset:49152
    v_mfma_f32_16x16x32_bf16 v[12:15], v[124:127], v[104:107], v[12:15]
    ds_read_b64_tr_b16 v[152:153], v170 offset:53248
    v_mfma_f32_16x16x32_bf16 v[16:19], v[104:107], v[128:131], v[16:19]
    ds_read_b64_tr_b16 v[154:155], v170 offset:53760
    v_mfma_f32_16x16x32_bf16 v[20:23], v[104:107], v[132:135], v[20:23]
    ds_read_b64_tr_b16 v[156:157], v171 offset:53248
    v_mfma_f32_16x16x32_bf16 v[72:75], v[172:175], v[104:107], v[72:75]
    ds_read_b64_tr_b16 v[158:159], v171 offset:53760
    v_mfma_f32_16x16x32_bf16 v[76:79], v[176:179], v[104:107], v[76:79]
    ds_read_b128 v[140:143], v169 offset:51200
    v_mfma_f32_16x16x32_bf16 v[24:27], v[120:123], v[108:111], v[24:27]
    ds_read_b64_tr_b16 v[160:161], v170 offset:61440
    v_mfma_f32_16x16x32_bf16 v[28:31], v[124:127], v[108:111], v[28:31]
    ds_read_b64_tr_b16 v[162:163], v170 offset:61952
    v_mfma_f32_16x16x32_bf16 v[32:35], v[108:111], v[128:131], v[32:35]
    ds_read_b64_tr_b16 v[164:165], v171 offset:61440
    v_mfma_f32_16x16x32_bf16 v[36:39], v[108:111], v[132:135], v[36:39]
    ds_read_b64_tr_b16 v[166:167], v171 offset:61952
    v_mfma_f32_16x16x32_bf16 v[80:83], v[172:175], v[108:111], v[80:83]
    ds_read_b64_tr_b16 v[180:181], v188 offset:4096
    v_mfma_f32_16x16x32_bf16 v[84:87], v[176:179], v[108:111], v[84:87]
    ds_read_b64_tr_b16 v[182:183], v188 offset:4608
    v_mfma_f32_16x16x32_bf16 v[40:43], v[120:123], v[112:115], v[40:43]
    ds_read_b64_tr_b16 v[184:185], v189 offset:4096
    v_mfma_f32_16x16x32_bf16 v[44:47], v[124:127], v[112:115], v[44:47]
    ds_read_b64_tr_b16 v[186:187], v189 offset:4608
    v_mfma_f32_16x16x32_bf16 v[48:51], v[112:115], v[128:131], v[48:51]
    ds_read_b128 v[144:147], v169 offset:53248
    v_mfma_f32_16x16x32_bf16 v[52:55], v[112:115], v[132:135], v[52:55]
    ds_read_b128 v[148:151], v169 offset:55296
    v_mfma_f32_16x16x32_bf16 v[88:91], v[172:175], v[112:115], v[88:91]
    v_mfma_f32_16x16x32_bf16 v[92:95], v[176:179], v[112:115], v[92:95]
    v_mfma_f32_16x16x32_bf16 v[56:59], v[120:123], v[116:119], v[56:59]
    v_mfma_f32_16x16x32_bf16 v[60:63], v[124:127], v[116:119], v[60:63]
    v_mfma_f32_16x16x32_bf16 v[64:67], v[116:119], v[128:131], v[64:67]
    v_mfma_f32_16x16x32_bf16 v[68:71], v[116:119], v[132:135], v[68:71]
    v_mfma_f32_16x16x32_bf16 v[96:99], v[172:175], v[116:119], v[96:99]
    v_mfma_f32_16x16x32_bf16 v[100:103], v[176:179], v[116:119], v[100:103]
    s_waitcnt lgkmcnt(0)
    s_barrier
    v_mfma_f32_16x16x32_bf16 v[8:11], v[152:155], v[136:139], v[8:11]
    ds_read_b128 v[104:107], v168 offset:0
    v_mfma_f32_16x16x32_bf16 v[12:15], v[156:159], v[136:139], v[12:15]
    ds_read_b64_tr_b16 v[120:121], v170 offset:0
    v_mfma_f32_16x16x32_bf16 v[16:19], v[136:139], v[160:163], v[16:19]
    ds_read_b64_tr_b16 v[122:123], v170 offset:512
    v_mfma_f32_16x16x32_bf16 v[20:23], v[136:139], v[164:167], v[20:23]
    ds_read_b64_tr_b16 v[124:125], v171 offset:0
    v_mfma_f32_16x16x32_bf16 v[72:75], v[180:183], v[136:139], v[72:75]
    ds_read_b64_tr_b16 v[126:127], v171 offset:512
    v_mfma_f32_16x16x32_bf16 v[76:79], v[184:187], v[136:139], v[76:79]
    ds_read_b128 v[108:111], v168 offset:2048
    v_mfma_f32_16x16x32_bf16 v[24:27], v[152:155], v[140:143], v[24:27]
    ds_read_b64_tr_b16 v[128:129], v170 offset:8192
    v_mfma_f32_16x16x32_bf16 v[28:31], v[156:159], v[140:143], v[28:31]
    ds_read_b64_tr_b16 v[130:131], v170 offset:8704
    v_mfma_f32_16x16x32_bf16 v[32:35], v[140:143], v[160:163], v[32:35]
    ds_read_b64_tr_b16 v[132:133], v171 offset:8192
    v_mfma_f32_16x16x32_bf16 v[36:39], v[140:143], v[164:167], v[36:39]
    ds_read_b64_tr_b16 v[134:135], v171 offset:8704
    v_mfma_f32_16x16x32_bf16 v[80:83], v[180:183], v[140:143], v[80:83]
    ds_read_b64_tr_b16 v[172:173], v188 offset:11520
    v_mfma_f32_16x16x32_bf16 v[84:87], v[184:187], v[140:143], v[84:87]
    ds_read_b64_tr_b16 v[174:175], v188 offset:12032
    v_mfma_f32_16x16x32_bf16 v[40:43], v[152:155], v[144:147], v[40:43]
    ds_read_b64_tr_b16 v[176:177], v189 offset:11520
    v_mfma_f32_16x16x32_bf16 v[44:47], v[156:159], v[144:147], v[44:47]
    ds_read_b64_tr_b16 v[178:179], v189 offset:12032
    v_mfma_f32_16x16x32_bf16 v[48:51], v[144:147], v[160:163], v[48:51]
    ds_read_b128 v[112:115], v168 offset:4096
    v_mfma_f32_16x16x32_bf16 v[52:55], v[144:147], v[164:167], v[52:55]
    ds_read_b128 v[116:119], v168 offset:6144
    v_mfma_f32_16x16x32_bf16 v[88:91], v[180:183], v[144:147], v[88:91]
    v_mfma_f32_16x16x32_bf16 v[92:95], v[184:187], v[144:147], v[92:95]
    v_mfma_f32_16x16x32_bf16 v[56:59], v[152:155], v[148:151], v[56:59]
    v_mfma_f32_16x16x32_bf16 v[60:63], v[156:159], v[148:151], v[60:63]
    v_mfma_f32_16x16x32_bf16 v[64:67], v[148:151], v[160:163], v[64:67]
    v_mfma_f32_16x16x32_bf16 v[68:71], v[148:151], v[164:167], v[68:71]
    v_mfma_f32_16x16x32_bf16 v[96:99], v[180:183], v[148:151], v[96:99]
    v_mfma_f32_16x16x32_bf16 v[100:103], v[184:187], v[148:151], v[100:103]
    s_waitcnt lgkmcnt(0)
    v_mfma_f32_16x16x32_bf16 v[8:11], v[120:123], v[104:107], v[8:11]
    ds_read_b128 v[136:139], v169 offset:0
    v_mfma_f32_16x16x32_bf16 v[12:15], v[124:127], v[104:107], v[12:15]
    ds_read_b64_tr_b16 v[152:153], v170 offset:4096
    v_mfma_f32_16x16x32_bf16 v[16:19], v[104:107], v[128:131], v[16:19]
    ds_read_b64_tr_b16 v[154:155], v170 offset:4608
    v_mfma_f32_16x16x32_bf16 v[20:23], v[104:107], v[132:135], v[20:23]
    ds_read_b64_tr_b16 v[156:157], v171 offset:4096
    v_mfma_f32_16x16x32_bf16 v[72:75], v[172:175], v[104:107], v[72:75]
    ds_read_b64_tr_b16 v[158:159], v171 offset:4608
    v_mfma_f32_16x16x32_bf16 v[76:79], v[176:179], v[104:107], v[76:79]
    ds_read_b128 v[140:143], v169 offset:2048
    v_mfma_f32_16x16x32_bf16 v[24:27], v[120:123], v[108:111], v[24:27]
    ds_read_b64_tr_b16 v[160:161], v170 offset:12288
    v_mfma_f32_16x16x32_bf16 v[28:31], v[124:127], v[108:111], v[28:31]
    ds_read_b64_tr_b16 v[162:163], v170 offset:12800
    v_mfma_f32_16x16x32_bf16 v[32:35], v[108:111], v[128:131], v[32:35]
    ds_read_b64_tr_b16 v[164:165], v171 offset:12288
    v_mfma_f32_16x16x32_bf16 v[36:39], v[108:111], v[132:135], v[36:39]
    ds_read_b64_tr_b16 v[166:167], v171 offset:12800
    v_mfma_f32_16x16x32_bf16 v[80:83], v[172:175], v[108:111], v[80:83]
    ds_read_b64_tr_b16 v[180:181], v188 offset:15616
    v_mfma_f32_16x16x32_bf16 v[84:87], v[176:179], v[108:111], v[84:87]
    ds_read_b64_tr_b16 v[182:183], v188 offset:16128
    v_mfma_f32_16x16x32_bf16 v[40:43], v[120:123], v[112:115], v[40:43]
    ds_read_b64_tr_b16 v[184:185], v189 offset:15616
    v_mfma_f32_16x16x32_bf16 v[44:47], v[124:127], v[112:115], v[44:47]
    ds_read_b64_tr_b16 v[186:187], v189 offset:16128
    v_mfma_f32_16x16x32_bf16 v[48:51], v[112:115], v[128:131], v[48:51]
    ds_read_b128 v[144:147], v169 offset:4096
    v_mfma_f32_16x16x32_bf16 v[52:55], v[112:115], v[132:135], v[52:55]
    ds_read_b128 v[148:151], v169 offset:6144
    v_mfma_f32_16x16x32_bf16 v[88:91], v[172:175], v[112:115], v[88:91]
    v_mfma_f32_16x16x32_bf16 v[92:95], v[176:179], v[112:115], v[92:95]
    v_mfma_f32_16x16x32_bf16 v[56:59], v[120:123], v[116:119], v[56:59]
    v_mfma_f32_16x16x32_bf16 v[60:63], v[124:127], v[116:119], v[60:63]
    v_mfma_f32_16x16x32_bf16 v[64:67], v[116:119], v[128:131], v[64:67]
    v_mfma_f32_16x16x32_bf16 v[68:71], v[116:119], v[132:135], v[68:71]
    v_mfma_f32_16x16x32_bf16 v[96:99], v[172:175], v[116:119], v[96:99]
    v_mfma_f32_16x16x32_bf16 v[100:103], v[176:179], v[116:119], v[100:103]
    s_waitcnt lgkmcnt(0)
    s_barrier
    v_mfma_f32_16x16x32_bf16 v[8:11], v[152:155], v[136:139], v[8:11]
    ds_read_b128 v[104:107], v168 offset:16384
    v_mfma_f32_16x16x32_bf16 v[12:15], v[156:159], v[136:139], v[12:15]
    ds_read_b64_tr_b16 v[120:121], v170 offset:16384
    v_mfma_f32_16x16x32_bf16 v[16:19], v[136:139], v[160:163], v[16:19]
    ds_read_b64_tr_b16 v[122:123], v170 offset:16896
    v_mfma_f32_16x16x32_bf16 v[20:23], v[136:139], v[164:167], v[20:23]
    ds_read_b64_tr_b16 v[124:125], v171 offset:16384
    v_mfma_f32_16x16x32_bf16 v[72:75], v[180:183], v[136:139], v[72:75]
    ds_read_b64_tr_b16 v[126:127], v171 offset:16896
    v_mfma_f32_16x16x32_bf16 v[76:79], v[184:187], v[136:139], v[76:79]
    ds_read_b128 v[108:111], v168 offset:18432
    v_mfma_f32_16x16x32_bf16 v[24:27], v[152:155], v[140:143], v[24:27]
    ds_read_b64_tr_b16 v[128:129], v170 offset:24576
    v_mfma_f32_16x16x32_bf16 v[28:31], v[156:159], v[140:143], v[28:31]
    ds_read_b64_tr_b16 v[130:131], v170 offset:25088
    v_mfma_f32_16x16x32_bf16 v[32:35], v[140:143], v[160:163], v[32:35]
    ds_read_b64_tr_b16 v[132:133], v171 offset:24576
    v_mfma_f32_16x16x32_bf16 v[36:39], v[140:143], v[164:167], v[36:39]
    ds_read_b64_tr_b16 v[134:135], v171 offset:25088
    v_mfma_f32_16x16x32_bf16 v[80:83], v[180:183], v[140:143], v[80:83]
    ds_read_b64_tr_b16 v[172:173], v188 offset:19712
    v_mfma_f32_16x16x32_bf16 v[84:87], v[184:187], v[140:143], v[84:87]
    ds_read_b64_tr_b16 v[174:175], v188 offset:20224
    v_mfma_f32_16x16x32_bf16 v[40:43], v[152:155], v[144:147], v[40:43]
    ds_read_b64_tr_b16 v[176:177], v189 offset:19712
    v_mfma_f32_16x16x32_bf16 v[44:47], v[156:159], v[144:147], v[44:47]
    ds_read_b64_tr_b16 v[178:179], v189 offset:20224
    v_mfma_f32_16x16x32_bf16 v[48:51], v[144:147], v[160:163], v[48:51]
    ds_read_b128 v[112:115], v168 offset:20480
    v_mfma_f32_16x16x32_bf16 v[52:55], v[144:147], v[164:167], v[52:55]
    ds_read_b128 v[116:119], v168 offset:22528
    v_mfma_f32_16x16x32_bf16 v[88:91], v[180:183], v[144:147], v[88:91]
    v_mfma_f32_16x16x32_bf16 v[92:95], v[184:187], v[144:147], v[92:95]
    v_mfma_f32_16x16x32_bf16 v[56:59], v[152:155], v[148:151], v[56:59]
    v_mfma_f32_16x16x32_bf16 v[60:63], v[156:159], v[148:151], v[60:63]
    v_mfma_f32_16x16x32_bf16 v[64:67], v[148:151], v[160:163], v[64:67]
    v_mfma_f32_16x16x32_bf16 v[68:71], v[148:151], v[164:167], v[68:71]
    v_mfma_f32_16x16x32_bf16 v[96:99], v[180:183], v[148:151], v[96:99]
    v_mfma_f32_16x16x32_bf16 v[100:103], v[184:187], v[148:151], v[100:103]
    s_waitcnt lgkmcnt(0)
    v_mfma_f32_16x16x32_bf16 v[8:11], v[120:123], v[104:107], v[8:11]
    ds_read_b128 v[136:139], v169 offset:16384
    v_mfma_f32_16x16x32_bf16 v[12:15], v[124:127], v[104:107], v[12:15]
    ds_read_b64_tr_b16 v[152:153], v170 offset:20480
    v_mfma_f32_16x16x32_bf16 v[16:19], v[104:107], v[128:131], v[16:19]
    ds_read_b64_tr_b16 v[154:155], v170 offset:20992
    v_mfma_f32_16x16x32_bf16 v[20:23], v[104:107], v[132:135], v[20:23]
    ds_read_b64_tr_b16 v[156:157], v171 offset:20480
    v_mfma_f32_16x16x32_bf16 v[72:75], v[172:175], v[104:107], v[72:75]
    ds_read_b64_tr_b16 v[158:159], v171 offset:20992
    v_mfma_f32_16x16x32_bf16 v[76:79], v[176:179], v[104:107], v[76:79]
    ds_read_b128 v[140:143], v169 offset:18432
    v_mfma_f32_16x16x32_bf16 v[24:27], v[120:123], v[108:111], v[24:27]
    ds_read_b64_tr_b16 v[160:161], v170 offset:28672
    v_mfma_f32_16x16x32_bf16 v[28:31], v[124:127], v[108:111], v[28:31]
    ds_read_b64_tr_b16 v[162:163], v170 offset:29184
    v_mfma_f32_16x16x32_bf16 v[32:35], v[108:111], v[128:131], v[32:35]
    ds_read_b64_tr_b16 v[164:165], v171 offset:28672
    v_mfma_f32_16x16x32_bf16 v[36:39], v[108:111], v[132:135], v[36:39]
    ds_read_b64_tr_b16 v[166:167], v171 offset:29184
    v_mfma_f32_16x16x32_bf16 v[80:83], v[172:175], v[108:111], v[80:83]
    ds_read_b64_tr_b16 v[180:181], v188 offset:23808
    v_mfma_f32_16x16x32_bf16 v[84:87], v[176:179], v[108:111], v[84:87]
    ds_read_b64_tr_b16 v[182:183], v188 offset:24320
    v_mfma_f32_16x16x32_bf16 v[40:43], v[120:123], v[112:115], v[40:43]
    ds_read_b64_tr_b16 v[184:185], v189 offset:23808
    v_mfma_f32_16x16x32_bf16 v[44:47], v[124:127], v[112:115], v[44:47]
    ds_read_b64_tr_b16 v[186:187], v189 offset:24320
    v_mfma_f32_16x16x32_bf16 v[48:51], v[112:115], v[128:131], v[48:51]
    ds_read_b128 v[144:147], v169 offset:20480
    v_mfma_f32_16x16x32_bf16 v[52:55], v[112:115], v[132:135], v[52:55]
    ds_read_b128 v[148:151], v169 offset:22528
    v_mfma_f32_16x16x32_bf16 v[88:91], v[172:175], v[112:115], v[88:91]
    v_mfma_f32_16x16x32_bf16 v[92:95], v[176:179], v[112:115], v[92:95]
    v_mfma_f32_16x16x32_bf16 v[56:59], v[120:123], v[116:119], v[56:59]
    v_mfma_f32_16x16x32_bf16 v[60:63], v[124:127], v[116:119], v[60:63]
    v_mfma_f32_16x16x32_bf16 v[64:67], v[116:119], v[128:131], v[64:67]
    v_mfma_f32_16x16x32_bf16 v[68:71], v[116:119], v[132:135], v[68:71]
    v_mfma_f32_16x16x32_bf16 v[96:99], v[172:175], v[116:119], v[96:99]
    v_mfma_f32_16x16x32_bf16 v[100:103], v[176:179], v[116:119], v[100:103]
    s_waitcnt lgkmcnt(0)
    s_barrier
    v_mfma_f32_16x16x32_bf16 v[8:11], v[152:155], v[136:139], v[8:11]
    ds_read_b128 v[104:107], v168 offset:32768
    v_mfma_f32_16x16x32_bf16 v[12:15], v[156:159], v[136:139], v[12:15]
    ds_read_b64_tr_b16 v[120:121], v170 offset:32768
    v_mfma_f32_16x16x32_bf16 v[16:19], v[136:139], v[160:163], v[16:19]
    ds_read_b64_tr_b16 v[122:123], v170 offset:33280
    v_mfma_f32_16x16x32_bf16 v[20:23], v[136:139], v[164:167], v[20:23]
    ds_read_b64_tr_b16 v[124:125], v171 offset:32768
    v_mfma_f32_16x16x32_bf16 v[72:75], v[180:183], v[136:139], v[72:75]
    ds_read_b64_tr_b16 v[126:127], v171 offset:33280
    v_mfma_f32_16x16x32_bf16 v[76:79], v[184:187], v[136:139], v[76:79]
    ds_read_b128 v[108:111], v168 offset:34816
    v_mfma_f32_16x16x32_bf16 v[24:27], v[152:155], v[140:143], v[24:27]
    ds_read_b64_tr_b16 v[128:129], v170 offset:40960
    v_mfma_f32_16x16x32_bf16 v[28:31], v[156:159], v[140:143], v[28:31]
    ds_read_b64_tr_b16 v[130:131], v170 offset:41472
    v_mfma_f32_16x16x32_bf16 v[32:35], v[140:143], v[160:163], v[32:35]
    ds_read_b64_tr_b16 v[132:133], v171 offset:40960
    v_mfma_f32_16x16x32_bf16 v[36:39], v[140:143], v[164:167], v[36:39]
    ds_read_b64_tr_b16 v[134:135], v171 offset:41472
    v_mfma_f32_16x16x32_bf16 v[80:83], v[180:183], v[140:143], v[80:83]
    ds_read_b128 v[112:115], v168 offset:36864
    v_mfma_f32_16x16x32_bf16 v[84:87], v[184:187], v[140:143], v[84:87]
    ds_read_b128 v[116:119], v168 offset:38912
    v_mfma_f32_16x16x32_bf16 v[40:43], v[152:155], v[144:147], v[40:43]
    v_mfma_f32_16x16x32_bf16 v[44:47], v[156:159], v[144:147], v[44:47]
    v_mfma_f32_16x16x32_bf16 v[48:51], v[144:147], v[160:163], v[48:51]
    v_mfma_f32_16x16x32_bf16 v[52:55], v[144:147], v[164:167], v[52:55]
    v_mfma_f32_16x16x32_bf16 v[88:91], v[180:183], v[144:147], v[88:91]
    v_mfma_f32_16x16x32_bf16 v[92:95], v[184:187], v[144:147], v[92:95]
    v_mfma_f32_16x16x32_bf16 v[56:59], v[152:155], v[148:151], v[56:59]
    v_mfma_f32_16x16x32_bf16 v[60:63], v[156:159], v[148:151], v[60:63]
    v_mfma_f32_16x16x32_bf16 v[64:67], v[148:151], v[160:163], v[64:67]
    v_mfma_f32_16x16x32_bf16 v[68:71], v[148:151], v[164:167], v[68:71]
    v_mfma_f32_16x16x32_bf16 v[96:99], v[180:183], v[148:151], v[96:99]
    v_mfma_f32_16x16x32_bf16 v[100:103], v[184:187], v[148:151], v[100:103]
    s_waitcnt lgkmcnt(0)
    v_mfma_f32_16x16x32_bf16 v[8:11], v[120:123], v[104:107], v[8:11]
    ds_read_b128 v[136:139], v169 offset:32768
    v_mfma_f32_16x16x32_bf16 v[12:15], v[124:127], v[104:107], v[12:15]
    ds_read_b64_tr_b16 v[152:153], v170 offset:36864
    v_mfma_f32_16x16x32_bf16 v[16:19], v[104:107], v[128:131], v[16:19]
    ds_read_b64_tr_b16 v[154:155], v170 offset:37376
    v_mfma_f32_16x16x32_bf16 v[20:23], v[104:107], v[132:135], v[20:23]
    ds_read_b64_tr_b16 v[156:157], v171 offset:36864
    v_mfma_f32_16x16x32_bf16 v[24:27], v[120:123], v[108:111], v[24:27]
    ds_read_b64_tr_b16 v[158:159], v171 offset:37376
    v_mfma_f32_16x16x32_bf16 v[28:31], v[124:127], v[108:111], v[28:31]
    ds_read_b128 v[140:143], v169 offset:34816
    v_mfma_f32_16x16x32_bf16 v[32:35], v[108:111], v[128:131], v[32:35]
    ds_read_b64_tr_b16 v[160:161], v170 offset:45056
    v_mfma_f32_16x16x32_bf16 v[36:39], v[108:111], v[132:135], v[36:39]
    ds_read_b64_tr_b16 v[162:163], v170 offset:45568
    v_mfma_f32_16x16x32_bf16 v[40:43], v[120:123], v[112:115], v[40:43]
    ds_read_b64_tr_b16 v[164:165], v171 offset:45056
    v_mfma_f32_16x16x32_bf16 v[44:47], v[124:127], v[112:115], v[44:47]
    ds_read_b64_tr_b16 v[166:167], v171 offset:45568
    v_mfma_f32_16x16x32_bf16 v[48:51], v[112:115], v[128:131], v[48:51]
    ds_read_b128 v[144:147], v169 offset:36864
    v_mfma_f32_16x16x32_bf16 v[52:55], v[112:115], v[132:135], v[52:55]
    ds_read_b128 v[148:151], v169 offset:38912
    v_mfma_f32_16x16x32_bf16 v[56:59], v[120:123], v[116:119], v[56:59]
    v_mfma_f32_16x16x32_bf16 v[60:63], v[124:127], v[116:119], v[60:63]
    v_mfma_f32_16x16x32_bf16 v[64:67], v[116:119], v[128:131], v[64:67]
    v_mfma_f32_16x16x32_bf16 v[68:71], v[116:119], v[132:135], v[68:71]
    s_waitcnt lgkmcnt(0)
    s_barrier
    v_mfma_f32_16x16x32_bf16 v[8:11], v[152:155], v[136:139], v[8:11]
    ds_read_b128 v[104:107], v168 offset:49152
    v_mfma_f32_16x16x32_bf16 v[12:15], v[156:159], v[136:139], v[12:15]
    ds_read_b64_tr_b16 v[120:121], v170 offset:49152
    v_mfma_f32_16x16x32_bf16 v[16:19], v[136:139], v[160:163], v[16:19]
    ds_read_b64_tr_b16 v[122:123], v170 offset:49664
    v_mfma_f32_16x16x32_bf16 v[20:23], v[136:139], v[164:167], v[20:23]
    ds_read_b64_tr_b16 v[124:125], v171 offset:49152
    v_mfma_f32_16x16x32_bf16 v[24:27], v[152:155], v[140:143], v[24:27]
    ds_read_b64_tr_b16 v[126:127], v171 offset:49664
    v_mfma_f32_16x16x32_bf16 v[28:31], v[156:159], v[140:143], v[28:31]
    ds_read_b128 v[108:111], v168 offset:51200
    v_mfma_f32_16x16x32_bf16 v[32:35], v[140:143], v[160:163], v[32:35]
    ds_read_b64_tr_b16 v[128:129], v170 offset:57344
    v_mfma_f32_16x16x32_bf16 v[36:39], v[140:143], v[164:167], v[36:39]
    ds_read_b64_tr_b16 v[130:131], v170 offset:57856
    v_mfma_f32_16x16x32_bf16 v[40:43], v[152:155], v[144:147], v[40:43]
    ds_read_b64_tr_b16 v[132:133], v171 offset:57344
    v_mfma_f32_16x16x32_bf16 v[44:47], v[156:159], v[144:147], v[44:47]
    ds_read_b64_tr_b16 v[134:135], v171 offset:57856
    v_mfma_f32_16x16x32_bf16 v[48:51], v[144:147], v[160:163], v[48:51]
    ds_read_b128 v[112:115], v168 offset:53248
    v_mfma_f32_16x16x32_bf16 v[52:55], v[144:147], v[164:167], v[52:55]
    ds_read_b128 v[116:119], v168 offset:55296
    v_mfma_f32_16x16x32_bf16 v[56:59], v[152:155], v[148:151], v[56:59]
    v_mfma_f32_16x16x32_bf16 v[60:63], v[156:159], v[148:151], v[60:63]
    v_mfma_f32_16x16x32_bf16 v[64:67], v[148:151], v[160:163], v[64:67]
    v_mfma_f32_16x16x32_bf16 v[68:71], v[148:151], v[164:167], v[68:71]
    s_waitcnt lgkmcnt(0)
    v_mfma_f32_16x16x32_bf16 v[8:11], v[120:123], v[104:107], v[8:11]
    ds_read_b128 v[136:139], v169 offset:49152
    v_mfma_f32_16x16x32_bf16 v[12:15], v[124:127], v[104:107], v[12:15]
    ds_read_b64_tr_b16 v[152:153], v170 offset:53248
    v_mfma_f32_16x16x32_bf16 v[16:19], v[104:107], v[128:131], v[16:19]
    ds_read_b64_tr_b16 v[154:155], v170 offset:53760
    v_mfma_f32_16x16x32_bf16 v[20:23], v[104:107], v[132:135], v[20:23]
    ds_read_b64_tr_b16 v[156:157], v171 offset:53248
    v_mfma_f32_16x16x32_bf16 v[24:27], v[120:123], v[108:111], v[24:27]
    ds_read_b64_tr_b16 v[158:159], v171 offset:53760
    v_mfma_f32_16x16x32_bf16 v[28:31], v[124:127], v[108:111], v[28:31]
    ds_read_b128 v[140:143], v169 offset:51200
    v_mfma_f32_16x16x32_bf16 v[32:35], v[108:111], v[128:131], v[32:35]
    ds_read_b64_tr_b16 v[160:161], v170 offset:61440
    v_mfma_f32_16x16x32_bf16 v[36:39], v[108:111], v[132:135], v[36:39]
    ds_read_b64_tr_b16 v[162:163], v170 offset:61952
    v_mfma_f32_16x16x32_bf16 v[40:43], v[120:123], v[112:115], v[40:43]
    ds_read_b64_tr_b16 v[164:165], v171 offset:61440
    v_mfma_f32_16x16x32_bf16 v[44:47], v[124:127], v[112:115], v[44:47]
    ds_read_b64_tr_b16 v[166:167], v171 offset:61952
    v_mfma_f32_16x16x32_bf16 v[48:51], v[112:115], v[128:131], v[48:51]
    ds_read_b128 v[144:147], v169 offset:53248
    v_mfma_f32_16x16x32_bf16 v[52:55], v[112:115], v[132:135], v[52:55]
    ds_read_b128 v[148:151], v169 offset:55296
    v_mfma_f32_16x16x32_bf16 v[56:59], v[120:123], v[116:119], v[56:59]
    v_mfma_f32_16x16x32_bf16 v[60:63], v[124:127], v[116:119], v[60:63]
    v_mfma_f32_16x16x32_bf16 v[64:67], v[116:119], v[128:131], v[64:67]
    v_mfma_f32_16x16x32_bf16 v[68:71], v[116:119], v[132:135], v[68:71]
    s_waitcnt lgkmcnt(0)
    s_barrier
    v_mfma_f32_16x16x32_bf16 v[8:11], v[152:155], v[136:139], v[8:11]
    ds_read_b128 v[104:107], v168 offset:0
    v_mfma_f32_16x16x32_bf16 v[12:15], v[156:159], v[136:139], v[12:15]
    ds_read_b64_tr_b16 v[120:121], v170 offset:0
    v_mfma_f32_16x16x32_bf16 v[16:19], v[136:139], v[160:163], v[16:19]
    ds_read_b64_tr_b16 v[122:123], v170 offset:512
    v_mfma_f32_16x16x32_bf16 v[20:23], v[136:139], v[164:167], v[20:23]
    ds_read_b64_tr_b16 v[124:125], v171 offset:0
    v_mfma_f32_16x16x32_bf16 v[24:27], v[152:155], v[140:143], v[24:27]
    ds_read_b64_tr_b16 v[126:127], v171 offset:512
    v_mfma_f32_16x16x32_bf16 v[28:31], v[156:159], v[140:143], v[28:31]
    ds_read_b128 v[108:111], v168 offset:2048
    v_mfma_f32_16x16x32_bf16 v[32:35], v[140:143], v[160:163], v[32:35]
    ds_read_b64_tr_b16 v[128:129], v170 offset:8192
    v_mfma_f32_16x16x32_bf16 v[36:39], v[140:143], v[164:167], v[36:39]
    ds_read_b64_tr_b16 v[130:131], v170 offset:8704
    v_mfma_f32_16x16x32_bf16 v[40:43], v[152:155], v[144:147], v[40:43]
    ds_read_b64_tr_b16 v[132:133], v171 offset:8192
    v_mfma_f32_16x16x32_bf16 v[44:47], v[156:159], v[144:147], v[44:47]
    ds_read_b64_tr_b16 v[134:135], v171 offset:8704
    v_mfma_f32_16x16x32_bf16 v[48:51], v[144:147], v[160:163], v[48:51]
    ds_read_b128 v[112:115], v168 offset:4096
    v_mfma_f32_16x16x32_bf16 v[52:55], v[144:147], v[164:167], v[52:55]
    ds_read_b128 v[116:119], v168 offset:6144
    v_mfma_f32_16x16x32_bf16 v[56:59], v[152:155], v[148:151], v[56:59]
    v_mfma_f32_16x16x32_bf16 v[60:63], v[156:159], v[148:151], v[60:63]
    v_mfma_f32_16x16x32_bf16 v[64:67], v[148:151], v[160:163], v[64:67]
    v_mfma_f32_16x16x32_bf16 v[68:71], v[148:151], v[164:167], v[68:71]
    s_waitcnt lgkmcnt(0)
    v_mfma_f32_16x16x32_bf16 v[8:11], v[120:123], v[104:107], v[8:11]
    ds_read_b128 v[136:139], v169 offset:0
    v_mfma_f32_16x16x32_bf16 v[12:15], v[124:127], v[104:107], v[12:15]
    ds_read_b64_tr_b16 v[152:153], v170 offset:4096
    v_mfma_f32_16x16x32_bf16 v[16:19], v[104:107], v[128:131], v[16:19]
    ds_read_b64_tr_b16 v[154:155], v170 offset:4608
    v_mfma_f32_16x16x32_bf16 v[20:23], v[104:107], v[132:135], v[20:23]
    ds_read_b64_tr_b16 v[156:157], v171 offset:4096
    v_mfma_f32_16x16x32_bf16 v[24:27], v[120:123], v[108:111], v[24:27]
    ds_read_b64_tr_b16 v[158:159], v171 offset:4608
    v_mfma_f32_16x16x32_bf16 v[28:31], v[124:127], v[108:111], v[28:31]
    ds_read_b128 v[140:143], v169 offset:2048
    v_mfma_f32_16x16x32_bf16 v[32:35], v[108:111], v[128:131], v[32:35]
    ds_read_b64_tr_b16 v[160:161], v170 offset:12288
    v_mfma_f32_16x16x32_bf16 v[36:39], v[108:111], v[132:135], v[36:39]
    ds_read_b64_tr_b16 v[162:163], v170 offset:12800
    v_mfma_f32_16x16x32_bf16 v[40:43], v[120:123], v[112:115], v[40:43]
    ds_read_b64_tr_b16 v[164:165], v171 offset:12288
    v_mfma_f32_16x16x32_bf16 v[44:47], v[124:127], v[112:115], v[44:47]
    ds_read_b64_tr_b16 v[166:167], v171 offset:12800
    v_mfma_f32_16x16x32_bf16 v[48:51], v[112:115], v[128:131], v[48:51]
    ds_read_b128 v[144:147], v169 offset:4096
    v_mfma_f32_16x16x32_bf16 v[52:55], v[112:115], v[132:135], v[52:55]
    ds_read_b128 v[148:151], v169 offset:6144
    v_mfma_f32_16x16x32_bf16 v[56:59], v[120:123], v[116:119], v[56:59]
    v_mfma_f32_16x16x32_bf16 v[60:63], v[124:127], v[116:119], v[60:63]
    v_mfma_f32_16x16x32_bf16 v[64:67], v[116:119], v[128:131], v[64:67]
    v_mfma_f32_16x16x32_bf16 v[68:71], v[116:119], v[132:135], v[68:71]
    s_waitcnt lgkmcnt(0)
    s_barrier
    v_mfma_f32_16x16x32_bf16 v[8:11], v[152:155], v[136:139], v[8:11]
    ds_read_b128 v[104:107], v168 offset:16384
    v_mfma_f32_16x16x32_bf16 v[12:15], v[156:159], v[136:139], v[12:15]
    ds_read_b64_tr_b16 v[120:121], v170 offset:16384
    v_mfma_f32_16x16x32_bf16 v[16:19], v[136:139], v[160:163], v[16:19]
    ds_read_b64_tr_b16 v[122:123], v170 offset:16896
    v_mfma_f32_16x16x32_bf16 v[20:23], v[136:139], v[164:167], v[20:23]
    ds_read_b64_tr_b16 v[124:125], v171 offset:16384
    v_mfma_f32_16x16x32_bf16 v[24:27], v[152:155], v[140:143], v[24:27]
    ds_read_b64_tr_b16 v[126:127], v171 offset:16896
    v_mfma_f32_16x16x32_bf16 v[28:31], v[156:159], v[140:143], v[28:31]
    ds_read_b128 v[108:111], v168 offset:18432
    v_mfma_f32_16x16x32_bf16 v[32:35], v[140:143], v[160:163], v[32:35]
    ds_read_b64_tr_b16 v[128:129], v170 offset:24576
    v_mfma_f32_16x16x32_bf16 v[36:39], v[140:143], v[164:167], v[36:39]
    ds_read_b64_tr_b16 v[130:131], v170 offset:25088
    v_mfma_f32_16x16x32_bf16 v[40:43], v[152:155], v[144:147], v[40:43]
    ds_read_b64_tr_b16 v[132:133], v171 offset:24576
    v_mfma_f32_16x16x32_bf16 v[44:47], v[156:159], v[144:147], v[44:47]
    ds_read_b64_tr_b16 v[134:135], v171 offset:25088
    v_mfma_f32_16x16x32_bf16 v[48:51], v[144:147], v[160:163], v[48:51]
    ds_read_b128 v[112:115], v168 offset:20480
    v_mfma_f32_16x16x32_bf16 v[52:55], v[144:147], v[164:167], v[52:55]
    ds_read_b128 v[116:119], v168 offset:22528
    v_mfma_f32_16x16x32_bf16 v[56:59], v[152:155], v[148:151], v[56:59]
    v_mfma_f32_16x16x32_bf16 v[60:63], v[156:159], v[148:151], v[60:63]
    v_mfma_f32_16x16x32_bf16 v[64:67], v[148:151], v[160:163], v[64:67]
    v_mfma_f32_16x16x32_bf16 v[68:71], v[148:151], v[164:167], v[68:71]
    s_waitcnt lgkmcnt(0)
    v_mfma_f32_16x16x32_bf16 v[8:11], v[120:123], v[104:107], v[8:11]
    ds_read_b128 v[136:139], v169 offset:16384
    v_mfma_f32_16x16x32_bf16 v[12:15], v[124:127], v[104:107], v[12:15]
    ds_read_b64_tr_b16 v[152:153], v170 offset:20480
    v_mfma_f32_16x16x32_bf16 v[16:19], v[104:107], v[128:131], v[16:19]
    ds_read_b64_tr_b16 v[154:155], v170 offset:20992
    v_mfma_f32_16x16x32_bf16 v[20:23], v[104:107], v[132:135], v[20:23]
    ds_read_b64_tr_b16 v[156:157], v171 offset:20480
    v_mfma_f32_16x16x32_bf16 v[24:27], v[120:123], v[108:111], v[24:27]
    ds_read_b64_tr_b16 v[158:159], v171 offset:20992
    v_mfma_f32_16x16x32_bf16 v[28:31], v[124:127], v[108:111], v[28:31]
    ds_read_b128 v[140:143], v169 offset:18432
    v_mfma_f32_16x16x32_bf16 v[32:35], v[108:111], v[128:131], v[32:35]
    ds_read_b64_tr_b16 v[160:161], v170 offset:28672
    v_mfma_f32_16x16x32_bf16 v[36:39], v[108:111], v[132:135], v[36:39]
    ds_read_b64_tr_b16 v[162:163], v170 offset:29184
    v_mfma_f32_16x16x32_bf16 v[40:43], v[120:123], v[112:115], v[40:43]
    ds_read_b64_tr_b16 v[164:165], v171 offset:28672
    v_mfma_f32_16x16x32_bf16 v[44:47], v[124:127], v[112:115], v[44:47]
    ds_read_b64_tr_b16 v[166:167], v171 offset:29184
    v_mfma_f32_16x16x32_bf16 v[48:51], v[112:115], v[128:131], v[48:51]
    ds_read_b128 v[144:147], v169 offset:20480
    v_mfma_f32_16x16x32_bf16 v[52:55], v[112:115], v[132:135], v[52:55]
    ds_read_b128 v[148:151], v169 offset:22528
    v_mfma_f32_16x16x32_bf16 v[56:59], v[120:123], v[116:119], v[56:59]
    v_mfma_f32_16x16x32_bf16 v[60:63], v[124:127], v[116:119], v[60:63]
    v_mfma_f32_16x16x32_bf16 v[64:67], v[116:119], v[128:131], v[64:67]
    v_mfma_f32_16x16x32_bf16 v[68:71], v[116:119], v[132:135], v[68:71]
    s_waitcnt lgkmcnt(0)
    s_barrier
    v_mfma_f32_16x16x32_bf16 v[8:11], v[152:155], v[136:139], v[8:11]
    ds_read_b128 v[104:107], v168 offset:32768
    v_mfma_f32_16x16x32_bf16 v[12:15], v[156:159], v[136:139], v[12:15]
    ds_read_b64_tr_b16 v[120:121], v170 offset:32768
    v_mfma_f32_16x16x32_bf16 v[16:19], v[136:139], v[160:163], v[16:19]
    ds_read_b64_tr_b16 v[122:123], v170 offset:33280
    v_mfma_f32_16x16x32_bf16 v[20:23], v[136:139], v[164:167], v[20:23]
    ds_read_b64_tr_b16 v[124:125], v171 offset:32768
    v_mfma_f32_16x16x32_bf16 v[24:27], v[152:155], v[140:143], v[24:27]
    ds_read_b64_tr_b16 v[126:127], v171 offset:33280
    v_mfma_f32_16x16x32_bf16 v[28:31], v[156:159], v[140:143], v[28:31]
    ds_read_b128 v[108:111], v168 offset:34816
    v_mfma_f32_16x16x32_bf16 v[32:35], v[140:143], v[160:163], v[32:35]
    ds_read_b64_tr_b16 v[128:129], v170 offset:40960
    v_mfma_f32_16x16x32_bf16 v[36:39], v[140:143], v[164:167], v[36:39]
    ds_read_b64_tr_b16 v[130:131], v170 offset:41472
    v_mfma_f32_16x16x32_bf16 v[40:43], v[152:155], v[144:147], v[40:43]
    ds_read_b64_tr_b16 v[132:133], v171 offset:40960
    v_mfma_f32_16x16x32_bf16 v[44:47], v[156:159], v[144:147], v[44:47]
    ds_read_b64_tr_b16 v[134:135], v171 offset:41472
    v_mfma_f32_16x16x32_bf16 v[48:51], v[144:147], v[160:163], v[48:51]
    ds_read_b128 v[112:115], v168 offset:36864
    v_mfma_f32_16x16x32_bf16 v[52:55], v[144:147], v[164:167], v[52:55]
    ds_read_b128 v[116:119], v168 offset:38912
    v_mfma_f32_16x16x32_bf16 v[56:59], v[152:155], v[148:151], v[56:59]
    v_mfma_f32_16x16x32_bf16 v[60:63], v[156:159], v[148:151], v[60:63]
    v_mfma_f32_16x16x32_bf16 v[64:67], v[148:151], v[160:163], v[64:67]
    v_mfma_f32_16x16x32_bf16 v[68:71], v[148:151], v[164:167], v[68:71]
    s_waitcnt lgkmcnt(0)
    v_mfma_f32_16x16x32_bf16 v[8:11], v[120:123], v[104:107], v[8:11]
    ds_read_b128 v[136:139], v169 offset:32768
    v_mfma_f32_16x16x32_bf16 v[12:15], v[124:127], v[104:107], v[12:15]
    ds_read_b64_tr_b16 v[152:153], v170 offset:36864
    v_mfma_f32_16x16x32_bf16 v[16:19], v[104:107], v[128:131], v[16:19]
    ds_read_b64_tr_b16 v[154:155], v170 offset:37376
    v_mfma_f32_16x16x32_bf16 v[20:23], v[104:107], v[132:135], v[20:23]
    ds_read_b64_tr_b16 v[156:157], v171 offset:36864
    v_mfma_f32_16x16x32_bf16 v[24:27], v[120:123], v[108:111], v[24:27]
    ds_read_b64_tr_b16 v[158:159], v171 offset:37376
    v_mfma_f32_16x16x32_bf16 v[28:31], v[124:127], v[108:111], v[28:31]
    ds_read_b128 v[140:143], v169 offset:34816
    v_mfma_f32_16x16x32_bf16 v[32:35], v[108:111], v[128:131], v[32:35]
    ds_read_b64_tr_b16 v[160:161], v170 offset:45056
    v_mfma_f32_16x16x32_bf16 v[36:39], v[108:111], v[132:135], v[36:39]
    ds_read_b64_tr_b16 v[162:163], v170 offset:45568
    v_mfma_f32_16x16x32_bf16 v[40:43], v[120:123], v[112:115], v[40:43]
    ds_read_b64_tr_b16 v[164:165], v171 offset:45056
    v_mfma_f32_16x16x32_bf16 v[44:47], v[124:127], v[112:115], v[44:47]
    ds_read_b64_tr_b16 v[166:167], v171 offset:45568
    v_mfma_f32_16x16x32_bf16 v[48:51], v[112:115], v[128:131], v[48:51]
    ds_read_b128 v[144:147], v169 offset:36864
    v_mfma_f32_16x16x32_bf16 v[52:55], v[112:115], v[132:135], v[52:55]
    ds_read_b128 v[148:151], v169 offset:38912
    v_mfma_f32_16x16x32_bf16 v[56:59], v[120:123], v[116:119], v[56:59]
    v_mfma_f32_16x16x32_bf16 v[60:63], v[124:127], v[116:119], v[60:63]
    v_mfma_f32_16x16x32_bf16 v[64:67], v[116:119], v[128:131], v[64:67]
    v_mfma_f32_16x16x32_bf16 v[68:71], v[116:119], v[132:135], v[68:71]
    s_waitcnt lgkmcnt(0)
    s_barrier
    v_mfma_f32_16x16x32_bf16 v[8:11], v[152:155], v[136:139], v[8:11]
    ds_read_b128 v[104:107], v168 offset:49152
    v_mfma_f32_16x16x32_bf16 v[12:15], v[156:159], v[136:139], v[12:15]
    ds_read_b64_tr_b16 v[120:121], v170 offset:49152
    v_mfma_f32_16x16x32_bf16 v[16:19], v[136:139], v[160:163], v[16:19]
    ds_read_b64_tr_b16 v[122:123], v170 offset:49664
    v_mfma_f32_16x16x32_bf16 v[20:23], v[136:139], v[164:167], v[20:23]
    ds_read_b64_tr_b16 v[124:125], v171 offset:49152
    v_mfma_f32_16x16x32_bf16 v[24:27], v[152:155], v[140:143], v[24:27]
    ds_read_b64_tr_b16 v[126:127], v171 offset:49664
    v_mfma_f32_16x16x32_bf16 v[28:31], v[156:159], v[140:143], v[28:31]
    ds_read_b128 v[108:111], v168 offset:51200
    v_mfma_f32_16x16x32_bf16 v[32:35], v[140:143], v[160:163], v[32:35]
    ds_read_b64_tr_b16 v[128:129], v170 offset:57344
    v_mfma_f32_16x16x32_bf16 v[36:39], v[140:143], v[164:167], v[36:39]
    ds_read_b64_tr_b16 v[130:131], v170 offset:57856
    v_mfma_f32_16x16x32_bf16 v[40:43], v[152:155], v[144:147], v[40:43]
    ds_read_b64_tr_b16 v[132:133], v171 offset:57344
    v_mfma_f32_16x16x32_bf16 v[44:47], v[156:159], v[144:147], v[44:47]
    ds_read_b64_tr_b16 v[134:135], v171 offset:57856
    v_mfma_f32_16x16x32_bf16 v[48:51], v[144:147], v[160:163], v[48:51]
    ds_read_b128 v[112:115], v168 offset:53248
    v_mfma_f32_16x16x32_bf16 v[52:55], v[144:147], v[164:167], v[52:55]
    ds_read_b128 v[116:119], v168 offset:55296
    v_mfma_f32_16x16x32_bf16 v[56:59], v[152:155], v[148:151], v[56:59]
    v_mfma_f32_16x16x32_bf16 v[60:63], v[156:159], v[148:151], v[60:63]
    v_mfma_f32_16x16x32_bf16 v[64:67], v[148:151], v[160:163], v[64:67]
    v_mfma_f32_16x16x32_bf16 v[68:71], v[148:151], v[164:167], v[68:71]
    s_waitcnt lgkmcnt(0)
    v_mfma_f32_16x16x32_bf16 v[8:11], v[120:123], v[104:107], v[8:11]
    ds_read_b128 v[136:139], v169 offset:49152
    v_mfma_f32_16x16x32_bf16 v[12:15], v[124:127], v[104:107], v[12:15]
    ds_read_b64_tr_b16 v[152:153], v170 offset:53248
    v_mfma_f32_16x16x32_bf16 v[16:19], v[104:107], v[128:131], v[16:19]
    ds_read_b64_tr_b16 v[154:155], v170 offset:53760
    v_mfma_f32_16x16x32_bf16 v[20:23], v[104:107], v[132:135], v[20:23]
    ds_read_b64_tr_b16 v[156:157], v171 offset:53248
    v_mfma_f32_16x16x32_bf16 v[24:27], v[120:123], v[108:111], v[24:27]
    ds_read_b64_tr_b16 v[158:159], v171 offset:53760
    v_mfma_f32_16x16x32_bf16 v[28:31], v[124:127], v[108:111], v[28:31]
    ds_read_b128 v[140:143], v169 offset:51200
    v_mfma_f32_16x16x32_bf16 v[32:35], v[108:111], v[128:131], v[32:35]
    ds_read_b64_tr_b16 v[160:161], v170 offset:61440
    v_mfma_f32_16x16x32_bf16 v[36:39], v[108:111], v[132:135], v[36:39]
    ds_read_b64_tr_b16 v[162:163], v170 offset:61952
    v_mfma_f32_16x16x32_bf16 v[40:43], v[120:123], v[112:115], v[40:43]
    ds_read_b64_tr_b16 v[164:165], v171 offset:61440
    v_mfma_f32_16x16x32_bf16 v[44:47], v[124:127], v[112:115], v[44:47]
    ds_read_b64_tr_b16 v[166:167], v171 offset:61952
    v_mfma_f32_16x16x32_bf16 v[48:51], v[112:115], v[128:131], v[48:51]
    ds_read_b128 v[144:147], v169 offset:53248
    v_mfma_f32_16x16x32_bf16 v[52:55], v[112:115], v[132:135], v[52:55]
    ds_read_b128 v[148:151], v169 offset:55296
    v_mfma_f32_16x16x32_bf16 v[56:59], v[120:123], v[116:119], v[56:59]
    v_mfma_f32_16x16x32_bf16 v[60:63], v[124:127], v[116:119], v[60:63]
    v_mfma_f32_16x16x32_bf16 v[64:67], v[116:119], v[128:131], v[64:67]
    v_mfma_f32_16x16x32_bf16 v[68:71], v[116:119], v[132:135], v[68:71]
    s_waitcnt lgkmcnt(0)
    s_barrier
    v_mfma_f32_16x16x32_bf16 v[8:11], v[152:155], v[136:139], v[8:11]
    ds_read_b128 v[104:107], v168 offset:0
    v_mfma_f32_16x16x32_bf16 v[12:15], v[156:159], v[136:139], v[12:15]
    ds_read_b64_tr_b16 v[120:121], v170 offset:0
    v_mfma_f32_16x16x32_bf16 v[16:19], v[136:139], v[160:163], v[16:19]
    ds_read_b64_tr_b16 v[122:123], v170 offset:512
    v_mfma_f32_16x16x32_bf16 v[20:23], v[136:139], v[164:167], v[20:23]
    ds_read_b64_tr_b16 v[124:125], v171 offset:0
    v_mfma_f32_16x16x32_bf16 v[24:27], v[152:155], v[140:143], v[24:27]
    ds_read_b64_tr_b16 v[126:127], v171 offset:512
    v_mfma_f32_16x16x32_bf16 v[28:31], v[156:159], v[140:143], v[28:31]
    ds_read_b128 v[108:111], v168 offset:2048
    v_mfma_f32_16x16x32_bf16 v[32:35], v[140:143], v[160:163], v[32:35]
    ds_read_b64_tr_b16 v[128:129], v170 offset:8192
    v_mfma_f32_16x16x32_bf16 v[36:39], v[140:143], v[164:167], v[36:39]
    ds_read_b64_tr_b16 v[130:131], v170 offset:8704
    v_mfma_f32_16x16x32_bf16 v[40:43], v[152:155], v[144:147], v[40:43]
    ds_read_b64_tr_b16 v[132:133], v171 offset:8192
    v_mfma_f32_16x16x32_bf16 v[44:47], v[156:159], v[144:147], v[44:47]
    ds_read_b64_tr_b16 v[134:135], v171 offset:8704
    v_mfma_f32_16x16x32_bf16 v[48:51], v[144:147], v[160:163], v[48:51]
    ds_read_b128 v[112:115], v168 offset:4096
    v_mfma_f32_16x16x32_bf16 v[52:55], v[144:147], v[164:167], v[52:55]
    ds_read_b128 v[116:119], v168 offset:6144
    v_mfma_f32_16x16x32_bf16 v[56:59], v[152:155], v[148:151], v[56:59]
    v_mfma_f32_16x16x32_bf16 v[60:63], v[156:159], v[148:151], v[60:63]
    v_mfma_f32_16x16x32_bf16 v[64:67], v[148:151], v[160:163], v[64:67]
    v_mfma_f32_16x16x32_bf16 v[68:71], v[148:151], v[164:167], v[68:71]
    s_waitcnt lgkmcnt(0)
    v_mfma_f32_16x16x32_bf16 v[8:11], v[120:123], v[104:107], v[8:11]
    ds_read_b128 v[136:139], v169 offset:0
    v_mfma_f32_16x16x32_bf16 v[12:15], v[124:127], v[104:107], v[12:15]
    ds_read_b64_tr_b16 v[152:153], v170 offset:4096
    v_mfma_f32_16x16x32_bf16 v[16:19], v[104:107], v[128:131], v[16:19]
    ds_read_b64_tr_b16 v[154:155], v170 offset:4608
    v_mfma_f32_16x16x32_bf16 v[20:23], v[104:107], v[132:135], v[20:23]
    ds_read_b64_tr_b16 v[156:157], v171 offset:4096
    v_mfma_f32_16x16x32_bf16 v[24:27], v[120:123], v[108:111], v[24:27]
    ds_read_b64_tr_b16 v[158:159], v171 offset:4608
    v_mfma_f32_16x16x32_bf16 v[28:31], v[124:127], v[108:111], v[28:31]
    ds_read_b128 v[140:143], v169 offset:2048
    v_mfma_f32_16x16x32_bf16 v[32:35], v[108:111], v[128:131], v[32:35]
    ds_read_b64_tr_b16 v[160:161], v170 offset:12288
    v_mfma_f32_16x16x32_bf16 v[36:39], v[108:111], v[132:135], v[36:39]
    ds_read_b64_tr_b16 v[162:163], v170 offset:12800
    v_mfma_f32_16x16x32_bf16 v[40:43], v[120:123], v[112:115], v[40:43]
    ds_read_b64_tr_b16 v[164:165], v171 offset:12288
    v_mfma_f32_16x16x32_bf16 v[44:47], v[124:127], v[112:115], v[44:47]
    ds_read_b64_tr_b16 v[166:167], v171 offset:12800
    v_mfma_f32_16x16x32_bf16 v[48:51], v[112:115], v[128:131], v[48:51]
    ds_read_b128 v[144:147], v169 offset:4096
    v_mfma_f32_16x16x32_bf16 v[52:55], v[112:115], v[132:135], v[52:55]
    ds_read_b128 v[148:151], v169 offset:6144
    v_mfma_f32_16x16x32_bf16 v[56:59], v[120:123], v[116:119], v[56:59]
    v_mfma_f32_16x16x32_bf16 v[60:63], v[124:127], v[116:119], v[60:63]
    v_mfma_f32_16x16x32_bf16 v[64:67], v[116:119], v[128:131], v[64:67]
    v_mfma_f32_16x16x32_bf16 v[68:71], v[116:119], v[132:135], v[68:71]
    s_waitcnt lgkmcnt(0)
    s_barrier
    v_mfma_f32_16x16x32_bf16 v[8:11], v[152:155], v[136:139], v[8:11]
    ds_read_b128 v[104:107], v168 offset:16384
    v_mfma_f32_16x16x32_bf16 v[12:15], v[156:159], v[136:139], v[12:15]
    ds_read_b64_tr_b16 v[120:121], v170 offset:16384
    v_mfma_f32_16x16x32_bf16 v[16:19], v[136:139], v[160:163], v[16:19]
    ds_read_b64_tr_b16 v[122:123], v170 offset:16896
    v_mfma_f32_16x16x32_bf16 v[20:23], v[136:139], v[164:167], v[20:23]
    ds_read_b64_tr_b16 v[124:125], v171 offset:16384
    v_mfma_f32_16x16x32_bf16 v[24:27], v[152:155], v[140:143], v[24:27]
    ds_read_b64_tr_b16 v[126:127], v171 offset:16896
    v_mfma_f32_16x16x32_bf16 v[28:31], v[156:159], v[140:143], v[28:31]
    ds_read_b128 v[108:111], v168 offset:18432
    v_mfma_f32_16x16x32_bf16 v[32:35], v[140:143], v[160:163], v[32:35]
    ds_read_b64_tr_b16 v[128:129], v170 offset:24576
    v_mfma_f32_16x16x32_bf16 v[36:39], v[140:143], v[164:167], v[36:39]
    ds_read_b64_tr_b16 v[130:131], v170 offset:25088
    v_mfma_f32_16x16x32_bf16 v[40:43], v[152:155], v[144:147], v[40:43]
    ds_read_b64_tr_b16 v[132:133], v171 offset:24576
    v_mfma_f32_16x16x32_bf16 v[44:47], v[156:159], v[144:147], v[44:47]
    ds_read_b64_tr_b16 v[134:135], v171 offset:25088
    v_mfma_f32_16x16x32_bf16 v[48:51], v[144:147], v[160:163], v[48:51]
    ds_read_b128 v[112:115], v168 offset:20480
    v_mfma_f32_16x16x32_bf16 v[52:55], v[144:147], v[164:167], v[52:55]
    ds_read_b128 v[116:119], v168 offset:22528
    v_mfma_f32_16x16x32_bf16 v[56:59], v[152:155], v[148:151], v[56:59]
    v_mfma_f32_16x16x32_bf16 v[60:63], v[156:159], v[148:151], v[60:63]
    v_mfma_f32_16x16x32_bf16 v[64:67], v[148:151], v[160:163], v[64:67]
    v_mfma_f32_16x16x32_bf16 v[68:71], v[148:151], v[164:167], v[68:71]
    s_waitcnt lgkmcnt(0)
    v_mfma_f32_16x16x32_bf16 v[8:11], v[120:123], v[104:107], v[8:11]
    ds_read_b128 v[136:139], v169 offset:16384
    v_mfma_f32_16x16x32_bf16 v[12:15], v[124:127], v[104:107], v[12:15]
    ds_read_b64_tr_b16 v[152:153], v170 offset:20480
    v_mfma_f32_16x16x32_bf16 v[16:19], v[104:107], v[128:131], v[16:19]
    ds_read_b64_tr_b16 v[154:155], v170 offset:20992
    v_mfma_f32_16x16x32_bf16 v[20:23], v[104:107], v[132:135], v[20:23]
    ds_read_b64_tr_b16 v[156:157], v171 offset:20480
    v_mfma_f32_16x16x32_bf16 v[24:27], v[120:123], v[108:111], v[24:27]
    ds_read_b64_tr_b16 v[158:159], v171 offset:20992
    v_mfma_f32_16x16x32_bf16 v[28:31], v[124:127], v[108:111], v[28:31]
    ds_read_b128 v[140:143], v169 offset:18432
    v_mfma_f32_16x16x32_bf16 v[32:35], v[108:111], v[128:131], v[32:35]
    ds_read_b64_tr_b16 v[160:161], v170 offset:28672
    v_mfma_f32_16x16x32_bf16 v[36:39], v[108:111], v[132:135], v[36:39]
    ds_read_b64_tr_b16 v[162:163], v170 offset:29184
    v_mfma_f32_16x16x32_bf16 v[40:43], v[120:123], v[112:115], v[40:43]
    ds_read_b64_tr_b16 v[164:165], v171 offset:28672
    v_mfma_f32_16x16x32_bf16 v[44:47], v[124:127], v[112:115], v[44:47]
    ds_read_b64_tr_b16 v[166:167], v171 offset:29184
    v_mfma_f32_16x16x32_bf16 v[48:51], v[112:115], v[128:131], v[48:51]
    ds_read_b128 v[144:147], v169 offset:20480
    v_mfma_f32_16x16x32_bf16 v[52:55], v[112:115], v[132:135], v[52:55]
    ds_read_b128 v[148:151], v169 offset:22528
    v_mfma_f32_16x16x32_bf16 v[56:59], v[120:123], v[116:119], v[56:59]
    v_mfma_f32_16x16x32_bf16 v[60:63], v[124:127], v[116:119], v[60:63]
    v_mfma_f32_16x16x32_bf16 v[64:67], v[116:119], v[128:131], v[64:67]
    v_mfma_f32_16x16x32_bf16 v[68:71], v[116:119], v[132:135], v[68:71]
    s_waitcnt lgkmcnt(0)
    s_barrier
    v_mfma_f32_16x16x32_bf16 v[8:11], v[152:155], v[136:139], v[8:11]
    ds_read_b128 v[104:107], v168 offset:32768
    v_mfma_f32_16x16x32_bf16 v[12:15], v[156:159], v[136:139], v[12:15]
    ds_read_b64_tr_b16 v[120:121], v170 offset:32768
    v_mfma_f32_16x16x32_bf16 v[16:19], v[136:139], v[160:163], v[16:19]
    ds_read_b64_tr_b16 v[122:123], v170 offset:33280
    v_mfma_f32_16x16x32_bf16 v[20:23], v[136:139], v[164:167], v[20:23]
    ds_read_b64_tr_b16 v[124:125], v171 offset:32768
    v_mfma_f32_16x16x32_bf16 v[24:27], v[152:155], v[140:143], v[24:27]
    ds_read_b64_tr_b16 v[126:127], v171 offset:33280
    v_mfma_f32_16x16x32_bf16 v[28:31], v[156:159], v[140:143], v[28:31]
    ds_read_b128 v[108:111], v168 offset:34816
    v_mfma_f32_16x16x32_bf16 v[32:35], v[140:143], v[160:163], v[32:35]
    ds_read_b64_tr_b16 v[128:129], v170 offset:40960
    v_mfma_f32_16x16x32_bf16 v[36:39], v[140:143], v[164:167], v[36:39]
    ds_read_b64_tr_b16 v[130:131], v170 offset:41472
    v_mfma_f32_16x16x32_bf16 v[40:43], v[152:155], v[144:147], v[40:43]
    ds_read_b64_tr_b16 v[132:133], v171 offset:40960
    v_mfma_f32_16x16x32_bf16 v[44:47], v[156:159], v[144:147], v[44:47]
    ds_read_b64_tr_b16 v[134:135], v171 offset:41472
    v_mfma_f32_16x16x32_bf16 v[48:51], v[144:147], v[160:163], v[48:51]
    ds_read_b128 v[112:115], v168 offset:36864
    v_mfma_f32_16x16x32_bf16 v[52:55], v[144:147], v[164:167], v[52:55]
    ds_read_b128 v[116:119], v168 offset:38912
    v_mfma_f32_16x16x32_bf16 v[56:59], v[152:155], v[148:151], v[56:59]
    v_mfma_f32_16x16x32_bf16 v[60:63], v[156:159], v[148:151], v[60:63]
    v_mfma_f32_16x16x32_bf16 v[64:67], v[148:151], v[160:163], v[64:67]
    v_mfma_f32_16x16x32_bf16 v[68:71], v[148:151], v[164:167], v[68:71]
    s_waitcnt lgkmcnt(0)
    v_mfma_f32_16x16x32_bf16 v[8:11], v[120:123], v[104:107], v[8:11]
    ds_read_b128 v[136:139], v169 offset:32768
    v_mfma_f32_16x16x32_bf16 v[12:15], v[124:127], v[104:107], v[12:15]
    ds_read_b64_tr_b16 v[152:153], v170 offset:36864
    v_mfma_f32_16x16x32_bf16 v[16:19], v[104:107], v[128:131], v[16:19]
    ds_read_b64_tr_b16 v[154:155], v170 offset:37376
    v_mfma_f32_16x16x32_bf16 v[20:23], v[104:107], v[132:135], v[20:23]
    ds_read_b64_tr_b16 v[156:157], v171 offset:36864
    v_mfma_f32_16x16x32_bf16 v[24:27], v[120:123], v[108:111], v[24:27]
    ds_read_b64_tr_b16 v[158:159], v171 offset:37376
    v_mfma_f32_16x16x32_bf16 v[28:31], v[124:127], v[108:111], v[28:31]
    ds_read_b128 v[140:143], v169 offset:34816
    v_mfma_f32_16x16x32_bf16 v[32:35], v[108:111], v[128:131], v[32:35]
    ds_read_b64_tr_b16 v[160:161], v170 offset:45056
    v_mfma_f32_16x16x32_bf16 v[36:39], v[108:111], v[132:135], v[36:39]
    ds_read_b64_tr_b16 v[162:163], v170 offset:45568
    v_mfma_f32_16x16x32_bf16 v[40:43], v[120:123], v[112:115], v[40:43]
    ds_read_b64_tr_b16 v[164:165], v171 offset:45056
    v_mfma_f32_16x16x32_bf16 v[44:47], v[124:127], v[112:115], v[44:47]
    ds_read_b64_tr_b16 v[166:167], v171 offset:45568
    v_mfma_f32_16x16x32_bf16 v[48:51], v[112:115], v[128:131], v[48:51]
    ds_read_b128 v[144:147], v169 offset:36864
    v_mfma_f32_16x16x32_bf16 v[52:55], v[112:115], v[132:135], v[52:55]
    ds_read_b128 v[148:151], v169 offset:38912
    v_mfma_f32_16x16x32_bf16 v[56:59], v[120:123], v[116:119], v[56:59]
    v_mfma_f32_16x16x32_bf16 v[60:63], v[124:127], v[116:119], v[60:63]
    v_mfma_f32_16x16x32_bf16 v[64:67], v[116:119], v[128:131], v[64:67]
    v_mfma_f32_16x16x32_bf16 v[68:71], v[116:119], v[132:135], v[68:71]
    s_waitcnt lgkmcnt(0)
    v_mfma_f32_16x16x32_bf16 v[8:11], v[152:155], v[136:139], v[8:11]
    ds_read_b128 v[104:107], v168 offset:49152
    v_mfma_f32_16x16x32_bf16 v[12:15], v[156:159], v[136:139], v[12:15]
    ds_read_b64_tr_b16 v[120:121], v170 offset:49152
    v_mfma_f32_16x16x32_bf16 v[16:19], v[136:139], v[160:163], v[16:19]
    ds_read_b64_tr_b16 v[122:123], v170 offset:49664
    v_mfma_f32_16x16x32_bf16 v[20:23], v[136:139], v[164:167], v[20:23]
    ds_read_b64_tr_b16 v[124:125], v171 offset:49152
    v_mfma_f32_16x16x32_bf16 v[24:27], v[152:155], v[140:143], v[24:27]
    ds_read_b64_tr_b16 v[126:127], v171 offset:49664
    v_mfma_f32_16x16x32_bf16 v[28:31], v[156:159], v[140:143], v[28:31]
    ds_read_b128 v[108:111], v168 offset:51200
    v_mfma_f32_16x16x32_bf16 v[32:35], v[140:143], v[160:163], v[32:35]
    ds_read_b64_tr_b16 v[128:129], v170 offset:57344
    v_mfma_f32_16x16x32_bf16 v[36:39], v[140:143], v[164:167], v[36:39]
    ds_read_b64_tr_b16 v[130:131], v170 offset:57856
    v_mfma_f32_16x16x32_bf16 v[40:43], v[152:155], v[144:147], v[40:43]
    ds_read_b64_tr_b16 v[132:133], v171 offset:57344
    v_mfma_f32_16x16x32_bf16 v[44:47], v[156:159], v[144:147], v[44:47]
    ds_read_b64_tr_b16 v[134:135], v171 offset:57856
    v_mfma_f32_16x16x32_bf16 v[48:51], v[144:147], v[160:163], v[48:51]
    ds_read_b128 v[112:115], v168 offset:53248
    v_mfma_f32_16x16x32_bf16 v[52:55], v[144:147], v[164:167], v[52:55]
    ds_read_b128 v[116:119], v168 offset:55296
    v_mfma_f32_16x16x32_bf16 v[56:59], v[152:155], v[148:151], v[56:59]
    v_mfma_f32_16x16x32_bf16 v[60:63], v[156:159], v[148:151], v[60:63]
    v_mfma_f32_16x16x32_bf16 v[64:67], v[148:151], v[160:163], v[64:67]
    v_mfma_f32_16x16x32_bf16 v[68:71], v[148:151], v[164:167], v[68:71]
    s_waitcnt lgkmcnt(0)
    v_mfma_f32_16x16x32_bf16 v[8:11], v[120:123], v[104:107], v[8:11]
    ds_read_b128 v[136:139], v169 offset:49152
    v_mfma_f32_16x16x32_bf16 v[12:15], v[124:127], v[104:107], v[12:15]
    ds_read_b64_tr_b16 v[152:153], v170 offset:53248
    v_mfma_f32_16x16x32_bf16 v[16:19], v[104:107], v[128:131], v[16:19]
    ds_read_b64_tr_b16 v[154:155], v170 offset:53760
    v_mfma_f32_16x16x32_bf16 v[20:23], v[104:107], v[132:135], v[20:23]
    ds_read_b64_tr_b16 v[156:157], v171 offset:53248
    v_mfma_f32_16x16x32_bf16 v[24:27], v[120:123], v[108:111], v[24:27]
    ds_read_b64_tr_b16 v[158:159], v171 offset:53760
    v_mfma_f32_16x16x32_bf16 v[28:31], v[124:127], v[108:111], v[28:31]
    ds_read_b128 v[140:143], v169 offset:51200
    v_mfma_f32_16x16x32_bf16 v[32:35], v[108:111], v[128:131], v[32:35]
    ds_read_b64_tr_b16 v[160:161], v170 offset:61440
    v_mfma_f32_16x16x32_bf16 v[36:39], v[108:111], v[132:135], v[36:39]
    ds_read_b64_tr_b16 v[162:163], v170 offset:61952
    v_mfma_f32_16x16x32_bf16 v[40:43], v[120:123], v[112:115], v[40:43]
    ds_read_b64_tr_b16 v[164:165], v171 offset:61440
    v_mfma_f32_16x16x32_bf16 v[44:47], v[124:127], v[112:115], v[44:47]
    ds_read_b64_tr_b16 v[166:167], v171 offset:61952
    v_mfma_f32_16x16x32_bf16 v[48:51], v[112:115], v[128:131], v[48:51]
    ds_read_b128 v[144:147], v169 offset:53248
    v_mfma_f32_16x16x32_bf16 v[52:55], v[112:115], v[132:135], v[52:55]
    ds_read_b128 v[148:151], v169 offset:55296
    v_mfma_f32_16x16x32_bf16 v[56:59], v[120:123], v[116:119], v[56:59]
    v_mfma_f32_16x16x32_bf16 v[60:63], v[124:127], v[116:119], v[60:63]
    v_mfma_f32_16x16x32_bf16 v[64:67], v[116:119], v[128:131], v[64:67]
    v_mfma_f32_16x16x32_bf16 v[68:71], v[116:119], v[132:135], v[68:71]
    s_waitcnt lgkmcnt(0)
    s_lshl_b32 s3, s38, 2
    s_add_u32 s3, s3, 141392
    v_mov_b32 v6, s3
    v_mov_b32 v7, 1
    ds_write_b32 v6, v7
    v_and_b32 v3, 15, v1
    s_lshl_b32 s3, s28, 8
    s_add_u32 s3, s3, 137984
    v_lshl_add_u32 v240, v3, 2, s3
    v_lshl_add_u32 v241, v1, 2, s3
    v_lshl_add_u32 v242, v2, 4, s3
    s_lshl_b32 s3, s29, 7
    s_add_u32 s3, s3, 140544
    v_lshl_add_u32 v243, v2, 4, s3
    v_lshl_add_u32 v244, v3, 2, s3
    s_lshl_b32 s3, s28, 7
    s_add_u32 s3, s3, 139008
    v_lshl_add_u32 v245, v2, 3, s3
    v_lshrrev_b32 v6, 2, v1
    v_lshlrev_b32 v6, 6, v6
    v_and_b32 v7, 3, v1
    v_lshl_add_u32 v6, v7, 3, v6
    s_lshl_b32 s3, s29, 11
    s_add_u32 s3, s3, 131072
    v_add_u32 v246, s3, v6
    v_mfma_f32_16x16x32_bf16 v[8:11], v[152:155], v[136:139], v[8:11]
    ds_read_b32 v180, v240 offset:0
    v_mfma_f32_16x16x32_bf16 v[12:15], v[156:159], v[136:139], v[12:15]
    ds_read_b32 v182, v240 offset:64
    v_mfma_f32_16x16x32_bf16 v[16:19], v[136:139], v[160:163], v[16:19]
    ds_read_b32 v184, v240 offset:128
    v_mfma_f32_16x16x32_bf16 v[20:23], v[136:139], v[164:167], v[20:23]
    ds_read_b32 v186, v240 offset:192
    v_mfma_f32_16x16x32_bf16 v[24:27], v[152:155], v[140:143], v[24:27]
    ds_read_b128 v[192:195], v243 offset:256
    v_mfma_f32_16x16x32_bf16 v[28:31], v[156:159], v[140:143], v[28:31]
    ds_read_b128 v[196:199], v243 offset:320
    v_mfma_f32_16x16x32_bf16 v[32:35], v[140:143], v[160:163], v[32:35]
    ds_read_b64_tr_b16 v[172:173], v246 offset:0
    v_mfma_f32_16x16x32_bf16 v[36:39], v[140:143], v[164:167], v[36:39]
    ds_read_b64_tr_b16 v[174:175], v246 offset:1024
    v_mfma_f32_16x16x32_bf16 v[40:43], v[152:155], v[144:147], v[40:43]
    ds_read_b64_tr_b16 v[176:177], v246 offset:32
    v_mfma_f32_16x16x32_bf16 v[44:47], v[156:159], v[144:147], v[44:47]
    ds_read_b64_tr_b16 v[178:179], v246 offset:1056
    v_mfma_f32_16x16x32_bf16 v[48:51], v[144:147], v[160:163], v[48:51]
    ds_read_b32 v248, v240 offset:512
    v_mfma_f32_16x16x32_bf16 v[52:55], v[144:147], v[164:167], v[52:55]
    ds_read_b32 v250, v240 offset:576
    v_mfma_f32_16x16x32_bf16 v[56:59], v[152:155], v[148:151], v[56:59]
    ds_read_b32 v252, v240 offset:640
    v_mfma_f32_16x16x32_bf16 v[60:63], v[156:159], v[148:151], v[60:63]
    ds_read_b32 v254, v240 offset:704
    v_mfma_f32_16x16x32_bf16 v[64:67], v[148:151], v[160:163], v[64:67]
    ds_read_b32 v183, v241 offset:512
    v_mfma_f32_16x16x32_bf16 v[68:71], v[148:151], v[164:167], v[68:71]
    v_mov_b32 v247, 141312
    ds_read_b32 v185, v247
    ds_read_b32 v187, v247 offset:8
    ds_read_b32 v188, v244 offset:512
    ds_read_b32 v190, v244 offset:576
    ds_read_b128 v[200:203], v242 offset:0
    ds_read_b128 v[204:207], v242 offset:64
    ds_read_b128 v[208:211], v242 offset:128
    ds_read_b128 v[212:215], v242 offset:192
    ds_read_b64 v[216:217], v245 offset:0
    ds_read_b64 v[218:219], v245 offset:32
    ds_read_b64 v[220:221], v245 offset:64
    ds_read_b64 v[222:223], v245 offset:96
    s_mov_b32 s71, 1069066811
    s_waitcnt lgkmcnt(12)
    v_pk_fma_f32 v[8:9], v[180:181], v[192:193], v[8:9] op_sel_hi:[0,1,1] neg_lo:[1,0,0] neg_hi:[1,0,0]
    v_pk_fma_f32 v[10:11], v[180:181], v[194:195], v[10:11] op_sel_hi:[0,1,1] neg_lo:[1,0,0] neg_hi:[1,0,0]
    v_pk_fma_f32 v[12:13], v[180:181], v[196:197], v[12:13] op_sel_hi:[0,1,1] neg_lo:[1,0,0] neg_hi:[1,0,0]
    v_pk_fma_f32 v[14:15], v[180:181], v[198:199], v[14:15] op_sel_hi:[0,1,1] neg_lo:[1,0,0] neg_hi:[1,0,0]
    v_cvt_pk_bf16_f32 v104, v8, v9
    v_cvt_pk_bf16_f32 v105, v10, v11
    v_cvt_pk_bf16_f32 v106, v12, v13
    v_cvt_pk_bf16_f32 v107, v14, v15
    v_pk_fma_f32 v[24:25], v[182:183], v[192:193], v[24:25] op_sel_hi:[0,1,1] neg_lo:[1,0,0] neg_hi:[1,0,0]
    v_pk_fma_f32 v[26:27], v[182:183], v[194:195], v[26:27] op_sel_hi:[0,1,1] neg_lo:[1,0,0] neg_hi:[1,0,0]
    v_pk_fma_f32 v[28:29], v[182:183], v[196:197], v[28:29] op_sel_hi:[0,1,1] neg_lo:[1,0,0] neg_hi:[1,0,0]
    v_pk_fma_f32 v[30:31], v[182:183], v[198:199], v[30:31] op_sel_hi:[0,1,1] neg_lo:[1,0,0] neg_hi:[1,0,0]
    v_cvt_pk_bf16_f32 v108, v24, v25
    v_cvt_pk_bf16_f32 v109, v26, v27
    v_cvt_pk_bf16_f32 v110, v28, v29
    v_cvt_pk_bf16_f32 v111, v30, v31
    v_pk_fma_f32 v[40:41], v[184:185], v[192:193], v[40:41] op_sel_hi:[0,1,1] neg_lo:[1,0,0] neg_hi:[1,0,0]
    v_pk_fma_f32 v[42:43], v[184:185], v[194:195], v[42:43] op_sel_hi:[0,1,1] neg_lo:[1,0,0] neg_hi:[1,0,0]
    v_pk_fma_f32 v[44:45], v[184:185], v[196:197], v[44:45] op_sel_hi:[0,1,1] neg_lo:[1,0,0] neg_hi:[1,0,0]
    v_pk_fma_f32 v[46:47], v[184:185], v[198:199], v[46:47] op_sel_hi:[0,1,1] neg_lo:[1,0,0] neg_hi:[1,0,0]
    v_cvt_pk_bf16_f32 v112, v40, v41
    v_cvt_pk_bf16_f32 v113, v42, v43
    v_cvt_pk_bf16_f32 v114, v44, v45
    v_cvt_pk_bf16_f32 v115, v46, v47
    v_pk_fma_f32 v[56:57], v[186:187], v[192:193], v[56:57] op_sel_hi:[0,1,1] neg_lo:[1,0,0] neg_hi:[1,0,0]
    v_pk_fma_f32 v[58:59], v[186:187], v[194:195], v[58:59] op_sel_hi:[0,1,1] neg_lo:[1,0,0] neg_hi:[1,0,0]
    v_pk_fma_f32 v[60:61], v[186:187], v[196:197], v[60:61] op_sel_hi:[0,1,1] neg_lo:[1,0,0] neg_hi:[1,0,0]
    v_pk_fma_f32 v[62:63], v[186:187], v[198:199], v[62:63] op_sel_hi:[0,1,1] neg_lo:[1,0,0] neg_hi:[1,0,0]
    v_cvt_pk_bf16_f32 v116, v56, v57
    v_cvt_pk_bf16_f32 v117, v58, v59
    v_cvt_pk_bf16_f32 v118, v60, v61
    v_cvt_pk_bf16_f32 v119, v62, v63
    v_mul_f32 v248, s71, v248
    v_mul_f32 v250, s71, v250
    v_mul_f32 v252, s71, v252
    v_mul_f32 v254, s71, v254
    v_mul_f32 v181, s71, v183
    s_waitcnt lgkmcnt(0)
    v_readfirstlane_b32 s33, v185
    v_readfirstlane_b32 s32, v187
    v_pk_fma_f32 v[16:17], v[200:201], v[188:189], v[16:17] op_sel_hi:[1,0,1] neg_lo:[1,0,0] neg_hi:[1,0,0]
    v_pk_fma_f32 v[18:19], v[202:203], v[188:189], v[18:19] op_sel_hi:[1,0,1] neg_lo:[1,0,0] neg_hi:[1,0,0]
    v_cvt_pk_bf16_f32 v152, v16, v17
    v_cvt_pk_bf16_f32 v153, v18, v19
    v_pk_fma_f32 v[20:21], v[200:201], v[190:191], v[20:21] op_sel_hi:[1,0,1] neg_lo:[1,0,0] neg_hi:[1,0,0]
    v_pk_fma_f32 v[22:23], v[202:203], v[190:191], v[22:23] op_sel_hi:[1,0,1] neg_lo:[1,0,0] neg_hi:[1,0,0]
    v_cvt_pk_bf16_f32 v156, v20, v21
    v_cvt_pk_bf16_f32 v157, v22, v23
    v_pk_fma_f32 v[32:33], v[204:205], v[188:189], v[32:33] op_sel_hi:[1,0,1] neg_lo:[1,0,0] neg_hi:[1,0,0]
    v_pk_fma_f32 v[34:35], v[206:207], v[188:189], v[34:35] op_sel_hi:[1,0,1] neg_lo:[1,0,0] neg_hi:[1,0,0]
    v_cvt_pk_bf16_f32 v154, v32, v33
    v_cvt_pk_bf16_f32 v155, v34, v35
    v_pk_fma_f32 v[36:37], v[204:205], v[190:191], v[36:37] op_sel_hi:[1,0,1] neg_lo:[1,0,0] neg_hi:[1,0,0]
    v_pk_fma_f32 v[38:39], v[206:207], v[190:191], v[38:39] op_sel_hi:[1,0,1] neg_lo:[1,0,0] neg_hi:[1,0,0]
    v_cvt_pk_bf16_f32 v158, v36, v37
    v_cvt_pk_bf16_f32 v159, v38, v39
    v_pk_fma_f32 v[48:49], v[208:209], v[188:189], v[48:49] op_sel_hi:[1,0,1] neg_lo:[1,0,0] neg_hi:[1,0,0]
    v_pk_fma_f32 v[50:51], v[210:211], v[188:189], v[50:51] op_sel_hi:[1,0,1] neg_lo:[1,0,0] neg_hi:[1,0,0]
    v_cvt_pk_bf16_f32 v160, v48, v49
    v_cvt_pk_bf16_f32 v161, v50, v51
    v_pk_fma_f32 v[52:53], v[208:209], v[190:191], v[52:53] op_sel_hi:[1,0,1] neg_lo:[1,0,0] neg_hi:[1,0,0]
    v_pk_fma_f32 v[54:55], v[210:211], v[190:191], v[54:55] op_sel_hi:[1,0,1] neg_lo:[1,0,0] neg_hi:[1,0,0]
    v_cvt_pk_bf16_f32 v164, v52, v53
    v_cvt_pk_bf16_f32 v165, v54, v55
    v_pk_fma_f32 v[64:65], v[212:213], v[188:189], v[64:65] op_sel_hi:[1,0,1] neg_lo:[1,0,0] neg_hi:[1,0,0]
    v_pk_fma_f32 v[66:67], v[214:215], v[188:189], v[66:67] op_sel_hi:[1,0,1] neg_lo:[1,0,0] neg_hi:[1,0,0]
    v_cvt_pk_bf16_f32 v162, v64, v65
    v_cvt_pk_bf16_f32 v163, v66, v67
    v_pk_fma_f32 v[68:69], v[212:213], v[190:191], v[68:69] op_sel_hi:[1,0,1] neg_lo:[1,0,0] neg_hi:[1,0,0]
    v_pk_fma_f32 v[70:71], v[214:215], v[190:191], v[70:71] op_sel_hi:[1,0,1] neg_lo:[1,0,0] neg_hi:[1,0,0]
    v_cvt_pk_bf16_f32 v166, v68, v69
    v_cvt_pk_bf16_f32 v167, v70, v71
    v_mfma_f32_16x16x32_bf16 v[120:123], v[172:175], v[104:107], 0
    v_mfma_f32_16x16x32_bf16 v[124:127], v[176:179], v[104:107], 0
    v_mfma_f32_16x16x32_bf16 v[128:131], v[172:175], v[108:111], 0
    v_mfma_f32_16x16x32_bf16 v[132:135], v[176:179], v[108:111], 0
    v_mfma_f32_16x16x32_bf16 v[136:139], v[172:175], v[112:115], 0
    v_mfma_f32_16x16x32_bf16 v[140:143], v[176:179], v[112:115], 0
    v_mfma_f32_16x16x32_bf16 v[144:147], v[172:175], v[116:119], 0
    v_mfma_f32_16x16x32_bf16 v[148:151], v[176:179], v[116:119], 0
    s_nop 0
    v_max3_f32 v224, v120, v121, v122
    v_min3_f32 v232, v120, v121, v122
    v_max3_f32 v224, v224, v123, v124
    v_min3_f32 v232, v232, v123, v124
    v_max3_f32 v224, v224, v125, v126
    v_min3_f32 v232, v232, v125, v126
    v_max_f32 v224, v224, v127
    v_min_f32 v232, v232, v127
    v_max3_f32 v226, v128, v129, v130
    v_min3_f32 v234, v128, v129, v130
    v_max3_f32 v226, v226, v131, v132
    v_min3_f32 v234, v234, v131, v132
    v_max3_f32 v226, v226, v133, v134
    v_min3_f32 v234, v234, v133, v134
    v_max_f32 v226, v226, v135
    v_min_f32 v234, v234, v135
    v_max3_f32 v228, v136, v137, v138
    v_min3_f32 v236, v136, v137, v138
    v_max3_f32 v228, v228, v139, v140
    v_min3_f32 v236, v236, v139, v140
    v_max3_f32 v228, v228, v141, v142
    v_min3_f32 v236, v236, v141, v142
    v_max_f32 v228, v228, v143
    v_min_f32 v236, v236, v143
    v_max3_f32 v230, v144, v145, v146
    v_min3_f32 v238, v144, v145, v146
    v_max3_f32 v230, v230, v147, v148
    v_min3_f32 v238, v238, v147, v148
    v_max3_f32 v230, v230, v149, v150
    v_min3_f32 v238, v238, v149, v150
    v_max_f32 v230, v230, v151
    v_min_f32 v238, v238, v151
    v_permlane32_swap_b32 v224, v228
    v_permlane32_swap_b32 v226, v230
    v_permlane32_swap_b32 v232, v236
    v_permlane32_swap_b32 v234, v238
    v_max_f32 v224, v224, v228
    v_max_f32 v226, v226, v230
    v_min_f32 v232, v232, v236
    v_min_f32 v234, v234, v238
    v_permlane16_swap_b32 v224, v226
    s_nop 0
    v_permlane16_swap_b32 v232, v234
    v_max_f32 v224, v224, v226
    v_min_f32 v232, v232, v234
    v_mul_f32 v224, v224, v181
    v_mul_f32 v232, v232, v181
    v_mov_b32 v226, v224
    v_mov_b32 v234, v232
    s_nop 0
    v_permlane16_swap_b32 v224, v226
    v_permlane16_swap_b32 v232, v234
    v_mov_b32 v228, v224
    v_mov_b32 v230, v226
    v_mov_b32 v236, v232
    v_mov_b32 v238, v234
    v_permlane32_swap_b32 v224, v228
    v_permlane32_swap_b32 v226, v230
    v_permlane32_swap_b32 v232, v236
    v_permlane32_swap_b32 v234, v238
    v_pk_fma_f32 v[8:9], v[120:121], v[248:249], v[224:225] op_sel_hi:[1,0,0] neg_lo:[0,0,1] neg_hi:[0,0,1]
    v_pk_fma_f32 v[16:17], v[120:121], v[248:249], v[232:233] op_sel_hi:[1,0,0] neg_lo:[1,0,0] neg_hi:[1,0,0]
    v_pk_fma_f32 v[10:11], v[122:123], v[248:249], v[224:225] op_sel_hi:[1,0,0] neg_lo:[0,0,1] neg_hi:[0,0,1]
    v_pk_fma_f32 v[18:19], v[122:123], v[248:249], v[232:233] op_sel_hi:[1,0,0] neg_lo:[1,0,0] neg_hi:[1,0,0]
    v_pk_fma_f32 v[12:13], v[124:125], v[248:249], v[224:225] op_sel_hi:[1,0,0] neg_lo:[0,0,1] neg_hi:[0,0,1]
    v_pk_fma_f32 v[20:21], v[124:125], v[248:249], v[232:233] op_sel_hi:[1,0,0] neg_lo:[1,0,0] neg_hi:[1,0,0]
    v_pk_fma_f32 v[14:15], v[126:127], v[248:249], v[224:225] op_sel_hi:[1,0,0] neg_lo:[0,0,1] neg_hi:[0,0,1]
    v_pk_fma_f32 v[22:23], v[126:127], v[248:249], v[232:233] op_sel_hi:[1,0,0] neg_lo:[1,0,0] neg_hi:[1,0,0]
    v_exp_f32 v8, v8
    v_exp_f32 v9, v9
    v_exp_f32 v10, v10
    v_exp_f32 v11, v11
    v_exp_f32 v12, v12
    v_exp_f32 v13, v13
    v_exp_f32 v14, v14
    v_exp_f32 v15, v15
    v_exp_f32 v16, v16
    v_exp_f32 v17, v17
    v_exp_f32 v18, v18
    v_exp_f32 v19, v19
    v_exp_f32 v20, v20
    v_exp_f32 v21, v21
    v_exp_f32 v22, v22
    v_exp_f32 v23, v23
    v_pk_fma_f32 v[24:25], v[128:129], v[250:251], v[226:227] op_sel_hi:[1,0,0] neg_lo:[0,0,1] neg_hi:[0,0,1]
    v_pk_fma_f32 v[32:33], v[128:129], v[250:251], v[234:235] op_sel_hi:[1,0,0] neg_lo:[1,0,0] neg_hi:[1,0,0]
    v_pk_fma_f32 v[26:27], v[130:131], v[250:251], v[226:227] op_sel_hi:[1,0,0] neg_lo:[0,0,1] neg_hi:[0,0,1]
    v_pk_fma_f32 v[34:35], v[130:131], v[250:251], v[234:235] op_sel_hi:[1,0,0] neg_lo:[1,0,0] neg_hi:[1,0,0]
    v_pk_fma_f32 v[28:29], v[132:133], v[250:251], v[226:227] op_sel_hi:[1,0,0] neg_lo:[0,0,1] neg_hi:[0,0,1]
    v_pk_fma_f32 v[36:37], v[132:133], v[250:251], v[234:235] op_sel_hi:[1,0,0] neg_lo:[1,0,0] neg_hi:[1,0,0]
    v_pk_fma_f32 v[30:31], v[134:135], v[250:251], v[226:227] op_sel_hi:[1,0,0] neg_lo:[0,0,1] neg_hi:[0,0,1]
    v_pk_fma_f32 v[38:39], v[134:135], v[250:251], v[234:235] op_sel_hi:[1,0,0] neg_lo:[1,0,0] neg_hi:[1,0,0]
    v_exp_f32 v24, v24
    v_exp_f32 v25, v25
    v_exp_f32 v26, v26
    v_exp_f32 v27, v27
    v_exp_f32 v28, v28
    v_exp_f32 v29, v29
    v_exp_f32 v30, v30
    v_exp_f32 v31, v31
    v_exp_f32 v32, v32
    v_exp_f32 v33, v33
    v_exp_f32 v34, v34
    v_exp_f32 v35, v35
    v_exp_f32 v36, v36
    v_exp_f32 v37, v37
    v_exp_f32 v38, v38
    v_exp_f32 v39, v39
    v_pk_fma_f32 v[40:41], v[136:137], v[252:253], v[228:229] op_sel_hi:[1,0,0] neg_lo:[0,0,1] neg_hi:[0,0,1]
    v_pk_fma_f32 v[48:49], v[136:137], v[252:253], v[236:237] op_sel_hi:[1,0,0] neg_lo:[1,0,0] neg_hi:[1,0,0]
    v_pk_fma_f32 v[42:43], v[138:139], v[252:253], v[228:229] op_sel_hi:[1,0,0] neg_lo:[0,0,1] neg_hi:[0,0,1]
    v_pk_fma_f32 v[50:51], v[138:139], v[252:253], v[236:237] op_sel_hi:[1,0,0] neg_lo:[1,0,0] neg_hi:[1,0,0]
    v_pk_fma_f32 v[44:45], v[140:141], v[252:253], v[228:229] op_sel_hi:[1,0,0] neg_lo:[0,0,1] neg_hi:[0,0,1]
    v_pk_fma_f32 v[52:53], v[140:141], v[252:253], v[236:237] op_sel_hi:[1,0,0] neg_lo:[1,0,0] neg_hi:[1,0,0]
    v_pk_fma_f32 v[46:47], v[142:143], v[252:253], v[228:229] op_sel_hi:[1,0,0] neg_lo:[0,0,1] neg_hi:[0,0,1]
    v_pk_fma_f32 v[54:55], v[142:143], v[252:253], v[236:237] op_sel_hi:[1,0,0] neg_lo:[1,0,0] neg_hi:[1,0,0]
    v_exp_f32 v40, v40
    v_exp_f32 v41, v41
    v_exp_f32 v42, v42
    v_exp_f32 v43, v43
    v_exp_f32 v44, v44
    v_exp_f32 v45, v45
    v_exp_f32 v46, v46
    v_exp_f32 v47, v47
    v_exp_f32 v48, v48
    v_exp_f32 v49, v49
    v_exp_f32 v50, v50
    v_exp_f32 v51, v51
    v_exp_f32 v52, v52
    v_exp_f32 v53, v53
    v_exp_f32 v54, v54
    v_exp_f32 v55, v55
    v_pk_fma_f32 v[56:57], v[144:145], v[254:255], v[230:231] op_sel_hi:[1,0,0] neg_lo:[0,0,1] neg_hi:[0,0,1]
    v_pk_fma_f32 v[64:65], v[144:145], v[254:255], v[238:239] op_sel_hi:[1,0,0] neg_lo:[1,0,0] neg_hi:[1,0,0]
    v_pk_fma_f32 v[58:59], v[146:147], v[254:255], v[230:231] op_sel_hi:[1,0,0] neg_lo:[0,0,1] neg_hi:[0,0,1]
    v_pk_fma_f32 v[66:67], v[146:147], v[254:255], v[238:239] op_sel_hi:[1,0,0] neg_lo:[1,0,0] neg_hi:[1,0,0]
    v_pk_fma_f32 v[60:61], v[148:149], v[254:255], v[230:231] op_sel_hi:[1,0,0] neg_lo:[0,0,1] neg_hi:[0,0,1]
    v_pk_fma_f32 v[68:69], v[148:149], v[254:255], v[238:239] op_sel_hi:[1,0,0] neg_lo:[1,0,0] neg_hi:[1,0,0]
    v_pk_fma_f32 v[62:63], v[150:151], v[254:255], v[230:231] op_sel_hi:[1,0,0] neg_lo:[0,0,1] neg_hi:[0,0,1]
    v_pk_fma_f32 v[70:71], v[150:151], v[254:255], v[238:239] op_sel_hi:[1,0,0] neg_lo:[1,0,0] neg_hi:[1,0,0]
    v_exp_f32 v56, v56
    v_exp_f32 v57, v57
    v_exp_f32 v58, v58
    v_exp_f32 v59, v59
    v_exp_f32 v60, v60
    v_exp_f32 v61, v61
    v_exp_f32 v62, v62
    v_exp_f32 v63, v63
    v_exp_f32 v64, v64
    v_exp_f32 v65, v65
    v_exp_f32 v66, v66
    v_exp_f32 v67, v67
    v_exp_f32 v68, v68
    v_exp_f32 v69, v69
    v_exp_f32 v70, v70
    v_exp_f32 v71, v71
    v_pk_add_f32 v[120:121], v[8:9], v[10:11]
    v_pk_add_f32 v[122:123], v[12:13], v[14:15]
    v_pk_add_f32 v[124:125], v[16:17], v[18:19]
    v_pk_add_f32 v[126:127], v[20:21], v[22:23]
    v_pk_add_f32 v[128:129], v[24:25], v[26:27]
    v_pk_add_f32 v[130:131], v[28:29], v[30:31]
    v_pk_add_f32 v[132:133], v[32:33], v[34:35]
    v_pk_add_f32 v[134:135], v[36:37], v[38:39]
    v_pk_add_f32 v[136:137], v[40:41], v[42:43]
    v_pk_add_f32 v[138:139], v[44:45], v[46:47]
    v_pk_add_f32 v[140:141], v[48:49], v[50:51]
    v_pk_add_f32 v[142:143], v[52:53], v[54:55]
    v_pk_add_f32 v[144:145], v[56:57], v[58:59]
    v_pk_add_f32 v[146:147], v[60:61], v[62:63]
    v_pk_add_f32 v[148:149], v[64:65], v[66:67]
    v_pk_add_f32 v[150:151], v[68:69], v[70:71]
    v_pk_add_f32 v[120:121], v[120:121], v[122:123]
    v_pk_add_f32 v[124:125], v[124:125], v[126:127]
    v_pk_add_f32 v[128:129], v[128:129], v[130:131]
    v_pk_add_f32 v[132:133], v[132:133], v[134:135]
    v_pk_add_f32 v[136:137], v[136:137], v[138:139]
    v_pk_add_f32 v[140:141], v[140:141], v[142:143]
    v_pk_add_f32 v[144:145], v[144:145], v[146:147]
    v_pk_add_f32 v[148:149], v[148:149], v[150:151]
    v_add_f32 v224, v120, v121
    v_add_f32 v232, v124, v125
    v_add_f32 v226, v128, v129
    v_add_f32 v234, v132, v133
    v_add_f32 v228, v136, v137
    v_add_f32 v236, v140, v141
    v_add_f32 v230, v144, v145
    v_add_f32 v238, v148, v149
    v_permlane32_swap_b32 v224, v228
    v_permlane32_swap_b32 v226, v230
    v_permlane32_swap_b32 v232, v236
    v_permlane32_swap_b32 v234, v238
    v_add_f32 v224, v224, v228
    v_add_f32 v226, v226, v230
    v_add_f32 v232, v232, v236
    v_add_f32 v234, v234, v238
    v_permlane16_swap_b32 v224, v226
    s_nop 0
    v_permlane16_swap_b32 v232, v234
    v_add_f32 v224, v224, v226
    v_add_f32 v232, v232, v234
    v_rcp_f32 v224, v224
    v_rcp_f32 v232, v232
    s_mul_i32 s3, s38, 4352
    s_add_u32 s3, s3, 142592
    v_mul_u32_u24 v6, 136, v3
    v_lshl_add_u32 v6, v2, 3, v6
    v_add_u32 v240, s3, v6
    v_mul_f32 v224, v224, v183
    v_mul_f32 v232, v232, v183
    v_lshrrev_b32 v6, 2, v1
    v_mul_u32_u24 v6, 136, v6
    v_lshl_add_u32 v6, v7, 3, v6
    v_add_u32 v6, s3, v6
    s_lshl_b32 s65, s28, 6
    v_add_u32 v241, s65, v6
    s_xor_b32 s65, s65, 64
    v_add_u32 v242, s65, v6
    v_mov_b32 v226, v224
    v_mov_b32 v234, v232
    s_nop 0
    v_permlane16_swap_b32 v224, v226
    v_permlane16_swap_b32 v232, v234
    v_mov_b32 v228, v224
    v_mov_b32 v230, v226
    v_mov_b32 v236, v232
    v_mov_b32 v238, v234
    v_permlane32_swap_b32 v224, v228
    v_permlane32_swap_b32 v226, v230
    v_permlane32_swap_b32 v232, v236
    v_permlane32_swap_b32 v234, v238
    v_pk_mul_f32 v[8:9], v[8:9], v[224:225] op_sel_hi:[1,0]
    v_pk_mul_f32 v[10:11], v[10:11], v[224:225] op_sel_hi:[1,0]
    v_pk_mul_f32 v[12:13], v[12:13], v[224:225] op_sel_hi:[1,0]
    v_pk_mul_f32 v[14:15], v[14:15], v[224:225] op_sel_hi:[1,0]
    v_cvt_pk_bf16_f32 v104, v8, v9
    v_cvt_pk_bf16_f32 v105, v10, v11
    v_cvt_pk_bf16_f32 v106, v12, v13
    v_cvt_pk_bf16_f32 v107, v14, v15
    ds_write_b64 v240, v[104:105] offset:0
    ds_write_b64 v240, v[106:107] offset:32
    v_pk_mul_f32 v[16:17], v[16:17], v[232:233] op_sel_hi:[1,0]
    v_pk_mul_f32 v[18:19], v[18:19], v[232:233] op_sel_hi:[1,0]
    v_pk_mul_f32 v[20:21], v[20:21], v[232:233] op_sel_hi:[1,0]
    v_pk_mul_f32 v[22:23], v[22:23], v[232:233] op_sel_hi:[1,0]
    v_cvt_pk_bf16_f32 v108, v16, v17
    v_cvt_pk_bf16_f32 v109, v18, v19
    v_cvt_pk_bf16_f32 v110, v20, v21
    v_cvt_pk_bf16_f32 v111, v22, v23
    ds_write_b64 v240, v[108:109] offset:64
    ds_write_b64 v240, v[110:111] offset:96
    v_pk_mul_f32 v[24:25], v[24:25], v[226:227] op_sel_hi:[1,0]
    v_pk_mul_f32 v[26:27], v[26:27], v[226:227] op_sel_hi:[1,0]
    v_pk_mul_f32 v[28:29], v[28:29], v[226:227] op_sel_hi:[1,0]
    v_pk_mul_f32 v[30:31], v[30:31], v[226:227] op_sel_hi:[1,0]
    v_cvt_pk_bf16_f32 v112, v24, v25
    v_cvt_pk_bf16_f32 v113, v26, v27
    v_cvt_pk_bf16_f32 v114, v28, v29
    v_cvt_pk_bf16_f32 v115, v30, v31
    ds_write_b64 v240, v[112:113] offset:2176
    ds_write_b64 v240, v[114:115] offset:2208
    v_pk_mul_f32 v[32:33], v[32:33], v[234:235] op_sel_hi:[1,0]
    v_pk_mul_f32 v[34:35], v[34:35], v[234:235] op_sel_hi:[1,0]
    v_pk_mul_f32 v[36:37], v[36:37], v[234:235] op_sel_hi:[1,0]
    v_pk_mul_f32 v[38:39], v[38:39], v[234:235] op_sel_hi:[1,0]
    v_cvt_pk_bf16_f32 v116, v32, v33
    v_cvt_pk_bf16_f32 v117, v34, v35
    v_cvt_pk_bf16_f32 v118, v36, v37
    v_cvt_pk_bf16_f32 v119, v38, v39
    ds_write_b64 v240, v[116:117] offset:2240
    ds_write_b64 v240, v[118:119] offset:2272
    ds_read_b64_tr_b16 v[120:121], v241 offset:0
    ds_read_b64_tr_b16 v[122:123], v241 offset:2176
    ds_read_b64_tr_b16 v[124:125], v241 offset:32
    ds_read_b64_tr_b16 v[126:127], v241 offset:2208
    ds_read_b64_tr_b16 v[128:129], v242 offset:0
    ds_read_b64_tr_b16 v[130:131], v242 offset:2176
    ds_read_b64_tr_b16 v[132:133], v242 offset:32
    ds_read_b64_tr_b16 v[134:135], v242 offset:2208
    v_pk_mul_f32 v[40:41], v[40:41], v[228:229] op_sel_hi:[1,0]
    v_pk_mul_f32 v[42:43], v[42:43], v[228:229] op_sel_hi:[1,0]
    v_pk_mul_f32 v[44:45], v[44:45], v[228:229] op_sel_hi:[1,0]
    v_pk_mul_f32 v[46:47], v[46:47], v[228:229] op_sel_hi:[1,0]
    v_cvt_pk_bf16_f32 v104, v40, v41
    v_cvt_pk_bf16_f32 v105, v42, v43
    v_cvt_pk_bf16_f32 v106, v44, v45
    v_cvt_pk_bf16_f32 v107, v46, v47
    ds_write_b64 v240, v[104:105] offset:0
    ds_write_b64 v240, v[106:107] offset:32
    v_pk_mul_f32 v[48:49], v[48:49], v[236:237] op_sel_hi:[1,0]
    v_pk_mul_f32 v[50:51], v[50:51], v[236:237] op_sel_hi:[1,0]
    v_pk_mul_f32 v[52:53], v[52:53], v[236:237] op_sel_hi:[1,0]
    v_pk_mul_f32 v[54:55], v[54:55], v[236:237] op_sel_hi:[1,0]
    v_cvt_pk_bf16_f32 v108, v48, v49
    v_cvt_pk_bf16_f32 v109, v50, v51
    v_cvt_pk_bf16_f32 v110, v52, v53
    v_cvt_pk_bf16_f32 v111, v54, v55
    ds_write_b64 v240, v[108:109] offset:64
    ds_write_b64 v240, v[110:111] offset:96
    v_pk_mul_f32 v[56:57], v[56:57], v[230:231] op_sel_hi:[1,0]
    v_pk_mul_f32 v[58:59], v[58:59], v[230:231] op_sel_hi:[1,0]
    v_pk_mul_f32 v[60:61], v[60:61], v[230:231] op_sel_hi:[1,0]
    v_pk_mul_f32 v[62:63], v[62:63], v[230:231] op_sel_hi:[1,0]
    v_cvt_pk_bf16_f32 v112, v56, v57
    v_cvt_pk_bf16_f32 v113, v58, v59
    v_cvt_pk_bf16_f32 v114, v60, v61
    v_cvt_pk_bf16_f32 v115, v62, v63
    ds_write_b64 v240, v[112:113] offset:2176
    ds_write_b64 v240, v[114:115] offset:2208
    v_pk_mul_f32 v[64:65], v[64:65], v[238:239] op_sel_hi:[1,0]
    v_pk_mul_f32 v[66:67], v[66:67], v[238:239] op_sel_hi:[1,0]
    v_pk_mul_f32 v[68:69], v[68:69], v[238:239] op_sel_hi:[1,0]
    v_pk_mul_f32 v[70:71], v[70:71], v[238:239] op_sel_hi:[1,0]
    v_cvt_pk_bf16_f32 v116, v64, v65
    v_cvt_pk_bf16_f32 v117, v66, v67
    v_cvt_pk_bf16_f32 v118, v68, v69
    v_cvt_pk_bf16_f32 v119, v70, v71
    ds_write_b64 v240, v[116:117] offset:2240
    ds_write_b64 v240, v[118:119] offset:2272
    ds_read_b64_tr_b16 v[136:137], v241 offset:0
    ds_read_b64_tr_b16 v[138:139], v241 offset:2176
    ds_read_b64_tr_b16 v[140:141], v241 offset:32
    ds_read_b64_tr_b16 v[142:143], v241 offset:2208
    ds_read_b64_tr_b16 v[144:145], v242 offset:0
    ds_read_b64_tr_b16 v[146:147], v242 offset:2176
    ds_read_b64_tr_b16 v[148:149], v242 offset:32
    ds_read_b64_tr_b16 v[150:151], v242 offset:2208
    s_waitcnt lgkmcnt(0)
    v_mfma_f32_16x16x32_bf16 v[24:27], v[128:131], v[152:155], 0
    v_mfma_f32_16x16x32_bf16 v[28:31], v[128:131], v[156:159], 0
    v_mfma_f32_16x16x32_bf16 v[48:51], v[128:131], v[216:219], 0
    v_mfma_f32_16x16x32_bf16 v[24:27], v[144:147], v[160:163], v[24:27]
    v_mfma_f32_16x16x32_bf16 v[28:31], v[144:147], v[164:167], v[28:31]
    v_mfma_f32_16x16x32_bf16 v[48:51], v[144:147], v[220:223], v[48:51]
    v_mfma_f32_16x16x32_bf16 v[32:35], v[132:135], v[152:155], 0
    v_mfma_f32_16x16x32_bf16 v[36:39], v[132:135], v[156:159], 0
    v_mfma_f32_16x16x32_bf16 v[52:55], v[132:135], v[216:219], 0
    v_mfma_f32_16x16x32_bf16 v[32:35], v[148:151], v[160:163], v[32:35]
    v_mfma_f32_16x16x32_bf16 v[36:39], v[148:151], v[164:167], v[36:39]
    v_mfma_f32_16x16x32_bf16 v[52:55], v[148:151], v[220:223], v[52:55]
    v_mfma_f32_16x16x32_bf16 v[8:11], v[120:123], v[152:155], 0
    v_mfma_f32_16x16x32_bf16 v[12:15], v[120:123], v[156:159], 0
    v_mfma_f32_16x16x32_bf16 v[40:43], v[120:123], v[216:219], 0
    v_mfma_f32_16x16x32_bf16 v[8:11], v[136:139], v[160:163], v[8:11]
    v_mfma_f32_16x16x32_bf16 v[12:15], v[136:139], v[164:167], v[12:15]
    v_mfma_f32_16x16x32_bf16 v[40:43], v[136:139], v[220:223], v[40:43]
    v_mfma_f32_16x16x32_bf16 v[16:19], v[124:127], v[152:155], 0
    v_mfma_f32_16x16x32_bf16 v[20:23], v[124:127], v[156:159], 0
    v_mfma_f32_16x16x32_bf16 v[44:47], v[124:127], v[216:219], 0
    v_mfma_f32_16x16x32_bf16 v[16:19], v[140:143], v[160:163], v[16:19]
    v_mfma_f32_16x16x32_bf16 v[20:23], v[140:143], v[164:167], v[20:23]
    v_mfma_f32_16x16x32_bf16 v[44:47], v[140:143], v[220:223], v[44:47]
    v_lshlrev_b32 v5, 4, v1
    v_add_u32 v240, s3, v5
    v_lshl_add_u32 v241, v2, 5, s3
    s_xor_b32 s65, s38, 1
    s_mul_i32 s65, s65, 4352
    s_add_u32 s65, s65, 142592
    v_add_u32 v242, s65, v5
    v_lshl_add_u32 v243, v2, 5, s65
    ds_write_b128 v240, v[24:27] offset:0
    ds_write_b128 v240, v[28:31] offset:1024
    ds_write_b128 v240, v[32:35] offset:2048
    ds_write_b128 v240, v[36:39] offset:3072
    ds_write_b128 v241, v[48:51] offset:4096
    ds_write_b128 v241, v[52:55] offset:4112
    s_lshl_b32 s3, s37, 1
    s_add_u32 s3, s3, s29
    s_lshl_b32 s3, s3, 4
    s_add_u32 s3, s3, s36
    s_lshl_b32 s3, s3, 1
    s_add_u32 s3, s3, s28
    s_lshl_b32 s3, s3, 12
    s_add_u32 s3, s3, 2097152
    v_mov_b32 v59, s32
    v_mov_b32 v63, s32
    v_mov_b32 v67, s32
    v_mov_b32 v71, s32
    s_waitcnt lgkmcnt(0)
    s_barrier
    ds_read_b128 v[192:195], v242 offset:0
    ds_read_b128 v[196:199], v242 offset:1024
    ds_read_b128 v[200:203], v242 offset:2048
    ds_read_b128 v[204:207], v242 offset:3072
    ds_read_b128 v[208:211], v243 offset:4096
    ds_read_b128 v[212:215], v243 offset:4112
    ds_read_b128 v[104:107], v168 offset:0
    ds_read_b64_tr_b16 v[120:121], v170 offset:0
    ds_read_b64_tr_b16 v[122:123], v170 offset:512
    ds_read_b64_tr_b16 v[124:125], v171 offset:0
    ds_read_b64_tr_b16 v[126:127], v171 offset:512
    ds_read_b128 v[108:111], v168 offset:2048
    ds_read_b128 v[112:115], v168 offset:4096
    ds_read_b128 v[116:119], v168 offset:6144
    s_waitcnt lgkmcnt(8)
    v_pk_add_f32 v[8:9], v[8:9], v[192:193]
    v_pk_add_f32 v[10:11], v[10:11], v[194:195]
    v_pk_add_f32 v[12:13], v[12:13], v[196:197]
    v_pk_add_f32 v[14:15], v[14:15], v[198:199]
    v_pk_add_f32 v[16:17], v[16:17], v[200:201]
    v_pk_add_f32 v[18:19], v[18:19], v[202:203]
    v_pk_add_f32 v[20:21], v[20:21], v[204:205]
    v_pk_add_f32 v[22:23], v[22:23], v[206:207]
    v_pk_add_f32 v[40:41], v[40:41], v[208:209]
    v_pk_add_f32 v[42:43], v[42:43], v[210:211]
    v_pk_add_f32 v[44:45], v[44:45], v[212:213]
    v_pk_add_f32 v[46:47], v[46:47], v[214:215]
    v_cvt_pk_bf16_f32 v56, v8, v9
    v_cvt_pk_bf16_f32 v57, v10, v11
    v_cvt_pk_bf16_f32 v58, v40, v41
    buffer_store_dwordx4 v[56:59], v5, s[12:15], s3 offen offset:0 sc1
    v_cvt_pk_bf16_f32 v60, v16, v17
    v_cvt_pk_bf16_f32 v61, v18, v19
    v_cvt_pk_bf16_f32 v62, v44, v45
    buffer_store_dwordx4 v[60:63], v5, s[12:15], s3 offen offset:1024 sc1
    v_cvt_pk_bf16_f32 v64, v12, v13
    v_cvt_pk_bf16_f32 v65, v14, v15
    v_cvt_pk_bf16_f32 v66, v42, v43
    buffer_store_dwordx4 v[64:67], v5, s[12:15], s3 offen offset:2048 sc1
    v_cvt_pk_bf16_f32 v68, v20, v21
    v_cvt_pk_bf16_f32 v69, v22, v23
    v_cvt_pk_bf16_f32 v70, v46, v47
    buffer_store_dwordx4 v[68:71], v5, s[12:15], s3 offen offset:3072 sc1
    s_lshl_b32 s3, s38, 2
    s_add_u32 s3, s3, 141424
    v_mov_b32 v6, s3
    v_mov_b32 v247, 141376
    s_waitcnt lgkmcnt(0)
    v_mfma_f32_16x16x32_bf16 v[72:75], v[120:123], v[104:107], v[72:75]
    ds_read_b128 v[136:139], v169 offset:0
    v_mfma_f32_16x16x32_bf16 v[76:79], v[124:127], v[104:107], v[76:79]
    ds_read_b64_tr_b16 v[152:153], v170 offset:4096
    v_mfma_f32_16x16x32_bf16 v[80:83], v[120:123], v[108:111], v[80:83]
    ds_read_b64_tr_b16 v[154:155], v170 offset:4608
    v_mfma_f32_16x16x32_bf16 v[84:87], v[124:127], v[108:111], v[84:87]
    ds_read_b64_tr_b16 v[156:157], v171 offset:4096
    v_mfma_f32_16x16x32_bf16 v[88:91], v[120:123], v[112:115], v[88:91]
    ds_read_b64_tr_b16 v[158:159], v171 offset:4608
    v_mfma_f32_16x16x32_bf16 v[92:95], v[124:127], v[112:115], v[92:95]
    ds_read_b128 v[140:143], v169 offset:2048
    v_mfma_f32_16x16x32_bf16 v[96:99], v[120:123], v[116:119], v[96:99]
    ds_read_b128 v[144:147], v169 offset:4096
    v_mfma_f32_16x16x32_bf16 v[100:103], v[124:127], v[116:119], v[100:103]
    ds_read_b128 v[148:151], v169 offset:6144
    s_waitcnt lgkmcnt(0)
    s_barrier
    v_mfma_f32_16x16x32_bf16 v[72:75], v[152:155], v[136:139], v[72:75]
    ds_read_b128 v[104:107], v168 offset:16384
    v_mfma_f32_16x16x32_bf16 v[76:79], v[156:159], v[136:139], v[76:79]
    ds_read_b64_tr_b16 v[120:121], v170 offset:8192
    v_mfma_f32_16x16x32_bf16 v[80:83], v[152:155], v[140:143], v[80:83]
    ds_read_b64_tr_b16 v[122:123], v170 offset:8704
    v_mfma_f32_16x16x32_bf16 v[84:87], v[156:159], v[140:143], v[84:87]
    ds_read_b64_tr_b16 v[124:125], v171 offset:8192
    v_mfma_f32_16x16x32_bf16 v[88:91], v[152:155], v[144:147], v[88:91]
    ds_read_b64_tr_b16 v[126:127], v171 offset:8704
    v_mfma_f32_16x16x32_bf16 v[92:95], v[156:159], v[144:147], v[92:95]
    ds_read_b128 v[108:111], v168 offset:18432
    v_mfma_f32_16x16x32_bf16 v[96:99], v[152:155], v[148:151], v[96:99]
    ds_read_b128 v[112:115], v168 offset:20480
    v_mfma_f32_16x16x32_bf16 v[100:103], v[156:159], v[148:151], v[100:103]
    ds_read_b128 v[116:119], v168 offset:22528
    s_waitcnt lgkmcnt(0)
    v_mfma_f32_16x16x32_bf16 v[72:75], v[120:123], v[104:107], v[72:75]
    ds_read_b128 v[136:139], v169 offset:16384
    v_mfma_f32_16x16x32_bf16 v[76:79], v[124:127], v[104:107], v[76:79]
    ds_read_b64_tr_b16 v[152:153], v170 offset:12288
    v_mfma_f32_16x16x32_bf16 v[80:83], v[120:123], v[108:111], v[80:83]
    ds_read_b64_tr_b16 v[154:155], v170 offset:12800
    v_mfma_f32_16x16x32_bf16 v[84:87], v[124:127], v[108:111], v[84:87]
    ds_read_b64_tr_b16 v[156:157], v171 offset:12288
    v_mfma_f32_16x16x32_bf16 v[88:91], v[120:123], v[112:115], v[88:91]
    ds_read_b64_tr_b16 v[158:159], v171 offset:12800
    v_mfma_f32_16x16x32_bf16 v[92:95], v[124:127], v[112:115], v[92:95]
    ds_read_b128 v[140:143], v169 offset:18432
    v_mfma_f32_16x16x32_bf16 v[96:99], v[120:123], v[116:119], v[96:99]
    ds_read_b128 v[144:147], v169 offset:20480
    v_mfma_f32_16x16x32_bf16 v[100:103], v[124:127], v[116:119], v[100:103]
    ds_read_b128 v[148:151], v169 offset:22528
    s_waitcnt lgkmcnt(0)
    s_barrier
    v_mfma_f32_16x16x32_bf16 v[72:75], v[152:155], v[136:139], v[72:75]
    ds_read_b128 v[104:107], v168 offset:32768
    v_mfma_f32_16x16x32_bf16 v[76:79], v[156:159], v[136:139], v[76:79]
    ds_read_b64_tr_b16 v[120:121], v170 offset:16384
    v_mfma_f32_16x16x32_bf16 v[80:83], v[152:155], v[140:143], v[80:83]
    ds_read_b64_tr_b16 v[122:123], v170 offset:16896
    v_mfma_f32_16x16x32_bf16 v[84:87], v[156:159], v[140:143], v[84:87]
    ds_read_b64_tr_b16 v[124:125], v171 offset:16384
    v_mfma_f32_16x16x32_bf16 v[88:91], v[152:155], v[144:147], v[88:91]
    ds_read_b64_tr_b16 v[126:127], v171 offset:16896
    v_mfma_f32_16x16x32_bf16 v[92:95], v[156:159], v[144:147], v[92:95]
    ds_read_b128 v[108:111], v168 offset:34816
    v_mfma_f32_16x16x32_bf16 v[96:99], v[152:155], v[148:151], v[96:99]
    ds_read_b128 v[112:115], v168 offset:36864
    v_mfma_f32_16x16x32_bf16 v[100:103], v[156:159], v[148:151], v[100:103]
    ds_read_b128 v[116:119], v168 offset:38912
    s_waitcnt lgkmcnt(0)
    v_mfma_f32_16x16x32_bf16 v[72:75], v[120:123], v[104:107], v[72:75]
    ds_read_b128 v[136:139], v169 offset:32768
    v_mfma_f32_16x16x32_bf16 v[76:79], v[124:127], v[104:107], v[76:79]
    ds_read_b64_tr_b16 v[152:153], v170 offset:20480
    v_mfma_f32_16x16x32_bf16 v[80:83], v[120:123], v[108:111], v[80:83]
    ds_read_b64_tr_b16 v[154:155], v170 offset:20992
    v_mfma_f32_16x16x32_bf16 v[84:87], v[124:127], v[108:111], v[84:87]
    ds_read_b64_tr_b16 v[156:157], v171 offset:20480
    v_mfma_f32_16x16x32_bf16 v[88:91], v[120:123], v[112:115], v[88:91]
    ds_read_b64_tr_b16 v[158:159], v171 offset:20992
    v_mfma_f32_16x16x32_bf16 v[92:95], v[124:127], v[112:115], v[92:95]
    ds_read_b128 v[140:143], v169 offset:34816
    v_mfma_f32_16x16x32_bf16 v[96:99], v[120:123], v[116:119], v[96:99]
    ds_read_b128 v[144:147], v169 offset:36864
    v_mfma_f32_16x16x32_bf16 v[100:103], v[124:127], v[116:119], v[100:103]
    ds_read_b128 v[148:151], v169 offset:38912
    s_waitcnt lgkmcnt(0)
    s_barrier
    v_mfma_f32_16x16x32_bf16 v[72:75], v[152:155], v[136:139], v[72:75]
    ds_read_b128 v[104:107], v168 offset:49152
    v_mfma_f32_16x16x32_bf16 v[76:79], v[156:159], v[136:139], v[76:79]
    ds_read_b64_tr_b16 v[120:121], v170 offset:24576
    v_mfma_f32_16x16x32_bf16 v[80:83], v[152:155], v[140:143], v[80:83]
    ds_read_b64_tr_b16 v[122:123], v170 offset:25088
    v_mfma_f32_16x16x32_bf16 v[84:87], v[156:159], v[140:143], v[84:87]
    ds_read_b64_tr_b16 v[124:125], v171 offset:24576
    v_mfma_f32_16x16x32_bf16 v[88:91], v[152:155], v[144:147], v[88:91]
    ds_read_b64_tr_b16 v[126:127], v171 offset:25088
    v_mfma_f32_16x16x32_bf16 v[92:95], v[156:159], v[144:147], v[92:95]
    ds_read_b128 v[108:111], v168 offset:51200
    v_mfma_f32_16x16x32_bf16 v[96:99], v[152:155], v[148:151], v[96:99]
    ds_read_b128 v[112:115], v168 offset:53248
    v_mfma_f32_16x16x32_bf16 v[100:103], v[156:159], v[148:151], v[100:103]
    ds_read_b128 v[116:119], v168 offset:55296
    s_waitcnt lgkmcnt(0)
    v_mfma_f32_16x16x32_bf16 v[72:75], v[120:123], v[104:107], v[72:75]
    ds_read_b128 v[136:139], v169 offset:49152
    v_mfma_f32_16x16x32_bf16 v[76:79], v[124:127], v[104:107], v[76:79]
    ds_read_b64_tr_b16 v[152:153], v170 offset:28672
    v_mfma_f32_16x16x32_bf16 v[80:83], v[120:123], v[108:111], v[80:83]
    ds_read_b64_tr_b16 v[154:155], v170 offset:29184
    v_mfma_f32_16x16x32_bf16 v[84:87], v[124:127], v[108:111], v[84:87]
    ds_read_b64_tr_b16 v[156:157], v171 offset:28672
    v_mfma_f32_16x16x32_bf16 v[88:91], v[120:123], v[112:115], v[88:91]
    ds_read_b64_tr_b16 v[158:159], v171 offset:29184
    v_mfma_f32_16x16x32_bf16 v[92:95], v[124:127], v[112:115], v[92:95]
    ds_read_b128 v[140:143], v169 offset:51200
    v_mfma_f32_16x16x32_bf16 v[96:99], v[120:123], v[116:119], v[96:99]
    ds_read_b128 v[144:147], v169 offset:53248
    v_mfma_f32_16x16x32_bf16 v[100:103], v[124:127], v[116:119], v[100:103]
    ds_read_b128 v[148:151], v169 offset:55296
    s_waitcnt lgkmcnt(0)
    s_barrier
    v_mfma_f32_16x16x32_bf16 v[72:75], v[152:155], v[136:139], v[72:75]
    ds_read_b128 v[104:107], v168 offset:0
    v_mfma_f32_16x16x32_bf16 v[76:79], v[156:159], v[136:139], v[76:79]
    ds_read_b64_tr_b16 v[120:121], v170 offset:32768
    v_mfma_f32_16x16x32_bf16 v[80:83], v[152:155], v[140:143], v[80:83]
    ds_read_b64_tr_b16 v[122:123], v170 offset:33280
    v_mfma_f32_16x16x32_bf16 v[84:87], v[156:159], v[140:143], v[84:87]
    ds_read_b64_tr_b16 v[124:125], v171 offset:32768
    v_mfma_f32_16x16x32_bf16 v[88:91], v[152:155], v[144:147], v[88:91]
    ds_read_b64_tr_b16 v[126:127], v171 offset:33280
    v_mfma_f32_16x16x32_bf16 v[92:95], v[156:159], v[144:147], v[92:95]
    ds_read_b128 v[108:111], v168 offset:2048
    v_mfma_f32_16x16x32_bf16 v[96:99], v[152:155], v[148:151], v[96:99]
    ds_read_b128 v[112:115], v168 offset:4096
    v_mfma_f32_16x16x32_bf16 v[100:103], v[156:159], v[148:151], v[100:103]
    ds_read_b128 v[116:119], v168 offset:6144
    s_waitcnt lgkmcnt(0)
    v_mfma_f32_16x16x32_bf16 v[72:75], v[120:123], v[104:107], v[72:75]
    ds_read_b128 v[136:139], v169 offset:0
    v_mfma_f32_16x16x32_bf16 v[76:79], v[124:127], v[104:107], v[76:79]
    ds_read_b64_tr_b16 v[152:153], v170 offset:36864
    v_mfma_f32_16x16x32_bf16 v[80:83], v[120:123], v[108:111], v[80:83]
    ds_read_b64_tr_b16 v[154:155], v170 offset:37376
    v_mfma_f32_16x16x32_bf16 v[84:87], v[124:127], v[108:111], v[84:87]
    ds_read_b64_tr_b16 v[156:157], v171 offset:36864
    v_mfma_f32_16x16x32_bf16 v[88:91], v[120:123], v[112:115], v[88:91]
    ds_read_b64_tr_b16 v[158:159], v171 offset:37376
    v_mfma_f32_16x16x32_bf16 v[92:95], v[124:127], v[112:115], v[92:95]
    ds_read_b128 v[140:143], v169 offset:2048
    v_mfma_f32_16x16x32_bf16 v[96:99], v[120:123], v[116:119], v[96:99]
    ds_read_b128 v[144:147], v169 offset:4096
    v_mfma_f32_16x16x32_bf16 v[100:103], v[124:127], v[116:119], v[100:103]
    ds_read_b128 v[148:151], v169 offset:6144
    s_waitcnt lgkmcnt(0)
    s_barrier
    v_mfma_f32_16x16x32_bf16 v[72:75], v[152:155], v[136:139], v[72:75]
    ds_read_b128 v[104:107], v168 offset:16384
    v_mfma_f32_16x16x32_bf16 v[76:79], v[156:159], v[136:139], v[76:79]
    ds_read_b64_tr_b16 v[120:121], v170 offset:40960
    v_mfma_f32_16x16x32_bf16 v[80:83], v[152:155], v[140:143], v[80:83]
    ds_read_b64_tr_b16 v[122:123], v170 offset:41472
    v_mfma_f32_16x16x32_bf16 v[84:87], v[156:159], v[140:143], v[84:87]
    ds_read_b64_tr_b16 v[124:125], v171 offset:40960
    v_mfma_f32_16x16x32_bf16 v[88:91], v[152:155], v[144:147], v[88:91]
    ds_read_b64_tr_b16 v[126:127], v171 offset:41472
    v_mfma_f32_16x16x32_bf16 v[92:95], v[156:159], v[144:147], v[92:95]
    ds_read_b128 v[108:111], v168 offset:18432
    v_mfma_f32_16x16x32_bf16 v[96:99], v[152:155], v[148:151], v[96:99]
    ds_read_b128 v[112:115], v168 offset:20480
    v_mfma_f32_16x16x32_bf16 v[100:103], v[156:159], v[148:151], v[100:103]
    ds_read_b128 v[116:119], v168 offset:22528
    s_waitcnt lgkmcnt(0)
    v_mfma_f32_16x16x32_bf16 v[72:75], v[120:123], v[104:107], v[72:75]
    ds_read_b128 v[136:139], v169 offset:16384
    v_mfma_f32_16x16x32_bf16 v[76:79], v[124:127], v[104:107], v[76:79]
    ds_read_b64_tr_b16 v[152:153], v170 offset:45056
    v_mfma_f32_16x16x32_bf16 v[80:83], v[120:123], v[108:111], v[80:83]
    ds_read_b64_tr_b16 v[154:155], v170 offset:45568
    v_mfma_f32_16x16x32_bf16 v[84:87], v[124:127], v[108:111], v[84:87]
    ds_read_b64_tr_b16 v[156:157], v171 offset:45056
    v_mfma_f32_16x16x32_bf16 v[88:91], v[120:123], v[112:115], v[88:91]
    ds_read_b64_tr_b16 v[158:159], v171 offset:45568
    v_mfma_f32_16x16x32_bf16 v[92:95], v[124:127], v[112:115], v[92:95]
    ds_read_b128 v[140:143], v169 offset:18432
    v_mfma_f32_16x16x32_bf16 v[96:99], v[120:123], v[116:119], v[96:99]
    ds_read_b128 v[144:147], v169 offset:20480
    v_mfma_f32_16x16x32_bf16 v[100:103], v[124:127], v[116:119], v[100:103]
    ds_read_b128 v[148:151], v169 offset:22528
    s_waitcnt lgkmcnt(0)
    s_barrier
    v_mfma_f32_16x16x32_bf16 v[72:75], v[152:155], v[136:139], v[72:75]
    ds_read_b128 v[104:107], v168 offset:32768
    v_mfma_f32_16x16x32_bf16 v[76:79], v[156:159], v[136:139], v[76:79]
    ds_read_b64_tr_b16 v[120:121], v170 offset:49152
    v_mfma_f32_16x16x32_bf16 v[80:83], v[152:155], v[140:143], v[80:83]
    ds_read_b64_tr_b16 v[122:123], v170 offset:49664
    v_mfma_f32_16x16x32_bf16 v[84:87], v[156:159], v[140:143], v[84:87]
    ds_read_b64_tr_b16 v[124:125], v171 offset:49152
    v_mfma_f32_16x16x32_bf16 v[88:91], v[152:155], v[144:147], v[88:91]
    ds_read_b64_tr_b16 v[126:127], v171 offset:49664
    v_mfma_f32_16x16x32_bf16 v[92:95], v[156:159], v[144:147], v[92:95]
    ds_read_b128 v[108:111], v168 offset:34816
    v_mfma_f32_16x16x32_bf16 v[96:99], v[152:155], v[148:151], v[96:99]
    ds_read_b128 v[112:115], v168 offset:36864
    v_mfma_f32_16x16x32_bf16 v[100:103], v[156:159], v[148:151], v[100:103]
    ds_read_b128 v[116:119], v168 offset:38912
    s_waitcnt lgkmcnt(0)
    v_mfma_f32_16x16x32_bf16 v[72:75], v[120:123], v[104:107], v[72:75]
    ds_read_b128 v[136:139], v169 offset:32768
    v_mfma_f32_16x16x32_bf16 v[76:79], v[124:127], v[104:107], v[76:79]
    ds_read_b64_tr_b16 v[152:153], v170 offset:53248
    v_mfma_f32_16x16x32_bf16 v[80:83], v[120:123], v[108:111], v[80:83]
    ds_read_b64_tr_b16 v[154:155], v170 offset:53760
    v_mfma_f32_16x16x32_bf16 v[84:87], v[124:127], v[108:111], v[84:87]
    ds_read_b64_tr_b16 v[156:157], v171 offset:53248
    v_mfma_f32_16x16x32_bf16 v[88:91], v[120:123], v[112:115], v[88:91]
    ds_read_b64_tr_b16 v[158:159], v171 offset:53760
    v_mfma_f32_16x16x32_bf16 v[92:95], v[124:127], v[112:115], v[92:95]
    ds_read_b128 v[140:143], v169 offset:34816
    v_mfma_f32_16x16x32_bf16 v[96:99], v[120:123], v[116:119], v[96:99]
    ds_read_b128 v[144:147], v169 offset:36864
    v_mfma_f32_16x16x32_bf16 v[100:103], v[124:127], v[116:119], v[100:103]
    ds_read_b128 v[148:151], v169 offset:38912
    s_waitcnt lgkmcnt(0)
    v_mov_b32 v7, 7
    ds_write_b32 v6, v7
    v_mfma_f32_16x16x32_bf16 v[72:75], v[152:155], v[136:139], v[72:75]
    ds_read_b128 v[104:107], v168 offset:49152
    v_mfma_f32_16x16x32_bf16 v[76:79], v[156:159], v[136:139], v[76:79]
    ds_read_b64_tr_b16 v[120:121], v170 offset:57344
    v_mfma_f32_16x16x32_bf16 v[80:83], v[152:155], v[140:143], v[80:83]
    ds_read_b64_tr_b16 v[122:123], v170 offset:57856
    v_mfma_f32_16x16x32_bf16 v[84:87], v[156:159], v[140:143], v[84:87]
    ds_read_b64_tr_b16 v[124:125], v171 offset:57344
    v_mfma_f32_16x16x32_bf16 v[88:91], v[152:155], v[144:147], v[88:91]
    ds_read_b64_tr_b16 v[126:127], v171 offset:57856
    v_mfma_f32_16x16x32_bf16 v[92:95], v[156:159], v[144:147], v[92:95]
    ds_read_b128 v[108:111], v168 offset:51200
    v_mfma_f32_16x16x32_bf16 v[96:99], v[152:155], v[148:151], v[96:99]
    ds_read_b128 v[112:115], v168 offset:53248
    v_mfma_f32_16x16x32_bf16 v[100:103], v[156:159], v[148:151], v[100:103]
    ds_read_b128 v[116:119], v168 offset:55296
    s_waitcnt lgkmcnt(0)
    v_mfma_f32_16x16x32_bf16 v[72:75], v[120:123], v[104:107], v[72:75]
    ds_read_b128 v[136:139], v169 offset:49152
    v_mfma_f32_16x16x32_bf16 v[76:79], v[124:127], v[104:107], v[76:79]
    ds_read_b64_tr_b16 v[152:153], v170 offset:61440
    v_mfma_f32_16x16x32_bf16 v[80:83], v[120:123], v[108:111], v[80:83]
    ds_read_b64_tr_b16 v[154:155], v170 offset:61952
    v_mfma_f32_16x16x32_bf16 v[84:87], v[124:127], v[108:111], v[84:87]
    ds_read_b64_tr_b16 v[156:157], v171 offset:61440
    v_mfma_f32_16x16x32_bf16 v[88:91], v[120:123], v[112:115], v[88:91]
    ds_read_b64_tr_b16 v[158:159], v171 offset:61952
    v_mfma_f32_16x16x32_bf16 v[92:95], v[124:127], v[112:115], v[92:95]
    ds_read_b128 v[140:143], v169 offset:51200
    v_mfma_f32_16x16x32_bf16 v[96:99], v[120:123], v[116:119], v[96:99]
    ds_read_b128 v[144:147], v169 offset:53248
    v_mfma_f32_16x16x32_bf16 v[100:103], v[124:127], v[116:119], v[100:103]
    ds_read_b128 v[148:151], v169 offset:55296
    ds_read_b128 v[8:11], v247 offset:32
    s_waitcnt lgkmcnt(0)
    v_mov_b32 v7, 8
    ds_write_b32 v6, v7
L_la8:
    v_and_b32 v8, v8, v9
    v_and_b32 v10, v10, v11
    v_and_b32 v8, v8, v10
    s_nop 0
    v_readfirstlane_b32 s3, v8
    s_nop 0
    s_cmp_ge_u32 s3, 1
    s_cbranch_scc1 L_lad8
    ds_read_b128 v[8:11], v247 offset:32
    s_waitcnt lgkmcnt(0)
    s_branch L_la8
L_lad8:
    v_mfma_f32_16x16x32_bf16 v[72:75], v[152:155], v[136:139], v[72:75]
    ds_read_b128 v[104:107], v168 offset:0
    v_mfma_f32_16x16x32_bf16 v[76:79], v[156:159], v[136:139], v[76:79]
    ds_read_b64_tr_b16 v[120:121], v170 offset:0
    v_mfma_f32_16x16x32_bf16 v[80:83], v[152:155], v[140:143], v[80:83]
    ds_read_b64_tr_b16 v[122:123], v170 offset:512
    v_mfma_f32_16x16x32_bf16 v[84:87], v[156:159], v[140:143], v[84:87]
    ds_read_b64_tr_b16 v[124:125], v171 offset:0
    v_mfma_f32_16x16x32_bf16 v[88:91], v[152:155], v[144:147], v[88:91]
    ds_read_b64_tr_b16 v[126:127], v171 offset:512
    v_mfma_f32_16x16x32_bf16 v[92:95], v[156:159], v[144:147], v[92:95]
    ds_read_b128 v[108:111], v168 offset:2048
    v_mfma_f32_16x16x32_bf16 v[96:99], v[152:155], v[148:151], v[96:99]
    ds_read_b128 v[112:115], v168 offset:4096
    v_mfma_f32_16x16x32_bf16 v[100:103], v[156:159], v[148:151], v[100:103]
    ds_read_b128 v[116:119], v168 offset:6144
    s_waitcnt lgkmcnt(0)
    v_mfma_f32_16x16x32_bf16 v[72:75], v[120:123], v[104:107], v[72:75]
    ds_read_b128 v[136:139], v169 offset:0
    v_mfma_f32_16x16x32_bf16 v[76:79], v[124:127], v[104:107], v[76:79]
    ds_read_b64_tr_b16 v[152:153], v170 offset:4096
    v_mfma_f32_16x16x32_bf16 v[80:83], v[120:123], v[108:111], v[80:83]
    ds_read_b64_tr_b16 v[154:155], v170 offset:4608
    v_mfma_f32_16x16x32_bf16 v[84:87], v[124:127], v[108:111], v[84:87]
    ds_read_b64_tr_b16 v[156:157], v171 offset:4096
    v_mfma_f32_16x16x32_bf16 v[88:91], v[120:123], v[112:115], v[88:91]
    ds_read_b64_tr_b16 v[158:159], v171 offset:4608
    v_mfma_f32_16x16x32_bf16 v[92:95], v[124:127], v[112:115], v[92:95]
    ds_read_b128 v[140:143], v169 offset:2048
    v_mfma_f32_16x16x32_bf16 v[96:99], v[120:123], v[116:119], v[96:99]
    ds_read_b128 v[144:147], v169 offset:4096
    v_mfma_f32_16x16x32_bf16 v[100:103], v[124:127], v[116:119], v[100:103]
    ds_read_b128 v[148:151], v169 offset:6144
    ds_read_b128 v[8:11], v247 offset:32
    s_waitcnt lgkmcnt(0)
    v_mov_b32 v7, 9
    ds_write_b32 v6, v7
L_la9:
    v_and_b32 v8, v8, v9
    v_and_b32 v10, v10, v11
    v_and_b32 v8, v8, v10
    s_nop 0
    v_readfirstlane_b32 s3, v8
    s_nop 0
    s_cmp_ge_u32 s3, 3
    s_cbranch_scc1 L_lad9
    ds_read_b128 v[8:11], v247 offset:32
    s_waitcnt lgkmcnt(0)
    s_branch L_la9
L_lad9:
    v_mfma_f32_16x16x32_bf16 v[72:75], v[152:155], v[136:139], v[72:75]
    ds_read_b128 v[104:107], v168 offset:16384
    v_mfma_f32_16x16x32_bf16 v[76:79], v[156:159], v[136:139], v[76:79]
    ds_read_b64_tr_b16 v[120:121], v170 offset:8192
    v_mfma_f32_16x16x32_bf16 v[80:83], v[152:155], v[140:143], v[80:83]
    ds_read_b64_tr_b16 v[122:123], v170 offset:8704
    v_mfma_f32_16x16x32_bf16 v[84:87], v[156:159], v[140:143], v[84:87]
    ds_read_b64_tr_b16 v[124:125], v171 offset:8192
    v_mfma_f32_16x16x32_bf16 v[88:91], v[152:155], v[144:147], v[88:91]
    ds_read_b64_tr_b16 v[126:127], v171 offset:8704
    v_mfma_f32_16x16x32_bf16 v[92:95], v[156:159], v[144:147], v[92:95]
    ds_read_b128 v[108:111], v168 offset:18432
    v_mfma_f32_16x16x32_bf16 v[96:99], v[152:155], v[148:151], v[96:99]
    ds_read_b128 v[112:115], v168 offset:20480
    v_mfma_f32_16x16x32_bf16 v[100:103], v[156:159], v[148:151], v[100:103]
    ds_read_b128 v[116:119], v168 offset:22528
    s_waitcnt lgkmcnt(0)
    v_mfma_f32_16x16x32_bf16 v[72:75], v[120:123], v[104:107], v[72:75]
    ds_read_b128 v[136:139], v169 offset:16384
    v_mfma_f32_16x16x32_bf16 v[76:79], v[124:127], v[104:107], v[76:79]
    ds_read_b64_tr_b16 v[152:153], v170 offset:12288
    v_mfma_f32_16x16x32_bf16 v[80:83], v[120:123], v[108:111], v[80:83]
    ds_read_b64_tr_b16 v[154:155], v170 offset:12800
    v_mfma_f32_16x16x32_bf16 v[84:87], v[124:127], v[108:111], v[84:87]
    ds_read_b64_tr_b16 v[156:157], v171 offset:12288
    v_mfma_f32_16x16x32_bf16 v[88:91], v[120:123], v[112:115], v[88:91]
    ds_read_b64_tr_b16 v[158:159], v171 offset:12800
    v_mfma_f32_16x16x32_bf16 v[92:95], v[124:127], v[112:115], v[92:95]
    ds_read_b128 v[140:143], v169 offset:18432
    v_mfma_f32_16x16x32_bf16 v[96:99], v[120:123], v[116:119], v[96:99]
    ds_read_b128 v[144:147], v169 offset:20480
    v_mfma_f32_16x16x32_bf16 v[100:103], v[124:127], v[116:119], v[100:103]
    ds_read_b128 v[148:151], v169 offset:22528
    s_waitcnt lgkmcnt(0)
    v_mov_b32 v7, 10
    ds_write_b32 v6, v7
    s_lshl_b32 s3, s29, 7
    s_add_u32 s3, s3, 140544
    v_lshl_add_u32 v243, v2, 4, s3
    v_mfma_f32_16x16x32_bf16 v[72:75], v[152:155], v[136:139], v[72:75]
    ds_read_b128 v[192:195], v243 offset:0
    v_mfma_f32_16x16x32_bf16 v[76:79], v[156:159], v[136:139], v[76:79]
    ds_read_b128 v[196:199], v243 offset:64
    v_mfma_f32_16x16x32_bf16 v[80:83], v[152:155], v[140:143], v[80:83]
    v_mfma_f32_16x16x32_bf16 v[84:87], v[156:159], v[140:143], v[84:87]
    v_mfma_f32_16x16x32_bf16 v[88:91], v[152:155], v[144:147], v[88:91]
    v_mfma_f32_16x16x32_bf16 v[92:95], v[156:159], v[144:147], v[92:95]
    v_mfma_f32_16x16x32_bf16 v[96:99], v[152:155], v[148:151], v[96:99]
    v_mfma_f32_16x16x32_bf16 v[100:103], v[156:159], v[148:151], v[100:103]
    s_waitcnt lgkmcnt(0)
    v_pk_fma_f32 v[72:73], v[180:181], v[192:193], v[72:73] op_sel_hi:[0,1,1] neg_lo:[1,0,0] neg_hi:[1,0,0]
    v_pk_fma_f32 v[74:75], v[180:181], v[194:195], v[74:75] op_sel_hi:[0,1,1] neg_lo:[1,0,0] neg_hi:[1,0,0]
    v_pk_fma_f32 v[76:77], v[180:181], v[196:197], v[76:77] op_sel_hi:[0,1,1] neg_lo:[1,0,0] neg_hi:[1,0,0]
    v_pk_fma_f32 v[78:79], v[180:181], v[198:199], v[78:79] op_sel_hi:[0,1,1] neg_lo:[1,0,0] neg_hi:[1,0,0]
    v_cvt_pk_bf16_f32 v104, v72, v73
    v_cvt_pk_bf16_f32 v105, v74, v75
    v_cvt_pk_bf16_f32 v106, v76, v77
    v_cvt_pk_bf16_f32 v107, v78, v79
    v_pk_fma_f32 v[80:81], v[182:183], v[192:193], v[80:81] op_sel_hi:[0,1,1] neg_lo:[1,0,0] neg_hi:[1,0,0]
    v_pk_fma_f32 v[82:83], v[182:183], v[194:195], v[82:83] op_sel_hi:[0,1,1] neg_lo:[1,0,0] neg_hi:[1,0,0]
    v_pk_fma_f32 v[84:85], v[182:183], v[196:197], v[84:85] op_sel_hi:[0,1,1] neg_lo:[1,0,0] neg_hi:[1,0,0]
    v_pk_fma_f32 v[86:87], v[182:183], v[198:199], v[86:87] op_sel_hi:[0,1,1] neg_lo:[1,0,0] neg_hi:[1,0,0]
    v_cvt_pk_bf16_f32 v108, v80, v81
    v_cvt_pk_bf16_f32 v109, v82, v83
    v_cvt_pk_bf16_f32 v110, v84, v85
    v_cvt_pk_bf16_f32 v111, v86, v87
    v_pk_fma_f32 v[88:89], v[184:185], v[192:193], v[88:89] op_sel_hi:[0,1,1] neg_lo:[1,0,0] neg_hi:[1,0,0]
    v_pk_fma_f32 v[90:91], v[184:185], v[194:195], v[90:91] op_sel_hi:[0,1,1] neg_lo:[1,0,0] neg_hi:[1,0,0]
    v_pk_fma_f32 v[92:93], v[184:185], v[196:197], v[92:93] op_sel_hi:[0,1,1] neg_lo:[1,0,0] neg_hi:[1,0,0]
    v_pk_fma_f32 v[94:95], v[184:185], v[198:199], v[94:95] op_sel_hi:[0,1,1] neg_lo:[1,0,0] neg_hi:[1,0,0]
    v_cvt_pk_bf16_f32 v112, v88, v89
    v_cvt_pk_bf16_f32 v113, v90, v91
    v_cvt_pk_bf16_f32 v114, v92, v93
    v_cvt_pk_bf16_f32 v115, v94, v95
    v_pk_fma_f32 v[96:97], v[186:187], v[192:193], v[96:97] op_sel_hi:[0,1,1] neg_lo:[1,0,0] neg_hi:[1,0,0]
    v_pk_fma_f32 v[98:99], v[186:187], v[194:195], v[98:99] op_sel_hi:[0,1,1] neg_lo:[1,0,0] neg_hi:[1,0,0]
    v_pk_fma_f32 v[100:101], v[186:187], v[196:197], v[100:101] op_sel_hi:[0,1,1] neg_lo:[1,0,0] neg_hi:[1,0,0]
    v_pk_fma_f32 v[102:103], v[186:187], v[198:199], v[102:103] op_sel_hi:[0,1,1] neg_lo:[1,0,0] neg_hi:[1,0,0]
    v_cvt_pk_bf16_f32 v116, v96, v97
    v_cvt_pk_bf16_f32 v117, v98, v99
    v_cvt_pk_bf16_f32 v118, v100, v101
    v_cvt_pk_bf16_f32 v119, v102, v103
    v_mfma_f32_16x16x32_bf16 v[120:123], v[172:175], v[104:107], 0
    v_mfma_f32_16x16x32_bf16 v[124:127], v[176:179], v[104:107], 0
    v_mfma_f32_16x16x32_bf16 v[128:131], v[172:175], v[108:111], 0
    v_mfma_f32_16x16x32_bf16 v[132:135], v[176:179], v[108:111], 0
    v_mfma_f32_16x16x32_bf16 v[136:139], v[172:175], v[112:115], 0
    v_mfma_f32_16x16x32_bf16 v[140:143], v[176:179], v[112:115], 0
    v_mfma_f32_16x16x32_bf16 v[144:147], v[172:175], v[116:119], 0
    v_mfma_f32_16x16x32_bf16 v[148:151], v[176:179], v[116:119], 0
    s_nop 0
    v_max3_f32 v224, v120, v121, v122
    v_min3_f32 v232, v120, v121, v122
    v_max3_f32 v224, v224, v123, v124
    v_min3_f32 v232, v232, v123, v124
    v_max3_f32 v224, v224, v125, v126
    v_min3_f32 v232, v232, v125, v126
    v_max_f32 v224, v224, v127
    v_min_f32 v232, v232, v127
    v_max3_f32 v226, v128, v129, v130
    v_min3_f32 v234, v128, v129, v130
    v_max3_f32 v226, v226, v131, v132
    v_min3_f32 v234, v234, v131, v132
    v_max3_f32 v226, v226, v133, v134
    v_min3_f32 v234, v234, v133, v134
    v_max_f32 v226, v226, v135
    v_min_f32 v234, v234, v135
    v_max3_f32 v228, v136, v137, v138
    v_min3_f32 v236, v136, v137, v138
    v_max3_f32 v228, v228, v139, v140
    v_min3_f32 v236, v236, v139, v140
    v_max3_f32 v228, v228, v141, v142
    v_min3_f32 v236, v236, v141, v142
    v_max_f32 v228, v228, v143
    v_min_f32 v236, v236, v143
    v_max3_f32 v230, v144, v145, v146
    v_min3_f32 v238, v144, v145, v146
    v_max3_f32 v230, v230, v147, v148
    v_min3_f32 v238, v238, v147, v148
    v_max3_f32 v230, v230, v149, v150
    v_min3_f32 v238, v238, v149, v150
    v_max_f32 v230, v230, v151
    v_min_f32 v238, v238, v151
    v_permlane32_swap_b32 v224, v228
    v_permlane32_swap_b32 v226, v230
    v_permlane32_swap_b32 v232, v236
    v_permlane32_swap_b32 v234, v238
    v_max_f32 v224, v224, v228
    v_max_f32 v226, v226, v230
    v_min_f32 v232, v232, v236
    v_min_f32 v234, v234, v238
    v_permlane16_swap_b32 v224, v226
    s_nop 0
    v_permlane16_swap_b32 v232, v234
    v_max_f32 v224, v224, v226
    v_min_f32 v232, v232, v234
    v_mul_f32 v224, v224, v181
    v_mul_f32 v232, v232, v181
    v_mov_b32 v226, v224
    v_mov_b32 v234, v232
    s_nop 0
    v_permlane16_swap_b32 v224, v226
    v_permlane16_swap_b32 v232, v234
    v_mov_b32 v228, v224
    v_mov_b32 v230, v226
    v_mov_b32 v236, v232
    v_mov_b32 v238, v234
    v_permlane32_swap_b32 v224, v228
    v_permlane32_swap_b32 v226, v230
    v_permlane32_swap_b32 v232, v236
    v_permlane32_swap_b32 v234, v238
    v_pk_fma_f32 v[8:9], v[120:121], v[248:249], v[224:225] op_sel_hi:[1,0,0] neg_lo:[0,0,1] neg_hi:[0,0,1]
    v_pk_fma_f32 v[16:17], v[120:121], v[248:249], v[232:233] op_sel_hi:[1,0,0] neg_lo:[1,0,0] neg_hi:[1,0,0]
    v_pk_fma_f32 v[10:11], v[122:123], v[248:249], v[224:225] op_sel_hi:[1,0,0] neg_lo:[0,0,1] neg_hi:[0,0,1]
    v_pk_fma_f32 v[18:19], v[122:123], v[248:249], v[232:233] op_sel_hi:[1,0,0] neg_lo:[1,0,0] neg_hi:[1,0,0]
    v_pk_fma_f32 v[12:13], v[124:125], v[248:249], v[224:225] op_sel_hi:[1,0,0] neg_lo:[0,0,1] neg_hi:[0,0,1]
    v_pk_fma_f32 v[20:21], v[124:125], v[248:249], v[232:233] op_sel_hi:[1,0,0] neg_lo:[1,0,0] neg_hi:[1,0,0]
    v_pk_fma_f32 v[14:15], v[126:127], v[248:249], v[224:225] op_sel_hi:[1,0,0] neg_lo:[0,0,1] neg_hi:[0,0,1]
    v_pk_fma_f32 v[22:23], v[126:127], v[248:249], v[232:233] op_sel_hi:[1,0,0] neg_lo:[1,0,0] neg_hi:[1,0,0]
    v_exp_f32 v8, v8
    v_exp_f32 v9, v9
    v_exp_f32 v10, v10
    v_exp_f32 v11, v11
    v_exp_f32 v12, v12
    v_exp_f32 v13, v13
    v_exp_f32 v14, v14
    v_exp_f32 v15, v15
    v_exp_f32 v16, v16
    v_exp_f32 v17, v17
    v_exp_f32 v18, v18
    v_exp_f32 v19, v19
    v_exp_f32 v20, v20
    v_exp_f32 v21, v21
    v_exp_f32 v22, v22
    v_exp_f32 v23, v23
    v_pk_fma_f32 v[24:25], v[128:129], v[250:251], v[226:227] op_sel_hi:[1,0,0] neg_lo:[0,0,1] neg_hi:[0,0,1]
    v_pk_fma_f32 v[32:33], v[128:129], v[250:251], v[234:235] op_sel_hi:[1,0,0] neg_lo:[1,0,0] neg_hi:[1,0,0]
    v_pk_fma_f32 v[26:27], v[130:131], v[250:251], v[226:227] op_sel_hi:[1,0,0] neg_lo:[0,0,1] neg_hi:[0,0,1]
    v_pk_fma_f32 v[34:35], v[130:131], v[250:251], v[234:235] op_sel_hi:[1,0,0] neg_lo:[1,0,0] neg_hi:[1,0,0]
    v_pk_fma_f32 v[28:29], v[132:133], v[250:251], v[226:227] op_sel_hi:[1,0,0] neg_lo:[0,0,1] neg_hi:[0,0,1]
    v_pk_fma_f32 v[36:37], v[132:133], v[250:251], v[234:235] op_sel_hi:[1,0,0] neg_lo:[1,0,0] neg_hi:[1,0,0]
    v_pk_fma_f32 v[30:31], v[134:135], v[250:251], v[226:227] op_sel_hi:[1,0,0] neg_lo:[0,0,1] neg_hi:[0,0,1]
    v_pk_fma_f32 v[38:39], v[134:135], v[250:251], v[234:235] op_sel_hi:[1,0,0] neg_lo:[1,0,0] neg_hi:[1,0,0]
    v_exp_f32 v24, v24
    v_exp_f32 v25, v25
    v_exp_f32 v26, v26
    v_exp_f32 v27, v27
    v_exp_f32 v28, v28
    v_exp_f32 v29, v29
    v_exp_f32 v30, v30
    v_exp_f32 v31, v31
    v_exp_f32 v32, v32
    v_exp_f32 v33, v33
    v_exp_f32 v34, v34
    v_exp_f32 v35, v35
    v_exp_f32 v36, v36
    v_exp_f32 v37, v37
    v_exp_f32 v38, v38
    v_exp_f32 v39, v39
    v_pk_fma_f32 v[40:41], v[136:137], v[252:253], v[228:229] op_sel_hi:[1,0,0] neg_lo:[0,0,1] neg_hi:[0,0,1]
    v_pk_fma_f32 v[48:49], v[136:137], v[252:253], v[236:237] op_sel_hi:[1,0,0] neg_lo:[1,0,0] neg_hi:[1,0,0]
    v_pk_fma_f32 v[42:43], v[138:139], v[252:253], v[228:229] op_sel_hi:[1,0,0] neg_lo:[0,0,1] neg_hi:[0,0,1]
    v_pk_fma_f32 v[50:51], v[138:139], v[252:253], v[236:237] op_sel_hi:[1,0,0] neg_lo:[1,0,0] neg_hi:[1,0,0]
    v_pk_fma_f32 v[44:45], v[140:141], v[252:253], v[228:229] op_sel_hi:[1,0,0] neg_lo:[0,0,1] neg_hi:[0,0,1]
    v_pk_fma_f32 v[52:53], v[140:141], v[252:253], v[236:237] op_sel_hi:[1,0,0] neg_lo:[1,0,0] neg_hi:[1,0,0]
    v_pk_fma_f32 v[46:47], v[142:143], v[252:253], v[228:229] op_sel_hi:[1,0,0] neg_lo:[0,0,1] neg_hi:[0,0,1]
    v_pk_fma_f32 v[54:55], v[142:143], v[252:253], v[236:237] op_sel_hi:[1,0,0] neg_lo:[1,0,0] neg_hi:[1,0,0]
    v_exp_f32 v40, v40
    v_exp_f32 v41, v41
    v_exp_f32 v42, v42
    v_exp_f32 v43, v43
    v_exp_f32 v44, v44
    v_exp_f32 v45, v45
    v_exp_f32 v46, v46
    v_exp_f32 v47, v47
    v_exp_f32 v48, v48
    v_exp_f32 v49, v49
    v_exp_f32 v50, v50
    v_exp_f32 v51, v51
    v_exp_f32 v52, v52
    v_exp_f32 v53, v53
    v_exp_f32 v54, v54
    v_exp_f32 v55, v55
    v_pk_fma_f32 v[56:57], v[144:145], v[254:255], v[230:231] op_sel_hi:[1,0,0] neg_lo:[0,0,1] neg_hi:[0,0,1]
    v_pk_fma_f32 v[64:65], v[144:145], v[254:255], v[238:239] op_sel_hi:[1,0,0] neg_lo:[1,0,0] neg_hi:[1,0,0]
    v_pk_fma_f32 v[58:59], v[146:147], v[254:255], v[230:231] op_sel_hi:[1,0,0] neg_lo:[0,0,1] neg_hi:[0,0,1]
    v_pk_fma_f32 v[66:67], v[146:147], v[254:255], v[238:239] op_sel_hi:[1,0,0] neg_lo:[1,0,0] neg_hi:[1,0,0]
    v_pk_fma_f32 v[60:61], v[148:149], v[254:255], v[230:231] op_sel_hi:[1,0,0] neg_lo:[0,0,1] neg_hi:[0,0,1]
    v_pk_fma_f32 v[68:69], v[148:149], v[254:255], v[238:239] op_sel_hi:[1,0,0] neg_lo:[1,0,0] neg_hi:[1,0,0]
    v_pk_fma_f32 v[62:63], v[150:151], v[254:255], v[230:231] op_sel_hi:[1,0,0] neg_lo:[0,0,1] neg_hi:[0,0,1]
    v_pk_fma_f32 v[70:71], v[150:151], v[254:255], v[238:239] op_sel_hi:[1,0,0] neg_lo:[1,0,0] neg_hi:[1,0,0]
    v_exp_f32 v56, v56
    v_exp_f32 v57, v57
    v_exp_f32 v58, v58
    v_exp_f32 v59, v59
    v_exp_f32 v60, v60
    v_exp_f32 v61, v61
    v_exp_f32 v62, v62
    v_exp_f32 v63, v63
    v_exp_f32 v64, v64
    v_exp_f32 v65, v65
    v_exp_f32 v66, v66
    v_exp_f32 v67, v67
    v_exp_f32 v68, v68
    v_exp_f32 v69, v69
    v_exp_f32 v70, v70
    v_exp_f32 v71, v71
    v_pk_add_f32 v[120:121], v[8:9], v[10:11]
    v_pk_add_f32 v[122:123], v[12:13], v[14:15]
    v_pk_add_f32 v[124:125], v[16:17], v[18:19]
    v_pk_add_f32 v[126:127], v[20:21], v[22:23]
    v_pk_add_f32 v[128:129], v[24:25], v[26:27]
    v_pk_add_f32 v[130:131], v[28:29], v[30:31]
    v_pk_add_f32 v[132:133], v[32:33], v[34:35]
    v_pk_add_f32 v[134:135], v[36:37], v[38:39]
    v_pk_add_f32 v[136:137], v[40:41], v[42:43]
    v_pk_add_f32 v[138:139], v[44:45], v[46:47]
    v_pk_add_f32 v[140:141], v[48:49], v[50:51]
    v_pk_add_f32 v[142:143], v[52:53], v[54:55]
    v_pk_add_f32 v[144:145], v[56:57], v[58:59]
    v_pk_add_f32 v[146:147], v[60:61], v[62:63]
    v_pk_add_f32 v[148:149], v[64:65], v[66:67]
    v_pk_add_f32 v[150:151], v[68:69], v[70:71]
    v_pk_add_f32 v[120:121], v[120:121], v[122:123]
    v_pk_add_f32 v[124:125], v[124:125], v[126:127]
    v_pk_add_f32 v[128:129], v[128:129], v[130:131]
    v_pk_add_f32 v[132:133], v[132:133], v[134:135]
    v_pk_add_f32 v[136:137], v[136:137], v[138:139]
    v_pk_add_f32 v[140:141], v[140:141], v[142:143]
    v_pk_add_f32 v[144:145], v[144:145], v[146:147]
    v_pk_add_f32 v[148:149], v[148:149], v[150:151]
    v_add_f32 v224, v120, v121
    v_add_f32 v232, v124, v125
    v_add_f32 v226, v128, v129
    v_add_f32 v234, v132, v133
    v_add_f32 v228, v136, v137
    v_add_f32 v236, v140, v141
    v_add_f32 v230, v144, v145
    v_add_f32 v238, v148, v149
    v_permlane32_swap_b32 v224, v228
    v_permlane32_swap_b32 v226, v230
    v_permlane32_swap_b32 v232, v236
    v_permlane32_swap_b32 v234, v238
    v_add_f32 v224, v224, v228
    v_add_f32 v226, v226, v230
    v_add_f32 v232, v232, v236
    v_add_f32 v234, v234, v238
    v_permlane16_swap_b32 v224, v226
    s_nop 0
    v_permlane16_swap_b32 v232, v234
    v_add_f32 v224, v224, v226
    v_add_f32 v232, v232, v234
    v_rcp_f32 v232, v232
    s_lshl_b32 s3, s29, 12
    s_add_u32 s3, s3, 131072
    v_add_u32 v240, s3, v5
    s_lshl_b32 s3, s29, 7
    s_add_u32 s3, s3, 139264
    v_lshl_add_u32 v241, v2, 3, s3
    v_mul_f32 v232, v232, v224
    v_mul_f32 v224, 0x358637bd, v224
    v_mov_b32 v226, v224
    v_mov_b32 v234, v232
    s_nop 0
    v_permlane16_swap_b32 v224, v226
    v_permlane16_swap_b32 v232, v234
    v_mov_b32 v228, v224
    v_mov_b32 v230, v226
    v_mov_b32 v236, v232
    v_mov_b32 v238, v234
    v_permlane32_swap_b32 v224, v228
    v_permlane32_swap_b32 v226, v230
    v_permlane32_swap_b32 v232, v236
    v_permlane32_swap_b32 v234, v238
    v_pk_mul_f32 v[16:17], v[16:17], v[232:233] op_sel_hi:[1,0]
    v_pk_mul_f32 v[18:19], v[18:19], v[232:233] op_sel_hi:[1,0]
    v_pk_mul_f32 v[20:21], v[20:21], v[232:233] op_sel_hi:[1,0]
    v_pk_mul_f32 v[22:23], v[22:23], v[232:233] op_sel_hi:[1,0]
    v_cvt_pk_bf16_f32 v72, v8, v9
    v_cvt_pk_bf16_f32 v73, v10, v11
    v_cvt_pk_bf16_f32 v74, v12, v13
    v_cvt_pk_bf16_f32 v75, v14, v15
    v_cvt_pk_bf16_f32 v76, v16, v17
    v_cvt_pk_bf16_f32 v77, v18, v19
    v_cvt_pk_bf16_f32 v78, v20, v21
    v_cvt_pk_bf16_f32 v79, v22, v23
    v_pk_mul_f32 v[32:33], v[32:33], v[234:235] op_sel_hi:[1,0]
    v_pk_mul_f32 v[34:35], v[34:35], v[234:235] op_sel_hi:[1,0]
    v_pk_mul_f32 v[36:37], v[36:37], v[234:235] op_sel_hi:[1,0]
    v_pk_mul_f32 v[38:39], v[38:39], v[234:235] op_sel_hi:[1,0]
    v_cvt_pk_bf16_f32 v80, v24, v25
    v_cvt_pk_bf16_f32 v81, v26, v27
    v_cvt_pk_bf16_f32 v82, v28, v29
    v_cvt_pk_bf16_f32 v83, v30, v31
    v_cvt_pk_bf16_f32 v84, v32, v33
    v_cvt_pk_bf16_f32 v85, v34, v35
    v_cvt_pk_bf16_f32 v86, v36, v37
    v_cvt_pk_bf16_f32 v87, v38, v39
    v_pk_mul_f32 v[48:49], v[48:49], v[236:237] op_sel_hi:[1,0]
    v_pk_mul_f32 v[50:51], v[50:51], v[236:237] op_sel_hi:[1,0]
    v_pk_mul_f32 v[52:53], v[52:53], v[236:237] op_sel_hi:[1,0]
    v_pk_mul_f32 v[54:55], v[54:55], v[236:237] op_sel_hi:[1,0]
    v_cvt_pk_bf16_f32 v88, v40, v41
    v_cvt_pk_bf16_f32 v89, v42, v43
    v_cvt_pk_bf16_f32 v90, v44, v45
    v_cvt_pk_bf16_f32 v91, v46, v47
    v_cvt_pk_bf16_f32 v92, v48, v49
    v_cvt_pk_bf16_f32 v93, v50, v51
    v_cvt_pk_bf16_f32 v94, v52, v53
    v_cvt_pk_bf16_f32 v95, v54, v55
    v_pk_mul_f32 v[64:65], v[64:65], v[238:239] op_sel_hi:[1,0]
    v_pk_mul_f32 v[66:67], v[66:67], v[238:239] op_sel_hi:[1,0]
    v_pk_mul_f32 v[68:69], v[68:69], v[238:239] op_sel_hi:[1,0]
    v_pk_mul_f32 v[70:71], v[70:71], v[238:239] op_sel_hi:[1,0]
    v_cvt_pk_bf16_f32 v96, v56, v57
    v_cvt_pk_bf16_f32 v97, v58, v59
    v_cvt_pk_bf16_f32 v98, v60, v61
    v_cvt_pk_bf16_f32 v99, v62, v63
    v_cvt_pk_bf16_f32 v100, v64, v65
    v_cvt_pk_bf16_f32 v101, v66, v67
    v_cvt_pk_bf16_f32 v102, v68, v69
    v_cvt_pk_bf16_f32 v103, v70, v71
    s_lshl_b32 s73, s30, 8
    s_add_u32 s73, s73, 131072
    v_lshlrev_b32 v161, 2, v1
    s_lshl_b32 s3, s36, 3
    s_lshl_b32 s65, s28, 2
    s_add_u32 s3, s3, s65
    s_lshl_b32 s3, s3, 5
    s_lshl_b32 s65, s37, 1
    s_add_u32 s65, s65, s29
    s_add_u32 s3, s3, s65
    s_lshl_b32 s3, s3, 10
    s_add_u32 s3, s3, 12582912
    s_lshl_b32 s66, s36, 4
    s_add_u32 s66, s66, s37
    s_lshl_b32 s66, s66, 7
    s_add_u32 s66, s66, 1310720
    v_mov_b32 v6, 141376
L_kv:
    ds_read_b64 v[104:105], v6
    s_waitcnt lgkmcnt(0)
    v_and_b32 v104, v104, v105
    s_nop 0
    v_readfirstlane_b32 s65, v104
    s_nop 0
    s_cmp_eq_u32 s65, 1
    s_cbranch_scc0 L_kv
    ds_read_b128 v[104:107], v240 offset:0
    ds_read_b128 v[108:111], v240 offset:1024
    ds_read_b128 v[112:115], v240 offset:2048
    ds_read_b128 v[116:119], v240 offset:3072
    ds_read_b64 v[120:121], v241 offset:0
    ds_read_b64 v[122:123], v241 offset:32
    ds_read_b64 v[124:125], v241 offset:64
    ds_read_b64 v[126:127], v241 offset:96
    s_waitcnt lgkmcnt(0)
    v_mfma_f32_16x16x32_bf16 v[40:43], v[120:123], v[72:75], 0
    v_mfma_f32_16x16x32_bf16 v[40:43], v[124:127], v[76:79], v[40:43]
    v_mfma_f32_16x16x32_bf16 v[44:47], v[120:123], v[80:83], 0
    v_mfma_f32_16x16x32_bf16 v[44:47], v[124:127], v[84:87], v[44:47]
    v_mfma_f32_16x16x32_bf16 v[48:51], v[120:123], v[88:91], 0
    v_mfma_f32_16x16x32_bf16 v[48:51], v[124:127], v[92:95], v[48:51]
    v_mfma_f32_16x16x32_bf16 v[52:55], v[120:123], v[96:99], 0
    v_mfma_f32_16x16x32_bf16 v[52:55], v[124:127], v[100:103], v[52:55]
    v_mfma_f32_16x16x32_bf16 v[8:11], v[104:107], v[72:75], 0
    v_mfma_f32_16x16x32_bf16 v[8:11], v[112:115], v[76:79], v[8:11]
    v_mfma_f32_16x16x32_bf16 v[12:15], v[108:111], v[72:75], 0
    v_mfma_f32_16x16x32_bf16 v[12:15], v[116:119], v[76:79], v[12:15]
    v_add_f32 v40, v40, v224
    v_add_f32 v44, v44, v226
    v_add_f32 v48, v48, v228
    s_nop 0
    v_add_f32 v52, v52, v230
    v_mfma_f32_16x16x32_bf16 v[16:19], v[104:107], v[80:83], 0
    v_mfma_f32_16x16x32_bf16 v[16:19], v[112:115], v[84:87], v[16:19]
    v_mfma_f32_16x16x32_bf16 v[20:23], v[108:111], v[80:83], 0
    v_mfma_f32_16x16x32_bf16 v[20:23], v[116:119], v[84:87], v[20:23]
    v_rcp_f32 v40, v40
    v_rcp_f32 v44, v44
    v_rcp_f32 v48, v48
    v_rcp_f32 v52, v52
    v_mfma_f32_16x16x32_bf16 v[24:27], v[104:107], v[88:91], 0
    v_mfma_f32_16x16x32_bf16 v[24:27], v[112:115], v[92:95], v[24:27]
    v_mfma_f32_16x16x32_bf16 v[28:31], v[108:111], v[88:91], 0
    v_mfma_f32_16x16x32_bf16 v[28:31], v[116:119], v[92:95], v[28:31]
    v_mfma_f32_16x16x32_bf16 v[32:35], v[104:107], v[96:99], 0
    v_mfma_f32_16x16x32_bf16 v[32:35], v[112:115], v[100:103], v[32:35]
    v_mfma_f32_16x16x32_bf16 v[36:39], v[108:111], v[96:99], 0
    v_mfma_f32_16x16x32_bf16 v[36:39], v[116:119], v[100:103], v[36:39]
    v_pk_mul_f32 v[8:9], v[8:9], v[40:41] op_sel_hi:[1,0]
    v_pk_mul_f32 v[10:11], v[10:11], v[40:41] op_sel_hi:[1,0]
    v_pk_mul_f32 v[12:13], v[12:13], v[40:41] op_sel_hi:[1,0]
    v_pk_mul_f32 v[14:15], v[14:15], v[40:41] op_sel_hi:[1,0]
    v_cvt_pk_bf16_f32 v128, v8, v9
    v_cvt_pk_bf16_f32 v129, v10, v11
    v_cvt_pk_bf16_f32 v130, v12, v13
    v_cvt_pk_bf16_f32 v131, v14, v15
    buffer_store_dwordx4 v[128:131], v5, s[12:15], s3 offen sc1
    s_add_u32 s3, s3, 32768
    v_pk_mul_f32 v[16:17], v[16:17], v[44:45] op_sel_hi:[1,0]
    v_pk_mul_f32 v[18:19], v[18:19], v[44:45] op_sel_hi:[1,0]
    v_pk_mul_f32 v[20:21], v[20:21], v[44:45] op_sel_hi:[1,0]
    v_pk_mul_f32 v[22:23], v[22:23], v[44:45] op_sel_hi:[1,0]
    v_cvt_pk_bf16_f32 v132, v16, v17
    v_cvt_pk_bf16_f32 v133, v18, v19
    v_cvt_pk_bf16_f32 v134, v20, v21
    v_cvt_pk_bf16_f32 v135, v22, v23
    buffer_store_dwordx4 v[132:135], v5, s[12:15], s3 offen sc1
    s_add_u32 s3, s3, 32768
    v_pk_mul_f32 v[24:25], v[24:25], v[48:49] op_sel_hi:[1,0]
    v_pk_mul_f32 v[26:27], v[26:27], v[48:49] op_sel_hi:[1,0]
    v_pk_mul_f32 v[28:29], v[28:29], v[48:49] op_sel_hi:[1,0]
    v_pk_mul_f32 v[30:31], v[30:31], v[48:49] op_sel_hi:[1,0]
    v_cvt_pk_bf16_f32 v136, v24, v25
    v_cvt_pk_bf16_f32 v137, v26, v27
    v_cvt_pk_bf16_f32 v138, v28, v29
    v_cvt_pk_bf16_f32 v139, v30, v31
    buffer_store_dwordx4 v[136:139], v5, s[12:15], s3 offen sc1
    s_add_u32 s3, s3, 32768
    v_pk_mul_f32 v[32:33], v[32:33], v[52:53] op_sel_hi:[1,0]
    v_pk_mul_f32 v[34:35], v[34:35], v[52:53] op_sel_hi:[1,0]
    v_pk_mul_f32 v[36:37], v[36:37], v[52:53] op_sel_hi:[1,0]
    v_pk_mul_f32 v[38:39], v[38:39], v[52:53] op_sel_hi:[1,0]
    v_cvt_pk_bf16_f32 v140, v32, v33
    v_cvt_pk_bf16_f32 v141, v34, v35
    v_cvt_pk_bf16_f32 v142, v36, v37
    v_cvt_pk_bf16_f32 v143, v38, v39
    buffer_store_dwordx4 v[140:143], v5, s[12:15], s3 offen sc1
    s_lshl_b32 s3, s38, 2
    s_add_u32 s3, s3, 141456
    v_mov_b32 v6, s3
    v_mov_b32 v7, 1
    ds_write_b32 v6, v7
    v_lshrrev_b32 v6, 2, v1
    v_lshlrev_b32 v6, 7, v6
    v_and_b32 v7, 3, v1
    v_lshl_add_u32 v6, v7, 3, v6
    v_bfe_u32 v7, v1, 3, 2
    v_xor_b32 v4, 0, v7
    v_lshl_add_u32 v250, v4, 5, v6
    v_xor_b32 v4, 1, v7
    v_lshl_add_u32 v251, v4, 5, v6
    v_xor_b32 v4, 2, v7
    v_lshl_add_u32 v252, v4, 5, v6
    v_xor_b32 v4, 3, v7
    v_lshl_add_u32 v253, v4, 5, v6
    s_lshl_b32 s72, s30, 3
    s_lshl_b32 s3, s38, 1
    s_add_u32 s72, s72, s3
    s_lshl_b32 s72, s72, 15
    s_add_u32 s72, s72, 12582912
    v_add_u32 v4, 32768, v5
    s_mul_i32 s3, s38, 4608
    s_add_u32 s3, s3, 142592
    v_mul_u32_u24 v6, 144, v3
    v_lshl_add_u32 v6, v2, 3, v6
    v_add_u32 v240, s3, v6
    v_mov_b32 v160, s32
    v_mov_b32 v161, s32
    v_mov_b32 v162, s32
    v_mov_b32 v163, s32
    v_mov_b32 v164, 141376
    v_mov_b32 v165, 1
    s_waitcnt vmcnt(0)
    s_mov_b64 exec, 1
    ds_add_rtn_u32 v166, v164, v165 offset:96
    s_waitcnt lgkmcnt(0)
    v_readfirstlane_b32 s3, v166
    s_mov_b64 exec, 0xff
    s_cmp_lg_u32 s3, 3
    s_cbranch_scc1 L_nof
    buffer_store_dwordx4 v[160:163], v5, s[12:15], s66 offen sc1
L_nof:
    s_mov_b64 exec, -1
    s_cmp_lg_u32 s38, 0
    s_cbranch_scc1 L_gw
    s_lshl_b32 s73, s30, 11
    s_add_u32 s73, s73, 1310720
    v_lshlrev_b32 v6, 7, v3
    s_sleep 8
    buffer_load_dword v7, v6, s[12:15], s73 offen sc1
    s_waitcnt vmcnt(0)
L_op:
    v_xor_b32 v7, s32, v7
    v_cmp_ne_u32 vcc, 0, v7
    s_nop 0
    s_cmp_eq_u64 vcc, 0
    s_cbranch_scc1 L_opok
    s_add_u32 s70, s70, 1
    s_cmp_ge_u32 s70, 200000
    s_cbranch_scc1 L_opok
    s_sleep 4
    buffer_load_dword v7, v6, s[12:15], s73 offen sc1
    s_waitcnt vmcnt(0)
    s_branch L_op
L_opok:
    ds_write_b32 v164, v165 offset:100
    s_branch L_gd
L_gw:
    ds_read_b32 v166, v164 offset:100
    s_waitcnt lgkmcnt(0)
    v_readfirstlane_b32 s3, v166
    s_nop 0
    s_cmp_eq_u32 s3, 1
    s_cbranch_scc0 L_gw
L_gd:
    s_add_u32 s3, s88, 0
    s_and_b32 s3, s3, 15
    s_lshl_b32 s3, s3, 11
    s_add_u32 s3, s3, s72
    buffer_load_dwordx4 v[72:75], v5, s[12:15], s3 offen offset:0 sc1
    buffer_load_dwordx4 v[76:79], v4, s[12:15], s3 offen offset:0 sc1
    buffer_load_dwordx4 v[80:83], v5, s[12:15], s3 offen offset:1024 sc1
    buffer_load_dwordx4 v[84:87], v4, s[12:15], s3 offen offset:1024 sc1
    s_add_u32 s3, s88, 1
    s_and_b32 s3, s3, 15
    s_lshl_b32 s3, s3, 11
    s_add_u32 s3, s3, s72
    buffer_load_dwordx4 v[88:91], v5, s[12:15], s3 offen offset:0 sc1
    buffer_load_dwordx4 v[92:95], v4, s[12:15], s3 offen offset:0 sc1
    buffer_load_dwordx4 v[96:99], v5, s[12:15], s3 offen offset:1024 sc1
    buffer_load_dwordx4 v[100:103], v4, s[12:15], s3 offen offset:1024 sc1
    s_add_u32 s3, s88, 2
    s_and_b32 s3, s3, 15
    s_lshl_b32 s3, s3, 11
    s_add_u32 s3, s3, s72
    buffer_load_dwordx4 v[104:107], v5, s[12:15], s3 offen offset:0 sc1
    buffer_load_dwordx4 v[108:111], v4, s[12:15], s3 offen offset:0 sc1
    buffer_load_dwordx4 v[112:115], v5, s[12:15], s3 offen offset:1024 sc1
    buffer_load_dwordx4 v[116:119], v4, s[12:15], s3 offen offset:1024 sc1
    v_mov_b32 v6, 141376
L_wl:
    ds_read_b64 v[40:41], v6 offset:8
    s_waitcnt lgkmcnt(0)
    v_and_b32 v40, v40, v41
    s_nop 0
    v_readfirstlane_b32 s65, v40
    s_nop 0
    s_cmp_eq_u32 s65, 1
    s_cbranch_scc0 L_wl
    ds_read_b64_tr_b16 v[40:41], v250 offset:0
    ds_read_b64_tr_b16 v[42:43], v250 offset:2048
    ds_read_b64_tr_b16 v[44:45], v251 offset:0
    ds_read_b64_tr_b16 v[46:47], v251 offset:2048
    ds_read_b64_tr_b16 v[48:49], v252 offset:0
    ds_read_b64_tr_b16 v[50:51], v252 offset:2048
    ds_read_b64_tr_b16 v[52:53], v253 offset:0
    ds_read_b64_tr_b16 v[54:55], v253 offset:2048
    s_add_u32 s3, s88, 3
    s_and_b32 s3, s3, 15
    s_lshl_b32 s3, s3, 11
    s_add_u32 s3, s3, s72
    buffer_load_dwordx4 v[120:123], v5, s[12:15], s3 offen offset:0 sc1
    buffer_load_dwordx4 v[124:127], v4, s[12:15], s3 offen offset:0 sc1
    s_waitcnt vmcnt(12)
    s_waitcnt lgkmcnt(0)
    v_mfma_f32_16x16x32_bf16 v[8:11], v[40:43], v[72:75], 0
    ds_read_b64_tr_b16 v[56:57], v250 offset:4096
    v_mfma_f32_16x16x32_bf16 v[12:15], v[44:47], v[72:75], 0
    ds_read_b64_tr_b16 v[58:59], v250 offset:6144
    v_mfma_f32_16x16x32_bf16 v[16:19], v[48:51], v[72:75], 0
    ds_read_b64_tr_b16 v[60:61], v251 offset:4096
    v_mfma_f32_16x16x32_bf16 v[20:23], v[52:55], v[72:75], 0
    ds_read_b64_tr_b16 v[62:63], v251 offset:6144
    v_mfma_f32_16x16x32_bf16 v[24:27], v[40:43], v[76:79], 0
    ds_read_b64_tr_b16 v[64:65], v252 offset:4096
    v_mfma_f32_16x16x32_bf16 v[28:31], v[44:47], v[76:79], 0
    ds_read_b64_tr_b16 v[66:67], v252 offset:6144
    v_mfma_f32_16x16x32_bf16 v[32:35], v[48:51], v[76:79], 0
    ds_read_b64_tr_b16 v[68:69], v253 offset:4096
    v_mfma_f32_16x16x32_bf16 v[36:39], v[52:55], v[76:79], 0
    ds_read_b64_tr_b16 v[70:71], v253 offset:6144
    buffer_load_dwordx4 v[72:75], v5, s[12:15], s3 offen offset:1024 sc1
    buffer_load_dwordx4 v[76:79], v4, s[12:15], s3 offen offset:1024 sc1
    s_waitcnt vmcnt(12)
    s_waitcnt lgkmcnt(0)
    v_mfma_f32_16x16x32_bf16 v[8:11], v[56:59], v[80:83], v[8:11]
    ds_read_b64_tr_b16 v[40:41], v250 offset:8192
    v_mfma_f32_16x16x32_bf16 v[12:15], v[60:63], v[80:83], v[12:15]
    ds_read_b64_tr_b16 v[42:43], v250 offset:10240
    v_mfma_f32_16x16x32_bf16 v[16:19], v[64:67], v[80:83], v[16:19]
    ds_read_b64_tr_b16 v[44:45], v251 offset:8192
    v_mfma_f32_16x16x32_bf16 v[20:23], v[68:71], v[80:83], v[20:23]
    ds_read_b64_tr_b16 v[46:47], v251 offset:10240
    v_mfma_f32_16x16x32_bf16 v[24:27], v[56:59], v[84:87], v[24:27]
    ds_read_b64_tr_b16 v[48:49], v252 offset:8192
    v_mfma_f32_16x16x32_bf16 v[28:31], v[60:63], v[84:87], v[28:31]
    ds_read_b64_tr_b16 v[50:51], v252 offset:10240
    v_mfma_f32_16x16x32_bf16 v[32:35], v[64:67], v[84:87], v[32:35]
    ds_read_b64_tr_b16 v[52:53], v253 offset:8192
    v_mfma_f32_16x16x32_bf16 v[36:39], v[68:71], v[84:87], v[36:39]
    ds_read_b64_tr_b16 v[54:55], v253 offset:10240
    s_add_u32 s3, s88, 4
    s_and_b32 s3, s3, 15
    s_lshl_b32 s3, s3, 11
    s_add_u32 s3, s3, s72
    buffer_load_dwordx4 v[80:83], v5, s[12:15], s3 offen offset:0 sc1
    buffer_load_dwordx4 v[84:87], v4, s[12:15], s3 offen offset:0 sc1
    s_waitcnt vmcnt(12)
    s_waitcnt lgkmcnt(0)
    v_mfma_f32_16x16x32_bf16 v[8:11], v[40:43], v[88:91], v[8:11]
    ds_read_b64_tr_b16 v[56:57], v250 offset:12288
    v_mfma_f32_16x16x32_bf16 v[12:15], v[44:47], v[88:91], v[12:15]
    ds_read_b64_tr_b16 v[58:59], v250 offset:14336
    v_mfma_f32_16x16x32_bf16 v[16:19], v[48:51], v[88:91], v[16:19]
    ds_read_b64_tr_b16 v[60:61], v251 offset:12288
    v_mfma_f32_16x16x32_bf16 v[20:23], v[52:55], v[88:91], v[20:23]
    ds_read_b64_tr_b16 v[62:63], v251 offset:14336
    v_mfma_f32_16x16x32_bf16 v[24:27], v[40:43], v[92:95], v[24:27]
    ds_read_b64_tr_b16 v[64:65], v252 offset:12288
    v_mfma_f32_16x16x32_bf16 v[28:31], v[44:47], v[92:95], v[28:31]
    ds_read_b64_tr_b16 v[66:67], v252 offset:14336
    v_mfma_f32_16x16x32_bf16 v[32:35], v[48:51], v[92:95], v[32:35]
    ds_read_b64_tr_b16 v[68:69], v253 offset:12288
    v_mfma_f32_16x16x32_bf16 v[36:39], v[52:55], v[92:95], v[36:39]
    ds_read_b64_tr_b16 v[70:71], v253 offset:14336
    buffer_load_dwordx4 v[88:91], v5, s[12:15], s3 offen offset:1024 sc1
    buffer_load_dwordx4 v[92:95], v4, s[12:15], s3 offen offset:1024 sc1
    s_waitcnt vmcnt(12)
    s_waitcnt lgkmcnt(0)
    v_mfma_f32_16x16x32_bf16 v[8:11], v[56:59], v[96:99], v[8:11]
    ds_read_b64_tr_b16 v[40:41], v250 offset:16384
    v_mfma_f32_16x16x32_bf16 v[12:15], v[60:63], v[96:99], v[12:15]
    ds_read_b64_tr_b16 v[42:43], v250 offset:18432
    v_mfma_f32_16x16x32_bf16 v[16:19], v[64:67], v[96:99], v[16:19]
    ds_read_b64_tr_b16 v[44:45], v251 offset:16384
    v_mfma_f32_16x16x32_bf16 v[20:23], v[68:71], v[96:99], v[20:23]
    ds_read_b64_tr_b16 v[46:47], v251 offset:18432
    v_mfma_f32_16x16x32_bf16 v[24:27], v[56:59], v[100:103], v[24:27]
    ds_read_b64_tr_b16 v[48:49], v252 offset:16384
    v_mfma_f32_16x16x32_bf16 v[28:31], v[60:63], v[100:103], v[28:31]
    ds_read_b64_tr_b16 v[50:51], v252 offset:18432
    v_mfma_f32_16x16x32_bf16 v[32:35], v[64:67], v[100:103], v[32:35]
    ds_read_b64_tr_b16 v[52:53], v253 offset:16384
    v_mfma_f32_16x16x32_bf16 v[36:39], v[68:71], v[100:103], v[36:39]
    ds_read_b64_tr_b16 v[54:55], v253 offset:18432
    s_add_u32 s3, s88, 5
    s_and_b32 s3, s3, 15
    s_lshl_b32 s3, s3, 11
    s_add_u32 s3, s3, s72
    buffer_load_dwordx4 v[96:99], v5, s[12:15], s3 offen offset:0 sc1
    buffer_load_dwordx4 v[100:103], v4, s[12:15], s3 offen offset:0 sc1
    s_waitcnt vmcnt(12)
    s_waitcnt lgkmcnt(0)
    v_mfma_f32_16x16x32_bf16 v[8:11], v[40:43], v[104:107], v[8:11]
    ds_read_b64_tr_b16 v[56:57], v250 offset:20480
    v_mfma_f32_16x16x32_bf16 v[12:15], v[44:47], v[104:107], v[12:15]
    ds_read_b64_tr_b16 v[58:59], v250 offset:22528
    v_mfma_f32_16x16x32_bf16 v[16:19], v[48:51], v[104:107], v[16:19]
    ds_read_b64_tr_b16 v[60:61], v251 offset:20480
    v_mfma_f32_16x16x32_bf16 v[20:23], v[52:55], v[104:107], v[20:23]
    ds_read_b64_tr_b16 v[62:63], v251 offset:22528
    v_mfma_f32_16x16x32_bf16 v[24:27], v[40:43], v[108:111], v[24:27]
    ds_read_b64_tr_b16 v[64:65], v252 offset:20480
    v_mfma_f32_16x16x32_bf16 v[28:31], v[44:47], v[108:111], v[28:31]
    ds_read_b64_tr_b16 v[66:67], v252 offset:22528
    v_mfma_f32_16x16x32_bf16 v[32:35], v[48:51], v[108:111], v[32:35]
    ds_read_b64_tr_b16 v[68:69], v253 offset:20480
    v_mfma_f32_16x16x32_bf16 v[36:39], v[52:55], v[108:111], v[36:39]
    ds_read_b64_tr_b16 v[70:71], v253 offset:22528
    buffer_load_dwordx4 v[104:107], v5, s[12:15], s3 offen offset:1024 sc1
    buffer_load_dwordx4 v[108:111], v4, s[12:15], s3 offen offset:1024 sc1
    s_waitcnt vmcnt(12)
    s_waitcnt lgkmcnt(0)
    v_mfma_f32_16x16x32_bf16 v[8:11], v[56:59], v[112:115], v[8:11]
    ds_read_b64_tr_b16 v[40:41], v250 offset:24576
    v_mfma_f32_16x16x32_bf16 v[12:15], v[60:63], v[112:115], v[12:15]
    ds_read_b64_tr_b16 v[42:43], v250 offset:26624
    v_mfma_f32_16x16x32_bf16 v[16:19], v[64:67], v[112:115], v[16:19]
    ds_read_b64_tr_b16 v[44:45], v251 offset:24576
    v_mfma_f32_16x16x32_bf16 v[20:23], v[68:71], v[112:115], v[20:23]
    ds_read_b64_tr_b16 v[46:47], v251 offset:26624
    v_mfma_f32_16x16x32_bf16 v[24:27], v[56:59], v[116:119], v[24:27]
    ds_read_b64_tr_b16 v[48:49], v252 offset:24576
    v_mfma_f32_16x16x32_bf16 v[28:31], v[60:63], v[116:119], v[28:31]
    ds_read_b64_tr_b16 v[50:51], v252 offset:26624
    v_mfma_f32_16x16x32_bf16 v[32:35], v[64:67], v[116:119], v[32:35]
    ds_read_b64_tr_b16 v[52:53], v253 offset:24576
    v_mfma_f32_16x16x32_bf16 v[36:39], v[68:71], v[116:119], v[36:39]
    ds_read_b64_tr_b16 v[54:55], v253 offset:26624
    s_add_u32 s3, s88, 6
    s_and_b32 s3, s3, 15
    s_lshl_b32 s3, s3, 11
    s_add_u32 s3, s3, s72
    buffer_load_dwordx4 v[112:115], v5, s[12:15], s3 offen offset:0 sc1
    buffer_load_dwordx4 v[116:119], v4, s[12:15], s3 offen offset:0 sc1
    s_waitcnt vmcnt(12)
    s_waitcnt lgkmcnt(0)
    v_mfma_f32_16x16x32_bf16 v[8:11], v[40:43], v[120:123], v[8:11]
    ds_read_b64_tr_b16 v[56:57], v250 offset:28672
    v_mfma_f32_16x16x32_bf16 v[12:15], v[44:47], v[120:123], v[12:15]
    ds_read_b64_tr_b16 v[58:59], v250 offset:30720
    v_mfma_f32_16x16x32_bf16 v[16:19], v[48:51], v[120:123], v[16:19]
    ds_read_b64_tr_b16 v[60:61], v251 offset:28672
    v_mfma_f32_16x16x32_bf16 v[20:23], v[52:55], v[120:123], v[20:23]
    ds_read_b64_tr_b16 v[62:63], v251 offset:30720
    v_mfma_f32_16x16x32_bf16 v[24:27], v[40:43], v[124:127], v[24:27]
    ds_read_b64_tr_b16 v[64:65], v252 offset:28672
    v_mfma_f32_16x16x32_bf16 v[28:31], v[44:47], v[124:127], v[28:31]
    ds_read_b64_tr_b16 v[66:67], v252 offset:30720
    v_mfma_f32_16x16x32_bf16 v[32:35], v[48:51], v[124:127], v[32:35]
    ds_read_b64_tr_b16 v[68:69], v253 offset:28672
    v_mfma_f32_16x16x32_bf16 v[36:39], v[52:55], v[124:127], v[36:39]
    ds_read_b64_tr_b16 v[70:71], v253 offset:30720
    buffer_load_dwordx4 v[120:123], v5, s[12:15], s3 offen offset:1024 sc1
    buffer_load_dwordx4 v[124:127], v4, s[12:15], s3 offen offset:1024 sc1
    s_waitcnt vmcnt(12)
    s_waitcnt lgkmcnt(0)
    v_mfma_f32_16x16x32_bf16 v[8:11], v[56:59], v[72:75], v[8:11]
    ds_read_b64_tr_b16 v[40:41], v250 offset:32768
    v_mfma_f32_16x16x32_bf16 v[12:15], v[60:63], v[72:75], v[12:15]
    ds_read_b64_tr_b16 v[42:43], v250 offset:34816
    v_mfma_f32_16x16x32_bf16 v[16:19], v[64:67], v[72:75], v[16:19]
    ds_read_b64_tr_b16 v[44:45], v251 offset:32768
    v_mfma_f32_16x16x32_bf16 v[20:23], v[68:71], v[72:75], v[20:23]
    ds_read_b64_tr_b16 v[46:47], v251 offset:34816
    v_mfma_f32_16x16x32_bf16 v[24:27], v[56:59], v[76:79], v[24:27]
    ds_read_b64_tr_b16 v[48:49], v252 offset:32768
    v_mfma_f32_16x16x32_bf16 v[28:31], v[60:63], v[76:79], v[28:31]
    ds_read_b64_tr_b16 v[50:51], v252 offset:34816
    v_mfma_f32_16x16x32_bf16 v[32:35], v[64:67], v[76:79], v[32:35]
    ds_read_b64_tr_b16 v[52:53], v253 offset:32768
    v_mfma_f32_16x16x32_bf16 v[36:39], v[68:71], v[76:79], v[36:39]
    ds_read_b64_tr_b16 v[54:55], v253 offset:34816
    s_add_u32 s3, s88, 7
    s_and_b32 s3, s3, 15
    s_lshl_b32 s3, s3, 11
    s_add_u32 s3, s3, s72
    buffer_load_dwordx4 v[72:75], v5, s[12:15], s3 offen offset:0 sc1
    buffer_load_dwordx4 v[76:79], v4, s[12:15], s3 offen offset:0 sc1
    s_waitcnt vmcnt(12)
    s_waitcnt lgkmcnt(0)
    v_mfma_f32_16x16x32_bf16 v[8:11], v[40:43], v[80:83], v[8:11]
    ds_read_b64_tr_b16 v[56:57], v250 offset:36864
    v_mfma_f32_16x16x32_bf16 v[12:15], v[44:47], v[80:83], v[12:15]
    ds_read_b64_tr_b16 v[58:59], v250 offset:38912
    v_mfma_f32_16x16x32_bf16 v[16:19], v[48:51], v[80:83], v[16:19]
    ds_read_b64_tr_b16 v[60:61], v251 offset:36864
    v_mfma_f32_16x16x32_bf16 v[20:23], v[52:55], v[80:83], v[20:23]
    ds_read_b64_tr_b16 v[62:63], v251 offset:38912
    v_mfma_f32_16x16x32_bf16 v[24:27], v[40:43], v[84:87], v[24:27]
    ds_read_b64_tr_b16 v[64:65], v252 offset:36864
    v_mfma_f32_16x16x32_bf16 v[28:31], v[44:47], v[84:87], v[28:31]
    ds_read_b64_tr_b16 v[66:67], v252 offset:38912
    v_mfma_f32_16x16x32_bf16 v[32:35], v[48:51], v[84:87], v[32:35]
    ds_read_b64_tr_b16 v[68:69], v253 offset:36864
    v_mfma_f32_16x16x32_bf16 v[36:39], v[52:55], v[84:87], v[36:39]
    ds_read_b64_tr_b16 v[70:71], v253 offset:38912
    buffer_load_dwordx4 v[80:83], v5, s[12:15], s3 offen offset:1024 sc1
    buffer_load_dwordx4 v[84:87], v4, s[12:15], s3 offen offset:1024 sc1
    s_waitcnt vmcnt(12)
    s_waitcnt lgkmcnt(0)
    v_mfma_f32_16x16x32_bf16 v[8:11], v[56:59], v[88:91], v[8:11]
    ds_read_b64_tr_b16 v[40:41], v250 offset:40960
    v_mfma_f32_16x16x32_bf16 v[12:15], v[60:63], v[88:91], v[12:15]
    ds_read_b64_tr_b16 v[42:43], v250 offset:43008
    v_mfma_f32_16x16x32_bf16 v[16:19], v[64:67], v[88:91], v[16:19]
    ds_read_b64_tr_b16 v[44:45], v251 offset:40960
    v_mfma_f32_16x16x32_bf16 v[20:23], v[68:71], v[88:91], v[20:23]
    ds_read_b64_tr_b16 v[46:47], v251 offset:43008
    v_mfma_f32_16x16x32_bf16 v[24:27], v[56:59], v[92:95], v[24:27]
    ds_read_b64_tr_b16 v[48:49], v252 offset:40960
    v_mfma_f32_16x16x32_bf16 v[28:31], v[60:63], v[92:95], v[28:31]
    ds_read_b64_tr_b16 v[50:51], v252 offset:43008
    v_mfma_f32_16x16x32_bf16 v[32:35], v[64:67], v[92:95], v[32:35]
    ds_read_b64_tr_b16 v[52:53], v253 offset:40960
    v_mfma_f32_16x16x32_bf16 v[36:39], v[68:71], v[92:95], v[36:39]
    ds_read_b64_tr_b16 v[54:55], v253 offset:43008
    s_add_u32 s3, s88, 8
    s_and_b32 s3, s3, 15
    s_lshl_b32 s3, s3, 11
    s_add_u32 s3, s3, s72
    buffer_load_dwordx4 v[88:91], v5, s[12:15], s3 offen offset:0 sc1
    buffer_load_dwordx4 v[92:95], v4, s[12:15], s3 offen offset:0 sc1
    s_waitcnt vmcnt(12)
    s_waitcnt lgkmcnt(0)
    v_mfma_f32_16x16x32_bf16 v[8:11], v[40:43], v[96:99], v[8:11]
    ds_read_b64_tr_b16 v[56:57], v250 offset:45056
    v_mfma_f32_16x16x32_bf16 v[12:15], v[44:47], v[96:99], v[12:15]
    ds_read_b64_tr_b16 v[58:59], v250 offset:47104
    v_mfma_f32_16x16x32_bf16 v[16:19], v[48:51], v[96:99], v[16:19]
    ds_read_b64_tr_b16 v[60:61], v251 offset:45056
    v_mfma_f32_16x16x32_bf16 v[20:23], v[52:55], v[96:99], v[20:23]
    ds_read_b64_tr_b16 v[62:63], v251 offset:47104
    v_mfma_f32_16x16x32_bf16 v[24:27], v[40:43], v[100:103], v[24:27]
    ds_read_b64_tr_b16 v[64:65], v252 offset:45056
    v_mfma_f32_16x16x32_bf16 v[28:31], v[44:47], v[100:103], v[28:31]
    ds_read_b64_tr_b16 v[66:67], v252 offset:47104
    v_mfma_f32_16x16x32_bf16 v[32:35], v[48:51], v[100:103], v[32:35]
    ds_read_b64_tr_b16 v[68:69], v253 offset:45056
    v_mfma_f32_16x16x32_bf16 v[36:39], v[52:55], v[100:103], v[36:39]
    ds_read_b64_tr_b16 v[70:71], v253 offset:47104
    buffer_load_dwordx4 v[96:99], v5, s[12:15], s3 offen offset:1024 sc1
    buffer_load_dwordx4 v[100:103], v4, s[12:15], s3 offen offset:1024 sc1
    s_waitcnt vmcnt(12)
    s_waitcnt lgkmcnt(0)
    v_mfma_f32_16x16x32_bf16 v[8:11], v[56:59], v[104:107], v[8:11]
    ds_read_b64_tr_b16 v[40:41], v250 offset:49152
    v_mfma_f32_16x16x32_bf16 v[12:15], v[60:63], v[104:107], v[12:15]
    ds_read_b64_tr_b16 v[42:43], v250 offset:51200
    v_mfma_f32_16x16x32_bf16 v[16:19], v[64:67], v[104:107], v[16:19]
    ds_read_b64_tr_b16 v[44:45], v251 offset:49152
    v_mfma_f32_16x16x32_bf16 v[20:23], v[68:71], v[104:107], v[20:23]
    ds_read_b64_tr_b16 v[46:47], v251 offset:51200
    v_mfma_f32_16x16x32_bf16 v[24:27], v[56:59], v[108:111], v[24:27]
    ds_read_b64_tr_b16 v[48:49], v252 offset:49152
    v_mfma_f32_16x16x32_bf16 v[28:31], v[60:63], v[108:111], v[28:31]
    ds_read_b64_tr_b16 v[50:51], v252 offset:51200
    v_mfma_f32_16x16x32_bf16 v[32:35], v[64:67], v[108:111], v[32:35]
    ds_read_b64_tr_b16 v[52:53], v253 offset:49152
    v_mfma_f32_16x16x32_bf16 v[36:39], v[68:71], v[108:111], v[36:39]
    ds_read_b64_tr_b16 v[54:55], v253 offset:51200
    s_add_u32 s3, s88, 9
    s_and_b32 s3, s3, 15
    s_lshl_b32 s3, s3, 11
    s_add_u32 s3, s3, s72
    buffer_load_dwordx4 v[104:107], v5, s[12:15], s3 offen offset:0 sc1
    buffer_load_dwordx4 v[108:111], v4, s[12:15], s3 offen offset:0 sc1
    s_waitcnt vmcnt(12)
    s_waitcnt lgkmcnt(0)
    v_mfma_f32_16x16x32_bf16 v[8:11], v[40:43], v[112:115], v[8:11]
    ds_read_b64_tr_b16 v[56:57], v250 offset:53248
    v_mfma_f32_16x16x32_bf16 v[12:15], v[44:47], v[112:115], v[12:15]
    ds_read_b64_tr_b16 v[58:59], v250 offset:55296
    v_mfma_f32_16x16x32_bf16 v[16:19], v[48:51], v[112:115], v[16:19]
    ds_read_b64_tr_b16 v[60:61], v251 offset:53248
    v_mfma_f32_16x16x32_bf16 v[20:23], v[52:55], v[112:115], v[20:23]
    ds_read_b64_tr_b16 v[62:63], v251 offset:55296
    v_mfma_f32_16x16x32_bf16 v[24:27], v[40:43], v[116:119], v[24:27]
    ds_read_b64_tr_b16 v[64:65], v252 offset:53248
    v_mfma_f32_16x16x32_bf16 v[28:31], v[44:47], v[116:119], v[28:31]
    ds_read_b64_tr_b16 v[66:67], v252 offset:55296
    v_mfma_f32_16x16x32_bf16 v[32:35], v[48:51], v[116:119], v[32:35]
    ds_read_b64_tr_b16 v[68:69], v253 offset:53248
    v_mfma_f32_16x16x32_bf16 v[36:39], v[52:55], v[116:119], v[36:39]
    ds_read_b64_tr_b16 v[70:71], v253 offset:55296
    buffer_load_dwordx4 v[112:115], v5, s[12:15], s3 offen offset:1024 sc1
    buffer_load_dwordx4 v[116:119], v4, s[12:15], s3 offen offset:1024 sc1
    s_waitcnt vmcnt(12)
    s_waitcnt lgkmcnt(0)
    v_mfma_f32_16x16x32_bf16 v[8:11], v[56:59], v[120:123], v[8:11]
    ds_read_b64_tr_b16 v[40:41], v250 offset:57344
    v_mfma_f32_16x16x32_bf16 v[12:15], v[60:63], v[120:123], v[12:15]
    ds_read_b64_tr_b16 v[42:43], v250 offset:59392
    v_mfma_f32_16x16x32_bf16 v[16:19], v[64:67], v[120:123], v[16:19]
    ds_read_b64_tr_b16 v[44:45], v251 offset:57344
    v_mfma_f32_16x16x32_bf16 v[20:23], v[68:71], v[120:123], v[20:23]
    ds_read_b64_tr_b16 v[46:47], v251 offset:59392
    v_mfma_f32_16x16x32_bf16 v[24:27], v[56:59], v[124:127], v[24:27]
    ds_read_b64_tr_b16 v[48:49], v252 offset:57344
    v_mfma_f32_16x16x32_bf16 v[28:31], v[60:63], v[124:127], v[28:31]
    ds_read_b64_tr_b16 v[50:51], v252 offset:59392
    v_mfma_f32_16x16x32_bf16 v[32:35], v[64:67], v[124:127], v[32:35]
    ds_read_b64_tr_b16 v[52:53], v253 offset:57344
    v_mfma_f32_16x16x32_bf16 v[36:39], v[68:71], v[124:127], v[36:39]
    ds_read_b64_tr_b16 v[54:55], v253 offset:59392
    s_add_u32 s3, s88, 10
    s_and_b32 s3, s3, 15
    s_lshl_b32 s3, s3, 11
    s_add_u32 s3, s3, s72
    buffer_load_dwordx4 v[120:123], v5, s[12:15], s3 offen offset:0 sc1
    buffer_load_dwordx4 v[124:127], v4, s[12:15], s3 offen offset:0 sc1
    s_waitcnt vmcnt(12)
    s_waitcnt lgkmcnt(0)
    v_mfma_f32_16x16x32_bf16 v[8:11], v[40:43], v[72:75], v[8:11]
    ds_read_b64_tr_b16 v[56:57], v250 offset:61440
    v_mfma_f32_16x16x32_bf16 v[12:15], v[44:47], v[72:75], v[12:15]
    ds_read_b64_tr_b16 v[58:59], v250 offset:63488
    v_mfma_f32_16x16x32_bf16 v[16:19], v[48:51], v[72:75], v[16:19]
    ds_read_b64_tr_b16 v[60:61], v251 offset:61440
    v_mfma_f32_16x16x32_bf16 v[20:23], v[52:55], v[72:75], v[20:23]
    ds_read_b64_tr_b16 v[62:63], v251 offset:63488
    v_mfma_f32_16x16x32_bf16 v[24:27], v[40:43], v[76:79], v[24:27]
    ds_read_b64_tr_b16 v[64:65], v252 offset:61440
    v_mfma_f32_16x16x32_bf16 v[28:31], v[44:47], v[76:79], v[28:31]
    ds_read_b64_tr_b16 v[66:67], v252 offset:63488
    v_mfma_f32_16x16x32_bf16 v[32:35], v[48:51], v[76:79], v[32:35]
    ds_read_b64_tr_b16 v[68:69], v253 offset:61440
    v_mfma_f32_16x16x32_bf16 v[36:39], v[52:55], v[76:79], v[36:39]
    ds_read_b64_tr_b16 v[70:71], v253 offset:63488
    buffer_load_dwordx4 v[72:75], v5, s[12:15], s3 offen offset:1024 sc1
    buffer_load_dwordx4 v[76:79], v4, s[12:15], s3 offen offset:1024 sc1
    s_waitcnt vmcnt(12)
    s_waitcnt lgkmcnt(0)
    v_add_u32 v250, 0x10000, v250
    v_add_u32 v251, 0x10000, v251
    v_add_u32 v252, 0x10000, v252
    v_add_u32 v253, 0x10000, v253
    v_mfma_f32_16x16x32_bf16 v[8:11], v[56:59], v[80:83], v[8:11]
    ds_read_b64_tr_b16 v[40:41], v250 offset:0
    v_mfma_f32_16x16x32_bf16 v[12:15], v[60:63], v[80:83], v[12:15]
    ds_read_b64_tr_b16 v[42:43], v250 offset:2048
    v_mfma_f32_16x16x32_bf16 v[16:19], v[64:67], v[80:83], v[16:19]
    ds_read_b64_tr_b16 v[44:45], v251 offset:0
    v_mfma_f32_16x16x32_bf16 v[20:23], v[68:71], v[80:83], v[20:23]
    ds_read_b64_tr_b16 v[46:47], v251 offset:2048
    v_mfma_f32_16x16x32_bf16 v[24:27], v[56:59], v[84:87], v[24:27]
    ds_read_b64_tr_b16 v[48:49], v252 offset:0
    v_mfma_f32_16x16x32_bf16 v[28:31], v[60:63], v[84:87], v[28:31]
    ds_read_b64_tr_b16 v[50:51], v252 offset:2048
    v_mfma_f32_16x16x32_bf16 v[32:35], v[64:67], v[84:87], v[32:35]
    ds_read_b64_tr_b16 v[52:53], v253 offset:0
    v_mfma_f32_16x16x32_bf16 v[36:39], v[68:71], v[84:87], v[36:39]
    ds_read_b64_tr_b16 v[54:55], v253 offset:2048
    s_add_u32 s3, s88, 11
    s_and_b32 s3, s3, 15
    s_lshl_b32 s3, s3, 11
    s_add_u32 s3, s3, s72
    buffer_load_dwordx4 v[80:83], v5, s[12:15], s3 offen offset:0 sc1
    buffer_load_dwordx4 v[84:87], v4, s[12:15], s3 offen offset:0 sc1
    s_waitcnt vmcnt(12)
    s_waitcnt lgkmcnt(0)
    v_mfma_f32_16x16x32_bf16 v[8:11], v[40:43], v[88:91], v[8:11]
    ds_read_b64_tr_b16 v[56:57], v250 offset:4096
    v_mfma_f32_16x16x32_bf16 v[12:15], v[44:47], v[88:91], v[12:15]
    ds_read_b64_tr_b16 v[58:59], v250 offset:6144
    v_mfma_f32_16x16x32_bf16 v[16:19], v[48:51], v[88:91], v[16:19]
    ds_read_b64_tr_b16 v[60:61], v251 offset:4096
    v_mfma_f32_16x16x32_bf16 v[20:23], v[52:55], v[88:91], v[20:23]
    ds_read_b64_tr_b16 v[62:63], v251 offset:6144
    v_mfma_f32_16x16x32_bf16 v[24:27], v[40:43], v[92:95], v[24:27]
    ds_read_b64_tr_b16 v[64:65], v252 offset:4096
    v_mfma_f32_16x16x32_bf16 v[28:31], v[44:47], v[92:95], v[28:31]
    ds_read_b64_tr_b16 v[66:67], v252 offset:6144
    v_mfma_f32_16x16x32_bf16 v[32:35], v[48:51], v[92:95], v[32:35]
    ds_read_b64_tr_b16 v[68:69], v253 offset:4096
    v_mfma_f32_16x16x32_bf16 v[36:39], v[52:55], v[92:95], v[36:39]
    ds_read_b64_tr_b16 v[70:71], v253 offset:6144
    buffer_load_dwordx4 v[88:91], v5, s[12:15], s3 offen offset:1024 sc1
    buffer_load_dwordx4 v[92:95], v4, s[12:15], s3 offen offset:1024 sc1
    s_waitcnt vmcnt(12)
    s_waitcnt lgkmcnt(0)
    v_mfma_f32_16x16x32_bf16 v[8:11], v[56:59], v[96:99], v[8:11]
    ds_read_b64_tr_b16 v[40:41], v250 offset:8192
    v_mfma_f32_16x16x32_bf16 v[12:15], v[60:63], v[96:99], v[12:15]
    ds_read_b64_tr_b16 v[42:43], v250 offset:10240
    v_mfma_f32_16x16x32_bf16 v[16:19], v[64:67], v[96:99], v[16:19]
    ds_read_b64_tr_b16 v[44:45], v251 offset:8192
    v_mfma_f32_16x16x32_bf16 v[20:23], v[68:71], v[96:99], v[20:23]
    ds_read_b64_tr_b16 v[46:47], v251 offset:10240
    v_mfma_f32_16x16x32_bf16 v[24:27], v[56:59], v[100:103], v[24:27]
    ds_read_b64_tr_b16 v[48:49], v252 offset:8192
    v_mfma_f32_16x16x32_bf16 v[28:31], v[60:63], v[100:103], v[28:31]
    ds_read_b64_tr_b16 v[50:51], v252 offset:10240
    v_mfma_f32_16x16x32_bf16 v[32:35], v[64:67], v[100:103], v[32:35]
    ds_read_b64_tr_b16 v[52:53], v253 offset:8192
    v_mfma_f32_16x16x32_bf16 v[36:39], v[68:71], v[100:103], v[36:39]
    ds_read_b64_tr_b16 v[54:55], v253 offset:10240
    s_add_u32 s3, s88, 12
    s_and_b32 s3, s3, 15
    s_lshl_b32 s3, s3, 11
    s_add_u32 s3, s3, s72
    buffer_load_dwordx4 v[96:99], v5, s[12:15], s3 offen offset:0 sc1
    buffer_load_dwordx4 v[100:103], v4, s[12:15], s3 offen offset:0 sc1
    s_waitcnt vmcnt(12)
    s_waitcnt lgkmcnt(0)
    v_mfma_f32_16x16x32_bf16 v[8:11], v[40:43], v[104:107], v[8:11]
    ds_read_b64_tr_b16 v[56:57], v250 offset:12288
    v_mfma_f32_16x16x32_bf16 v[12:15], v[44:47], v[104:107], v[12:15]
    ds_read_b64_tr_b16 v[58:59], v250 offset:14336
    v_mfma_f32_16x16x32_bf16 v[16:19], v[48:51], v[104:107], v[16:19]
    ds_read_b64_tr_b16 v[60:61], v251 offset:12288
    v_mfma_f32_16x16x32_bf16 v[20:23], v[52:55], v[104:107], v[20:23]
    ds_read_b64_tr_b16 v[62:63], v251 offset:14336
    v_mfma_f32_16x16x32_bf16 v[24:27], v[40:43], v[108:111], v[24:27]
    ds_read_b64_tr_b16 v[64:65], v252 offset:12288
    v_mfma_f32_16x16x32_bf16 v[28:31], v[44:47], v[108:111], v[28:31]
    ds_read_b64_tr_b16 v[66:67], v252 offset:14336
    v_mfma_f32_16x16x32_bf16 v[32:35], v[48:51], v[108:111], v[32:35]
    ds_read_b64_tr_b16 v[68:69], v253 offset:12288
    v_mfma_f32_16x16x32_bf16 v[36:39], v[52:55], v[108:111], v[36:39]
    ds_read_b64_tr_b16 v[70:71], v253 offset:14336
    buffer_load_dwordx4 v[104:107], v5, s[12:15], s3 offen offset:1024 sc1
    buffer_load_dwordx4 v[108:111], v4, s[12:15], s3 offen offset:1024 sc1
    s_waitcnt vmcnt(12)
    s_waitcnt lgkmcnt(0)
    v_mfma_f32_16x16x32_bf16 v[8:11], v[56:59], v[112:115], v[8:11]
    ds_read_b64_tr_b16 v[40:41], v250 offset:16384
    v_mfma_f32_16x16x32_bf16 v[12:15], v[60:63], v[112:115], v[12:15]
    ds_read_b64_tr_b16 v[42:43], v250 offset:18432
    v_mfma_f32_16x16x32_bf16 v[16:19], v[64:67], v[112:115], v[16:19]
    ds_read_b64_tr_b16 v[44:45], v251 offset:16384
    v_mfma_f32_16x16x32_bf16 v[20:23], v[68:71], v[112:115], v[20:23]
    ds_read_b64_tr_b16 v[46:47], v251 offset:18432
    v_mfma_f32_16x16x32_bf16 v[24:27], v[56:59], v[116:119], v[24:27]
    ds_read_b64_tr_b16 v[48:49], v252 offset:16384
    v_mfma_f32_16x16x32_bf16 v[28:31], v[60:63], v[116:119], v[28:31]
    ds_read_b64_tr_b16 v[50:51], v252 offset:18432
    v_mfma_f32_16x16x32_bf16 v[32:35], v[64:67], v[116:119], v[32:35]
    ds_read_b64_tr_b16 v[52:53], v253 offset:16384
    v_mfma_f32_16x16x32_bf16 v[36:39], v[68:71], v[116:119], v[36:39]
    ds_read_b64_tr_b16 v[54:55], v253 offset:18432
    s_add_u32 s3, s88, 13
    s_and_b32 s3, s3, 15
    s_lshl_b32 s3, s3, 11
    s_add_u32 s3, s3, s72
    buffer_load_dwordx4 v[112:115], v5, s[12:15], s3 offen offset:0 sc1
    buffer_load_dwordx4 v[116:119], v4, s[12:15], s3 offen offset:0 sc1
    s_waitcnt vmcnt(12)
    s_waitcnt lgkmcnt(0)
    v_mfma_f32_16x16x32_bf16 v[8:11], v[40:43], v[120:123], v[8:11]
    ds_read_b64_tr_b16 v[56:57], v250 offset:20480
    v_mfma_f32_16x16x32_bf16 v[12:15], v[44:47], v[120:123], v[12:15]
    ds_read_b64_tr_b16 v[58:59], v250 offset:22528
    v_mfma_f32_16x16x32_bf16 v[16:19], v[48:51], v[120:123], v[16:19]
    ds_read_b64_tr_b16 v[60:61], v251 offset:20480
    v_mfma_f32_16x16x32_bf16 v[20:23], v[52:55], v[120:123], v[20:23]
    ds_read_b64_tr_b16 v[62:63], v251 offset:22528
    v_mfma_f32_16x16x32_bf16 v[24:27], v[40:43], v[124:127], v[24:27]
    ds_read_b64_tr_b16 v[64:65], v252 offset:20480
    v_mfma_f32_16x16x32_bf16 v[28:31], v[44:47], v[124:127], v[28:31]
    ds_read_b64_tr_b16 v[66:67], v252 offset:22528
    v_mfma_f32_16x16x32_bf16 v[32:35], v[48:51], v[124:127], v[32:35]
    ds_read_b64_tr_b16 v[68:69], v253 offset:20480
    v_mfma_f32_16x16x32_bf16 v[36:39], v[52:55], v[124:127], v[36:39]
    ds_read_b64_tr_b16 v[70:71], v253 offset:22528
    buffer_load_dwordx4 v[120:123], v5, s[12:15], s3 offen offset:1024 sc1
    buffer_load_dwordx4 v[124:127], v4, s[12:15], s3 offen offset:1024 sc1
    s_waitcnt vmcnt(12)
    s_waitcnt lgkmcnt(0)
    v_mfma_f32_16x16x32_bf16 v[8:11], v[56:59], v[72:75], v[8:11]
    ds_read_b64_tr_b16 v[40:41], v250 offset:24576
    v_mfma_f32_16x16x32_bf16 v[12:15], v[60:63], v[72:75], v[12:15]
    ds_read_b64_tr_b16 v[42:43], v250 offset:26624
    v_mfma_f32_16x16x32_bf16 v[16:19], v[64:67], v[72:75], v[16:19]
    ds_read_b64_tr_b16 v[44:45], v251 offset:24576
    v_mfma_f32_16x16x32_bf16 v[20:23], v[68:71], v[72:75], v[20:23]
    ds_read_b64_tr_b16 v[46:47], v251 offset:26624
    v_mfma_f32_16x16x32_bf16 v[24:27], v[56:59], v[76:79], v[24:27]
    ds_read_b64_tr_b16 v[48:49], v252 offset:24576
    v_mfma_f32_16x16x32_bf16 v[28:31], v[60:63], v[76:79], v[28:31]
    ds_read_b64_tr_b16 v[50:51], v252 offset:26624
    v_mfma_f32_16x16x32_bf16 v[32:35], v[64:67], v[76:79], v[32:35]
    ds_read_b64_tr_b16 v[52:53], v253 offset:24576
    v_mfma_f32_16x16x32_bf16 v[36:39], v[68:71], v[76:79], v[36:39]
    ds_read_b64_tr_b16 v[54:55], v253 offset:26624
    s_add_u32 s3, s88, 14
    s_and_b32 s3, s3, 15
    s_lshl_b32 s3, s3, 11
    s_add_u32 s3, s3, s72
    buffer_load_dwordx4 v[72:75], v5, s[12:15], s3 offen offset:0 sc1
    buffer_load_dwordx4 v[76:79], v4, s[12:15], s3 offen offset:0 sc1
    s_waitcnt vmcnt(12)
    s_waitcnt lgkmcnt(0)
    v_mfma_f32_16x16x32_bf16 v[8:11], v[40:43], v[80:83], v[8:11]
    ds_read_b64_tr_b16 v[56:57], v250 offset:28672
    v_mfma_f32_16x16x32_bf16 v[12:15], v[44:47], v[80:83], v[12:15]
    ds_read_b64_tr_b16 v[58:59], v250 offset:30720
    v_mfma_f32_16x16x32_bf16 v[16:19], v[48:51], v[80:83], v[16:19]
    ds_read_b64_tr_b16 v[60:61], v251 offset:28672
    v_mfma_f32_16x16x32_bf16 v[20:23], v[52:55], v[80:83], v[20:23]
    ds_read_b64_tr_b16 v[62:63], v251 offset:30720
    v_mfma_f32_16x16x32_bf16 v[24:27], v[40:43], v[84:87], v[24:27]
    ds_read_b64_tr_b16 v[64:65], v252 offset:28672
    v_mfma_f32_16x16x32_bf16 v[28:31], v[44:47], v[84:87], v[28:31]
    ds_read_b64_tr_b16 v[66:67], v252 offset:30720
    v_mfma_f32_16x16x32_bf16 v[32:35], v[48:51], v[84:87], v[32:35]
    ds_read_b64_tr_b16 v[68:69], v253 offset:28672
    v_mfma_f32_16x16x32_bf16 v[36:39], v[52:55], v[84:87], v[36:39]
    ds_read_b64_tr_b16 v[70:71], v253 offset:30720
    buffer_load_dwordx4 v[80:83], v5, s[12:15], s3 offen offset:1024 sc1
    buffer_load_dwordx4 v[84:87], v4, s[12:15], s3 offen offset:1024 sc1
    s_waitcnt vmcnt(12)
    s_waitcnt lgkmcnt(0)
    v_mfma_f32_16x16x32_bf16 v[8:11], v[56:59], v[88:91], v[8:11]
    ds_read_b64_tr_b16 v[40:41], v250 offset:32768
    v_mfma_f32_16x16x32_bf16 v[12:15], v[60:63], v[88:91], v[12:15]
    ds_read_b64_tr_b16 v[42:43], v250 offset:34816
    v_mfma_f32_16x16x32_bf16 v[16:19], v[64:67], v[88:91], v[16:19]
    ds_read_b64_tr_b16 v[44:45], v251 offset:32768
    v_mfma_f32_16x16x32_bf16 v[20:23], v[68:71], v[88:91], v[20:23]
    ds_read_b64_tr_b16 v[46:47], v251 offset:34816
    v_mfma_f32_16x16x32_bf16 v[24:27], v[56:59], v[92:95], v[24:27]
    ds_read_b64_tr_b16 v[48:49], v252 offset:32768
    v_mfma_f32_16x16x32_bf16 v[28:31], v[60:63], v[92:95], v[28:31]
    ds_read_b64_tr_b16 v[50:51], v252 offset:34816
    v_mfma_f32_16x16x32_bf16 v[32:35], v[64:67], v[92:95], v[32:35]
    ds_read_b64_tr_b16 v[52:53], v253 offset:32768
    v_mfma_f32_16x16x32_bf16 v[36:39], v[68:71], v[92:95], v[36:39]
    ds_read_b64_tr_b16 v[54:55], v253 offset:34816
    s_add_u32 s3, s88, 15
    s_and_b32 s3, s3, 15
    s_lshl_b32 s3, s3, 11
    s_add_u32 s3, s3, s72
    buffer_load_dwordx4 v[88:91], v5, s[12:15], s3 offen offset:0 sc1
    buffer_load_dwordx4 v[92:95], v4, s[12:15], s3 offen offset:0 sc1
    s_waitcnt vmcnt(12)
    s_waitcnt lgkmcnt(0)
    v_mfma_f32_16x16x32_bf16 v[8:11], v[40:43], v[96:99], v[8:11]
    ds_read_b64_tr_b16 v[56:57], v250 offset:36864
    v_mfma_f32_16x16x32_bf16 v[12:15], v[44:47], v[96:99], v[12:15]
    ds_read_b64_tr_b16 v[58:59], v250 offset:38912
    v_mfma_f32_16x16x32_bf16 v[16:19], v[48:51], v[96:99], v[16:19]
    ds_read_b64_tr_b16 v[60:61], v251 offset:36864
    v_mfma_f32_16x16x32_bf16 v[20:23], v[52:55], v[96:99], v[20:23]
    ds_read_b64_tr_b16 v[62:63], v251 offset:38912
    v_mfma_f32_16x16x32_bf16 v[24:27], v[40:43], v[100:103], v[24:27]
    ds_read_b64_tr_b16 v[64:65], v252 offset:36864
    v_mfma_f32_16x16x32_bf16 v[28:31], v[44:47], v[100:103], v[28:31]
    ds_read_b64_tr_b16 v[66:67], v252 offset:38912
    v_mfma_f32_16x16x32_bf16 v[32:35], v[48:51], v[100:103], v[32:35]
    ds_read_b64_tr_b16 v[68:69], v253 offset:36864
    v_mfma_f32_16x16x32_bf16 v[36:39], v[52:55], v[100:103], v[36:39]
    ds_read_b64_tr_b16 v[70:71], v253 offset:38912
    buffer_load_dwordx4 v[96:99], v5, s[12:15], s3 offen offset:1024 sc1
    buffer_load_dwordx4 v[100:103], v4, s[12:15], s3 offen offset:1024 sc1
    s_waitcnt vmcnt(12)
    s_waitcnt lgkmcnt(0)
    v_mfma_f32_16x16x32_bf16 v[8:11], v[56:59], v[104:107], v[8:11]
    ds_read_b64_tr_b16 v[40:41], v250 offset:40960
    v_mfma_f32_16x16x32_bf16 v[12:15], v[60:63], v[104:107], v[12:15]
    ds_read_b64_tr_b16 v[42:43], v250 offset:43008
    v_mfma_f32_16x16x32_bf16 v[16:19], v[64:67], v[104:107], v[16:19]
    ds_read_b64_tr_b16 v[44:45], v251 offset:40960
    v_mfma_f32_16x16x32_bf16 v[20:23], v[68:71], v[104:107], v[20:23]
    ds_read_b64_tr_b16 v[46:47], v251 offset:43008
    v_mfma_f32_16x16x32_bf16 v[24:27], v[56:59], v[108:111], v[24:27]
    ds_read_b64_tr_b16 v[48:49], v252 offset:40960
    v_mfma_f32_16x16x32_bf16 v[28:31], v[60:63], v[108:111], v[28:31]
    ds_read_b64_tr_b16 v[50:51], v252 offset:43008
    v_mfma_f32_16x16x32_bf16 v[32:35], v[64:67], v[108:111], v[32:35]
    ds_read_b64_tr_b16 v[52:53], v253 offset:40960
    v_mfma_f32_16x16x32_bf16 v[36:39], v[68:71], v[108:111], v[36:39]
    ds_read_b64_tr_b16 v[54:55], v253 offset:43008
    s_waitcnt vmcnt(10)
    s_waitcnt lgkmcnt(0)
    v_mfma_f32_16x16x32_bf16 v[8:11], v[40:43], v[112:115], v[8:11]
    ds_read_b64_tr_b16 v[56:57], v250 offset:45056
    v_mfma_f32_16x16x32_bf16 v[12:15], v[44:47], v[112:115], v[12:15]
    ds_read_b64_tr_b16 v[58:59], v250 offset:47104
    v_mfma_f32_16x16x32_bf16 v[16:19], v[48:51], v[112:115], v[16:19]
    ds_read_b64_tr_b16 v[60:61], v251 offset:45056
    v_mfma_f32_16x16x32_bf16 v[20:23], v[52:55], v[112:115], v[20:23]
    ds_read_b64_tr_b16 v[62:63], v251 offset:47104
    v_mfma_f32_16x16x32_bf16 v[24:27], v[40:43], v[116:119], v[24:27]
    ds_read_b64_tr_b16 v[64:65], v252 offset:45056
    v_mfma_f32_16x16x32_bf16 v[28:31], v[44:47], v[116:119], v[28:31]
    ds_read_b64_tr_b16 v[66:67], v252 offset:47104
    v_mfma_f32_16x16x32_bf16 v[32:35], v[48:51], v[116:119], v[32:35]
    ds_read_b64_tr_b16 v[68:69], v253 offset:45056
    v_mfma_f32_16x16x32_bf16 v[36:39], v[52:55], v[116:119], v[36:39]
    ds_read_b64_tr_b16 v[70:71], v253 offset:47104
    s_waitcnt vmcnt(8)
    s_waitcnt lgkmcnt(0)
    v_mfma_f32_16x16x32_bf16 v[8:11], v[56:59], v[120:123], v[8:11]
    ds_read_b64_tr_b16 v[40:41], v250 offset:49152
    v_mfma_f32_16x16x32_bf16 v[12:15], v[60:63], v[120:123], v[12:15]
    ds_read_b64_tr_b16 v[42:43], v250 offset:51200
    v_mfma_f32_16x16x32_bf16 v[16:19], v[64:67], v[120:123], v[16:19]
    ds_read_b64_tr_b16 v[44:45], v251 offset:49152
    v_mfma_f32_16x16x32_bf16 v[20:23], v[68:71], v[120:123], v[20:23]
    ds_read_b64_tr_b16 v[46:47], v251 offset:51200
    v_mfma_f32_16x16x32_bf16 v[24:27], v[56:59], v[124:127], v[24:27]
    ds_read_b64_tr_b16 v[48:49], v252 offset:49152
    v_mfma_f32_16x16x32_bf16 v[28:31], v[60:63], v[124:127], v[28:31]
    ds_read_b64_tr_b16 v[50:51], v252 offset:51200
    v_mfma_f32_16x16x32_bf16 v[32:35], v[64:67], v[124:127], v[32:35]
    ds_read_b64_tr_b16 v[52:53], v253 offset:49152
    v_mfma_f32_16x16x32_bf16 v[36:39], v[68:71], v[124:127], v[36:39]
    ds_read_b64_tr_b16 v[54:55], v253 offset:51200
    s_waitcnt vmcnt(6)
    s_waitcnt lgkmcnt(0)
    v_mfma_f32_16x16x32_bf16 v[8:11], v[40:43], v[72:75], v[8:11]
    ds_read_b64_tr_b16 v[56:57], v250 offset:53248
    v_mfma_f32_16x16x32_bf16 v[12:15], v[44:47], v[72:75], v[12:15]
    ds_read_b64_tr_b16 v[58:59], v250 offset:55296
    v_mfma_f32_16x16x32_bf16 v[16:19], v[48:51], v[72:75], v[16:19]
    ds_read_b64_tr_b16 v[60:61], v251 offset:53248
    v_mfma_f32_16x16x32_bf16 v[20:23], v[52:55], v[72:75], v[20:23]
    ds_read_b64_tr_b16 v[62:63], v251 offset:55296
    v_mfma_f32_16x16x32_bf16 v[24:27], v[40:43], v[76:79], v[24:27]
    ds_read_b64_tr_b16 v[64:65], v252 offset:53248
    v_mfma_f32_16x16x32_bf16 v[28:31], v[44:47], v[76:79], v[28:31]
    ds_read_b64_tr_b16 v[66:67], v252 offset:55296
    v_mfma_f32_16x16x32_bf16 v[32:35], v[48:51], v[76:79], v[32:35]
    ds_read_b64_tr_b16 v[68:69], v253 offset:53248
    v_mfma_f32_16x16x32_bf16 v[36:39], v[52:55], v[76:79], v[36:39]
    ds_read_b64_tr_b16 v[70:71], v253 offset:55296
    s_waitcnt vmcnt(4)
    s_waitcnt lgkmcnt(0)
    v_mfma_f32_16x16x32_bf16 v[8:11], v[56:59], v[80:83], v[8:11]
    ds_read_b64_tr_b16 v[40:41], v250 offset:57344
    v_mfma_f32_16x16x32_bf16 v[12:15], v[60:63], v[80:83], v[12:15]
    ds_read_b64_tr_b16 v[42:43], v250 offset:59392
    v_mfma_f32_16x16x32_bf16 v[16:19], v[64:67], v[80:83], v[16:19]
    ds_read_b64_tr_b16 v[44:45], v251 offset:57344
    v_mfma_f32_16x16x32_bf16 v[20:23], v[68:71], v[80:83], v[20:23]
    ds_read_b64_tr_b16 v[46:47], v251 offset:59392
    v_mfma_f32_16x16x32_bf16 v[24:27], v[56:59], v[84:87], v[24:27]
    ds_read_b64_tr_b16 v[48:49], v252 offset:57344
    v_mfma_f32_16x16x32_bf16 v[28:31], v[60:63], v[84:87], v[28:31]
    ds_read_b64_tr_b16 v[50:51], v252 offset:59392
    v_mfma_f32_16x16x32_bf16 v[32:35], v[64:67], v[84:87], v[32:35]
    ds_read_b64_tr_b16 v[52:53], v253 offset:57344
    v_mfma_f32_16x16x32_bf16 v[36:39], v[68:71], v[84:87], v[36:39]
    ds_read_b64_tr_b16 v[54:55], v253 offset:59392
    s_waitcnt vmcnt(2)
    s_waitcnt lgkmcnt(0)
    v_mfma_f32_16x16x32_bf16 v[8:11], v[40:43], v[88:91], v[8:11]
    ds_read_b64_tr_b16 v[56:57], v250 offset:61440
    v_mfma_f32_16x16x32_bf16 v[12:15], v[44:47], v[88:91], v[12:15]
    ds_read_b64_tr_b16 v[58:59], v250 offset:63488
    v_mfma_f32_16x16x32_bf16 v[16:19], v[48:51], v[88:91], v[16:19]
    ds_read_b64_tr_b16 v[60:61], v251 offset:61440
    v_mfma_f32_16x16x32_bf16 v[20:23], v[52:55], v[88:91], v[20:23]
    ds_read_b64_tr_b16 v[62:63], v251 offset:63488
    v_mfma_f32_16x16x32_bf16 v[24:27], v[40:43], v[92:95], v[24:27]
    ds_read_b64_tr_b16 v[64:65], v252 offset:61440
    v_mfma_f32_16x16x32_bf16 v[28:31], v[44:47], v[92:95], v[28:31]
    ds_read_b64_tr_b16 v[66:67], v252 offset:63488
    v_mfma_f32_16x16x32_bf16 v[32:35], v[48:51], v[92:95], v[32:35]
    ds_read_b64_tr_b16 v[68:69], v253 offset:61440
    v_mfma_f32_16x16x32_bf16 v[36:39], v[52:55], v[92:95], v[36:39]
    ds_read_b64_tr_b16 v[70:71], v253 offset:63488
    s_waitcnt vmcnt(0)
    s_waitcnt lgkmcnt(0)
    v_mfma_f32_16x16x32_bf16 v[8:11], v[56:59], v[96:99], v[8:11]
    v_mfma_f32_16x16x32_bf16 v[12:15], v[60:63], v[96:99], v[12:15]
    v_mfma_f32_16x16x32_bf16 v[16:19], v[64:67], v[96:99], v[16:19]
    v_mfma_f32_16x16x32_bf16 v[20:23], v[68:71], v[96:99], v[20:23]
    v_mfma_f32_16x16x32_bf16 v[24:27], v[56:59], v[100:103], v[24:27]
    v_mfma_f32_16x16x32_bf16 v[28:31], v[60:63], v[100:103], v[28:31]
    v_mfma_f32_16x16x32_bf16 v[32:35], v[64:67], v[100:103], v[32:35]
    v_mfma_f32_16x16x32_bf16 v[36:39], v[68:71], v[100:103], v[36:39]
    s_nop 0
    v_cvt_pk_bf16_f32 v72, v8, v9
    v_cvt_pk_bf16_f32 v73, v10, v11
    ds_write_b64 v240, v[72:73] offset:0
    v_cvt_pk_bf16_f32 v74, v12, v13
    v_cvt_pk_bf16_f32 v75, v14, v15
    ds_write_b64 v240, v[74:75] offset:32
    v_cvt_pk_bf16_f32 v76, v16, v17
    v_cvt_pk_bf16_f32 v77, v18, v19
    ds_write_b64 v240, v[76:77] offset:64
    v_cvt_pk_bf16_f32 v78, v20, v21
    v_cvt_pk_bf16_f32 v79, v22, v23
    ds_write_b64 v240, v[78:79] offset:96
    v_cvt_pk_bf16_f32 v80, v24, v25
    v_cvt_pk_bf16_f32 v81, v26, v27
    ds_write_b64 v240, v[80:81] offset:2304
    v_cvt_pk_bf16_f32 v82, v28, v29
    v_cvt_pk_bf16_f32 v83, v30, v31
    ds_write_b64 v240, v[82:83] offset:2336
    v_cvt_pk_bf16_f32 v84, v32, v33
    v_cvt_pk_bf16_f32 v85, v34, v35
    ds_write_b64 v240, v[84:85] offset:2368
    v_cvt_pk_bf16_f32 v86, v36, v37
    v_cvt_pk_bf16_f32 v87, v38, v39
    ds_write_b64 v240, v[86:87] offset:2400
    s_waitcnt lgkmcnt(0)
    s_barrier
    s_endpgm
.p2align 8
L_code_end:
.fill 3072, 4, 0xbf800000
.section .rodata,"a"
.p2align 6
.amdhsa_kernel recurrent_scan__linear_kernel_hedgehog__moe_arch_mod__prompt_kernel
  .amdhsa_next_free_vgpr 256
  .amdhsa_next_free_sgpr 102
  .amdhsa_accum_offset 256
  .amdhsa_group_segment_fixed_size 0
  .amdhsa_kernarg_size 96
  .amdhsa_user_sgpr_count 2
  .amdhsa_user_sgpr_kernarg_segment_ptr 1
  .amdhsa_system_sgpr_workgroup_id_x 1
.end_amdhsa_kernel
```

```asm
; @launch grid=(256,1,1) block=(512,1,1) lds=163840
.amdgcn_target "amdgcn-amd-amdhsa--gfx950"
.text
.globl recurrent_scan__linear_kernel_hedgehog__moe_arch_mod__prompt_kernel
.p2align 8
.type recurrent_scan__linear_kernel_hedgehog__moe_arch_mod__prompt_kernel,@function
recurrent_scan__linear_kernel_hedgehog__moe_arch_mod__prompt_kernel:
    s_cmp_ge_u32 s2, 256
    s_cbranch_scc1 L_done
    s_load_dwordx16 s[40:55], s[0:1], 0
    s_load_dwordx8 s[56:63], s[0:1], 64
    v_and_b32 v1, 63, v0
    v_lshrrev_b32 v2, 6, v0
    s_nop 0
    v_readfirstlane_b32 s38, v2
    s_and_b32 s65, s2, 1
    s_bfe_u32 s66, s2, 0x30003
    s_bfe_u32 s67, s2, 0x20001
    s_lshl_b32 s67, s67, 2
    s_lshl_b32 s36, s65, 3
    s_add_u32 s36, s36, s66
    s_lshr_b32 s3, s2, 6
    s_add_u32 s37, s67, s3
    s_lshr_b32 s39, s66, 0
    s_lshl_b32 s39, s39, 1
    s_add_u32 s39, s39, s65
    s_lshl_b32 s39, s39, 0
    s_and_b32 s101, s66, 0
    s_add_u32 s39, s39, s67
    s_and_b32 s39, s39, 15
    s_and_b32 s67, s2, 7
    s_lshl_b32 s67, s67, 1
    s_bfe_u32 s3, s2, 0x10003
    s_add_u32 s37, s67, s3
    s_lshr_b32 s36, s2, 4
    s_and_b32 s101, s36, 0
    s_sub_u32 s39, s36, s101
    s_add_u32 s39, s39, s67
    s_and_b32 s39, s39, 15
    s_cmp_lt_u32 s38, 4
    s_cbranch_scc1 L_g1
    s_sub_u32 s38, s38, 4
    s_lshl_b32 s3, s38, 4
    v_lshrrev_b32 v7, 3, v1
    v_add_u32 v3, s3, v7
    v_mul_u32_u24 v3, 6144, v3
    s_lshl_b32 s3, s37, 7
    v_add_u32 v3, s3, v3
    v_and_b32 v6, 7, v1
    v_bfe_u32 v5, v1, 4, 1
    v_lshlrev_b32 v5, 1, v5
    v_xor_b32 v5, v6, v5
    v_lshl_add_u32 v16, v5, 4, v3
    v_xor_b32 v5, 4, v5
    v_lshl_add_u32 v5, v5, 4, v3
    v_add_u32 v17, 48128, v5
    v_add_u32 v12, 2048, v16
    v_add_u32 v13, 2048, v17
    v_add_u32 v14, 4096, v16
    v_add_u32 v15, 4096, v17
    s_lshl_b32 s3, s36, 7
    s_lshl_b32 s65, s38, 5
    s_add_u32 s3, s3, s65
    v_add_u32 v3, s3, v7
    v_lshlrev_b32 v3, 11, v3
    v_lshrrev_b32 v5, 4, v1
    v_xor_b32 v6, v6, v5
    v_xor_b32 v5, 4, v6
    v_lshl_add_u32 v8, v6, 4, v3
    v_lshl_add_u32 v5, v5, 4, v3
    v_add_u32 v9, 15360, v5
    v_add_u32 v10, 30720, v8
    v_add_u32 v11, 46080, v5
    s_lshl_b32 s72, s38, 12
    s_lshl_b32 s73, s38, 11
    s_lshl_b32 s74, s39, 7
    s_mul_i32 s75, s39, 393216
    s_mov_b32 s76, s75
    s_waitcnt lgkmcnt(0)
    s_mov_b32 s8, s42
    s_mov_b32 s9, s43
    s_mov_b32 s10, 6291456
    s_mov_b32 s11, 0x00020000
    s_mov_b32 s4, s40
    s_mov_b32 s5, s41
    s_mov_b32 s6, 4194304
    s_mov_b32 s7, 0x00020000
    s_cmp_ge_u32 s38, 2
    s_cbranch_scc1 L_xw
    s_add_u32 s3, s75, 196608
    s_add_u32 m0, s73, 65536
    s_nop 0
    buffer_load_dwordx4 v12, s[8:11], s75 offen offset:0  lds
    buffer_load_dwordx4 v13, s[8:11], s75 offen offset:1024  lds
    s_add_u32 m0, s73, 73728
    s_nop 0
    buffer_load_dwordx4 v14, s[8:11], s75 offen offset:0  lds
    buffer_load_dwordx4 v15, s[8:11], s75 offen offset:1024  lds
    s_add_u32 m0, s73, 69632
    s_nop 0
    buffer_load_dwordx4 v12, s[8:11], s3 offen offset:0  lds
    buffer_load_dwordx4 v13, s[8:11], s3 offen offset:1024  lds
    s_add_u32 m0, s73, 77824
    s_nop 0
    buffer_load_dwordx4 v14, s[8:11], s3 offen offset:0  lds
    buffer_load_dwordx4 v15, s[8:11], s3 offen offset:1024  lds
    s_add_u32 s75, s75, 393216
    s_cmp_eq_u32 s75, 6291456
    s_cselect_b32 s75, 0, s75
    s_add_u32 m0, s73, 131072
    s_nop 0
    buffer_load_dwordx4 v16, s[8:11], s76 offen offset:0  lds
    buffer_load_dwordx4 v17, s[8:11], s76 offen offset:1024  lds
    s_add_u32 m0, s73, 135168
    s_add_u32 s3, s76, 196608
    buffer_load_dwordx4 v16, s[8:11], s3 offen offset:0  lds
    buffer_load_dwordx4 v17, s[8:11], s3 offen offset:1024  lds
    s_add_u32 s76, s76, 393216
    s_cmp_eq_u32 s76, 6291456
    s_cselect_b32 s76, 0, s76
    s_add_u32 m0, s72, 0
    s_nop 0
    buffer_load_dwordx4 v8, s[4:7], s74 offen offset:0  lds
    buffer_load_dwordx4 v9, s[4:7], s74 offen offset:1024  lds
    buffer_load_dwordx4 v10, s[4:7], s74 offen offset:2048  lds
    buffer_load_dwordx4 v11, s[4:7], s74 offen offset:3072  lds
    s_add_u32 m0, s72, 8192
    s_add_u32 s3, s74, 131072
    buffer_load_dwordx4 v8, s[4:7], s3 offen offset:0  lds
    buffer_load_dwordx4 v9, s[4:7], s3 offen offset:1024  lds
    buffer_load_dwordx4 v10, s[4:7], s3 offen offset:2048  lds
    buffer_load_dwordx4 v11, s[4:7], s3 offen offset:3072  lds
    s_add_u32 s74, s74, 128
    s_and_b32 s74, s74, 2047
    v_lshlrev_b32 v3, 4, v1
    s_mov_b32 s12, s62
    s_mov_b32 s13, s63
    s_mov_b32 s14, 268435456
    s_mov_b32 s15, 0x00020000
    s_and_b32 s30, s2, 3
    s_lshl_b32 s30, s30, 2
    s_bfe_u32 s3, s2, 0x20003
    s_add_u32 s30, s30, s3
    s_bfe_u32 s31, s2, 0x10002
    s_lshl_b32 s31, s31, 3
    s_lshr_b32 s3, s2, 5
    s_add_u32 s31, s31, s3
    s_mov_b32 s88, 0
    s_mov_b32 s70, 0
    s_mov_b32 s80, s52
    s_mov_b32 s81, s53
    s_mov_b32 s82, 7340032
    s_mov_b32 s83, 0x00020000
    s_mov_b32 s84, s54
    s_mov_b32 s85, s55
    s_mov_b32 s86, 7340032
    s_mov_b32 s87, 0x00020000
    s_cmp_lt_u32 s2, 224
    s_cselect_b32 s82, s82, 0
    s_cselect_b32 s86, s86, 0
    s_and_b32 s3, s2, 15
    s_lshl_b32 s3, s3, 6
    v_and_b32 v5, 0x38, v1
    v_add_u32 v5, s3, v5
    v_mul_u32_u24 v5, 7168, v5
    v_and_b32 v6, 7, v1
    v_lshl_add_u32 v2, v6, 4, v5
    s_lshr_b32 s77, s2, 4
    s_lshl_b32 s77, s77, 2
    s_add_u32 s77, s77, s38
    s_lshl_b32 s77, s77, 7
    v_and_b32 v5, 1, v1
    v_cmp_eq_u32 vcc, 0, v5
    v_mov_b32 v6, 0xffff0000
    v_mov_b32 v7, 0xffff
    v_cndmask_b32 v6, v6, v7, vcc
    v_bfe_u32 v5, v1, 1, 2
    v_cmp_eq_u32 vcc, 0, v5
    s_nop 1
    v_cndmask_b32 v88, 0, v6, vcc
    v_cmp_eq_u32 vcc, 1, v5
    s_nop 1
    v_cndmask_b32 v89, 0, v6, vcc
    v_cmp_eq_u32 vcc, 2, v5
    s_nop 1
    v_cndmask_b32 v90, 0, v6, vcc
    v_cmp_eq_u32 vcc, 3, v5
    s_nop 1
    v_cndmask_b32 v91, 0, v6, vcc
    v_and_b32 v20, 0x3f803f80, v88
    v_and_b32 v21, 0x3f803f80, v89
    v_and_b32 v22, 0x3f803f80, v90
    v_and_b32 v23, 0x3f803f80, v91
    s_lshl_b32 s3, s30, 7
    s_lshl_b32 s65, s38, 5
    s_add_u32 s3, s3, s65
    v_lshrrev_b32 v249, 3, v1
    v_add_u32 v6, s3, v249
    v_lshlrev_b32 v6, 11, v6
    v_and_b32 v250, 7, v1
    v_lshl_add_u32 v6, v250, 4, v6
    s_lshl_b32 s3, s31, 7
    v_add_u32 v248, s3, v6
    s_mov_b32 s48, 16384
    s_mov_b32 s49, 32768
    s_mov_b32 s100, 49152
    s_lshl_b32 s3, s38, 2
    s_add_u32 s3, s3, 163136
    v_mov_b32 v27, s3
    v_mov_b32 v26, 163104
    s_add_u32 m0, s72, 16384
    s_nop 0
    buffer_load_dwordx4 v8, s[4:7], s74 offen offset:0  lds
    buffer_load_dwordx4 v9, s[4:7], s74 offen offset:1024  lds
    buffer_load_dwordx4 v10, s[4:7], s74 offen offset:2048  lds
    buffer_load_dwordx4 v11, s[4:7], s74 offen offset:3072  lds
    s_add_u32 m0, s72, 24576
    s_add_u32 s3, s74, 131072
    buffer_load_dwordx4 v8, s[4:7], s3 offen offset:0  lds
    buffer_load_dwordx4 v9, s[4:7], s3 offen offset:1024  lds
    buffer_load_dwordx4 v10, s[4:7], s3 offen offset:2048  lds
    buffer_load_dwordx4 v11, s[4:7], s3 offen offset:3072  lds
    s_add_u32 s74, s74, 128
    s_and_b32 s74, s74, 2047
    s_waitcnt vmcnt(8)
    s_barrier
    s_add_u32 s3, s75, 196608
    s_add_u32 m0, s73, 81920
    s_nop 0
    buffer_load_dwordx4 v12, s[8:11], s75 offen offset:0  lds
    buffer_load_dwordx4 v13, s[8:11], s75 offen offset:1024  lds
    s_add_u32 m0, s73, 90112
    s_nop 0
    buffer_load_dwordx4 v14, s[8:11], s75 offen offset:0  lds
    buffer_load_dwordx4 v15, s[8:11], s75 offen offset:1024  lds
    s_add_u32 m0, s73, 86016
    s_nop 0
    buffer_load_dwordx4 v12, s[8:11], s3 offen offset:0  lds
    buffer_load_dwordx4 v13, s[8:11], s3 offen offset:1024  lds
    s_add_u32 m0, s73, 94208
    s_nop 0
    buffer_load_dwordx4 v14, s[8:11], s3 offen offset:0  lds
    buffer_load_dwordx4 v15, s[8:11], s3 offen offset:1024  lds
    s_add_u32 s75, s75, 393216
    s_cmp_eq_u32 s75, 6291456
    s_cselect_b32 s75, 0, s75
    s_add_u32 m0, s73, 139264
    s_nop 0
    buffer_load_dwordx4 v16, s[8:11], s76 offen offset:0  lds
    buffer_load_dwordx4 v17, s[8:11], s76 offen offset:1024  lds
    s_add_u32 m0, s73, 143360
    s_add_u32 s3, s76, 196608
    buffer_load_dwordx4 v16, s[8:11], s3 offen offset:0  lds
    buffer_load_dwordx4 v17, s[8:11], s3 offen offset:1024  lds
    s_add_u32 s76, s76, 393216
    s_cmp_eq_u32 s76, 6291456
    s_cselect_b32 s76, 0, s76
    s_add_u32 m0, s72, 32768
    s_nop 0
    buffer_load_dwordx4 v8, s[4:7], s74 offen offset:0  lds
    buffer_load_dwordx4 v9, s[4:7], s74 offen offset:1024  lds
    buffer_load_dwordx4 v10, s[4:7], s74 offen offset:2048  lds
    buffer_load_dwordx4 v11, s[4:7], s74 offen offset:3072  lds
    s_add_u32 m0, s72, 40960
    s_add_u32 s3, s74, 131072
    buffer_load_dwordx4 v8, s[4:7], s3 offen offset:0  lds
    buffer_load_dwordx4 v9, s[4:7], s3 offen offset:1024  lds
    buffer_load_dwordx4 v10, s[4:7], s3 offen offset:2048  lds
    buffer_load_dwordx4 v11, s[4:7], s3 offen offset:3072  lds
    s_add_u32 s74, s74, 128
    s_and_b32 s74, s74, 2047
    s_add_u32 s3, s75, 196608
    s_add_u32 m0, s73, 98304
    s_nop 0
    buffer_load_dwordx4 v12, s[8:11], s75 offen offset:0  lds
    buffer_load_dwordx4 v13, s[8:11], s75 offen offset:1024  lds
    s_add_u32 m0, s73, 106496
    s_nop 0
    buffer_load_dwordx4 v14, s[8:11], s75 offen offset:0  lds
    buffer_load_dwordx4 v15, s[8:11], s75 offen offset:1024  lds
    s_add_u32 m0, s73, 102400
    s_nop 0
    buffer_load_dwordx4 v12, s[8:11], s3 offen offset:0  lds
    buffer_load_dwordx4 v13, s[8:11], s3 offen offset:1024  lds
    s_add_u32 m0, s73, 110592
    s_nop 0
    buffer_load_dwordx4 v14, s[8:11], s3 offen offset:0  lds
    buffer_load_dwordx4 v15, s[8:11], s3 offen offset:1024  lds
    s_add_u32 s75, s75, 393216
    s_cmp_eq_u32 s75, 6291456
    s_cselect_b32 s75, 0, s75
    s_waitcnt vmcnt(16)
    s_barrier
    s_add_u32 m0, s73, 147456
    s_nop 0
    buffer_load_dwordx4 v16, s[8:11], s76 offen offset:0  lds
    buffer_load_dwordx4 v17, s[8:11], s76 offen offset:1024  lds
    s_add_u32 m0, s73, 151552
    s_add_u32 s3, s76, 196608
    buffer_load_dwordx4 v16, s[8:11], s3 offen offset:0  lds
    buffer_load_dwordx4 v17, s[8:11], s3 offen offset:1024  lds
    s_add_u32 s76, s76, 393216
    s_cmp_eq_u32 s76, 6291456
    s_cselect_b32 s76, 0, s76
    s_add_u32 m0, s72, 49152
    s_nop 0
    buffer_load_dwordx4 v8, s[4:7], s74 offen offset:0  lds
    buffer_load_dwordx4 v9, s[4:7], s74 offen offset:1024  lds
    buffer_load_dwordx4 v10, s[4:7], s74 offen offset:2048  lds
    buffer_load_dwordx4 v11, s[4:7], s74 offen offset:3072  lds
    s_add_u32 m0, s72, 57344
    s_add_u32 s3, s74, 131072
    buffer_load_dwordx4 v8, s[4:7], s3 offen offset:0  lds
    buffer_load_dwordx4 v9, s[4:7], s3 offen offset:1024  lds
    buffer_load_dwordx4 v10, s[4:7], s3 offen offset:2048  lds
    buffer_load_dwordx4 v11, s[4:7], s3 offen offset:3072  lds
    s_add_u32 s74, s74, 128
    s_and_b32 s74, s74, 2047
    s_add_u32 s3, s75, 196608
    s_add_u32 m0, s73, 114688
    s_nop 0
    buffer_load_dwordx4 v12, s[8:11], s75 offen offset:0  lds
    buffer_load_dwordx4 v13, s[8:11], s75 offen offset:1024  lds
    s_add_u32 m0, s73, 122880
    s_nop 0
    buffer_load_dwordx4 v14, s[8:11], s75 offen offset:0  lds
    buffer_load_dwordx4 v15, s[8:11], s75 offen offset:1024  lds
    s_add_u32 m0, s73, 118784
    s_nop 0
    buffer_load_dwordx4 v12, s[8:11], s3 offen offset:0  lds
    buffer_load_dwordx4 v13, s[8:11], s3 offen offset:1024  lds
    s_add_u32 m0, s73, 126976
    s_nop 0
    buffer_load_dwordx4 v14, s[8:11], s3 offen offset:0  lds
    buffer_load_dwordx4 v15, s[8:11], s3 offen offset:1024  lds
    s_add_u32 s75, s75, 393216
    s_cmp_eq_u32 s75, 6291456
    s_cselect_b32 s75, 0, s75
    s_add_u32 m0, s73, 131072
    s_nop 0
    buffer_load_dwordx4 v16, s[8:11], s76 offen offset:0  lds
    buffer_load_dwordx4 v17, s[8:11], s76 offen offset:1024  lds
    s_add_u32 m0, s73, 135168
    s_add_u32 s3, s76, 196608
    buffer_load_dwordx4 v16, s[8:11], s3 offen offset:0  lds
    buffer_load_dwordx4 v17, s[8:11], s3 offen offset:1024  lds
    s_add_u32 s76, s76, 393216
    s_cmp_eq_u32 s76, 6291456
    s_cselect_b32 s76, 0, s76
    s_waitcnt vmcnt(20)
    s_barrier
    s_add_u32 m0, s72, 0
    s_nop 0
    buffer_load_dwordx4 v8, s[4:7], s74 offen offset:0  lds
    buffer_load_dwordx4 v9, s[4:7], s74 offen offset:1024  lds
    buffer_load_dwordx4 v10, s[4:7], s74 offen offset:2048  lds
    buffer_load_dwordx4 v11, s[4:7], s74 offen offset:3072  lds
    s_add_u32 m0, s72, 8192
    s_add_u32 s3, s74, 131072
    buffer_load_dwordx4 v8, s[4:7], s3 offen offset:0  lds
    buffer_load_dwordx4 v9, s[4:7], s3 offen offset:1024  lds
    buffer_load_dwordx4 v10, s[4:7], s3 offen offset:2048  lds
    buffer_load_dwordx4 v11, s[4:7], s3 offen offset:3072  lds
    s_add_u32 s74, s74, 128
    s_and_b32 s74, s74, 2047
    s_add_u32 s3, s75, 196608
    s_add_u32 m0, s73, 65536
    s_nop 0
    buffer_load_dwordx4 v12, s[8:11], s75 offen offset:0  lds
    buffer_load_dwordx4 v13, s[8:11], s75 offen offset:1024  lds
    s_add_u32 m0, s73, 73728
    s_nop 0
    buffer_load_dwordx4 v14, s[8:11], s75 offen offset:0  lds
    buffer_load_dwordx4 v15, s[8:11], s75 offen offset:1024  lds
    s_add_u32 m0, s73, 69632
    s_nop 0
    buffer_load_dwordx4 v12, s[8:11], s3 offen offset:0  lds
    buffer_load_dwordx4 v13, s[8:11], s3 offen offset:1024  lds
    s_add_u32 m0, s73, 77824
    s_nop 0
    buffer_load_dwordx4 v14, s[8:11], s3 offen offset:0  lds
    buffer_load_dwordx4 v15, s[8:11], s3 offen offset:1024  lds
    s_add_u32 s75, s75, 393216
    s_cmp_eq_u32 s75, 6291456
    s_cselect_b32 s75, 0, s75
    s_add_u32 m0, s73, 139264
    s_nop 0
    buffer_load_dwordx4 v16, s[8:11], s76 offen offset:0  lds
    buffer_load_dwordx4 v17, s[8:11], s76 offen offset:1024  lds
    s_add_u32 m0, s73, 143360
    s_add_u32 s3, s76, 196608
    buffer_load_dwordx4 v16, s[8:11], s3 offen offset:0  lds
    buffer_load_dwordx4 v17, s[8:11], s3 offen offset:1024  lds
    s_add_u32 s76, s76, 393216
    s_cmp_eq_u32 s76, 6291456
    s_cselect_b32 s76, 0, s76
    s_add_u32 m0, s72, 16384
    s_nop 0
    buffer_load_dwordx4 v8, s[4:7], s74 offen offset:0  lds
    buffer_load_dwordx4 v9, s[4:7], s74 offen offset:1024  lds
    buffer_load_dwordx4 v10, s[4:7], s74 offen offset:2048  lds
    buffer_load_dwordx4 v11, s[4:7], s74 offen offset:3072  lds
    s_add_u32 m0, s72, 24576
    s_add_u32 s3, s74, 131072
    buffer_load_dwordx4 v8, s[4:7], s3 offen offset:0  lds
    buffer_load_dwordx4 v9, s[4:7], s3 offen offset:1024  lds
    buffer_load_dwordx4 v10, s[4:7], s3 offen offset:2048  lds
    buffer_load_dwordx4 v11, s[4:7], s3 offen offset:3072  lds
    s_add_u32 s74, s74, 128
    s_and_b32 s74, s74, 2047
    s_waitcnt vmcnt(28)
    s_barrier
    s_add_u32 s3, s75, 196608
    s_add_u32 m0, s73, 81920
    s_nop 0
    buffer_load_dwordx4 v12, s[8:11], s75 offen offset:0  lds
    buffer_load_dwordx4 v13, s[8:11], s75 offen offset:1024  lds
    s_add_u32 m0, s73, 90112
    s_nop 0
    buffer_load_dwordx4 v14, s[8:11], s75 offen offset:0  lds
    buffer_load_dwordx4 v15, s[8:11], s75 offen offset:1024  lds
    s_add_u32 m0, s73, 86016
    s_nop 0
    buffer_load_dwordx4 v12, s[8:11], s3 offen offset:0  lds
    buffer_load_dwordx4 v13, s[8:11], s3 offen offset:1024  lds
    s_add_u32 m0, s73, 94208
    s_nop 0
    buffer_load_dwordx4 v14, s[8:11], s3 offen offset:0  lds
    buffer_load_dwordx4 v15, s[8:11], s3 offen offset:1024  lds
    s_add_u32 s75, s75, 393216
    s_cmp_eq_u32 s75, 6291456
    s_cselect_b32 s75, 0, s75
    s_add_u32 m0, s73, 147456
    s_nop 0
    buffer_load_dwordx4 v16, s[8:11], s76 offen offset:0  lds
    buffer_load_dwordx4 v17, s[8:11], s76 offen offset:1024  lds
    s_add_u32 m0, s73, 151552
    s_add_u32 s3, s76, 196608
    buffer_load_dwordx4 v16, s[8:11], s3 offen offset:0  lds
    buffer_load_dwordx4 v17, s[8:11], s3 offen offset:1024  lds
    s_add_u32 s76, s76, 393216
    s_cmp_eq_u32 s76, 6291456
    s_cselect_b32 s76, 0, s76
    s_add_u32 m0, s72, 32768
    s_nop 0
    buffer_load_dwordx4 v8, s[4:7], s74 offen offset:0  lds
    buffer_load_dwordx4 v9, s[4:7], s74 offen offset:1024  lds
    buffer_load_dwordx4 v10, s[4:7], s74 offen offset:2048  lds
    buffer_load_dwordx4 v11, s[4:7], s74 offen offset:3072  lds
    s_add_u32 m0, s72, 40960
    s_add_u32 s3, s74, 131072
    buffer_load_dwordx4 v8, s[4:7], s3 offen offset:0  lds
    buffer_load_dwordx4 v9, s[4:7], s3 offen offset:1024  lds
    buffer_load_dwordx4 v10, s[4:7], s3 offen offset:2048  lds
    buffer_load_dwordx4 v11, s[4:7], s3 offen offset:3072  lds
    s_add_u32 s74, s74, 128
    s_and_b32 s74, s74, 2047
    s_add_u32 s3, s75, 196608
    s_add_u32 m0, s73, 98304
    s_nop 0
    buffer_load_dwordx4 v12, s[8:11], s75 offen offset:0  lds
    buffer_load_dwordx4 v13, s[8:11], s75 offen offset:1024  lds
    s_add_u32 m0, s73, 106496
    s_nop 0
    buffer_load_dwordx4 v14, s[8:11], s75 offen offset:0  lds
    buffer_load_dwordx4 v15, s[8:11], s75 offen offset:1024  lds
    s_add_u32 m0, s73, 102400
    s_nop 0
    buffer_load_dwordx4 v12, s[8:11], s3 offen offset:0  lds
    buffer_load_dwordx4 v13, s[8:11], s3 offen offset:1024  lds
    s_add_u32 m0, s73, 110592
    s_nop 0
    buffer_load_dwordx4 v14, s[8:11], s3 offen offset:0  lds
    buffer_load_dwordx4 v15, s[8:11], s3 offen offset:1024  lds
    s_add_u32 s75, s75, 393216
    s_cmp_eq_u32 s75, 6291456
    s_cselect_b32 s75, 0, s75
    s_waitcnt vmcnt(36)
    s_barrier
    s_add_u32 m0, s73, 131072
    s_nop 0
    buffer_load_dwordx4 v16, s[8:11], s76 offen offset:0  lds
    buffer_load_dwordx4 v17, s[8:11], s76 offen offset:1024  lds
    s_add_u32 m0, s73, 135168
    s_add_u32 s3, s76, 196608
    buffer_load_dwordx4 v16, s[8:11], s3 offen offset:0  lds
    buffer_load_dwordx4 v17, s[8:11], s3 offen offset:1024  lds
    s_add_u32 s76, s76, 393216
    s_cmp_eq_u32 s76, 6291456
    s_cselect_b32 s76, 0, s76
    s_add_u32 m0, s72, 49152
    s_nop 0
    buffer_load_dwordx4 v8, s[4:7], s74 offen offset:0  lds
    buffer_load_dwordx4 v9, s[4:7], s74 offen offset:1024  lds
    buffer_load_dwordx4 v10, s[4:7], s74 offen offset:2048  lds
    buffer_load_dwordx4 v11, s[4:7], s74 offen offset:3072  lds
    s_add_u32 m0, s72, 57344
    s_add_u32 s3, s74, 131072
    buffer_load_dwordx4 v8, s[4:7], s3 offen offset:0  lds
    buffer_load_dwordx4 v9, s[4:7], s3 offen offset:1024  lds
    buffer_load_dwordx4 v10, s[4:7], s3 offen offset:2048  lds
    buffer_load_dwordx4 v11, s[4:7], s3 offen offset:3072  lds
    s_add_u32 s74, s74, 128
    s_and_b32 s74, s74, 2047
    s_add_u32 s3, s75, 196608
    s_add_u32 m0, s73, 114688
    s_nop 0
    buffer_load_dwordx4 v12, s[8:11], s75 offen offset:0  lds
    buffer_load_dwordx4 v13, s[8:11], s75 offen offset:1024  lds
    s_add_u32 m0, s73, 122880
    s_nop 0
    buffer_load_dwordx4 v14, s[8:11], s75 offen offset:0  lds
    buffer_load_dwordx4 v15, s[8:11], s75 offen offset:1024  lds
    s_add_u32 m0, s73, 118784
    s_nop 0
    buffer_load_dwordx4 v12, s[8:11], s3 offen offset:0  lds
    buffer_load_dwordx4 v13, s[8:11], s3 offen offset:1024  lds
    s_add_u32 m0, s73, 126976
    s_nop 0
    buffer_load_dwordx4 v14, s[8:11], s3 offen offset:0  lds
    buffer_load_dwordx4 v15, s[8:11], s3 offen offset:1024  lds
    s_add_u32 s75, s75, 393216
    s_cmp_eq_u32 s75, 6291456
    s_cselect_b32 s75, 0, s75
    s_waitcnt vmcnt(36)
    s_barrier
    s_add_u32 m0, s73, 139264
    s_nop 0
    buffer_load_dwordx4 v16, s[8:11], s76 offen offset:0  lds
    buffer_load_dwordx4 v17, s[8:11], s76 offen offset:1024  lds
    s_add_u32 m0, s73, 143360
    s_add_u32 s3, s76, 196608
    buffer_load_dwordx4 v16, s[8:11], s3 offen offset:0  lds
    buffer_load_dwordx4 v17, s[8:11], s3 offen offset:1024  lds
    s_add_u32 s76, s76, 393216
    s_cmp_eq_u32 s76, 6291456
    s_cselect_b32 s76, 0, s76
    s_add_u32 m0, s72, 0
    s_nop 0
    buffer_load_dwordx4 v8, s[4:7], s74 offen offset:0  lds
    buffer_load_dwordx4 v9, s[4:7], s74 offen offset:1024  lds
    buffer_load_dwordx4 v10, s[4:7], s74 offen offset:2048  lds
    buffer_load_dwordx4 v11, s[4:7], s74 offen offset:3072  lds
    s_add_u32 m0, s72, 8192
    s_add_u32 s3, s74, 131072
    buffer_load_dwordx4 v8, s[4:7], s3 offen offset:0  lds
    buffer_load_dwordx4 v9, s[4:7], s3 offen offset:1024  lds
    buffer_load_dwordx4 v10, s[4:7], s3 offen offset:2048  lds
    buffer_load_dwordx4 v11, s[4:7], s3 offen offset:3072  lds
    s_add_u32 s74, s74, 128
    s_and_b32 s74, s74, 2047
    s_add_u32 s3, s75, 196608
    s_add_u32 m0, s73, 65536
    s_nop 0
    buffer_load_dwordx4 v12, s[8:11], s75 offen offset:0  lds
    buffer_load_dwordx4 v13, s[8:11], s75 offen offset:1024  lds
    s_add_u32 m0, s73, 73728
    s_nop 0
    buffer_load_dwordx4 v14, s[8:11], s75 offen offset:0  lds
    buffer_load_dwordx4 v15, s[8:11], s75 offen offset:1024  lds
    s_add_u32 m0, s73, 69632
    s_nop 0
    buffer_load_dwordx4 v12, s[8:11], s3 offen offset:0  lds
    buffer_load_dwordx4 v13, s[8:11], s3 offen offset:1024  lds
    s_add_u32 m0, s73, 77824
    s_nop 0
    buffer_load_dwordx4 v14, s[8:11], s3 offen offset:0  lds
    buffer_load_dwordx4 v15, s[8:11], s3 offen offset:1024  lds
    s_add_u32 s75, s75, 393216
    s_cmp_eq_u32 s75, 6291456
    s_cselect_b32 s75, 0, s75
    s_waitcnt vmcnt(36)
    s_barrier
    s_add_u32 m0, s73, 147456
    s_nop 0
    buffer_load_dwordx4 v16, s[8:11], s76 offen offset:0  lds
    buffer_load_dwordx4 v17, s[8:11], s76 offen offset:1024  lds
    s_add_u32 m0, s73, 151552
    s_add_u32 s3, s76, 196608
    buffer_load_dwordx4 v16, s[8:11], s3 offen offset:0  lds
    buffer_load_dwordx4 v17, s[8:11], s3 offen offset:1024  lds
    s_add_u32 s76, s76, 393216
    s_cmp_eq_u32 s76, 6291456
    s_cselect_b32 s76, 0, s76
    s_add_u32 m0, s72, 16384
    s_nop 0
    buffer_load_dwordx4 v8, s[4:7], s74 offen offset:0  lds
    buffer_load_dwordx4 v9, s[4:7], s74 offen offset:1024  lds
    buffer_load_dwordx4 v10, s[4:7], s74 offen offset:2048  lds
    buffer_load_dwordx4 v11, s[4:7], s74 offen offset:3072  lds
    s_add_u32 m0, s72, 24576
    s_add_u32 s3, s74, 131072
    buffer_load_dwordx4 v8, s[4:7], s3 offen offset:0  lds
    buffer_load_dwordx4 v9, s[4:7], s3 offen offset:1024  lds
    buffer_load_dwordx4 v10, s[4:7], s3 offen offset:2048  lds
    buffer_load_dwordx4 v11, s[4:7], s3 offen offset:3072  lds
    s_add_u32 s74, s74, 128
    s_and_b32 s74, s74, 2047
    s_add_u32 s3, s75, 196608
    s_add_u32 m0, s73, 81920
    s_nop 0
    buffer_load_dwordx4 v12, s[8:11], s75 offen offset:0  lds
    buffer_load_dwordx4 v13, s[8:11], s75 offen offset:1024  lds
    s_add_u32 m0, s73, 90112
    s_nop 0
    buffer_load_dwordx4 v14, s[8:11], s75 offen offset:0  lds
    buffer_load_dwordx4 v15, s[8:11], s75 offen offset:1024  lds
    s_add_u32 m0, s73, 86016
    s_nop 0
    buffer_load_dwordx4 v12, s[8:11], s3 offen offset:0  lds
    buffer_load_dwordx4 v13, s[8:11], s3 offen offset:1024  lds
    s_add_u32 m0, s73, 94208
    s_nop 0
    buffer_load_dwordx4 v14, s[8:11], s3 offen offset:0  lds
    buffer_load_dwordx4 v15, s[8:11], s3 offen offset:1024  lds
    s_add_u32 s75, s75, 393216
    s_cmp_eq_u32 s75, 6291456
    s_cselect_b32 s75, 0, s75
    s_waitcnt vmcnt(36)
    s_barrier
    s_add_u32 m0, s73, 131072
    s_nop 0
    buffer_load_dwordx4 v16, s[8:11], s76 offen offset:0  lds
    buffer_load_dwordx4 v17, s[8:11], s76 offen offset:1024  lds
    s_add_u32 m0, s73, 135168
    s_add_u32 s3, s76, 196608
    buffer_load_dwordx4 v16, s[8:11], s3 offen offset:0  lds
    buffer_load_dwordx4 v17, s[8:11], s3 offen offset:1024  lds
    s_add_u32 s76, s76, 393216
    s_cmp_eq_u32 s76, 6291456
    s_cselect_b32 s76, 0, s76
    s_add_u32 m0, s72, 32768
    s_nop 0
    buffer_load_dwordx4 v8, s[4:7], s74 offen offset:0  lds
    buffer_load_dwordx4 v9, s[4:7], s74 offen offset:1024  lds
    buffer_load_dwordx4 v10, s[4:7], s74 offen offset:2048  lds
    buffer_load_dwordx4 v11, s[4:7], s74 offen offset:3072  lds
    s_add_u32 m0, s72, 40960
    s_add_u32 s3, s74, 131072
    buffer_load_dwordx4 v8, s[4:7], s3 offen offset:0  lds
    buffer_load_dwordx4 v9, s[4:7], s3 offen offset:1024  lds
    buffer_load_dwordx4 v10, s[4:7], s3 offen offset:2048  lds
    buffer_load_dwordx4 v11, s[4:7], s3 offen offset:3072  lds
    s_add_u32 s74, s74, 128
    s_and_b32 s74, s74, 2047
    s_add_u32 s3, s75, 196608
    s_add_u32 m0, s73, 98304
    s_nop 0
    buffer_load_dwordx4 v12, s[8:11], s75 offen offset:0  lds
    buffer_load_dwordx4 v13, s[8:11], s75 offen offset:1024  lds
    s_add_u32 m0, s73, 106496
    s_nop 0
    buffer_load_dwordx4 v14, s[8:11], s75 offen offset:0  lds
    buffer_load_dwordx4 v15, s[8:11], s75 offen offset:1024  lds
    s_add_u32 m0, s73, 102400
    s_nop 0
    buffer_load_dwordx4 v12, s[8:11], s3 offen offset:0  lds
    buffer_load_dwordx4 v13, s[8:11], s3 offen offset:1024  lds
    s_add_u32 m0, s73, 110592
    s_nop 0
    buffer_load_dwordx4 v14, s[8:11], s3 offen offset:0  lds
    buffer_load_dwordx4 v15, s[8:11], s3 offen offset:1024  lds
    s_add_u32 s75, s75, 393216
    s_cmp_eq_u32 s75, 6291456
    s_cselect_b32 s75, 0, s75
    s_waitcnt vmcnt(36)
    s_barrier
    s_add_u32 m0, s73, 139264
    s_nop 0
    buffer_load_dwordx4 v16, s[8:11], s76 offen offset:0  lds
    buffer_load_dwordx4 v17, s[8:11], s76 offen offset:1024  lds
    s_add_u32 m0, s73, 143360
    s_add_u32 s3, s76, 196608
    buffer_load_dwordx4 v16, s[8:11], s3 offen offset:0  lds
    buffer_load_dwordx4 v17, s[8:11], s3 offen offset:1024  lds
    s_add_u32 s76, s76, 393216
    s_cmp_eq_u32 s76, 6291456
    s_cselect_b32 s76, 0, s76
    s_add_u32 m0, s72, 49152
    s_nop 0
    buffer_load_dwordx4 v8, s[4:7], s74 offen offset:0  lds
    buffer_load_dwordx4 v9, s[4:7], s74 offen offset:1024  lds
    buffer_load_dwordx4 v10, s[4:7], s74 offen offset:2048  lds
    buffer_load_dwordx4 v11, s[4:7], s74 offen offset:3072  lds
    s_add_u32 m0, s72, 57344
    s_add_u32 s3, s74, 131072
    buffer_load_dwordx4 v8, s[4:7], s3 offen offset:0  lds
    buffer_load_dwordx4 v9, s[4:7], s3 offen offset:1024  lds
    buffer_load_dwordx4 v10, s[4:7], s3 offen offset:2048  lds
    buffer_load_dwordx4 v11, s[4:7], s3 offen offset:3072  lds
    s_add_u32 s74, s74, 128
    s_and_b32 s74, s74, 2047
    s_add_u32 s3, s75, 196608
    s_add_u32 m0, s73, 114688
    s_nop 0
    buffer_load_dwordx4 v12, s[8:11], s75 offen offset:0  lds
    buffer_load_dwordx4 v13, s[8:11], s75 offen offset:1024  lds
    s_add_u32 m0, s73, 122880
    s_nop 0
    buffer_load_dwordx4 v14, s[8:11], s75 offen offset:0  lds
    buffer_load_dwordx4 v15, s[8:11], s75 offen offset:1024  lds
    s_add_u32 m0, s73, 118784
    s_nop 0
    buffer_load_dwordx4 v12, s[8:11], s3 offen offset:0  lds
    buffer_load_dwordx4 v13, s[8:11], s3 offen offset:1024  lds
    s_add_u32 m0, s73, 126976
    s_nop 0
    buffer_load_dwordx4 v14, s[8:11], s3 offen offset:0  lds
    buffer_load_dwordx4 v15, s[8:11], s3 offen offset:1024  lds
    s_add_u32 s75, s75, 393216
    s_cmp_eq_u32 s75, 6291456
    s_cselect_b32 s75, 0, s75
    s_waitcnt vmcnt(36)
    s_barrier
    s_getpc_b64 s[66:67]
L_pc2:
    s_add_u32 s66, s66, L_e1-L_pc2
    s_addc_u32 s67, s67, 0
    s_lshr_b32 s3, s2, 3
    s_lshl_b32 s3, s3, 1
    s_add_u32 s3, s3, s38
    s_lshl_b32 s3, s3, 6
    s_add_u32 s66, s66, s3
    s_addc_u32 s67, s67, 0
    s_load_dword s65, s[66:67], 0
    s_load_dword s65, s[66:67], 4096
    s_load_dword s65, s[66:67], 8192
    s_load_dword s65, s[66:67], 12288
    s_add_u32 m0, s73, 147456
    s_nop 0
    buffer_load_dwordx4 v16, s[8:11], s76 offen offset:0  lds
    buffer_load_dwordx4 v17, s[8:11], s76 offen offset:1024  lds
    s_add_u32 m0, s73, 151552
    s_add_u32 s3, s76, 196608
    buffer_load_dwordx4 v16, s[8:11], s3 offen offset:0  lds
    buffer_load_dwordx4 v17, s[8:11], s3 offen offset:1024  lds
    s_add_u32 s76, s76, 393216
    s_cmp_eq_u32 s76, 6291456
    s_cselect_b32 s76, 0, s76
    s_add_u32 m0, s72, 0
    s_nop 0
    buffer_load_dwordx4 v8, s[4:7], s74 offen offset:0  lds
    buffer_load_dwordx4 v9, s[4:7], s74 offen offset:1024  lds
    buffer_load_dwordx4 v10, s[4:7], s74 offen offset:2048  lds
    buffer_load_dwordx4 v11, s[4:7], s74 offen offset:3072  lds
    s_add_u32 m0, s72, 8192
    s_add_u32 s3, s74, 131072
    buffer_load_dwordx4 v8, s[4:7], s3 offen offset:0  lds
    buffer_load_dwordx4 v9, s[4:7], s3 offen offset:1024  lds
    buffer_load_dwordx4 v10, s[4:7], s3 offen offset:2048  lds
    buffer_load_dwordx4 v11, s[4:7], s3 offen offset:3072  lds
    s_add_u32 s74, s74, 128
    s_and_b32 s74, s74, 2047
    s_add_u32 s3, s75, 196608
    s_add_u32 m0, s73, 65536
    s_nop 0
    buffer_load_dwordx4 v12, s[8:11], s75 offen offset:0  lds
    buffer_load_dwordx4 v13, s[8:11], s75 offen offset:1024  lds
    s_add_u32 m0, s73, 73728
    s_nop 0
    buffer_load_dwordx4 v14, s[8:11], s75 offen offset:0  lds
    buffer_load_dwordx4 v15, s[8:11], s75 offen offset:1024  lds
    s_add_u32 m0, s73, 69632
    s_nop 0
    buffer_load_dwordx4 v12, s[8:11], s3 offen offset:0  lds
    buffer_load_dwordx4 v13, s[8:11], s3 offen offset:1024  lds
    s_add_u32 m0, s73, 77824
    s_nop 0
    buffer_load_dwordx4 v14, s[8:11], s3 offen offset:0  lds
    buffer_load_dwordx4 v15, s[8:11], s3 offen offset:1024  lds
    s_add_u32 s75, s75, 393216
    s_cmp_eq_u32 s75, 6291456
    s_cselect_b32 s75, 0, s75
    buffer_load_dwordx4 v[232:235], v248, s[4:7], 0 offen
    buffer_load_dwordx4 v[236:239], v248, s[4:7], s48 offen
    buffer_load_dwordx4 v[240:243], v248, s[4:7], s49 offen
    buffer_load_dwordx4 v[244:247], v248, s[4:7], s100 offen
    s_waitcnt vmcnt(40)
    s_barrier
    s_add_u32 m0, s73, 131072
    s_nop 0
    buffer_load_dwordx4 v16, s[8:11], s76 offen offset:0  lds
    buffer_load_dwordx4 v17, s[8:11], s76 offen offset:1024  lds
    s_add_u32 m0, s73, 135168
    s_add_u32 s3, s76, 196608
    buffer_load_dwordx4 v16, s[8:11], s3 offen offset:0  lds
    buffer_load_dwordx4 v17, s[8:11], s3 offen offset:1024  lds
    s_add_u32 s76, s76, 393216
    s_cmp_eq_u32 s76, 6291456
    s_cselect_b32 s76, 0, s76
    s_add_u32 m0, s72, 16384
    s_nop 0
    buffer_load_dwordx4 v8, s[4:7], s74 offen offset:0  lds
    buffer_load_dwordx4 v9, s[4:7], s74 offen offset:1024  lds
    buffer_load_dwordx4 v10, s[4:7], s74 offen offset:2048  lds
    buffer_load_dwordx4 v11, s[4:7], s74 offen offset:3072  lds
    s_add_u32 m0, s72, 24576
    s_add_u32 s3, s74, 131072
    buffer_load_dwordx4 v8, s[4:7], s3 offen offset:0  lds
    buffer_load_dwordx4 v9, s[4:7], s3 offen offset:1024  lds
    buffer_load_dwordx4 v10, s[4:7], s3 offen offset:2048  lds
    buffer_load_dwordx4 v11, s[4:7], s3 offen offset:3072  lds
    s_add_u32 s74, s74, 128
    s_and_b32 s74, s74, 2047
    s_add_u32 s3, s75, 196608
    s_add_u32 m0, s73, 81920
    s_nop 0
    buffer_load_dwordx4 v12, s[8:11], s75 offen offset:0  lds
    buffer_load_dwordx4 v13, s[8:11], s75 offen offset:1024  lds
    s_add_u32 m0, s73, 90112
    s_nop 0
    buffer_load_dwordx4 v14, s[8:11], s75 offen offset:0  lds
    buffer_load_dwordx4 v15, s[8:11], s75 offen offset:1024  lds
    s_add_u32 m0, s73, 86016
    s_nop 0
    buffer_load_dwordx4 v12, s[8:11], s3 offen offset:0  lds
    buffer_load_dwordx4 v13, s[8:11], s3 offen offset:1024  lds
    s_add_u32 m0, s73, 94208
    s_nop 0
    buffer_load_dwordx4 v14, s[8:11], s3 offen offset:0  lds
    buffer_load_dwordx4 v15, s[8:11], s3 offen offset:1024  lds
    s_add_u32 s75, s75, 393216
    s_cmp_eq_u32 s75, 6291456
    s_cselect_b32 s75, 0, s75
    s_waitcnt vmcnt(40)
    s_barrier
    s_add_u32 m0, s73, 139264
    s_nop 0
    buffer_load_dwordx4 v16, s[8:11], s76 offen offset:0  lds
    buffer_load_dwordx4 v17, s[8:11], s76 offen offset:1024  lds
    s_add_u32 m0, s73, 143360
    s_add_u32 s3, s76, 196608
    buffer_load_dwordx4 v16, s[8:11], s3 offen offset:0  lds
    buffer_load_dwordx4 v17, s[8:11], s3 offen offset:1024  lds
    s_add_u32 s76, s76, 393216
    s_cmp_eq_u32 s76, 6291456
    s_cselect_b32 s76, 0, s76
    s_add_u32 m0, s72, 32768
    s_nop 0
    buffer_load_dwordx4 v8, s[4:7], s74 offen offset:0  lds
    buffer_load_dwordx4 v9, s[4:7], s74 offen offset:1024  lds
    buffer_load_dwordx4 v10, s[4:7], s74 offen offset:2048  lds
    buffer_load_dwordx4 v11, s[4:7], s74 offen offset:3072  lds
    s_add_u32 m0, s72, 40960
    s_add_u32 s3, s74, 131072
    buffer_load_dwordx4 v8, s[4:7], s3 offen offset:0  lds
    buffer_load_dwordx4 v9, s[4:7], s3 offen offset:1024  lds
    buffer_load_dwordx4 v10, s[4:7], s3 offen offset:2048  lds
    buffer_load_dwordx4 v11, s[4:7], s3 offen offset:3072  lds
    s_add_u32 s74, s74, 128
    s_and_b32 s74, s74, 2047
    s_add_u32 s3, s75, 196608
    s_add_u32 m0, s73, 98304
    s_nop 0
    buffer_load_dwordx4 v12, s[8:11], s75 offen offset:0  lds
    buffer_load_dwordx4 v13, s[8:11], s75 offen offset:1024  lds
    s_add_u32 m0, s73, 106496
    s_nop 0
    buffer_load_dwordx4 v14, s[8:11], s75 offen offset:0  lds
    buffer_load_dwordx4 v15, s[8:11], s75 offen offset:1024  lds
    s_add_u32 m0, s73, 102400
    s_nop 0
    buffer_load_dwordx4 v12, s[8:11], s3 offen offset:0  lds
    buffer_load_dwordx4 v13, s[8:11], s3 offen offset:1024  lds
    s_add_u32 m0, s73, 110592
    s_nop 0
    buffer_load_dwordx4 v14, s[8:11], s3 offen offset:0  lds
    buffer_load_dwordx4 v15, s[8:11], s3 offen offset:1024  lds
    s_add_u32 s75, s75, 393216
    s_cmp_eq_u32 s75, 6291456
    s_cselect_b32 s75, 0, s75
    s_waitcnt vmcnt(44)
    s_waitcnt vmcnt(20)
    s_barrier
    s_add_u32 m0, s72, 49152
    s_nop 0
    buffer_load_dwordx4 v8, s[4:7], s74 offen offset:0  lds
    buffer_load_dwordx4 v9, s[4:7], s74 offen offset:1024  lds
    buffer_load_dwordx4 v10, s[4:7], s74 offen offset:2048  lds
    buffer_load_dwordx4 v11, s[4:7], s74 offen offset:3072  lds
    s_add_u32 m0, s72, 57344
    s_add_u32 s3, s74, 131072
    buffer_load_dwordx4 v8, s[4:7], s3 offen offset:0  lds
    buffer_load_dwordx4 v9, s[4:7], s3 offen offset:1024  lds
    buffer_load_dwordx4 v10, s[4:7], s3 offen offset:2048  lds
    buffer_load_dwordx4 v11, s[4:7], s3 offen offset:3072  lds
    s_add_u32 s74, s74, 128
    s_and_b32 s74, s74, 2047
    s_waitcnt vmcnt(8)
    v_mov_b32 v19, 14
    ds_write_b32 v27, v19
    s_add_u32 s3, s75, 196608
    s_add_u32 m0, s73, 114688
    s_nop 0
    buffer_load_dwordx4 v12, s[8:11], s75 offen offset:0  lds
    buffer_load_dwordx4 v13, s[8:11], s75 offen offset:1024  lds
    s_add_u32 m0, s73, 122880
    s_nop 0
    buffer_load_dwordx4 v14, s[8:11], s75 offen offset:0  lds
    buffer_load_dwordx4 v15, s[8:11], s75 offen offset:1024  lds
    s_add_u32 m0, s73, 118784
    s_nop 0
    buffer_load_dwordx4 v12, s[8:11], s3 offen offset:0  lds
    buffer_load_dwordx4 v13, s[8:11], s3 offen offset:1024  lds
    s_add_u32 m0, s73, 126976
    s_nop 0
    buffer_load_dwordx4 v14, s[8:11], s3 offen offset:0  lds
    buffer_load_dwordx4 v15, s[8:11], s3 offen offset:1024  lds
    s_add_u32 s75, s75, 393216
    s_cmp_eq_u32 s75, 6291456
    s_cselect_b32 s75, 0, s75
    s_add_u32 m0, s73, 147456
    s_nop 0
    buffer_load_dwordx4 v16, s[8:11], s76 offen offset:0  lds
    buffer_load_dwordx4 v17, s[8:11], s76 offen offset:1024  lds
    s_add_u32 m0, s73, 151552
    s_add_u32 s3, s76, 196608
    buffer_load_dwordx4 v16, s[8:11], s3 offen offset:0  lds
    buffer_load_dwordx4 v17, s[8:11], s3 offen offset:1024  lds
    s_add_u32 s76, s76, 393216
    s_cmp_eq_u32 s76, 6291456
    s_cselect_b32 s76, 0, s76
    s_waitcnt lgkmcnt(0)
    s_branch L_join
L_xw:
    s_mov_b32 s16, s60
    s_mov_b32 s17, s61
    s_mov_b32 s18, 256
    s_mov_b32 s19, 0x00020000
    s_mov_b32 s20, s44
    s_mov_b32 s21, s45
    s_mov_b32 s22, 65536
    s_mov_b32 s23, 0x00020000
    v_lshlrev_b32 v3, 4, v1
    s_mov_b32 s12, s62
    s_mov_b32 s13, s63
    s_mov_b32 s14, 268435456
    s_mov_b32 s15, 0x00020000
    s_and_b32 s30, s2, 3
    s_lshl_b32 s30, s30, 2
    s_bfe_u32 s3, s2, 0x20003
    s_add_u32 s30, s30, s3
    s_bfe_u32 s31, s2, 0x10002
    s_lshl_b32 s31, s31, 3
    s_lshr_b32 s3, s2, 5
    s_add_u32 s31, s31, s3
    s_mov_b32 s88, 0
    s_mov_b32 s70, 0
    s_mov_b32 s80, s52
    s_mov_b32 s81, s53
    s_mov_b32 s82, 7340032
    s_mov_b32 s83, 0x00020000
    s_mov_b32 s84, s54
    s_mov_b32 s85, s55
    s_mov_b32 s86, 7340032
    s_mov_b32 s87, 0x00020000
    s_cmp_lt_u32 s2, 224
    s_cselect_b32 s82, s82, 0
    s_cselect_b32 s86, s86, 0
    s_and_b32 s3, s2, 15
    s_lshl_b32 s3, s3, 6
    v_and_b32 v5, 0x38, v1
    v_add_u32 v5, s3, v5
    v_mul_u32_u24 v5, 7168, v5
    v_and_b32 v6, 7, v1
    v_lshl_add_u32 v2, v6, 4, v5
    s_lshr_b32 s77, s2, 4
    s_lshl_b32 s77, s77, 2
    s_add_u32 s77, s77, s38
    s_lshl_b32 s77, s77, 7
    v_and_b32 v5, 1, v1
    v_cmp_eq_u32 vcc, 0, v5
    v_mov_b32 v6, 0xffff0000
    v_mov_b32 v7, 0xffff
    v_cndmask_b32 v6, v6, v7, vcc
    v_bfe_u32 v5, v1, 1, 2
    v_cmp_eq_u32 vcc, 0, v5
    s_nop 1
    v_cndmask_b32 v88, 0, v6, vcc
    v_cmp_eq_u32 vcc, 1, v5
    s_nop 1
    v_cndmask_b32 v89, 0, v6, vcc
    v_cmp_eq_u32 vcc, 2, v5
    s_nop 1
    v_cndmask_b32 v90, 0, v6, vcc
    v_cmp_eq_u32 vcc, 3, v5
    s_nop 1
    v_cndmask_b32 v91, 0, v6, vcc
    v_and_b32 v20, 0x3f803f80, v88
    v_and_b32 v21, 0x3f803f80, v89
    v_and_b32 v22, 0x3f803f80, v90
    v_and_b32 v23, 0x3f803f80, v91
    s_lshl_b32 s3, s30, 7
    s_lshl_b32 s65, s38, 5
    s_add_u32 s3, s3, s65
    v_lshrrev_b32 v249, 3, v1
    v_add_u32 v6, s3, v249
    v_lshlrev_b32 v6, 11, v6
    v_and_b32 v250, 7, v1
    v_lshl_add_u32 v6, v250, 4, v6
    s_lshl_b32 s3, s31, 7
    v_add_u32 v248, s3, v6
    s_mov_b32 s48, 16384
    s_mov_b32 s49, 32768
    s_mov_b32 s100, 49152
    s_lshl_b32 s3, s38, 2
    s_add_u32 s3, s3, 163136
    v_mov_b32 v27, s3
    v_mov_b32 v26, 163104
    v_mov_b32 v28, 0x3f803f80
    v_mov_b32 v29, 0x3f803f80
    v_mov_b32 v30, 0x3f803f80
    v_mov_b32 v31, 0x3f803f80
    v_lshrrev_b32 v5, 4, v1
    v_lshlrev_b32 v4, 3, v5
    v_bfe_u32 v6, v1, 2, 2
    v_add_u32 v4, v4, v6
    v_lshlrev_b32 v4, 7, v4
    v_and_b32 v5, 3, v1
    v_lshl_add_u32 v4, v5, 3, v4
    v_add_u32 v4, 65536, v4
    s_and_b32 s3, s38, 1
    s_lshl_b32 s3, s3, 1
    v_bfe_u32 v6, v1, 3, 2
    v_xor_b32 v6, s3, v6
    v_lshl_add_u32 v252, v6, 5, v4
    v_xor_b32 v6, 1, v6
    v_lshl_add_u32 v253, v6, 5, v4
    s_mul_i32 s3, s101, 43
    s_lshr_b32 s3, s3, 7
    s_mul_i32 s3, s3, 3
    s_sub_u32 s3, s101, s3
    s_lshl_b32 s65, s3, 13
    s_add_u32 s65, s65, 65536
    v_add_u32 v32, s65, v252
    v_add_u32 v33, s65, v253
    s_and_b32 s3, s101, 3
    s_lshl_b32 s3, s3, 14
    v_add_u32 v252, s3, v252
    v_add_u32 v253, s3, v253
    s_lshl_b32 s3, s37, 4
    s_add_u32 s3, s3, s36
    s_lshl_b32 s3, s3, 10
    s_and_b32 s65, s38, 1
    s_lshl_b32 s65, s65, 9
    s_add_u32 s3, s3, s65
    s_add_u32 s68, s3, 1048576
    s_mov_b32 s79, 0
    v_mov_b32 v34, 0
    v_mov_b32 v35, 0
    v_mov_b32 v5, 163104
    ds_write_b64 v5, v[34:35]
    ds_write_b64 v5, v[34:35] offset:8
    ds_write_b64 v5, v[34:35] offset:16
    ds_write_b64 v5, v[34:35] offset:24
    ds_write_b64 v5, v[34:35] offset:32
    ds_write_b64 v5, v[34:35] offset:40
    ds_write_b64 v5, v[34:35] offset:48
    ds_write_b64 v5, v[34:35] offset:56
    ds_write_b64 v5, v[34:35] offset:64
    ds_write_b64 v5, v[34:35] offset:72
    ds_write_b64 v5, v[34:35] offset:80
    ds_write_b64 v5, v[34:35] offset:88
    ds_write_b64 v5, v[34:35] offset:96
    ds_write_b64 v5, v[34:35] offset:112
    ds_write_b64 v5, v[34:35] offset:120
L_x0:
    s_barrier
    s_add_u32 s79, s79, 1
    s_cmp_le_u32 s79, s101
    s_cbranch_scc1 L_x0
    ds_read_b64_tr_b16 v[144:145], v252 offset:0
    ds_read_b64_tr_b16 v[146:147], v252 offset:512
    ds_read_b64_tr_b16 v[148:149], v252 offset:4096
    ds_read_b64_tr_b16 v[150:151], v252 offset:4608
    ds_read_b64_tr_b16 v[168:169], v253 offset:0
    ds_read_b64_tr_b16 v[170:171], v253 offset:512
    ds_read_b64_tr_b16 v[172:173], v253 offset:4096
    ds_read_b64_tr_b16 v[174:175], v253 offset:4608
    s_waitcnt lgkmcnt(4)
    ds_read_b64_tr_b16 v[152:153], v252 offset:8192
    ds_read_b64_tr_b16 v[154:155], v252 offset:8704
    ds_read_b64_tr_b16 v[156:157], v252 offset:12288
    ds_read_b64_tr_b16 v[158:159], v252 offset:12800
    ds_read_b64_tr_b16 v[176:177], v253 offset:8192
    ds_read_b64_tr_b16 v[178:179], v253 offset:8704
    ds_read_b64_tr_b16 v[180:181], v253 offset:12288
    ds_read_b64_tr_b16 v[182:183], v253 offset:12800
    s_waitcnt lgkmcnt(4)
    ds_read_b64_tr_b16 v[136:137], v32 offset:0
    ds_read_b64_tr_b16 v[138:139], v32 offset:512
    ds_read_b64_tr_b16 v[140:141], v32 offset:4096
    ds_read_b64_tr_b16 v[142:143], v32 offset:4608
    ds_read_b64_tr_b16 v[160:161], v33 offset:0
    ds_read_b64_tr_b16 v[162:163], v33 offset:512
    ds_read_b64_tr_b16 v[164:165], v33 offset:4096
    ds_read_b64_tr_b16 v[166:167], v33 offset:4608
    s_waitcnt lgkmcnt(0)
    v_mfma_f32_16x16x32_bf16 v[116:119], v[28:31], v[144:147], 0
    v_mfma_f32_16x16x32_bf16 v[120:123], v[28:31], v[152:155], 0
    v_mfma_f32_16x16x32_bf16 v[112:115], v[28:31], v[136:139], 0
    v_mfma_f32_16x16x32_bf16 v[128:131], v[28:31], v[168:171], 0
    v_mfma_f32_16x16x32_bf16 v[132:135], v[28:31], v[176:179], 0
    v_mfma_f32_16x16x32_bf16 v[124:127], v[28:31], v[160:163], 0
    v_mfma_f32_16x16x32_bf16 v[116:119], v[28:31], v[148:151], v[116:119]
    v_mfma_f32_16x16x32_bf16 v[120:123], v[28:31], v[156:159], v[120:123]
    v_mfma_f32_16x16x32_bf16 v[112:115], v[28:31], v[140:143], v[112:115]
    v_mfma_f32_16x16x32_bf16 v[128:131], v[28:31], v[172:175], v[128:131]
    v_mfma_f32_16x16x32_bf16 v[132:135], v[28:31], v[180:183], v[132:135]
    v_mfma_f32_16x16x32_bf16 v[124:127], v[28:31], v[164:167], v[124:127]
L_non:
    buffer_load_dword v18, v34, s[16:19], 0 offen sc1
    s_cmp_lt_u32 s79, 12
    s_cbranch_scc0 L_xb1
    s_barrier
    s_add_u32 s79, s79, 1
L_xb1:
    s_cmp_lt_u32 s79, 12
    s_cbranch_scc0 L_xb2
    s_barrier
    s_add_u32 s79, s79, 1
L_xb2:
    s_waitcnt vmcnt(0)
    v_cmp_eq_u32 vcc, 0, v18
    s_nop 1
    v_cndmask_b32 v6, 0, 1, vcc
    v_cmp_ne_u32 vcc, 0, v6
    s_add_u32 s70, s70, 1
    s_cmp_ge_u32 s70, 200000
    s_cbranch_scc1 L_nonok
    s_cmp_lg_u64 vcc, 0
    s_cbranch_scc1 L_non
L_nonok:
    v_and_b32 v5, 16, v1
    v_cmp_eq_u32 vcc, 0, v5
    s_getreg_b32 s3, hwreg(HW_REG_XCC_ID, 0, 4)
    v_and_b32 v139, -16, v18
    v_or_b32 v139, s3, v139
    v_cndmask_b32 v136, v124, v112, vcc
    v_cndmask_b32 v137, v128, v116, vcc
    v_cndmask_b32 v138, v132, v120, vcc
    s_mov_b64 exec, 0xffffffff
    buffer_store_dwordx4 v[136:139], v3, s[12:15], s68 offen sc1
    s_mov_b64 exec, -1
    s_cmp_eq_u32 s38, 3
    s_cbranch_scc1 L_xbw
L_xu3:
    s_cmp_ge_u32 s79, 7
    s_cbranch_scc1 L_xe3
    s_barrier
    s_add_u32 s79, s79, 1
    s_branch L_xu3
L_xe3:
    s_add_u32 m0, s73, 151552
    s_lshl_b32 s65, s37, 12
    s_add_u32 s65, s65, s73
    s_sub_u32 s65, s65, 4096
    buffer_load_dwordx4 v3, s[20:23], s65 offen offset:0 lds
    buffer_load_dwordx4 v3, s[20:23], s65 offen offset:1024 lds
    s_lshl_b32 s68, s37, 14
    s_add_u32 s68, s68, 1048576
L_cs:
    s_mov_b32 s3, s68
    buffer_load_dwordx4 v[112:115], v3, s[12:15], s3 offen offset:0 sc1
    buffer_load_dwordx4 v[116:119], v3, s[12:15], s3 offen offset:1024 sc1
    buffer_load_dwordx4 v[120:123], v3, s[12:15], s3 offen offset:2048 sc1
    buffer_load_dwordx4 v[124:127], v3, s[12:15], s3 offen offset:3072 sc1
    s_add_u32 s3, s3, 4096
    buffer_load_dwordx4 v[128:131], v3, s[12:15], s3 offen offset:0 sc1
    buffer_load_dwordx4 v[132:135], v3, s[12:15], s3 offen offset:1024 sc1
    buffer_load_dwordx4 v[136:139], v3, s[12:15], s3 offen offset:2048 sc1
    buffer_load_dwordx4 v[140:143], v3, s[12:15], s3 offen offset:3072 sc1
    s_add_u32 s3, s3, 4096
    s_cmp_lt_u32 s79, 12
    s_cbranch_scc0 L_xb4
    s_barrier
    s_add_u32 s79, s79, 1
L_xb4:
    buffer_load_dwordx4 v[144:147], v3, s[12:15], s3 offen offset:0 sc1
    buffer_load_dwordx4 v[148:151], v3, s[12:15], s3 offen offset:1024 sc1
    buffer_load_dwordx4 v[152:155], v3, s[12:15], s3 offen offset:2048 sc1
    buffer_load_dwordx4 v[156:159], v3, s[12:15], s3 offen offset:3072 sc1
    s_add_u32 s3, s3, 4096
    buffer_load_dwordx4 v[160:163], v3, s[12:15], s3 offen offset:0 sc1
    buffer_load_dwordx4 v[164:167], v3, s[12:15], s3 offen offset:1024 sc1
    buffer_load_dwordx4 v[168:171], v3, s[12:15], s3 offen offset:2048 sc1
    buffer_load_dwordx4 v[172:175], v3, s[12:15], s3 offen offset:3072 sc1
    s_cmp_lt_u32 s79, 12
    s_cbranch_scc0 L_xb5
    s_barrier
    s_add_u32 s79, s79, 1
L_xb5:
    s_cmp_lt_u32 s79, 12
    s_cbranch_scc0 L_xb6
    s_barrier
    s_add_u32 s79, s79, 1
L_xb6:
    s_waitcnt vmcnt(0)
    v_and_b32 v4, v115, v119
    v_or_b32 v5, v115, v119
    v_min3_u32 v4, v4, v123, v127
    v_max3_u32 v5, v5, v123, v127
    v_min3_u32 v4, v4, v131, v135
    v_max3_u32 v5, v5, v131, v135
    v_min3_u32 v4, v4, v139, v143
    v_max3_u32 v5, v5, v139, v143
    v_min3_u32 v4, v4, v147, v151
    v_max3_u32 v5, v5, v147, v151
    v_min3_u32 v4, v4, v155, v159
    v_max3_u32 v5, v5, v155, v159
    v_min3_u32 v4, v4, v163, v167
    v_max3_u32 v5, v5, v163, v167
    v_min3_u32 v4, v4, v171, v175
    v_max3_u32 v5, v5, v171, v175
    v_xor_b32 v6, v4, v18
    v_xor_b32 v7, v5, v18
    v_or_b32 v6, v6, v7
    v_and_b32 v6, -16, v6
    v_cmp_ne_u32 vcc, 0, v6
    s_add_u32 s70, s70, 1
    s_cmp_ge_u32 s70, 200000
    s_cbranch_scc1 L_csok
    s_cmp_lg_u64 vcc, 0
    s_cbranch_scc1 L_cs
L_csok:
    v_xor_b32 v4, v4, v5
    v_mov_b32 v5, 163072
    ds_write_b32 v5, v4 offset:16
    s_cmp_lt_u32 s79, 12
    s_cbranch_scc0 L_xb7
    s_barrier
    s_add_u32 s79, s79, 1
L_xb7:
    v_pk_add_f32 v[112:113], v[112:113], v[144:145]
    v_add_f32 v114, v114, v146
    v_pk_add_f32 v[116:117], v[116:117], v[148:149]
    v_add_f32 v118, v118, v150
    v_pk_add_f32 v[120:121], v[120:121], v[152:153]
    v_add_f32 v122, v122, v154
    v_pk_add_f32 v[124:125], v[124:125], v[156:157]
    v_add_f32 v126, v126, v158
    v_pk_add_f32 v[128:129], v[128:129], v[160:161]
    v_add_f32 v130, v130, v162
    v_pk_add_f32 v[132:133], v[132:133], v[164:165]
    v_add_f32 v134, v134, v166
    v_pk_add_f32 v[136:137], v[136:137], v[168:169]
    v_add_f32 v138, v138, v170
    v_pk_add_f32 v[140:141], v[140:141], v[172:173]
    v_add_f32 v142, v142, v174
    v_pk_add_f32 v[112:113], v[112:113], v[128:129]
    v_add_f32 v114, v114, v130
    v_pk_add_f32 v[116:117], v[116:117], v[132:133]
    v_add_f32 v118, v118, v134
    v_pk_add_f32 v[120:121], v[120:121], v[136:137]
    v_add_f32 v122, v122, v138
    v_pk_add_f32 v[124:125], v[124:125], v[140:141]
    v_add_f32 v126, v126, v142
    s_cmp_lt_u32 s79, 12
    s_cbranch_scc0 L_xb8
    s_barrier
    s_add_u32 s79, s79, 1
L_xb8:
    v_pk_add_f32 v[112:113], v[112:113], v[120:121]
    v_add_f32 v114, v114, v122
    v_pk_add_f32 v[116:117], v[116:117], v[124:125]
    v_add_f32 v118, v118, v126
    v_pk_add_f32 v[112:113], v[112:113], v[116:117]
    v_add_f32 v114, v114, v118
    v_lshlrev_b32 v5, 2, v1
    v_add_u32 v5, 162304, v5
    ds_write_b32 v5, v112
    ds_write_b32 v5, v113 offset:256
    ds_write_b32 v5, v114 offset:512
    s_branch L_xend
L_xbw:
    s_cmp_lt_u32 s79, 12
    s_cbranch_scc0 L_xb9
    s_barrier
    s_add_u32 s79, s79, 1
L_xb9:
    v_and_b32 v5, 7, v1
    v_lshlrev_b32 v5, 3, v5
    v_add_u32 v6, 163264, v5
    ds_read_b64 v[140:141], v6
    s_lshl_b32 s65, s36, 4
    s_add_u32 s65, s65, s37
    s_lshl_b32 s65, s65, 6
    s_add_u32 s65, s65, 0
    s_lshl_b32 s3, s2, 4
    s_add_u32 s3, s3, 65536
    v_mov_b32 v146, v18
    v_mov_b32 v147, v18
    s_waitcnt lgkmcnt(0)
    v_mov_b32 v144, v141
    v_mov_b32 v145, v140
    s_nop 0
    v_max_u32 v144, v144, v144 quad_perm:[1,0,3,2] row_mask:0xf bank_mask:0xf
    s_nop 1
    v_max_u32 v144, v144, v144 quad_perm:[2,3,0,1] row_mask:0xf bank_mask:0xf
    s_nop 1
    v_max_u32 v144, v144, v144 row_half_mirror row_mask:0xf bank_mask:0xf
    v_cmp_eq_u32 vcc, v144, v141
    v_mov_b32 v141, v18
    s_mov_b64 exec, 0xff
    buffer_store_dwordx2 v[140:141], v5, s[12:15], s65 offen sc1
    s_and_b64 exec, exec, vcc
    buffer_store_dwordx4 v[144:147], v34, s[12:15], s3 offen sc1
    s_mov_b64 exec, -1
L_xu10:
    s_cmp_ge_u32 s79, 7
    s_cbranch_scc1 L_xe10
    s_barrier
    s_add_u32 s79, s79, 1
    s_branch L_xu10
L_xe10:
    s_add_u32 m0, s73, 151552
    s_lshl_b32 s65, s37, 12
    s_add_u32 s65, s65, s73
    s_sub_u32 s65, s65, 4096
    buffer_load_dwordx4 v3, s[20:23], s65 offen offset:0 lds
    buffer_load_dwordx4 v3, s[20:23], s65 offen offset:1024 lds
    s_mov_b32 s68, 65536
    s_lshl_b32 s66, s36, 10
    s_lshl_b32 s67, s30, 10
L_st:
    buffer_load_dwordx4 v[112:115], v3, s[12:15], s68 offen offset:0 sc1
    buffer_load_dwordx4 v[116:119], v3, s[12:15], s68 offen offset:1024 sc1
    buffer_load_dwordx4 v[120:123], v3, s[12:15], s68 offen offset:2048 sc1
    buffer_load_dwordx4 v[124:127], v3, s[12:15], s68 offen offset:3072 sc1
    buffer_load_dwordx4 v[128:131], v3, s[12:15], s66 offen offset:0 sc1
    buffer_load_dwordx4 v[132:135], v3, s[12:15], s67 offen offset:0 sc1
    s_cmp_lt_u32 s79, 12
    s_cbranch_scc0 L_xb11
    s_barrier
    s_add_u32 s79, s79, 1
L_xb11:
    s_cmp_lt_u32 s79, 12
    s_cbranch_scc0 L_xb12
    s_barrier
    s_add_u32 s79, s79, 1
L_xb12:
    s_waitcnt vmcnt(0)
    v_and_b32 v6, v114, v118
    v_or_b32 v7, v114, v118
    v_min3_u32 v6, v6, v122, v126
    v_max3_u32 v7, v7, v122, v126
    v_min3_u32 v6, v6, v129, v131
    v_max3_u32 v7, v7, v129, v131
    v_min3_u32 v6, v6, v133, v135
    v_max3_u32 v7, v7, v133, v135
    v_xor_b32 v6, v6, v18
    v_xor_b32 v7, v7, v18
    v_or_b32 v6, v6, v7
    v_cmp_ne_u32 vcc, 0, v6
    s_add_u32 s70, s70, 1
    s_cmp_ge_u32 s70, 200000
    s_cbranch_scc1 L_stok
    s_cmp_lg_u64 vcc, 0
    s_cbranch_scc1 L_st
L_stok:
    s_cmp_lt_u32 s79, 12
    s_cbranch_scc0 L_xb13
    s_barrier
    s_add_u32 s79, s79, 1
L_xb13:
    v_and_b32 v140, 0xffff0000, v128
    v_and_b32 v141, 0xffff0000, v130
    v_and_b32 v142, 0xffff0000, v132
    v_and_b32 v143, 0xffff0000, v134
    v_rcp_f32 v144, v140
    v_rcp_f32 v145, v141
    v_rcp_f32 v146, v142
    v_rcp_f32 v147, v143
    v_lshlrev_b32 v136, 16, v128
    v_lshlrev_b32 v137, 16, v130
    v_lshlrev_b32 v138, 16, v132
    v_lshlrev_b32 v139, 16, v134
    v_lshrrev_b32 v7, 16, v128
    v_or_b32 v7, v7, v141
    v_lshlrev_b32 v5, 3, v1
    v_add_u32 v5, 159744, v5
    v_lshlrev_b32 v4, 2, v1
    v_add_u32 v4, 160768, v4
    v_fma_f32 v140, -v144, v140, 1.0
    v_fma_f32 v141, -v145, v141, 1.0
    v_fma_f32 v142, -v146, v142, 1.0
    v_fma_f32 v143, -v147, v143, 1.0
    v_fmac_f32 v144, v140, v144
    v_fmac_f32 v145, v141, v145
    v_fmac_f32 v146, v142, v146
    v_fmac_f32 v147, v143, v147
    v_xor_b32 v136, 0x80000000, v136
    v_xor_b32 v137, 0x80000000, v137
    v_mul_f32 v140, 0x3fb8aa3b, v144
    v_mul_f32 v141, 0x3fb8aa3b, v145
    s_cmp_lt_u32 s79, 12
    s_cbranch_scc0 L_xb14
    s_barrier
    s_add_u32 s79, s79, 1
L_xb14:
    ds_write_b64 v5, v[140:141] offset:3584
    ds_write_b64 v5, v[136:137]
    ds_write_b64 v5, v[144:145] offset:512
    ds_write_b64 v5, v[138:139] offset:1536
    ds_write_b64 v5, v[146:147] offset:2048
    ds_write_b32 v4, v7
    v_cmp_gt_u32 vcc, v116, v112
    s_nop 1
    v_cndmask_b32 v112, v112, v116, vcc
    v_cndmask_b32 v113, v113, v117, vcc
    v_cmp_gt_u32 vcc, v124, v120
    s_nop 1
    v_cndmask_b32 v120, v120, v124, vcc
    v_cndmask_b32 v121, v121, v125, vcc
    v_cmp_gt_u32 vcc, v120, v112
    s_nop 1
    v_cndmask_b32 v112, v112, v120, vcc
    v_cndmask_b32 v113, v113, v121, vcc
    v_mov_b32 v6, v112
    s_cmp_lt_u32 s79, 12
    s_cbranch_scc0 L_xb15
    s_barrier
    s_add_u32 s79, s79, 1
L_xb15:
    v_max_u32 v6, v6, v6 quad_perm:[1,0,3,2] row_mask:0xf bank_mask:0xf
    s_nop 1
    v_max_u32 v6, v6, v6 quad_perm:[2,3,0,1] row_mask:0xf bank_mask:0xf
    s_nop 1
    v_max_u32 v6, v6, v6 row_half_mirror row_mask:0xf bank_mask:0xf
    s_nop 1
    v_max_u32 v6, v6, v6 row_mirror row_mask:0xf bank_mask:0xf
    v_mov_b32 v7, v6
    s_nop 1
    v_permlane16_swap_b32 v6, v7
    v_max_u32 v6, v6, v7
    v_mov_b32 v7, v6
    s_nop 1
    v_permlane32_swap_b32 v6, v7
    v_max_u32 v6, v6, v7
    v_cmp_eq_u32 vcc, v6, v112
    v_mov_b32 v5, 163072
    s_mov_b64 exec, vcc
    ds_write_b128 v5, v[112:115]
    s_mov_b64 exec, -1
L_xend:
    s_waitcnt lgkmcnt(0)
    buffer_load_dwordx4 v[232:235], v248, s[4:7], 0 offen
    buffer_load_dwordx4 v[236:239], v248, s[4:7], s48 offen
    buffer_load_dwordx4 v[240:243], v248, s[4:7], s49 offen
    buffer_load_dwordx4 v[244:247], v248, s[4:7], s100 offen
L_xu16:
    s_cmp_ge_u32 s79, 12
    s_cbranch_scc1 L_xe16
    s_barrier
    s_add_u32 s79, s79, 1
    s_branch L_xu16
L_xe16:
    s_barrier
    s_sleep 6
L_join:
    s_add_u32 s76, s39, 15
    s_and_b32 s76, s76, 15
    s_mul_i32 s76, s76, 393216
    buffer_load_dwordx4 v[36:39], v16, s[8:11], s76 offen offset:0
    buffer_load_dwordx4 v[40:43], v17, s[8:11], s76 offen offset:1024
    s_waitcnt vmcnt(2)
    v_mov_b32 v19, 15
    ds_write_b32 v27, v19
    buffer_load_dwordx4 v[128:131], v2, s[80:83], s77 offen nt
    buffer_load_dwordx4 v[160:163], v2, s[84:87], s77 offen nt
    s_add_u32 s77, s77, 7168
    buffer_load_dwordx4 v[132:135], v2, s[80:83], s77 offen nt
    buffer_load_dwordx4 v[164:167], v2, s[84:87], s77 offen nt
    s_add_u32 s77, s77, 7168
    v_mov_b32 v5, 163072
    ds_read_b128 v[80:83], v5
    ds_read_b32 v84, v5 offset:16
    s_and_b32 s65, s2, 15
    s_lshl_b32 s65, s65, 7
    v_lshrrev_b32 v5, 3, v1
    v_lshlrev_b32 v5, 4, v5
    s_waitcnt lgkmcnt(0)
    v_readfirstlane_b32 s33, v80
    v_readfirstlane_b32 s64, v81
    v_mov_b32 v18, v82
    v_readfirstlane_b32 s101, v84
    s_and_b32 s34, s33, 0x7ff
    s_sub_u32 s34, 2047, s34
    s_lshl_b32 s3, s34, 11
    s_add_u32 s3, s3, s65
    buffer_load_dwordx4 v[76:79], v5, s[4:7], s3 offen
    s_lshr_b32 s3, s34, 7
    s_cmp_eq_u32 s3, s30
    s_cselect_b32 s35, 1, 0
    s_mov_b32 s16, s46
    s_mov_b32 s17, s47
    s_mov_b32 s18, 2097152
    s_mov_b32 s19, 0x00020000
    s_lshl_b32 s3, s2, 2
    s_add_u32 s3, s3, s38
    s_lshl_b32 s3, s3, 11
    v_lshlrev_b32 v5, 7, v1
    s_mov_b64 exec, 0xffff
    buffer_load_dword v0, v5, s[16:19], s3 offen
    s_mov_b64 exec, -1
    buffer_load_dwordx4 v[136:139], v2, s[80:83], s77 offen nt
    buffer_load_dwordx4 v[168:171], v2, s[84:87], s77 offen nt
    s_add_u32 s77, s77, 7168
    buffer_load_dwordx4 v[140:143], v2, s[80:83], s77 offen nt
    buffer_load_dwordx4 v[172:175], v2, s[84:87], s77 offen nt
    s_add_u32 s77, s77, 7168
L_pe14:
    ds_read_b128 v[224:227], v26 offset:48
    s_waitcnt lgkmcnt(0)
    v_min_u32 v224, v224, v225
    v_min3_u32 v224, v224, v226, v227
    s_nop 0
    v_readfirstlane_b32 s3, v224
    s_nop 0
    s_cmp_ge_u32 s3, 14
    s_cbranch_scc1 L_pd14
    s_sleep 3
    s_branch L_pe14
L_pd14:
    s_waitcnt vmcnt(10)
    s_add_u32 s3, s73, 65536
    v_add_u32 v24, s3, v3
    ds_write_b128 v24, v[36:39] offset:16384
    ds_write_b128 v24, v[40:43] offset:17408
    s_lshl_b32 s3, s38, 2
    s_add_u32 s3, s3, 163120
    v_mov_b32 v5, s3
    v_mov_b32 v6, 1
    ds_write_b32 v5, v6
    buffer_load_dwordx4 v[144:147], v2, s[80:83], s77 offen nt
    buffer_load_dwordx4 v[176:179], v2, s[84:87], s77 offen nt
    s_add_u32 s77, s77, 7168
    buffer_load_dwordx4 v[148:151], v2, s[80:83], s77 offen nt
    buffer_load_dwordx4 v[180:183], v2, s[84:87], s77 offen nt
    s_add_u32 s77, s77, 7168
    buffer_load_dwordx4 v[152:155], v2, s[80:83], s77 offen nt
    buffer_load_dwordx4 v[184:187], v2, s[84:87], s77 offen nt
    s_add_u32 s77, s77, 7168
    buffer_load_dwordx4 v[156:159], v2, s[80:83], s77 offen nt
    buffer_load_dwordx4 v[188:191], v2, s[84:87], s77 offen nt
    s_add_u32 s77, s77, 7168
    s_mov_b32 s20, s56
    s_mov_b32 s21, s57
    s_mov_b32 s22, 7340032
    s_mov_b32 s23, 0x00020000
    s_mov_b32 s24, s58
    s_mov_b32 s25, s59
    s_mov_b32 s26, 4194304
    s_mov_b32 s27, 0x00020000
    s_cmp_lt_u32 s2, 224
    s_cselect_b32 s22, s22, 0
    v_lshrrev_b32 v5, 4, v1
    v_lshlrev_b32 v5, 11, v5
    v_and_b32 v6, 15, v1
    v_lshl_add_u32 v109, v6, 4, v5
    s_lshl_b32 s93, s2, 15
    s_lshl_b32 s65, s38, 9
    s_add_u32 s93, s93, s65
    buffer_load_dwordx4 v[192:195], v109, s[20:23], s93 offen offset:0 nt
    buffer_load_dwordx4 v[196:199], v109, s[20:23], s93 offen offset:256 nt
    s_add_u32 s93, s93, 8192
    buffer_load_dwordx4 v[200:203], v109, s[20:23], s93 offen offset:0 nt
    buffer_load_dwordx4 v[204:207], v109, s[20:23], s93 offen offset:256 nt
    s_add_u32 s93, s93, 8192
    buffer_load_dwordx4 v[208:211], v109, s[20:23], s93 offen offset:0 nt
    buffer_load_dwordx4 v[212:215], v109, s[20:23], s93 offen offset:256 nt
    s_add_u32 s93, s93, 8192
    buffer_load_dwordx4 v[216:219], v109, s[20:23], s93 offen offset:0 nt
    buffer_load_dwordx4 v[220:223], v109, s[20:23], s93 offen offset:256 nt
    s_lshl_b32 s65, s37, 1
    s_and_b32 s3, s38, 1
    s_add_u32 s65, s65, s3
    s_lshl_b32 s3, s36, 9
    s_lshl_b32 s89, s65, 17
    s_add_u32 s89, s89, s3
    s_add_u32 s89, s89, 2097152
    s_add_u32 s90, s89, 32768
    s_add_u32 s91, s89, 65536
    s_add_u32 s92, s89, 98304
    s_lshl_b32 s69, s65, 13
    s_add_u32 s69, s69, 524288
    s_add_u32 s68, s69, s3
    s_add_u32 s71, s69, 4096
    s_mov_b32 s94, 0xffff
    s_mov_b32 s95, 0xffff
    v_lshrrev_b32 v5, 4, v1
    v_and_b32 v6, 15, v1
    v_lshlrev_b32 v6, 4, v6
    v_lshl_add_u32 v28, v5, 13, v6
    v_lshrrev_b32 v7, 5, v1
    v_lshl_add_u32 v29, v7, 8, v6
    s_lshl_b32 s3, s38, 12
    s_add_u32 s3, s3, 141312
    v_add_u32 v30, s3, v3
    s_lshl_b32 s3, s38, 7
    s_add_u32 s3, s3, 157440
    v_lshl_add_u32 v31, v5, 3, s3
    v_and_b32 v5, 8, v1
    v_cmp_eq_u32 vcc, 0, v5
    s_nop 1
    v_cndmask_b32 v112, 0, v20, vcc
    v_cndmask_b32 v116, v20, 0, vcc
    v_cndmask_b32 v113, 0, v21, vcc
    v_cndmask_b32 v117, v21, 0, vcc
    v_cndmask_b32 v114, 0, v22, vcc
    v_cndmask_b32 v118, v22, 0, vcc
    v_cndmask_b32 v115, 0, v23, vcc
    v_cndmask_b32 v119, v23, 0, vcc
    v_mov_b32 v127, v18
    s_waitcnt vmcnt(21)
    s_lshl_b32 s65, s64, 16
    s_and_b32 s66, s64, 0xffff0000
    v_rcp_f32 v6, s66
    v_lshlrev_b32 v80, 16, v76
    v_and_b32 v81, 0xffff0000, v76
    v_lshlrev_b32 v82, 16, v77
    v_and_b32 v83, 0xffff0000, v77
    v_lshlrev_b32 v84, 16, v78
    v_and_b32 v85, 0xffff0000, v78
    v_lshlrev_b32 v86, 16, v79
    v_and_b32 v87, 0xffff0000, v79
    v_fma_f32 v4, -v6, s66, 1.0
    v_fmac_f32 v6, v4, v6
    v_subrev_f32 v80, s65, v80
    v_subrev_f32 v81, s65, v81
    v_subrev_f32 v82, s65, v82
    v_subrev_f32 v83, s65, v83
    v_subrev_f32 v84, s65, v84
    v_subrev_f32 v85, s65, v85
    v_subrev_f32 v86, s65, v86
    v_subrev_f32 v87, s65, v87
    v_cvt_pk_bf16_f32 v80, v80, v80
    v_cvt_pk_bf16_f32 v81, v81, v81
    v_cvt_pk_bf16_f32 v82, v82, v82
    v_cvt_pk_bf16_f32 v83, v83, v83
    v_cvt_pk_bf16_f32 v84, v84, v84
    v_cvt_pk_bf16_f32 v85, v85, v85
    v_cvt_pk_bf16_f32 v86, v86, v86
    v_cvt_pk_bf16_f32 v87, v87, v87
    v_lshlrev_b32 v80, 16, v80
    v_lshlrev_b32 v81, 16, v81
    v_lshlrev_b32 v82, 16, v82
    v_lshlrev_b32 v83, 16, v83
    v_lshlrev_b32 v84, 16, v84
    v_lshlrev_b32 v85, 16, v85
    v_lshlrev_b32 v86, 16, v86
    v_lshlrev_b32 v87, 16, v87
    v_mul_f32 v80, v80, v6
    v_mul_f32 v81, v81, v6
    v_mul_f32 v82, v82, v6
    v_mul_f32 v83, v83, v6
    v_mul_f32 v84, v84, v6
    v_mul_f32 v85, v85, v6
    v_mul_f32 v86, v86, v6
    v_mul_f32 v87, v87, v6
    v_cvt_pk_bf16_f32 v80, v80, v80
    v_cvt_pk_bf16_f32 v81, v81, v81
    v_cvt_pk_bf16_f32 v82, v82, v82
    v_cvt_pk_bf16_f32 v83, v83, v83
    v_cvt_pk_bf16_f32 v84, v84, v84
    v_cvt_pk_bf16_f32 v85, v85, v85
    v_cvt_pk_bf16_f32 v86, v86, v86
    v_cvt_pk_bf16_f32 v87, v87, v87
    v_lshrrev_b32 v5, 5, v1
    v_and_b32 v6, 7, v1
    v_lshlrev_b32 v6, 1, v6
    v_lshl_add_u32 v6, v5, 4, v6
    v_bfe_u32 v5, v1, 4, 1
    v_add_u32 v6, v6, v5
    v_lshlrev_b32 v108, 4, v6
    s_lshr_b32 s3, s2, 4
    s_lshl_b32 s3, s3, 2
    s_add_u32 s3, s3, s38
    s_lshl_b32 s3, s3, 4
    s_and_b32 s65, s2, 15
    s_add_u32 s3, s3, s65
    s_lshl_b32 s3, s3, 10
    s_add_u32 s78, s3, 6291456
    s_mov_b32 s66, 0x00ff00ff
    s_mov_b32 s67, 0x00ff00ff
    v_mov_b32 v93, v18
    v_mov_b32 v95, v18
    v_mov_b32 v97, v18
    v_mov_b32 v99, v18
    v_lshrrev_b32 v5, 3, v1
    v_lshlrev_b32 v5, 11, v5
    v_lshrrev_b32 v6, 4, v1
    v_lshlrev_b32 v6, 1, v6
    v_and_b32 v7, 7, v1
    v_xor_b32 v6, v6, v7
    v_lshl_add_u32 v5, v6, 4, v5
    s_lshl_b32 s3, s31, 7
    s_lshl_b32 s65, s38, 15
    s_add_u32 s3, s3, s65
    v_add_u32 v110, s3, v5
    v_add_u32 v111, 15360, v110
    v_and_b32 v68, v80, v88
    v_and_b32 v69, v80, v89
    v_and_b32 v70, v80, v90
    v_and_b32 v71, v80, v91
    s_nop 1
    v_mfma_f32_16x16x32_bf16 v[100:103], v[68:71], v[128:131], 0
    v_mfma_f32_16x16x32_bf16 v[104:107], v[68:71], v[160:163], 0
    v_and_b32 v72, v81, v88
    v_and_b32 v73, v81, v89
    v_and_b32 v74, v81, v90
    v_and_b32 v75, v81, v91
    s_nop 1
    v_mfma_f32_16x16x32_bf16 v[100:103], v[72:75], v[132:135], v[100:103]
    v_mfma_f32_16x16x32_bf16 v[104:107], v[72:75], v[164:167], v[104:107]
    s_waitcnt vmcnt(18)
    v_and_b32 v68, v82, v88
    v_and_b32 v69, v82, v89
    v_and_b32 v70, v82, v90
    v_and_b32 v71, v82, v91
    s_nop 1
    v_mfma_f32_16x16x32_bf16 v[100:103], v[68:71], v[136:139], v[100:103]
    v_mfma_f32_16x16x32_bf16 v[104:107], v[68:71], v[168:171], v[104:107]
    s_waitcnt vmcnt(16)
    v_and_b32 v72, v83, v88
    v_and_b32 v73, v83, v89
    v_and_b32 v74, v83, v90
    v_and_b32 v75, v83, v91
    s_nop 1
    v_mfma_f32_16x16x32_bf16 v[100:103], v[72:75], v[140:143], v[100:103]
    v_mfma_f32_16x16x32_bf16 v[104:107], v[72:75], v[172:175], v[104:107]
    s_waitcnt vmcnt(14)
    v_and_b32 v68, v84, v88
    v_and_b32 v69, v84, v89
    v_and_b32 v70, v84, v90
    v_and_b32 v71, v84, v91
    s_nop 1
    v_mfma_f32_16x16x32_bf16 v[100:103], v[68:71], v[144:147], v[100:103]
    v_mfma_f32_16x16x32_bf16 v[104:107], v[68:71], v[176:179], v[104:107]
    s_waitcnt vmcnt(12)
    v_and_b32 v72, v85, v88
    v_and_b32 v73, v85, v89
    v_and_b32 v74, v85, v90
    v_and_b32 v75, v85, v91
    s_nop 1
    v_mfma_f32_16x16x32_bf16 v[100:103], v[72:75], v[148:151], v[100:103]
    v_mfma_f32_16x16x32_bf16 v[104:107], v[72:75], v[180:183], v[104:107]
    s_waitcnt vmcnt(10)
    v_and_b32 v68, v86, v88
    v_and_b32 v69, v86, v89
    v_and_b32 v70, v86, v90
    v_and_b32 v71, v86, v91
    s_nop 1
    v_mfma_f32_16x16x32_bf16 v[100:103], v[68:71], v[152:155], v[100:103]
    v_mfma_f32_16x16x32_bf16 v[104:107], v[68:71], v[184:187], v[104:107]
    s_waitcnt vmcnt(8)
    v_and_b32 v72, v87, v88
    v_and_b32 v73, v87, v89
    v_and_b32 v74, v87, v90
    v_and_b32 v75, v87, v91
    s_nop 1
    v_mfma_f32_16x16x32_bf16 v[100:103], v[72:75], v[156:159], v[100:103]
    v_mfma_f32_16x16x32_bf16 v[104:107], v[72:75], v[188:191], v[104:107]
    s_nop 7
    v_permlane32_swap_b32 v100, v104
    v_permlane32_swap_b32 v101, v105
    v_permlane32_swap_b32 v102, v106
    v_permlane32_swap_b32 v103, v107
    v_add_f32 v92, v104, v100 row_ror:8 row_mask:0xf bank_mask:0xf
    v_add_f32 v94, v105, v101 row_ror:8 row_mask:0xf bank_mask:0xf
    v_add_f32 v96, v106, v102 row_ror:8 row_mask:0xf bank_mask:0xf
    v_add_f32 v98, v107, v103 row_ror:8 row_mask:0xf bank_mask:0xf
    s_mov_b64 exec, s[66:67]
    buffer_store_dwordx4 v[92:95], v108, s[12:15], s78 offen offset:0 sc1
    buffer_store_dwordx4 v[96:99], v108, s[12:15], s78 offen offset:512 sc1
    s_mov_b64 exec, -1
L_pe17:
    ds_read_b128 v[224:227], v26 offset:48
    s_waitcnt lgkmcnt(0)
    v_min_u32 v224, v224, v225
    v_min3_u32 v224, v224, v226, v227
    s_nop 0
    v_readfirstlane_b32 s3, v224
    s_nop 0
    s_cmp_ge_u32 s3, 17
    s_cbranch_scc1 L_pd17
    s_sleep 3
    s_branch L_pe17
L_pd17:
    s_cmp_ge_u32 s38, 2
    s_cbranch_scc1 L_xw2
    s_waitcnt vmcnt(8)
    s_add_u32 m0, s73, 0
    s_mov_b32 s3, 0
    buffer_load_dwordx4 v110, s[16:19], s3 offen offset:0  lds
    buffer_load_dwordx4 v111, s[16:19], s3 offen offset:1024  lds
    s_add_u32 m0, s73, 4096
    s_add_u32 s3, s3, 65536
    buffer_load_dwordx4 v110, s[16:19], s3 offen offset:0  lds
    buffer_load_dwordx4 v111, s[16:19], s3 offen offset:1024  lds
    s_waitcnt vmcnt(8)
    s_add_u32 m0, s73, 8192
    s_mov_b32 s3, 131072
    buffer_load_dwordx4 v110, s[16:19], s3 offen offset:0  lds
    buffer_load_dwordx4 v111, s[16:19], s3 offen offset:1024  lds
    s_add_u32 m0, s73, 12288
    s_add_u32 s3, s3, 65536
    buffer_load_dwordx4 v110, s[16:19], s3 offen offset:0  lds
    buffer_load_dwordx4 v111, s[16:19], s3 offen offset:1024  lds
    s_waitcnt vmcnt(8)
    s_add_u32 m0, s73, 65536
    s_mov_b32 s3, 1048576
    buffer_load_dwordx4 v110, s[16:19], s3 offen offset:0  lds
    buffer_load_dwordx4 v111, s[16:19], s3 offen offset:1024  lds
    s_add_u32 m0, s73, 69632
    s_add_u32 s3, s3, 65536
    buffer_load_dwordx4 v110, s[16:19], s3 offen offset:0  lds
    buffer_load_dwordx4 v111, s[16:19], s3 offen offset:1024  lds
    s_waitcnt vmcnt(8)
    s_add_u32 m0, s73, 73728
    s_mov_b32 s3, 1179648
    buffer_load_dwordx4 v110, s[16:19], s3 offen offset:0  lds
    buffer_load_dwordx4 v111, s[16:19], s3 offen offset:1024  lds
    s_add_u32 m0, s73, 77824
    s_add_u32 s3, s3, 65536
    buffer_load_dwordx4 v110, s[16:19], s3 offen offset:0  lds
    buffer_load_dwordx4 v111, s[16:19], s3 offen offset:1024  lds
    s_waitcnt vmcnt(8)
    s_add_u32 m0, s73, 90112
    s_mov_b32 s3, 1441792
    buffer_load_dwordx4 v110, s[16:19], s3 offen offset:0  lds
    buffer_load_dwordx4 v111, s[16:19], s3 offen offset:1024  lds
    s_add_u32 m0, s73, 94208
    s_add_u32 s3, s3, 65536
    buffer_load_dwordx4 v110, s[16:19], s3 offen offset:0  lds
    buffer_load_dwordx4 v111, s[16:19], s3 offen offset:1024  lds
    s_waitcnt vmcnt(8)
    s_add_u32 m0, s73, 98304
    s_mov_b32 s3, 1572864
    buffer_load_dwordx4 v110, s[16:19], s3 offen offset:0  lds
    buffer_load_dwordx4 v111, s[16:19], s3 offen offset:1024  lds
    s_add_u32 m0, s73, 102400
    s_add_u32 s3, s3, 65536
    buffer_load_dwordx4 v110, s[16:19], s3 offen offset:0  lds
    buffer_load_dwordx4 v111, s[16:19], s3 offen offset:1024  lds
    s_waitcnt vmcnt(8)
    s_add_u32 m0, s73, 106496
    s_mov_b32 s3, 1703936
    buffer_load_dwordx4 v110, s[16:19], s3 offen offset:0  lds
    buffer_load_dwordx4 v111, s[16:19], s3 offen offset:1024  lds
    s_add_u32 m0, s73, 110592
    s_add_u32 s3, s3, 65536
    buffer_load_dwordx4 v110, s[16:19], s3 offen offset:0  lds
    buffer_load_dwordx4 v111, s[16:19], s3 offen offset:1024  lds
    s_waitcnt vmcnt(8)
    s_add_u32 m0, s73, 114688
    s_mov_b32 s3, 1835008
    buffer_load_dwordx4 v110, s[16:19], s3 offen offset:0  lds
    buffer_load_dwordx4 v111, s[16:19], s3 offen offset:1024  lds
    s_add_u32 m0, s73, 118784
    s_add_u32 s3, s3, 65536
    buffer_load_dwordx4 v110, s[16:19], s3 offen offset:0  lds
    buffer_load_dwordx4 v111, s[16:19], s3 offen offset:1024  lds
    s_waitcnt vmcnt(8)
    s_add_u32 m0, s73, 122880
    s_mov_b32 s3, 1966080
    buffer_load_dwordx4 v110, s[16:19], s3 offen offset:0  lds
    buffer_load_dwordx4 v111, s[16:19], s3 offen offset:1024  lds
    s_add_u32 m0, s73, 126976
    s_add_u32 s3, s3, 65536
    buffer_load_dwordx4 v110, s[16:19], s3 offen offset:0  lds
    buffer_load_dwordx4 v111, s[16:19], s3 offen offset:1024  lds
L_pe18:
    ds_read_b128 v[224:227], v26 offset:48
    s_waitcnt lgkmcnt(0)
    v_min_u32 v224, v224, v225
    v_min3_u32 v224, v224, v226, v227
    s_nop 0
    v_readfirstlane_b32 s3, v224
    s_nop 0
    s_cmp_ge_u32 s3, 18
    s_cbranch_scc1 L_pd18
    s_sleep 3
    s_branch L_pe18
L_pd18:
    s_waitcnt vmcnt(8)
    s_add_u32 m0, s73, 16384
    s_mov_b32 s3, 262144
    buffer_load_dwordx4 v110, s[16:19], s3 offen offset:0  lds
    buffer_load_dwordx4 v111, s[16:19], s3 offen offset:1024  lds
    s_add_u32 m0, s73, 20480
    s_add_u32 s3, s3, 65536
    buffer_load_dwordx4 v110, s[16:19], s3 offen offset:0  lds
    buffer_load_dwordx4 v111, s[16:19], s3 offen offset:1024  lds
    s_waitcnt vmcnt(8)
    s_add_u32 m0, s73, 24576
    s_mov_b32 s3, 393216
    buffer_load_dwordx4 v110, s[16:19], s3 offen offset:0  lds
    buffer_load_dwordx4 v111, s[16:19], s3 offen offset:1024  lds
    s_add_u32 m0, s73, 28672
    s_add_u32 s3, s3, 65536
    buffer_load_dwordx4 v110, s[16:19], s3 offen offset:0  lds
    buffer_load_dwordx4 v111, s[16:19], s3 offen offset:1024  lds
L_pe19:
    ds_read_b128 v[224:227], v26 offset:48
    s_waitcnt lgkmcnt(0)
    v_min_u32 v224, v224, v225
    v_min3_u32 v224, v224, v226, v227
    s_nop 0
    v_readfirstlane_b32 s3, v224
    s_nop 0
    s_cmp_ge_u32 s3, 19
    s_cbranch_scc1 L_pd19
    s_sleep 3
    s_branch L_pe19
L_pd19:
    s_waitcnt vmcnt(8)
    s_add_u32 m0, s73, 32768
    s_mov_b32 s3, 524288
    buffer_load_dwordx4 v110, s[16:19], s3 offen offset:0  lds
    buffer_load_dwordx4 v111, s[16:19], s3 offen offset:1024  lds
    s_add_u32 m0, s73, 36864
    s_add_u32 s3, s3, 65536
    buffer_load_dwordx4 v110, s[16:19], s3 offen offset:0  lds
    buffer_load_dwordx4 v111, s[16:19], s3 offen offset:1024  lds
    s_waitcnt vmcnt(8)
    s_add_u32 m0, s73, 40960
    s_mov_b32 s3, 655360
    buffer_load_dwordx4 v110, s[16:19], s3 offen offset:0  lds
    buffer_load_dwordx4 v111, s[16:19], s3 offen offset:1024  lds
    s_add_u32 m0, s73, 45056
    s_add_u32 s3, s3, 65536
    buffer_load_dwordx4 v110, s[16:19], s3 offen offset:0  lds
    buffer_load_dwordx4 v111, s[16:19], s3 offen offset:1024  lds
L_pe20:
    ds_read_b128 v[224:227], v26 offset:48
    s_waitcnt lgkmcnt(0)
    v_min_u32 v224, v224, v225
    v_min3_u32 v224, v224, v226, v227
    s_nop 0
    v_readfirstlane_b32 s3, v224
    s_nop 0
    s_cmp_ge_u32 s3, 20
    s_cbranch_scc1 L_pd20
    s_sleep 3
    s_branch L_pe20
L_pd20:
    s_waitcnt vmcnt(8)
    s_add_u32 m0, s73, 49152
    s_mov_b32 s3, 786432
    buffer_load_dwordx4 v110, s[16:19], s3 offen offset:0  lds
    buffer_load_dwordx4 v111, s[16:19], s3 offen offset:1024  lds
    s_add_u32 m0, s73, 53248
    s_add_u32 s3, s3, 65536
    buffer_load_dwordx4 v110, s[16:19], s3 offen offset:0  lds
    buffer_load_dwordx4 v111, s[16:19], s3 offen offset:1024  lds
    s_waitcnt vmcnt(8)
    s_add_u32 m0, s73, 57344
    s_mov_b32 s3, 917504
    buffer_load_dwordx4 v110, s[16:19], s3 offen offset:0  lds
    buffer_load_dwordx4 v111, s[16:19], s3 offen offset:1024  lds
    s_add_u32 m0, s73, 61440
    s_add_u32 s3, s3, 65536
    buffer_load_dwordx4 v110, s[16:19], s3 offen offset:0  lds
    buffer_load_dwordx4 v111, s[16:19], s3 offen offset:1024  lds
    s_waitcnt vmcnt(8)
    s_add_u32 m0, s73, 81920
    s_mov_b32 s3, 1310720
    buffer_load_dwordx4 v110, s[16:19], s3 offen offset:0  lds
    buffer_load_dwordx4 v111, s[16:19], s3 offen offset:1024  lds
    s_add_u32 m0, s73, 86016
    s_add_u32 s3, s3, 65536
    buffer_load_dwordx4 v110, s[16:19], s3 offen offset:0  lds
    buffer_load_dwordx4 v111, s[16:19], s3 offen offset:1024  lds
    s_branch L_join2
L_xw2:
    s_setprio 3
    buffer_load_dwordx4 v[36:39], v28, s[12:15], s89 offen offset:0 sc1
    buffer_load_dwordx4 v[40:43], v28, s[12:15], s89 offen offset:256 sc1
    buffer_load_dwordx4 v[44:47], v28, s[12:15], s90 offen offset:0 sc1
    buffer_load_dwordx4 v[48:51], v28, s[12:15], s90 offen offset:256 sc1
    buffer_load_dwordx4 v[52:55], v28, s[12:15], s91 offen offset:0 sc1
    buffer_load_dwordx4 v[56:59], v28, s[12:15], s91 offen offset:256 sc1
    buffer_load_dwordx4 v[60:63], v28, s[12:15], s92 offen offset:0 sc1
    buffer_load_dwordx4 v[64:67], v28, s[12:15], s92 offen offset:256 sc1
    s_waitcnt vmcnt(0)
L_ha:
    v_mfma_f32_16x16x32_bf16 v[120:123], v[112:115], v[36:39], 0
    v_mfma_f32_16x16x32_bf16 v[120:123], v[116:119], v[40:43], v[120:123]
    v_mfma_f32_16x16x32_bf16 v[120:123], v[112:115], v[44:47], v[120:123]
    v_mfma_f32_16x16x32_bf16 v[120:123], v[116:119], v[48:51], v[120:123]
    v_mfma_f32_16x16x32_bf16 v[120:123], v[112:115], v[52:55], v[120:123]
    v_mfma_f32_16x16x32_bf16 v[120:123], v[116:119], v[56:59], v[120:123]
    v_mfma_f32_16x16x32_bf16 v[120:123], v[112:115], v[60:63], v[120:123]
    v_mfma_f32_16x16x32_bf16 v[120:123], v[116:119], v[64:67], v[120:123]
    v_and_b32 v6, v39, v43
    v_or_b32 v7, v39, v43
    v_min3_u32 v6, v6, v47, v51
    v_max3_u32 v7, v7, v47, v51
    v_min3_u32 v6, v6, v55, v59
    v_max3_u32 v7, v7, v55, v59
    v_min3_u32 v6, v6, v63, v67
    v_max3_u32 v7, v7, v63, v67
    v_xor_b32 v6, v6, v18
    v_xor_b32 v7, v7, v18
    v_or_b32 v6, v6, v7
    v_cmp_ne_u32 vcc, 0, v6
    s_nop 0
    s_cmp_eq_u64 vcc, 0
    s_cbranch_scc1 L_haok
    s_add_u32 s70, s70, 1
    s_cmp_ge_u32 s70, 200000
    s_cbranch_scc1 L_haok
    s_sleep 2
    buffer_load_dwordx4 v[36:39], v28, s[12:15], s89 offen offset:0 sc1
    buffer_load_dwordx4 v[40:43], v28, s[12:15], s89 offen offset:256 sc1
    buffer_load_dwordx4 v[44:47], v28, s[12:15], s90 offen offset:0 sc1
    buffer_load_dwordx4 v[48:51], v28, s[12:15], s90 offen offset:256 sc1
    buffer_load_dwordx4 v[52:55], v28, s[12:15], s91 offen offset:0 sc1
    buffer_load_dwordx4 v[56:59], v28, s[12:15], s91 offen offset:256 sc1
    buffer_load_dwordx4 v[60:63], v28, s[12:15], s92 offen offset:0 sc1
    buffer_load_dwordx4 v[64:67], v28, s[12:15], s92 offen offset:256 sc1
    s_waitcnt vmcnt(0)
    s_branch L_ha
L_haok:
    v_cvt_pk_bf16_f32 v6, v120, v121
    v_cvt_pk_bf16_f32 v124, v120, v121
    v_cvt_pk_bf16_f32 v125, v122, v123
    v_permlane16_swap_b32 v6, v126
    s_mov_b64 exec, s[94:95]
    s_cmp_lg_u32 s101, 0
    s_cbranch_scc1 L_hr
    buffer_store_dwordx4 v[124:127], v29, s[12:15], s68 offen nt
    s_branch L_hs
L_hr:
    buffer_store_dwordx4 v[124:127], v29, s[12:15], s68 offen sc1
L_hs:
    s_mov_b64 exec, -1
    buffer_load_dwordx4 v[36:39], v3, s[12:15], s69 offen offset:0 sc1
    buffer_load_dwordx4 v[40:43], v3, s[12:15], s69 offen offset:1024 sc1
    buffer_load_dwordx4 v[44:47], v3, s[12:15], s69 offen offset:2048 sc1
    buffer_load_dwordx4 v[48:51], v3, s[12:15], s69 offen offset:3072 sc1
    buffer_load_dwordx4 v[52:55], v3, s[12:15], s71 offen offset:0 sc1
    buffer_load_dwordx4 v[56:59], v3, s[12:15], s71 offen offset:1024 sc1
    buffer_load_dwordx4 v[60:63], v3, s[12:15], s71 offen offset:2048 sc1
    buffer_load_dwordx4 v[64:67], v3, s[12:15], s71 offen offset:3072 sc1
L_pe119:
    ds_read_b128 v[224:227], v26 offset:48
    s_waitcnt lgkmcnt(0)
    v_min_u32 v224, v224, v225
    v_min3_u32 v224, v224, v226, v227
    s_nop 0
    v_readfirstlane_b32 s3, v224
    s_nop 0
    s_cmp_ge_u32 s3, 19
    s_cbranch_scc1 L_pd119
    s_sleep 3
    s_branch L_pe119
L_pd119:
    s_waitcnt vmcnt(0)
L_hb:
    v_and_b32 v6, v39, v43
    v_or_b32 v7, v39, v43
    v_min3_u32 v6, v6, v47, v51
    v_max3_u32 v7, v7, v47, v51
    v_min3_u32 v6, v6, v55, v59
    v_max3_u32 v7, v7, v55, v59
    v_min3_u32 v6, v6, v63, v67
    v_max3_u32 v7, v7, v63, v67
    v_xor_b32 v6, v6, v18
    v_xor_b32 v7, v7, v18
    v_or_b32 v6, v6, v7
    v_cmp_ne_u32 vcc, 0, v6
    s_nop 0
    s_cmp_eq_u64 vcc, 0
    s_cbranch_scc1 L_hbok
    s_add_u32 s70, s70, 1
    s_cmp_ge_u32 s70, 200000
    s_cbranch_scc1 L_hbok
    s_sleep 2
    buffer_load_dwordx4 v[36:39], v3, s[12:15], s69 offen offset:0 sc1
    buffer_load_dwordx4 v[40:43], v3, s[12:15], s69 offen offset:1024 sc1
    buffer_load_dwordx4 v[44:47], v3, s[12:15], s69 offen offset:2048 sc1
    buffer_load_dwordx4 v[48:51], v3, s[12:15], s69 offen offset:3072 sc1
    buffer_load_dwordx4 v[52:55], v3, s[12:15], s71 offen offset:0 sc1
    buffer_load_dwordx4 v[56:59], v3, s[12:15], s71 offen offset:1024 sc1
    buffer_load_dwordx4 v[60:63], v3, s[12:15], s71 offen offset:2048 sc1
    buffer_load_dwordx4 v[64:67], v3, s[12:15], s71 offen offset:3072 sc1
    s_waitcnt vmcnt(0)
    s_branch L_hb
L_hbok:
    ds_write_b64 v30, v[36:37] offset:0
    ds_write_b64 v30, v[40:41] offset:8
    ds_write_b64 v30, v[44:45] offset:1024
    ds_write_b64 v30, v[48:49] offset:1032
    ds_write_b64 v30, v[52:53] offset:2048
    ds_write_b64 v30, v[56:57] offset:2056
    ds_write_b64 v30, v[60:61] offset:3072
    ds_write_b64 v30, v[64:65] offset:3080
    ds_write_b32 v31, v38 offset:0
    ds_write_b32 v31, v42 offset:32
    ds_write_b32 v31, v46 offset:4
    ds_write_b32 v31, v50 offset:36
    ds_write_b32 v31, v54 offset:64
    ds_write_b32 v31, v58 offset:96
    ds_write_b32 v31, v62 offset:68
    ds_write_b32 v31, v66 offset:100
    s_lshl_b32 s3, s38, 2
    s_add_u32 s3, s3, 163096
    v_mov_b32 v5, s3
    v_mov_b32 v6, 1
    ds_write_b32 v5, v6
    s_setprio 0
L_join2:
    v_lshrrev_b32 v5, 2, v1
    v_lshlrev_b32 v5, 10, v5
    v_and_b32 v6, 3, v1
    v_lshl_add_u32 v5, v6, 4, v5
    s_lshr_b32 s3, s2, 2
    s_lshl_b32 s3, s3, 14
    s_and_b32 s65, s2, 3
    s_lshl_b32 s65, s65, 6
    s_add_u32 s3, s3, s65
    s_add_u32 s3, s3, 6291456
    buffer_load_dwordx4 v[52:55], v5, s[12:15], s3 offen offset:0 sc1
    buffer_load_dwordx4 v[56:59], v5, s[12:15], s3 offen offset:512 sc1
    buffer_load_dwordx4 v[60:63], v5, s[12:15], s3 offen offset:256 sc1
    buffer_load_dwordx4 v[64:67], v5, s[12:15], s3 offen offset:768 sc1
    s_waitcnt vmcnt(4)
    s_lshl_b32 s3, s38, 2
    s_add_u32 s3, s3, 163216
    v_mov_b32 v5, s3
    v_mov_b32 v6, 1
    ds_write_b32 v5, v6
    s_waitcnt vmcnt(0)
L_gu:
    v_xor_b32 v6, v53, v18
    v_xor_b32 v7, v55, v18
    v_or_b32 v6, v6, v7
    v_xor_b32 v7, v57, v18
    v_or_b32 v6, v6, v7
    v_xor_b32 v7, v59, v18
    v_or_b32 v6, v6, v7
    v_xor_b32 v7, v61, v18
    v_or_b32 v6, v6, v7
    v_xor_b32 v7, v63, v18
    v_or_b32 v6, v6, v7
    v_xor_b32 v7, v65, v18
    v_or_b32 v6, v6, v7
    v_xor_b32 v7, v67, v18
    v_or_b32 v6, v6, v7
    v_cmp_ne_u32 vcc, 0, v6
    s_nop 0
    s_cmp_eq_u64 vcc, 0
    s_cbranch_scc1 L_guok
    s_add_u32 s70, s70, 1
    s_cmp_ge_u32 s70, 200000
    s_cbranch_scc1 L_guok
    s_sleep 8
    v_lshrrev_b32 v5, 2, v1
    v_lshlrev_b32 v5, 10, v5
    v_and_b32 v6, 3, v1
    v_lshl_add_u32 v5, v6, 4, v5
    s_lshr_b32 s3, s2, 2
    s_lshl_b32 s3, s3, 14
    s_and_b32 s65, s2, 3
    s_lshl_b32 s65, s65, 6
    s_add_u32 s3, s3, s65
    s_add_u32 s3, s3, 6291456
    buffer_load_dwordx4 v[52:55], v5, s[12:15], s3 offen offset:0 sc1
    buffer_load_dwordx4 v[56:59], v5, s[12:15], s3 offen offset:512 sc1
    buffer_load_dwordx4 v[60:63], v5, s[12:15], s3 offen offset:256 sc1
    buffer_load_dwordx4 v[64:67], v5, s[12:15], s3 offen offset:768 sc1
    s_waitcnt vmcnt(0)
    s_branch L_gu
L_guok:
    v_permlane32_swap_b32 v52, v56
    v_permlane32_swap_b32 v54, v58
    v_permlane32_swap_b32 v60, v64
    v_permlane32_swap_b32 v62, v66
    v_add_f32 v52, v52, v56
    v_add_f32 v54, v54, v58
    v_add_f32 v60, v60, v64
    v_add_f32 v62, v62, v66
    v_permlane16_swap_b32 v52, v54
    s_nop 0
    v_permlane16_swap_b32 v60, v62
    v_add_f32 v52, v52, v54
    v_add_f32 v60, v60, v62
    s_nop 0
    v_add_f32 v52, v52, v52 row_ror:4 row_mask:0xf bank_mask:0xf
    v_add_f32 v60, v60, v60 row_ror:4 row_mask:0xf bank_mask:0xf
    s_nop 0
    v_add_f32 v52, v52, v52 row_ror:8 row_mask:0xf bank_mask:0xf
    v_add_f32 v60, v60, v60 row_ror:8 row_mask:0xf bank_mask:0xf
    v_cvt_pk_bf16_f32 v52, v52, v52
    v_lshlrev_b32 v52, 16, v52
    v_cvt_pk_bf16_f32 v60, v60, v60
    v_lshlrev_b32 v60, 16, v60
    v_mul_f32 v53, 0xbfb8aa3b, v52
    v_exp_f32 v53, v53
    s_nop 0
    v_add_f32 v53, 1.0, v53
    v_rcp_f32 v53, v53
    s_nop 0
    v_mul_f32 v52, v52, v53
    v_cvt_pk_bf16_f32 v52, v52, v52
    v_lshlrev_b32 v52, 16, v52
    v_mul_f32 v52, v52, v60
    v_cvt_pk_bf16_f32 v52, v52, v52
    s_nop 1
    v_mov_b32 v80, v52 quad_perm:[0,0,0,0] row_mask:0xf bank_mask:0xf
    v_mov_b32 v81, v52 quad_perm:[1,1,1,1] row_mask:0xf bank_mask:0xf
    v_mov_b32 v82, v52 quad_perm:[2,2,2,2] row_mask:0xf bank_mask:0xf
    v_mov_b32 v83, v52 quad_perm:[3,3,3,3] row_mask:0xf bank_mask:0xf
    s_waitcnt lgkmcnt(0)
    v_and_b32 v92, v80, v88
    v_and_b32 v93, v80, v89
    v_and_b32 v94, v80, v90
    v_and_b32 v95, v80, v91
    s_nop 1
    v_mfma_f32_16x16x32_bf16 v[100:103], v[92:95], v[192:195], 0
    v_mfma_f32_16x16x32_bf16 v[104:107], v[92:95], v[196:199], 0
    v_and_b32 v96, v81, v88
    v_and_b32 v97, v81, v89
    v_and_b32 v98, v81, v90
    v_and_b32 v99, v81, v91
    s_nop 1
    v_mfma_f32_16x16x32_bf16 v[100:103], v[96:99], v[200:203], v[100:103]
    v_mfma_f32_16x16x32_bf16 v[104:107], v[96:99], v[204:207], v[104:107]
    v_and_b32 v92, v82, v88
    v_and_b32 v93, v82, v89
    v_and_b32 v94, v82, v90
    v_and_b32 v95, v82, v91
    s_nop 1
    v_mfma_f32_16x16x32_bf16 v[100:103], v[92:95], v[208:211], v[100:103]
    v_mfma_f32_16x16x32_bf16 v[104:107], v[92:95], v[212:215], v[104:107]
    v_and_b32 v96, v83, v88
    v_and_b32 v97, v83, v89
    v_and_b32 v98, v83, v90
    v_and_b32 v99, v83, v91
    s_nop 1
    v_mfma_f32_16x16x32_bf16 v[100:103], v[96:99], v[216:219], v[100:103]
    v_mfma_f32_16x16x32_bf16 v[104:107], v[96:99], v[220:223], v[104:107]
    v_and_b32 v5, 15, v1
    v_lshlrev_b32 v5, 5, v5
    v_bfe_u32 v6, v1, 4, 1
    v_lshl_add_u32 v5, v6, 4, v5
    v_lshrrev_b32 v6, 5, v1
    v_lshl_add_u32 v5, v6, 9, v5
    v_cmp_eq_u32 vcc, 0, v6
    s_lshl_b32 s3, s2, 12
    s_lshl_b32 s65, s38, 10
    s_add_u32 s3, s3, s65
    s_add_u32 s3, s3, 8388608
    v_cndmask_b32 v100, v104, v100, vcc
    v_cndmask_b32 v101, v105, v101, vcc
    v_cndmask_b32 v102, v106, v102, vcc
    v_cndmask_b32 v103, v107, v103, vcc
    v_mov_b32 v28, v18
    v_lshrrev_b32 v29, 8, v18
    v_lshrrev_b32 v30, 16, v18
    v_lshrrev_b32 v31, 24, v18
    v_mov_b32 v6, 0xff
    v_bfi_b32 v100, v6, v28, v100
    v_bfi_b32 v101, v6, v29, v101
    v_bfi_b32 v102, v6, v30, v102
    v_bfi_b32 v103, v6, v31, v103
    s_cmp_ge_u32 s2, 224
    s_cbranch_scc1 L_noy
    buffer_store_dwordx4 v[100:103], v5, s[12:15], s3 offen sc1
L_noy:
    s_lshl_b32 s3, s38, 7
    s_add_u32 s3, s3, 161280
    v_lshl_add_u32 v6, v249, 2, s3
    ds_read_b32 v112, v6 offset:0
    ds_read_b32 v120, v6 offset:512
    ds_read_b32 v114, v6 offset:32
    ds_read_b32 v122, v6 offset:544
    ds_read_b32 v116, v6 offset:64
    ds_read_b32 v124, v6 offset:576
    ds_read_b32 v118, v6 offset:96
    ds_read_b32 v126, v6 offset:608
    s_mul_i32 s3, s38, 4608
    s_add_u32 s3, s3, 131072
    v_mul_u32_u24 v6, 144, v249
    v_lshl_add_u32 v6, v250, 4, v6
    v_add_u32 v15, s3, v6
    s_mov_b32 s71, 0xbfb8aa3b
    s_waitcnt lgkmcnt(0)
    v_lshlrev_b32 v36, 16, v232
    v_and_b32 v37, 0xffff0000, v232
    v_lshlrev_b32 v38, 16, v233
    v_and_b32 v39, 0xffff0000, v233
    v_lshlrev_b32 v40, 16, v234
    v_and_b32 v41, 0xffff0000, v234
    v_lshlrev_b32 v42, 16, v235
    v_and_b32 v43, 0xffff0000, v235
    v_lshlrev_b32 v44, 16, v236
    v_and_b32 v45, 0xffff0000, v236
    v_lshlrev_b32 v46, 16, v237
    v_and_b32 v47, 0xffff0000, v237
    v_lshlrev_b32 v48, 16, v238
    v_and_b32 v49, 0xffff0000, v238
    v_lshlrev_b32 v50, 16, v239
    v_and_b32 v51, 0xffff0000, v239
    v_lshlrev_b32 v52, 16, v240
    v_and_b32 v53, 0xffff0000, v240
    v_lshlrev_b32 v54, 16, v241
    v_and_b32 v55, 0xffff0000, v241
    v_lshlrev_b32 v56, 16, v242
    v_and_b32 v57, 0xffff0000, v242
    v_lshlrev_b32 v58, 16, v243
    v_and_b32 v59, 0xffff0000, v243
    v_lshlrev_b32 v60, 16, v244
    v_and_b32 v61, 0xffff0000, v244
    v_lshlrev_b32 v62, 16, v245
    v_and_b32 v63, 0xffff0000, v245
    v_lshlrev_b32 v64, 16, v246
    v_and_b32 v65, 0xffff0000, v246
    v_lshlrev_b32 v66, 16, v247
    v_and_b32 v67, 0xffff0000, v247
    v_pk_add_f32 v[68:69], v[36:37], v[112:113] op_sel_hi:[1,0] neg_lo:[0,1] neg_hi:[0,1]
    v_pk_add_f32 v[70:71], v[38:39], v[112:113] op_sel_hi:[1,0] neg_lo:[0,1] neg_hi:[0,1]
    v_pk_add_f32 v[72:73], v[40:41], v[112:113] op_sel_hi:[1,0] neg_lo:[0,1] neg_hi:[0,1]
    v_pk_add_f32 v[74:75], v[42:43], v[112:113] op_sel_hi:[1,0] neg_lo:[0,1] neg_hi:[0,1]
    v_pk_add_f32 v[76:77], v[44:45], v[114:115] op_sel_hi:[1,0] neg_lo:[0,1] neg_hi:[0,1]
    v_pk_add_f32 v[78:79], v[46:47], v[114:115] op_sel_hi:[1,0] neg_lo:[0,1] neg_hi:[0,1]
    v_pk_add_f32 v[80:81], v[48:49], v[114:115] op_sel_hi:[1,0] neg_lo:[0,1] neg_hi:[0,1]
    v_pk_add_f32 v[82:83], v[50:51], v[114:115] op_sel_hi:[1,0] neg_lo:[0,1] neg_hi:[0,1]
    v_pk_add_f32 v[84:85], v[52:53], v[116:117] op_sel_hi:[1,0] neg_lo:[0,1] neg_hi:[0,1]
    v_pk_add_f32 v[86:87], v[54:55], v[116:117] op_sel_hi:[1,0] neg_lo:[0,1] neg_hi:[0,1]
    v_pk_add_f32 v[88:89], v[56:57], v[116:117] op_sel_hi:[1,0] neg_lo:[0,1] neg_hi:[0,1]
    v_pk_add_f32 v[90:91], v[58:59], v[116:117] op_sel_hi:[1,0] neg_lo:[0,1] neg_hi:[0,1]
    v_pk_add_f32 v[92:93], v[60:61], v[118:119] op_sel_hi:[1,0] neg_lo:[0,1] neg_hi:[0,1]
    v_pk_add_f32 v[94:95], v[62:63], v[118:119] op_sel_hi:[1,0] neg_lo:[0,1] neg_hi:[0,1]
    v_pk_add_f32 v[96:97], v[64:65], v[118:119] op_sel_hi:[1,0] neg_lo:[0,1] neg_hi:[0,1]
    v_pk_add_f32 v[98:99], v[66:67], v[118:119] op_sel_hi:[1,0] neg_lo:[0,1] neg_hi:[0,1]
    v_cvt_pk_bf16_f32 v192, v68, v69
    v_cvt_pk_bf16_f32 v193, v70, v71
    v_cvt_pk_bf16_f32 v194, v72, v73
    v_cvt_pk_bf16_f32 v195, v74, v75
    v_cvt_pk_bf16_f32 v196, v76, v77
    v_cvt_pk_bf16_f32 v197, v78, v79
    v_cvt_pk_bf16_f32 v198, v80, v81
    v_cvt_pk_bf16_f32 v199, v82, v83
    v_cvt_pk_bf16_f32 v200, v84, v85
    v_cvt_pk_bf16_f32 v201, v86, v87
    v_cvt_pk_bf16_f32 v202, v88, v89
    v_cvt_pk_bf16_f32 v203, v90, v91
    v_cvt_pk_bf16_f32 v204, v92, v93
    v_cvt_pk_bf16_f32 v205, v94, v95
    v_cvt_pk_bf16_f32 v206, v96, v97
    v_cvt_pk_bf16_f32 v207, v98, v99
    v_lshlrev_b32 v68, 16, v192
    v_and_b32 v69, 0xffff0000, v192
    v_lshlrev_b32 v70, 16, v193
    v_and_b32 v71, 0xffff0000, v193
    v_lshlrev_b32 v72, 16, v194
    v_and_b32 v73, 0xffff0000, v194
    v_lshlrev_b32 v74, 16, v195
    v_and_b32 v75, 0xffff0000, v195
    v_lshlrev_b32 v76, 16, v196
    v_and_b32 v77, 0xffff0000, v196
    v_lshlrev_b32 v78, 16, v197
    v_and_b32 v79, 0xffff0000, v197
    v_lshlrev_b32 v80, 16, v198
    v_and_b32 v81, 0xffff0000, v198
    v_lshlrev_b32 v82, 16, v199
    v_and_b32 v83, 0xffff0000, v199
    v_lshlrev_b32 v84, 16, v200
    v_and_b32 v85, 0xffff0000, v200
    v_lshlrev_b32 v86, 16, v201
    v_and_b32 v87, 0xffff0000, v201
    v_lshlrev_b32 v88, 16, v202
    v_and_b32 v89, 0xffff0000, v202
    v_lshlrev_b32 v90, 16, v203
    v_and_b32 v91, 0xffff0000, v203
    v_lshlrev_b32 v92, 16, v204
    v_and_b32 v93, 0xffff0000, v204
    v_lshlrev_b32 v94, 16, v205
    v_and_b32 v95, 0xffff0000, v205
    v_lshlrev_b32 v96, 16, v206
    v_and_b32 v97, 0xffff0000, v206
    v_lshlrev_b32 v98, 16, v207
    v_and_b32 v99, 0xffff0000, v207
    v_pk_mul_f32 v[68:69], v[68:69], v[120:121] op_sel_hi:[1,0]
    v_pk_mul_f32 v[70:71], v[70:71], v[120:121] op_sel_hi:[1,0]
    v_pk_mul_f32 v[72:73], v[72:73], v[120:121] op_sel_hi:[1,0]
    v_pk_mul_f32 v[74:75], v[74:75], v[120:121] op_sel_hi:[1,0]
    v_pk_mul_f32 v[76:77], v[76:77], v[122:123] op_sel_hi:[1,0]
    v_pk_mul_f32 v[78:79], v[78:79], v[122:123] op_sel_hi:[1,0]
    v_pk_mul_f32 v[80:81], v[80:81], v[122:123] op_sel_hi:[1,0]
    v_pk_mul_f32 v[82:83], v[82:83], v[122:123] op_sel_hi:[1,0]
    v_pk_mul_f32 v[84:85], v[84:85], v[124:125] op_sel_hi:[1,0]
    v_pk_mul_f32 v[86:87], v[86:87], v[124:125] op_sel_hi:[1,0]
    v_pk_mul_f32 v[88:89], v[88:89], v[124:125] op_sel_hi:[1,0]
    v_pk_mul_f32 v[90:91], v[90:91], v[124:125] op_sel_hi:[1,0]
    v_pk_mul_f32 v[92:93], v[92:93], v[126:127] op_sel_hi:[1,0]
    v_pk_mul_f32 v[94:95], v[94:95], v[126:127] op_sel_hi:[1,0]
    v_pk_mul_f32 v[96:97], v[96:97], v[126:127] op_sel_hi:[1,0]
    v_pk_mul_f32 v[98:99], v[98:99], v[126:127] op_sel_hi:[1,0]
    v_cvt_pk_bf16_f32 v192, v68, v69
    v_cvt_pk_bf16_f32 v193, v70, v71
    v_cvt_pk_bf16_f32 v194, v72, v73
    v_cvt_pk_bf16_f32 v195, v74, v75
    v_cvt_pk_bf16_f32 v196, v76, v77
    v_cvt_pk_bf16_f32 v197, v78, v79
    v_cvt_pk_bf16_f32 v198, v80, v81
    v_cvt_pk_bf16_f32 v199, v82, v83
    v_cvt_pk_bf16_f32 v200, v84, v85
    v_cvt_pk_bf16_f32 v201, v86, v87
    v_cvt_pk_bf16_f32 v202, v88, v89
    v_cvt_pk_bf16_f32 v203, v90, v91
    v_cvt_pk_bf16_f32 v204, v92, v93
    v_cvt_pk_bf16_f32 v205, v94, v95
    v_cvt_pk_bf16_f32 v206, v96, v97
    v_cvt_pk_bf16_f32 v207, v98, v99
    v_lshlrev_b32 v68, 16, v192
    v_and_b32 v69, 0xffff0000, v192
    v_lshlrev_b32 v70, 16, v193
    v_and_b32 v71, 0xffff0000, v193
    v_lshlrev_b32 v72, 16, v194
    v_and_b32 v73, 0xffff0000, v194
    v_lshlrev_b32 v74, 16, v195
    v_and_b32 v75, 0xffff0000, v195
    v_lshlrev_b32 v76, 16, v196
    v_and_b32 v77, 0xffff0000, v196
    v_lshlrev_b32 v78, 16, v197
    v_and_b32 v79, 0xffff0000, v197
    v_lshlrev_b32 v80, 16, v198
    v_and_b32 v81, 0xffff0000, v198
    v_lshlrev_b32 v82, 16, v199
    v_and_b32 v83, 0xffff0000, v199
    v_lshlrev_b32 v84, 16, v200
    v_and_b32 v85, 0xffff0000, v200
    v_lshlrev_b32 v86, 16, v201
    v_and_b32 v87, 0xffff0000, v201
    v_lshlrev_b32 v88, 16, v202
    v_and_b32 v89, 0xffff0000, v202
    v_lshlrev_b32 v90, 16, v203
    v_and_b32 v91, 0xffff0000, v203
    v_lshlrev_b32 v92, 16, v204
    v_and_b32 v93, 0xffff0000, v204
    v_lshlrev_b32 v94, 16, v205
    v_and_b32 v95, 0xffff0000, v205
    v_lshlrev_b32 v96, 16, v206
    v_and_b32 v97, 0xffff0000, v206
    v_lshlrev_b32 v98, 16, v207
    v_and_b32 v99, 0xffff0000, v207
    v_mul_f32 v192, s71, v68
    v_mul_f32 v193, s71, v69
    v_mul_f32 v194, s71, v70
    v_mul_f32 v195, s71, v71
    v_mul_f32 v196, s71, v72
    v_mul_f32 v197, s71, v73
    v_mul_f32 v198, s71, v74
    v_mul_f32 v199, s71, v75
    v_mul_f32 v200, s71, v76
    v_mul_f32 v201, s71, v77
    v_mul_f32 v202, s71, v78
    v_mul_f32 v203, s71, v79
    v_mul_f32 v204, s71, v80
    v_mul_f32 v205, s71, v81
    v_mul_f32 v206, s71, v82
    v_mul_f32 v207, s71, v83
    v_mul_f32 v208, s71, v84
    v_mul_f32 v209, s71, v85
    v_mul_f32 v210, s71, v86
    v_mul_f32 v211, s71, v87
    v_mul_f32 v212, s71, v88
    v_mul_f32 v213, s71, v89
    v_mul_f32 v214, s71, v90
    v_mul_f32 v215, s71, v91
    v_mul_f32 v216, s71, v92
    v_mul_f32 v217, s71, v93
    v_mul_f32 v218, s71, v94
    v_mul_f32 v219, s71, v95
    v_mul_f32 v220, s71, v96
    v_mul_f32 v221, s71, v97
    v_mul_f32 v222, s71, v98
    v_mul_f32 v223, s71, v99
    v_exp_f32 v192, v192
    v_exp_f32 v193, v193
    v_exp_f32 v194, v194
    v_exp_f32 v195, v195
    v_exp_f32 v196, v196
    v_exp_f32 v197, v197
    v_exp_f32 v198, v198
    v_exp_f32 v199, v199
    v_exp_f32 v200, v200
    v_exp_f32 v201, v201
    v_exp_f32 v202, v202
    v_exp_f32 v203, v203
    v_exp_f32 v204, v204
    v_exp_f32 v205, v205
    v_exp_f32 v206, v206
    v_exp_f32 v207, v207
    v_exp_f32 v208, v208
    v_exp_f32 v209, v209
    v_exp_f32 v210, v210
    v_exp_f32 v211, v211
    v_exp_f32 v212, v212
    v_exp_f32 v213, v213
    v_exp_f32 v214, v214
    v_exp_f32 v215, v215
    v_exp_f32 v216, v216
    v_exp_f32 v217, v217
    v_exp_f32 v218, v218
    v_exp_f32 v219, v219
    v_exp_f32 v220, v220
    v_exp_f32 v221, v221
    v_exp_f32 v222, v222
    v_exp_f32 v223, v223
    v_add_f32 v192, 1.0, v192
    v_add_f32 v193, 1.0, v193
    v_add_f32 v194, 1.0, v194
    v_add_f32 v195, 1.0, v195
    v_add_f32 v196, 1.0, v196
    v_add_f32 v197, 1.0, v197
    v_add_f32 v198, 1.0, v198
    v_add_f32 v199, 1.0, v199
    v_add_f32 v200, 1.0, v200
    v_add_f32 v201, 1.0, v201
    v_add_f32 v202, 1.0, v202
    v_add_f32 v203, 1.0, v203
    v_add_f32 v204, 1.0, v204
    v_add_f32 v205, 1.0, v205
    v_add_f32 v206, 1.0, v206
    v_add_f32 v207, 1.0, v207
    v_add_f32 v208, 1.0, v208
    v_add_f32 v209, 1.0, v209
    v_add_f32 v210, 1.0, v210
    v_add_f32 v211, 1.0, v211
    v_add_f32 v212, 1.0, v212
    v_add_f32 v213, 1.0, v213
    v_add_f32 v214, 1.0, v214
    v_add_f32 v215, 1.0, v215
    v_add_f32 v216, 1.0, v216
    v_add_f32 v217, 1.0, v217
    v_add_f32 v218, 1.0, v218
    v_add_f32 v219, 1.0, v219
    v_add_f32 v220, 1.0, v220
    v_add_f32 v221, 1.0, v221
    v_add_f32 v222, 1.0, v222
    v_add_f32 v223, 1.0, v223
    v_rcp_f32 v192, v192
    v_rcp_f32 v193, v193
    v_rcp_f32 v194, v194
    v_rcp_f32 v195, v195
    v_rcp_f32 v196, v196
    v_rcp_f32 v197, v197
    v_rcp_f32 v198, v198
    v_rcp_f32 v199, v199
    v_rcp_f32 v200, v200
    v_rcp_f32 v201, v201
    v_rcp_f32 v202, v202
    v_rcp_f32 v203, v203
    v_rcp_f32 v204, v204
    v_rcp_f32 v205, v205
    v_rcp_f32 v206, v206
    v_rcp_f32 v207, v207
    v_rcp_f32 v208, v208
    v_rcp_f32 v209, v209
    v_rcp_f32 v210, v210
    v_rcp_f32 v211, v211
    v_rcp_f32 v212, v212
    v_rcp_f32 v213, v213
    v_rcp_f32 v214, v214
    v_rcp_f32 v215, v215
    v_rcp_f32 v216, v216
    v_rcp_f32 v217, v217
    v_rcp_f32 v218, v218
    v_rcp_f32 v219, v219
    v_rcp_f32 v220, v220
    v_rcp_f32 v221, v221
    v_rcp_f32 v222, v222
    v_rcp_f32 v223, v223
    v_pk_mul_f32 v[68:69], v[68:69], v[192:193]
    v_pk_mul_f32 v[70:71], v[70:71], v[194:195]
    v_pk_mul_f32 v[72:73], v[72:73], v[196:197]
    v_pk_mul_f32 v[74:75], v[74:75], v[198:199]
    v_pk_mul_f32 v[76:77], v[76:77], v[200:201]
    v_pk_mul_f32 v[78:79], v[78:79], v[202:203]
    v_pk_mul_f32 v[80:81], v[80:81], v[204:205]
    v_pk_mul_f32 v[82:83], v[82:83], v[206:207]
    v_pk_mul_f32 v[84:85], v[84:85], v[208:209]
    v_pk_mul_f32 v[86:87], v[86:87], v[210:211]
    v_pk_mul_f32 v[88:89], v[88:89], v[212:213]
    v_pk_mul_f32 v[90:91], v[90:91], v[214:215]
    v_pk_mul_f32 v[92:93], v[92:93], v[216:217]
    v_pk_mul_f32 v[94:95], v[94:95], v[218:219]
    v_pk_mul_f32 v[96:97], v[96:97], v[220:221]
    v_pk_mul_f32 v[98:99], v[98:99], v[222:223]
    s_cmp_eq_u32 s35, 0
    s_cbranch_scc1 L_fin
    s_lshl_b32 s65, s38, 2
    v_lshrrev_b32 v5, 4, v1
    v_add_u32 v5, s65, v5
    v_lshlrev_b32 v5, 12, v5
    v_and_b32 v6, 15, v1
    v_lshl_add_u32 v11, v6, 4, v5
    v_mov_b32 v5, 163104
L_yg:
    ds_read_b32 v6, v5 offset:100
    s_waitcnt lgkmcnt(0)
    v_readfirstlane_b32 s3, v6
    s_nop 0
    s_cmp_eq_u32 s3, 1
    s_cbranch_scc1 L_ygd
    s_sleep 2
    s_branch L_yg
L_ygd:
    s_lshl_b32 s3, s31, 8
    s_add_u32 s3, s3, 8388608
    buffer_load_dwordx4 v[128:131], v11, s[12:15], s3 offen sc1
    s_add_u32 s3, s3, 65536
    buffer_load_dwordx4 v[132:135], v11, s[12:15], s3 offen sc1
    s_add_u32 s3, s3, 65536
    buffer_load_dwordx4 v[136:139], v11, s[12:15], s3 offen sc1
    s_add_u32 s3, s3, 65536
    buffer_load_dwordx4 v[140:143], v11, s[12:15], s3 offen sc1
    s_add_u32 s3, s3, 65536
    buffer_load_dwordx4 v[144:147], v11, s[12:15], s3 offen sc1
    s_add_u32 s3, s3, 65536
    buffer_load_dwordx4 v[148:151], v11, s[12:15], s3 offen sc1
    s_add_u32 s3, s3, 65536
    buffer_load_dwordx4 v[152:155], v11, s[12:15], s3 offen sc1
    s_add_u32 s3, s3, 65536
    buffer_load_dwordx4 v[156:159], v11, s[12:15], s3 offen sc1
    s_add_u32 s3, s3, 65536
    buffer_load_dwordx4 v[160:163], v11, s[12:15], s3 offen sc1
    s_add_u32 s3, s3, 65536
    buffer_load_dwordx4 v[164:167], v11, s[12:15], s3 offen sc1
    s_add_u32 s3, s3, 65536
    buffer_load_dwordx4 v[168:171], v11, s[12:15], s3 offen sc1
    s_add_u32 s3, s3, 65536
    buffer_load_dwordx4 v[172:175], v11, s[12:15], s3 offen sc1
    s_add_u32 s3, s3, 65536
    buffer_load_dwordx4 v[176:179], v11, s[12:15], s3 offen sc1
    s_add_u32 s3, s3, 65536
    buffer_load_dwordx4 v[180:183], v11, s[12:15], s3 offen sc1
    s_lshl_b32 s68, s34, 11
    s_lshl_b32 s3, s31, 7
    s_add_u32 s68, s68, s3
    v_lshlrev_b32 v7, 1, v1
    buffer_load_ushort v8, v7, s[4:7], s68 offen
    s_and_b32 s3, s33, 0xfffff800
    s_xor_b32 s65, s3, 0x80000000
    s_not_b32 s66, s3
    s_and_b32 s66, s66, 0xfffff800
    s_bitcmp1_b32 s3, 31
    s_cselect_b32 s3, s65, s66
    v_mov_b32 v5, s3
    v_cvt_pk_bf16_f32 v5, v5, v5
    v_lshlrev_b32 v5, 16, v5
    v_mul_f32 v5, 0xbfb8aa3b, v5
    v_exp_f32 v5, v5
    s_nop 0
    v_add_f32 v5, 1.0, v5
    v_rcp_f32 v5, v5
    s_nop 0
    v_cvt_pk_bf16_f32 v5, v5, v5
    v_lshlrev_b32 v5, 16, v5
    s_lshl_b32 s65, s64, 16
    s_and_b32 s66, s64, 0xffff0000
    v_rcp_f32 v10, s66
    s_nop 0
    v_fma_f32 v4, -v10, s66, 1.0
    v_fmac_f32 v10, v4, v10
    s_waitcnt vmcnt(0)
L_yf:
    v_and_b32 v184, v128, v132
    v_or_b32 v188, v128, v132
    v_and_b32 v185, v129, v133
    v_or_b32 v189, v129, v133
    v_and_b32 v186, v130, v134
    v_or_b32 v190, v130, v134
    v_and_b32 v187, v131, v135
    v_or_b32 v191, v131, v135
    v_bitop3_b32 v184, v184, v136, v140 bitop3:0x80
    v_or3_b32 v188, v188, v136, v140
    v_bitop3_b32 v185, v185, v137, v141 bitop3:0x80
    v_or3_b32 v189, v189, v137, v141
    v_bitop3_b32 v186, v186, v138, v142 bitop3:0x80
    v_or3_b32 v190, v190, v138, v142
    v_bitop3_b32 v187, v187, v139, v143 bitop3:0x80
    v_or3_b32 v191, v191, v139, v143
    v_bitop3_b32 v184, v184, v144, v148 bitop3:0x80
    v_or3_b32 v188, v188, v144, v148
    v_bitop3_b32 v185, v185, v145, v149 bitop3:0x80
    v_or3_b32 v189, v189, v145, v149
    v_bitop3_b32 v186, v186, v146, v150 bitop3:0x80
    v_or3_b32 v190, v190, v146, v150
    v_bitop3_b32 v187, v187, v147, v151 bitop3:0x80
    v_or3_b32 v191, v191, v147, v151
    v_bitop3_b32 v184, v184, v152, v156 bitop3:0x80
    v_or3_b32 v188, v188, v152, v156
    v_bitop3_b32 v185, v185, v153, v157 bitop3:0x80
    v_or3_b32 v189, v189, v153, v157
    v_bitop3_b32 v186, v186, v154, v158 bitop3:0x80
    v_or3_b32 v190, v190, v154, v158
    v_bitop3_b32 v187, v187, v155, v159 bitop3:0x80
    v_or3_b32 v191, v191, v155, v159
    v_bitop3_b32 v184, v184, v160, v164 bitop3:0x80
    v_or3_b32 v188, v188, v160, v164
    v_bitop3_b32 v185, v185, v161, v165 bitop3:0x80
    v_or3_b32 v189, v189, v161, v165
    v_bitop3_b32 v186, v186, v162, v166 bitop3:0x80
    v_or3_b32 v190, v190, v162, v166
    v_bitop3_b32 v187, v187, v163, v167 bitop3:0x80
    v_or3_b32 v191, v191, v163, v167
    v_bitop3_b32 v184, v184, v168, v172 bitop3:0x80
    v_or3_b32 v188, v188, v168, v172
    v_bitop3_b32 v185, v185, v169, v173 bitop3:0x80
    v_or3_b32 v189, v189, v169, v173
    v_bitop3_b32 v186, v186, v170, v174 bitop3:0x80
    v_or3_b32 v190, v190, v170, v174
    v_bitop3_b32 v187, v187, v171, v175 bitop3:0x80
    v_or3_b32 v191, v191, v171, v175
    v_bitop3_b32 v184, v184, v176, v180 bitop3:0x80
    v_or3_b32 v188, v188, v176, v180
    v_bitop3_b32 v185, v185, v177, v181 bitop3:0x80
    v_or3_b32 v189, v189, v177, v181
    v_bitop3_b32 v186, v186, v178, v182 bitop3:0x80
    v_or3_b32 v190, v190, v178, v182
    v_bitop3_b32 v187, v187, v179, v183 bitop3:0x80
    v_or3_b32 v191, v191, v179, v183
    v_xor_b32 v184, v184, v28
    v_xor_b32 v188, v188, v28
    v_xor_b32 v185, v185, v29
    v_xor_b32 v189, v189, v29
    v_xor_b32 v186, v186, v30
    v_xor_b32 v190, v190, v30
    v_xor_b32 v187, v187, v31
    v_xor_b32 v191, v191, v31
    v_or3_b32 v6, v184, v185, v186
    v_or3_b32 v6, v6, v187, v188
    v_or3_b32 v6, v6, v189, v190
    v_or_b32 v6, v6, v191
    v_and_b32 v6, 0xff, v6
    v_cmp_ne_u32 vcc, 0, v6
    s_nop 0
    s_cmp_eq_u64 vcc, 0
    s_cbranch_scc1 L_yfok
    s_add_u32 s70, s70, 1
    s_cmp_ge_u32 s70, 200000
    s_cbranch_scc1 L_yfok
    s_sleep 16
    s_lshl_b32 s3, s31, 8
    s_add_u32 s3, s3, 8388608
    buffer_load_dwordx4 v[128:131], v11, s[12:15], s3 offen sc1
    s_add_u32 s3, s3, 65536
    buffer_load_dwordx4 v[132:135], v11, s[12:15], s3 offen sc1
    s_add_u32 s3, s3, 65536
    buffer_load_dwordx4 v[136:139], v11, s[12:15], s3 offen sc1
    s_add_u32 s3, s3, 65536
    buffer_load_dwordx4 v[140:143], v11, s[12:15], s3 offen sc1
    s_add_u32 s3, s3, 65536
    buffer_load_dwordx4 v[144:147], v11, s[12:15], s3 offen sc1
    s_add_u32 s3, s3, 65536
    buffer_load_dwordx4 v[148:151], v11, s[12:15], s3 offen sc1
    s_add_u32 s3, s3, 65536
    buffer_load_dwordx4 v[152:155], v11, s[12:15], s3 offen sc1
    s_add_u32 s3, s3, 65536
    buffer_load_dwordx4 v[156:159], v11, s[12:15], s3 offen sc1
    s_add_u32 s3, s3, 65536
    buffer_load_dwordx4 v[160:163], v11, s[12:15], s3 offen sc1
    s_add_u32 s3, s3, 65536
    buffer_load_dwordx4 v[164:167], v11, s[12:15], s3 offen sc1
    s_add_u32 s3, s3, 65536
    buffer_load_dwordx4 v[168:171], v11, s[12:15], s3 offen sc1
    s_add_u32 s3, s3, 65536
    buffer_load_dwordx4 v[172:175], v11, s[12:15], s3 offen sc1
    s_add_u32 s3, s3, 65536
    buffer_load_dwordx4 v[176:179], v11, s[12:15], s3 offen sc1
    s_add_u32 s3, s3, 65536
    buffer_load_dwordx4 v[180:183], v11, s[12:15], s3 offen sc1
    s_waitcnt vmcnt(0)
    s_branch L_yf
L_yfok:
    v_and_b32 v6, 15, v1
    s_mov_b32 s3, 0xffffff00
    v_and_b32 v128, s3, v128
    v_and_b32 v129, s3, v129
    v_and_b32 v130, s3, v130
    v_and_b32 v131, s3, v131
    v_and_b32 v132, s3, v132
    v_and_b32 v133, s3, v133
    v_and_b32 v134, s3, v134
    v_and_b32 v135, s3, v135
    v_and_b32 v136, s3, v136
    v_and_b32 v137, s3, v137
    v_and_b32 v138, s3, v138
    v_and_b32 v139, s3, v139
    v_and_b32 v140, s3, v140
    v_and_b32 v141, s3, v141
    v_and_b32 v142, s3, v142
    v_and_b32 v143, s3, v143
    v_and_b32 v144, s3, v144
    v_and_b32 v145, s3, v145
    v_and_b32 v146, s3, v146
    v_and_b32 v147, s3, v147
    v_and_b32 v148, s3, v148
    v_and_b32 v149, s3, v149
    v_and_b32 v150, s3, v150
    v_and_b32 v151, s3, v151
    v_and_b32 v152, s3, v152
    v_and_b32 v153, s3, v153
    v_and_b32 v154, s3, v154
    v_and_b32 v155, s3, v155
    v_and_b32 v156, s3, v156
    v_and_b32 v157, s3, v157
    v_and_b32 v158, s3, v158
    v_and_b32 v159, s3, v159
    v_and_b32 v160, s3, v160
    v_and_b32 v161, s3, v161
    v_and_b32 v162, s3, v162
    v_and_b32 v163, s3, v163
    v_and_b32 v164, s3, v164
    v_and_b32 v165, s3, v165
    v_and_b32 v166, s3, v166
    v_and_b32 v167, s3, v167
    v_and_b32 v168, s3, v168
    v_and_b32 v169, s3, v169
    v_and_b32 v170, s3, v170
    v_and_b32 v171, s3, v171
    v_and_b32 v172, s3, v172
    v_and_b32 v173, s3, v173
    v_and_b32 v174, s3, v174
    v_and_b32 v175, s3, v175
    v_and_b32 v176, s3, v176
    v_and_b32 v177, s3, v177
    v_and_b32 v178, s3, v178
    v_and_b32 v179, s3, v179
    v_and_b32 v180, s3, v180
    v_and_b32 v181, s3, v181
    v_and_b32 v182, s3, v182
    v_and_b32 v183, s3, v183
    v_pk_add_f32 v[128:129], v[128:129], v[136:137]
    v_pk_add_f32 v[130:131], v[130:131], v[138:139]
    v_pk_add_f32 v[132:133], v[132:133], v[140:141]
    v_pk_add_f32 v[134:135], v[134:135], v[142:143]
    v_pk_add_f32 v[128:129], v[128:129], v[144:145]
    v_pk_add_f32 v[130:131], v[130:131], v[146:147]
    v_pk_add_f32 v[132:133], v[132:133], v[148:149]
    v_pk_add_f32 v[134:135], v[134:135], v[150:151]
    v_pk_add_f32 v[128:129], v[128:129], v[152:153]
    v_pk_add_f32 v[130:131], v[130:131], v[154:155]
    v_pk_add_f32 v[132:133], v[132:133], v[156:157]
    v_pk_add_f32 v[134:135], v[134:135], v[158:159]
    v_pk_add_f32 v[128:129], v[128:129], v[160:161]
    v_pk_add_f32 v[130:131], v[130:131], v[162:163]
    v_pk_add_f32 v[132:133], v[132:133], v[164:165]
    v_pk_add_f32 v[134:135], v[134:135], v[166:167]
    v_pk_add_f32 v[128:129], v[128:129], v[168:169]
    v_pk_add_f32 v[130:131], v[130:131], v[170:171]
    v_pk_add_f32 v[132:133], v[132:133], v[172:173]
    v_pk_add_f32 v[134:135], v[134:135], v[174:175]
    v_pk_add_f32 v[128:129], v[128:129], v[176:177]
    v_pk_add_f32 v[130:131], v[130:131], v[178:179]
    v_pk_add_f32 v[132:133], v[132:133], v[180:181]
    v_pk_add_f32 v[134:135], v[134:135], v[182:183]
    v_pk_add_f32 v[128:129], v[128:129], v[132:133]
    v_pk_add_f32 v[130:131], v[130:131], v[134:135]
    v_mov_b32 v132, v128
    v_mov_b32 v133, v129
    v_mov_b32 v134, v130
    v_mov_b32 v135, v131
    v_permlane16_swap_b32 v128, v132
    v_permlane16_swap_b32 v129, v133
    v_permlane16_swap_b32 v130, v134
    v_permlane16_swap_b32 v131, v135
    v_pk_add_f32 v[128:129], v[128:129], v[132:133]
    v_pk_add_f32 v[130:131], v[130:131], v[134:135]
    v_mov_b32 v132, v128
    v_mov_b32 v133, v129
    v_mov_b32 v134, v130
    v_mov_b32 v135, v131
    v_permlane32_swap_b32 v128, v132
    v_permlane32_swap_b32 v129, v133
    v_permlane32_swap_b32 v130, v134
    v_permlane32_swap_b32 v131, v135
    v_pk_add_f32 v[128:129], v[128:129], v[132:133]
    v_pk_add_f32 v[130:131], v[130:131], v[134:135]
    s_lshl_b32 s3, s38, 8
    s_add_u32 s3, s3, 157952
    v_lshl_add_u32 v6, v6, 4, s3
    ds_write_b128 v6, v[128:131]
    v_lshlrev_b32 v8, 16, v8
    v_subrev_f32 v9, s65, v8
    v_cvt_pk_bf16_f32 v9, v9, v9
    v_lshlrev_b32 v9, 16, v9
    v_mul_f32 v9, v9, v10
    v_cvt_pk_bf16_f32 v9, v9, v9
    v_lshlrev_b32 v9, 16, v9
    v_mov_b32 v16, v5
    s_lshl_b32 s3, s38, 2
    s_add_u32 s3, s3, 163168
    v_mov_b32 v5, s3
    v_mov_b32 v6, 1
    ds_write_b32 v5, v6
    v_mov_b32 v5, 163104
L_yr:
    ds_read_b128 v[20:23], v5 offset:64
    s_waitcnt lgkmcnt(0)
    v_and_b32 v20, v20, v21
    v_and_b32 v22, v22, v23
    v_and_b32 v20, v20, v22
    s_nop 0
    v_readfirstlane_b32 s3, v20
    s_nop 0
    s_cmp_eq_u32 s3, 1
    s_cbranch_scc1 L_yrd
    s_sleep 1
    s_branch L_yr
L_yrd:
    v_lshlrev_b32 v6, 2, v1
    v_add_u32 v6, 157952, v6
    ds_read_b32 v20, v6 offset:0
    ds_read_b32 v21, v6 offset:256
    ds_read_b32 v22, v6 offset:512
    ds_read_b32 v23, v6 offset:768
    s_bfe_u32 s3, s34, 0x20005
    s_and_b32 s65, s34, 7
    s_lshl_b32 s65, s65, 3
    s_lshl_b64 s[66:67], 0xff, s65
    s_bfe_u32 s65, s34, 0x20003
    s_cmp_lg_u32 s3, s38
    s_cbranch_scc1 L_fin
    s_waitcnt lgkmcnt(0)
    v_add_f32 v20, v20, v21
    v_add_f32 v22, v22, v23
    v_add_f32 v20, v20, v22
    v_cvt_pk_bf16_f32 v20, v20, v20
    v_lshlrev_b32 v20, 16, v20
    v_mul_f32 v20, v20, v16
    v_cvt_pk_bf16_f32 v20, v20, v20
    v_lshlrev_b32 v20, 16, v20
    v_add_f32 v20, v20, v9
    v_cvt_pk_bf16_f32 v20, v20, v20
    v_lshlrev_b32 v20, 16, v20
    v_mul_f32 v21, 0xbfb8aa3b, v20
    v_exp_f32 v21, v21
    s_nop 0
    v_add_f32 v21, 1.0, v21
    v_rcp_f32 v21, v21
    s_nop 0
    v_mul_f32 v20, v20, v21
    ds_write_b32 v6, v20 offset:1024
    v_lshlrev_b32 v6, 5, v250
    v_add_u32 v6, 158976, v6
    s_mov_b64 exec, s[66:67]
    s_cmp_lg_u32 s65, 0
    s_cbranch_scc1 L_gr0
    ds_read_b128 v[68:71], v6
    ds_read_b128 v[72:75], v6 offset:16
L_gr0:
    s_cmp_lg_u32 s65, 1
    s_cbranch_scc1 L_gr1
    ds_read_b128 v[76:79], v6
    ds_read_b128 v[80:83], v6 offset:16
L_gr1:
    s_cmp_lg_u32 s65, 2
    s_cbranch_scc1 L_gr2
    ds_read_b128 v[84:87], v6
    ds_read_b128 v[88:91], v6 offset:16
L_gr2:
    s_cmp_lg_u32 s65, 3
    s_cbranch_scc1 L_gr3
    ds_read_b128 v[92:95], v6
    ds_read_b128 v[96:99], v6 offset:16
L_gr3:
    s_mov_b64 exec, -1
L_fin:
    s_waitcnt lgkmcnt(0)
    s_barrier
    ds_read_b128 v[232:235], v15 offset:0
    ds_read_b128 v[236:239], v15 offset:1152
    ds_read_b128 v[240:243], v15 offset:2304
    ds_read_b128 v[244:247], v15 offset:3456
    s_waitcnt lgkmcnt(3)
    v_lshlrev_b32 v192, 16, v232
    v_and_b32 v193, 0xffff0000, v232
    v_lshlrev_b32 v194, 16, v233
    v_and_b32 v195, 0xffff0000, v233
    v_lshlrev_b32 v196, 16, v234
    v_and_b32 v197, 0xffff0000, v234
    v_lshlrev_b32 v198, 16, v235
    v_and_b32 v199, 0xffff0000, v235
    v_pk_fma_f32 v[36:37], v[192:193], v[68:69], v[36:37]
    v_pk_fma_f32 v[38:39], v[194:195], v[70:71], v[38:39]
    v_pk_fma_f32 v[40:41], v[196:197], v[72:73], v[40:41]
    v_pk_fma_f32 v[42:43], v[198:199], v[74:75], v[42:43]
    v_cvt_pk_bf16_f32 v232, v36, v37
    v_cvt_pk_bf16_f32 v233, v38, v39
    v_cvt_pk_bf16_f32 v234, v40, v41
    v_cvt_pk_bf16_f32 v235, v42, v43
    buffer_store_dwordx4 v[232:235], v248, s[24:27], 0 offen nt
    s_waitcnt lgkmcnt(2)
    v_lshlrev_b32 v200, 16, v236
    v_and_b32 v201, 0xffff0000, v236
    v_lshlrev_b32 v202, 16, v237
    v_and_b32 v203, 0xffff0000, v237
    v_lshlrev_b32 v204, 16, v238
    v_and_b32 v205, 0xffff0000, v238
    v_lshlrev_b32 v206, 16, v239
    v_and_b32 v207, 0xffff0000, v239
    v_pk_fma_f32 v[44:45], v[200:201], v[76:77], v[44:45]
    v_pk_fma_f32 v[46:47], v[202:203], v[78:79], v[46:47]
    v_pk_fma_f32 v[48:49], v[204:205], v[80:81], v[48:49]
    v_pk_fma_f32 v[50:51], v[206:207], v[82:83], v[50:51]
    v_cvt_pk_bf16_f32 v236, v44, v45
    v_cvt_pk_bf16_f32 v237, v46, v47
    v_cvt_pk_bf16_f32 v238, v48, v49
    v_cvt_pk_bf16_f32 v239, v50, v51
    buffer_store_dwordx4 v[236:239], v248, s[24:27], s48 offen nt
    s_waitcnt lgkmcnt(1)
    v_lshlrev_b32 v208, 16, v240
    v_and_b32 v209, 0xffff0000, v240
    v_lshlrev_b32 v210, 16, v241
    v_and_b32 v211, 0xffff0000, v241
    v_lshlrev_b32 v212, 16, v242
    v_and_b32 v213, 0xffff0000, v242
    v_lshlrev_b32 v214, 16, v243
    v_and_b32 v215, 0xffff0000, v243
    v_pk_fma_f32 v[52:53], v[208:209], v[84:85], v[52:53]
    v_pk_fma_f32 v[54:55], v[210:211], v[86:87], v[54:55]
    v_pk_fma_f32 v[56:57], v[212:213], v[88:89], v[56:57]
    v_pk_fma_f32 v[58:59], v[214:215], v[90:91], v[58:59]
    v_cvt_pk_bf16_f32 v240, v52, v53
    v_cvt_pk_bf16_f32 v241, v54, v55
    v_cvt_pk_bf16_f32 v242, v56, v57
    v_cvt_pk_bf16_f32 v243, v58, v59
    buffer_store_dwordx4 v[240:243], v248, s[24:27], s49 offen nt
    s_waitcnt lgkmcnt(0)
    v_lshlrev_b32 v216, 16, v244
    v_and_b32 v217, 0xffff0000, v244
    v_lshlrev_b32 v218, 16, v245
    v_and_b32 v219, 0xffff0000, v245
    v_lshlrev_b32 v220, 16, v246
    v_and_b32 v221, 0xffff0000, v246
    v_lshlrev_b32 v222, 16, v247
    v_and_b32 v223, 0xffff0000, v247
    v_pk_fma_f32 v[60:61], v[216:217], v[92:93], v[60:61]
    v_pk_fma_f32 v[62:63], v[218:219], v[94:95], v[62:63]
    v_pk_fma_f32 v[64:65], v[220:221], v[96:97], v[64:65]
    v_pk_fma_f32 v[66:67], v[222:223], v[98:99], v[66:67]
    v_cvt_pk_bf16_f32 v244, v60, v61
    v_cvt_pk_bf16_f32 v245, v62, v63
    v_cvt_pk_bf16_f32 v246, v64, v65
    v_cvt_pk_bf16_f32 v247, v66, v67
    buffer_store_dwordx4 v[244:247], v248, s[24:27], s100 offen nt
L_done:
    s_endpgm
L_g1:
    s_and_b32 s28, s38, 1
    s_lshr_b32 s29, s38, 1
    s_lshl_b32 s3, s36, 7
    s_lshl_b32 s65, s37, 3
    s_add_u32 s3, s3, s65
    s_lshl_b32 s65, s38, 1
    s_add_u32 s68, s3, s65
    s_lshl_b32 s3, s68, 11
    v_and_b32 v3, 31, v1
    v_lshlrev_b32 v3, 4, v3
    v_lshrrev_b32 v4, 5, v1
    v_lshl_add_u32 v5, v4, 11, v3
    s_waitcnt lgkmcnt(0)
    s_mov_b32 s4, s40
    s_mov_b32 s5, s41
    s_mov_b32 s6, 4194304
    s_mov_b32 s7, 0x00020000
    s_mov_b32 s16, s50
    s_mov_b32 s17, s51
    s_mov_b32 s18, 2048
    s_mov_b32 s19, 0x00020000
    buffer_load_dwordx4 v[200:203], v5, s[4:7], s3 offen offset:0
    buffer_load_dwordx4 v[204:207], v5, s[4:7], s3 offen offset:512
    buffer_load_dwordx4 v[208:211], v5, s[4:7], s3 offen offset:1024
    buffer_load_dwordx4 v[212:215], v5, s[4:7], s3 offen offset:1536
    buffer_load_dwordx4 v[216:219], v3, s[16:19], 0 offen offset:0
    buffer_load_dwordx4 v[220:223], v3, s[16:19], 0 offen offset:512
    buffer_load_dwordx4 v[224:227], v3, s[16:19], 0 offen offset:1024
    buffer_load_dwordx4 v[228:231], v3, s[16:19], 0 offen offset:1536
    s_or_b32 s3, s2, s38
    s_cmp_lg_u32 s3, 0
    s_cbranch_scc1 L_nn
    s_mov_b32 s20, s60
    s_mov_b32 s21, s61
    s_mov_b32 s22, 256
    s_mov_b32 s23, 0x00020000
    s_memrealtime s[66:67]
    s_memtime s[70:71]
    s_waitcnt lgkmcnt(0)
    s_lshl_b32 s70, s70, 20
    s_xor_b32 s66, s66, s70
    s_or_b32 s66, s66, 1
    s_and_b32 s66, s66, 0xbfffbfff
    v_mov_b32 v6, s66
    v_mov_b32 v7, 0
    s_mov_b64 exec, 1
    buffer_store_dword v6, v7, s[20:23], 0 offen sc1
    s_mov_b64 exec, -1
L_nn:
    s_getpc_b64 s[66:67]
L_pc:
    s_sub_u32 s66, s66, L_pc-recurrent_scan__linear_kernel_hedgehog__moe_arch_mod__prompt_kernel
    s_subb_u32 s67, s67, 0
    s_lshr_b32 s3, s2, 3
    s_lshl_b32 s3, s3, 2
    s_add_u32 s3, s3, s38
    s_lshl_b32 s3, s3, 6
    s_add_u32 s66, s66, s3
    s_addc_u32 s67, s67, 0
    s_load_dword s71, s[66:67], 0
    s_load_dword s71, s[66:67], 8192
    s_load_dword s71, s[66:67], 16384
    s_load_dword s71, s[66:67], 24576
    s_load_dword s71, s[66:67], 32768
    s_load_dword s71, s[66:67], 40960
    s_mov_b32 s12, s62
    s_mov_b32 s13, s63
    s_mov_b32 s14, 268435456
    s_mov_b32 s15, 0x00020000
    s_and_b32 s30, s2, 3
    s_lshl_b32 s30, s30, 2
    s_bfe_u32 s3, s2, 0x20003
    s_add_u32 s30, s30, s3
    s_bfe_u32 s31, s2, 0x10002
    s_lshl_b32 s31, s31, 3
    s_lshr_b32 s3, s2, 5
    s_add_u32 s31, s31, s3
    s_mov_b32 s88, 0
    s_mov_b32 s70, 0
    v_and_b32 v3, 15, v1
    v_lshlrev_b32 v6, 7, v3
    s_lshl_b32 s3, s28, 13
    v_add_u32 v6, s3, v6
    v_lshrrev_b32 v3, 1, v3
    v_lshrrev_b32 v2, 4, v1
    v_xor_b32 v3, v3, v2
    v_lshl_add_u32 v168, v3, 4, v6
    v_xor_b32 v3, 4, v3
    v_lshl_add_u32 v169, v3, 4, v6
    v_lshlrev_b32 v6, 3, v2
    v_bfe_u32 v7, v1, 2, 2
    v_add_u32 v6, v6, v7
    v_lshlrev_b32 v6, 7, v6
    v_and_b32 v7, 3, v1
    v_lshl_add_u32 v6, v7, 3, v6
    v_bfe_u32 v7, v1, 3, 2
    s_lshl_b32 s3, s29, 1
    v_xor_b32 v7, s3, v7
    v_add_u32 v6, 65536, v6
    v_lshl_add_u32 v170, v7, 5, v6
    v_xor_b32 v7, 1, v7
    v_lshl_add_u32 v171, v7, 5, v6
    v_add_u32 v189, 65536, v170
    v_add_u32 v191, 65536, v171
    v_mov_b64 v[8:9], 0
    v_mov_b64 v[10:11], 0
    v_mov_b64 v[12:13], 0
    v_mov_b64 v[14:15], 0
    v_mov_b64 v[16:17], 0
    v_mov_b64 v[18:19], 0
    v_mov_b64 v[20:21], 0
    v_mov_b64 v[22:23], 0
    v_mov_b64 v[24:25], 0
    v_mov_b64 v[26:27], 0
    v_mov_b64 v[28:29], 0
    v_mov_b64 v[30:31], 0
    v_mov_b64 v[32:33], 0
    v_mov_b64 v[34:35], 0
    v_mov_b64 v[36:37], 0
    v_mov_b64 v[38:39], 0
    v_mov_b64 v[40:41], 0
    v_mov_b64 v[42:43], 0
    v_mov_b64 v[44:45], 0
    v_mov_b64 v[46:47], 0
    v_mov_b64 v[48:49], 0
    v_mov_b64 v[50:51], 0
    v_mov_b64 v[52:53], 0
    v_mov_b64 v[54:55], 0
    v_mov_b64 v[56:57], 0
    v_mov_b64 v[58:59], 0
    v_mov_b64 v[60:61], 0
    v_mov_b64 v[62:63], 0
    v_mov_b64 v[64:65], 0
    v_mov_b64 v[66:67], 0
    v_mov_b64 v[68:69], 0
    v_mov_b64 v[70:71], 0
    v_mov_b64 v[72:73], 0
    v_mov_b64 v[74:75], 0
    v_mov_b64 v[76:77], 0
    v_mov_b64 v[78:79], 0
    v_mov_b64 v[80:81], 0
    v_mov_b64 v[82:83], 0
    v_mov_b64 v[84:85], 0
    v_mov_b64 v[86:87], 0
    v_mov_b64 v[88:89], 0
    v_mov_b64 v[90:91], 0
    v_mov_b64 v[92:93], 0
    v_mov_b64 v[94:95], 0
    v_mov_b64 v[96:97], 0
    v_mov_b64 v[98:99], 0
    v_mov_b64 v[100:101], 0
    v_mov_b64 v[102:103], 0
    v_mov_b32 v190, v4
    s_lshl_b32 s3, s38, 2
    s_add_u32 s3, s3, 163152
    v_mov_b32 v249, s3
    v_mov_b32 v251, 163072
    v_and_b32 v3, 15, v1
    s_lshl_b32 s3, s28, 8
    s_add_u32 s3, s3, 159744
    v_lshl_add_u32 v240, v3, 2, s3
    v_lshl_add_u32 v241, v1, 2, s3
    v_lshl_add_u32 v242, v2, 4, s3
    s_lshl_b32 s3, s29, 7
    s_add_u32 s3, s3, 162304
    v_lshl_add_u32 v243, v2, 4, s3
    v_lshl_add_u32 v244, v3, 2, s3
    s_lshl_b32 s3, s28, 7
    s_add_u32 s72, s3, 160768
    v_lshl_add_u32 v245, v2, 3, s72
    s_xor_b32 s3, s3, 128
    s_add_u32 s72, s3, 160768
    v_lshl_add_u32 v247, v2, 3, s72
    v_lshrrev_b32 v6, 2, v1
    v_lshlrev_b32 v4, 6, v6
    v_and_b32 v7, 3, v1
    v_lshl_add_u32 v4, v7, 3, v4
    s_lshl_b32 s3, s29, 11
    s_add_u32 s3, s3, 155648
    v_add_u32 v246, s3, v4
    v_mul_u32_u24 v4, 136, v3
    v_lshl_add_u32 v4, v2, 3, v4
    v_mul_u32_u24 v6, 136, v6
    v_lshl_add_u32 v6, v7, 3, v6
    s_lshl_b32 s3, s28, 6
    v_add_u32 v6, s3, v6
    v_lshlrev_b32 v5, 4, v1
    s_mul_i32 s72, s38, 8704
    s_add_u32 s72, s72, 96256
    s_xor_b32 s3, s38, 1
    s_mul_i32 s73, s3, 8704
    s_add_u32 s73, s73, 96256
    s_lshl_b32 s74, s38, 12
    s_add_u32 s74, s74, 65536
    s_lshl_b32 s75, s3, 12
    s_add_u32 s75, s75, 65536
    s_lshl_b32 s76, s3, 2
    s_add_u32 s76, s76, 163184
    s_lshl_b32 s3, s37, 1
    s_add_u32 s3, s3, s29
    s_lshl_b32 s3, s3, 4
    s_add_u32 s3, s3, s36
    s_lshl_b32 s3, s3, 1
    s_add_u32 s3, s3, s28
    s_lshl_b32 s3, s3, 12
    s_add_u32 s77, s3, 2097152
    v_mov_b32 v236, 0x3f803f80
    v_mov_b32 v232, 0
    v_mov_b32 v233, 0
    v_mov_b32 v234, 0
    v_mov_b32 v235, 0
    s_waitcnt vmcnt(0)
    v_dot2_f32_bf16 v232, v200, v236, v232
    v_dot2_f32_bf16 v233, v200, v200, v233
    v_dot2_f32_bf16 v234, v200, v216, v234
    v_dot2_f32_bf16 v235, v216, v236, v235
    v_dot2_f32_bf16 v232, v201, v236, v232
    v_dot2_f32_bf16 v233, v201, v201, v233
    v_dot2_f32_bf16 v234, v201, v217, v234
    v_dot2_f32_bf16 v235, v217, v236, v235
    v_dot2_f32_bf16 v232, v202, v236, v232
    v_dot2_f32_bf16 v233, v202, v202, v233
    v_dot2_f32_bf16 v234, v202, v218, v234
    v_dot2_f32_bf16 v235, v218, v236, v235
    v_dot2_f32_bf16 v232, v203, v236, v232
    v_dot2_f32_bf16 v233, v203, v203, v233
    v_dot2_f32_bf16 v234, v203, v219, v234
    v_dot2_f32_bf16 v235, v219, v236, v235
    v_dot2_f32_bf16 v232, v204, v236, v232
    v_dot2_f32_bf16 v233, v204, v204, v233
    v_dot2_f32_bf16 v234, v204, v220, v234
    v_dot2_f32_bf16 v235, v220, v236, v235
    v_dot2_f32_bf16 v232, v205, v236, v232
    v_dot2_f32_bf16 v233, v205, v205, v233
    v_dot2_f32_bf16 v234, v205, v221, v234
    v_dot2_f32_bf16 v235, v221, v236, v235
    v_dot2_f32_bf16 v232, v206, v236, v232
    v_dot2_f32_bf16 v233, v206, v206, v233
    v_dot2_f32_bf16 v234, v206, v222, v234
    v_dot2_f32_bf16 v235, v222, v236, v235
    v_dot2_f32_bf16 v232, v207, v236, v232
    v_dot2_f32_bf16 v233, v207, v207, v233
    v_dot2_f32_bf16 v234, v207, v223, v234
    v_dot2_f32_bf16 v235, v223, v236, v235
    v_dot2_f32_bf16 v232, v208, v236, v232
    v_dot2_f32_bf16 v233, v208, v208, v233
    v_dot2_f32_bf16 v234, v208, v224, v234
    v_dot2_f32_bf16 v235, v224, v236, v235
    v_dot2_f32_bf16 v232, v209, v236, v232
    v_dot2_f32_bf16 v233, v209, v209, v233
    v_dot2_f32_bf16 v234, v209, v225, v234
    v_dot2_f32_bf16 v235, v225, v236, v235
    v_dot2_f32_bf16 v232, v210, v236, v232
    v_dot2_f32_bf16 v233, v210, v210, v233
    v_dot2_f32_bf16 v234, v210, v226, v234
    v_dot2_f32_bf16 v235, v226, v236, v235
    v_dot2_f32_bf16 v232, v211, v236, v232
    v_dot2_f32_bf16 v233, v211, v211, v233
    v_dot2_f32_bf16 v234, v211, v227, v234
    v_dot2_f32_bf16 v235, v227, v236, v235
    v_dot2_f32_bf16 v232, v212, v236, v232
    v_dot2_f32_bf16 v233, v212, v212, v233
    v_dot2_f32_bf16 v234, v212, v228, v234
    v_dot2_f32_bf16 v235, v228, v236, v235
    v_dot2_f32_bf16 v232, v213, v236, v232
    v_dot2_f32_bf16 v233, v213, v213, v233
    v_dot2_f32_bf16 v234, v213, v229, v234
    v_dot2_f32_bf16 v235, v229, v236, v235
    v_dot2_f32_bf16 v232, v214, v236, v232
    v_dot2_f32_bf16 v233, v214, v214, v233
    v_dot2_f32_bf16 v234, v214, v230, v234
    v_dot2_f32_bf16 v235, v230, v236, v235
    v_dot2_f32_bf16 v232, v215, v236, v232
    v_dot2_f32_bf16 v233, v215, v215, v233
    v_dot2_f32_bf16 v234, v215, v231, v234
    v_dot2_f32_bf16 v235, v231, v236, v235
    v_add_f32 v232, v232, v232 quad_perm:[1,0,3,2] row_mask:0xf bank_mask:0xf
    v_add_f32 v233, v233, v233 quad_perm:[1,0,3,2] row_mask:0xf bank_mask:0xf
    v_add_f32 v234, v234, v234 quad_perm:[1,0,3,2] row_mask:0xf bank_mask:0xf
    v_add_f32 v235, v235, v235 quad_perm:[1,0,3,2] row_mask:0xf bank_mask:0xf
    v_add_f32 v232, v232, v232 quad_perm:[2,3,0,1] row_mask:0xf bank_mask:0xf
    v_add_f32 v233, v233, v233 quad_perm:[2,3,0,1] row_mask:0xf bank_mask:0xf
    v_add_f32 v234, v234, v234 quad_perm:[2,3,0,1] row_mask:0xf bank_mask:0xf
    v_add_f32 v235, v235, v235 quad_perm:[2,3,0,1] row_mask:0xf bank_mask:0xf
    v_add_f32 v232, v232, v232 row_half_mirror row_mask:0xf bank_mask:0xf
    v_add_f32 v233, v233, v233 row_half_mirror row_mask:0xf bank_mask:0xf
    v_add_f32 v234, v234, v234 row_half_mirror row_mask:0xf bank_mask:0xf
    v_add_f32 v235, v235, v235 row_half_mirror row_mask:0xf bank_mask:0xf
    v_add_f32 v232, v232, v232 row_mirror row_mask:0xf bank_mask:0xf
    v_add_f32 v233, v233, v233 row_mirror row_mask:0xf bank_mask:0xf
    v_add_f32 v234, v234, v234 row_mirror row_mask:0xf bank_mask:0xf
    v_add_f32 v235, v235, v235 row_mirror row_mask:0xf bank_mask:0xf
    v_mov_b32 v236, v232
    v_mov_b32 v237, v233
    v_mov_b32 v238, v234
    v_mov_b32 v239, v235
    v_permlane16_swap_b32 v232, v236
    v_permlane16_swap_b32 v233, v237
    v_permlane16_swap_b32 v234, v238
    v_permlane16_swap_b32 v235, v239
    v_add_f32 v232, v232, v236
    v_add_f32 v233, v233, v237
    v_add_f32 v234, v234, v238
    v_add_f32 v235, v235, v239
    v_mul_f32 v232, 0x3a800000, v232
    v_mul_f32 v233, 0x3a800000, v233
    v_fma_f32 v233, -v232, v232, v233
    v_max_f32 v233, 0, v233
    v_cvt_pk_bf16_f32 v232, v232, v232
    v_lshlrev_b32 v232, 16, v232
    v_cvt_pk_bf16_f32 v233, v233, v233
    v_lshlrev_b32 v233, 16, v233
    v_add_f32 v233, 0x3727c5ac, v233
    v_cvt_pk_bf16_f32 v233, v233, v233
    v_lshlrev_b32 v233, 16, v233
    v_sqrt_f32 v233, v233
    v_fma_f32 v234, -v232, v235, v234
    v_cvt_pk_bf16_f32 v233, v233, v233
    v_lshlrev_b32 v233, 16, v233
    v_rcp_f32 v235, v233
    v_lshrrev_b32 v232, 16, v232
    v_or_b32 v232, v232, v233
    v_mul_f32 v234, v234, v235
    v_ashrrev_i32 v235, 31, v234
    v_or_b32 v235, 0x80000000, v235
    v_xor_b32 v234, v234, v235
    v_and_b32 v234, 0xfffff800, v234
    s_sub_u32 s3, 2047, s68
    v_sub_u32 v235, s3, v190
    v_or_b32 v233, v234, v235
    s_lshl_b32 s3, s38, 4
    s_add_u32 s3, s3, 163264
    v_lshl_add_u32 v235, v190, 3, s3
    ds_write_b64 v235, v[232:233]
L_c1:
    s_waitcnt lgkmcnt(0)
    s_barrier
    ds_read_b128 v[104:107], v168 offset:0
    ds_read_b64_tr_b16 v[120:121], v170 offset:0
    ds_read_b64_tr_b16 v[122:123], v170 offset:512
    ds_read_b64_tr_b16 v[124:125], v171 offset:0
    ds_read_b64_tr_b16 v[126:127], v171 offset:512
    ds_read_b128 v[108:111], v168 offset:2048
    ds_read_b64_tr_b16 v[128:129], v170 offset:8192
    ds_read_b64_tr_b16 v[130:131], v170 offset:8704
    ds_read_b64_tr_b16 v[132:133], v171 offset:8192
    ds_read_b64_tr_b16 v[134:135], v171 offset:8704
    ds_read_b64_tr_b16 v[172:173], v189 offset:0
    ds_read_b64_tr_b16 v[174:175], v189 offset:512
    s_waitcnt lgkmcnt(8)
    ds_read_b64_tr_b16 v[176:177], v191 offset:0
    ds_read_b64_tr_b16 v[178:179], v191 offset:512
    ds_read_b128 v[112:115], v168 offset:4096
    ds_read_b128 v[116:119], v168 offset:6144
    s_waitcnt lgkmcnt(0)
    v_mfma_f32_16x16x32_bf16 v[8:11], v[120:123], v[104:107], v[8:11]
    ds_read_b128 v[136:139], v169 offset:0
    v_mfma_f32_16x16x32_bf16 v[12:15], v[124:127], v[104:107], v[12:15]
    ds_read_b64_tr_b16 v[152:153], v170 offset:4096
    v_mfma_f32_16x16x32_bf16 v[16:19], v[104:107], v[128:131], v[16:19]
    ds_read_b64_tr_b16 v[154:155], v170 offset:4608
    v_mfma_f32_16x16x32_bf16 v[20:23], v[104:107], v[132:135], v[20:23]
    ds_read_b64_tr_b16 v[156:157], v171 offset:4096
    v_mfma_f32_16x16x32_bf16 v[72:75], v[172:175], v[104:107], v[72:75]
    ds_read_b64_tr_b16 v[158:159], v171 offset:4608
    v_mfma_f32_16x16x32_bf16 v[76:79], v[176:179], v[104:107], v[76:79]
    ds_read_b128 v[140:143], v169 offset:2048
    v_mfma_f32_16x16x32_bf16 v[24:27], v[120:123], v[108:111], v[24:27]
    ds_read_b64_tr_b16 v[160:161], v170 offset:12288
    v_mfma_f32_16x16x32_bf16 v[28:31], v[124:127], v[108:111], v[28:31]
    ds_read_b64_tr_b16 v[162:163], v170 offset:12800
    v_mfma_f32_16x16x32_bf16 v[32:35], v[108:111], v[128:131], v[32:35]
    ds_read_b64_tr_b16 v[164:165], v171 offset:12288
    v_mfma_f32_16x16x32_bf16 v[36:39], v[108:111], v[132:135], v[36:39]
    ds_read_b64_tr_b16 v[166:167], v171 offset:12800
    v_mfma_f32_16x16x32_bf16 v[80:83], v[172:175], v[108:111], v[80:83]
    ds_read_b64_tr_b16 v[180:181], v189 offset:4096
    v_mfma_f32_16x16x32_bf16 v[84:87], v[176:179], v[108:111], v[84:87]
    ds_read_b64_tr_b16 v[182:183], v189 offset:4608
    v_mfma_f32_16x16x32_bf16 v[40:43], v[120:123], v[112:115], v[40:43]
    ds_read_b64_tr_b16 v[184:185], v191 offset:4096
    v_mfma_f32_16x16x32_bf16 v[44:47], v[124:127], v[112:115], v[44:47]
    ds_read_b64_tr_b16 v[186:187], v191 offset:4608
    v_mfma_f32_16x16x32_bf16 v[48:51], v[112:115], v[128:131], v[48:51]
    ds_read_b128 v[144:147], v169 offset:4096
    v_mfma_f32_16x16x32_bf16 v[52:55], v[112:115], v[132:135], v[52:55]
    ds_read_b128 v[148:151], v169 offset:6144
    v_mfma_f32_16x16x32_bf16 v[88:91], v[172:175], v[112:115], v[88:91]
    v_mfma_f32_16x16x32_bf16 v[92:95], v[176:179], v[112:115], v[92:95]
    v_mfma_f32_16x16x32_bf16 v[56:59], v[120:123], v[116:119], v[56:59]
    v_mfma_f32_16x16x32_bf16 v[60:63], v[124:127], v[116:119], v[60:63]
    v_mfma_f32_16x16x32_bf16 v[64:67], v[116:119], v[128:131], v[64:67]
    v_mfma_f32_16x16x32_bf16 v[68:71], v[116:119], v[132:135], v[68:71]
    v_mfma_f32_16x16x32_bf16 v[96:99], v[172:175], v[116:119], v[96:99]
    v_mfma_f32_16x16x32_bf16 v[100:103], v[176:179], v[116:119], v[100:103]
    s_waitcnt lgkmcnt(0)
    s_barrier
    v_mfma_f32_16x16x32_bf16 v[8:11], v[152:155], v[136:139], v[8:11]
    ds_read_b128 v[104:107], v168 offset:16384
    v_mfma_f32_16x16x32_bf16 v[12:15], v[156:159], v[136:139], v[12:15]
    ds_read_b64_tr_b16 v[120:121], v170 offset:16384
    v_mfma_f32_16x16x32_bf16 v[16:19], v[136:139], v[160:163], v[16:19]
    ds_read_b64_tr_b16 v[122:123], v170 offset:16896
    v_mfma_f32_16x16x32_bf16 v[20:23], v[136:139], v[164:167], v[20:23]
    ds_read_b64_tr_b16 v[124:125], v171 offset:16384
    v_mfma_f32_16x16x32_bf16 v[72:75], v[180:183], v[136:139], v[72:75]
    ds_read_b64_tr_b16 v[126:127], v171 offset:16896
    v_mfma_f32_16x16x32_bf16 v[76:79], v[184:187], v[136:139], v[76:79]
    ds_read_b128 v[108:111], v168 offset:18432
    v_mfma_f32_16x16x32_bf16 v[24:27], v[152:155], v[140:143], v[24:27]
    ds_read_b64_tr_b16 v[128:129], v170 offset:24576
    v_mfma_f32_16x16x32_bf16 v[28:31], v[156:159], v[140:143], v[28:31]
    ds_read_b64_tr_b16 v[130:131], v170 offset:25088
    v_mfma_f32_16x16x32_bf16 v[32:35], v[140:143], v[160:163], v[32:35]
    ds_read_b64_tr_b16 v[132:133], v171 offset:24576
    v_mfma_f32_16x16x32_bf16 v[36:39], v[140:143], v[164:167], v[36:39]
    ds_read_b64_tr_b16 v[134:135], v171 offset:25088
    v_mfma_f32_16x16x32_bf16 v[80:83], v[180:183], v[140:143], v[80:83]
    ds_read_b64_tr_b16 v[172:173], v189 offset:8192
    v_mfma_f32_16x16x32_bf16 v[84:87], v[184:187], v[140:143], v[84:87]
    ds_read_b64_tr_b16 v[174:175], v189 offset:8704
    v_mfma_f32_16x16x32_bf16 v[40:43], v[152:155], v[144:147], v[40:43]
    ds_read_b64_tr_b16 v[176:177], v191 offset:8192
    v_mfma_f32_16x16x32_bf16 v[44:47], v[156:159], v[144:147], v[44:47]
    ds_read_b64_tr_b16 v[178:179], v191 offset:8704
    v_mfma_f32_16x16x32_bf16 v[48:51], v[144:147], v[160:163], v[48:51]
    ds_read_b128 v[112:115], v168 offset:20480
    v_mfma_f32_16x16x32_bf16 v[52:55], v[144:147], v[164:167], v[52:55]
    ds_read_b128 v[116:119], v168 offset:22528
    v_mfma_f32_16x16x32_bf16 v[88:91], v[180:183], v[144:147], v[88:91]
    v_mfma_f32_16x16x32_bf16 v[92:95], v[184:187], v[144:147], v[92:95]
    v_mfma_f32_16x16x32_bf16 v[56:59], v[152:155], v[148:151], v[56:59]
    v_mfma_f32_16x16x32_bf16 v[60:63], v[156:159], v[148:151], v[60:63]
    v_mfma_f32_16x16x32_bf16 v[64:67], v[148:151], v[160:163], v[64:67]
    v_mfma_f32_16x16x32_bf16 v[68:71], v[148:151], v[164:167], v[68:71]
    v_mfma_f32_16x16x32_bf16 v[96:99], v[180:183], v[148:151], v[96:99]
    v_mfma_f32_16x16x32_bf16 v[100:103], v[184:187], v[148:151], v[100:103]
    s_waitcnt lgkmcnt(0)
    v_mfma_f32_16x16x32_bf16 v[8:11], v[120:123], v[104:107], v[8:11]
    ds_read_b128 v[136:139], v169 offset:16384
    v_mfma_f32_16x16x32_bf16 v[12:15], v[124:127], v[104:107], v[12:15]
    ds_read_b64_tr_b16 v[152:153], v170 offset:20480
    v_mfma_f32_16x16x32_bf16 v[16:19], v[104:107], v[128:131], v[16:19]
    ds_read_b64_tr_b16 v[154:155], v170 offset:20992
    v_mfma_f32_16x16x32_bf16 v[20:23], v[104:107], v[132:135], v[20:23]
    ds_read_b64_tr_b16 v[156:157], v171 offset:20480
    v_mfma_f32_16x16x32_bf16 v[72:75], v[172:175], v[104:107], v[72:75]
    ds_read_b64_tr_b16 v[158:159], v171 offset:20992
    v_mfma_f32_16x16x32_bf16 v[76:79], v[176:179], v[104:107], v[76:79]
    ds_read_b128 v[140:143], v169 offset:18432
    v_mfma_f32_16x16x32_bf16 v[24:27], v[120:123], v[108:111], v[24:27]
    ds_read_b64_tr_b16 v[160:161], v170 offset:28672
    v_mfma_f32_16x16x32_bf16 v[28:31], v[124:127], v[108:111], v[28:31]
    ds_read_b64_tr_b16 v[162:163], v170 offset:29184
    v_mfma_f32_16x16x32_bf16 v[32:35], v[108:111], v[128:131], v[32:35]
    ds_read_b64_tr_b16 v[164:165], v171 offset:28672
    v_mfma_f32_16x16x32_bf16 v[36:39], v[108:111], v[132:135], v[36:39]
    ds_read_b64_tr_b16 v[166:167], v171 offset:29184
    v_mfma_f32_16x16x32_bf16 v[80:83], v[172:175], v[108:111], v[80:83]
    ds_read_b64_tr_b16 v[180:181], v189 offset:12288
    v_mfma_f32_16x16x32_bf16 v[84:87], v[176:179], v[108:111], v[84:87]
    ds_read_b64_tr_b16 v[182:183], v189 offset:12800
    v_mfma_f32_16x16x32_bf16 v[40:43], v[120:123], v[112:115], v[40:43]
    ds_read_b64_tr_b16 v[184:185], v191 offset:12288
    v_mfma_f32_16x16x32_bf16 v[44:47], v[124:127], v[112:115], v[44:47]
    ds_read_b64_tr_b16 v[186:187], v191 offset:12800
    v_mfma_f32_16x16x32_bf16 v[48:51], v[112:115], v[128:131], v[48:51]
    ds_read_b128 v[144:147], v169 offset:20480
    v_mfma_f32_16x16x32_bf16 v[52:55], v[112:115], v[132:135], v[52:55]
    ds_read_b128 v[148:151], v169 offset:22528
    v_mfma_f32_16x16x32_bf16 v[88:91], v[172:175], v[112:115], v[88:91]
    v_mfma_f32_16x16x32_bf16 v[92:95], v[176:179], v[112:115], v[92:95]
    v_mfma_f32_16x16x32_bf16 v[56:59], v[120:123], v[116:119], v[56:59]
    v_mfma_f32_16x16x32_bf16 v[60:63], v[124:127], v[116:119], v[60:63]
    v_mfma_f32_16x16x32_bf16 v[64:67], v[116:119], v[128:131], v[64:67]
    v_mfma_f32_16x16x32_bf16 v[68:71], v[116:119], v[132:135], v[68:71]
    v_mfma_f32_16x16x32_bf16 v[96:99], v[172:175], v[116:119], v[96:99]
    v_mfma_f32_16x16x32_bf16 v[100:103], v[176:179], v[116:119], v[100:103]
    s_waitcnt lgkmcnt(0)
    s_barrier
    v_mfma_f32_16x16x32_bf16 v[8:11], v[152:155], v[136:139], v[8:11]
    ds_read_b128 v[104:107], v168 offset:32768
    v_mfma_f32_16x16x32_bf16 v[12:15], v[156:159], v[136:139], v[12:15]
    ds_read_b64_tr_b16 v[120:121], v170 offset:32768
    v_mfma_f32_16x16x32_bf16 v[16:19], v[136:139], v[160:163], v[16:19]
    ds_read_b64_tr_b16 v[122:123], v170 offset:33280
    v_mfma_f32_16x16x32_bf16 v[20:23], v[136:139], v[164:167], v[20:23]
    ds_read_b64_tr_b16 v[124:125], v171 offset:32768
    v_mfma_f32_16x16x32_bf16 v[72:75], v[180:183], v[136:139], v[72:75]
    ds_read_b64_tr_b16 v[126:127], v171 offset:33280
    v_mfma_f32_16x16x32_bf16 v[76:79], v[184:187], v[136:139], v[76:79]
    ds_read_b128 v[108:111], v168 offset:34816
    v_mfma_f32_16x16x32_bf16 v[24:27], v[152:155], v[140:143], v[24:27]
    ds_read_b64_tr_b16 v[128:129], v170 offset:40960
    v_mfma_f32_16x16x32_bf16 v[28:31], v[156:159], v[140:143], v[28:31]
    ds_read_b64_tr_b16 v[130:131], v170 offset:41472
    v_mfma_f32_16x16x32_bf16 v[32:35], v[140:143], v[160:163], v[32:35]
    ds_read_b64_tr_b16 v[132:133], v171 offset:40960
    v_mfma_f32_16x16x32_bf16 v[36:39], v[140:143], v[164:167], v[36:39]
    ds_read_b64_tr_b16 v[134:135], v171 offset:41472
    v_mfma_f32_16x16x32_bf16 v[80:83], v[180:183], v[140:143], v[80:83]
    ds_read_b64_tr_b16 v[172:173], v189 offset:16384
    v_mfma_f32_16x16x32_bf16 v[84:87], v[184:187], v[140:143], v[84:87]
    ds_read_b64_tr_b16 v[174:175], v189 offset:16896
    v_mfma_f32_16x16x32_bf16 v[40:43], v[152:155], v[144:147], v[40:43]
    ds_read_b64_tr_b16 v[176:177], v191 offset:16384
    v_mfma_f32_16x16x32_bf16 v[44:47], v[156:159], v[144:147], v[44:47]
    ds_read_b64_tr_b16 v[178:179], v191 offset:16896
    v_mfma_f32_16x16x32_bf16 v[48:51], v[144:147], v[160:163], v[48:51]
    ds_read_b128 v[112:115], v168 offset:36864
    v_mfma_f32_16x16x32_bf16 v[52:55], v[144:147], v[164:167], v[52:55]
    ds_read_b128 v[116:119], v168 offset:38912
    v_mfma_f32_16x16x32_bf16 v[88:91], v[180:183], v[144:147], v[88:91]
    v_mfma_f32_16x16x32_bf16 v[92:95], v[184:187], v[144:147], v[92:95]
    v_mfma_f32_16x16x32_bf16 v[56:59], v[152:155], v[148:151], v[56:59]
    v_mfma_f32_16x16x32_bf16 v[60:63], v[156:159], v[148:151], v[60:63]
    v_mfma_f32_16x16x32_bf16 v[64:67], v[148:151], v[160:163], v[64:67]
    v_mfma_f32_16x16x32_bf16 v[68:71], v[148:151], v[164:167], v[68:71]
    v_mfma_f32_16x16x32_bf16 v[96:99], v[180:183], v[148:151], v[96:99]
    v_mfma_f32_16x16x32_bf16 v[100:103], v[184:187], v[148:151], v[100:103]
    s_waitcnt lgkmcnt(0)
    v_mfma_f32_16x16x32_bf16 v[8:11], v[120:123], v[104:107], v[8:11]
    ds_read_b128 v[136:139], v169 offset:32768
    v_mfma_f32_16x16x32_bf16 v[12:15], v[124:127], v[104:107], v[12:15]
    ds_read_b64_tr_b16 v[152:153], v170 offset:36864
    v_mfma_f32_16x16x32_bf16 v[16:19], v[104:107], v[128:131], v[16:19]
    ds_read_b64_tr_b16 v[154:155], v170 offset:37376
    v_mfma_f32_16x16x32_bf16 v[20:23], v[104:107], v[132:135], v[20:23]
    ds_read_b64_tr_b16 v[156:157], v171 offset:36864
    v_mfma_f32_16x16x32_bf16 v[72:75], v[172:175], v[104:107], v[72:75]
    ds_read_b64_tr_b16 v[158:159], v171 offset:37376
    v_mfma_f32_16x16x32_bf16 v[76:79], v[176:179], v[104:107], v[76:79]
    ds_read_b128 v[140:143], v169 offset:34816
    v_mfma_f32_16x16x32_bf16 v[24:27], v[120:123], v[108:111], v[24:27]
    ds_read_b64_tr_b16 v[160:161], v170 offset:45056
    v_mfma_f32_16x16x32_bf16 v[28:31], v[124:127], v[108:111], v[28:31]
    ds_read_b64_tr_b16 v[162:163], v170 offset:45568
    v_mfma_f32_16x16x32_bf16 v[32:35], v[108:111], v[128:131], v[32:35]
    ds_read_b64_tr_b16 v[164:165], v171 offset:45056
    v_mfma_f32_16x16x32_bf16 v[36:39], v[108:111], v[132:135], v[36:39]
    ds_read_b64_tr_b16 v[166:167], v171 offset:45568
    v_mfma_f32_16x16x32_bf16 v[80:83], v[172:175], v[108:111], v[80:83]
    ds_read_b64_tr_b16 v[180:181], v189 offset:20480
    v_mfma_f32_16x16x32_bf16 v[84:87], v[176:179], v[108:111], v[84:87]
    ds_read_b64_tr_b16 v[182:183], v189 offset:20992
    v_mfma_f32_16x16x32_bf16 v[40:43], v[120:123], v[112:115], v[40:43]
    ds_read_b64_tr_b16 v[184:185], v191 offset:20480
    v_mfma_f32_16x16x32_bf16 v[44:47], v[124:127], v[112:115], v[44:47]
    ds_read_b64_tr_b16 v[186:187], v191 offset:20992
    v_mfma_f32_16x16x32_bf16 v[48:51], v[112:115], v[128:131], v[48:51]
    ds_read_b128 v[144:147], v169 offset:36864
    v_mfma_f32_16x16x32_bf16 v[52:55], v[112:115], v[132:135], v[52:55]
    ds_read_b128 v[148:151], v169 offset:38912
    v_mfma_f32_16x16x32_bf16 v[88:91], v[172:175], v[112:115], v[88:91]
    v_mfma_f32_16x16x32_bf16 v[92:95], v[176:179], v[112:115], v[92:95]
    v_mfma_f32_16x16x32_bf16 v[56:59], v[120:123], v[116:119], v[56:59]
    v_mfma_f32_16x16x32_bf16 v[60:63], v[124:127], v[116:119], v[60:63]
    v_mfma_f32_16x16x32_bf16 v[64:67], v[116:119], v[128:131], v[64:67]
    v_mfma_f32_16x16x32_bf16 v[68:71], v[116:119], v[132:135], v[68:71]
    v_mfma_f32_16x16x32_bf16 v[96:99], v[172:175], v[116:119], v[96:99]
    v_mfma_f32_16x16x32_bf16 v[100:103], v[176:179], v[116:119], v[100:103]
    s_waitcnt lgkmcnt(0)
    s_barrier
    v_mfma_f32_16x16x32_bf16 v[8:11], v[152:155], v[136:139], v[8:11]
    ds_read_b128 v[104:107], v168 offset:49152
    v_mfma_f32_16x16x32_bf16 v[12:15], v[156:159], v[136:139], v[12:15]
    ds_read_b64_tr_b16 v[120:121], v170 offset:49152
    v_mfma_f32_16x16x32_bf16 v[16:19], v[136:139], v[160:163], v[16:19]
    ds_read_b64_tr_b16 v[122:123], v170 offset:49664
    v_mfma_f32_16x16x32_bf16 v[20:23], v[136:139], v[164:167], v[20:23]
    ds_read_b64_tr_b16 v[124:125], v171 offset:49152
    v_mfma_f32_16x16x32_bf16 v[72:75], v[180:183], v[136:139], v[72:75]
    ds_read_b64_tr_b16 v[126:127], v171 offset:49664
    v_mfma_f32_16x16x32_bf16 v[76:79], v[184:187], v[136:139], v[76:79]
    ds_read_b128 v[108:111], v168 offset:51200
    v_mfma_f32_16x16x32_bf16 v[24:27], v[152:155], v[140:143], v[24:27]
    ds_read_b64_tr_b16 v[128:129], v170 offset:57344
    v_mfma_f32_16x16x32_bf16 v[28:31], v[156:159], v[140:143], v[28:31]
    ds_read_b64_tr_b16 v[130:131], v170 offset:57856
    v_mfma_f32_16x16x32_bf16 v[32:35], v[140:143], v[160:163], v[32:35]
    ds_read_b64_tr_b16 v[132:133], v171 offset:57344
    v_mfma_f32_16x16x32_bf16 v[36:39], v[140:143], v[164:167], v[36:39]
    ds_read_b64_tr_b16 v[134:135], v171 offset:57856
    v_mfma_f32_16x16x32_bf16 v[80:83], v[180:183], v[140:143], v[80:83]
    ds_read_b64_tr_b16 v[172:173], v189 offset:0
    v_mfma_f32_16x16x32_bf16 v[84:87], v[184:187], v[140:143], v[84:87]
    ds_read_b64_tr_b16 v[174:175], v189 offset:512
    v_mfma_f32_16x16x32_bf16 v[40:43], v[152:155], v[144:147], v[40:43]
    ds_read_b64_tr_b16 v[176:177], v191 offset:0
    v_mfma_f32_16x16x32_bf16 v[44:47], v[156:159], v[144:147], v[44:47]
    ds_read_b64_tr_b16 v[178:179], v191 offset:512
    v_mfma_f32_16x16x32_bf16 v[48:51], v[144:147], v[160:163], v[48:51]
    ds_read_b128 v[112:115], v168 offset:53248
    v_mfma_f32_16x16x32_bf16 v[52:55], v[144:147], v[164:167], v[52:55]
    ds_read_b128 v[116:119], v168 offset:55296
    v_mfma_f32_16x16x32_bf16 v[88:91], v[180:183], v[144:147], v[88:91]
    v_mfma_f32_16x16x32_bf16 v[92:95], v[184:187], v[144:147], v[92:95]
    v_mfma_f32_16x16x32_bf16 v[56:59], v[152:155], v[148:151], v[56:59]
    v_mfma_f32_16x16x32_bf16 v[60:63], v[156:159], v[148:151], v[60:63]
    v_mfma_f32_16x16x32_bf16 v[64:67], v[148:151], v[160:163], v[64:67]
    v_mfma_f32_16x16x32_bf16 v[68:71], v[148:151], v[164:167], v[68:71]
    v_mfma_f32_16x16x32_bf16 v[96:99], v[180:183], v[148:151], v[96:99]
    v_mfma_f32_16x16x32_bf16 v[100:103], v[184:187], v[148:151], v[100:103]
    s_waitcnt lgkmcnt(0)
    v_mfma_f32_16x16x32_bf16 v[8:11], v[120:123], v[104:107], v[8:11]
    ds_read_b128 v[136:139], v169 offset:49152
    v_mfma_f32_16x16x32_bf16 v[12:15], v[124:127], v[104:107], v[12:15]
    ds_read_b64_tr_b16 v[152:153], v170 offset:53248
    v_mfma_f32_16x16x32_bf16 v[16:19], v[104:107], v[128:131], v[16:19]
    ds_read_b64_tr_b16 v[154:155], v170 offset:53760
    v_mfma_f32_16x16x32_bf16 v[20:23], v[104:107], v[132:135], v[20:23]
    ds_read_b64_tr_b16 v[156:157], v171 offset:53248
    v_mfma_f32_16x16x32_bf16 v[72:75], v[172:175], v[104:107], v[72:75]
    ds_read_b64_tr_b16 v[158:159], v171 offset:53760
    v_mfma_f32_16x16x32_bf16 v[76:79], v[176:179], v[104:107], v[76:79]
    ds_read_b128 v[140:143], v169 offset:51200
    v_mfma_f32_16x16x32_bf16 v[24:27], v[120:123], v[108:111], v[24:27]
    ds_read_b64_tr_b16 v[160:161], v170 offset:61440
    v_mfma_f32_16x16x32_bf16 v[28:31], v[124:127], v[108:111], v[28:31]
    ds_read_b64_tr_b16 v[162:163], v170 offset:61952
    v_mfma_f32_16x16x32_bf16 v[32:35], v[108:111], v[128:131], v[32:35]
    ds_read_b64_tr_b16 v[164:165], v171 offset:61440
    v_mfma_f32_16x16x32_bf16 v[36:39], v[108:111], v[132:135], v[36:39]
    ds_read_b64_tr_b16 v[166:167], v171 offset:61952
    v_mfma_f32_16x16x32_bf16 v[80:83], v[172:175], v[108:111], v[80:83]
    ds_read_b64_tr_b16 v[180:181], v189 offset:4096
    v_mfma_f32_16x16x32_bf16 v[84:87], v[176:179], v[108:111], v[84:87]
    ds_read_b64_tr_b16 v[182:183], v189 offset:4608
    v_mfma_f32_16x16x32_bf16 v[40:43], v[120:123], v[112:115], v[40:43]
    ds_read_b64_tr_b16 v[184:185], v191 offset:4096
    v_mfma_f32_16x16x32_bf16 v[44:47], v[124:127], v[112:115], v[44:47]
    ds_read_b64_tr_b16 v[186:187], v191 offset:4608
    v_mfma_f32_16x16x32_bf16 v[48:51], v[112:115], v[128:131], v[48:51]
    ds_read_b128 v[144:147], v169 offset:53248
    v_mfma_f32_16x16x32_bf16 v[52:55], v[112:115], v[132:135], v[52:55]
    ds_read_b128 v[148:151], v169 offset:55296
    v_mfma_f32_16x16x32_bf16 v[88:91], v[172:175], v[112:115], v[88:91]
    v_mfma_f32_16x16x32_bf16 v[92:95], v[176:179], v[112:115], v[92:95]
    v_mfma_f32_16x16x32_bf16 v[56:59], v[120:123], v[116:119], v[56:59]
    v_mfma_f32_16x16x32_bf16 v[60:63], v[124:127], v[116:119], v[60:63]
    v_mfma_f32_16x16x32_bf16 v[64:67], v[116:119], v[128:131], v[64:67]
    v_mfma_f32_16x16x32_bf16 v[68:71], v[116:119], v[132:135], v[68:71]
    v_mfma_f32_16x16x32_bf16 v[96:99], v[172:175], v[116:119], v[96:99]
    v_mfma_f32_16x16x32_bf16 v[100:103], v[176:179], v[116:119], v[100:103]
    s_waitcnt lgkmcnt(0)
    s_barrier
    v_mfma_f32_16x16x32_bf16 v[8:11], v[152:155], v[136:139], v[8:11]
    ds_read_b128 v[104:107], v168 offset:0
    v_mfma_f32_16x16x32_bf16 v[12:15], v[156:159], v[136:139], v[12:15]
    ds_read_b64_tr_b16 v[120:121], v170 offset:0
    v_mfma_f32_16x16x32_bf16 v[16:19], v[136:139], v[160:163], v[16:19]
    ds_read_b64_tr_b16 v[122:123], v170 offset:512
    v_mfma_f32_16x16x32_bf16 v[20:23], v[136:139], v[164:167], v[20:23]
    ds_read_b64_tr_b16 v[124:125], v171 offset:0
    v_mfma_f32_16x16x32_bf16 v[72:75], v[180:183], v[136:139], v[72:75]
    ds_read_b64_tr_b16 v[126:127], v171 offset:512
    v_mfma_f32_16x16x32_bf16 v[76:79], v[184:187], v[136:139], v[76:79]
    ds_read_b128 v[108:111], v168 offset:2048
    v_mfma_f32_16x16x32_bf16 v[24:27], v[152:155], v[140:143], v[24:27]
    ds_read_b64_tr_b16 v[128:129], v170 offset:8192
    v_mfma_f32_16x16x32_bf16 v[28:31], v[156:159], v[140:143], v[28:31]
    ds_read_b64_tr_b16 v[130:131], v170 offset:8704
    v_mfma_f32_16x16x32_bf16 v[32:35], v[140:143], v[160:163], v[32:35]
    ds_read_b64_tr_b16 v[132:133], v171 offset:8192
    v_mfma_f32_16x16x32_bf16 v[36:39], v[140:143], v[164:167], v[36:39]
    ds_read_b64_tr_b16 v[134:135], v171 offset:8704
    v_mfma_f32_16x16x32_bf16 v[80:83], v[180:183], v[140:143], v[80:83]
    ds_read_b64_tr_b16 v[172:173], v189 offset:8192
    v_mfma_f32_16x16x32_bf16 v[84:87], v[184:187], v[140:143], v[84:87]
    ds_read_b64_tr_b16 v[174:175], v189 offset:8704
    v_mfma_f32_16x16x32_bf16 v[40:43], v[152:155], v[144:147], v[40:43]
    ds_read_b64_tr_b16 v[176:177], v191 offset:8192
    v_mfma_f32_16x16x32_bf16 v[44:47], v[156:159], v[144:147], v[44:47]
    ds_read_b64_tr_b16 v[178:179], v191 offset:8704
    v_mfma_f32_16x16x32_bf16 v[48:51], v[144:147], v[160:163], v[48:51]
    ds_read_b128 v[112:115], v168 offset:4096
    v_mfma_f32_16x16x32_bf16 v[52:55], v[144:147], v[164:167], v[52:55]
    ds_read_b128 v[116:119], v168 offset:6144
    v_mfma_f32_16x16x32_bf16 v[88:91], v[180:183], v[144:147], v[88:91]
    v_mfma_f32_16x16x32_bf16 v[92:95], v[184:187], v[144:147], v[92:95]
    v_mfma_f32_16x16x32_bf16 v[56:59], v[152:155], v[148:151], v[56:59]
    v_mfma_f32_16x16x32_bf16 v[60:63], v[156:159], v[148:151], v[60:63]
    v_mfma_f32_16x16x32_bf16 v[64:67], v[148:151], v[160:163], v[64:67]
    v_mfma_f32_16x16x32_bf16 v[68:71], v[148:151], v[164:167], v[68:71]
    v_mfma_f32_16x16x32_bf16 v[96:99], v[180:183], v[148:151], v[96:99]
    v_mfma_f32_16x16x32_bf16 v[100:103], v[184:187], v[148:151], v[100:103]
    s_waitcnt lgkmcnt(0)
    v_mfma_f32_16x16x32_bf16 v[8:11], v[120:123], v[104:107], v[8:11]
    ds_read_b128 v[136:139], v169 offset:0
    v_mfma_f32_16x16x32_bf16 v[12:15], v[124:127], v[104:107], v[12:15]
    ds_read_b64_tr_b16 v[152:153], v170 offset:4096
    v_mfma_f32_16x16x32_bf16 v[16:19], v[104:107], v[128:131], v[16:19]
    ds_read_b64_tr_b16 v[154:155], v170 offset:4608
    v_mfma_f32_16x16x32_bf16 v[20:23], v[104:107], v[132:135], v[20:23]
    ds_read_b64_tr_b16 v[156:157], v171 offset:4096
    v_mfma_f32_16x16x32_bf16 v[72:75], v[172:175], v[104:107], v[72:75]
    ds_read_b64_tr_b16 v[158:159], v171 offset:4608
    v_mfma_f32_16x16x32_bf16 v[76:79], v[176:179], v[104:107], v[76:79]
    ds_read_b128 v[140:143], v169 offset:2048
    v_mfma_f32_16x16x32_bf16 v[24:27], v[120:123], v[108:111], v[24:27]
    ds_read_b64_tr_b16 v[160:161], v170 offset:12288
    v_mfma_f32_16x16x32_bf16 v[28:31], v[124:127], v[108:111], v[28:31]
    ds_read_b64_tr_b16 v[162:163], v170 offset:12800
    v_mfma_f32_16x16x32_bf16 v[32:35], v[108:111], v[128:131], v[32:35]
    ds_read_b64_tr_b16 v[164:165], v171 offset:12288
    v_mfma_f32_16x16x32_bf16 v[36:39], v[108:111], v[132:135], v[36:39]
    ds_read_b64_tr_b16 v[166:167], v171 offset:12800
    v_mfma_f32_16x16x32_bf16 v[80:83], v[172:175], v[108:111], v[80:83]
    ds_read_b64_tr_b16 v[180:181], v189 offset:12288
    v_mfma_f32_16x16x32_bf16 v[84:87], v[176:179], v[108:111], v[84:87]
    ds_read_b64_tr_b16 v[182:183], v189 offset:12800
    v_mfma_f32_16x16x32_bf16 v[40:43], v[120:123], v[112:115], v[40:43]
    ds_read_b64_tr_b16 v[184:185], v191 offset:12288
    v_mfma_f32_16x16x32_bf16 v[44:47], v[124:127], v[112:115], v[44:47]
    ds_read_b64_tr_b16 v[186:187], v191 offset:12800
    v_mfma_f32_16x16x32_bf16 v[48:51], v[112:115], v[128:131], v[48:51]
    ds_read_b128 v[144:147], v169 offset:4096
    v_mfma_f32_16x16x32_bf16 v[52:55], v[112:115], v[132:135], v[52:55]
    ds_read_b128 v[148:151], v169 offset:6144
    v_mfma_f32_16x16x32_bf16 v[88:91], v[172:175], v[112:115], v[88:91]
    v_mfma_f32_16x16x32_bf16 v[92:95], v[176:179], v[112:115], v[92:95]
    v_mfma_f32_16x16x32_bf16 v[56:59], v[120:123], v[116:119], v[56:59]
    v_mfma_f32_16x16x32_bf16 v[60:63], v[124:127], v[116:119], v[60:63]
    v_mfma_f32_16x16x32_bf16 v[64:67], v[116:119], v[128:131], v[64:67]
    v_mfma_f32_16x16x32_bf16 v[68:71], v[116:119], v[132:135], v[68:71]
    v_mfma_f32_16x16x32_bf16 v[96:99], v[172:175], v[116:119], v[96:99]
    v_mfma_f32_16x16x32_bf16 v[100:103], v[176:179], v[116:119], v[100:103]
    s_waitcnt lgkmcnt(0)
    s_barrier
    v_mfma_f32_16x16x32_bf16 v[8:11], v[152:155], v[136:139], v[8:11]
    ds_read_b128 v[104:107], v168 offset:16384
    v_mfma_f32_16x16x32_bf16 v[12:15], v[156:159], v[136:139], v[12:15]
    ds_read_b64_tr_b16 v[120:121], v170 offset:16384
    v_mfma_f32_16x16x32_bf16 v[16:19], v[136:139], v[160:163], v[16:19]
    ds_read_b64_tr_b16 v[122:123], v170 offset:16896
    v_mfma_f32_16x16x32_bf16 v[20:23], v[136:139], v[164:167], v[20:23]
    ds_read_b64_tr_b16 v[124:125], v171 offset:16384
    v_mfma_f32_16x16x32_bf16 v[72:75], v[180:183], v[136:139], v[72:75]
    ds_read_b64_tr_b16 v[126:127], v171 offset:16896
    v_mfma_f32_16x16x32_bf16 v[76:79], v[184:187], v[136:139], v[76:79]
    ds_read_b128 v[108:111], v168 offset:18432
    v_mfma_f32_16x16x32_bf16 v[24:27], v[152:155], v[140:143], v[24:27]
    ds_read_b64_tr_b16 v[128:129], v170 offset:24576
    v_mfma_f32_16x16x32_bf16 v[28:31], v[156:159], v[140:143], v[28:31]
    ds_read_b64_tr_b16 v[130:131], v170 offset:25088
    v_mfma_f32_16x16x32_bf16 v[32:35], v[140:143], v[160:163], v[32:35]
    ds_read_b64_tr_b16 v[132:133], v171 offset:24576
    v_mfma_f32_16x16x32_bf16 v[36:39], v[140:143], v[164:167], v[36:39]
    ds_read_b64_tr_b16 v[134:135], v171 offset:25088
    v_mfma_f32_16x16x32_bf16 v[80:83], v[180:183], v[140:143], v[80:83]
    ds_read_b64_tr_b16 v[172:173], v189 offset:16384
    v_mfma_f32_16x16x32_bf16 v[84:87], v[184:187], v[140:143], v[84:87]
    ds_read_b64_tr_b16 v[174:175], v189 offset:16896
    v_mfma_f32_16x16x32_bf16 v[40:43], v[152:155], v[144:147], v[40:43]
    ds_read_b64_tr_b16 v[176:177], v191 offset:16384
    v_mfma_f32_16x16x32_bf16 v[44:47], v[156:159], v[144:147], v[44:47]
    ds_read_b64_tr_b16 v[178:179], v191 offset:16896
    v_mfma_f32_16x16x32_bf16 v[48:51], v[144:147], v[160:163], v[48:51]
    ds_read_b128 v[112:115], v168 offset:20480
    v_mfma_f32_16x16x32_bf16 v[52:55], v[144:147], v[164:167], v[52:55]
    ds_read_b128 v[116:119], v168 offset:22528
    v_mfma_f32_16x16x32_bf16 v[88:91], v[180:183], v[144:147], v[88:91]
    v_mfma_f32_16x16x32_bf16 v[92:95], v[184:187], v[144:147], v[92:95]
    v_mfma_f32_16x16x32_bf16 v[56:59], v[152:155], v[148:151], v[56:59]
    v_mfma_f32_16x16x32_bf16 v[60:63], v[156:159], v[148:151], v[60:63]
    v_mfma_f32_16x16x32_bf16 v[64:67], v[148:151], v[160:163], v[64:67]
    v_mfma_f32_16x16x32_bf16 v[68:71], v[148:151], v[164:167], v[68:71]
    v_mfma_f32_16x16x32_bf16 v[96:99], v[180:183], v[148:151], v[96:99]
    v_mfma_f32_16x16x32_bf16 v[100:103], v[184:187], v[148:151], v[100:103]
    s_waitcnt lgkmcnt(0)
    v_mfma_f32_16x16x32_bf16 v[8:11], v[120:123], v[104:107], v[8:11]
    ds_read_b128 v[136:139], v169 offset:16384
    v_mfma_f32_16x16x32_bf16 v[12:15], v[124:127], v[104:107], v[12:15]
    ds_read_b64_tr_b16 v[152:153], v170 offset:20480
    v_mfma_f32_16x16x32_bf16 v[16:19], v[104:107], v[128:131], v[16:19]
    ds_read_b64_tr_b16 v[154:155], v170 offset:20992
    v_mfma_f32_16x16x32_bf16 v[20:23], v[104:107], v[132:135], v[20:23]
    ds_read_b64_tr_b16 v[156:157], v171 offset:20480
    v_mfma_f32_16x16x32_bf16 v[72:75], v[172:175], v[104:107], v[72:75]
    ds_read_b64_tr_b16 v[158:159], v171 offset:20992
    v_mfma_f32_16x16x32_bf16 v[76:79], v[176:179], v[104:107], v[76:79]
    ds_read_b128 v[140:143], v169 offset:18432
    v_mfma_f32_16x16x32_bf16 v[24:27], v[120:123], v[108:111], v[24:27]
    ds_read_b64_tr_b16 v[160:161], v170 offset:28672
    v_mfma_f32_16x16x32_bf16 v[28:31], v[124:127], v[108:111], v[28:31]
    ds_read_b64_tr_b16 v[162:163], v170 offset:29184
    v_mfma_f32_16x16x32_bf16 v[32:35], v[108:111], v[128:131], v[32:35]
    ds_read_b64_tr_b16 v[164:165], v171 offset:28672
    v_mfma_f32_16x16x32_bf16 v[36:39], v[108:111], v[132:135], v[36:39]
    ds_read_b64_tr_b16 v[166:167], v171 offset:29184
    v_mfma_f32_16x16x32_bf16 v[80:83], v[172:175], v[108:111], v[80:83]
    ds_read_b64_tr_b16 v[180:181], v189 offset:20480
    v_mfma_f32_16x16x32_bf16 v[84:87], v[176:179], v[108:111], v[84:87]
    ds_read_b64_tr_b16 v[182:183], v189 offset:20992
    v_mfma_f32_16x16x32_bf16 v[40:43], v[120:123], v[112:115], v[40:43]
    ds_read_b64_tr_b16 v[184:185], v191 offset:20480
    v_mfma_f32_16x16x32_bf16 v[44:47], v[124:127], v[112:115], v[44:47]
    ds_read_b64_tr_b16 v[186:187], v191 offset:20992
    v_mfma_f32_16x16x32_bf16 v[48:51], v[112:115], v[128:131], v[48:51]
    ds_read_b128 v[144:147], v169 offset:20480
    v_mfma_f32_16x16x32_bf16 v[52:55], v[112:115], v[132:135], v[52:55]
    ds_read_b128 v[148:151], v169 offset:22528
    v_mfma_f32_16x16x32_bf16 v[88:91], v[172:175], v[112:115], v[88:91]
    v_mfma_f32_16x16x32_bf16 v[92:95], v[176:179], v[112:115], v[92:95]
    v_mfma_f32_16x16x32_bf16 v[56:59], v[120:123], v[116:119], v[56:59]
    v_mfma_f32_16x16x32_bf16 v[60:63], v[124:127], v[116:119], v[60:63]
    v_mfma_f32_16x16x32_bf16 v[64:67], v[116:119], v[128:131], v[64:67]
    v_mfma_f32_16x16x32_bf16 v[68:71], v[116:119], v[132:135], v[68:71]
    v_mfma_f32_16x16x32_bf16 v[96:99], v[172:175], v[116:119], v[96:99]
    v_mfma_f32_16x16x32_bf16 v[100:103], v[176:179], v[116:119], v[100:103]
    s_waitcnt lgkmcnt(0)
    s_barrier
    v_mfma_f32_16x16x32_bf16 v[8:11], v[152:155], v[136:139], v[8:11]
    ds_read_b128 v[104:107], v168 offset:32768
    v_mfma_f32_16x16x32_bf16 v[12:15], v[156:159], v[136:139], v[12:15]
    ds_read_b64_tr_b16 v[120:121], v170 offset:32768
    v_mfma_f32_16x16x32_bf16 v[16:19], v[136:139], v[160:163], v[16:19]
    ds_read_b64_tr_b16 v[122:123], v170 offset:33280
    v_mfma_f32_16x16x32_bf16 v[20:23], v[136:139], v[164:167], v[20:23]
    ds_read_b64_tr_b16 v[124:125], v171 offset:32768
    v_mfma_f32_16x16x32_bf16 v[72:75], v[180:183], v[136:139], v[72:75]
    ds_read_b64_tr_b16 v[126:127], v171 offset:33280
    v_mfma_f32_16x16x32_bf16 v[76:79], v[184:187], v[136:139], v[76:79]
    ds_read_b128 v[108:111], v168 offset:34816
    v_mfma_f32_16x16x32_bf16 v[24:27], v[152:155], v[140:143], v[24:27]
    ds_read_b64_tr_b16 v[128:129], v170 offset:40960
    v_mfma_f32_16x16x32_bf16 v[28:31], v[156:159], v[140:143], v[28:31]
    ds_read_b64_tr_b16 v[130:131], v170 offset:41472
    v_mfma_f32_16x16x32_bf16 v[32:35], v[140:143], v[160:163], v[32:35]
    ds_read_b64_tr_b16 v[132:133], v171 offset:40960
    v_mfma_f32_16x16x32_bf16 v[36:39], v[140:143], v[164:167], v[36:39]
    ds_read_b64_tr_b16 v[134:135], v171 offset:41472
    v_mfma_f32_16x16x32_bf16 v[80:83], v[180:183], v[140:143], v[80:83]
    ds_read_b64_tr_b16 v[172:173], v189 offset:0
    v_mfma_f32_16x16x32_bf16 v[84:87], v[184:187], v[140:143], v[84:87]
    ds_read_b64_tr_b16 v[174:175], v189 offset:512
    v_mfma_f32_16x16x32_bf16 v[40:43], v[152:155], v[144:147], v[40:43]
    ds_read_b64_tr_b16 v[176:177], v191 offset:0
    v_mfma_f32_16x16x32_bf16 v[44:47], v[156:159], v[144:147], v[44:47]
    ds_read_b64_tr_b16 v[178:179], v191 offset:512
    v_mfma_f32_16x16x32_bf16 v[48:51], v[144:147], v[160:163], v[48:51]
    ds_read_b128 v[112:115], v168 offset:36864
    v_mfma_f32_16x16x32_bf16 v[52:55], v[144:147], v[164:167], v[52:55]
    ds_read_b128 v[116:119], v168 offset:38912
    v_mfma_f32_16x16x32_bf16 v[88:91], v[180:183], v[144:147], v[88:91]
    v_mfma_f32_16x16x32_bf16 v[92:95], v[184:187], v[144:147], v[92:95]
    v_mfma_f32_16x16x32_bf16 v[56:59], v[152:155], v[148:151], v[56:59]
    v_mfma_f32_16x16x32_bf16 v[60:63], v[156:159], v[148:151], v[60:63]
    v_mfma_f32_16x16x32_bf16 v[64:67], v[148:151], v[160:163], v[64:67]
    v_mfma_f32_16x16x32_bf16 v[68:71], v[148:151], v[164:167], v[68:71]
    v_mfma_f32_16x16x32_bf16 v[96:99], v[180:183], v[148:151], v[96:99]
    v_mfma_f32_16x16x32_bf16 v[100:103], v[184:187], v[148:151], v[100:103]
    s_waitcnt lgkmcnt(0)
    v_mfma_f32_16x16x32_bf16 v[8:11], v[120:123], v[104:107], v[8:11]
    ds_read_b128 v[136:139], v169 offset:32768
    v_mfma_f32_16x16x32_bf16 v[12:15], v[124:127], v[104:107], v[12:15]
    ds_read_b64_tr_b16 v[152:153], v170 offset:36864
    v_mfma_f32_16x16x32_bf16 v[16:19], v[104:107], v[128:131], v[16:19]
    ds_read_b64_tr_b16 v[154:155], v170 offset:37376
    v_mfma_f32_16x16x32_bf16 v[20:23], v[104:107], v[132:135], v[20:23]
    ds_read_b64_tr_b16 v[156:157], v171 offset:36864
    v_mfma_f32_16x16x32_bf16 v[72:75], v[172:175], v[104:107], v[72:75]
    ds_read_b64_tr_b16 v[158:159], v171 offset:37376
    v_mfma_f32_16x16x32_bf16 v[76:79], v[176:179], v[104:107], v[76:79]
    ds_read_b128 v[140:143], v169 offset:34816
    v_mfma_f32_16x16x32_bf16 v[24:27], v[120:123], v[108:111], v[24:27]
    ds_read_b64_tr_b16 v[160:161], v170 offset:45056
    v_mfma_f32_16x16x32_bf16 v[28:31], v[124:127], v[108:111], v[28:31]
    ds_read_b64_tr_b16 v[162:163], v170 offset:45568
    v_mfma_f32_16x16x32_bf16 v[32:35], v[108:111], v[128:131], v[32:35]
    ds_read_b64_tr_b16 v[164:165], v171 offset:45056
    v_mfma_f32_16x16x32_bf16 v[36:39], v[108:111], v[132:135], v[36:39]
    ds_read_b64_tr_b16 v[166:167], v171 offset:45568
    v_mfma_f32_16x16x32_bf16 v[80:83], v[172:175], v[108:111], v[80:83]
    ds_read_b64_tr_b16 v[180:181], v189 offset:4096
    v_mfma_f32_16x16x32_bf16 v[84:87], v[176:179], v[108:111], v[84:87]
    ds_read_b64_tr_b16 v[182:183], v189 offset:4608
    v_mfma_f32_16x16x32_bf16 v[40:43], v[120:123], v[112:115], v[40:43]
    ds_read_b64_tr_b16 v[184:185], v191 offset:4096
    v_mfma_f32_16x16x32_bf16 v[44:47], v[124:127], v[112:115], v[44:47]
    ds_read_b64_tr_b16 v[186:187], v191 offset:4608
    v_mfma_f32_16x16x32_bf16 v[48:51], v[112:115], v[128:131], v[48:51]
    ds_read_b128 v[144:147], v169 offset:36864
    v_mfma_f32_16x16x32_bf16 v[52:55], v[112:115], v[132:135], v[52:55]
    ds_read_b128 v[148:151], v169 offset:38912
    v_mfma_f32_16x16x32_bf16 v[88:91], v[172:175], v[112:115], v[88:91]
    v_mfma_f32_16x16x32_bf16 v[92:95], v[176:179], v[112:115], v[92:95]
    v_mfma_f32_16x16x32_bf16 v[56:59], v[120:123], v[116:119], v[56:59]
    v_mfma_f32_16x16x32_bf16 v[60:63], v[124:127], v[116:119], v[60:63]
    v_mfma_f32_16x16x32_bf16 v[64:67], v[116:119], v[128:131], v[64:67]
    v_mfma_f32_16x16x32_bf16 v[68:71], v[116:119], v[132:135], v[68:71]
    v_mfma_f32_16x16x32_bf16 v[96:99], v[172:175], v[116:119], v[96:99]
    v_mfma_f32_16x16x32_bf16 v[100:103], v[176:179], v[116:119], v[100:103]
    s_waitcnt lgkmcnt(0)
    s_barrier
    v_mfma_f32_16x16x32_bf16 v[8:11], v[152:155], v[136:139], v[8:11]
    ds_read_b128 v[104:107], v168 offset:49152
    v_mfma_f32_16x16x32_bf16 v[12:15], v[156:159], v[136:139], v[12:15]
    ds_read_b64_tr_b16 v[120:121], v170 offset:49152
    v_mfma_f32_16x16x32_bf16 v[16:19], v[136:139], v[160:163], v[16:19]
    ds_read_b64_tr_b16 v[122:123], v170 offset:49664
    v_mfma_f32_16x16x32_bf16 v[20:23], v[136:139], v[164:167], v[20:23]
    ds_read_b64_tr_b16 v[124:125], v171 offset:49152
    v_mfma_f32_16x16x32_bf16 v[72:75], v[180:183], v[136:139], v[72:75]
    ds_read_b64_tr_b16 v[126:127], v171 offset:49664
    v_mfma_f32_16x16x32_bf16 v[76:79], v[184:187], v[136:139], v[76:79]
    ds_read_b128 v[108:111], v168 offset:51200
    v_mfma_f32_16x16x32_bf16 v[24:27], v[152:155], v[140:143], v[24:27]
    ds_read_b64_tr_b16 v[128:129], v170 offset:57344
    v_mfma_f32_16x16x32_bf16 v[28:31], v[156:159], v[140:143], v[28:31]
    ds_read_b64_tr_b16 v[130:131], v170 offset:57856
    v_mfma_f32_16x16x32_bf16 v[32:35], v[140:143], v[160:163], v[32:35]
    ds_read_b64_tr_b16 v[132:133], v171 offset:57344
    v_mfma_f32_16x16x32_bf16 v[36:39], v[140:143], v[164:167], v[36:39]
    ds_read_b64_tr_b16 v[134:135], v171 offset:57856
    v_mfma_f32_16x16x32_bf16 v[80:83], v[180:183], v[140:143], v[80:83]
    ds_read_b64_tr_b16 v[172:173], v189 offset:8192
    v_mfma_f32_16x16x32_bf16 v[84:87], v[184:187], v[140:143], v[84:87]
    ds_read_b64_tr_b16 v[174:175], v189 offset:8704
    v_mfma_f32_16x16x32_bf16 v[40:43], v[152:155], v[144:147], v[40:43]
    ds_read_b64_tr_b16 v[176:177], v191 offset:8192
    v_mfma_f32_16x16x32_bf16 v[44:47], v[156:159], v[144:147], v[44:47]
    ds_read_b64_tr_b16 v[178:179], v191 offset:8704
    v_mfma_f32_16x16x32_bf16 v[48:51], v[144:147], v[160:163], v[48:51]
    ds_read_b128 v[112:115], v168 offset:53248
    v_mfma_f32_16x16x32_bf16 v[52:55], v[144:147], v[164:167], v[52:55]
    ds_read_b128 v[116:119], v168 offset:55296
    v_mfma_f32_16x16x32_bf16 v[88:91], v[180:183], v[144:147], v[88:91]
    v_mfma_f32_16x16x32_bf16 v[92:95], v[184:187], v[144:147], v[92:95]
    v_mfma_f32_16x16x32_bf16 v[56:59], v[152:155], v[148:151], v[56:59]
    v_mfma_f32_16x16x32_bf16 v[60:63], v[156:159], v[148:151], v[60:63]
    v_mfma_f32_16x16x32_bf16 v[64:67], v[148:151], v[160:163], v[64:67]
    v_mfma_f32_16x16x32_bf16 v[68:71], v[148:151], v[164:167], v[68:71]
    v_mfma_f32_16x16x32_bf16 v[96:99], v[180:183], v[148:151], v[96:99]
    v_mfma_f32_16x16x32_bf16 v[100:103], v[184:187], v[148:151], v[100:103]
    s_waitcnt lgkmcnt(0)
    v_mfma_f32_16x16x32_bf16 v[8:11], v[120:123], v[104:107], v[8:11]
    ds_read_b128 v[136:139], v169 offset:49152
    v_mfma_f32_16x16x32_bf16 v[12:15], v[124:127], v[104:107], v[12:15]
    ds_read_b64_tr_b16 v[152:153], v170 offset:53248
    v_mfma_f32_16x16x32_bf16 v[16:19], v[104:107], v[128:131], v[16:19]
    ds_read_b64_tr_b16 v[154:155], v170 offset:53760
    v_mfma_f32_16x16x32_bf16 v[20:23], v[104:107], v[132:135], v[20:23]
    ds_read_b64_tr_b16 v[156:157], v171 offset:53248
    v_mfma_f32_16x16x32_bf16 v[72:75], v[172:175], v[104:107], v[72:75]
    ds_read_b64_tr_b16 v[158:159], v171 offset:53760
    v_mfma_f32_16x16x32_bf16 v[76:79], v[176:179], v[104:107], v[76:79]
    ds_read_b128 v[140:143], v169 offset:51200
    v_mfma_f32_16x16x32_bf16 v[24:27], v[120:123], v[108:111], v[24:27]
    ds_read_b64_tr_b16 v[160:161], v170 offset:61440
    v_mfma_f32_16x16x32_bf16 v[28:31], v[124:127], v[108:111], v[28:31]
    ds_read_b64_tr_b16 v[162:163], v170 offset:61952
    v_mfma_f32_16x16x32_bf16 v[32:35], v[108:111], v[128:131], v[32:35]
    ds_read_b64_tr_b16 v[164:165], v171 offset:61440
    v_mfma_f32_16x16x32_bf16 v[36:39], v[108:111], v[132:135], v[36:39]
    ds_read_b64_tr_b16 v[166:167], v171 offset:61952
    v_mfma_f32_16x16x32_bf16 v[80:83], v[172:175], v[108:111], v[80:83]
    ds_read_b64_tr_b16 v[180:181], v189 offset:12288
    v_mfma_f32_16x16x32_bf16 v[84:87], v[176:179], v[108:111], v[84:87]
    ds_read_b64_tr_b16 v[182:183], v189 offset:12800
    v_mfma_f32_16x16x32_bf16 v[40:43], v[120:123], v[112:115], v[40:43]
    ds_read_b64_tr_b16 v[184:185], v191 offset:12288
    v_mfma_f32_16x16x32_bf16 v[44:47], v[124:127], v[112:115], v[44:47]
    ds_read_b64_tr_b16 v[186:187], v191 offset:12800
    v_mfma_f32_16x16x32_bf16 v[48:51], v[112:115], v[128:131], v[48:51]
    ds_read_b128 v[144:147], v169 offset:53248
    v_mfma_f32_16x16x32_bf16 v[52:55], v[112:115], v[132:135], v[52:55]
    ds_read_b128 v[148:151], v169 offset:55296
    v_mfma_f32_16x16x32_bf16 v[88:91], v[172:175], v[112:115], v[88:91]
    v_mfma_f32_16x16x32_bf16 v[92:95], v[176:179], v[112:115], v[92:95]
    v_mfma_f32_16x16x32_bf16 v[56:59], v[120:123], v[116:119], v[56:59]
    v_mfma_f32_16x16x32_bf16 v[60:63], v[124:127], v[116:119], v[60:63]
    v_mfma_f32_16x16x32_bf16 v[64:67], v[116:119], v[128:131], v[64:67]
    v_mfma_f32_16x16x32_bf16 v[68:71], v[116:119], v[132:135], v[68:71]
    v_mfma_f32_16x16x32_bf16 v[96:99], v[172:175], v[116:119], v[96:99]
    v_mfma_f32_16x16x32_bf16 v[100:103], v[176:179], v[116:119], v[100:103]
    s_waitcnt lgkmcnt(0)
    s_barrier
    v_mfma_f32_16x16x32_bf16 v[8:11], v[152:155], v[136:139], v[8:11]
    ds_read_b128 v[104:107], v168 offset:0
    v_mfma_f32_16x16x32_bf16 v[12:15], v[156:159], v[136:139], v[12:15]
    ds_read_b64_tr_b16 v[120:121], v170 offset:0
    v_mfma_f32_16x16x32_bf16 v[16:19], v[136:139], v[160:163], v[16:19]
    ds_read_b64_tr_b16 v[122:123], v170 offset:512
    v_mfma_f32_16x16x32_bf16 v[20:23], v[136:139], v[164:167], v[20:23]
    ds_read_b64_tr_b16 v[124:125], v171 offset:0
    v_mfma_f32_16x16x32_bf16 v[72:75], v[180:183], v[136:139], v[72:75]
    ds_read_b64_tr_b16 v[126:127], v171 offset:512
    v_mfma_f32_16x16x32_bf16 v[76:79], v[184:187], v[136:139], v[76:79]
    ds_read_b128 v[108:111], v168 offset:2048
    v_mfma_f32_16x16x32_bf16 v[24:27], v[152:155], v[140:143], v[24:27]
    ds_read_b64_tr_b16 v[128:129], v170 offset:8192
    v_mfma_f32_16x16x32_bf16 v[28:31], v[156:159], v[140:143], v[28:31]
    ds_read_b64_tr_b16 v[130:131], v170 offset:8704
    v_mfma_f32_16x16x32_bf16 v[32:35], v[140:143], v[160:163], v[32:35]
    ds_read_b64_tr_b16 v[132:133], v171 offset:8192
    v_mfma_f32_16x16x32_bf16 v[36:39], v[140:143], v[164:167], v[36:39]
    ds_read_b64_tr_b16 v[134:135], v171 offset:8704
    v_mfma_f32_16x16x32_bf16 v[80:83], v[180:183], v[140:143], v[80:83]
    ds_read_b64_tr_b16 v[172:173], v189 offset:16384
    v_mfma_f32_16x16x32_bf16 v[84:87], v[184:187], v[140:143], v[84:87]
    ds_read_b64_tr_b16 v[174:175], v189 offset:16896
    v_mfma_f32_16x16x32_bf16 v[40:43], v[152:155], v[144:147], v[40:43]
    ds_read_b64_tr_b16 v[176:177], v191 offset:16384
    v_mfma_f32_16x16x32_bf16 v[44:47], v[156:159], v[144:147], v[44:47]
    ds_read_b64_tr_b16 v[178:179], v191 offset:16896
    v_mfma_f32_16x16x32_bf16 v[48:51], v[144:147], v[160:163], v[48:51]
    ds_read_b128 v[112:115], v168 offset:4096
    v_mfma_f32_16x16x32_bf16 v[52:55], v[144:147], v[164:167], v[52:55]
    ds_read_b128 v[116:119], v168 offset:6144
    v_mfma_f32_16x16x32_bf16 v[88:91], v[180:183], v[144:147], v[88:91]
    v_mfma_f32_16x16x32_bf16 v[92:95], v[184:187], v[144:147], v[92:95]
    v_mfma_f32_16x16x32_bf16 v[56:59], v[152:155], v[148:151], v[56:59]
    v_mfma_f32_16x16x32_bf16 v[60:63], v[156:159], v[148:151], v[60:63]
    v_mfma_f32_16x16x32_bf16 v[64:67], v[148:151], v[160:163], v[64:67]
    v_mfma_f32_16x16x32_bf16 v[68:71], v[148:151], v[164:167], v[68:71]
    v_mfma_f32_16x16x32_bf16 v[96:99], v[180:183], v[148:151], v[96:99]
    v_mfma_f32_16x16x32_bf16 v[100:103], v[184:187], v[148:151], v[100:103]
    s_waitcnt lgkmcnt(0)
    v_mfma_f32_16x16x32_bf16 v[8:11], v[120:123], v[104:107], v[8:11]
    ds_read_b128 v[136:139], v169 offset:0
    v_mfma_f32_16x16x32_bf16 v[12:15], v[124:127], v[104:107], v[12:15]
    ds_read_b64_tr_b16 v[152:153], v170 offset:4096
    v_mfma_f32_16x16x32_bf16 v[16:19], v[104:107], v[128:131], v[16:19]
    ds_read_b64_tr_b16 v[154:155], v170 offset:4608
    v_mfma_f32_16x16x32_bf16 v[20:23], v[104:107], v[132:135], v[20:23]
    ds_read_b64_tr_b16 v[156:157], v171 offset:4096
    v_mfma_f32_16x16x32_bf16 v[72:75], v[172:175], v[104:107], v[72:75]
    ds_read_b64_tr_b16 v[158:159], v171 offset:4608
    v_mfma_f32_16x16x32_bf16 v[76:79], v[176:179], v[104:107], v[76:79]
    ds_read_b128 v[140:143], v169 offset:2048
    v_mfma_f32_16x16x32_bf16 v[24:27], v[120:123], v[108:111], v[24:27]
    ds_read_b64_tr_b16 v[160:161], v170 offset:12288
    v_mfma_f32_16x16x32_bf16 v[28:31], v[124:127], v[108:111], v[28:31]
    ds_read_b64_tr_b16 v[162:163], v170 offset:12800
    v_mfma_f32_16x16x32_bf16 v[32:35], v[108:111], v[128:131], v[32:35]
    ds_read_b64_tr_b16 v[164:165], v171 offset:12288
    v_mfma_f32_16x16x32_bf16 v[36:39], v[108:111], v[132:135], v[36:39]
    ds_read_b64_tr_b16 v[166:167], v171 offset:12800
    v_mfma_f32_16x16x32_bf16 v[80:83], v[172:175], v[108:111], v[80:83]
    ds_read_b64_tr_b16 v[180:181], v189 offset:20480
    v_mfma_f32_16x16x32_bf16 v[84:87], v[176:179], v[108:111], v[84:87]
    ds_read_b64_tr_b16 v[182:183], v189 offset:20992
    v_mfma_f32_16x16x32_bf16 v[40:43], v[120:123], v[112:115], v[40:43]
    ds_read_b64_tr_b16 v[184:185], v191 offset:20480
    v_mfma_f32_16x16x32_bf16 v[44:47], v[124:127], v[112:115], v[44:47]
    ds_read_b64_tr_b16 v[186:187], v191 offset:20992
    v_mfma_f32_16x16x32_bf16 v[48:51], v[112:115], v[128:131], v[48:51]
    ds_read_b128 v[144:147], v169 offset:4096
    v_mfma_f32_16x16x32_bf16 v[52:55], v[112:115], v[132:135], v[52:55]
    ds_read_b128 v[148:151], v169 offset:6144
    v_mfma_f32_16x16x32_bf16 v[88:91], v[172:175], v[112:115], v[88:91]
    v_mfma_f32_16x16x32_bf16 v[92:95], v[176:179], v[112:115], v[92:95]
    v_mfma_f32_16x16x32_bf16 v[56:59], v[120:123], v[116:119], v[56:59]
    v_mfma_f32_16x16x32_bf16 v[60:63], v[124:127], v[116:119], v[60:63]
    v_mfma_f32_16x16x32_bf16 v[64:67], v[116:119], v[128:131], v[64:67]
    v_mfma_f32_16x16x32_bf16 v[68:71], v[116:119], v[132:135], v[68:71]
    v_mfma_f32_16x16x32_bf16 v[96:99], v[172:175], v[116:119], v[96:99]
    v_mfma_f32_16x16x32_bf16 v[100:103], v[176:179], v[116:119], v[100:103]
    s_waitcnt lgkmcnt(0)
    s_barrier
    v_mfma_f32_16x16x32_bf16 v[8:11], v[152:155], v[136:139], v[8:11]
    ds_read_b128 v[104:107], v168 offset:16384
    v_mfma_f32_16x16x32_bf16 v[12:15], v[156:159], v[136:139], v[12:15]
    ds_read_b64_tr_b16 v[120:121], v170 offset:16384
    v_mfma_f32_16x16x32_bf16 v[16:19], v[136:139], v[160:163], v[16:19]
    ds_read_b64_tr_b16 v[122:123], v170 offset:16896
    v_mfma_f32_16x16x32_bf16 v[20:23], v[136:139], v[164:167], v[20:23]
    ds_read_b64_tr_b16 v[124:125], v171 offset:16384
    v_mfma_f32_16x16x32_bf16 v[72:75], v[180:183], v[136:139], v[72:75]
    ds_read_b64_tr_b16 v[126:127], v171 offset:16896
    v_mfma_f32_16x16x32_bf16 v[76:79], v[184:187], v[136:139], v[76:79]
    ds_read_b128 v[108:111], v168 offset:18432
    v_mfma_f32_16x16x32_bf16 v[24:27], v[152:155], v[140:143], v[24:27]
    ds_read_b64_tr_b16 v[128:129], v170 offset:24576
    v_mfma_f32_16x16x32_bf16 v[28:31], v[156:159], v[140:143], v[28:31]
    ds_read_b64_tr_b16 v[130:131], v170 offset:25088
    v_mfma_f32_16x16x32_bf16 v[32:35], v[140:143], v[160:163], v[32:35]
    ds_read_b64_tr_b16 v[132:133], v171 offset:24576
    v_mfma_f32_16x16x32_bf16 v[36:39], v[140:143], v[164:167], v[36:39]
    ds_read_b64_tr_b16 v[134:135], v171 offset:25088
    v_mfma_f32_16x16x32_bf16 v[80:83], v[180:183], v[140:143], v[80:83]
    ds_read_b64_tr_b16 v[172:173], v189 offset:0
    v_mfma_f32_16x16x32_bf16 v[84:87], v[184:187], v[140:143], v[84:87]
    ds_read_b64_tr_b16 v[174:175], v189 offset:512
    v_mfma_f32_16x16x32_bf16 v[40:43], v[152:155], v[144:147], v[40:43]
    ds_read_b64_tr_b16 v[176:177], v191 offset:0
    v_mfma_f32_16x16x32_bf16 v[44:47], v[156:159], v[144:147], v[44:47]
    ds_read_b64_tr_b16 v[178:179], v191 offset:512
    v_mfma_f32_16x16x32_bf16 v[48:51], v[144:147], v[160:163], v[48:51]
    ds_read_b128 v[112:115], v168 offset:20480
    v_mfma_f32_16x16x32_bf16 v[52:55], v[144:147], v[164:167], v[52:55]
    ds_read_b128 v[116:119], v168 offset:22528
    v_mfma_f32_16x16x32_bf16 v[88:91], v[180:183], v[144:147], v[88:91]
    v_mfma_f32_16x16x32_bf16 v[92:95], v[184:187], v[144:147], v[92:95]
    v_mfma_f32_16x16x32_bf16 v[56:59], v[152:155], v[148:151], v[56:59]
    v_mfma_f32_16x16x32_bf16 v[60:63], v[156:159], v[148:151], v[60:63]
    v_mfma_f32_16x16x32_bf16 v[64:67], v[148:151], v[160:163], v[64:67]
    v_mfma_f32_16x16x32_bf16 v[68:71], v[148:151], v[164:167], v[68:71]
    v_mfma_f32_16x16x32_bf16 v[96:99], v[180:183], v[148:151], v[96:99]
    v_mfma_f32_16x16x32_bf16 v[100:103], v[184:187], v[148:151], v[100:103]
    s_waitcnt lgkmcnt(0)
    v_mfma_f32_16x16x32_bf16 v[8:11], v[120:123], v[104:107], v[8:11]
    ds_read_b128 v[136:139], v169 offset:16384
    v_mfma_f32_16x16x32_bf16 v[12:15], v[124:127], v[104:107], v[12:15]
    ds_read_b64_tr_b16 v[152:153], v170 offset:20480
    v_mfma_f32_16x16x32_bf16 v[16:19], v[104:107], v[128:131], v[16:19]
    ds_read_b64_tr_b16 v[154:155], v170 offset:20992
    v_mfma_f32_16x16x32_bf16 v[20:23], v[104:107], v[132:135], v[20:23]
    ds_read_b64_tr_b16 v[156:157], v171 offset:20480
    v_mfma_f32_16x16x32_bf16 v[72:75], v[172:175], v[104:107], v[72:75]
    ds_read_b64_tr_b16 v[158:159], v171 offset:20992
    v_mfma_f32_16x16x32_bf16 v[76:79], v[176:179], v[104:107], v[76:79]
    ds_read_b128 v[140:143], v169 offset:18432
    v_mfma_f32_16x16x32_bf16 v[24:27], v[120:123], v[108:111], v[24:27]
    ds_read_b64_tr_b16 v[160:161], v170 offset:28672
    v_mfma_f32_16x16x32_bf16 v[28:31], v[124:127], v[108:111], v[28:31]
    ds_read_b64_tr_b16 v[162:163], v170 offset:29184
    v_mfma_f32_16x16x32_bf16 v[32:35], v[108:111], v[128:131], v[32:35]
    ds_read_b64_tr_b16 v[164:165], v171 offset:28672
    v_mfma_f32_16x16x32_bf16 v[36:39], v[108:111], v[132:135], v[36:39]
    ds_read_b64_tr_b16 v[166:167], v171 offset:29184
    v_mfma_f32_16x16x32_bf16 v[80:83], v[172:175], v[108:111], v[80:83]
    ds_read_b64_tr_b16 v[180:181], v189 offset:4096
    v_mfma_f32_16x16x32_bf16 v[84:87], v[176:179], v[108:111], v[84:87]
    ds_read_b64_tr_b16 v[182:183], v189 offset:4608
    v_mfma_f32_16x16x32_bf16 v[40:43], v[120:123], v[112:115], v[40:43]
    ds_read_b64_tr_b16 v[184:185], v191 offset:4096
    v_mfma_f32_16x16x32_bf16 v[44:47], v[124:127], v[112:115], v[44:47]
    ds_read_b64_tr_b16 v[186:187], v191 offset:4608
    v_mfma_f32_16x16x32_bf16 v[48:51], v[112:115], v[128:131], v[48:51]
    ds_read_b128 v[144:147], v169 offset:20480
    v_mfma_f32_16x16x32_bf16 v[52:55], v[112:115], v[132:135], v[52:55]
    ds_read_b128 v[148:151], v169 offset:22528
    v_mfma_f32_16x16x32_bf16 v[88:91], v[172:175], v[112:115], v[88:91]
    v_mfma_f32_16x16x32_bf16 v[92:95], v[176:179], v[112:115], v[92:95]
    v_mfma_f32_16x16x32_bf16 v[56:59], v[120:123], v[116:119], v[56:59]
    v_mfma_f32_16x16x32_bf16 v[60:63], v[124:127], v[116:119], v[60:63]
    v_mfma_f32_16x16x32_bf16 v[64:67], v[116:119], v[128:131], v[64:67]
    v_mfma_f32_16x16x32_bf16 v[68:71], v[116:119], v[132:135], v[68:71]
    v_mfma_f32_16x16x32_bf16 v[96:99], v[172:175], v[116:119], v[96:99]
    v_mfma_f32_16x16x32_bf16 v[100:103], v[176:179], v[116:119], v[100:103]
    s_waitcnt lgkmcnt(0)
    s_barrier
    v_mfma_f32_16x16x32_bf16 v[8:11], v[152:155], v[136:139], v[8:11]
    ds_read_b128 v[104:107], v168 offset:32768
    v_mfma_f32_16x16x32_bf16 v[12:15], v[156:159], v[136:139], v[12:15]
    ds_read_b64_tr_b16 v[120:121], v170 offset:32768
    v_mfma_f32_16x16x32_bf16 v[16:19], v[136:139], v[160:163], v[16:19]
    ds_read_b64_tr_b16 v[122:123], v170 offset:33280
    v_mfma_f32_16x16x32_bf16 v[20:23], v[136:139], v[164:167], v[20:23]
    ds_read_b64_tr_b16 v[124:125], v171 offset:32768
    v_mfma_f32_16x16x32_bf16 v[72:75], v[180:183], v[136:139], v[72:75]
    ds_read_b64_tr_b16 v[126:127], v171 offset:33280
    v_mfma_f32_16x16x32_bf16 v[76:79], v[184:187], v[136:139], v[76:79]
    ds_read_b128 v[108:111], v168 offset:34816
    v_mfma_f32_16x16x32_bf16 v[24:27], v[152:155], v[140:143], v[24:27]
    ds_read_b64_tr_b16 v[128:129], v170 offset:40960
    v_mfma_f32_16x16x32_bf16 v[28:31], v[156:159], v[140:143], v[28:31]
    ds_read_b64_tr_b16 v[130:131], v170 offset:41472
    v_mfma_f32_16x16x32_bf16 v[32:35], v[140:143], v[160:163], v[32:35]
    ds_read_b64_tr_b16 v[132:133], v171 offset:40960
    v_mfma_f32_16x16x32_bf16 v[36:39], v[140:143], v[164:167], v[36:39]
    ds_read_b64_tr_b16 v[134:135], v171 offset:41472
    v_mfma_f32_16x16x32_bf16 v[80:83], v[180:183], v[140:143], v[80:83]
    ds_read_b64_tr_b16 v[172:173], v189 offset:8192
    v_mfma_f32_16x16x32_bf16 v[84:87], v[184:187], v[140:143], v[84:87]
    ds_read_b64_tr_b16 v[174:175], v189 offset:8704
    v_mfma_f32_16x16x32_bf16 v[40:43], v[152:155], v[144:147], v[40:43]
    ds_read_b64_tr_b16 v[176:177], v191 offset:8192
    v_mfma_f32_16x16x32_bf16 v[44:47], v[156:159], v[144:147], v[44:47]
    ds_read_b64_tr_b16 v[178:179], v191 offset:8704
    v_mfma_f32_16x16x32_bf16 v[48:51], v[144:147], v[160:163], v[48:51]
    ds_read_b128 v[112:115], v168 offset:36864
    v_mfma_f32_16x16x32_bf16 v[52:55], v[144:147], v[164:167], v[52:55]
    ds_read_b128 v[116:119], v168 offset:38912
    v_mfma_f32_16x16x32_bf16 v[88:91], v[180:183], v[144:147], v[88:91]
    v_mfma_f32_16x16x32_bf16 v[92:95], v[184:187], v[144:147], v[92:95]
    v_mfma_f32_16x16x32_bf16 v[56:59], v[152:155], v[148:151], v[56:59]
    v_mfma_f32_16x16x32_bf16 v[60:63], v[156:159], v[148:151], v[60:63]
    v_mfma_f32_16x16x32_bf16 v[64:67], v[148:151], v[160:163], v[64:67]
    v_mfma_f32_16x16x32_bf16 v[68:71], v[148:151], v[164:167], v[68:71]
    v_mfma_f32_16x16x32_bf16 v[96:99], v[180:183], v[148:151], v[96:99]
    v_mfma_f32_16x16x32_bf16 v[100:103], v[184:187], v[148:151], v[100:103]
    s_waitcnt lgkmcnt(0)
    v_mfma_f32_16x16x32_bf16 v[8:11], v[120:123], v[104:107], v[8:11]
    ds_read_b128 v[136:139], v169 offset:32768
    v_mfma_f32_16x16x32_bf16 v[12:15], v[124:127], v[104:107], v[12:15]
    ds_read_b64_tr_b16 v[152:153], v170 offset:36864
    v_mfma_f32_16x16x32_bf16 v[16:19], v[104:107], v[128:131], v[16:19]
    ds_read_b64_tr_b16 v[154:155], v170 offset:37376
    v_mfma_f32_16x16x32_bf16 v[20:23], v[104:107], v[132:135], v[20:23]
    ds_read_b64_tr_b16 v[156:157], v171 offset:36864
    v_mfma_f32_16x16x32_bf16 v[72:75], v[172:175], v[104:107], v[72:75]
    ds_read_b64_tr_b16 v[158:159], v171 offset:37376
    v_mfma_f32_16x16x32_bf16 v[76:79], v[176:179], v[104:107], v[76:79]
    ds_read_b128 v[140:143], v169 offset:34816
    v_mfma_f32_16x16x32_bf16 v[24:27], v[120:123], v[108:111], v[24:27]
    ds_read_b64_tr_b16 v[160:161], v170 offset:45056
    v_mfma_f32_16x16x32_bf16 v[28:31], v[124:127], v[108:111], v[28:31]
    ds_read_b64_tr_b16 v[162:163], v170 offset:45568
    v_mfma_f32_16x16x32_bf16 v[32:35], v[108:111], v[128:131], v[32:35]
    ds_read_b64_tr_b16 v[164:165], v171 offset:45056
    v_mfma_f32_16x16x32_bf16 v[36:39], v[108:111], v[132:135], v[36:39]
    ds_read_b64_tr_b16 v[166:167], v171 offset:45568
    v_mfma_f32_16x16x32_bf16 v[80:83], v[172:175], v[108:111], v[80:83]
    ds_read_b64_tr_b16 v[180:181], v189 offset:12288
    v_mfma_f32_16x16x32_bf16 v[84:87], v[176:179], v[108:111], v[84:87]
    ds_read_b64_tr_b16 v[182:183], v189 offset:12800
    v_mfma_f32_16x16x32_bf16 v[40:43], v[120:123], v[112:115], v[40:43]
    ds_read_b64_tr_b16 v[184:185], v191 offset:12288
    v_mfma_f32_16x16x32_bf16 v[44:47], v[124:127], v[112:115], v[44:47]
    ds_read_b64_tr_b16 v[186:187], v191 offset:12800
    v_mfma_f32_16x16x32_bf16 v[48:51], v[112:115], v[128:131], v[48:51]
    ds_read_b128 v[144:147], v169 offset:36864
    v_mfma_f32_16x16x32_bf16 v[52:55], v[112:115], v[132:135], v[52:55]
    ds_read_b128 v[148:151], v169 offset:38912
    v_mfma_f32_16x16x32_bf16 v[88:91], v[172:175], v[112:115], v[88:91]
    v_mfma_f32_16x16x32_bf16 v[92:95], v[176:179], v[112:115], v[92:95]
    v_mfma_f32_16x16x32_bf16 v[56:59], v[120:123], v[116:119], v[56:59]
    v_mfma_f32_16x16x32_bf16 v[60:63], v[124:127], v[116:119], v[60:63]
    v_mfma_f32_16x16x32_bf16 v[64:67], v[116:119], v[128:131], v[64:67]
    v_mfma_f32_16x16x32_bf16 v[68:71], v[116:119], v[132:135], v[68:71]
    v_mfma_f32_16x16x32_bf16 v[96:99], v[172:175], v[116:119], v[96:99]
    v_mfma_f32_16x16x32_bf16 v[100:103], v[176:179], v[116:119], v[100:103]
    s_waitcnt lgkmcnt(0)
    s_barrier
    v_mfma_f32_16x16x32_bf16 v[8:11], v[152:155], v[136:139], v[8:11]
    ds_read_b128 v[104:107], v168 offset:49152
    v_mfma_f32_16x16x32_bf16 v[12:15], v[156:159], v[136:139], v[12:15]
    ds_read_b64_tr_b16 v[120:121], v170 offset:49152
    v_mfma_f32_16x16x32_bf16 v[16:19], v[136:139], v[160:163], v[16:19]
    ds_read_b64_tr_b16 v[122:123], v170 offset:49664
    v_mfma_f32_16x16x32_bf16 v[20:23], v[136:139], v[164:167], v[20:23]
    ds_read_b64_tr_b16 v[124:125], v171 offset:49152
    v_mfma_f32_16x16x32_bf16 v[72:75], v[180:183], v[136:139], v[72:75]
    ds_read_b64_tr_b16 v[126:127], v171 offset:49664
    v_mfma_f32_16x16x32_bf16 v[76:79], v[184:187], v[136:139], v[76:79]
    ds_read_b128 v[108:111], v168 offset:51200
    v_mfma_f32_16x16x32_bf16 v[24:27], v[152:155], v[140:143], v[24:27]
    ds_read_b64_tr_b16 v[128:129], v170 offset:57344
    v_mfma_f32_16x16x32_bf16 v[28:31], v[156:159], v[140:143], v[28:31]
    ds_read_b64_tr_b16 v[130:131], v170 offset:57856
    v_mfma_f32_16x16x32_bf16 v[32:35], v[140:143], v[160:163], v[32:35]
    ds_read_b64_tr_b16 v[132:133], v171 offset:57344
    v_mfma_f32_16x16x32_bf16 v[36:39], v[140:143], v[164:167], v[36:39]
    ds_read_b64_tr_b16 v[134:135], v171 offset:57856
    v_mfma_f32_16x16x32_bf16 v[80:83], v[180:183], v[140:143], v[80:83]
    ds_read_b64_tr_b16 v[172:173], v189 offset:16384
    v_mfma_f32_16x16x32_bf16 v[84:87], v[184:187], v[140:143], v[84:87]
    ds_read_b64_tr_b16 v[174:175], v189 offset:16896
    v_mfma_f32_16x16x32_bf16 v[40:43], v[152:155], v[144:147], v[40:43]
    ds_read_b64_tr_b16 v[176:177], v191 offset:16384
    v_mfma_f32_16x16x32_bf16 v[44:47], v[156:159], v[144:147], v[44:47]
    ds_read_b64_tr_b16 v[178:179], v191 offset:16896
    v_mfma_f32_16x16x32_bf16 v[48:51], v[144:147], v[160:163], v[48:51]
    ds_read_b128 v[112:115], v168 offset:53248
    v_mfma_f32_16x16x32_bf16 v[52:55], v[144:147], v[164:167], v[52:55]
    ds_read_b128 v[116:119], v168 offset:55296
    v_mfma_f32_16x16x32_bf16 v[88:91], v[180:183], v[144:147], v[88:91]
    v_mfma_f32_16x16x32_bf16 v[92:95], v[184:187], v[144:147], v[92:95]
    v_mfma_f32_16x16x32_bf16 v[56:59], v[152:155], v[148:151], v[56:59]
    v_mfma_f32_16x16x32_bf16 v[60:63], v[156:159], v[148:151], v[60:63]
    v_mfma_f32_16x16x32_bf16 v[64:67], v[148:151], v[160:163], v[64:67]
    v_mfma_f32_16x16x32_bf16 v[68:71], v[148:151], v[164:167], v[68:71]
    v_mfma_f32_16x16x32_bf16 v[96:99], v[180:183], v[148:151], v[96:99]
    v_mfma_f32_16x16x32_bf16 v[100:103], v[184:187], v[148:151], v[100:103]
    s_waitcnt lgkmcnt(0)
    v_mfma_f32_16x16x32_bf16 v[8:11], v[120:123], v[104:107], v[8:11]
    ds_read_b128 v[136:139], v169 offset:49152
    v_mfma_f32_16x16x32_bf16 v[12:15], v[124:127], v[104:107], v[12:15]
    ds_read_b64_tr_b16 v[152:153], v170 offset:53248
    v_mfma_f32_16x16x32_bf16 v[16:19], v[104:107], v[128:131], v[16:19]
    ds_read_b64_tr_b16 v[154:155], v170 offset:53760
    v_mfma_f32_16x16x32_bf16 v[20:23], v[104:107], v[132:135], v[20:23]
    ds_read_b64_tr_b16 v[156:157], v171 offset:53248
    v_mfma_f32_16x16x32_bf16 v[72:75], v[172:175], v[104:107], v[72:75]
    ds_read_b64_tr_b16 v[158:159], v171 offset:53760
    v_mfma_f32_16x16x32_bf16 v[76:79], v[176:179], v[104:107], v[76:79]
    ds_read_b128 v[140:143], v169 offset:51200
    v_mfma_f32_16x16x32_bf16 v[24:27], v[120:123], v[108:111], v[24:27]
    ds_read_b64_tr_b16 v[160:161], v170 offset:61440
    v_mfma_f32_16x16x32_bf16 v[28:31], v[124:127], v[108:111], v[28:31]
    ds_read_b64_tr_b16 v[162:163], v170 offset:61952
    v_mfma_f32_16x16x32_bf16 v[32:35], v[108:111], v[128:131], v[32:35]
    ds_read_b64_tr_b16 v[164:165], v171 offset:61440
    v_mfma_f32_16x16x32_bf16 v[36:39], v[108:111], v[132:135], v[36:39]
    ds_read_b64_tr_b16 v[166:167], v171 offset:61952
    v_mfma_f32_16x16x32_bf16 v[80:83], v[172:175], v[108:111], v[80:83]
    ds_read_b64_tr_b16 v[180:181], v189 offset:20480
    v_mfma_f32_16x16x32_bf16 v[84:87], v[176:179], v[108:111], v[84:87]
    ds_read_b64_tr_b16 v[182:183], v189 offset:20992
    v_mfma_f32_16x16x32_bf16 v[40:43], v[120:123], v[112:115], v[40:43]
    ds_read_b64_tr_b16 v[184:185], v191 offset:20480
    v_mfma_f32_16x16x32_bf16 v[44:47], v[124:127], v[112:115], v[44:47]
    ds_read_b64_tr_b16 v[186:187], v191 offset:20992
    v_mfma_f32_16x16x32_bf16 v[48:51], v[112:115], v[128:131], v[48:51]
    ds_read_b128 v[144:147], v169 offset:53248
    v_mfma_f32_16x16x32_bf16 v[52:55], v[112:115], v[132:135], v[52:55]
    ds_read_b128 v[148:151], v169 offset:55296
    v_mfma_f32_16x16x32_bf16 v[88:91], v[172:175], v[112:115], v[88:91]
    v_mfma_f32_16x16x32_bf16 v[92:95], v[176:179], v[112:115], v[92:95]
    v_mfma_f32_16x16x32_bf16 v[56:59], v[120:123], v[116:119], v[56:59]
    v_mfma_f32_16x16x32_bf16 v[60:63], v[124:127], v[116:119], v[60:63]
    v_mfma_f32_16x16x32_bf16 v[64:67], v[116:119], v[128:131], v[64:67]
    v_mfma_f32_16x16x32_bf16 v[68:71], v[116:119], v[132:135], v[68:71]
    v_mfma_f32_16x16x32_bf16 v[96:99], v[172:175], v[116:119], v[96:99]
    v_mfma_f32_16x16x32_bf16 v[100:103], v[176:179], v[116:119], v[100:103]
L_e1:
    s_waitcnt lgkmcnt(0)
    s_barrier
    v_mfma_f32_16x16x32_bf16 v[8:11], v[152:155], v[136:139], v[8:11]
    ds_read_b128 v[104:107], v168 offset:0
    v_mfma_f32_16x16x32_bf16 v[12:15], v[156:159], v[136:139], v[12:15]
    ds_read_b64_tr_b16 v[120:121], v170 offset:0
    v_mfma_f32_16x16x32_bf16 v[16:19], v[136:139], v[160:163], v[16:19]
    ds_read_b64_tr_b16 v[122:123], v170 offset:512
    v_mfma_f32_16x16x32_bf16 v[20:23], v[136:139], v[164:167], v[20:23]
    ds_read_b64_tr_b16 v[124:125], v171 offset:0
    v_mfma_f32_16x16x32_bf16 v[72:75], v[180:183], v[136:139], v[72:75]
    ds_read_b64_tr_b16 v[126:127], v171 offset:512
    v_mfma_f32_16x16x32_bf16 v[76:79], v[184:187], v[136:139], v[76:79]
    ds_read_b128 v[108:111], v168 offset:2048
    v_mfma_f32_16x16x32_bf16 v[24:27], v[152:155], v[140:143], v[24:27]
    ds_read_b64_tr_b16 v[128:129], v170 offset:8192
    v_mfma_f32_16x16x32_bf16 v[28:31], v[156:159], v[140:143], v[28:31]
    ds_read_b64_tr_b16 v[130:131], v170 offset:8704
    v_mfma_f32_16x16x32_bf16 v[32:35], v[140:143], v[160:163], v[32:35]
    ds_read_b64_tr_b16 v[132:133], v171 offset:8192
    v_mfma_f32_16x16x32_bf16 v[36:39], v[140:143], v[164:167], v[36:39]
    ds_read_b64_tr_b16 v[134:135], v171 offset:8704
    v_mfma_f32_16x16x32_bf16 v[80:83], v[180:183], v[140:143], v[80:83]
    ds_read_b128 v[112:115], v168 offset:4096
    v_mfma_f32_16x16x32_bf16 v[84:87], v[184:187], v[140:143], v[84:87]
    ds_read_b128 v[116:119], v168 offset:6144
    v_mfma_f32_16x16x32_bf16 v[40:43], v[152:155], v[144:147], v[40:43]
    v_mfma_f32_16x16x32_bf16 v[44:47], v[156:159], v[144:147], v[44:47]
    v_mfma_f32_16x16x32_bf16 v[48:51], v[144:147], v[160:163], v[48:51]
    v_mfma_f32_16x16x32_bf16 v[52:55], v[144:147], v[164:167], v[52:55]
    v_mfma_f32_16x16x32_bf16 v[88:91], v[180:183], v[144:147], v[88:91]
    v_mfma_f32_16x16x32_bf16 v[92:95], v[184:187], v[144:147], v[92:95]
    v_mfma_f32_16x16x32_bf16 v[56:59], v[152:155], v[148:151], v[56:59]
    v_mfma_f32_16x16x32_bf16 v[60:63], v[156:159], v[148:151], v[60:63]
    v_mfma_f32_16x16x32_bf16 v[64:67], v[148:151], v[160:163], v[64:67]
    v_mfma_f32_16x16x32_bf16 v[68:71], v[148:151], v[164:167], v[68:71]
    v_mfma_f32_16x16x32_bf16 v[96:99], v[180:183], v[148:151], v[96:99]
    v_mfma_f32_16x16x32_bf16 v[100:103], v[184:187], v[148:151], v[100:103]
    s_waitcnt lgkmcnt(0)
    v_mfma_f32_16x16x32_bf16 v[8:11], v[120:123], v[104:107], v[8:11]
    ds_read_b128 v[136:139], v169 offset:0
    v_mfma_f32_16x16x32_bf16 v[12:15], v[124:127], v[104:107], v[12:15]
    ds_read_b64_tr_b16 v[152:153], v170 offset:4096
    v_mfma_f32_16x16x32_bf16 v[16:19], v[104:107], v[128:131], v[16:19]
    ds_read_b64_tr_b16 v[154:155], v170 offset:4608
    v_mfma_f32_16x16x32_bf16 v[20:23], v[104:107], v[132:135], v[20:23]
    ds_read_b64_tr_b16 v[156:157], v171 offset:4096
    v_mfma_f32_16x16x32_bf16 v[24:27], v[120:123], v[108:111], v[24:27]
    ds_read_b64_tr_b16 v[158:159], v171 offset:4608
    v_mfma_f32_16x16x32_bf16 v[28:31], v[124:127], v[108:111], v[28:31]
    ds_read_b128 v[140:143], v169 offset:2048
    v_mfma_f32_16x16x32_bf16 v[32:35], v[108:111], v[128:131], v[32:35]
    ds_read_b64_tr_b16 v[160:161], v170 offset:12288
    v_mfma_f32_16x16x32_bf16 v[36:39], v[108:111], v[132:135], v[36:39]
    ds_read_b64_tr_b16 v[162:163], v170 offset:12800
    v_mfma_f32_16x16x32_bf16 v[40:43], v[120:123], v[112:115], v[40:43]
    ds_read_b64_tr_b16 v[164:165], v171 offset:12288
    ds_read_b128 v[196:199], v243 offset:320
    v_mfma_f32_16x16x32_bf16 v[44:47], v[124:127], v[112:115], v[44:47]
    ds_read_b64_tr_b16 v[166:167], v171 offset:12800
    ds_read_b128 v[192:195], v243 offset:256
    v_mfma_f32_16x16x32_bf16 v[48:51], v[112:115], v[128:131], v[48:51]
    ds_read_b128 v[144:147], v169 offset:4096
    ds_read_b128 v[220:223], v243 offset:64
    v_mfma_f32_16x16x32_bf16 v[52:55], v[112:115], v[132:135], v[52:55]
    ds_read_b128 v[148:151], v169 offset:6144
    ds_read_b128 v[216:219], v243 offset:0
    v_mfma_f32_16x16x32_bf16 v[56:59], v[120:123], v[116:119], v[56:59]
    ds_read_b32 v186, v240 offset:192
    v_mfma_f32_16x16x32_bf16 v[60:63], v[124:127], v[116:119], v[60:63]
    ds_read_b32 v184, v240 offset:128
    v_mfma_f32_16x16x32_bf16 v[64:67], v[116:119], v[128:131], v[64:67]
    ds_read_b32 v182, v240 offset:64
    v_mfma_f32_16x16x32_bf16 v[68:71], v[116:119], v[132:135], v[68:71]
    ds_read_b32 v180, v240 offset:0
    s_waitcnt lgkmcnt(0)
    v_mov_b32 v7, 13
    ds_write_b32 v249, v7
    v_mfma_f32_16x16x32_bf16 v[8:11], v[152:155], v[136:139], v[8:11]
    ds_read_b128 v[104:107], v168 offset:16384
    v_mfma_f32_16x16x32_bf16 v[12:15], v[156:159], v[136:139], v[12:15]
    ds_read_b64_tr_b16 v[120:121], v170 offset:16384
    v_mfma_f32_16x16x32_bf16 v[16:19], v[136:139], v[160:163], v[16:19]
    ds_read_b64_tr_b16 v[122:123], v170 offset:16896
    v_mfma_f32_16x16x32_bf16 v[20:23], v[136:139], v[164:167], v[20:23]
    ds_read_b64_tr_b16 v[124:125], v171 offset:16384
    v_mfma_f32_16x16x32_bf16 v[24:27], v[152:155], v[140:143], v[24:27]
    ds_read_b64_tr_b16 v[126:127], v171 offset:16896
    v_mfma_f32_16x16x32_bf16 v[28:31], v[156:159], v[140:143], v[28:31]
    ds_read_b128 v[108:111], v168 offset:18432
    v_mfma_f32_16x16x32_bf16 v[32:35], v[140:143], v[160:163], v[32:35]
    ds_read_b64_tr_b16 v[128:129], v170 offset:24576
    v_mfma_f32_16x16x32_bf16 v[36:39], v[140:143], v[164:167], v[36:39]
    ds_read_b64_tr_b16 v[130:131], v170 offset:25088
    v_mfma_f32_16x16x32_bf16 v[40:43], v[152:155], v[144:147], v[40:43]
    ds_read_b64_tr_b16 v[132:133], v171 offset:24576
    v_mfma_f32_16x16x32_bf16 v[44:47], v[156:159], v[144:147], v[44:47]
    ds_read_b64_tr_b16 v[134:135], v171 offset:25088
    v_mfma_f32_16x16x32_bf16 v[48:51], v[144:147], v[160:163], v[48:51]
    ds_read_b128 v[112:115], v168 offset:20480
    ds_read_b128 v[212:215], v242 offset:192
    v_mfma_f32_16x16x32_bf16 v[52:55], v[144:147], v[164:167], v[52:55]
    ds_read_b128 v[116:119], v168 offset:22528
    ds_read_b128 v[208:211], v242 offset:128
    v_mfma_f32_16x16x32_bf16 v[56:59], v[152:155], v[148:151], v[56:59]
    ds_read_b128 v[204:207], v242 offset:64
    v_mfma_f32_16x16x32_bf16 v[60:63], v[156:159], v[148:151], v[60:63]
    ds_read_b128 v[200:203], v242 offset:0
    v_mfma_f32_16x16x32_bf16 v[64:67], v[148:151], v[160:163], v[64:67]
    ds_read_b32 v190, v244 offset:576
    v_mfma_f32_16x16x32_bf16 v[68:71], v[148:151], v[164:167], v[68:71]
    ds_read_b32 v188, v244 offset:512
    s_waitcnt lgkmcnt(0)
    v_mfma_f32_16x16x32_bf16 v[8:11], v[120:123], v[104:107], v[8:11]
    ds_read_b128 v[136:139], v169 offset:16384
    v_fmac_f32 v40, v184, v192
    v_mfma_f32_16x16x32_bf16 v[12:15], v[124:127], v[104:107], v[12:15]
    ds_read_b64_tr_b16 v[152:153], v170 offset:20480
    v_fmac_f32 v44, v184, v196
    v_mfma_f32_16x16x32_bf16 v[16:19], v[104:107], v[128:131], v[16:19]
    ds_read_b64_tr_b16 v[154:155], v170 offset:20992
    v_fmac_f32 v48, v208, v188
    v_mfma_f32_16x16x32_bf16 v[20:23], v[104:107], v[132:135], v[20:23]
    ds_read_b64_tr_b16 v[156:157], v171 offset:20480
    v_fmac_f32 v52, v208, v190
    v_mfma_f32_16x16x32_bf16 v[24:27], v[120:123], v[108:111], v[24:27]
    ds_read_b64_tr_b16 v[158:159], v171 offset:20992
    v_fmac_f32 v56, v186, v192
    v_mfma_f32_16x16x32_bf16 v[28:31], v[124:127], v[108:111], v[28:31]
    ds_read_b128 v[140:143], v169 offset:18432
    v_fmac_f32 v60, v186, v196
    v_mfma_f32_16x16x32_bf16 v[32:35], v[108:111], v[128:131], v[32:35]
    ds_read_b64_tr_b16 v[160:161], v170 offset:28672
    v_fmac_f32 v64, v212, v188
    v_mfma_f32_16x16x32_bf16 v[36:39], v[108:111], v[132:135], v[36:39]
    ds_read_b64_tr_b16 v[162:163], v170 offset:29184
    v_fmac_f32 v68, v212, v190
    v_mfma_f32_16x16x32_bf16 v[40:43], v[120:123], v[112:115], v[40:43]
    ds_read_b64_tr_b16 v[164:165], v171 offset:28672
    v_fmac_f32 v8, v180, v192
    v_mfma_f32_16x16x32_bf16 v[44:47], v[124:127], v[112:115], v[44:47]
    ds_read_b64_tr_b16 v[166:167], v171 offset:29184
    v_fmac_f32 v12, v180, v196
    v_mfma_f32_16x16x32_bf16 v[48:51], v[112:115], v[128:131], v[48:51]
    ds_read_b128 v[144:147], v169 offset:20480
    v_fmac_f32 v16, v200, v188
    v_mfma_f32_16x16x32_bf16 v[52:55], v[112:115], v[132:135], v[52:55]
    ds_read_b128 v[148:151], v169 offset:22528
    v_fmac_f32 v20, v200, v190
    v_mfma_f32_16x16x32_bf16 v[56:59], v[120:123], v[116:119], v[56:59]
    ds_read_b64 v[238:239], v251 offset:64
    v_fmac_f32 v24, v182, v192
    ds_read_b64_tr_b16 v[178:179], v246 offset:1056
    v_mfma_f32_16x16x32_bf16 v[60:63], v[124:127], v[116:119], v[60:63]
    v_fmac_f32 v28, v182, v196
    ds_read_b64_tr_b16 v[176:177], v246 offset:32
    v_mfma_f32_16x16x32_bf16 v[64:67], v[116:119], v[128:131], v[64:67]
    v_fmac_f32 v32, v204, v188
    ds_read_b64_tr_b16 v[174:175], v246 offset:1024
    v_mfma_f32_16x16x32_bf16 v[68:71], v[116:119], v[132:135], v[68:71]
    v_fmac_f32 v36, v204, v190
    ds_read_b64_tr_b16 v[172:173], v246 offset:0
    s_waitcnt lgkmcnt(0)
    v_mov_b32 v7, 14
    ds_write_b32 v249, v7
L_la14:
    v_min_u32 v238, v238, v239
    s_nop 0
    v_readfirstlane_b32 s3, v238
    s_nop 0
    s_cmp_ge_u32 s3, 14
    s_cbranch_scc1 L_lad14
    ds_read_b64 v[238:239], v251 offset:64
    s_waitcnt lgkmcnt(0)
    s_branch L_la14
L_lad14:
    v_mfma_f32_16x16x32_bf16 v[8:11], v[152:155], v[136:139], v[8:11]
    ds_read_b128 v[104:107], v168 offset:32768
    v_fmac_f32 v41, v184, v193
    v_mfma_f32_16x16x32_bf16 v[12:15], v[156:159], v[136:139], v[12:15]
    ds_read_b64_tr_b16 v[120:121], v170 offset:32768
    v_fmac_f32 v45, v184, v197
    v_mfma_f32_16x16x32_bf16 v[16:19], v[136:139], v[160:163], v[16:19]
    ds_read_b64_tr_b16 v[122:123], v170 offset:33280
    v_fmac_f32 v49, v209, v188
    v_mfma_f32_16x16x32_bf16 v[20:23], v[136:139], v[164:167], v[20:23]
    ds_read_b64_tr_b16 v[124:125], v171 offset:32768
    v_fmac_f32 v53, v209, v190
    v_mfma_f32_16x16x32_bf16 v[24:27], v[152:155], v[140:143], v[24:27]
    ds_read_b64_tr_b16 v[126:127], v171 offset:33280
    v_fmac_f32 v57, v186, v193
    v_mfma_f32_16x16x32_bf16 v[28:31], v[156:159], v[140:143], v[28:31]
    ds_read_b128 v[108:111], v168 offset:34816
    v_fmac_f32 v61, v186, v197
    v_mfma_f32_16x16x32_bf16 v[32:35], v[140:143], v[160:163], v[32:35]
    ds_read_b64_tr_b16 v[128:129], v170 offset:40960
    v_fmac_f32 v65, v213, v188
    v_mfma_f32_16x16x32_bf16 v[36:39], v[140:143], v[164:167], v[36:39]
    ds_read_b64_tr_b16 v[130:131], v170 offset:41472
    v_fmac_f32 v69, v213, v190
    v_mfma_f32_16x16x32_bf16 v[40:43], v[152:155], v[144:147], v[40:43]
    ds_read_b64_tr_b16 v[132:133], v171 offset:40960
    v_fmac_f32 v9, v180, v193
    v_mfma_f32_16x16x32_bf16 v[44:47], v[156:159], v[144:147], v[44:47]
    ds_read_b64_tr_b16 v[134:135], v171 offset:41472
    v_fmac_f32 v13, v180, v197
    v_mfma_f32_16x16x32_bf16 v[48:51], v[144:147], v[160:163], v[48:51]
    ds_read_b128 v[112:115], v168 offset:36864
    v_fmac_f32 v17, v201, v188
    v_mfma_f32_16x16x32_bf16 v[52:55], v[144:147], v[164:167], v[52:55]
    ds_read_b128 v[116:119], v168 offset:38912
    v_fmac_f32 v21, v201, v190
    v_mfma_f32_16x16x32_bf16 v[56:59], v[152:155], v[148:151], v[56:59]
    v_fmac_f32 v25, v182, v193
    ds_read_b32 v254, v240 offset:3776
    v_mfma_f32_16x16x32_bf16 v[60:63], v[156:159], v[148:151], v[60:63]
    v_fmac_f32 v29, v182, v197
    ds_read_b32 v252, v240 offset:3712
    v_mfma_f32_16x16x32_bf16 v[64:67], v[148:151], v[160:163], v[64:67]
    v_fmac_f32 v33, v205, v188
    ds_read_b32 v250, v240 offset:3648
    v_mfma_f32_16x16x32_bf16 v[68:71], v[148:151], v[164:167], v[68:71]
    v_fmac_f32 v37, v205, v190
    ds_read_b32 v248, v240 offset:3584
    s_waitcnt lgkmcnt(0)
    v_mfma_f32_16x16x32_bf16 v[8:11], v[120:123], v[104:107], v[8:11]
    ds_read_b128 v[136:139], v169 offset:32768
    v_fmac_f32 v42, v184, v194
    v_mfma_f32_16x16x32_bf16 v[12:15], v[124:127], v[104:107], v[12:15]
    ds_read_b64_tr_b16 v[152:153], v170 offset:36864
    v_fmac_f32 v46, v184, v198
    v_mfma_f32_16x16x32_bf16 v[16:19], v[104:107], v[128:131], v[16:19]
    ds_read_b64_tr_b16 v[154:155], v170 offset:37376
    v_fmac_f32 v50, v210, v188
    v_mfma_f32_16x16x32_bf16 v[20:23], v[104:107], v[132:135], v[20:23]
    ds_read_b64_tr_b16 v[156:157], v171 offset:36864
    v_fmac_f32 v54, v210, v190
    v_mfma_f32_16x16x32_bf16 v[24:27], v[120:123], v[108:111], v[24:27]
    ds_read_b64_tr_b16 v[158:159], v171 offset:37376
    v_fmac_f32 v58, v186, v194
    v_mfma_f32_16x16x32_bf16 v[28:31], v[124:127], v[108:111], v[28:31]
    ds_read_b128 v[140:143], v169 offset:34816
    v_fmac_f32 v62, v186, v198
    v_mfma_f32_16x16x32_bf16 v[32:35], v[108:111], v[128:131], v[32:35]
    ds_read_b64_tr_b16 v[160:161], v170 offset:45056
    v_fmac_f32 v66, v214, v188
    v_mfma_f32_16x16x32_bf16 v[36:39], v[108:111], v[132:135], v[36:39]
    ds_read_b64_tr_b16 v[162:163], v170 offset:45568
    v_fmac_f32 v70, v214, v190
    v_mfma_f32_16x16x32_bf16 v[40:43], v[120:123], v[112:115], v[40:43]
    ds_read_b64_tr_b16 v[164:165], v171 offset:45056
    v_fmac_f32 v10, v180, v194
    v_mfma_f32_16x16x32_bf16 v[44:47], v[124:127], v[112:115], v[44:47]
    ds_read_b64_tr_b16 v[166:167], v171 offset:45568
    v_fmac_f32 v14, v180, v198
    v_mfma_f32_16x16x32_bf16 v[48:51], v[112:115], v[128:131], v[48:51]
    ds_read_b128 v[144:147], v169 offset:36864
    v_fmac_f32 v18, v202, v188
    v_mfma_f32_16x16x32_bf16 v[52:55], v[112:115], v[132:135], v[52:55]
    ds_read_b128 v[148:151], v169 offset:38912
    v_fmac_f32 v22, v202, v190
    v_mfma_f32_16x16x32_bf16 v[56:59], v[120:123], v[116:119], v[56:59]
    ds_read_b64 v[238:239], v251 offset:64
    v_fmac_f32 v26, v182, v194
    ds_read_b32 v181, v241 offset:3584
    v_mfma_f32_16x16x32_bf16 v[60:63], v[124:127], v[116:119], v[60:63]
    v_fmac_f32 v30, v182, v198
    ds_read_b32 v183, v241 offset:512
    v_mfma_f32_16x16x32_bf16 v[64:67], v[116:119], v[128:131], v[64:67]
    v_fmac_f32 v34, v206, v188
    ds_read_b32 v187, v251 offset:8
    v_mfma_f32_16x16x32_bf16 v[68:71], v[116:119], v[132:135], v[68:71]
    v_fmac_f32 v38, v206, v190
    ds_read_b32 v185, v251 offset:16
    s_waitcnt lgkmcnt(0)
    v_mov_b32 v7, 15
    ds_write_b32 v249, v7
L_la15:
    v_min_u32 v238, v238, v239
    s_nop 0
    v_readfirstlane_b32 s3, v238
    s_nop 0
    s_cmp_ge_u32 s3, 15
    s_cbranch_scc1 L_lad15
    ds_read_b64 v[238:239], v251 offset:64
    s_waitcnt lgkmcnt(0)
    s_branch L_la15
L_lad15:
    v_mfma_f32_16x16x32_bf16 v[8:11], v[152:155], v[136:139], v[8:11]
    ds_read_b128 v[104:107], v168 offset:49152
    v_fmac_f32 v43, v184, v195
    v_mfma_f32_16x16x32_bf16 v[12:15], v[156:159], v[136:139], v[12:15]
    ds_read_b64_tr_b16 v[120:121], v170 offset:49152
    v_fmac_f32 v47, v184, v199
    v_mfma_f32_16x16x32_bf16 v[16:19], v[136:139], v[160:163], v[16:19]
    ds_read_b64_tr_b16 v[122:123], v170 offset:49664
    v_fmac_f32 v51, v211, v188
    v_mfma_f32_16x16x32_bf16 v[20:23], v[136:139], v[164:167], v[20:23]
    ds_read_b64_tr_b16 v[124:125], v171 offset:49152
    v_fmac_f32 v55, v211, v190
    v_mfma_f32_16x16x32_bf16 v[24:27], v[152:155], v[140:143], v[24:27]
    ds_read_b64_tr_b16 v[126:127], v171 offset:49664
    v_fmac_f32 v59, v186, v195
    v_mfma_f32_16x16x32_bf16 v[28:31], v[156:159], v[140:143], v[28:31]
    ds_read_b128 v[108:111], v168 offset:51200
    v_fmac_f32 v63, v186, v199
    v_mfma_f32_16x16x32_bf16 v[32:35], v[140:143], v[160:163], v[32:35]
    ds_read_b64_tr_b16 v[128:129], v170 offset:57344
    v_fmac_f32 v67, v215, v188
    v_mfma_f32_16x16x32_bf16 v[36:39], v[140:143], v[164:167], v[36:39]
    ds_read_b64_tr_b16 v[130:131], v170 offset:57856
    v_fmac_f32 v71, v215, v190
    v_mfma_f32_16x16x32_bf16 v[40:43], v[152:155], v[144:147], v[40:43]
    ds_read_b64_tr_b16 v[132:133], v171 offset:57344
    v_fmac_f32 v11, v180, v195
    v_mfma_f32_16x16x32_bf16 v[44:47], v[156:159], v[144:147], v[44:47]
    ds_read_b64_tr_b16 v[134:135], v171 offset:57856
    v_fmac_f32 v15, v180, v199
    v_mfma_f32_16x16x32_bf16 v[48:51], v[144:147], v[160:163], v[48:51]
    ds_read_b128 v[112:115], v168 offset:53248
    v_fmac_f32 v19, v203, v188
    v_mfma_f32_16x16x32_bf16 v[52:55], v[144:147], v[164:167], v[52:55]
    ds_read_b128 v[116:119], v168 offset:55296
    v_fmac_f32 v23, v203, v190
    v_mfma_f32_16x16x32_bf16 v[56:59], v[152:155], v[148:151], v[56:59]
    v_fmac_f32 v27, v182, v195
    v_mfma_f32_16x16x32_bf16 v[60:63], v[156:159], v[148:151], v[60:63]
    v_fmac_f32 v31, v182, v199
    v_mfma_f32_16x16x32_bf16 v[64:67], v[148:151], v[160:163], v[64:67]
    v_fmac_f32 v35, v207, v188
    v_mfma_f32_16x16x32_bf16 v[68:71], v[148:151], v[164:167], v[68:71]
    v_fmac_f32 v39, v207, v190
    s_waitcnt lgkmcnt(0)
    v_mfma_f32_16x16x32_bf16 v[8:11], v[120:123], v[104:107], v[8:11]
    ds_read_b128 v[136:139], v169 offset:49152
    v_mfma_f32_16x16x32_bf16 v[12:15], v[124:127], v[104:107], v[12:15]
    ds_read_b64_tr_b16 v[152:153], v170 offset:53248
    v_mfma_f32_16x16x32_bf16 v[16:19], v[104:107], v[128:131], v[16:19]
    ds_read_b64_tr_b16 v[154:155], v170 offset:53760
    v_mfma_f32_16x16x32_bf16 v[20:23], v[104:107], v[132:135], v[20:23]
    ds_read_b64_tr_b16 v[156:157], v171 offset:53248
    v_mfma_f32_16x16x32_bf16 v[24:27], v[120:123], v[108:111], v[24:27]
    ds_read_b64_tr_b16 v[158:159], v171 offset:53760
    v_mfma_f32_16x16x32_bf16 v[28:31], v[124:127], v[108:111], v[28:31]
    ds_read_b128 v[140:143], v169 offset:51200
    v_mfma_f32_16x16x32_bf16 v[32:35], v[108:111], v[128:131], v[32:35]
    ds_read_b64_tr_b16 v[160:161], v170 offset:61440
    v_mfma_f32_16x16x32_bf16 v[36:39], v[108:111], v[132:135], v[36:39]
    ds_read_b64_tr_b16 v[162:163], v170 offset:61952
    v_mfma_f32_16x16x32_bf16 v[40:43], v[120:123], v[112:115], v[40:43]
    ds_read_b64_tr_b16 v[164:165], v171 offset:61440
    v_mfma_f32_16x16x32_bf16 v[44:47], v[124:127], v[112:115], v[44:47]
    ds_read_b64_tr_b16 v[166:167], v171 offset:61952
    v_mfma_f32_16x16x32_bf16 v[48:51], v[112:115], v[128:131], v[48:51]
    ds_read_b128 v[144:147], v169 offset:53248
    v_mov_b32 v246, s76
    v_mfma_f32_16x16x32_bf16 v[52:55], v[112:115], v[132:135], v[52:55]
    ds_read_b128 v[148:151], v169 offset:55296
    v_add_u32 v244, s75, v5
    v_mfma_f32_16x16x32_bf16 v[56:59], v[120:123], v[116:119], v[56:59]
    v_add_u32 v243, s74, v5
    v_mfma_f32_16x16x32_bf16 v[60:63], v[124:127], v[116:119], v[60:63]
    v_add_u32 v242, s73, v6
    v_mfma_f32_16x16x32_bf16 v[64:67], v[116:119], v[128:131], v[64:67]
    v_add_u32 v241, s72, v6
    v_mfma_f32_16x16x32_bf16 v[68:71], v[116:119], v[132:135], v[68:71]
    v_add_u32 v240, s72, v4
    s_waitcnt lgkmcnt(0)
    v_mov_b32 v7, 16
    ds_write_b32 v249, v7
    v_mfma_f32_16x16x32_bf16 v[8:11], v[152:155], v[136:139], v[8:11]
    ds_read_b64 v[200:201], v245 offset:0
    v_mfma_f32_16x16x32_bf16 v[12:15], v[156:159], v[136:139], v[12:15]
    ds_read_b64 v[202:203], v245 offset:32
    v_mfma_f32_16x16x32_bf16 v[24:27], v[152:155], v[140:143], v[24:27]
    ds_read_b64 v[204:205], v245 offset:64
    v_mfma_f32_16x16x32_bf16 v[28:31], v[156:159], v[140:143], v[28:31]
    ds_read_b64 v[206:207], v245 offset:96
    v_mfma_f32_16x16x32_bf16 v[40:43], v[152:155], v[144:147], v[40:43]
    ds_read_b64 v[208:209], v247 offset:0
    v_mfma_f32_16x16x32_bf16 v[44:47], v[156:159], v[144:147], v[44:47]
    ds_read_b64 v[210:211], v247 offset:32
    v_mfma_f32_16x16x32_bf16 v[56:59], v[152:155], v[148:151], v[56:59]
    ds_read_b64 v[212:213], v247 offset:64
    v_mfma_f32_16x16x32_bf16 v[60:63], v[156:159], v[148:151], v[60:63]
    ds_read_b64 v[214:215], v247 offset:96
    v_mfma_f32_16x16x32_bf16 v[16:19], v[136:139], v[160:163], v[16:19]
    v_cvt_pk_bf16_f32 v104, v8, v9
    v_cvt_pk_bf16_f32 v105, v10, v11
    v_mfma_f32_16x16x32_bf16 v[20:23], v[136:139], v[164:167], v[20:23]
    v_cvt_pk_bf16_f32 v106, v12, v13
    v_cvt_pk_bf16_f32 v107, v14, v15
    v_mfma_f32_16x16x32_bf16 v[32:35], v[140:143], v[160:163], v[32:35]
    v_cvt_pk_bf16_f32 v108, v24, v25
    v_cvt_pk_bf16_f32 v109, v26, v27
    v_mfma_f32_16x16x32_bf16 v[36:39], v[140:143], v[164:167], v[36:39]
    v_cvt_pk_bf16_f32 v110, v28, v29
    v_cvt_pk_bf16_f32 v111, v30, v31
    v_mfma_f32_16x16x32_bf16 v[48:51], v[144:147], v[160:163], v[48:51]
    v_cvt_pk_bf16_f32 v112, v40, v41
    v_cvt_pk_bf16_f32 v113, v42, v43
    v_mfma_f32_16x16x32_bf16 v[52:55], v[144:147], v[164:167], v[52:55]
    v_cvt_pk_bf16_f32 v114, v44, v45
    v_cvt_pk_bf16_f32 v115, v46, v47
    v_mfma_f32_16x16x32_bf16 v[64:67], v[148:151], v[160:163], v[64:67]
    v_cvt_pk_bf16_f32 v116, v56, v57
    v_cvt_pk_bf16_f32 v117, v58, v59
    v_mfma_f32_16x16x32_bf16 v[68:71], v[148:151], v[164:167], v[68:71]
    v_cvt_pk_bf16_f32 v118, v60, v61
    v_cvt_pk_bf16_f32 v119, v62, v63
    v_readfirstlane_b32 s101, v185
    v_readfirstlane_b32 s32, v187
    v_mfma_f32_16x16x32_bf16 v[120:123], v[172:175], v[104:107], 0
    v_cvt_pk_bf16_f32 v152, v16, v17
    v_cvt_pk_bf16_f32 v153, v18, v19
    v_mfma_f32_16x16x32_bf16 v[124:127], v[176:179], v[104:107], 0
    v_cvt_pk_bf16_f32 v156, v20, v21
    v_cvt_pk_bf16_f32 v157, v22, v23
    v_mfma_f32_16x16x32_bf16 v[128:131], v[172:175], v[108:111], 0
    v_cvt_pk_bf16_f32 v154, v32, v33
    v_cvt_pk_bf16_f32 v155, v34, v35
    v_mfma_f32_16x16x32_bf16 v[132:135], v[176:179], v[108:111], 0
    v_cvt_pk_bf16_f32 v158, v36, v37
    v_cvt_pk_bf16_f32 v159, v38, v39
    v_mfma_f32_16x16x32_bf16 v[136:139], v[172:175], v[112:115], 0
    v_cvt_pk_bf16_f32 v160, v48, v49
    v_cvt_pk_bf16_f32 v161, v50, v51
    v_mfma_f32_16x16x32_bf16 v[140:143], v[176:179], v[112:115], 0
    v_cvt_pk_bf16_f32 v164, v52, v53
    v_cvt_pk_bf16_f32 v165, v54, v55
    v_mfma_f32_16x16x32_bf16 v[144:147], v[172:175], v[116:119], 0
    v_cvt_pk_bf16_f32 v162, v64, v65
    v_cvt_pk_bf16_f32 v163, v66, v67
    v_mfma_f32_16x16x32_bf16 v[148:151], v[176:179], v[116:119], 0
    v_cvt_pk_bf16_f32 v166, v68, v69
    v_cvt_pk_bf16_f32 v167, v70, v71
    ds_read_b128 v[192:195], v251 offset:80
    v_max3_f32 v224, v120, v121, v122
    v_min3_f32 v232, v120, v121, v122
    v_max3_f32 v224, v224, v123, v124
    v_min3_f32 v232, v232, v123, v124
    v_max3_f32 v224, v224, v125, v126
    v_min3_f32 v232, v232, v125, v126
    v_max_f32 v224, v224, v127
    v_min_f32 v232, v232, v127
    v_max3_f32 v226, v128, v129, v130
    v_min3_f32 v234, v128, v129, v130
    v_max3_f32 v226, v226, v131, v132
    v_min3_f32 v234, v234, v131, v132
    v_max3_f32 v226, v226, v133, v134
    v_min3_f32 v234, v234, v133, v134
    v_max_f32 v226, v226, v135
    v_min_f32 v234, v234, v135
    v_max3_f32 v228, v136, v137, v138
    v_min3_f32 v236, v136, v137, v138
    v_max3_f32 v228, v228, v139, v140
    v_min3_f32 v236, v236, v139, v140
    v_max3_f32 v228, v228, v141, v142
    v_min3_f32 v236, v236, v141, v142
    v_max_f32 v228, v228, v143
    v_min_f32 v236, v236, v143
    v_max3_f32 v230, v144, v145, v146
    v_min3_f32 v238, v144, v145, v146
    v_max3_f32 v230, v230, v147, v148
    v_min3_f32 v238, v238, v147, v148
    v_max3_f32 v230, v230, v149, v150
    v_min3_f32 v238, v238, v149, v150
    v_max_f32 v230, v230, v151
    v_min_f32 v238, v238, v151
    v_permlane32_swap_b32 v224, v228
    v_permlane32_swap_b32 v226, v230
    v_permlane32_swap_b32 v232, v236
    v_permlane32_swap_b32 v234, v238
    v_max_f32 v224, v224, v228
    v_max_f32 v226, v226, v230
    v_min_f32 v232, v232, v236
    v_min_f32 v234, v234, v238
    v_permlane16_swap_b32 v224, v226
    s_nop 0
    v_permlane16_swap_b32 v232, v234
    v_max_f32 v224, v224, v226
    v_min_f32 v232, v232, v234
    v_mul_f32 v224, v224, v181
    v_mul_f32 v232, v232, v181
    v_mov_b32 v226, v224
    v_mov_b32 v234, v232
    s_nop 0
    v_permlane16_swap_b32 v224, v226
    v_permlane16_swap_b32 v232, v234
    v_mov_b32 v228, v224
    v_mov_b32 v230, v226
    v_mov_b32 v236, v232
    v_mov_b32 v238, v234
    v_permlane32_swap_b32 v224, v228
    v_permlane32_swap_b32 v226, v230
    v_permlane32_swap_b32 v232, v236
    v_permlane32_swap_b32 v234, v238
    v_pk_fma_f32 v[8:9], v[120:121], v[248:249], v[224:225] op_sel_hi:[1,0,0] neg_lo:[0,0,1] neg_hi:[0,0,1]
    v_pk_fma_f32 v[16:17], v[120:121], v[248:249], v[232:233] op_sel_hi:[1,0,0] neg_lo:[1,0,0] neg_hi:[1,0,0]
    v_pk_fma_f32 v[10:11], v[122:123], v[248:249], v[224:225] op_sel_hi:[1,0,0] neg_lo:[0,0,1] neg_hi:[0,0,1]
    v_pk_fma_f32 v[18:19], v[122:123], v[248:249], v[232:233] op_sel_hi:[1,0,0] neg_lo:[1,0,0] neg_hi:[1,0,0]
    v_pk_fma_f32 v[12:13], v[124:125], v[248:249], v[224:225] op_sel_hi:[1,0,0] neg_lo:[0,0,1] neg_hi:[0,0,1]
    v_pk_fma_f32 v[20:21], v[124:125], v[248:249], v[232:233] op_sel_hi:[1,0,0] neg_lo:[1,0,0] neg_hi:[1,0,0]
    v_pk_fma_f32 v[14:15], v[126:127], v[248:249], v[224:225] op_sel_hi:[1,0,0] neg_lo:[0,0,1] neg_hi:[0,0,1]
    v_pk_fma_f32 v[22:23], v[126:127], v[248:249], v[232:233] op_sel_hi:[1,0,0] neg_lo:[1,0,0] neg_hi:[1,0,0]
L_sf:
    s_waitcnt lgkmcnt(0)
    v_min_u32 v192, v192, v193
    v_min3_u32 v192, v192, v194, v195
    s_nop 0
    v_readfirstlane_b32 s3, v192
    s_nop 0
    s_cmp_ge_u32 s3, 16
    s_cbranch_scc1 L_sfd
    ds_read_b128 v[192:195], v251 offset:80
    s_branch L_sf
L_sfd:
    ds_write_b128 v243, v[152:155] offset:0
    v_exp_f32 v8, v8
    v_exp_f32 v9, v9
    v_exp_f32 v10, v10
    v_exp_f32 v11, v11
    v_exp_f32 v12, v12
    v_exp_f32 v13, v13
    v_exp_f32 v14, v14
    v_exp_f32 v15, v15
    v_exp_f32 v16, v16
    v_exp_f32 v17, v17
    v_exp_f32 v18, v18
    v_exp_f32 v19, v19
    v_exp_f32 v20, v20
    v_exp_f32 v21, v21
    v_exp_f32 v22, v22
    v_exp_f32 v23, v23
    v_pk_fma_f32 v[24:25], v[128:129], v[250:251], v[226:227] op_sel_hi:[1,0,0] neg_lo:[0,0,1] neg_hi:[0,0,1]
    v_pk_fma_f32 v[32:33], v[128:129], v[250:251], v[234:235] op_sel_hi:[1,0,0] neg_lo:[1,0,0] neg_hi:[1,0,0]
    v_pk_fma_f32 v[26:27], v[130:131], v[250:251], v[226:227] op_sel_hi:[1,0,0] neg_lo:[0,0,1] neg_hi:[0,0,1]
    v_pk_fma_f32 v[34:35], v[130:131], v[250:251], v[234:235] op_sel_hi:[1,0,0] neg_lo:[1,0,0] neg_hi:[1,0,0]
    v_pk_fma_f32 v[28:29], v[132:133], v[250:251], v[226:227] op_sel_hi:[1,0,0] neg_lo:[0,0,1] neg_hi:[0,0,1]
    v_pk_fma_f32 v[36:37], v[132:133], v[250:251], v[234:235] op_sel_hi:[1,0,0] neg_lo:[1,0,0] neg_hi:[1,0,0]
    v_pk_fma_f32 v[30:31], v[134:135], v[250:251], v[226:227] op_sel_hi:[1,0,0] neg_lo:[0,0,1] neg_hi:[0,0,1]
    v_pk_fma_f32 v[38:39], v[134:135], v[250:251], v[234:235] op_sel_hi:[1,0,0] neg_lo:[1,0,0] neg_hi:[1,0,0]
    ds_write_b128 v243, v[156:159] offset:1024
    v_exp_f32 v24, v24
    v_exp_f32 v25, v25
    v_exp_f32 v26, v26
    v_exp_f32 v27, v27
    v_exp_f32 v28, v28
    v_exp_f32 v29, v29
    v_exp_f32 v30, v30
    v_exp_f32 v31, v31
    v_exp_f32 v32, v32
    v_exp_f32 v33, v33
    v_exp_f32 v34, v34
    v_exp_f32 v35, v35
    v_exp_f32 v36, v36
    v_exp_f32 v37, v37
    v_exp_f32 v38, v38
    v_exp_f32 v39, v39
    v_pk_fma_f32 v[40:41], v[136:137], v[252:253], v[228:229] op_sel_hi:[1,0,0] neg_lo:[0,0,1] neg_hi:[0,0,1]
    v_pk_fma_f32 v[48:49], v[136:137], v[252:253], v[236:237] op_sel_hi:[1,0,0] neg_lo:[1,0,0] neg_hi:[1,0,0]
    v_pk_fma_f32 v[42:43], v[138:139], v[252:253], v[228:229] op_sel_hi:[1,0,0] neg_lo:[0,0,1] neg_hi:[0,0,1]
    v_pk_fma_f32 v[50:51], v[138:139], v[252:253], v[236:237] op_sel_hi:[1,0,0] neg_lo:[1,0,0] neg_hi:[1,0,0]
    v_pk_fma_f32 v[44:45], v[140:141], v[252:253], v[228:229] op_sel_hi:[1,0,0] neg_lo:[0,0,1] neg_hi:[0,0,1]
    v_pk_fma_f32 v[52:53], v[140:141], v[252:253], v[236:237] op_sel_hi:[1,0,0] neg_lo:[1,0,0] neg_hi:[1,0,0]
    v_pk_fma_f32 v[46:47], v[142:143], v[252:253], v[228:229] op_sel_hi:[1,0,0] neg_lo:[0,0,1] neg_hi:[0,0,1]
    v_pk_fma_f32 v[54:55], v[142:143], v[252:253], v[236:237] op_sel_hi:[1,0,0] neg_lo:[1,0,0] neg_hi:[1,0,0]
    ds_write_b128 v243, v[160:163] offset:2048
    v_exp_f32 v40, v40
    v_exp_f32 v41, v41
    v_exp_f32 v42, v42
    v_exp_f32 v43, v43
    v_exp_f32 v44, v44
    v_exp_f32 v45, v45
    v_exp_f32 v46, v46
    v_exp_f32 v47, v47
    v_exp_f32 v48, v48
    v_exp_f32 v49, v49
    v_exp_f32 v50, v50
    v_exp_f32 v51, v51
    v_exp_f32 v52, v52
    v_exp_f32 v53, v53
    v_exp_f32 v54, v54
    v_exp_f32 v55, v55
    v_pk_fma_f32 v[56:57], v[144:145], v[254:255], v[230:231] op_sel_hi:[1,0,0] neg_lo:[0,0,1] neg_hi:[0,0,1]
    v_pk_fma_f32 v[64:65], v[144:145], v[254:255], v[238:239] op_sel_hi:[1,0,0] neg_lo:[1,0,0] neg_hi:[1,0,0]
    v_pk_fma_f32 v[58:59], v[146:147], v[254:255], v[230:231] op_sel_hi:[1,0,0] neg_lo:[0,0,1] neg_hi:[0,0,1]
    v_pk_fma_f32 v[66:67], v[146:147], v[254:255], v[238:239] op_sel_hi:[1,0,0] neg_lo:[1,0,0] neg_hi:[1,0,0]
    v_pk_fma_f32 v[60:61], v[148:149], v[254:255], v[230:231] op_sel_hi:[1,0,0] neg_lo:[0,0,1] neg_hi:[0,0,1]
    v_pk_fma_f32 v[68:69], v[148:149], v[254:255], v[238:239] op_sel_hi:[1,0,0] neg_lo:[1,0,0] neg_hi:[1,0,0]
    v_pk_fma_f32 v[62:63], v[150:151], v[254:255], v[230:231] op_sel_hi:[1,0,0] neg_lo:[0,0,1] neg_hi:[0,0,1]
    v_pk_fma_f32 v[70:71], v[150:151], v[254:255], v[238:239] op_sel_hi:[1,0,0] neg_lo:[1,0,0] neg_hi:[1,0,0]
    ds_write_b128 v243, v[164:167] offset:3072
    v_exp_f32 v56, v56
    v_exp_f32 v57, v57
    v_exp_f32 v58, v58
    v_exp_f32 v59, v59
    v_exp_f32 v60, v60
    v_exp_f32 v61, v61
    v_exp_f32 v62, v62
    v_exp_f32 v63, v63
    v_exp_f32 v64, v64
    v_exp_f32 v65, v65
    v_exp_f32 v66, v66
    v_exp_f32 v67, v67
    v_exp_f32 v68, v68
    v_exp_f32 v69, v69
    v_exp_f32 v70, v70
    v_exp_f32 v71, v71
    v_pk_add_f32 v[120:121], v[8:9], v[10:11]
    v_pk_add_f32 v[122:123], v[12:13], v[14:15]
    v_pk_add_f32 v[124:125], v[16:17], v[18:19]
    v_pk_add_f32 v[126:127], v[20:21], v[22:23]
    v_pk_add_f32 v[128:129], v[24:25], v[26:27]
    v_pk_add_f32 v[130:131], v[28:29], v[30:31]
    v_pk_add_f32 v[132:133], v[32:33], v[34:35]
    v_pk_add_f32 v[134:135], v[36:37], v[38:39]
    v_pk_add_f32 v[136:137], v[40:41], v[42:43]
    v_pk_add_f32 v[138:139], v[44:45], v[46:47]
    v_pk_add_f32 v[140:141], v[48:49], v[50:51]
    v_pk_add_f32 v[142:143], v[52:53], v[54:55]
    v_pk_add_f32 v[144:145], v[56:57], v[58:59]
    v_pk_add_f32 v[146:147], v[60:61], v[62:63]
    v_pk_add_f32 v[148:149], v[64:65], v[66:67]
    v_pk_add_f32 v[150:151], v[68:69], v[70:71]
    v_pk_add_f32 v[120:121], v[120:121], v[122:123]
    v_pk_add_f32 v[124:125], v[124:125], v[126:127]
    v_pk_add_f32 v[128:129], v[128:129], v[130:131]
    v_pk_add_f32 v[132:133], v[132:133], v[134:135]
    v_pk_add_f32 v[136:137], v[136:137], v[138:139]
    v_pk_add_f32 v[140:141], v[140:141], v[142:143]
    v_pk_add_f32 v[144:145], v[144:145], v[146:147]
    v_pk_add_f32 v[148:149], v[148:149], v[150:151]
    v_add_f32 v224, v120, v121
    v_add_f32 v232, v124, v125
    v_add_f32 v226, v128, v129
    v_add_f32 v234, v132, v133
    v_add_f32 v228, v136, v137
    v_add_f32 v236, v140, v141
    v_add_f32 v230, v144, v145
    v_add_f32 v238, v148, v149
    v_permlane32_swap_b32 v224, v228
    v_permlane32_swap_b32 v226, v230
    v_permlane32_swap_b32 v232, v236
    v_permlane32_swap_b32 v234, v238
    v_add_f32 v224, v224, v228
    v_add_f32 v226, v226, v230
    v_add_f32 v232, v232, v236
    v_add_f32 v234, v234, v238
    v_permlane16_swap_b32 v224, v226
    s_nop 0
    v_permlane16_swap_b32 v232, v234
    v_add_f32 v224, v224, v226
    v_add_f32 v232, v232, v234
    v_rcp_f32 v224, v224
    v_rcp_f32 v232, v232
    v_mul_f32 v224, v224, v183
    v_mul_f32 v232, v232, v183
    v_mov_b32 v226, v224
    v_mov_b32 v234, v232
    s_nop 0
    v_permlane16_swap_b32 v224, v226
    v_permlane16_swap_b32 v232, v234
    v_mov_b32 v228, v224
    v_mov_b32 v230, v226
    v_mov_b32 v236, v232
    v_mov_b32 v238, v234
    v_permlane32_swap_b32 v224, v228
    v_permlane32_swap_b32 v226, v230
    v_permlane32_swap_b32 v232, v236
    v_permlane32_swap_b32 v234, v238
    v_pk_mul_f32 v[8:9], v[8:9], v[224:225] op_sel_hi:[1,0]
    v_pk_mul_f32 v[10:11], v[10:11], v[224:225] op_sel_hi:[1,0]
    v_pk_mul_f32 v[12:13], v[12:13], v[224:225] op_sel_hi:[1,0]
    v_pk_mul_f32 v[14:15], v[14:15], v[224:225] op_sel_hi:[1,0]
    v_cvt_pk_bf16_f32 v104, v8, v9
    v_cvt_pk_bf16_f32 v105, v10, v11
    ds_write_b64 v240, v[104:105] offset:0
    v_cvt_pk_bf16_f32 v106, v12, v13
    v_cvt_pk_bf16_f32 v107, v14, v15
    ds_write_b64 v240, v[106:107] offset:32
    v_pk_mul_f32 v[16:17], v[16:17], v[232:233] op_sel_hi:[1,0]
    v_pk_mul_f32 v[18:19], v[18:19], v[232:233] op_sel_hi:[1,0]
    v_pk_mul_f32 v[20:21], v[20:21], v[232:233] op_sel_hi:[1,0]
    v_pk_mul_f32 v[22:23], v[22:23], v[232:233] op_sel_hi:[1,0]
    v_cvt_pk_bf16_f32 v108, v16, v17
    v_cvt_pk_bf16_f32 v109, v18, v19
    ds_write_b64 v240, v[108:109] offset:64
    v_cvt_pk_bf16_f32 v110, v20, v21
    v_cvt_pk_bf16_f32 v111, v22, v23
    ds_write_b64 v240, v[110:111] offset:96
    v_pk_mul_f32 v[24:25], v[24:25], v[226:227] op_sel_hi:[1,0]
    v_pk_mul_f32 v[26:27], v[26:27], v[226:227] op_sel_hi:[1,0]
    v_pk_mul_f32 v[28:29], v[28:29], v[226:227] op_sel_hi:[1,0]
    v_pk_mul_f32 v[30:31], v[30:31], v[226:227] op_sel_hi:[1,0]
    v_cvt_pk_bf16_f32 v112, v24, v25
    v_cvt_pk_bf16_f32 v113, v26, v27
    ds_write_b64 v240, v[112:113] offset:2176
    v_cvt_pk_bf16_f32 v114, v28, v29
    v_cvt_pk_bf16_f32 v115, v30, v31
    ds_write_b64 v240, v[114:115] offset:2208
    v_pk_mul_f32 v[32:33], v[32:33], v[234:235] op_sel_hi:[1,0]
    v_pk_mul_f32 v[34:35], v[34:35], v[234:235] op_sel_hi:[1,0]
    v_pk_mul_f32 v[36:37], v[36:37], v[234:235] op_sel_hi:[1,0]
    v_pk_mul_f32 v[38:39], v[38:39], v[234:235] op_sel_hi:[1,0]
    v_cvt_pk_bf16_f32 v116, v32, v33
    v_cvt_pk_bf16_f32 v117, v34, v35
    ds_write_b64 v240, v[116:117] offset:2240
    v_cvt_pk_bf16_f32 v118, v36, v37
    v_cvt_pk_bf16_f32 v119, v38, v39
    ds_write_b64 v240, v[118:119] offset:2272
    ds_read_b64_tr_b16 v[120:121], v241 offset:0
    ds_read_b64_tr_b16 v[122:123], v241 offset:2176
    ds_read_b64_tr_b16 v[124:125], v241 offset:32
    ds_read_b64_tr_b16 v[126:127], v241 offset:2208
    v_pk_mul_f32 v[40:41], v[40:41], v[228:229] op_sel_hi:[1,0]
    v_pk_mul_f32 v[42:43], v[42:43], v[228:229] op_sel_hi:[1,0]
    v_pk_mul_f32 v[44:45], v[44:45], v[228:229] op_sel_hi:[1,0]
    v_pk_mul_f32 v[46:47], v[46:47], v[228:229] op_sel_hi:[1,0]
    v_cvt_pk_bf16_f32 v104, v40, v41
    v_cvt_pk_bf16_f32 v105, v42, v43
    ds_write_b64 v240, v[104:105] offset:4352
    v_cvt_pk_bf16_f32 v106, v44, v45
    v_cvt_pk_bf16_f32 v107, v46, v47
    ds_write_b64 v240, v[106:107] offset:4384
    v_pk_mul_f32 v[48:49], v[48:49], v[236:237] op_sel_hi:[1,0]
    v_pk_mul_f32 v[50:51], v[50:51], v[236:237] op_sel_hi:[1,0]
    v_pk_mul_f32 v[52:53], v[52:53], v[236:237] op_sel_hi:[1,0]
    v_pk_mul_f32 v[54:55], v[54:55], v[236:237] op_sel_hi:[1,0]
    v_cvt_pk_bf16_f32 v108, v48, v49
    v_cvt_pk_bf16_f32 v109, v50, v51
    ds_write_b64 v240, v[108:109] offset:4416
    v_cvt_pk_bf16_f32 v110, v52, v53
    v_cvt_pk_bf16_f32 v111, v54, v55
    ds_write_b64 v240, v[110:111] offset:4448
    v_pk_mul_f32 v[56:57], v[56:57], v[230:231] op_sel_hi:[1,0]
    v_pk_mul_f32 v[58:59], v[58:59], v[230:231] op_sel_hi:[1,0]
    v_pk_mul_f32 v[60:61], v[60:61], v[230:231] op_sel_hi:[1,0]
    v_pk_mul_f32 v[62:63], v[62:63], v[230:231] op_sel_hi:[1,0]
    v_cvt_pk_bf16_f32 v112, v56, v57
    v_cvt_pk_bf16_f32 v113, v58, v59
    ds_write_b64 v240, v[112:113] offset:6528
    v_cvt_pk_bf16_f32 v114, v60, v61
    v_cvt_pk_bf16_f32 v115, v62, v63
    ds_write_b64 v240, v[114:115] offset:6560
    v_pk_mul_f32 v[64:65], v[64:65], v[238:239] op_sel_hi:[1,0]
    v_pk_mul_f32 v[66:67], v[66:67], v[238:239] op_sel_hi:[1,0]
    v_pk_mul_f32 v[68:69], v[68:69], v[238:239] op_sel_hi:[1,0]
    v_pk_mul_f32 v[70:71], v[70:71], v[238:239] op_sel_hi:[1,0]
    v_cvt_pk_bf16_f32 v116, v64, v65
    v_cvt_pk_bf16_f32 v117, v66, v67
    ds_write_b64 v240, v[116:117] offset:6592
    v_cvt_pk_bf16_f32 v118, v68, v69
    v_cvt_pk_bf16_f32 v119, v70, v71
    ds_write_b64 v240, v[118:119] offset:6624
    v_mov_b32 v7, 1
    ds_write_b32 v249, v7 offset:32
    ds_read_b32 v7, v246
    ds_read_b64_tr_b16 v[128:129], v241 offset:4352
    ds_read_b64_tr_b16 v[130:131], v241 offset:6528
    ds_read_b64_tr_b16 v[132:133], v241 offset:4384
    ds_read_b64_tr_b16 v[134:135], v241 offset:6560
    ds_read_b128 v[192:195], v251 offset:48
    s_waitcnt lgkmcnt(14)
    v_mfma_f32_16x16x32_bf16 v[8:11], v[120:123], v[152:155], 0
    v_mov_b32 v59, s32
    v_mfma_f32_16x16x32_bf16 v[12:15], v[120:123], v[156:159], 0
    v_mov_b32 v63, s32
    v_mfma_f32_16x16x32_bf16 v[24:27], v[120:123], v[200:203], 0
    v_mov_b32 v67, s32
    v_mfma_f32_16x16x32_bf16 v[16:19], v[124:127], v[152:155], 0
    v_mov_b32 v71, s32
    v_mfma_f32_16x16x32_bf16 v[20:23], v[124:127], v[156:159], 0
    v_mfma_f32_16x16x32_bf16 v[28:31], v[124:127], v[200:203], 0
    s_waitcnt lgkmcnt(0)
L_ex:
    v_readfirstlane_b32 s65, v7
    s_nop 0
    s_cmp_eq_u32 s65, 1
    s_cbranch_scc1 L_exd
    ds_read_b32 v7, v246
    s_waitcnt lgkmcnt(0)
    s_branch L_ex
L_exd:
    v_mfma_f32_16x16x32_bf16 v[8:11], v[128:131], v[160:163], v[8:11]
    ds_read_b64_tr_b16 v[136:137], v242 offset:0
    ds_read_b64_tr_b16 v[138:139], v242 offset:2176
    v_mfma_f32_16x16x32_bf16 v[12:15], v[128:131], v[164:167], v[12:15]
    ds_read_b64_tr_b16 v[140:141], v242 offset:32
    ds_read_b64_tr_b16 v[142:143], v242 offset:2208
    v_mfma_f32_16x16x32_bf16 v[24:27], v[128:131], v[204:207], v[24:27]
    ds_read_b128 v[32:35], v244 offset:0
    ds_read_b128 v[36:39], v244 offset:1024
    v_mfma_f32_16x16x32_bf16 v[16:19], v[132:135], v[160:163], v[16:19]
    ds_read_b64_tr_b16 v[144:145], v242 offset:4352
    ds_read_b64_tr_b16 v[146:147], v242 offset:6528
    v_mfma_f32_16x16x32_bf16 v[20:23], v[132:135], v[164:167], v[20:23]
    ds_read_b64_tr_b16 v[148:149], v242 offset:4384
    ds_read_b64_tr_b16 v[150:151], v242 offset:6560
    v_mfma_f32_16x16x32_bf16 v[28:31], v[132:135], v[204:207], v[28:31]
    ds_read_b128 v[40:43], v244 offset:2048
    ds_read_b128 v[44:47], v244 offset:3072
    s_waitcnt lgkmcnt(6)
    v_mfma_f32_16x16x32_bf16 v[8:11], v[136:139], v[32:35], v[8:11]
    v_mfma_f32_16x16x32_bf16 v[12:15], v[136:139], v[36:39], v[12:15]
    v_mfma_f32_16x16x32_bf16 v[24:27], v[136:139], v[208:211], v[24:27]
    v_mfma_f32_16x16x32_bf16 v[16:19], v[140:143], v[32:35], v[16:19]
    v_mfma_f32_16x16x32_bf16 v[20:23], v[140:143], v[36:39], v[20:23]
    v_mfma_f32_16x16x32_bf16 v[28:31], v[140:143], v[208:211], v[28:31]
    s_waitcnt lgkmcnt(0)
    v_mfma_f32_16x16x32_bf16 v[8:11], v[144:147], v[40:43], v[8:11]
    v_mfma_f32_16x16x32_bf16 v[12:15], v[144:147], v[44:47], v[12:15]
    v_mfma_f32_16x16x32_bf16 v[24:27], v[144:147], v[212:215], v[24:27]
    v_mfma_f32_16x16x32_bf16 v[16:19], v[148:151], v[40:43], v[16:19]
    v_mfma_f32_16x16x32_bf16 v[20:23], v[148:151], v[44:47], v[20:23]
    v_mfma_f32_16x16x32_bf16 v[28:31], v[148:151], v[212:215], v[28:31]
L_qr:
    v_and_b32 v192, v192, v193
    v_and_b32 v194, v194, v195
    v_and_b32 v192, v192, v194
    s_nop 0
    v_readfirstlane_b32 s65, v192
    s_nop 0
    s_cmp_eq_u32 s65, 1
    s_cbranch_scc1 L_qrd
    ds_read_b128 v[192:195], v251 offset:48
    s_waitcnt lgkmcnt(0)
    s_branch L_qr
L_qrd:
    ds_read_b128 v[104:107], v168 offset:0
    ds_read_b64_tr_b16 v[120:121], v189 offset:0
    ds_read_b64_tr_b16 v[122:123], v189 offset:512
    ds_read_b64_tr_b16 v[124:125], v191 offset:0
    ds_read_b64_tr_b16 v[126:127], v191 offset:512
    ds_read_b128 v[108:111], v168 offset:2048
    ds_read_b128 v[112:115], v168 offset:4096
    ds_read_b128 v[116:119], v168 offset:6144
    v_cvt_pk_bf16_f32 v56, v8, v9
    v_cvt_pk_bf16_f32 v57, v10, v11
    v_cvt_pk_bf16_f32 v58, v24, v25
    v_cvt_pk_bf16_f32 v64, v12, v13
    v_cvt_pk_bf16_f32 v65, v14, v15
    v_cvt_pk_bf16_f32 v66, v26, v27
    v_cvt_pk_bf16_f32 v60, v16, v17
    v_cvt_pk_bf16_f32 v61, v18, v19
    v_cvt_pk_bf16_f32 v62, v28, v29
    v_cvt_pk_bf16_f32 v68, v20, v21
    v_cvt_pk_bf16_f32 v69, v22, v23
    v_cvt_pk_bf16_f32 v70, v30, v31
    s_cmp_lg_u32 s101, 0
    s_cbranch_scc1 L_kr
    buffer_store_dwordx4 v[56:59], v5, s[12:15], s77 offen offset:0 nt
    buffer_store_dwordx4 v[60:63], v5, s[12:15], s77 offen offset:1024 nt
    buffer_store_dwordx4 v[64:67], v5, s[12:15], s77 offen offset:2048 nt
    buffer_store_dwordx4 v[68:71], v5, s[12:15], s77 offen offset:3072 nt
    s_branch L_ks
L_kr:
    buffer_store_dwordx4 v[56:59], v5, s[12:15], s77 offen offset:0 sc1
    buffer_store_dwordx4 v[60:63], v5, s[12:15], s77 offen offset:1024 sc1
    buffer_store_dwordx4 v[64:67], v5, s[12:15], s77 offen offset:2048 sc1
    buffer_store_dwordx4 v[68:71], v5, s[12:15], s77 offen offset:3072 sc1
L_ks:
    s_waitcnt lgkmcnt(0)
    v_mfma_f32_16x16x32_bf16 v[72:75], v[120:123], v[104:107], v[72:75]
    ds_read_b128 v[136:139], v169 offset:0
    v_mfma_f32_16x16x32_bf16 v[76:79], v[124:127], v[104:107], v[76:79]
    ds_read_b64_tr_b16 v[152:153], v189 offset:4096
    v_mfma_f32_16x16x32_bf16 v[80:83], v[120:123], v[108:111], v[80:83]
    ds_read_b64_tr_b16 v[154:155], v189 offset:4608
    v_mfma_f32_16x16x32_bf16 v[84:87], v[124:127], v[108:111], v[84:87]
    ds_read_b64_tr_b16 v[156:157], v191 offset:4096
    v_mfma_f32_16x16x32_bf16 v[88:91], v[120:123], v[112:115], v[88:91]
    ds_read_b64_tr_b16 v[158:159], v191 offset:4608
    v_mfma_f32_16x16x32_bf16 v[92:95], v[124:127], v[112:115], v[92:95]
    ds_read_b128 v[140:143], v169 offset:2048
    v_mfma_f32_16x16x32_bf16 v[96:99], v[120:123], v[116:119], v[96:99]
    ds_read_b128 v[144:147], v169 offset:4096
    v_mfma_f32_16x16x32_bf16 v[100:103], v[124:127], v[116:119], v[100:103]
    ds_read_b128 v[148:151], v169 offset:6144
    s_waitcnt lgkmcnt(0)
    v_mov_b32 v7, 17
    ds_write_b32 v249, v7
    v_mfma_f32_16x16x32_bf16 v[72:75], v[152:155], v[136:139], v[72:75]
    ds_read_b128 v[104:107], v168 offset:16384
    v_mfma_f32_16x16x32_bf16 v[76:79], v[156:159], v[136:139], v[76:79]
    ds_read_b64_tr_b16 v[120:121], v189 offset:8192
    v_mfma_f32_16x16x32_bf16 v[80:83], v[152:155], v[140:143], v[80:83]
    ds_read_b64_tr_b16 v[122:123], v189 offset:8704
    v_mfma_f32_16x16x32_bf16 v[84:87], v[156:159], v[140:143], v[84:87]
    ds_read_b64_tr_b16 v[124:125], v191 offset:8192
    v_mfma_f32_16x16x32_bf16 v[88:91], v[152:155], v[144:147], v[88:91]
    ds_read_b64_tr_b16 v[126:127], v191 offset:8704
    v_mfma_f32_16x16x32_bf16 v[92:95], v[156:159], v[144:147], v[92:95]
    ds_read_b128 v[108:111], v168 offset:18432
    v_mfma_f32_16x16x32_bf16 v[96:99], v[152:155], v[148:151], v[96:99]
    ds_read_b128 v[112:115], v168 offset:20480
    v_mfma_f32_16x16x32_bf16 v[100:103], v[156:159], v[148:151], v[100:103]
    ds_read_b128 v[116:119], v168 offset:22528
    s_waitcnt lgkmcnt(0)
    v_mfma_f32_16x16x32_bf16 v[72:75], v[120:123], v[104:107], v[72:75]
    ds_read_b128 v[136:139], v169 offset:16384
    v_mfma_f32_16x16x32_bf16 v[76:79], v[124:127], v[104:107], v[76:79]
    ds_read_b64_tr_b16 v[152:153], v189 offset:12288
    v_mfma_f32_16x16x32_bf16 v[80:83], v[120:123], v[108:111], v[80:83]
    ds_read_b64_tr_b16 v[154:155], v189 offset:12800
    v_mfma_f32_16x16x32_bf16 v[84:87], v[124:127], v[108:111], v[84:87]
    ds_read_b64_tr_b16 v[156:157], v191 offset:12288
    v_mfma_f32_16x16x32_bf16 v[88:91], v[120:123], v[112:115], v[88:91]
    ds_read_b64_tr_b16 v[158:159], v191 offset:12800
    v_mfma_f32_16x16x32_bf16 v[92:95], v[124:127], v[112:115], v[92:95]
    ds_read_b128 v[140:143], v169 offset:18432
    v_mfma_f32_16x16x32_bf16 v[96:99], v[120:123], v[116:119], v[96:99]
    ds_read_b128 v[144:147], v169 offset:20480
    v_mfma_f32_16x16x32_bf16 v[100:103], v[124:127], v[116:119], v[100:103]
    ds_read_b128 v[148:151], v169 offset:22528
    s_waitcnt lgkmcnt(0)
    v_mov_b32 v7, 18
    ds_write_b32 v249, v7
    v_mfma_f32_16x16x32_bf16 v[72:75], v[152:155], v[136:139], v[72:75]
    ds_read_b128 v[104:107], v168 offset:32768
    v_mfma_f32_16x16x32_bf16 v[76:79], v[156:159], v[136:139], v[76:79]
    ds_read_b64_tr_b16 v[120:121], v189 offset:16384
    v_mfma_f32_16x16x32_bf16 v[80:83], v[152:155], v[140:143], v[80:83]
    ds_read_b64_tr_b16 v[122:123], v189 offset:16896
    v_mfma_f32_16x16x32_bf16 v[84:87], v[156:159], v[140:143], v[84:87]
    ds_read_b64_tr_b16 v[124:125], v191 offset:16384
    v_mfma_f32_16x16x32_bf16 v[88:91], v[152:155], v[144:147], v[88:91]
    ds_read_b64_tr_b16 v[126:127], v191 offset:16896
    v_mfma_f32_16x16x32_bf16 v[92:95], v[156:159], v[144:147], v[92:95]
    ds_read_b128 v[108:111], v168 offset:34816
    v_mfma_f32_16x16x32_bf16 v[96:99], v[152:155], v[148:151], v[96:99]
    ds_read_b128 v[112:115], v168 offset:36864
    v_mfma_f32_16x16x32_bf16 v[100:103], v[156:159], v[148:151], v[100:103]
    ds_read_b128 v[116:119], v168 offset:38912
    s_waitcnt lgkmcnt(0)
    v_mfma_f32_16x16x32_bf16 v[72:75], v[120:123], v[104:107], v[72:75]
    ds_read_b128 v[136:139], v169 offset:32768
    v_mfma_f32_16x16x32_bf16 v[76:79], v[124:127], v[104:107], v[76:79]
    ds_read_b64_tr_b16 v[152:153], v189 offset:20480
    v_mfma_f32_16x16x32_bf16 v[80:83], v[120:123], v[108:111], v[80:83]
    ds_read_b64_tr_b16 v[154:155], v189 offset:20992
    v_mfma_f32_16x16x32_bf16 v[84:87], v[124:127], v[108:111], v[84:87]
    ds_read_b64_tr_b16 v[156:157], v191 offset:20480
    v_mfma_f32_16x16x32_bf16 v[88:91], v[120:123], v[112:115], v[88:91]
    ds_read_b64_tr_b16 v[158:159], v191 offset:20992
    v_mfma_f32_16x16x32_bf16 v[92:95], v[124:127], v[112:115], v[92:95]
    ds_read_b128 v[140:143], v169 offset:34816
    v_mfma_f32_16x16x32_bf16 v[96:99], v[120:123], v[116:119], v[96:99]
    ds_read_b128 v[144:147], v169 offset:36864
    v_mfma_f32_16x16x32_bf16 v[100:103], v[124:127], v[116:119], v[100:103]
    ds_read_b128 v[148:151], v169 offset:38912
    s_waitcnt lgkmcnt(0)
    v_mov_b32 v7, 19
    ds_write_b32 v249, v7
    v_mfma_f32_16x16x32_bf16 v[72:75], v[152:155], v[136:139], v[72:75]
    ds_read_b128 v[104:107], v168 offset:49152
    v_mfma_f32_16x16x32_bf16 v[76:79], v[156:159], v[136:139], v[76:79]
    ds_read_b64_tr_b16 v[120:121], v170 offset:16384
    v_mfma_f32_16x16x32_bf16 v[80:83], v[152:155], v[140:143], v[80:83]
    ds_read_b64_tr_b16 v[122:123], v170 offset:16896
    v_mfma_f32_16x16x32_bf16 v[84:87], v[156:159], v[140:143], v[84:87]
    ds_read_b64_tr_b16 v[124:125], v171 offset:16384
    v_mfma_f32_16x16x32_bf16 v[88:91], v[152:155], v[144:147], v[88:91]
    ds_read_b64_tr_b16 v[126:127], v171 offset:16896
    v_mfma_f32_16x16x32_bf16 v[92:95], v[156:159], v[144:147], v[92:95]
    ds_read_b128 v[108:111], v168 offset:51200
    v_mfma_f32_16x16x32_bf16 v[96:99], v[152:155], v[148:151], v[96:99]
    ds_read_b128 v[112:115], v168 offset:53248
    v_mfma_f32_16x16x32_bf16 v[100:103], v[156:159], v[148:151], v[100:103]
    ds_read_b128 v[116:119], v168 offset:55296
    s_waitcnt lgkmcnt(0)
    v_mfma_f32_16x16x32_bf16 v[72:75], v[120:123], v[104:107], v[72:75]
    ds_read_b128 v[136:139], v169 offset:49152
    v_mfma_f32_16x16x32_bf16 v[76:79], v[124:127], v[104:107], v[76:79]
    ds_read_b64_tr_b16 v[152:153], v170 offset:20480
    v_mfma_f32_16x16x32_bf16 v[80:83], v[120:123], v[108:111], v[80:83]
    ds_read_b64_tr_b16 v[154:155], v170 offset:20992
    v_mfma_f32_16x16x32_bf16 v[84:87], v[124:127], v[108:111], v[84:87]
    ds_read_b64_tr_b16 v[156:157], v171 offset:20480
    v_mfma_f32_16x16x32_bf16 v[88:91], v[120:123], v[112:115], v[88:91]
    ds_read_b64_tr_b16 v[158:159], v171 offset:20992
    v_mfma_f32_16x16x32_bf16 v[92:95], v[124:127], v[112:115], v[92:95]
    ds_read_b128 v[140:143], v169 offset:51200
    v_mfma_f32_16x16x32_bf16 v[96:99], v[120:123], v[116:119], v[96:99]
    ds_read_b128 v[144:147], v169 offset:53248
    v_mfma_f32_16x16x32_bf16 v[100:103], v[124:127], v[116:119], v[100:103]
    ds_read_b128 v[148:151], v169 offset:55296
    s_waitcnt lgkmcnt(0)
    v_mov_b32 v7, 20
    ds_write_b32 v249, v7
    v_mfma_f32_16x16x32_bf16 v[72:75], v[152:155], v[136:139], v[72:75]
    v_mfma_f32_16x16x32_bf16 v[76:79], v[156:159], v[136:139], v[76:79]
    v_mfma_f32_16x16x32_bf16 v[80:83], v[152:155], v[140:143], v[80:83]
    v_mfma_f32_16x16x32_bf16 v[84:87], v[156:159], v[140:143], v[84:87]
    v_mfma_f32_16x16x32_bf16 v[88:91], v[152:155], v[144:147], v[88:91]
    v_mfma_f32_16x16x32_bf16 v[92:95], v[156:159], v[144:147], v[92:95]
    v_mfma_f32_16x16x32_bf16 v[96:99], v[152:155], v[148:151], v[96:99]
    v_mfma_f32_16x16x32_bf16 v[100:103], v[156:159], v[148:151], v[100:103]
    s_nop 0
    v_pk_fma_f32 v[72:73], v[180:181], v[216:217], v[72:73] op_sel_hi:[0,1,1]
    v_pk_fma_f32 v[74:75], v[180:181], v[218:219], v[74:75] op_sel_hi:[0,1,1]
    v_pk_fma_f32 v[76:77], v[180:181], v[220:221], v[76:77] op_sel_hi:[0,1,1]
    v_pk_fma_f32 v[78:79], v[180:181], v[222:223], v[78:79] op_sel_hi:[0,1,1]
    v_pk_fma_f32 v[80:81], v[182:183], v[216:217], v[80:81] op_sel_hi:[0,1,1]
    v_pk_fma_f32 v[82:83], v[182:183], v[218:219], v[82:83] op_sel_hi:[0,1,1]
    v_pk_fma_f32 v[84:85], v[182:183], v[220:221], v[84:85] op_sel_hi:[0,1,1]
    v_pk_fma_f32 v[86:87], v[182:183], v[222:223], v[86:87] op_sel_hi:[0,1,1]
    v_pk_fma_f32 v[88:89], v[184:185], v[216:217], v[88:89] op_sel_hi:[0,1,1]
    v_pk_fma_f32 v[90:91], v[184:185], v[218:219], v[90:91] op_sel_hi:[0,1,1]
    v_pk_fma_f32 v[92:93], v[184:185], v[220:221], v[92:93] op_sel_hi:[0,1,1]
    v_pk_fma_f32 v[94:95], v[184:185], v[222:223], v[94:95] op_sel_hi:[0,1,1]
    v_pk_fma_f32 v[96:97], v[186:187], v[216:217], v[96:97] op_sel_hi:[0,1,1]
    v_pk_fma_f32 v[98:99], v[186:187], v[218:219], v[98:99] op_sel_hi:[0,1,1]
    v_pk_fma_f32 v[100:101], v[186:187], v[220:221], v[100:101] op_sel_hi:[0,1,1]
    v_pk_fma_f32 v[102:103], v[186:187], v[222:223], v[102:103] op_sel_hi:[0,1,1]
    v_cvt_pk_bf16_f32 v104, v72, v73
    v_cvt_pk_bf16_f32 v105, v74, v75
    v_cvt_pk_bf16_f32 v106, v76, v77
    v_cvt_pk_bf16_f32 v107, v78, v79
    s_nop 1
    v_mfma_f32_16x16x32_bf16 v[120:123], v[172:175], v[104:107], 0
    v_cvt_pk_bf16_f32 v108, v80, v81
    v_cvt_pk_bf16_f32 v109, v82, v83
    v_mfma_f32_16x16x32_bf16 v[124:127], v[176:179], v[104:107], 0
    v_cvt_pk_bf16_f32 v110, v84, v85
    v_cvt_pk_bf16_f32 v111, v86, v87
    s_nop 1
    v_mfma_f32_16x16x32_bf16 v[128:131], v[172:175], v[108:111], 0
    v_cvt_pk_bf16_f32 v112, v88, v89
    v_cvt_pk_bf16_f32 v113, v90, v91
    v_mfma_f32_16x16x32_bf16 v[132:135], v[176:179], v[108:111], 0
    v_cvt_pk_bf16_f32 v114, v92, v93
    v_cvt_pk_bf16_f32 v115, v94, v95
    s_nop 1
    v_mfma_f32_16x16x32_bf16 v[136:139], v[172:175], v[112:115], 0
    v_cvt_pk_bf16_f32 v116, v96, v97
    v_cvt_pk_bf16_f32 v117, v98, v99
    v_mfma_f32_16x16x32_bf16 v[140:143], v[176:179], v[112:115], 0
    v_cvt_pk_bf16_f32 v118, v100, v101
    v_cvt_pk_bf16_f32 v119, v102, v103
    s_nop 1
    v_mfma_f32_16x16x32_bf16 v[144:147], v[172:175], v[116:119], 0
    v_mfma_f32_16x16x32_bf16 v[148:151], v[176:179], v[116:119], 0
    v_max3_f32 v224, v120, v121, v122
    v_min3_f32 v232, v120, v121, v122
    v_max3_f32 v224, v224, v123, v124
    v_min3_f32 v232, v232, v123, v124
    v_max3_f32 v224, v224, v125, v126
    v_min3_f32 v232, v232, v125, v126
    v_max_f32 v224, v224, v127
    v_min_f32 v232, v232, v127
    v_max3_f32 v226, v128, v129, v130
    v_min3_f32 v234, v128, v129, v130
    v_max3_f32 v226, v226, v131, v132
    v_min3_f32 v234, v234, v131, v132
    v_max3_f32 v226, v226, v133, v134
    v_min3_f32 v234, v234, v133, v134
    v_max_f32 v226, v226, v135
    v_min_f32 v234, v234, v135
    v_max3_f32 v228, v136, v137, v138
    v_min3_f32 v236, v136, v137, v138
    v_max3_f32 v228, v228, v139, v140
    v_min3_f32 v236, v236, v139, v140
    v_max3_f32 v228, v228, v141, v142
    v_min3_f32 v236, v236, v141, v142
    v_max_f32 v228, v228, v143
    v_min_f32 v236, v236, v143
    v_max3_f32 v230, v144, v145, v146
    v_min3_f32 v238, v144, v145, v146
    v_max3_f32 v230, v230, v147, v148
    v_min3_f32 v238, v238, v147, v148
    v_max3_f32 v230, v230, v149, v150
    v_min3_f32 v238, v238, v149, v150
    v_max_f32 v230, v230, v151
    v_min_f32 v238, v238, v151
    v_permlane32_swap_b32 v224, v228
    v_permlane32_swap_b32 v226, v230
    v_permlane32_swap_b32 v232, v236
    v_permlane32_swap_b32 v234, v238
    v_max_f32 v224, v224, v228
    v_max_f32 v226, v226, v230
    v_min_f32 v232, v232, v236
    v_min_f32 v234, v234, v238
    v_permlane16_swap_b32 v224, v226
    s_nop 0
    v_permlane16_swap_b32 v232, v234
    v_max_f32 v224, v224, v226
    v_min_f32 v232, v232, v234
    v_mul_f32 v224, v224, v181
    v_mul_f32 v232, v232, v181
    v_mov_b32 v226, v224
    v_mov_b32 v234, v232
    s_nop 0
    v_permlane16_swap_b32 v224, v226
    v_permlane16_swap_b32 v232, v234
    v_mov_b32 v228, v224
    v_mov_b32 v230, v226
    v_mov_b32 v236, v232
    v_mov_b32 v238, v234
    v_permlane32_swap_b32 v224, v228
    v_permlane32_swap_b32 v226, v230
    v_permlane32_swap_b32 v232, v236
    v_permlane32_swap_b32 v234, v238
    v_pk_fma_f32 v[8:9], v[120:121], v[248:249], v[224:225] op_sel_hi:[1,0,0] neg_lo:[0,0,1] neg_hi:[0,0,1]
    v_pk_fma_f32 v[16:17], v[120:121], v[248:249], v[232:233] op_sel_hi:[1,0,0] neg_lo:[1,0,0] neg_hi:[1,0,0]
    v_pk_fma_f32 v[10:11], v[122:123], v[248:249], v[224:225] op_sel_hi:[1,0,0] neg_lo:[0,0,1] neg_hi:[0,0,1]
    v_pk_fma_f32 v[18:19], v[122:123], v[248:249], v[232:233] op_sel_hi:[1,0,0] neg_lo:[1,0,0] neg_hi:[1,0,0]
    v_pk_fma_f32 v[12:13], v[124:125], v[248:249], v[224:225] op_sel_hi:[1,0,0] neg_lo:[0,0,1] neg_hi:[0,0,1]
    v_pk_fma_f32 v[20:21], v[124:125], v[248:249], v[232:233] op_sel_hi:[1,0,0] neg_lo:[1,0,0] neg_hi:[1,0,0]
    v_pk_fma_f32 v[14:15], v[126:127], v[248:249], v[224:225] op_sel_hi:[1,0,0] neg_lo:[0,0,1] neg_hi:[0,0,1]
    v_pk_fma_f32 v[22:23], v[126:127], v[248:249], v[232:233] op_sel_hi:[1,0,0] neg_lo:[1,0,0] neg_hi:[1,0,0]
    v_exp_f32 v8, v8
    v_exp_f32 v9, v9
    v_exp_f32 v10, v10
    v_exp_f32 v11, v11
    v_exp_f32 v12, v12
    v_exp_f32 v13, v13
    v_exp_f32 v14, v14
    v_exp_f32 v15, v15
    v_exp_f32 v16, v16
    v_exp_f32 v17, v17
    v_exp_f32 v18, v18
    v_exp_f32 v19, v19
    v_exp_f32 v20, v20
    v_exp_f32 v21, v21
    v_exp_f32 v22, v22
    v_exp_f32 v23, v23
    v_pk_fma_f32 v[24:25], v[128:129], v[250:251], v[226:227] op_sel_hi:[1,0,0] neg_lo:[0,0,1] neg_hi:[0,0,1]
    v_pk_fma_f32 v[32:33], v[128:129], v[250:251], v[234:235] op_sel_hi:[1,0,0] neg_lo:[1,0,0] neg_hi:[1,0,0]
    v_pk_fma_f32 v[26:27], v[130:131], v[250:251], v[226:227] op_sel_hi:[1,0,0] neg_lo:[0,0,1] neg_hi:[0,0,1]
    v_pk_fma_f32 v[34:35], v[130:131], v[250:251], v[234:235] op_sel_hi:[1,0,0] neg_lo:[1,0,0] neg_hi:[1,0,0]
    v_pk_fma_f32 v[28:29], v[132:133], v[250:251], v[226:227] op_sel_hi:[1,0,0] neg_lo:[0,0,1] neg_hi:[0,0,1]
    v_pk_fma_f32 v[36:37], v[132:133], v[250:251], v[234:235] op_sel_hi:[1,0,0] neg_lo:[1,0,0] neg_hi:[1,0,0]
    v_pk_fma_f32 v[30:31], v[134:135], v[250:251], v[226:227] op_sel_hi:[1,0,0] neg_lo:[0,0,1] neg_hi:[0,0,1]
    v_pk_fma_f32 v[38:39], v[134:135], v[250:251], v[234:235] op_sel_hi:[1,0,0] neg_lo:[1,0,0] neg_hi:[1,0,0]
    v_exp_f32 v24, v24
    v_exp_f32 v25, v25
    v_exp_f32 v26, v26
    v_exp_f32 v27, v27
    v_exp_f32 v28, v28
    v_exp_f32 v29, v29
    v_exp_f32 v30, v30
    v_exp_f32 v31, v31
    v_exp_f32 v32, v32
    v_exp_f32 v33, v33
    v_exp_f32 v34, v34
    v_exp_f32 v35, v35
    v_exp_f32 v36, v36
    v_exp_f32 v37, v37
    v_exp_f32 v38, v38
    v_exp_f32 v39, v39
    v_pk_fma_f32 v[40:41], v[136:137], v[252:253], v[228:229] op_sel_hi:[1,0,0] neg_lo:[0,0,1] neg_hi:[0,0,1]
    v_pk_fma_f32 v[48:49], v[136:137], v[252:253], v[236:237] op_sel_hi:[1,0,0] neg_lo:[1,0,0] neg_hi:[1,0,0]
    v_pk_fma_f32 v[42:43], v[138:139], v[252:253], v[228:229] op_sel_hi:[1,0,0] neg_lo:[0,0,1] neg_hi:[0,0,1]
    v_pk_fma_f32 v[50:51], v[138:139], v[252:253], v[236:237] op_sel_hi:[1,0,0] neg_lo:[1,0,0] neg_hi:[1,0,0]
    v_pk_fma_f32 v[44:45], v[140:141], v[252:253], v[228:229] op_sel_hi:[1,0,0] neg_lo:[0,0,1] neg_hi:[0,0,1]
    v_pk_fma_f32 v[52:53], v[140:141], v[252:253], v[236:237] op_sel_hi:[1,0,0] neg_lo:[1,0,0] neg_hi:[1,0,0]
    v_pk_fma_f32 v[46:47], v[142:143], v[252:253], v[228:229] op_sel_hi:[1,0,0] neg_lo:[0,0,1] neg_hi:[0,0,1]
    v_pk_fma_f32 v[54:55], v[142:143], v[252:253], v[236:237] op_sel_hi:[1,0,0] neg_lo:[1,0,0] neg_hi:[1,0,0]
    v_exp_f32 v40, v40
    v_exp_f32 v41, v41
    v_exp_f32 v42, v42
    v_exp_f32 v43, v43
    v_exp_f32 v44, v44
    v_exp_f32 v45, v45
    v_exp_f32 v46, v46
    v_exp_f32 v47, v47
    v_exp_f32 v48, v48
    v_exp_f32 v49, v49
    v_exp_f32 v50, v50
    v_exp_f32 v51, v51
    v_exp_f32 v52, v52
    v_exp_f32 v53, v53
    v_exp_f32 v54, v54
    v_exp_f32 v55, v55
    v_pk_fma_f32 v[56:57], v[144:145], v[254:255], v[230:231] op_sel_hi:[1,0,0] neg_lo:[0,0,1] neg_hi:[0,0,1]
    v_pk_fma_f32 v[64:65], v[144:145], v[254:255], v[238:239] op_sel_hi:[1,0,0] neg_lo:[1,0,0] neg_hi:[1,0,0]
    v_pk_fma_f32 v[58:59], v[146:147], v[254:255], v[230:231] op_sel_hi:[1,0,0] neg_lo:[0,0,1] neg_hi:[0,0,1]
    v_pk_fma_f32 v[66:67], v[146:147], v[254:255], v[238:239] op_sel_hi:[1,0,0] neg_lo:[1,0,0] neg_hi:[1,0,0]
    v_pk_fma_f32 v[60:61], v[148:149], v[254:255], v[230:231] op_sel_hi:[1,0,0] neg_lo:[0,0,1] neg_hi:[0,0,1]
    v_pk_fma_f32 v[68:69], v[148:149], v[254:255], v[238:239] op_sel_hi:[1,0,0] neg_lo:[1,0,0] neg_hi:[1,0,0]
    v_pk_fma_f32 v[62:63], v[150:151], v[254:255], v[230:231] op_sel_hi:[1,0,0] neg_lo:[0,0,1] neg_hi:[0,0,1]
    v_pk_fma_f32 v[70:71], v[150:151], v[254:255], v[238:239] op_sel_hi:[1,0,0] neg_lo:[1,0,0] neg_hi:[1,0,0]
    v_exp_f32 v56, v56
    v_exp_f32 v57, v57
    v_exp_f32 v58, v58
    v_exp_f32 v59, v59
    v_exp_f32 v60, v60
    v_exp_f32 v61, v61
    v_exp_f32 v62, v62
    v_exp_f32 v63, v63
    v_exp_f32 v64, v64
    v_exp_f32 v65, v65
    v_exp_f32 v66, v66
    v_exp_f32 v67, v67
    v_exp_f32 v68, v68
    v_exp_f32 v69, v69
    v_exp_f32 v70, v70
    v_exp_f32 v71, v71
    v_pk_add_f32 v[120:121], v[8:9], v[10:11]
    v_pk_add_f32 v[122:123], v[12:13], v[14:15]
    v_pk_add_f32 v[124:125], v[16:17], v[18:19]
    v_pk_add_f32 v[126:127], v[20:21], v[22:23]
    v_pk_add_f32 v[128:129], v[24:25], v[26:27]
    v_pk_add_f32 v[130:131], v[28:29], v[30:31]
    v_pk_add_f32 v[132:133], v[32:33], v[34:35]
    v_pk_add_f32 v[134:135], v[36:37], v[38:39]
    v_pk_add_f32 v[136:137], v[40:41], v[42:43]
    v_pk_add_f32 v[138:139], v[44:45], v[46:47]
    v_pk_add_f32 v[140:141], v[48:49], v[50:51]
    v_pk_add_f32 v[142:143], v[52:53], v[54:55]
    v_pk_add_f32 v[144:145], v[56:57], v[58:59]
    v_pk_add_f32 v[146:147], v[60:61], v[62:63]
    v_pk_add_f32 v[148:149], v[64:65], v[66:67]
    v_pk_add_f32 v[150:151], v[68:69], v[70:71]
    v_pk_add_f32 v[120:121], v[120:121], v[122:123]
    v_pk_add_f32 v[124:125], v[124:125], v[126:127]
    v_pk_add_f32 v[128:129], v[128:129], v[130:131]
    v_pk_add_f32 v[132:133], v[132:133], v[134:135]
    v_pk_add_f32 v[136:137], v[136:137], v[138:139]
    v_pk_add_f32 v[140:141], v[140:141], v[142:143]
    v_pk_add_f32 v[144:145], v[144:145], v[146:147]
    v_pk_add_f32 v[148:149], v[148:149], v[150:151]
    v_add_f32 v224, v120, v121
    v_add_f32 v232, v124, v125
    v_add_f32 v226, v128, v129
    v_add_f32 v234, v132, v133
    v_add_f32 v228, v136, v137
    v_add_f32 v236, v140, v141
    v_add_f32 v230, v144, v145
    v_add_f32 v238, v148, v149
    v_permlane32_swap_b32 v224, v228
    v_permlane32_swap_b32 v226, v230
    v_permlane32_swap_b32 v232, v236
    v_permlane32_swap_b32 v234, v238
    v_add_f32 v224, v224, v228
    v_add_f32 v226, v226, v230
    v_add_f32 v232, v232, v236
    v_add_f32 v234, v234, v238
    v_permlane16_swap_b32 v224, v226
    s_nop 0
    v_permlane16_swap_b32 v232, v234
    v_add_f32 v224, v224, v226
    v_add_f32 v232, v232, v234
    v_rcp_f32 v232, v232
    s_lshl_b32 s3, s29, 12
    s_add_u32 s3, s3, 149504
    v_add_u32 v240, s3, v5
    s_lshl_b32 s3, s29, 7
    s_add_u32 s3, s3, 157696
    v_lshl_add_u32 v241, v2, 3, s3
    v_mul_f32 v232, v232, v224
    v_mul_f32 v224, 0x358637bd, v224
    v_mov_b32 v226, v224
    v_mov_b32 v234, v232
    s_nop 0
    v_permlane16_swap_b32 v224, v226
    v_permlane16_swap_b32 v232, v234
    v_mov_b32 v228, v224
    v_mov_b32 v230, v226
    v_mov_b32 v236, v232
    v_mov_b32 v238, v234
    v_permlane32_swap_b32 v224, v228
    v_permlane32_swap_b32 v226, v230
    v_permlane32_swap_b32 v232, v236
    v_permlane32_swap_b32 v234, v238
    v_pk_mul_f32 v[16:17], v[16:17], v[232:233] op_sel_hi:[1,0]
    v_pk_mul_f32 v[18:19], v[18:19], v[232:233] op_sel_hi:[1,0]
    v_pk_mul_f32 v[20:21], v[20:21], v[232:233] op_sel_hi:[1,0]
    v_pk_mul_f32 v[22:23], v[22:23], v[232:233] op_sel_hi:[1,0]
    v_cvt_pk_bf16_f32 v72, v8, v9
    v_cvt_pk_bf16_f32 v73, v10, v11
    v_cvt_pk_bf16_f32 v74, v12, v13
    v_cvt_pk_bf16_f32 v75, v14, v15
    v_cvt_pk_bf16_f32 v76, v16, v17
    v_cvt_pk_bf16_f32 v77, v18, v19
    v_cvt_pk_bf16_f32 v78, v20, v21
    v_cvt_pk_bf16_f32 v79, v22, v23
    v_pk_mul_f32 v[32:33], v[32:33], v[234:235] op_sel_hi:[1,0]
    v_pk_mul_f32 v[34:35], v[34:35], v[234:235] op_sel_hi:[1,0]
    v_pk_mul_f32 v[36:37], v[36:37], v[234:235] op_sel_hi:[1,0]
    v_pk_mul_f32 v[38:39], v[38:39], v[234:235] op_sel_hi:[1,0]
    v_cvt_pk_bf16_f32 v80, v24, v25
    v_cvt_pk_bf16_f32 v81, v26, v27
    v_cvt_pk_bf16_f32 v82, v28, v29
    v_cvt_pk_bf16_f32 v83, v30, v31
    v_cvt_pk_bf16_f32 v84, v32, v33
    v_cvt_pk_bf16_f32 v85, v34, v35
    v_cvt_pk_bf16_f32 v86, v36, v37
    v_cvt_pk_bf16_f32 v87, v38, v39
    v_pk_mul_f32 v[48:49], v[48:49], v[236:237] op_sel_hi:[1,0]
    v_pk_mul_f32 v[50:51], v[50:51], v[236:237] op_sel_hi:[1,0]
    v_pk_mul_f32 v[52:53], v[52:53], v[236:237] op_sel_hi:[1,0]
    v_pk_mul_f32 v[54:55], v[54:55], v[236:237] op_sel_hi:[1,0]
    v_cvt_pk_bf16_f32 v88, v40, v41
    v_cvt_pk_bf16_f32 v89, v42, v43
    v_cvt_pk_bf16_f32 v90, v44, v45
    v_cvt_pk_bf16_f32 v91, v46, v47
    v_cvt_pk_bf16_f32 v92, v48, v49
    v_cvt_pk_bf16_f32 v93, v50, v51
    v_cvt_pk_bf16_f32 v94, v52, v53
    v_cvt_pk_bf16_f32 v95, v54, v55
    v_pk_mul_f32 v[64:65], v[64:65], v[238:239] op_sel_hi:[1,0]
    v_pk_mul_f32 v[66:67], v[66:67], v[238:239] op_sel_hi:[1,0]
    v_pk_mul_f32 v[68:69], v[68:69], v[238:239] op_sel_hi:[1,0]
    v_pk_mul_f32 v[70:71], v[70:71], v[238:239] op_sel_hi:[1,0]
    v_cvt_pk_bf16_f32 v96, v56, v57
    v_cvt_pk_bf16_f32 v97, v58, v59
    v_cvt_pk_bf16_f32 v98, v60, v61
    v_cvt_pk_bf16_f32 v99, v62, v63
    v_cvt_pk_bf16_f32 v100, v64, v65
    v_cvt_pk_bf16_f32 v101, v66, v67
    v_cvt_pk_bf16_f32 v102, v68, v69
    v_cvt_pk_bf16_f32 v103, v70, v71
    s_lshl_b32 s73, s30, 8
    s_add_u32 s73, s73, 131072
    v_lshlrev_b32 v161, 2, v1
    s_lshl_b32 s3, s36, 3
    s_lshl_b32 s65, s28, 2
    s_add_u32 s3, s3, s65
    s_lshl_b32 s3, s3, 5
    s_lshl_b32 s65, s37, 1
    s_add_u32 s65, s65, s29
    s_add_u32 s3, s3, s65
    s_lshl_b32 s3, s3, 10
    s_add_u32 s3, s3, 12582912
    s_lshl_b32 s66, s36, 4
    s_add_u32 s66, s66, s37
    s_lshl_b32 s66, s66, 7
    s_add_u32 s66, s66, 1310720
    v_mov_b32 v6, 163104
L_kv:
    ds_read_b64 v[104:105], v6
    s_waitcnt lgkmcnt(0)
    v_and_b32 v104, v104, v105
    s_nop 0
    v_readfirstlane_b32 s65, v104
    s_nop 0
    s_cmp_eq_u32 s65, 1
    s_cbranch_scc1 L_kvd
    s_sleep 1
    s_branch L_kv
L_kvd:
    ds_read_b128 v[104:107], v240 offset:0
    ds_read_b128 v[108:111], v240 offset:1024
    ds_read_b128 v[112:115], v240 offset:2048
    ds_read_b128 v[116:119], v240 offset:3072
    ds_read_b64 v[120:121], v241 offset:0
    ds_read_b64 v[122:123], v241 offset:32
    ds_read_b64 v[124:125], v241 offset:64
    ds_read_b64 v[126:127], v241 offset:96
    s_waitcnt lgkmcnt(0)
    v_mfma_f32_16x16x32_bf16 v[40:43], v[120:123], v[72:75], 0
    v_mfma_f32_16x16x32_bf16 v[40:43], v[124:127], v[76:79], v[40:43]
    v_mfma_f32_16x16x32_bf16 v[44:47], v[120:123], v[80:83], 0
    v_mfma_f32_16x16x32_bf16 v[44:47], v[124:127], v[84:87], v[44:47]
    v_mfma_f32_16x16x32_bf16 v[48:51], v[120:123], v[88:91], 0
    v_mfma_f32_16x16x32_bf16 v[48:51], v[124:127], v[92:95], v[48:51]
    v_mfma_f32_16x16x32_bf16 v[52:55], v[120:123], v[96:99], 0
    v_mfma_f32_16x16x32_bf16 v[52:55], v[124:127], v[100:103], v[52:55]
    v_mfma_f32_16x16x32_bf16 v[8:11], v[104:107], v[72:75], 0
    v_mfma_f32_16x16x32_bf16 v[8:11], v[112:115], v[76:79], v[8:11]
    v_mfma_f32_16x16x32_bf16 v[12:15], v[108:111], v[72:75], 0
    v_mfma_f32_16x16x32_bf16 v[12:15], v[116:119], v[76:79], v[12:15]
    v_add_f32 v40, v40, v224
    v_add_f32 v44, v44, v226
    v_add_f32 v48, v48, v228
    s_nop 0
    v_add_f32 v52, v52, v230
    v_mfma_f32_16x16x32_bf16 v[16:19], v[104:107], v[80:83], 0
    v_mfma_f32_16x16x32_bf16 v[16:19], v[112:115], v[84:87], v[16:19]
    v_mfma_f32_16x16x32_bf16 v[20:23], v[108:111], v[80:83], 0
    v_mfma_f32_16x16x32_bf16 v[20:23], v[116:119], v[84:87], v[20:23]
    v_rcp_f32 v40, v40
    v_rcp_f32 v44, v44
    v_rcp_f32 v48, v48
    v_rcp_f32 v52, v52
    v_mfma_f32_16x16x32_bf16 v[24:27], v[104:107], v[88:91], 0
    v_mfma_f32_16x16x32_bf16 v[24:27], v[112:115], v[92:95], v[24:27]
    v_mfma_f32_16x16x32_bf16 v[28:31], v[108:111], v[88:91], 0
    v_mfma_f32_16x16x32_bf16 v[28:31], v[116:119], v[92:95], v[28:31]
    v_mfma_f32_16x16x32_bf16 v[32:35], v[104:107], v[96:99], 0
    v_mfma_f32_16x16x32_bf16 v[32:35], v[112:115], v[100:103], v[32:35]
    v_mfma_f32_16x16x32_bf16 v[36:39], v[108:111], v[96:99], 0
    v_mfma_f32_16x16x32_bf16 v[36:39], v[116:119], v[100:103], v[36:39]
    v_pk_mul_f32 v[8:9], v[8:9], v[40:41] op_sel_hi:[1,0]
    v_pk_mul_f32 v[10:11], v[10:11], v[40:41] op_sel_hi:[1,0]
    v_pk_mul_f32 v[12:13], v[12:13], v[40:41] op_sel_hi:[1,0]
    v_pk_mul_f32 v[14:15], v[14:15], v[40:41] op_sel_hi:[1,0]
    v_cvt_pk_bf16_f32 v128, v8, v9
    v_cvt_pk_bf16_f32 v129, v10, v11
    v_cvt_pk_bf16_f32 v130, v12, v13
    v_cvt_pk_bf16_f32 v131, v14, v15
    buffer_store_dwordx4 v[128:131], v5, s[12:15], s3 offen sc1
    s_add_u32 s3, s3, 32768
    v_pk_mul_f32 v[16:17], v[16:17], v[44:45] op_sel_hi:[1,0]
    v_pk_mul_f32 v[18:19], v[18:19], v[44:45] op_sel_hi:[1,0]
    v_pk_mul_f32 v[20:21], v[20:21], v[44:45] op_sel_hi:[1,0]
    v_pk_mul_f32 v[22:23], v[22:23], v[44:45] op_sel_hi:[1,0]
    v_cvt_pk_bf16_f32 v132, v16, v17
    v_cvt_pk_bf16_f32 v133, v18, v19
    v_cvt_pk_bf16_f32 v134, v20, v21
    v_cvt_pk_bf16_f32 v135, v22, v23
    buffer_store_dwordx4 v[132:135], v5, s[12:15], s3 offen sc1
    s_add_u32 s3, s3, 32768
    v_pk_mul_f32 v[24:25], v[24:25], v[48:49] op_sel_hi:[1,0]
    v_pk_mul_f32 v[26:27], v[26:27], v[48:49] op_sel_hi:[1,0]
    v_pk_mul_f32 v[28:29], v[28:29], v[48:49] op_sel_hi:[1,0]
    v_pk_mul_f32 v[30:31], v[30:31], v[48:49] op_sel_hi:[1,0]
    v_cvt_pk_bf16_f32 v136, v24, v25
    v_cvt_pk_bf16_f32 v137, v26, v27
    v_cvt_pk_bf16_f32 v138, v28, v29
    v_cvt_pk_bf16_f32 v139, v30, v31
    buffer_store_dwordx4 v[136:139], v5, s[12:15], s3 offen sc1
    s_add_u32 s3, s3, 32768
    v_pk_mul_f32 v[32:33], v[32:33], v[52:53] op_sel_hi:[1,0]
    v_pk_mul_f32 v[34:35], v[34:35], v[52:53] op_sel_hi:[1,0]
    v_pk_mul_f32 v[36:37], v[36:37], v[52:53] op_sel_hi:[1,0]
    v_pk_mul_f32 v[38:39], v[38:39], v[52:53] op_sel_hi:[1,0]
    v_cvt_pk_bf16_f32 v140, v32, v33
    v_cvt_pk_bf16_f32 v141, v34, v35
    v_cvt_pk_bf16_f32 v142, v36, v37
    v_cvt_pk_bf16_f32 v143, v38, v39
    buffer_store_dwordx4 v[140:143], v5, s[12:15], s3 offen sc1
    v_lshrrev_b32 v6, 2, v1
    v_lshlrev_b32 v6, 7, v6
    v_and_b32 v7, 3, v1
    v_lshl_add_u32 v6, v7, 3, v6
    v_bfe_u32 v7, v1, 3, 2
    v_xor_b32 v4, 0, v7
    v_lshl_add_u32 v250, v4, 5, v6
    v_xor_b32 v4, 1, v7
    v_lshl_add_u32 v251, v4, 5, v6
    v_xor_b32 v4, 2, v7
    v_lshl_add_u32 v252, v4, 5, v6
    v_xor_b32 v4, 3, v7
    v_lshl_add_u32 v253, v4, 5, v6
    s_lshl_b32 s72, s30, 3
    s_lshl_b32 s3, s38, 1
    s_add_u32 s72, s72, s3
    s_lshl_b32 s72, s72, 15
    s_add_u32 s72, s72, 12582912
    v_add_u32 v4, 32768, v5
    s_mul_i32 s3, s38, 4608
    s_add_u32 s3, s3, 131072
    v_mul_u32_u24 v6, 144, v3
    v_lshl_add_u32 v6, v2, 3, v6
    v_add_u32 v240, s3, v6
    v_mov_b32 v160, s32
    v_mov_b32 v161, s32
    v_mov_b32 v162, s32
    v_mov_b32 v163, s32
    v_mov_b32 v164, 163104
    v_mov_b32 v165, 1
    s_waitcnt vmcnt(0)
    s_mov_b64 exec, 1
    ds_add_rtn_u32 v166, v164, v165 offset:96
    s_waitcnt lgkmcnt(0)
    v_readfirstlane_b32 s3, v166
    s_mov_b64 exec, 0xff
    s_cmp_lg_u32 s3, 3
    s_cbranch_scc1 L_nof
    buffer_store_dwordx4 v[160:163], v5, s[12:15], s66 offen sc1
L_nof:
    s_mov_b64 exec, -1
    s_cmp_lg_u32 s38, 0
    s_cbranch_scc1 L_gw
    s_lshl_b32 s73, s30, 11
    s_add_u32 s73, s73, 1310720
    v_lshlrev_b32 v6, 7, v3
    s_sleep 8
    buffer_load_dword v7, v6, s[12:15], s73 offen sc1
    s_waitcnt vmcnt(0)
L_op:
    v_xor_b32 v7, s32, v7
    v_cmp_ne_u32 vcc, 0, v7
    s_nop 0
    s_cmp_eq_u64 vcc, 0
    s_cbranch_scc1 L_opok
    s_add_u32 s70, s70, 1
    s_cmp_ge_u32 s70, 200000
    s_cbranch_scc1 L_opok
    s_sleep 4
    buffer_load_dword v7, v6, s[12:15], s73 offen sc1
    s_waitcnt vmcnt(0)
    s_branch L_op
L_opok:
    ds_write_b32 v164, v165 offset:100
    s_branch L_gd
L_gw:
    ds_read_b32 v166, v164 offset:100
    s_waitcnt lgkmcnt(0)
    v_readfirstlane_b32 s3, v166
    s_nop 0
    s_cmp_eq_u32 s3, 1
    s_cbranch_scc1 L_gd
    s_sleep 1
    s_branch L_gw
L_gd:
    s_add_u32 s3, s88, 0
    s_and_b32 s3, s3, 15
    s_lshl_b32 s3, s3, 11
    s_add_u32 s3, s3, s72
    buffer_load_dwordx4 v[72:75], v5, s[12:15], s3 offen offset:0 sc1
    buffer_load_dwordx4 v[76:79], v4, s[12:15], s3 offen offset:0 sc1
    buffer_load_dwordx4 v[80:83], v5, s[12:15], s3 offen offset:1024 sc1
    buffer_load_dwordx4 v[84:87], v4, s[12:15], s3 offen offset:1024 sc1
    s_add_u32 s3, s88, 1
    s_and_b32 s3, s3, 15
    s_lshl_b32 s3, s3, 11
    s_add_u32 s3, s3, s72
    buffer_load_dwordx4 v[88:91], v5, s[12:15], s3 offen offset:0 sc1
    buffer_load_dwordx4 v[92:95], v4, s[12:15], s3 offen offset:0 sc1
    buffer_load_dwordx4 v[96:99], v5, s[12:15], s3 offen offset:1024 sc1
    buffer_load_dwordx4 v[100:103], v4, s[12:15], s3 offen offset:1024 sc1
    s_add_u32 s3, s88, 2
    s_and_b32 s3, s3, 15
    s_lshl_b32 s3, s3, 11
    s_add_u32 s3, s3, s72
    buffer_load_dwordx4 v[104:107], v5, s[12:15], s3 offen offset:0 sc1
    buffer_load_dwordx4 v[108:111], v4, s[12:15], s3 offen offset:0 sc1
    buffer_load_dwordx4 v[112:115], v5, s[12:15], s3 offen offset:1024 sc1
    buffer_load_dwordx4 v[116:119], v4, s[12:15], s3 offen offset:1024 sc1
    v_mov_b32 v6, 163104
L_wl:
    ds_read_b128 v[40:43], v6 offset:112
    s_waitcnt lgkmcnt(0)
    v_and_b32 v40, v40, v41
    v_and_b32 v42, v42, v43
    v_and_b32 v40, v40, v42
    s_nop 0
    v_readfirstlane_b32 s65, v40
    s_nop 0
    s_cmp_eq_u32 s65, 1
    s_cbranch_scc0 L_wl
    ds_read_b64_tr_b16 v[40:41], v250 offset:0
    ds_read_b64_tr_b16 v[42:43], v250 offset:2048
    ds_read_b64_tr_b16 v[44:45], v251 offset:0
    ds_read_b64_tr_b16 v[46:47], v251 offset:2048
    ds_read_b64_tr_b16 v[48:49], v252 offset:0
    ds_read_b64_tr_b16 v[50:51], v252 offset:2048
    ds_read_b64_tr_b16 v[52:53], v253 offset:0
    ds_read_b64_tr_b16 v[54:55], v253 offset:2048
    s_add_u32 s3, s88, 3
    s_and_b32 s3, s3, 15
    s_lshl_b32 s3, s3, 11
    s_add_u32 s3, s3, s72
    buffer_load_dwordx4 v[120:123], v5, s[12:15], s3 offen offset:0 sc1
    buffer_load_dwordx4 v[124:127], v4, s[12:15], s3 offen offset:0 sc1
    s_waitcnt vmcnt(12)
    s_waitcnt lgkmcnt(0)
    v_mfma_f32_16x16x32_bf16 v[8:11], v[40:43], v[72:75], 0
    ds_read_b64_tr_b16 v[56:57], v250 offset:4096
    v_mfma_f32_16x16x32_bf16 v[12:15], v[44:47], v[72:75], 0
    ds_read_b64_tr_b16 v[58:59], v250 offset:6144
    v_mfma_f32_16x16x32_bf16 v[16:19], v[48:51], v[72:75], 0
    ds_read_b64_tr_b16 v[60:61], v251 offset:4096
    v_mfma_f32_16x16x32_bf16 v[20:23], v[52:55], v[72:75], 0
    ds_read_b64_tr_b16 v[62:63], v251 offset:6144
    v_mfma_f32_16x16x32_bf16 v[24:27], v[40:43], v[76:79], 0
    ds_read_b64_tr_b16 v[64:65], v252 offset:4096
    v_mfma_f32_16x16x32_bf16 v[28:31], v[44:47], v[76:79], 0
    ds_read_b64_tr_b16 v[66:67], v252 offset:6144
    v_mfma_f32_16x16x32_bf16 v[32:35], v[48:51], v[76:79], 0
    ds_read_b64_tr_b16 v[68:69], v253 offset:4096
    v_mfma_f32_16x16x32_bf16 v[36:39], v[52:55], v[76:79], 0
    ds_read_b64_tr_b16 v[70:71], v253 offset:6144
    buffer_load_dwordx4 v[72:75], v5, s[12:15], s3 offen offset:1024 sc1
    buffer_load_dwordx4 v[76:79], v4, s[12:15], s3 offen offset:1024 sc1
    s_waitcnt vmcnt(12)
    s_waitcnt lgkmcnt(0)
    v_mfma_f32_16x16x32_bf16 v[8:11], v[56:59], v[80:83], v[8:11]
    ds_read_b64_tr_b16 v[40:41], v250 offset:8192
    v_mfma_f32_16x16x32_bf16 v[12:15], v[60:63], v[80:83], v[12:15]
    ds_read_b64_tr_b16 v[42:43], v250 offset:10240
    v_mfma_f32_16x16x32_bf16 v[16:19], v[64:67], v[80:83], v[16:19]
    ds_read_b64_tr_b16 v[44:45], v251 offset:8192
    v_mfma_f32_16x16x32_bf16 v[20:23], v[68:71], v[80:83], v[20:23]
    ds_read_b64_tr_b16 v[46:47], v251 offset:10240
    v_mfma_f32_16x16x32_bf16 v[24:27], v[56:59], v[84:87], v[24:27]
    ds_read_b64_tr_b16 v[48:49], v252 offset:8192
    v_mfma_f32_16x16x32_bf16 v[28:31], v[60:63], v[84:87], v[28:31]
    ds_read_b64_tr_b16 v[50:51], v252 offset:10240
    v_mfma_f32_16x16x32_bf16 v[32:35], v[64:67], v[84:87], v[32:35]
    ds_read_b64_tr_b16 v[52:53], v253 offset:8192
    v_mfma_f32_16x16x32_bf16 v[36:39], v[68:71], v[84:87], v[36:39]
    ds_read_b64_tr_b16 v[54:55], v253 offset:10240
    s_add_u32 s3, s88, 4
    s_and_b32 s3, s3, 15
    s_lshl_b32 s3, s3, 11
    s_add_u32 s3, s3, s72
    buffer_load_dwordx4 v[80:83], v5, s[12:15], s3 offen offset:0 sc1
    buffer_load_dwordx4 v[84:87], v4, s[12:15], s3 offen offset:0 sc1
    s_waitcnt vmcnt(12)
    s_waitcnt lgkmcnt(0)
    v_mfma_f32_16x16x32_bf16 v[8:11], v[40:43], v[88:91], v[8:11]
    ds_read_b64_tr_b16 v[56:57], v250 offset:12288
    v_mfma_f32_16x16x32_bf16 v[12:15], v[44:47], v[88:91], v[12:15]
    ds_read_b64_tr_b16 v[58:59], v250 offset:14336
    v_mfma_f32_16x16x32_bf16 v[16:19], v[48:51], v[88:91], v[16:19]
    ds_read_b64_tr_b16 v[60:61], v251 offset:12288
    v_mfma_f32_16x16x32_bf16 v[20:23], v[52:55], v[88:91], v[20:23]
    ds_read_b64_tr_b16 v[62:63], v251 offset:14336
    v_mfma_f32_16x16x32_bf16 v[24:27], v[40:43], v[92:95], v[24:27]
    ds_read_b64_tr_b16 v[64:65], v252 offset:12288
    v_mfma_f32_16x16x32_bf16 v[28:31], v[44:47], v[92:95], v[28:31]
    ds_read_b64_tr_b16 v[66:67], v252 offset:14336
    v_mfma_f32_16x16x32_bf16 v[32:35], v[48:51], v[92:95], v[32:35]
    ds_read_b64_tr_b16 v[68:69], v253 offset:12288
    v_mfma_f32_16x16x32_bf16 v[36:39], v[52:55], v[92:95], v[36:39]
    ds_read_b64_tr_b16 v[70:71], v253 offset:14336
    buffer_load_dwordx4 v[88:91], v5, s[12:15], s3 offen offset:1024 sc1
    buffer_load_dwordx4 v[92:95], v4, s[12:15], s3 offen offset:1024 sc1
    s_waitcnt vmcnt(12)
    s_waitcnt lgkmcnt(0)
    v_mfma_f32_16x16x32_bf16 v[8:11], v[56:59], v[96:99], v[8:11]
    ds_read_b64_tr_b16 v[40:41], v250 offset:16384
    v_mfma_f32_16x16x32_bf16 v[12:15], v[60:63], v[96:99], v[12:15]
    ds_read_b64_tr_b16 v[42:43], v250 offset:18432
    v_mfma_f32_16x16x32_bf16 v[16:19], v[64:67], v[96:99], v[16:19]
    ds_read_b64_tr_b16 v[44:45], v251 offset:16384
    v_mfma_f32_16x16x32_bf16 v[20:23], v[68:71], v[96:99], v[20:23]
    ds_read_b64_tr_b16 v[46:47], v251 offset:18432
    v_mfma_f32_16x16x32_bf16 v[24:27], v[56:59], v[100:103], v[24:27]
    ds_read_b64_tr_b16 v[48:49], v252 offset:16384
    v_mfma_f32_16x16x32_bf16 v[28:31], v[60:63], v[100:103], v[28:31]
    ds_read_b64_tr_b16 v[50:51], v252 offset:18432
    v_mfma_f32_16x16x32_bf16 v[32:35], v[64:67], v[100:103], v[32:35]
    ds_read_b64_tr_b16 v[52:53], v253 offset:16384
    v_mfma_f32_16x16x32_bf16 v[36:39], v[68:71], v[100:103], v[36:39]
    ds_read_b64_tr_b16 v[54:55], v253 offset:18432
    s_add_u32 s3, s88, 5
    s_and_b32 s3, s3, 15
    s_lshl_b32 s3, s3, 11
    s_add_u32 s3, s3, s72
    buffer_load_dwordx4 v[96:99], v5, s[12:15], s3 offen offset:0 sc1
    buffer_load_dwordx4 v[100:103], v4, s[12:15], s3 offen offset:0 sc1
    s_waitcnt vmcnt(12)
    s_waitcnt lgkmcnt(0)
    v_mfma_f32_16x16x32_bf16 v[8:11], v[40:43], v[104:107], v[8:11]
    ds_read_b64_tr_b16 v[56:57], v250 offset:20480
    v_mfma_f32_16x16x32_bf16 v[12:15], v[44:47], v[104:107], v[12:15]
    ds_read_b64_tr_b16 v[58:59], v250 offset:22528
    v_mfma_f32_16x16x32_bf16 v[16:19], v[48:51], v[104:107], v[16:19]
    ds_read_b64_tr_b16 v[60:61], v251 offset:20480
    v_mfma_f32_16x16x32_bf16 v[20:23], v[52:55], v[104:107], v[20:23]
    ds_read_b64_tr_b16 v[62:63], v251 offset:22528
    v_mfma_f32_16x16x32_bf16 v[24:27], v[40:43], v[108:111], v[24:27]
    ds_read_b64_tr_b16 v[64:65], v252 offset:20480
    v_mfma_f32_16x16x32_bf16 v[28:31], v[44:47], v[108:111], v[28:31]
    ds_read_b64_tr_b16 v[66:67], v252 offset:22528
    v_mfma_f32_16x16x32_bf16 v[32:35], v[48:51], v[108:111], v[32:35]
    ds_read_b64_tr_b16 v[68:69], v253 offset:20480
    v_mfma_f32_16x16x32_bf16 v[36:39], v[52:55], v[108:111], v[36:39]
    ds_read_b64_tr_b16 v[70:71], v253 offset:22528
    buffer_load_dwordx4 v[104:107], v5, s[12:15], s3 offen offset:1024 sc1
    buffer_load_dwordx4 v[108:111], v4, s[12:15], s3 offen offset:1024 sc1
    s_waitcnt vmcnt(12)
    s_waitcnt lgkmcnt(0)
    v_mfma_f32_16x16x32_bf16 v[8:11], v[56:59], v[112:115], v[8:11]
    ds_read_b64_tr_b16 v[40:41], v250 offset:24576
    v_mfma_f32_16x16x32_bf16 v[12:15], v[60:63], v[112:115], v[12:15]
    ds_read_b64_tr_b16 v[42:43], v250 offset:26624
    v_mfma_f32_16x16x32_bf16 v[16:19], v[64:67], v[112:115], v[16:19]
    ds_read_b64_tr_b16 v[44:45], v251 offset:24576
    v_mfma_f32_16x16x32_bf16 v[20:23], v[68:71], v[112:115], v[20:23]
    ds_read_b64_tr_b16 v[46:47], v251 offset:26624
    v_mfma_f32_16x16x32_bf16 v[24:27], v[56:59], v[116:119], v[24:27]
    ds_read_b64_tr_b16 v[48:49], v252 offset:24576
    v_mfma_f32_16x16x32_bf16 v[28:31], v[60:63], v[116:119], v[28:31]
    ds_read_b64_tr_b16 v[50:51], v252 offset:26624
    v_mfma_f32_16x16x32_bf16 v[32:35], v[64:67], v[116:119], v[32:35]
    ds_read_b64_tr_b16 v[52:53], v253 offset:24576
    v_mfma_f32_16x16x32_bf16 v[36:39], v[68:71], v[116:119], v[36:39]
    ds_read_b64_tr_b16 v[54:55], v253 offset:26624
    s_add_u32 s3, s88, 6
    s_and_b32 s3, s3, 15
    s_lshl_b32 s3, s3, 11
    s_add_u32 s3, s3, s72
    buffer_load_dwordx4 v[112:115], v5, s[12:15], s3 offen offset:0 sc1
    buffer_load_dwordx4 v[116:119], v4, s[12:15], s3 offen offset:0 sc1
    s_waitcnt vmcnt(12)
    s_waitcnt lgkmcnt(0)
    v_mfma_f32_16x16x32_bf16 v[8:11], v[40:43], v[120:123], v[8:11]
    ds_read_b64_tr_b16 v[56:57], v250 offset:28672
    v_mfma_f32_16x16x32_bf16 v[12:15], v[44:47], v[120:123], v[12:15]
    ds_read_b64_tr_b16 v[58:59], v250 offset:30720
    v_mfma_f32_16x16x32_bf16 v[16:19], v[48:51], v[120:123], v[16:19]
    ds_read_b64_tr_b16 v[60:61], v251 offset:28672
    v_mfma_f32_16x16x32_bf16 v[20:23], v[52:55], v[120:123], v[20:23]
    ds_read_b64_tr_b16 v[62:63], v251 offset:30720
    v_mfma_f32_16x16x32_bf16 v[24:27], v[40:43], v[124:127], v[24:27]
    ds_read_b64_tr_b16 v[64:65], v252 offset:28672
    v_mfma_f32_16x16x32_bf16 v[28:31], v[44:47], v[124:127], v[28:31]
    ds_read_b64_tr_b16 v[66:67], v252 offset:30720
    v_mfma_f32_16x16x32_bf16 v[32:35], v[48:51], v[124:127], v[32:35]
    ds_read_b64_tr_b16 v[68:69], v253 offset:28672
    v_mfma_f32_16x16x32_bf16 v[36:39], v[52:55], v[124:127], v[36:39]
    ds_read_b64_tr_b16 v[70:71], v253 offset:30720
    buffer_load_dwordx4 v[120:123], v5, s[12:15], s3 offen offset:1024 sc1
    buffer_load_dwordx4 v[124:127], v4, s[12:15], s3 offen offset:1024 sc1
    s_waitcnt vmcnt(12)
    s_waitcnt lgkmcnt(0)
    v_mfma_f32_16x16x32_bf16 v[8:11], v[56:59], v[72:75], v[8:11]
    ds_read_b64_tr_b16 v[40:41], v250 offset:32768
    v_mfma_f32_16x16x32_bf16 v[12:15], v[60:63], v[72:75], v[12:15]
    ds_read_b64_tr_b16 v[42:43], v250 offset:34816
    v_mfma_f32_16x16x32_bf16 v[16:19], v[64:67], v[72:75], v[16:19]
    ds_read_b64_tr_b16 v[44:45], v251 offset:32768
    v_mfma_f32_16x16x32_bf16 v[20:23], v[68:71], v[72:75], v[20:23]
    ds_read_b64_tr_b16 v[46:47], v251 offset:34816
    v_mfma_f32_16x16x32_bf16 v[24:27], v[56:59], v[76:79], v[24:27]
    ds_read_b64_tr_b16 v[48:49], v252 offset:32768
    v_mfma_f32_16x16x32_bf16 v[28:31], v[60:63], v[76:79], v[28:31]
    ds_read_b64_tr_b16 v[50:51], v252 offset:34816
    v_mfma_f32_16x16x32_bf16 v[32:35], v[64:67], v[76:79], v[32:35]
    ds_read_b64_tr_b16 v[52:53], v253 offset:32768
    v_mfma_f32_16x16x32_bf16 v[36:39], v[68:71], v[76:79], v[36:39]
    ds_read_b64_tr_b16 v[54:55], v253 offset:34816
    s_add_u32 s3, s88, 7
    s_and_b32 s3, s3, 15
    s_lshl_b32 s3, s3, 11
    s_add_u32 s3, s3, s72
    buffer_load_dwordx4 v[72:75], v5, s[12:15], s3 offen offset:0 sc1
    buffer_load_dwordx4 v[76:79], v4, s[12:15], s3 offen offset:0 sc1
    s_waitcnt vmcnt(12)
    s_waitcnt lgkmcnt(0)
    v_mfma_f32_16x16x32_bf16 v[8:11], v[40:43], v[80:83], v[8:11]
    ds_read_b64_tr_b16 v[56:57], v250 offset:36864
    v_mfma_f32_16x16x32_bf16 v[12:15], v[44:47], v[80:83], v[12:15]
    ds_read_b64_tr_b16 v[58:59], v250 offset:38912
    v_mfma_f32_16x16x32_bf16 v[16:19], v[48:51], v[80:83], v[16:19]
    ds_read_b64_tr_b16 v[60:61], v251 offset:36864
    v_mfma_f32_16x16x32_bf16 v[20:23], v[52:55], v[80:83], v[20:23]
    ds_read_b64_tr_b16 v[62:63], v251 offset:38912
    v_mfma_f32_16x16x32_bf16 v[24:27], v[40:43], v[84:87], v[24:27]
    ds_read_b64_tr_b16 v[64:65], v252 offset:36864
    v_mfma_f32_16x16x32_bf16 v[28:31], v[44:47], v[84:87], v[28:31]
    ds_read_b64_tr_b16 v[66:67], v252 offset:38912
    v_mfma_f32_16x16x32_bf16 v[32:35], v[48:51], v[84:87], v[32:35]
    ds_read_b64_tr_b16 v[68:69], v253 offset:36864
    v_mfma_f32_16x16x32_bf16 v[36:39], v[52:55], v[84:87], v[36:39]
    ds_read_b64_tr_b16 v[70:71], v253 offset:38912
    buffer_load_dwordx4 v[80:83], v5, s[12:15], s3 offen offset:1024 sc1
    buffer_load_dwordx4 v[84:87], v4, s[12:15], s3 offen offset:1024 sc1
    s_waitcnt vmcnt(12)
    s_waitcnt lgkmcnt(0)
    v_mfma_f32_16x16x32_bf16 v[8:11], v[56:59], v[88:91], v[8:11]
    ds_read_b64_tr_b16 v[40:41], v250 offset:40960
    v_mfma_f32_16x16x32_bf16 v[12:15], v[60:63], v[88:91], v[12:15]
    ds_read_b64_tr_b16 v[42:43], v250 offset:43008
    v_mfma_f32_16x16x32_bf16 v[16:19], v[64:67], v[88:91], v[16:19]
    ds_read_b64_tr_b16 v[44:45], v251 offset:40960
    v_mfma_f32_16x16x32_bf16 v[20:23], v[68:71], v[88:91], v[20:23]
    ds_read_b64_tr_b16 v[46:47], v251 offset:43008
    v_mfma_f32_16x16x32_bf16 v[24:27], v[56:59], v[92:95], v[24:27]
    ds_read_b64_tr_b16 v[48:49], v252 offset:40960
    v_mfma_f32_16x16x32_bf16 v[28:31], v[60:63], v[92:95], v[28:31]
    ds_read_b64_tr_b16 v[50:51], v252 offset:43008
    v_mfma_f32_16x16x32_bf16 v[32:35], v[64:67], v[92:95], v[32:35]
    ds_read_b64_tr_b16 v[52:53], v253 offset:40960
    v_mfma_f32_16x16x32_bf16 v[36:39], v[68:71], v[92:95], v[36:39]
    ds_read_b64_tr_b16 v[54:55], v253 offset:43008
    s_add_u32 s3, s88, 8
    s_and_b32 s3, s3, 15
    s_lshl_b32 s3, s3, 11
    s_add_u32 s3, s3, s72
    buffer_load_dwordx4 v[88:91], v5, s[12:15], s3 offen offset:0 sc1
    buffer_load_dwordx4 v[92:95], v4, s[12:15], s3 offen offset:0 sc1
    s_waitcnt vmcnt(12)
    s_waitcnt lgkmcnt(0)
    v_mfma_f32_16x16x32_bf16 v[8:11], v[40:43], v[96:99], v[8:11]
    ds_read_b64_tr_b16 v[56:57], v250 offset:45056
    v_mfma_f32_16x16x32_bf16 v[12:15], v[44:47], v[96:99], v[12:15]
    ds_read_b64_tr_b16 v[58:59], v250 offset:47104
    v_mfma_f32_16x16x32_bf16 v[16:19], v[48:51], v[96:99], v[16:19]
    ds_read_b64_tr_b16 v[60:61], v251 offset:45056
    v_mfma_f32_16x16x32_bf16 v[20:23], v[52:55], v[96:99], v[20:23]
    ds_read_b64_tr_b16 v[62:63], v251 offset:47104
    v_mfma_f32_16x16x32_bf16 v[24:27], v[40:43], v[100:103], v[24:27]
    ds_read_b64_tr_b16 v[64:65], v252 offset:45056
    v_mfma_f32_16x16x32_bf16 v[28:31], v[44:47], v[100:103], v[28:31]
    ds_read_b64_tr_b16 v[66:67], v252 offset:47104
    v_mfma_f32_16x16x32_bf16 v[32:35], v[48:51], v[100:103], v[32:35]
    ds_read_b64_tr_b16 v[68:69], v253 offset:45056
    v_mfma_f32_16x16x32_bf16 v[36:39], v[52:55], v[100:103], v[36:39]
    ds_read_b64_tr_b16 v[70:71], v253 offset:47104
    buffer_load_dwordx4 v[96:99], v5, s[12:15], s3 offen offset:1024 sc1
    buffer_load_dwordx4 v[100:103], v4, s[12:15], s3 offen offset:1024 sc1
    s_waitcnt vmcnt(12)
    s_waitcnt lgkmcnt(0)
    v_mfma_f32_16x16x32_bf16 v[8:11], v[56:59], v[104:107], v[8:11]
    ds_read_b64_tr_b16 v[40:41], v250 offset:49152
    v_mfma_f32_16x16x32_bf16 v[12:15], v[60:63], v[104:107], v[12:15]
    ds_read_b64_tr_b16 v[42:43], v250 offset:51200
    v_mfma_f32_16x16x32_bf16 v[16:19], v[64:67], v[104:107], v[16:19]
    ds_read_b64_tr_b16 v[44:45], v251 offset:49152
    v_mfma_f32_16x16x32_bf16 v[20:23], v[68:71], v[104:107], v[20:23]
    ds_read_b64_tr_b16 v[46:47], v251 offset:51200
    v_mfma_f32_16x16x32_bf16 v[24:27], v[56:59], v[108:111], v[24:27]
    ds_read_b64_tr_b16 v[48:49], v252 offset:49152
    v_mfma_f32_16x16x32_bf16 v[28:31], v[60:63], v[108:111], v[28:31]
    ds_read_b64_tr_b16 v[50:51], v252 offset:51200
    v_mfma_f32_16x16x32_bf16 v[32:35], v[64:67], v[108:111], v[32:35]
    ds_read_b64_tr_b16 v[52:53], v253 offset:49152
    v_mfma_f32_16x16x32_bf16 v[36:39], v[68:71], v[108:111], v[36:39]
    ds_read_b64_tr_b16 v[54:55], v253 offset:51200
    s_add_u32 s3, s88, 9
    s_and_b32 s3, s3, 15
    s_lshl_b32 s3, s3, 11
    s_add_u32 s3, s3, s72
    buffer_load_dwordx4 v[104:107], v5, s[12:15], s3 offen offset:0 sc1
    buffer_load_dwordx4 v[108:111], v4, s[12:15], s3 offen offset:0 sc1
    s_waitcnt vmcnt(12)
    s_waitcnt lgkmcnt(0)
    v_mfma_f32_16x16x32_bf16 v[8:11], v[40:43], v[112:115], v[8:11]
    ds_read_b64_tr_b16 v[56:57], v250 offset:53248
    v_mfma_f32_16x16x32_bf16 v[12:15], v[44:47], v[112:115], v[12:15]
    ds_read_b64_tr_b16 v[58:59], v250 offset:55296
    v_mfma_f32_16x16x32_bf16 v[16:19], v[48:51], v[112:115], v[16:19]
    ds_read_b64_tr_b16 v[60:61], v251 offset:53248
    v_mfma_f32_16x16x32_bf16 v[20:23], v[52:55], v[112:115], v[20:23]
    ds_read_b64_tr_b16 v[62:63], v251 offset:55296
    v_mfma_f32_16x16x32_bf16 v[24:27], v[40:43], v[116:119], v[24:27]
    ds_read_b64_tr_b16 v[64:65], v252 offset:53248
    v_mfma_f32_16x16x32_bf16 v[28:31], v[44:47], v[116:119], v[28:31]
    ds_read_b64_tr_b16 v[66:67], v252 offset:55296
    v_mfma_f32_16x16x32_bf16 v[32:35], v[48:51], v[116:119], v[32:35]
    ds_read_b64_tr_b16 v[68:69], v253 offset:53248
    v_mfma_f32_16x16x32_bf16 v[36:39], v[52:55], v[116:119], v[36:39]
    ds_read_b64_tr_b16 v[70:71], v253 offset:55296
    buffer_load_dwordx4 v[112:115], v5, s[12:15], s3 offen offset:1024 sc1
    buffer_load_dwordx4 v[116:119], v4, s[12:15], s3 offen offset:1024 sc1
    s_waitcnt vmcnt(12)
    s_waitcnt lgkmcnt(0)
    v_mfma_f32_16x16x32_bf16 v[8:11], v[56:59], v[120:123], v[8:11]
    ds_read_b64_tr_b16 v[40:41], v250 offset:57344
    v_mfma_f32_16x16x32_bf16 v[12:15], v[60:63], v[120:123], v[12:15]
    ds_read_b64_tr_b16 v[42:43], v250 offset:59392
    v_mfma_f32_16x16x32_bf16 v[16:19], v[64:67], v[120:123], v[16:19]
    ds_read_b64_tr_b16 v[44:45], v251 offset:57344
    v_mfma_f32_16x16x32_bf16 v[20:23], v[68:71], v[120:123], v[20:23]
    ds_read_b64_tr_b16 v[46:47], v251 offset:59392
    v_mfma_f32_16x16x32_bf16 v[24:27], v[56:59], v[124:127], v[24:27]
    ds_read_b64_tr_b16 v[48:49], v252 offset:57344
    v_mfma_f32_16x16x32_bf16 v[28:31], v[60:63], v[124:127], v[28:31]
    ds_read_b64_tr_b16 v[50:51], v252 offset:59392
    v_mfma_f32_16x16x32_bf16 v[32:35], v[64:67], v[124:127], v[32:35]
    ds_read_b64_tr_b16 v[52:53], v253 offset:57344
    v_mfma_f32_16x16x32_bf16 v[36:39], v[68:71], v[124:127], v[36:39]
    ds_read_b64_tr_b16 v[54:55], v253 offset:59392
    s_add_u32 s3, s88, 10
    s_and_b32 s3, s3, 15
    s_lshl_b32 s3, s3, 11
    s_add_u32 s3, s3, s72
    buffer_load_dwordx4 v[120:123], v5, s[12:15], s3 offen offset:0 sc1
    buffer_load_dwordx4 v[124:127], v4, s[12:15], s3 offen offset:0 sc1
    s_waitcnt vmcnt(12)
    s_waitcnt lgkmcnt(0)
    v_mfma_f32_16x16x32_bf16 v[8:11], v[40:43], v[72:75], v[8:11]
    ds_read_b64_tr_b16 v[56:57], v250 offset:61440
    v_mfma_f32_16x16x32_bf16 v[12:15], v[44:47], v[72:75], v[12:15]
    ds_read_b64_tr_b16 v[58:59], v250 offset:63488
    v_mfma_f32_16x16x32_bf16 v[16:19], v[48:51], v[72:75], v[16:19]
    ds_read_b64_tr_b16 v[60:61], v251 offset:61440
    v_mfma_f32_16x16x32_bf16 v[20:23], v[52:55], v[72:75], v[20:23]
    ds_read_b64_tr_b16 v[62:63], v251 offset:63488
    v_mfma_f32_16x16x32_bf16 v[24:27], v[40:43], v[76:79], v[24:27]
    ds_read_b64_tr_b16 v[64:65], v252 offset:61440
    v_mfma_f32_16x16x32_bf16 v[28:31], v[44:47], v[76:79], v[28:31]
    ds_read_b64_tr_b16 v[66:67], v252 offset:63488
    v_mfma_f32_16x16x32_bf16 v[32:35], v[48:51], v[76:79], v[32:35]
    ds_read_b64_tr_b16 v[68:69], v253 offset:61440
    v_mfma_f32_16x16x32_bf16 v[36:39], v[52:55], v[76:79], v[36:39]
    ds_read_b64_tr_b16 v[70:71], v253 offset:63488
    buffer_load_dwordx4 v[72:75], v5, s[12:15], s3 offen offset:1024 sc1
    buffer_load_dwordx4 v[76:79], v4, s[12:15], s3 offen offset:1024 sc1
    s_waitcnt vmcnt(12)
    s_waitcnt lgkmcnt(0)
    v_add_u32 v250, 0x10000, v250
    v_add_u32 v251, 0x10000, v251
    v_add_u32 v252, 0x10000, v252
    v_add_u32 v253, 0x10000, v253
    v_mfma_f32_16x16x32_bf16 v[8:11], v[56:59], v[80:83], v[8:11]
    ds_read_b64_tr_b16 v[40:41], v250 offset:0
    v_mfma_f32_16x16x32_bf16 v[12:15], v[60:63], v[80:83], v[12:15]
    ds_read_b64_tr_b16 v[42:43], v250 offset:2048
    v_mfma_f32_16x16x32_bf16 v[16:19], v[64:67], v[80:83], v[16:19]
    ds_read_b64_tr_b16 v[44:45], v251 offset:0
    v_mfma_f32_16x16x32_bf16 v[20:23], v[68:71], v[80:83], v[20:23]
    ds_read_b64_tr_b16 v[46:47], v251 offset:2048
    v_mfma_f32_16x16x32_bf16 v[24:27], v[56:59], v[84:87], v[24:27]
    ds_read_b64_tr_b16 v[48:49], v252 offset:0
    v_mfma_f32_16x16x32_bf16 v[28:31], v[60:63], v[84:87], v[28:31]
    ds_read_b64_tr_b16 v[50:51], v252 offset:2048
    v_mfma_f32_16x16x32_bf16 v[32:35], v[64:67], v[84:87], v[32:35]
    ds_read_b64_tr_b16 v[52:53], v253 offset:0
    v_mfma_f32_16x16x32_bf16 v[36:39], v[68:71], v[84:87], v[36:39]
    ds_read_b64_tr_b16 v[54:55], v253 offset:2048
    s_add_u32 s3, s88, 11
    s_and_b32 s3, s3, 15
    s_lshl_b32 s3, s3, 11
    s_add_u32 s3, s3, s72
    buffer_load_dwordx4 v[80:83], v5, s[12:15], s3 offen offset:0 sc1
    buffer_load_dwordx4 v[84:87], v4, s[12:15], s3 offen offset:0 sc1
    s_waitcnt vmcnt(12)
    s_waitcnt lgkmcnt(0)
    v_mfma_f32_16x16x32_bf16 v[8:11], v[40:43], v[88:91], v[8:11]
    ds_read_b64_tr_b16 v[56:57], v250 offset:4096
    v_mfma_f32_16x16x32_bf16 v[12:15], v[44:47], v[88:91], v[12:15]
    ds_read_b64_tr_b16 v[58:59], v250 offset:6144
    v_mfma_f32_16x16x32_bf16 v[16:19], v[48:51], v[88:91], v[16:19]
    ds_read_b64_tr_b16 v[60:61], v251 offset:4096
    v_mfma_f32_16x16x32_bf16 v[20:23], v[52:55], v[88:91], v[20:23]
    ds_read_b64_tr_b16 v[62:63], v251 offset:6144
    v_mfma_f32_16x16x32_bf16 v[24:27], v[40:43], v[92:95], v[24:27]
    ds_read_b64_tr_b16 v[64:65], v252 offset:4096
    v_mfma_f32_16x16x32_bf16 v[28:31], v[44:47], v[92:95], v[28:31]
    ds_read_b64_tr_b16 v[66:67], v252 offset:6144
    v_mfma_f32_16x16x32_bf16 v[32:35], v[48:51], v[92:95], v[32:35]
    ds_read_b64_tr_b16 v[68:69], v253 offset:4096
    v_mfma_f32_16x16x32_bf16 v[36:39], v[52:55], v[92:95], v[36:39]
    ds_read_b64_tr_b16 v[70:71], v253 offset:6144
    buffer_load_dwordx4 v[88:91], v5, s[12:15], s3 offen offset:1024 sc1
    buffer_load_dwordx4 v[92:95], v4, s[12:15], s3 offen offset:1024 sc1
    s_waitcnt vmcnt(12)
    s_waitcnt lgkmcnt(0)
    v_mfma_f32_16x16x32_bf16 v[8:11], v[56:59], v[96:99], v[8:11]
    ds_read_b64_tr_b16 v[40:41], v250 offset:8192
    v_mfma_f32_16x16x32_bf16 v[12:15], v[60:63], v[96:99], v[12:15]
    ds_read_b64_tr_b16 v[42:43], v250 offset:10240
    v_mfma_f32_16x16x32_bf16 v[16:19], v[64:67], v[96:99], v[16:19]
    ds_read_b64_tr_b16 v[44:45], v251 offset:8192
    v_mfma_f32_16x16x32_bf16 v[20:23], v[68:71], v[96:99], v[20:23]
    ds_read_b64_tr_b16 v[46:47], v251 offset:10240
    v_mfma_f32_16x16x32_bf16 v[24:27], v[56:59], v[100:103], v[24:27]
    ds_read_b64_tr_b16 v[48:49], v252 offset:8192
    v_mfma_f32_16x16x32_bf16 v[28:31], v[60:63], v[100:103], v[28:31]
    ds_read_b64_tr_b16 v[50:51], v252 offset:10240
    v_mfma_f32_16x16x32_bf16 v[32:35], v[64:67], v[100:103], v[32:35]
    ds_read_b64_tr_b16 v[52:53], v253 offset:8192
    v_mfma_f32_16x16x32_bf16 v[36:39], v[68:71], v[100:103], v[36:39]
    ds_read_b64_tr_b16 v[54:55], v253 offset:10240
    s_add_u32 s3, s88, 12
    s_and_b32 s3, s3, 15
    s_lshl_b32 s3, s3, 11
    s_add_u32 s3, s3, s72
    buffer_load_dwordx4 v[96:99], v5, s[12:15], s3 offen offset:0 sc1
    buffer_load_dwordx4 v[100:103], v4, s[12:15], s3 offen offset:0 sc1
    s_waitcnt vmcnt(12)
    s_waitcnt lgkmcnt(0)
    v_mfma_f32_16x16x32_bf16 v[8:11], v[40:43], v[104:107], v[8:11]
    ds_read_b64_tr_b16 v[56:57], v250 offset:12288
    v_mfma_f32_16x16x32_bf16 v[12:15], v[44:47], v[104:107], v[12:15]
    ds_read_b64_tr_b16 v[58:59], v250 offset:14336
    v_mfma_f32_16x16x32_bf16 v[16:19], v[48:51], v[104:107], v[16:19]
    ds_read_b64_tr_b16 v[60:61], v251 offset:12288
    v_mfma_f32_16x16x32_bf16 v[20:23], v[52:55], v[104:107], v[20:23]
    ds_read_b64_tr_b16 v[62:63], v251 offset:14336
    v_mfma_f32_16x16x32_bf16 v[24:27], v[40:43], v[108:111], v[24:27]
    ds_read_b64_tr_b16 v[64:65], v252 offset:12288
    v_mfma_f32_16x16x32_bf16 v[28:31], v[44:47], v[108:111], v[28:31]
    ds_read_b64_tr_b16 v[66:67], v252 offset:14336
    v_mfma_f32_16x16x32_bf16 v[32:35], v[48:51], v[108:111], v[32:35]
    ds_read_b64_tr_b16 v[68:69], v253 offset:12288
    v_mfma_f32_16x16x32_bf16 v[36:39], v[52:55], v[108:111], v[36:39]
    ds_read_b64_tr_b16 v[70:71], v253 offset:14336
    buffer_load_dwordx4 v[104:107], v5, s[12:15], s3 offen offset:1024 sc1
    buffer_load_dwordx4 v[108:111], v4, s[12:15], s3 offen offset:1024 sc1
    s_waitcnt vmcnt(12)
    s_waitcnt lgkmcnt(0)
    v_mfma_f32_16x16x32_bf16 v[8:11], v[56:59], v[112:115], v[8:11]
    ds_read_b64_tr_b16 v[40:41], v250 offset:16384
    v_mfma_f32_16x16x32_bf16 v[12:15], v[60:63], v[112:115], v[12:15]
    ds_read_b64_tr_b16 v[42:43], v250 offset:18432
    v_mfma_f32_16x16x32_bf16 v[16:19], v[64:67], v[112:115], v[16:19]
    ds_read_b64_tr_b16 v[44:45], v251 offset:16384
    v_mfma_f32_16x16x32_bf16 v[20:23], v[68:71], v[112:115], v[20:23]
    ds_read_b64_tr_b16 v[46:47], v251 offset:18432
    v_mfma_f32_16x16x32_bf16 v[24:27], v[56:59], v[116:119], v[24:27]
    ds_read_b64_tr_b16 v[48:49], v252 offset:16384
    v_mfma_f32_16x16x32_bf16 v[28:31], v[60:63], v[116:119], v[28:31]
    ds_read_b64_tr_b16 v[50:51], v252 offset:18432
    v_mfma_f32_16x16x32_bf16 v[32:35], v[64:67], v[116:119], v[32:35]
    ds_read_b64_tr_b16 v[52:53], v253 offset:16384
    v_mfma_f32_16x16x32_bf16 v[36:39], v[68:71], v[116:119], v[36:39]
    ds_read_b64_tr_b16 v[54:55], v253 offset:18432
    s_add_u32 s3, s88, 13
    s_and_b32 s3, s3, 15
    s_lshl_b32 s3, s3, 11
    s_add_u32 s3, s3, s72
    buffer_load_dwordx4 v[112:115], v5, s[12:15], s3 offen offset:0 sc1
    buffer_load_dwordx4 v[116:119], v4, s[12:15], s3 offen offset:0 sc1
    s_waitcnt vmcnt(12)
    s_waitcnt lgkmcnt(0)
    v_mfma_f32_16x16x32_bf16 v[8:11], v[40:43], v[120:123], v[8:11]
    ds_read_b64_tr_b16 v[56:57], v250 offset:20480
    v_mfma_f32_16x16x32_bf16 v[12:15], v[44:47], v[120:123], v[12:15]
    ds_read_b64_tr_b16 v[58:59], v250 offset:22528
    v_mfma_f32_16x16x32_bf16 v[16:19], v[48:51], v[120:123], v[16:19]
    ds_read_b64_tr_b16 v[60:61], v251 offset:20480
    v_mfma_f32_16x16x32_bf16 v[20:23], v[52:55], v[120:123], v[20:23]
    ds_read_b64_tr_b16 v[62:63], v251 offset:22528
    v_mfma_f32_16x16x32_bf16 v[24:27], v[40:43], v[124:127], v[24:27]
    ds_read_b64_tr_b16 v[64:65], v252 offset:20480
    v_mfma_f32_16x16x32_bf16 v[28:31], v[44:47], v[124:127], v[28:31]
    ds_read_b64_tr_b16 v[66:67], v252 offset:22528
    v_mfma_f32_16x16x32_bf16 v[32:35], v[48:51], v[124:127], v[32:35]
    ds_read_b64_tr_b16 v[68:69], v253 offset:20480
    v_mfma_f32_16x16x32_bf16 v[36:39], v[52:55], v[124:127], v[36:39]
    ds_read_b64_tr_b16 v[70:71], v253 offset:22528
    buffer_load_dwordx4 v[120:123], v5, s[12:15], s3 offen offset:1024 sc1
    buffer_load_dwordx4 v[124:127], v4, s[12:15], s3 offen offset:1024 sc1
    s_waitcnt vmcnt(12)
    s_waitcnt lgkmcnt(0)
    v_mfma_f32_16x16x32_bf16 v[8:11], v[56:59], v[72:75], v[8:11]
    ds_read_b64_tr_b16 v[40:41], v250 offset:24576
    v_mfma_f32_16x16x32_bf16 v[12:15], v[60:63], v[72:75], v[12:15]
    ds_read_b64_tr_b16 v[42:43], v250 offset:26624
    v_mfma_f32_16x16x32_bf16 v[16:19], v[64:67], v[72:75], v[16:19]
    ds_read_b64_tr_b16 v[44:45], v251 offset:24576
    v_mfma_f32_16x16x32_bf16 v[20:23], v[68:71], v[72:75], v[20:23]
    ds_read_b64_tr_b16 v[46:47], v251 offset:26624
    v_mfma_f32_16x16x32_bf16 v[24:27], v[56:59], v[76:79], v[24:27]
    ds_read_b64_tr_b16 v[48:49], v252 offset:24576
    v_mfma_f32_16x16x32_bf16 v[28:31], v[60:63], v[76:79], v[28:31]
    ds_read_b64_tr_b16 v[50:51], v252 offset:26624
    v_mfma_f32_16x16x32_bf16 v[32:35], v[64:67], v[76:79], v[32:35]
    ds_read_b64_tr_b16 v[52:53], v253 offset:24576
    v_mfma_f32_16x16x32_bf16 v[36:39], v[68:71], v[76:79], v[36:39]
    ds_read_b64_tr_b16 v[54:55], v253 offset:26624
    s_add_u32 s3, s88, 14
    s_and_b32 s3, s3, 15
    s_lshl_b32 s3, s3, 11
    s_add_u32 s3, s3, s72
    buffer_load_dwordx4 v[72:75], v5, s[12:15], s3 offen offset:0 sc1
    buffer_load_dwordx4 v[76:79], v4, s[12:15], s3 offen offset:0 sc1
    s_waitcnt vmcnt(12)
    s_waitcnt lgkmcnt(0)
    v_mfma_f32_16x16x32_bf16 v[8:11], v[40:43], v[80:83], v[8:11]
    ds_read_b64_tr_b16 v[56:57], v250 offset:28672
    v_mfma_f32_16x16x32_bf16 v[12:15], v[44:47], v[80:83], v[12:15]
    ds_read_b64_tr_b16 v[58:59], v250 offset:30720
    v_mfma_f32_16x16x32_bf16 v[16:19], v[48:51], v[80:83], v[16:19]
    ds_read_b64_tr_b16 v[60:61], v251 offset:28672
    v_mfma_f32_16x16x32_bf16 v[20:23], v[52:55], v[80:83], v[20:23]
    ds_read_b64_tr_b16 v[62:63], v251 offset:30720
    v_mfma_f32_16x16x32_bf16 v[24:27], v[40:43], v[84:87], v[24:27]
    ds_read_b64_tr_b16 v[64:65], v252 offset:28672
    v_mfma_f32_16x16x32_bf16 v[28:31], v[44:47], v[84:87], v[28:31]
    ds_read_b64_tr_b16 v[66:67], v252 offset:30720
    v_mfma_f32_16x16x32_bf16 v[32:35], v[48:51], v[84:87], v[32:35]
    ds_read_b64_tr_b16 v[68:69], v253 offset:28672
    v_mfma_f32_16x16x32_bf16 v[36:39], v[52:55], v[84:87], v[36:39]
    ds_read_b64_tr_b16 v[70:71], v253 offset:30720
    buffer_load_dwordx4 v[80:83], v5, s[12:15], s3 offen offset:1024 sc1
    buffer_load_dwordx4 v[84:87], v4, s[12:15], s3 offen offset:1024 sc1
    s_waitcnt vmcnt(12)
    s_waitcnt lgkmcnt(0)
    v_mfma_f32_16x16x32_bf16 v[8:11], v[56:59], v[88:91], v[8:11]
    ds_read_b64_tr_b16 v[40:41], v250 offset:32768
    v_mfma_f32_16x16x32_bf16 v[12:15], v[60:63], v[88:91], v[12:15]
    ds_read_b64_tr_b16 v[42:43], v250 offset:34816
    v_mfma_f32_16x16x32_bf16 v[16:19], v[64:67], v[88:91], v[16:19]
    ds_read_b64_tr_b16 v[44:45], v251 offset:32768
    v_mfma_f32_16x16x32_bf16 v[20:23], v[68:71], v[88:91], v[20:23]
    ds_read_b64_tr_b16 v[46:47], v251 offset:34816
    v_mfma_f32_16x16x32_bf16 v[24:27], v[56:59], v[92:95], v[24:27]
    ds_read_b64_tr_b16 v[48:49], v252 offset:32768
    v_mfma_f32_16x16x32_bf16 v[28:31], v[60:63], v[92:95], v[28:31]
    ds_read_b64_tr_b16 v[50:51], v252 offset:34816
    v_mfma_f32_16x16x32_bf16 v[32:35], v[64:67], v[92:95], v[32:35]
    ds_read_b64_tr_b16 v[52:53], v253 offset:32768
    v_mfma_f32_16x16x32_bf16 v[36:39], v[68:71], v[92:95], v[36:39]
    ds_read_b64_tr_b16 v[54:55], v253 offset:34816
    s_add_u32 s3, s88, 15
    s_and_b32 s3, s3, 15
    s_lshl_b32 s3, s3, 11
    s_add_u32 s3, s3, s72
    buffer_load_dwordx4 v[88:91], v5, s[12:15], s3 offen offset:0 sc1
    buffer_load_dwordx4 v[92:95], v4, s[12:15], s3 offen offset:0 sc1
    s_waitcnt vmcnt(12)
    s_waitcnt lgkmcnt(0)
    v_mfma_f32_16x16x32_bf16 v[8:11], v[40:43], v[96:99], v[8:11]
    ds_read_b64_tr_b16 v[56:57], v250 offset:36864
    v_mfma_f32_16x16x32_bf16 v[12:15], v[44:47], v[96:99], v[12:15]
    ds_read_b64_tr_b16 v[58:59], v250 offset:38912
    v_mfma_f32_16x16x32_bf16 v[16:19], v[48:51], v[96:99], v[16:19]
    ds_read_b64_tr_b16 v[60:61], v251 offset:36864
    v_mfma_f32_16x16x32_bf16 v[20:23], v[52:55], v[96:99], v[20:23]
    ds_read_b64_tr_b16 v[62:63], v251 offset:38912
    v_mfma_f32_16x16x32_bf16 v[24:27], v[40:43], v[100:103], v[24:27]
    ds_read_b64_tr_b16 v[64:65], v252 offset:36864
    v_mfma_f32_16x16x32_bf16 v[28:31], v[44:47], v[100:103], v[28:31]
    ds_read_b64_tr_b16 v[66:67], v252 offset:38912
    v_mfma_f32_16x16x32_bf16 v[32:35], v[48:51], v[100:103], v[32:35]
    ds_read_b64_tr_b16 v[68:69], v253 offset:36864
    v_mfma_f32_16x16x32_bf16 v[36:39], v[52:55], v[100:103], v[36:39]
    ds_read_b64_tr_b16 v[70:71], v253 offset:38912
    buffer_load_dwordx4 v[96:99], v5, s[12:15], s3 offen offset:1024 sc1
    buffer_load_dwordx4 v[100:103], v4, s[12:15], s3 offen offset:1024 sc1
    s_waitcnt vmcnt(12)
    s_waitcnt lgkmcnt(0)
    v_mfma_f32_16x16x32_bf16 v[8:11], v[56:59], v[104:107], v[8:11]
    ds_read_b64_tr_b16 v[40:41], v250 offset:40960
    v_mfma_f32_16x16x32_bf16 v[12:15], v[60:63], v[104:107], v[12:15]
    ds_read_b64_tr_b16 v[42:43], v250 offset:43008
    v_mfma_f32_16x16x32_bf16 v[16:19], v[64:67], v[104:107], v[16:19]
    ds_read_b64_tr_b16 v[44:45], v251 offset:40960
    v_mfma_f32_16x16x32_bf16 v[20:23], v[68:71], v[104:107], v[20:23]
    ds_read_b64_tr_b16 v[46:47], v251 offset:43008
    v_mfma_f32_16x16x32_bf16 v[24:27], v[56:59], v[108:111], v[24:27]
    ds_read_b64_tr_b16 v[48:49], v252 offset:40960
    v_mfma_f32_16x16x32_bf16 v[28:31], v[60:63], v[108:111], v[28:31]
    ds_read_b64_tr_b16 v[50:51], v252 offset:43008
    v_mfma_f32_16x16x32_bf16 v[32:35], v[64:67], v[108:111], v[32:35]
    ds_read_b64_tr_b16 v[52:53], v253 offset:40960
    v_mfma_f32_16x16x32_bf16 v[36:39], v[68:71], v[108:111], v[36:39]
    ds_read_b64_tr_b16 v[54:55], v253 offset:43008
    s_waitcnt vmcnt(10)
    s_waitcnt lgkmcnt(0)
    v_mfma_f32_16x16x32_bf16 v[8:11], v[40:43], v[112:115], v[8:11]
    ds_read_b64_tr_b16 v[56:57], v250 offset:45056
    v_mfma_f32_16x16x32_bf16 v[12:15], v[44:47], v[112:115], v[12:15]
    ds_read_b64_tr_b16 v[58:59], v250 offset:47104
    v_mfma_f32_16x16x32_bf16 v[16:19], v[48:51], v[112:115], v[16:19]
    ds_read_b64_tr_b16 v[60:61], v251 offset:45056
    v_mfma_f32_16x16x32_bf16 v[20:23], v[52:55], v[112:115], v[20:23]
    ds_read_b64_tr_b16 v[62:63], v251 offset:47104
    v_mfma_f32_16x16x32_bf16 v[24:27], v[40:43], v[116:119], v[24:27]
    ds_read_b64_tr_b16 v[64:65], v252 offset:45056
    v_mfma_f32_16x16x32_bf16 v[28:31], v[44:47], v[116:119], v[28:31]
    ds_read_b64_tr_b16 v[66:67], v252 offset:47104
    v_mfma_f32_16x16x32_bf16 v[32:35], v[48:51], v[116:119], v[32:35]
    ds_read_b64_tr_b16 v[68:69], v253 offset:45056
    v_mfma_f32_16x16x32_bf16 v[36:39], v[52:55], v[116:119], v[36:39]
    ds_read_b64_tr_b16 v[70:71], v253 offset:47104
    s_waitcnt vmcnt(8)
    s_waitcnt lgkmcnt(0)
    v_mfma_f32_16x16x32_bf16 v[8:11], v[56:59], v[120:123], v[8:11]
    ds_read_b64_tr_b16 v[40:41], v250 offset:49152
    v_mfma_f32_16x16x32_bf16 v[12:15], v[60:63], v[120:123], v[12:15]
    ds_read_b64_tr_b16 v[42:43], v250 offset:51200
    v_mfma_f32_16x16x32_bf16 v[16:19], v[64:67], v[120:123], v[16:19]
    ds_read_b64_tr_b16 v[44:45], v251 offset:49152
    v_mfma_f32_16x16x32_bf16 v[20:23], v[68:71], v[120:123], v[20:23]
    ds_read_b64_tr_b16 v[46:47], v251 offset:51200
    v_mfma_f32_16x16x32_bf16 v[24:27], v[56:59], v[124:127], v[24:27]
    ds_read_b64_tr_b16 v[48:49], v252 offset:49152
    v_mfma_f32_16x16x32_bf16 v[28:31], v[60:63], v[124:127], v[28:31]
    ds_read_b64_tr_b16 v[50:51], v252 offset:51200
    v_mfma_f32_16x16x32_bf16 v[32:35], v[64:67], v[124:127], v[32:35]
    ds_read_b64_tr_b16 v[52:53], v253 offset:49152
    v_mfma_f32_16x16x32_bf16 v[36:39], v[68:71], v[124:127], v[36:39]
    ds_read_b64_tr_b16 v[54:55], v253 offset:51200
    s_waitcnt vmcnt(6)
    s_waitcnt lgkmcnt(0)
    v_mfma_f32_16x16x32_bf16 v[8:11], v[40:43], v[72:75], v[8:11]
    ds_read_b64_tr_b16 v[56:57], v250 offset:53248
    v_mfma_f32_16x16x32_bf16 v[12:15], v[44:47], v[72:75], v[12:15]
    ds_read_b64_tr_b16 v[58:59], v250 offset:55296
    v_mfma_f32_16x16x32_bf16 v[16:19], v[48:51], v[72:75], v[16:19]
    ds_read_b64_tr_b16 v[60:61], v251 offset:53248
    v_mfma_f32_16x16x32_bf16 v[20:23], v[52:55], v[72:75], v[20:23]
    ds_read_b64_tr_b16 v[62:63], v251 offset:55296
    v_mfma_f32_16x16x32_bf16 v[24:27], v[40:43], v[76:79], v[24:27]
    ds_read_b64_tr_b16 v[64:65], v252 offset:53248
    v_mfma_f32_16x16x32_bf16 v[28:31], v[44:47], v[76:79], v[28:31]
    ds_read_b64_tr_b16 v[66:67], v252 offset:55296
    v_mfma_f32_16x16x32_bf16 v[32:35], v[48:51], v[76:79], v[32:35]
    ds_read_b64_tr_b16 v[68:69], v253 offset:53248
    v_mfma_f32_16x16x32_bf16 v[36:39], v[52:55], v[76:79], v[36:39]
    ds_read_b64_tr_b16 v[70:71], v253 offset:55296
    s_waitcnt vmcnt(4)
    s_waitcnt lgkmcnt(0)
    v_mfma_f32_16x16x32_bf16 v[8:11], v[56:59], v[80:83], v[8:11]
    ds_read_b64_tr_b16 v[40:41], v250 offset:57344
    v_mfma_f32_16x16x32_bf16 v[12:15], v[60:63], v[80:83], v[12:15]
    ds_read_b64_tr_b16 v[42:43], v250 offset:59392
    v_mfma_f32_16x16x32_bf16 v[16:19], v[64:67], v[80:83], v[16:19]
    ds_read_b64_tr_b16 v[44:45], v251 offset:57344
    v_mfma_f32_16x16x32_bf16 v[20:23], v[68:71], v[80:83], v[20:23]
    ds_read_b64_tr_b16 v[46:47], v251 offset:59392
    v_mfma_f32_16x16x32_bf16 v[24:27], v[56:59], v[84:87], v[24:27]
    ds_read_b64_tr_b16 v[48:49], v252 offset:57344
    v_mfma_f32_16x16x32_bf16 v[28:31], v[60:63], v[84:87], v[28:31]
    ds_read_b64_tr_b16 v[50:51], v252 offset:59392
    v_mfma_f32_16x16x32_bf16 v[32:35], v[64:67], v[84:87], v[32:35]
    ds_read_b64_tr_b16 v[52:53], v253 offset:57344
    v_mfma_f32_16x16x32_bf16 v[36:39], v[68:71], v[84:87], v[36:39]
    ds_read_b64_tr_b16 v[54:55], v253 offset:59392
    s_waitcnt vmcnt(2)
    s_waitcnt lgkmcnt(0)
    v_mfma_f32_16x16x32_bf16 v[8:11], v[40:43], v[88:91], v[8:11]
    ds_read_b64_tr_b16 v[56:57], v250 offset:61440
    v_mfma_f32_16x16x32_bf16 v[12:15], v[44:47], v[88:91], v[12:15]
    ds_read_b64_tr_b16 v[58:59], v250 offset:63488
    v_mfma_f32_16x16x32_bf16 v[16:19], v[48:51], v[88:91], v[16:19]
    ds_read_b64_tr_b16 v[60:61], v251 offset:61440
    v_mfma_f32_16x16x32_bf16 v[20:23], v[52:55], v[88:91], v[20:23]
    ds_read_b64_tr_b16 v[62:63], v251 offset:63488
    v_mfma_f32_16x16x32_bf16 v[24:27], v[40:43], v[92:95], v[24:27]
    ds_read_b64_tr_b16 v[64:65], v252 offset:61440
    v_mfma_f32_16x16x32_bf16 v[28:31], v[44:47], v[92:95], v[28:31]
    ds_read_b64_tr_b16 v[66:67], v252 offset:63488
    v_mfma_f32_16x16x32_bf16 v[32:35], v[48:51], v[92:95], v[32:35]
    ds_read_b64_tr_b16 v[68:69], v253 offset:61440
    v_mfma_f32_16x16x32_bf16 v[36:39], v[52:55], v[92:95], v[36:39]
    ds_read_b64_tr_b16 v[70:71], v253 offset:63488
    s_waitcnt vmcnt(0)
    s_waitcnt lgkmcnt(0)
    v_mfma_f32_16x16x32_bf16 v[8:11], v[56:59], v[96:99], v[8:11]
    v_mfma_f32_16x16x32_bf16 v[12:15], v[60:63], v[96:99], v[12:15]
    v_mfma_f32_16x16x32_bf16 v[16:19], v[64:67], v[96:99], v[16:19]
    v_mfma_f32_16x16x32_bf16 v[20:23], v[68:71], v[96:99], v[20:23]
    v_mfma_f32_16x16x32_bf16 v[24:27], v[56:59], v[100:103], v[24:27]
    v_mfma_f32_16x16x32_bf16 v[28:31], v[60:63], v[100:103], v[28:31]
    v_mfma_f32_16x16x32_bf16 v[32:35], v[64:67], v[100:103], v[32:35]
    v_mfma_f32_16x16x32_bf16 v[36:39], v[68:71], v[100:103], v[36:39]
    s_nop 0
    v_cvt_pk_bf16_f32 v72, v8, v9
    v_cvt_pk_bf16_f32 v73, v10, v11
    ds_write_b64 v240, v[72:73] offset:0
    v_cvt_pk_bf16_f32 v74, v12, v13
    v_cvt_pk_bf16_f32 v75, v14, v15
    ds_write_b64 v240, v[74:75] offset:32
    v_cvt_pk_bf16_f32 v76, v16, v17
    v_cvt_pk_bf16_f32 v77, v18, v19
    ds_write_b64 v240, v[76:77] offset:64
    v_cvt_pk_bf16_f32 v78, v20, v21
    v_cvt_pk_bf16_f32 v79, v22, v23
    ds_write_b64 v240, v[78:79] offset:96
    v_cvt_pk_bf16_f32 v80, v24, v25
    v_cvt_pk_bf16_f32 v81, v26, v27
    ds_write_b64 v240, v[80:81] offset:2304
    v_cvt_pk_bf16_f32 v82, v28, v29
    v_cvt_pk_bf16_f32 v83, v30, v31
    ds_write_b64 v240, v[82:83] offset:2336
    v_cvt_pk_bf16_f32 v84, v32, v33
    v_cvt_pk_bf16_f32 v85, v34, v35
    ds_write_b64 v240, v[84:85] offset:2368
    v_cvt_pk_bf16_f32 v86, v36, v37
    v_cvt_pk_bf16_f32 v87, v38, v39
    ds_write_b64 v240, v[86:87] offset:2400
    s_waitcnt lgkmcnt(0)
    s_barrier
    s_endpgm
.p2align 8
L_code_end:
.fill 3072, 4, 0xbf800000
.section .rodata,"a"
.p2align 6
.amdhsa_kernel recurrent_scan__linear_kernel_hedgehog__moe_arch_mod__prompt_kernel
  .amdhsa_next_free_vgpr 256
  .amdhsa_next_free_sgpr 102
  .amdhsa_accum_offset 256
  .amdhsa_group_segment_fixed_size 0
  .amdhsa_kernarg_size 96
  .amdhsa_user_sgpr_count 2
  .amdhsa_user_sgpr_kernarg_segment_ptr 1
  .amdhsa_system_sgpr_workgroup_id_x 1
.end_amdhsa_kernel
```

```asm
; @launch grid=(256,1,1) block=(512,1,1) lds=163840
.amdgcn_target "amdgcn-amd-amdhsa--gfx950"
.text
.globl recurrent_scan__linear_kernel_hedgehog__moe_arch_mod__prompt_kernel
.p2align 8
.type recurrent_scan__linear_kernel_hedgehog__moe_arch_mod__prompt_kernel,@function
recurrent_scan__linear_kernel_hedgehog__moe_arch_mod__prompt_kernel:
    s_cmp_ge_u32 s2, 256
    s_cbranch_scc1 L_done
    s_load_dwordx16 s[40:55], s[0:1], 0
    s_load_dwordx8 s[56:63], s[0:1], 64
    v_and_b32 v1, 63, v0
    v_lshrrev_b32 v2, 6, v0
    s_nop 0
    v_readfirstlane_b32 s38, v2
    s_and_b32 s65, s2, 1
    s_bfe_u32 s66, s2, 0x30003
    s_bfe_u32 s67, s2, 0x20001
    s_lshl_b32 s67, s67, 2
    s_lshl_b32 s36, s65, 3
    s_add_u32 s36, s36, s66
    s_lshr_b32 s3, s2, 6
    s_add_u32 s37, s67, s3
    s_lshr_b32 s39, s66, 0
    s_lshl_b32 s39, s39, 1
    s_add_u32 s39, s39, s65
    s_lshl_b32 s39, s39, 0
    s_and_b32 s101, s66, 0
    s_add_u32 s39, s39, s67
    s_and_b32 s39, s39, 15
    s_and_b32 s67, s2, 7
    s_lshl_b32 s67, s67, 1
    s_bfe_u32 s3, s2, 0x10003
    s_add_u32 s37, s67, s3
    s_lshr_b32 s36, s2, 4
    s_and_b32 s101, s36, 0
    s_sub_u32 s39, s36, s101
    s_add_u32 s39, s39, s67
    s_and_b32 s39, s39, 15
    s_cmp_lt_u32 s38, 4
    s_cbranch_scc1 L_g1
    s_sub_u32 s38, s38, 4
    s_lshl_b32 s3, s38, 4
    v_lshrrev_b32 v7, 3, v1
    v_add_u32 v3, s3, v7
    v_mul_u32_u24 v3, 6144, v3
    s_lshl_b32 s3, s37, 7
    v_add_u32 v3, s3, v3
    v_and_b32 v6, 7, v1
    v_bfe_u32 v5, v1, 4, 1
    v_lshlrev_b32 v5, 1, v5
    v_xor_b32 v5, v6, v5
    v_lshl_add_u32 v16, v5, 4, v3
    v_xor_b32 v5, 4, v5
    v_lshl_add_u32 v5, v5, 4, v3
    v_add_u32 v17, 48128, v5
    v_add_u32 v12, 2048, v16
    v_add_u32 v13, 2048, v17
    v_add_u32 v14, 4096, v16
    v_add_u32 v15, 4096, v17
    s_lshl_b32 s3, s36, 7
    s_lshl_b32 s65, s38, 5
    s_add_u32 s3, s3, s65
    v_add_u32 v3, s3, v7
    v_lshlrev_b32 v3, 11, v3
    v_lshrrev_b32 v5, 4, v1
    v_xor_b32 v6, v6, v5
    v_xor_b32 v5, 4, v6
    v_lshl_add_u32 v8, v6, 4, v3
    v_lshl_add_u32 v5, v5, 4, v3
    v_add_u32 v9, 15360, v5
    v_add_u32 v10, 30720, v8
    v_add_u32 v11, 46080, v5
    s_lshl_b32 s72, s38, 12
    s_lshl_b32 s73, s38, 11
    s_lshl_b32 s74, s39, 7
    s_mul_i32 s75, s39, 393216
    s_mov_b32 s76, s75
    s_waitcnt lgkmcnt(0)
    s_mov_b32 s8, s42
    s_mov_b32 s9, s43
    s_mov_b32 s10, 6291456
    s_mov_b32 s11, 0x00020000
    s_mov_b32 s4, s40
    s_mov_b32 s5, s41
    s_mov_b32 s6, 4194304
    s_mov_b32 s7, 0x00020000
    s_cmp_ge_u32 s38, 2
    s_cbranch_scc1 L_xw
    s_add_u32 s3, s75, 196608
    s_add_u32 m0, s73, 65536
    s_nop 0
    buffer_load_dwordx4 v12, s[8:11], s75 offen offset:0  lds
    buffer_load_dwordx4 v13, s[8:11], s75 offen offset:1024  lds
    s_add_u32 m0, s73, 73728
    s_nop 0
    buffer_load_dwordx4 v14, s[8:11], s75 offen offset:0  lds
    buffer_load_dwordx4 v15, s[8:11], s75 offen offset:1024  lds
    s_add_u32 m0, s73, 69632
    s_nop 0
    buffer_load_dwordx4 v12, s[8:11], s3 offen offset:0  lds
    buffer_load_dwordx4 v13, s[8:11], s3 offen offset:1024  lds
    s_add_u32 m0, s73, 77824
    s_nop 0
    buffer_load_dwordx4 v14, s[8:11], s3 offen offset:0  lds
    buffer_load_dwordx4 v15, s[8:11], s3 offen offset:1024  lds
    s_add_u32 s75, s75, 393216
    s_cmp_eq_u32 s75, 6291456
    s_cselect_b32 s75, 0, s75
    s_add_u32 m0, s73, 131072
    s_nop 0
    buffer_load_dwordx4 v16, s[8:11], s76 offen offset:0  lds
    buffer_load_dwordx4 v17, s[8:11], s76 offen offset:1024  lds
    s_add_u32 m0, s73, 135168
    s_add_u32 s3, s76, 196608
    buffer_load_dwordx4 v16, s[8:11], s3 offen offset:0  lds
    buffer_load_dwordx4 v17, s[8:11], s3 offen offset:1024  lds
    s_add_u32 s76, s76, 393216
    s_cmp_eq_u32 s76, 6291456
    s_cselect_b32 s76, 0, s76
    s_add_u32 m0, s72, 0
    s_nop 0
    buffer_load_dwordx4 v8, s[4:7], s74 offen offset:0  lds
    buffer_load_dwordx4 v9, s[4:7], s74 offen offset:1024  lds
    buffer_load_dwordx4 v10, s[4:7], s74 offen offset:2048  lds
    buffer_load_dwordx4 v11, s[4:7], s74 offen offset:3072  lds
    s_add_u32 m0, s72, 8192
    s_add_u32 s3, s74, 131072
    buffer_load_dwordx4 v8, s[4:7], s3 offen offset:0  lds
    buffer_load_dwordx4 v9, s[4:7], s3 offen offset:1024  lds
    buffer_load_dwordx4 v10, s[4:7], s3 offen offset:2048  lds
    buffer_load_dwordx4 v11, s[4:7], s3 offen offset:3072  lds
    s_add_u32 s74, s74, 128
    s_and_b32 s74, s74, 2047
    v_lshlrev_b32 v3, 4, v1
    s_mov_b32 s12, s62
    s_mov_b32 s13, s63
    s_mov_b32 s14, 268435456
    s_mov_b32 s15, 0x00020000
    s_mov_b32 s24, s58
    s_mov_b32 s25, s59
    s_mov_b32 s26, 4194304
    s_mov_b32 s27, 0x00020000
    s_mov_b32 s16, s60
    s_mov_b32 s17, s61
    s_mov_b32 s18, 256
    s_mov_b32 s19, 0x00020000
    s_mov_b32 s20, s44
    s_mov_b32 s21, s45
    s_mov_b32 s22, 65536
    s_mov_b32 s23, 0x00020000
    s_and_b32 s30, s2, 3
    s_lshl_b32 s30, s30, 2
    s_bfe_u32 s3, s2, 0x20003
    s_add_u32 s30, s30, s3
    s_bfe_u32 s31, s2, 0x10002
    s_lshl_b32 s31, s31, 3
    s_lshr_b32 s3, s2, 5
    s_add_u32 s31, s31, s3
    s_mov_b32 s70, 0
    s_mov_b32 s80, s52
    s_mov_b32 s81, s53
    s_mov_b32 s82, 7340032
    s_mov_b32 s83, 0x00020000
    s_mov_b32 s84, s54
    s_mov_b32 s85, s55
    s_mov_b32 s86, 7340032
    s_mov_b32 s87, 0x00020000
    s_cmp_lt_u32 s2, 224
    s_cselect_b32 s82, s82, 0
    s_cselect_b32 s86, s86, 0
    s_and_b32 s3, s2, 15
    s_lshl_b32 s3, s3, 6
    v_and_b32 v5, 0x38, v1
    v_add_u32 v5, s3, v5
    v_mul_u32_u24 v5, 7168, v5
    v_and_b32 v6, 7, v1
    v_lshl_add_u32 v2, v6, 4, v5
    s_lshr_b32 s77, s2, 4
    s_lshl_b32 s77, s77, 2
    s_add_u32 s77, s77, s38
    s_lshl_b32 s77, s77, 7
    v_and_b32 v5, 1, v1
    v_cmp_eq_u32 vcc, 0, v5
    v_mov_b32 v6, 0xffff0000
    v_mov_b32 v7, 0xffff
    v_cndmask_b32 v6, v6, v7, vcc
    v_bfe_u32 v5, v1, 1, 2
    v_cmp_eq_u32 vcc, 0, v5
    s_nop 1
    v_cndmask_b32 v88, 0, v6, vcc
    v_cmp_eq_u32 vcc, 1, v5
    s_nop 1
    v_cndmask_b32 v89, 0, v6, vcc
    v_cmp_eq_u32 vcc, 2, v5
    s_nop 1
    v_cndmask_b32 v90, 0, v6, vcc
    v_cmp_eq_u32 vcc, 3, v5
    s_nop 1
    v_cndmask_b32 v91, 0, v6, vcc
    v_and_b32 v20, 0x3f803f80, v88
    v_and_b32 v21, 0x3f803f80, v89
    v_and_b32 v22, 0x3f803f80, v90
    v_and_b32 v23, 0x3f803f80, v91
    s_lshl_b32 s3, s30, 7
    s_lshl_b32 s65, s38, 5
    s_add_u32 s3, s3, s65
    v_lshrrev_b32 v249, 3, v1
    v_add_u32 v6, s3, v249
    v_lshlrev_b32 v6, 11, v6
    v_and_b32 v250, 7, v1
    v_lshl_add_u32 v6, v250, 4, v6
    s_lshl_b32 s3, s31, 7
    v_add_u32 v248, s3, v6
    s_mov_b32 s48, 16384
    s_mov_b32 s49, 32768
    s_mov_b32 s100, 49152
    s_lshl_b32 s3, s38, 2
    s_add_u32 s3, s3, 163136
    v_mov_b32 v27, s3
    v_mov_b32 v26, 163104
    s_add_u32 m0, s72, 16384
    s_nop 0
    buffer_load_dwordx4 v8, s[4:7], s74 offen offset:0  lds
    buffer_load_dwordx4 v9, s[4:7], s74 offen offset:1024  lds
    buffer_load_dwordx4 v10, s[4:7], s74 offen offset:2048  lds
    buffer_load_dwordx4 v11, s[4:7], s74 offen offset:3072  lds
    s_add_u32 m0, s72, 24576
    s_add_u32 s3, s74, 131072
    buffer_load_dwordx4 v8, s[4:7], s3 offen offset:0  lds
    buffer_load_dwordx4 v9, s[4:7], s3 offen offset:1024  lds
    buffer_load_dwordx4 v10, s[4:7], s3 offen offset:2048  lds
    buffer_load_dwordx4 v11, s[4:7], s3 offen offset:3072  lds
    s_add_u32 s74, s74, 128
    s_and_b32 s74, s74, 2047
    s_add_u32 s3, s75, 196608
    s_add_u32 m0, s73, 81920
    s_nop 0
    buffer_load_dwordx4 v12, s[8:11], s75 offen offset:0  lds
    buffer_load_dwordx4 v13, s[8:11], s75 offen offset:1024  lds
    s_add_u32 m0, s73, 90112
    s_nop 0
    buffer_load_dwordx4 v14, s[8:11], s75 offen offset:0  lds
    buffer_load_dwordx4 v15, s[8:11], s75 offen offset:1024  lds
    s_add_u32 m0, s73, 86016
    s_nop 0
    buffer_load_dwordx4 v12, s[8:11], s3 offen offset:0  lds
    buffer_load_dwordx4 v13, s[8:11], s3 offen offset:1024  lds
    s_add_u32 m0, s73, 94208
    s_nop 0
    buffer_load_dwordx4 v14, s[8:11], s3 offen offset:0  lds
    buffer_load_dwordx4 v15, s[8:11], s3 offen offset:1024  lds
    s_add_u32 s75, s75, 393216
    s_cmp_eq_u32 s75, 6291456
    s_cselect_b32 s75, 0, s75
    s_add_u32 m0, s73, 139264
    s_nop 0
    buffer_load_dwordx4 v16, s[8:11], s76 offen offset:0  lds
    buffer_load_dwordx4 v17, s[8:11], s76 offen offset:1024  lds
    s_add_u32 m0, s73, 143360
    s_add_u32 s3, s76, 196608
    buffer_load_dwordx4 v16, s[8:11], s3 offen offset:0  lds
    buffer_load_dwordx4 v17, s[8:11], s3 offen offset:1024  lds
    s_add_u32 s76, s76, 393216
    s_cmp_eq_u32 s76, 6291456
    s_cselect_b32 s76, 0, s76
    s_waitcnt vmcnt(20)
    s_barrier
    s_add_u32 m0, s72, 32768
    s_nop 0
    buffer_load_dwordx4 v8, s[4:7], s74 offen offset:0  lds
    buffer_load_dwordx4 v9, s[4:7], s74 offen offset:1024  lds
    buffer_load_dwordx4 v10, s[4:7], s74 offen offset:2048  lds
    buffer_load_dwordx4 v11, s[4:7], s74 offen offset:3072  lds
    s_add_u32 m0, s72, 40960
    s_add_u32 s3, s74, 131072
    buffer_load_dwordx4 v8, s[4:7], s3 offen offset:0  lds
    buffer_load_dwordx4 v9, s[4:7], s3 offen offset:1024  lds
    buffer_load_dwordx4 v10, s[4:7], s3 offen offset:2048  lds
    buffer_load_dwordx4 v11, s[4:7], s3 offen offset:3072  lds
    s_add_u32 s74, s74, 128
    s_and_b32 s74, s74, 2047
    s_add_u32 s3, s75, 196608
    s_add_u32 m0, s73, 98304
    s_nop 0
    buffer_load_dwordx4 v12, s[8:11], s75 offen offset:0  lds
    buffer_load_dwordx4 v13, s[8:11], s75 offen offset:1024  lds
    s_add_u32 m0, s73, 106496
    s_nop 0
    buffer_load_dwordx4 v14, s[8:11], s75 offen offset:0  lds
    buffer_load_dwordx4 v15, s[8:11], s75 offen offset:1024  lds
    s_add_u32 m0, s73, 102400
    s_nop 0
    buffer_load_dwordx4 v12, s[8:11], s3 offen offset:0  lds
    buffer_load_dwordx4 v13, s[8:11], s3 offen offset:1024  lds
    s_add_u32 m0, s73, 110592
    s_nop 0
    buffer_load_dwordx4 v14, s[8:11], s3 offen offset:0  lds
    buffer_load_dwordx4 v15, s[8:11], s3 offen offset:1024  lds
    s_add_u32 s75, s75, 393216
    s_cmp_eq_u32 s75, 6291456
    s_cselect_b32 s75, 0, s75
    s_add_u32 m0, s73, 147456
    s_nop 0
    buffer_load_dwordx4 v16, s[8:11], s76 offen offset:0  lds
    buffer_load_dwordx4 v17, s[8:11], s76 offen offset:1024  lds
    s_add_u32 m0, s73, 151552
    s_add_u32 s3, s76, 196608
    buffer_load_dwordx4 v16, s[8:11], s3 offen offset:0  lds
    buffer_load_dwordx4 v17, s[8:11], s3 offen offset:1024  lds
    s_add_u32 s76, s76, 393216
    s_cmp_eq_u32 s76, 6291456
    s_cselect_b32 s76, 0, s76
    s_add_u32 m0, s72, 49152
    s_nop 0
    buffer_load_dwordx4 v8, s[4:7], s74 offen offset:0  lds
    buffer_load_dwordx4 v9, s[4:7], s74 offen offset:1024  lds
    buffer_load_dwordx4 v10, s[4:7], s74 offen offset:2048  lds
    buffer_load_dwordx4 v11, s[4:7], s74 offen offset:3072  lds
    s_add_u32 m0, s72, 57344
    s_add_u32 s3, s74, 131072
    buffer_load_dwordx4 v8, s[4:7], s3 offen offset:0  lds
    buffer_load_dwordx4 v9, s[4:7], s3 offen offset:1024  lds
    buffer_load_dwordx4 v10, s[4:7], s3 offen offset:2048  lds
    buffer_load_dwordx4 v11, s[4:7], s3 offen offset:3072  lds
    s_add_u32 s74, s74, 128
    s_and_b32 s74, s74, 2047
    s_waitcnt vmcnt(28)
    s_barrier
    s_add_u32 s3, s75, 196608
    s_add_u32 m0, s73, 114688
    s_nop 0
    buffer_load_dwordx4 v12, s[8:11], s75 offen offset:0  lds
    buffer_load_dwordx4 v13, s[8:11], s75 offen offset:1024  lds
    s_add_u32 m0, s73, 122880
    s_nop 0
    buffer_load_dwordx4 v14, s[8:11], s75 offen offset:0  lds
    buffer_load_dwordx4 v15, s[8:11], s75 offen offset:1024  lds
    s_add_u32 m0, s73, 118784
    s_nop 0
    buffer_load_dwordx4 v12, s[8:11], s3 offen offset:0  lds
    buffer_load_dwordx4 v13, s[8:11], s3 offen offset:1024  lds
    s_add_u32 m0, s73, 126976
    s_nop 0
    buffer_load_dwordx4 v14, s[8:11], s3 offen offset:0  lds
    buffer_load_dwordx4 v15, s[8:11], s3 offen offset:1024  lds
    s_add_u32 s75, s75, 393216
    s_cmp_eq_u32 s75, 6291456
    s_cselect_b32 s75, 0, s75
    s_add_u32 m0, s73, 131072
    s_nop 0
    buffer_load_dwordx4 v16, s[8:11], s76 offen offset:0  lds
    buffer_load_dwordx4 v17, s[8:11], s76 offen offset:1024  lds
    s_add_u32 m0, s73, 135168
    s_add_u32 s3, s76, 196608
    buffer_load_dwordx4 v16, s[8:11], s3 offen offset:0  lds
    buffer_load_dwordx4 v17, s[8:11], s3 offen offset:1024  lds
    s_add_u32 s76, s76, 393216
    s_cmp_eq_u32 s76, 6291456
    s_cselect_b32 s76, 0, s76
    s_add_u32 m0, s72, 0
    s_nop 0
    buffer_load_dwordx4 v8, s[4:7], s74 offen offset:0  lds
    buffer_load_dwordx4 v9, s[4:7], s74 offen offset:1024  lds
    buffer_load_dwordx4 v10, s[4:7], s74 offen offset:2048  lds
    buffer_load_dwordx4 v11, s[4:7], s74 offen offset:3072  lds
    s_add_u32 m0, s72, 8192
    s_add_u32 s3, s74, 131072
    buffer_load_dwordx4 v8, s[4:7], s3 offen offset:0  lds
    buffer_load_dwordx4 v9, s[4:7], s3 offen offset:1024  lds
    buffer_load_dwordx4 v10, s[4:7], s3 offen offset:2048  lds
    buffer_load_dwordx4 v11, s[4:7], s3 offen offset:3072  lds
    s_add_u32 s74, s74, 128
    s_and_b32 s74, s74, 2047
    s_add_u32 s3, s75, 196608
    s_add_u32 m0, s73, 65536
    s_nop 0
    buffer_load_dwordx4 v12, s[8:11], s75 offen offset:0  lds
    buffer_load_dwordx4 v13, s[8:11], s75 offen offset:1024  lds
    s_add_u32 m0, s73, 73728
    s_nop 0
    buffer_load_dwordx4 v14, s[8:11], s75 offen offset:0  lds
    buffer_load_dwordx4 v15, s[8:11], s75 offen offset:1024  lds
    s_add_u32 m0, s73, 69632
    s_nop 0
    buffer_load_dwordx4 v12, s[8:11], s3 offen offset:0  lds
    buffer_load_dwordx4 v13, s[8:11], s3 offen offset:1024  lds
    s_add_u32 m0, s73, 77824
    s_nop 0
    buffer_load_dwordx4 v14, s[8:11], s3 offen offset:0  lds
    buffer_load_dwordx4 v15, s[8:11], s3 offen offset:1024  lds
    s_add_u32 s75, s75, 393216
    s_cmp_eq_u32 s75, 6291456
    s_cselect_b32 s75, 0, s75
    s_waitcnt vmcnt(36)
    s_barrier
    s_add_u32 m0, s73, 139264
    s_nop 0
    buffer_load_dwordx4 v16, s[8:11], s76 offen offset:0  lds
    buffer_load_dwordx4 v17, s[8:11], s76 offen offset:1024  lds
    s_add_u32 m0, s73, 143360
    s_add_u32 s3, s76, 196608
    buffer_load_dwordx4 v16, s[8:11], s3 offen offset:0  lds
    buffer_load_dwordx4 v17, s[8:11], s3 offen offset:1024  lds
    s_add_u32 s76, s76, 393216
    s_cmp_eq_u32 s76, 6291456
    s_cselect_b32 s76, 0, s76
    s_add_u32 m0, s72, 16384
    s_nop 0
    buffer_load_dwordx4 v8, s[4:7], s74 offen offset:0  lds
    buffer_load_dwordx4 v9, s[4:7], s74 offen offset:1024  lds
    buffer_load_dwordx4 v10, s[4:7], s74 offen offset:2048  lds
    buffer_load_dwordx4 v11, s[4:7], s74 offen offset:3072  lds
    s_add_u32 m0, s72, 24576
    s_add_u32 s3, s74, 131072
    buffer_load_dwordx4 v8, s[4:7], s3 offen offset:0  lds
    buffer_load_dwordx4 v9, s[4:7], s3 offen offset:1024  lds
    buffer_load_dwordx4 v10, s[4:7], s3 offen offset:2048  lds
    buffer_load_dwordx4 v11, s[4:7], s3 offen offset:3072  lds
    s_add_u32 s74, s74, 128
    s_and_b32 s74, s74, 2047
    s_add_u32 s3, s75, 196608
    s_add_u32 m0, s73, 81920
    s_nop 0
    buffer_load_dwordx4 v12, s[8:11], s75 offen offset:0  lds
    buffer_load_dwordx4 v13, s[8:11], s75 offen offset:1024  lds
    s_add_u32 m0, s73, 90112
    s_nop 0
    buffer_load_dwordx4 v14, s[8:11], s75 offen offset:0  lds
    buffer_load_dwordx4 v15, s[8:11], s75 offen offset:1024  lds
    s_add_u32 m0, s73, 86016
    s_nop 0
    buffer_load_dwordx4 v12, s[8:11], s3 offen offset:0  lds
    buffer_load_dwordx4 v13, s[8:11], s3 offen offset:1024  lds
    s_add_u32 m0, s73, 94208
    s_nop 0
    buffer_load_dwordx4 v14, s[8:11], s3 offen offset:0  lds
    buffer_load_dwordx4 v15, s[8:11], s3 offen offset:1024  lds
    s_add_u32 s75, s75, 393216
    s_cmp_eq_u32 s75, 6291456
    s_cselect_b32 s75, 0, s75
    s_waitcnt vmcnt(36)
    s_barrier
    s_add_u32 m0, s73, 147456
    s_nop 0
    buffer_load_dwordx4 v16, s[8:11], s76 offen offset:0  lds
    buffer_load_dwordx4 v17, s[8:11], s76 offen offset:1024  lds
    s_add_u32 m0, s73, 151552
    s_add_u32 s3, s76, 196608
    buffer_load_dwordx4 v16, s[8:11], s3 offen offset:0  lds
    buffer_load_dwordx4 v17, s[8:11], s3 offen offset:1024  lds
    s_add_u32 s76, s76, 393216
    s_cmp_eq_u32 s76, 6291456
    s_cselect_b32 s76, 0, s76
    s_add_u32 m0, s72, 32768
    s_nop 0
    buffer_load_dwordx4 v8, s[4:7], s74 offen offset:0  lds
    buffer_load_dwordx4 v9, s[4:7], s74 offen offset:1024  lds
    buffer_load_dwordx4 v10, s[4:7], s74 offen offset:2048  lds
    buffer_load_dwordx4 v11, s[4:7], s74 offen offset:3072  lds
    s_add_u32 m0, s72, 40960
    s_add_u32 s3, s74, 131072
    buffer_load_dwordx4 v8, s[4:7], s3 offen offset:0  lds
    buffer_load_dwordx4 v9, s[4:7], s3 offen offset:1024  lds
    buffer_load_dwordx4 v10, s[4:7], s3 offen offset:2048  lds
    buffer_load_dwordx4 v11, s[4:7], s3 offen offset:3072  lds
    s_add_u32 s74, s74, 128
    s_and_b32 s74, s74, 2047
    s_add_u32 s3, s75, 196608
    s_add_u32 m0, s73, 98304
    s_nop 0
    buffer_load_dwordx4 v12, s[8:11], s75 offen offset:0  lds
    buffer_load_dwordx4 v13, s[8:11], s75 offen offset:1024  lds
    s_add_u32 m0, s73, 106496
    s_nop 0
    buffer_load_dwordx4 v14, s[8:11], s75 offen offset:0  lds
    buffer_load_dwordx4 v15, s[8:11], s75 offen offset:1024  lds
    s_add_u32 m0, s73, 102400
    s_nop 0
    buffer_load_dwordx4 v12, s[8:11], s3 offen offset:0  lds
    buffer_load_dwordx4 v13, s[8:11], s3 offen offset:1024  lds
    s_add_u32 m0, s73, 110592
    s_nop 0
    buffer_load_dwordx4 v14, s[8:11], s3 offen offset:0  lds
    buffer_load_dwordx4 v15, s[8:11], s3 offen offset:1024  lds
    s_add_u32 s75, s75, 393216
    s_cmp_eq_u32 s75, 6291456
    s_cselect_b32 s75, 0, s75
    s_waitcnt vmcnt(36)
    s_barrier
    s_add_u32 m0, s73, 131072
    s_nop 0
    buffer_load_dwordx4 v16, s[8:11], s76 offen offset:0  lds
    buffer_load_dwordx4 v17, s[8:11], s76 offen offset:1024  lds
    s_add_u32 m0, s73, 135168
    s_add_u32 s3, s76, 196608
    buffer_load_dwordx4 v16, s[8:11], s3 offen offset:0  lds
    buffer_load_dwordx4 v17, s[8:11], s3 offen offset:1024  lds
    s_add_u32 s76, s76, 393216
    s_cmp_eq_u32 s76, 6291456
    s_cselect_b32 s76, 0, s76
    s_add_u32 m0, s72, 49152
    s_nop 0
    buffer_load_dwordx4 v8, s[4:7], s74 offen offset:0  lds
    buffer_load_dwordx4 v9, s[4:7], s74 offen offset:1024  lds
    buffer_load_dwordx4 v10, s[4:7], s74 offen offset:2048  lds
    buffer_load_dwordx4 v11, s[4:7], s74 offen offset:3072  lds
    s_add_u32 m0, s72, 57344
    s_add_u32 s3, s74, 131072
    buffer_load_dwordx4 v8, s[4:7], s3 offen offset:0  lds
    buffer_load_dwordx4 v9, s[4:7], s3 offen offset:1024  lds
    buffer_load_dwordx4 v10, s[4:7], s3 offen offset:2048  lds
    buffer_load_dwordx4 v11, s[4:7], s3 offen offset:3072  lds
    s_add_u32 s74, s74, 128
    s_and_b32 s74, s74, 2047
    s_add_u32 s3, s75, 196608
    s_add_u32 m0, s73, 114688
    s_nop 0
    buffer_load_dwordx4 v12, s[8:11], s75 offen offset:0  lds
    buffer_load_dwordx4 v13, s[8:11], s75 offen offset:1024  lds
    s_add_u32 m0, s73, 122880
    s_nop 0
    buffer_load_dwordx4 v14, s[8:11], s75 offen offset:0  lds
    buffer_load_dwordx4 v15, s[8:11], s75 offen offset:1024  lds
    s_add_u32 m0, s73, 118784
    s_nop 0
    buffer_load_dwordx4 v12, s[8:11], s3 offen offset:0  lds
    buffer_load_dwordx4 v13, s[8:11], s3 offen offset:1024  lds
    s_add_u32 m0, s73, 126976
    s_nop 0
    buffer_load_dwordx4 v14, s[8:11], s3 offen offset:0  lds
    buffer_load_dwordx4 v15, s[8:11], s3 offen offset:1024  lds
    s_add_u32 s75, s75, 393216
    s_cmp_eq_u32 s75, 6291456
    s_cselect_b32 s75, 0, s75
    s_waitcnt vmcnt(36)
    s_barrier
    s_add_u32 m0, s73, 139264
    s_nop 0
    buffer_load_dwordx4 v16, s[8:11], s76 offen offset:0  lds
    buffer_load_dwordx4 v17, s[8:11], s76 offen offset:1024  lds
    s_add_u32 m0, s73, 143360
    s_add_u32 s3, s76, 196608
    buffer_load_dwordx4 v16, s[8:11], s3 offen offset:0  lds
    buffer_load_dwordx4 v17, s[8:11], s3 offen offset:1024  lds
    s_add_u32 s76, s76, 393216
    s_cmp_eq_u32 s76, 6291456
    s_cselect_b32 s76, 0, s76
    s_add_u32 m0, s72, 0
    s_nop 0
    buffer_load_dwordx4 v8, s[4:7], s74 offen offset:0  lds
    buffer_load_dwordx4 v9, s[4:7], s74 offen offset:1024  lds
    buffer_load_dwordx4 v10, s[4:7], s74 offen offset:2048  lds
    buffer_load_dwordx4 v11, s[4:7], s74 offen offset:3072  lds
    s_add_u32 m0, s72, 8192
    s_add_u32 s3, s74, 131072
    buffer_load_dwordx4 v8, s[4:7], s3 offen offset:0  lds
    buffer_load_dwordx4 v9, s[4:7], s3 offen offset:1024  lds
    buffer_load_dwordx4 v10, s[4:7], s3 offen offset:2048  lds
    buffer_load_dwordx4 v11, s[4:7], s3 offen offset:3072  lds
    s_add_u32 s74, s74, 128
    s_and_b32 s74, s74, 2047
    s_add_u32 s3, s75, 196608
    s_add_u32 m0, s73, 65536
    s_nop 0
    buffer_load_dwordx4 v12, s[8:11], s75 offen offset:0  lds
    buffer_load_dwordx4 v13, s[8:11], s75 offen offset:1024  lds
    s_add_u32 m0, s73, 73728
    s_nop 0
    buffer_load_dwordx4 v14, s[8:11], s75 offen offset:0  lds
    buffer_load_dwordx4 v15, s[8:11], s75 offen offset:1024  lds
    s_add_u32 m0, s73, 69632
    s_nop 0
    buffer_load_dwordx4 v12, s[8:11], s3 offen offset:0  lds
    buffer_load_dwordx4 v13, s[8:11], s3 offen offset:1024  lds
    s_add_u32 m0, s73, 77824
    s_nop 0
    buffer_load_dwordx4 v14, s[8:11], s3 offen offset:0  lds
    buffer_load_dwordx4 v15, s[8:11], s3 offen offset:1024  lds
    s_add_u32 s75, s75, 393216
    s_cmp_eq_u32 s75, 6291456
    s_cselect_b32 s75, 0, s75
    s_waitcnt vmcnt(36)
    s_barrier
    s_add_u32 m0, s73, 147456
    s_nop 0
    buffer_load_dwordx4 v16, s[8:11], s76 offen offset:0  lds
    buffer_load_dwordx4 v17, s[8:11], s76 offen offset:1024  lds
    s_add_u32 m0, s73, 151552
    s_add_u32 s3, s76, 196608
    buffer_load_dwordx4 v16, s[8:11], s3 offen offset:0  lds
    buffer_load_dwordx4 v17, s[8:11], s3 offen offset:1024  lds
    s_add_u32 s76, s76, 393216
    s_cmp_eq_u32 s76, 6291456
    s_cselect_b32 s76, 0, s76
    s_add_u32 m0, s72, 16384
    s_nop 0
    buffer_load_dwordx4 v8, s[4:7], s74 offen offset:0  lds
    buffer_load_dwordx4 v9, s[4:7], s74 offen offset:1024  lds
    buffer_load_dwordx4 v10, s[4:7], s74 offen offset:2048  lds
    buffer_load_dwordx4 v11, s[4:7], s74 offen offset:3072  lds
    s_add_u32 m0, s72, 24576
    s_add_u32 s3, s74, 131072
    buffer_load_dwordx4 v8, s[4:7], s3 offen offset:0  lds
    buffer_load_dwordx4 v9, s[4:7], s3 offen offset:1024  lds
    buffer_load_dwordx4 v10, s[4:7], s3 offen offset:2048  lds
    buffer_load_dwordx4 v11, s[4:7], s3 offen offset:3072  lds
    s_add_u32 s74, s74, 128
    s_and_b32 s74, s74, 2047
    s_add_u32 s3, s75, 196608
    s_add_u32 m0, s73, 81920
    s_nop 0
    buffer_load_dwordx4 v12, s[8:11], s75 offen offset:0  lds
    buffer_load_dwordx4 v13, s[8:11], s75 offen offset:1024  lds
    s_add_u32 m0, s73, 90112
    s_nop 0
    buffer_load_dwordx4 v14, s[8:11], s75 offen offset:0  lds
    buffer_load_dwordx4 v15, s[8:11], s75 offen offset:1024  lds
    s_add_u32 m0, s73, 86016
    s_nop 0
    buffer_load_dwordx4 v12, s[8:11], s3 offen offset:0  lds
    buffer_load_dwordx4 v13, s[8:11], s3 offen offset:1024  lds
    s_add_u32 m0, s73, 94208
    s_nop 0
    buffer_load_dwordx4 v14, s[8:11], s3 offen offset:0  lds
    buffer_load_dwordx4 v15, s[8:11], s3 offen offset:1024  lds
    s_add_u32 s75, s75, 393216
    s_cmp_eq_u32 s75, 6291456
    s_cselect_b32 s75, 0, s75
    s_waitcnt vmcnt(36)
    s_barrier
    s_add_u32 m0, s73, 131072
    s_nop 0
    buffer_load_dwordx4 v16, s[8:11], s76 offen offset:0  lds
    buffer_load_dwordx4 v17, s[8:11], s76 offen offset:1024  lds
    s_add_u32 m0, s73, 135168
    s_add_u32 s3, s76, 196608
    buffer_load_dwordx4 v16, s[8:11], s3 offen offset:0  lds
    buffer_load_dwordx4 v17, s[8:11], s3 offen offset:1024  lds
    s_add_u32 s76, s76, 393216
    s_cmp_eq_u32 s76, 6291456
    s_cselect_b32 s76, 0, s76
    s_add_u32 m0, s72, 32768
    s_nop 0
    buffer_load_dwordx4 v8, s[4:7], s74 offen offset:0  lds
    buffer_load_dwordx4 v9, s[4:7], s74 offen offset:1024  lds
    buffer_load_dwordx4 v10, s[4:7], s74 offen offset:2048  lds
    buffer_load_dwordx4 v11, s[4:7], s74 offen offset:3072  lds
    s_add_u32 m0, s72, 40960
    s_add_u32 s3, s74, 131072
    buffer_load_dwordx4 v8, s[4:7], s3 offen offset:0  lds
    buffer_load_dwordx4 v9, s[4:7], s3 offen offset:1024  lds
    buffer_load_dwordx4 v10, s[4:7], s3 offen offset:2048  lds
    buffer_load_dwordx4 v11, s[4:7], s3 offen offset:3072  lds
    s_add_u32 s74, s74, 128
    s_and_b32 s74, s74, 2047
    s_add_u32 s3, s75, 196608
    s_add_u32 m0, s73, 98304
    s_nop 0
    buffer_load_dwordx4 v12, s[8:11], s75 offen offset:0  lds
    buffer_load_dwordx4 v13, s[8:11], s75 offen offset:1024  lds
    s_add_u32 m0, s73, 106496
    s_nop 0
    buffer_load_dwordx4 v14, s[8:11], s75 offen offset:0  lds
    buffer_load_dwordx4 v15, s[8:11], s75 offen offset:1024  lds
    s_add_u32 m0, s73, 102400
    s_nop 0
    buffer_load_dwordx4 v12, s[8:11], s3 offen offset:0  lds
    buffer_load_dwordx4 v13, s[8:11], s3 offen offset:1024  lds
    s_add_u32 m0, s73, 110592
    s_nop 0
    buffer_load_dwordx4 v14, s[8:11], s3 offen offset:0  lds
    buffer_load_dwordx4 v15, s[8:11], s3 offen offset:1024  lds
    s_add_u32 s75, s75, 393216
    s_cmp_eq_u32 s75, 6291456
    s_cselect_b32 s75, 0, s75
    s_waitcnt vmcnt(36)
    s_barrier
    s_add_u32 m0, s73, 139264
    s_nop 0
    buffer_load_dwordx4 v16, s[8:11], s76 offen offset:0  lds
    buffer_load_dwordx4 v17, s[8:11], s76 offen offset:1024  lds
    s_add_u32 m0, s73, 143360
    s_add_u32 s3, s76, 196608
    buffer_load_dwordx4 v16, s[8:11], s3 offen offset:0  lds
    buffer_load_dwordx4 v17, s[8:11], s3 offen offset:1024  lds
    s_add_u32 s76, s76, 393216
    s_cmp_eq_u32 s76, 6291456
    s_cselect_b32 s76, 0, s76
    s_add_u32 m0, s72, 49152
    s_nop 0
    buffer_load_dwordx4 v8, s[4:7], s74 offen offset:0  lds
    buffer_load_dwordx4 v9, s[4:7], s74 offen offset:1024  lds
    buffer_load_dwordx4 v10, s[4:7], s74 offen offset:2048  lds
    buffer_load_dwordx4 v11, s[4:7], s74 offen offset:3072  lds
    s_add_u32 m0, s72, 57344
    s_add_u32 s3, s74, 131072
    buffer_load_dwordx4 v8, s[4:7], s3 offen offset:0  lds
    buffer_load_dwordx4 v9, s[4:7], s3 offen offset:1024  lds
    buffer_load_dwordx4 v10, s[4:7], s3 offen offset:2048  lds
    buffer_load_dwordx4 v11, s[4:7], s3 offen offset:3072  lds
    s_add_u32 s74, s74, 128
    s_and_b32 s74, s74, 2047
    s_add_u32 s3, s75, 196608
    s_add_u32 m0, s73, 114688
    s_nop 0
    buffer_load_dwordx4 v12, s[8:11], s75 offen offset:0  lds
    buffer_load_dwordx4 v13, s[8:11], s75 offen offset:1024  lds
    s_add_u32 m0, s73, 122880
    s_nop 0
    buffer_load_dwordx4 v14, s[8:11], s75 offen offset:0  lds
    buffer_load_dwordx4 v15, s[8:11], s75 offen offset:1024  lds
    s_add_u32 m0, s73, 118784
    s_nop 0
    buffer_load_dwordx4 v12, s[8:11], s3 offen offset:0  lds
    buffer_load_dwordx4 v13, s[8:11], s3 offen offset:1024  lds
    s_add_u32 m0, s73, 126976
    s_nop 0
    buffer_load_dwordx4 v14, s[8:11], s3 offen offset:0  lds
    buffer_load_dwordx4 v15, s[8:11], s3 offen offset:1024  lds
    s_add_u32 s75, s75, 393216
    s_cmp_eq_u32 s75, 6291456
    s_cselect_b32 s75, 0, s75
    s_waitcnt vmcnt(36)
    s_barrier
    s_getpc_b64 s[66:67]
L_pc2:
    s_add_u32 s66, s66, L_e1-L_pc2
    s_addc_u32 s67, s67, 0
    s_lshr_b32 s3, s2, 3
    s_lshl_b32 s3, s3, 1
    s_add_u32 s3, s3, s38
    s_lshl_b32 s3, s3, 6
    s_add_u32 s66, s66, s3
    s_addc_u32 s67, s67, 0
    s_load_dword s65, s[66:67], 0
    s_load_dword s65, s[66:67], 4096
    s_load_dword s65, s[66:67], 8192
    s_load_dword s65, s[66:67], 12288
    s_add_u32 m0, s73, 147456
    s_nop 0
    buffer_load_dwordx4 v16, s[8:11], s76 offen offset:0  lds
    buffer_load_dwordx4 v17, s[8:11], s76 offen offset:1024  lds
    s_add_u32 m0, s73, 151552
    s_add_u32 s3, s76, 196608
    buffer_load_dwordx4 v16, s[8:11], s3 offen offset:0  lds
    buffer_load_dwordx4 v17, s[8:11], s3 offen offset:1024  lds
    s_add_u32 s76, s76, 393216
    s_cmp_eq_u32 s76, 6291456
    s_cselect_b32 s76, 0, s76
    s_add_u32 m0, s72, 0
    s_nop 0
    buffer_load_dwordx4 v8, s[4:7], s74 offen offset:0  lds
    buffer_load_dwordx4 v9, s[4:7], s74 offen offset:1024  lds
    buffer_load_dwordx4 v10, s[4:7], s74 offen offset:2048  lds
    buffer_load_dwordx4 v11, s[4:7], s74 offen offset:3072  lds
    s_add_u32 m0, s72, 8192
    s_add_u32 s3, s74, 131072
    buffer_load_dwordx4 v8, s[4:7], s3 offen offset:0  lds
    buffer_load_dwordx4 v9, s[4:7], s3 offen offset:1024  lds
    buffer_load_dwordx4 v10, s[4:7], s3 offen offset:2048  lds
    buffer_load_dwordx4 v11, s[4:7], s3 offen offset:3072  lds
    s_add_u32 s74, s74, 128
    s_and_b32 s74, s74, 2047
    s_add_u32 s3, s75, 196608
    s_add_u32 m0, s73, 65536
    s_nop 0
    buffer_load_dwordx4 v12, s[8:11], s75 offen offset:0  lds
    buffer_load_dwordx4 v13, s[8:11], s75 offen offset:1024  lds
    s_add_u32 m0, s73, 73728
    s_nop 0
    buffer_load_dwordx4 v14, s[8:11], s75 offen offset:0  lds
    buffer_load_dwordx4 v15, s[8:11], s75 offen offset:1024  lds
    s_add_u32 m0, s73, 69632
    s_nop 0
    buffer_load_dwordx4 v12, s[8:11], s3 offen offset:0  lds
    buffer_load_dwordx4 v13, s[8:11], s3 offen offset:1024  lds
    s_add_u32 m0, s73, 77824
    s_nop 0
    buffer_load_dwordx4 v14, s[8:11], s3 offen offset:0  lds
    buffer_load_dwordx4 v15, s[8:11], s3 offen offset:1024  lds
    s_add_u32 s75, s75, 393216
    s_cmp_eq_u32 s75, 6291456
    s_cselect_b32 s75, 0, s75
    buffer_load_dwordx4 v[232:235], v248, s[4:7], 0 offen
    buffer_load_dwordx4 v[236:239], v248, s[4:7], s48 offen
    buffer_load_dwordx4 v[240:243], v248, s[4:7], s49 offen
    buffer_load_dwordx4 v[244:247], v248, s[4:7], s100 offen
    s_waitcnt vmcnt(40)
    s_barrier
    s_add_u32 m0, s73, 131072
    s_nop 0
    buffer_load_dwordx4 v16, s[8:11], s76 offen offset:0  lds
    buffer_load_dwordx4 v17, s[8:11], s76 offen offset:1024  lds
    s_add_u32 m0, s73, 135168
    s_add_u32 s3, s76, 196608
    buffer_load_dwordx4 v16, s[8:11], s3 offen offset:0  lds
    buffer_load_dwordx4 v17, s[8:11], s3 offen offset:1024  lds
    s_add_u32 s76, s76, 393216
    s_cmp_eq_u32 s76, 6291456
    s_cselect_b32 s76, 0, s76
    s_add_u32 m0, s72, 16384
    s_nop 0
    buffer_load_dwordx4 v8, s[4:7], s74 offen offset:0  lds
    buffer_load_dwordx4 v9, s[4:7], s74 offen offset:1024  lds
    buffer_load_dwordx4 v10, s[4:7], s74 offen offset:2048  lds
    buffer_load_dwordx4 v11, s[4:7], s74 offen offset:3072  lds
    s_add_u32 m0, s72, 24576
    s_add_u32 s3, s74, 131072
    buffer_load_dwordx4 v8, s[4:7], s3 offen offset:0  lds
    buffer_load_dwordx4 v9, s[4:7], s3 offen offset:1024  lds
    buffer_load_dwordx4 v10, s[4:7], s3 offen offset:2048  lds
    buffer_load_dwordx4 v11, s[4:7], s3 offen offset:3072  lds
    s_add_u32 s74, s74, 128
    s_and_b32 s74, s74, 2047
    s_add_u32 s3, s75, 196608
    s_add_u32 m0, s73, 81920
    s_nop 0
    buffer_load_dwordx4 v12, s[8:11], s75 offen offset:0  lds
    buffer_load_dwordx4 v13, s[8:11], s75 offen offset:1024  lds
    s_add_u32 m0, s73, 90112
    s_nop 0
    buffer_load_dwordx4 v14, s[8:11], s75 offen offset:0  lds
    buffer_load_dwordx4 v15, s[8:11], s75 offen offset:1024  lds
    s_add_u32 m0, s73, 86016
    s_nop 0
    buffer_load_dwordx4 v12, s[8:11], s3 offen offset:0  lds
    buffer_load_dwordx4 v13, s[8:11], s3 offen offset:1024  lds
    s_add_u32 m0, s73, 94208
    s_nop 0
    buffer_load_dwordx4 v14, s[8:11], s3 offen offset:0  lds
    buffer_load_dwordx4 v15, s[8:11], s3 offen offset:1024  lds
    s_add_u32 s75, s75, 393216
    s_cmp_eq_u32 s75, 6291456
    s_cselect_b32 s75, 0, s75
    s_waitcnt vmcnt(40)
    s_barrier
    s_add_u32 m0, s73, 139264
    s_nop 0
    buffer_load_dwordx4 v16, s[8:11], s76 offen offset:0  lds
    buffer_load_dwordx4 v17, s[8:11], s76 offen offset:1024  lds
    s_add_u32 m0, s73, 143360
    s_add_u32 s3, s76, 196608
    buffer_load_dwordx4 v16, s[8:11], s3 offen offset:0  lds
    buffer_load_dwordx4 v17, s[8:11], s3 offen offset:1024  lds
    s_add_u32 s76, s76, 393216
    s_cmp_eq_u32 s76, 6291456
    s_cselect_b32 s76, 0, s76
    s_add_u32 m0, s72, 32768
    s_nop 0
    buffer_load_dwordx4 v8, s[4:7], s74 offen offset:0  lds
    buffer_load_dwordx4 v9, s[4:7], s74 offen offset:1024  lds
    buffer_load_dwordx4 v10, s[4:7], s74 offen offset:2048  lds
    buffer_load_dwordx4 v11, s[4:7], s74 offen offset:3072  lds
    s_add_u32 m0, s72, 40960
    s_add_u32 s3, s74, 131072
    buffer_load_dwordx4 v8, s[4:7], s3 offen offset:0  lds
    buffer_load_dwordx4 v9, s[4:7], s3 offen offset:1024  lds
    buffer_load_dwordx4 v10, s[4:7], s3 offen offset:2048  lds
    buffer_load_dwordx4 v11, s[4:7], s3 offen offset:3072  lds
    s_add_u32 s74, s74, 128
    s_and_b32 s74, s74, 2047
    s_add_u32 s3, s75, 196608
    s_add_u32 m0, s73, 98304
    s_nop 0
    buffer_load_dwordx4 v12, s[8:11], s75 offen offset:0  lds
    buffer_load_dwordx4 v13, s[8:11], s75 offen offset:1024  lds
    s_add_u32 m0, s73, 106496
    s_nop 0
    buffer_load_dwordx4 v14, s[8:11], s75 offen offset:0  lds
    buffer_load_dwordx4 v15, s[8:11], s75 offen offset:1024  lds
    s_add_u32 m0, s73, 102400
    s_nop 0
    buffer_load_dwordx4 v12, s[8:11], s3 offen offset:0  lds
    buffer_load_dwordx4 v13, s[8:11], s3 offen offset:1024  lds
    s_add_u32 m0, s73, 110592
    s_nop 0
    buffer_load_dwordx4 v14, s[8:11], s3 offen offset:0  lds
    buffer_load_dwordx4 v15, s[8:11], s3 offen offset:1024  lds
    s_add_u32 s75, s75, 393216
    s_cmp_eq_u32 s75, 6291456
    s_cselect_b32 s75, 0, s75
    s_waitcnt vmcnt(44)
    s_waitcnt vmcnt(20)
    s_barrier
    s_add_u32 m0, s72, 49152
    s_nop 0
    buffer_load_dwordx4 v8, s[4:7], s74 offen offset:0  lds
    buffer_load_dwordx4 v9, s[4:7], s74 offen offset:1024  lds
    buffer_load_dwordx4 v10, s[4:7], s74 offen offset:2048  lds
    buffer_load_dwordx4 v11, s[4:7], s74 offen offset:3072  lds
    s_add_u32 m0, s72, 57344
    s_add_u32 s3, s74, 131072
    buffer_load_dwordx4 v8, s[4:7], s3 offen offset:0  lds
    buffer_load_dwordx4 v9, s[4:7], s3 offen offset:1024  lds
    buffer_load_dwordx4 v10, s[4:7], s3 offen offset:2048  lds
    buffer_load_dwordx4 v11, s[4:7], s3 offen offset:3072  lds
    s_add_u32 s74, s74, 128
    s_and_b32 s74, s74, 2047
    s_waitcnt vmcnt(8)
    v_mov_b32 v19, 14
    ds_write_b32 v27, v19
    s_add_u32 s3, s75, 196608
    s_add_u32 m0, s73, 114688
    s_nop 0
    buffer_load_dwordx4 v12, s[8:11], s75 offen offset:0  lds
    buffer_load_dwordx4 v13, s[8:11], s75 offen offset:1024  lds
    s_add_u32 m0, s73, 122880
    s_nop 0
    buffer_load_dwordx4 v14, s[8:11], s75 offen offset:0  lds
    buffer_load_dwordx4 v15, s[8:11], s75 offen offset:1024  lds
    s_add_u32 m0, s73, 118784
    s_nop 0
    buffer_load_dwordx4 v12, s[8:11], s3 offen offset:0  lds
    buffer_load_dwordx4 v13, s[8:11], s3 offen offset:1024  lds
    s_add_u32 m0, s73, 126976
    s_nop 0
    buffer_load_dwordx4 v14, s[8:11], s3 offen offset:0  lds
    buffer_load_dwordx4 v15, s[8:11], s3 offen offset:1024  lds
    s_add_u32 s75, s75, 393216
    s_cmp_eq_u32 s75, 6291456
    s_cselect_b32 s75, 0, s75
    s_add_u32 m0, s73, 147456
    s_nop 0
    buffer_load_dwordx4 v16, s[8:11], s76 offen offset:0  lds
    buffer_load_dwordx4 v17, s[8:11], s76 offen offset:1024  lds
    s_add_u32 m0, s73, 151552
    s_add_u32 s3, s76, 196608
    buffer_load_dwordx4 v16, s[8:11], s3 offen offset:0  lds
    buffer_load_dwordx4 v17, s[8:11], s3 offen offset:1024  lds
    s_add_u32 s76, s76, 393216
    s_cmp_eq_u32 s76, 6291456
    s_cselect_b32 s76, 0, s76
    s_waitcnt lgkmcnt(0)
    s_branch L_join
L_xw:
    v_lshlrev_b32 v3, 4, v1
    s_mov_b32 s12, s62
    s_mov_b32 s13, s63
    s_mov_b32 s14, 268435456
    s_mov_b32 s15, 0x00020000
    s_mov_b32 s24, s58
    s_mov_b32 s25, s59
    s_mov_b32 s26, 4194304
    s_mov_b32 s27, 0x00020000
    s_mov_b32 s16, s60
    s_mov_b32 s17, s61
    s_mov_b32 s18, 256
    s_mov_b32 s19, 0x00020000
    s_mov_b32 s20, s44
    s_mov_b32 s21, s45
    s_mov_b32 s22, 65536
    s_mov_b32 s23, 0x00020000
    s_and_b32 s30, s2, 3
    s_lshl_b32 s30, s30, 2
    s_bfe_u32 s3, s2, 0x20003
    s_add_u32 s30, s30, s3
    s_bfe_u32 s31, s2, 0x10002
    s_lshl_b32 s31, s31, 3
    s_lshr_b32 s3, s2, 5
    s_add_u32 s31, s31, s3
    s_mov_b32 s70, 0
    s_mov_b32 s80, s52
    s_mov_b32 s81, s53
    s_mov_b32 s82, 7340032
    s_mov_b32 s83, 0x00020000
    s_mov_b32 s84, s54
    s_mov_b32 s85, s55
    s_mov_b32 s86, 7340032
    s_mov_b32 s87, 0x00020000
    s_cmp_lt_u32 s2, 224
    s_cselect_b32 s82, s82, 0
    s_cselect_b32 s86, s86, 0
    s_and_b32 s3, s2, 15
    s_lshl_b32 s3, s3, 6
    v_and_b32 v5, 0x38, v1
    v_add_u32 v5, s3, v5
    v_mul_u32_u24 v5, 7168, v5
    v_and_b32 v6, 7, v1
    v_lshl_add_u32 v2, v6, 4, v5
    s_lshr_b32 s77, s2, 4
    s_lshl_b32 s77, s77, 2
    s_add_u32 s77, s77, s38
    s_lshl_b32 s77, s77, 7
    v_and_b32 v5, 1, v1
    v_cmp_eq_u32 vcc, 0, v5
    v_mov_b32 v6, 0xffff0000
    v_mov_b32 v7, 0xffff
    v_cndmask_b32 v6, v6, v7, vcc
    v_bfe_u32 v5, v1, 1, 2
    v_cmp_eq_u32 vcc, 0, v5
    s_nop 1
    v_cndmask_b32 v88, 0, v6, vcc
    v_cmp_eq_u32 vcc, 1, v5
    s_nop 1
    v_cndmask_b32 v89, 0, v6, vcc
    v_cmp_eq_u32 vcc, 2, v5
    s_nop 1
    v_cndmask_b32 v90, 0, v6, vcc
    v_cmp_eq_u32 vcc, 3, v5
    s_nop 1
    v_cndmask_b32 v91, 0, v6, vcc
    v_and_b32 v20, 0x3f803f80, v88
    v_and_b32 v21, 0x3f803f80, v89
    v_and_b32 v22, 0x3f803f80, v90
    v_and_b32 v23, 0x3f803f80, v91
    s_lshl_b32 s3, s30, 7
    s_lshl_b32 s65, s38, 5
    s_add_u32 s3, s3, s65
    v_lshrrev_b32 v249, 3, v1
    v_add_u32 v6, s3, v249
    v_lshlrev_b32 v6, 11, v6
    v_and_b32 v250, 7, v1
    v_lshl_add_u32 v6, v250, 4, v6
    s_lshl_b32 s3, s31, 7
    v_add_u32 v248, s3, v6
    s_mov_b32 s48, 16384
    s_mov_b32 s49, 32768
    s_mov_b32 s100, 49152
    s_lshl_b32 s3, s38, 2
    s_add_u32 s3, s3, 163136
    v_mov_b32 v27, s3
    v_mov_b32 v26, 163104
    v_mov_b32 v28, 0x3f803f80
    v_mov_b32 v29, 0x3f803f80
    v_mov_b32 v30, 0x3f803f80
    v_mov_b32 v31, 0x3f803f80
    v_lshrrev_b32 v5, 4, v1
    v_lshlrev_b32 v4, 3, v5
    v_bfe_u32 v6, v1, 2, 2
    v_add_u32 v4, v4, v6
    v_lshlrev_b32 v4, 7, v4
    v_and_b32 v5, 3, v1
    v_lshl_add_u32 v4, v5, 3, v4
    v_add_u32 v4, 65536, v4
    s_and_b32 s3, s38, 1
    s_lshl_b32 s3, s3, 1
    v_bfe_u32 v6, v1, 3, 2
    v_xor_b32 v6, s3, v6
    v_lshl_add_u32 v252, v6, 5, v4
    v_xor_b32 v6, 1, v6
    v_lshl_add_u32 v253, v6, 5, v4
    s_mul_i32 s3, s101, 43
    s_lshr_b32 s3, s3, 7
    s_mul_i32 s3, s3, 3
    s_sub_u32 s3, s101, s3
    s_lshl_b32 s65, s3, 13
    s_add_u32 s65, s65, 65536
    v_add_u32 v32, s65, v252
    v_add_u32 v33, s65, v253
    s_and_b32 s3, s101, 3
    s_lshl_b32 s3, s3, 14
    v_add_u32 v252, s3, v252
    v_add_u32 v253, s3, v253
    s_lshl_b32 s3, s37, 4
    s_add_u32 s3, s3, s36
    s_lshl_b32 s3, s3, 10
    s_and_b32 s65, s38, 1
    s_lshl_b32 s65, s65, 9
    s_add_u32 s3, s3, s65
    s_add_u32 s68, s3, 1048576
    s_mov_b32 s79, 0
    v_mov_b32 v34, 0
    v_mov_b32 v35, 0
    v_mov_b32 v5, 163104
    ds_write_b64 v5, v[34:35]
    ds_write_b64 v5, v[34:35] offset:8
    ds_write_b64 v5, v[34:35] offset:16
    ds_write_b64 v5, v[34:35] offset:24
    ds_write_b64 v5, v[34:35] offset:32
    ds_write_b64 v5, v[34:35] offset:40
    ds_write_b64 v5, v[34:35] offset:48
    ds_write_b64 v5, v[34:35] offset:56
    ds_write_b64 v5, v[34:35] offset:64
    ds_write_b64 v5, v[34:35] offset:72
    ds_write_b64 v5, v[34:35] offset:80
    ds_write_b64 v5, v[34:35] offset:88
    ds_write_b64 v5, v[34:35] offset:96
    ds_write_b64 v5, v[34:35] offset:112
    ds_write_b64 v5, v[34:35] offset:120
    v_and_b32 v5, 16, v1
    v_cmp_eq_u32 s[66:67], 0, v5
    s_getreg_b32 s69, hwreg(HW_REG_XCC_ID, 0, 4)
L_x0:
    s_barrier
    s_add_u32 s79, s79, 1
    s_cmp_le_u32 s79, s101
    s_cbranch_scc1 L_x0
    buffer_load_dword v18, v34, s[16:19], 0 offen sc1
    ds_read_b64_tr_b16 v[144:145], v252 offset:0
    ds_read_b64_tr_b16 v[146:147], v252 offset:512
    ds_read_b64_tr_b16 v[148:149], v252 offset:4096
    ds_read_b64_tr_b16 v[150:151], v252 offset:4608
    ds_read_b64_tr_b16 v[168:169], v253 offset:0
    ds_read_b64_tr_b16 v[170:171], v253 offset:512
    ds_read_b64_tr_b16 v[172:173], v253 offset:4096
    ds_read_b64_tr_b16 v[174:175], v253 offset:4608
    s_waitcnt lgkmcnt(4)
    ds_read_b64_tr_b16 v[152:153], v252 offset:8192
    ds_read_b64_tr_b16 v[154:155], v252 offset:8704
    ds_read_b64_tr_b16 v[156:157], v252 offset:12288
    ds_read_b64_tr_b16 v[158:159], v252 offset:12800
    ds_read_b64_tr_b16 v[176:177], v253 offset:8192
    ds_read_b64_tr_b16 v[178:179], v253 offset:8704
    ds_read_b64_tr_b16 v[180:181], v253 offset:12288
    ds_read_b64_tr_b16 v[182:183], v253 offset:12800
    s_waitcnt lgkmcnt(4)
    ds_read_b64_tr_b16 v[136:137], v32 offset:0
    ds_read_b64_tr_b16 v[138:139], v32 offset:512
    ds_read_b64_tr_b16 v[140:141], v32 offset:4096
    ds_read_b64_tr_b16 v[142:143], v32 offset:4608
    ds_read_b64_tr_b16 v[160:161], v33 offset:0
    ds_read_b64_tr_b16 v[162:163], v33 offset:512
    ds_read_b64_tr_b16 v[164:165], v33 offset:4096
    ds_read_b64_tr_b16 v[166:167], v33 offset:4608
    s_waitcnt lgkmcnt(0)
    s_barrier
    s_add_u32 s79, s79, 1
    v_mfma_f32_16x16x32_bf16 v[116:119], v[28:31], v[144:147], 0
    v_mfma_f32_16x16x32_bf16 v[120:123], v[28:31], v[152:155], 0
    v_mfma_f32_16x16x32_bf16 v[112:115], v[28:31], v[136:139], 0
    v_mfma_f32_16x16x32_bf16 v[128:131], v[28:31], v[168:171], 0
    v_mfma_f32_16x16x32_bf16 v[132:135], v[28:31], v[176:179], 0
    v_mfma_f32_16x16x32_bf16 v[124:127], v[28:31], v[160:163], 0
    v_mfma_f32_16x16x32_bf16 v[116:119], v[28:31], v[148:151], v[116:119]
    v_mfma_f32_16x16x32_bf16 v[120:123], v[28:31], v[156:159], v[120:123]
    v_mfma_f32_16x16x32_bf16 v[112:115], v[28:31], v[140:143], v[112:115]
    v_mfma_f32_16x16x32_bf16 v[128:131], v[28:31], v[172:175], v[128:131]
    v_mfma_f32_16x16x32_bf16 v[132:135], v[28:31], v[180:183], v[132:135]
    v_mfma_f32_16x16x32_bf16 v[124:127], v[28:31], v[164:167], v[124:127]
    s_barrier
    s_add_u32 s79, s79, 1
    s_waitcnt vmcnt(0)
    v_readfirstlane_b32 s3, v18
    s_nop 0
    s_cmp_lg_u32 s3, 0
    s_cbranch_scc1 L_nonok
L_non:
    buffer_load_dword v18, v34, s[16:19], 0 offen sc1
    s_cmp_lt_u32 s79, 12
    s_cbranch_scc0 L_xb3
    s_barrier
    s_add_u32 s79, s79, 1
L_xb3:
    s_waitcnt vmcnt(0)
    v_cmp_eq_u32 vcc, 0, v18
    s_nop 1
    v_cndmask_b32 v6, 0, 1, vcc
    v_cmp_ne_u32 vcc, 0, v6
    s_add_u32 s70, s70, 1
    s_cmp_ge_u32 s70, 200000
    s_cbranch_scc1 L_nonok
    s_cmp_lg_u64 vcc, 0
    s_cbranch_scc1 L_non
L_nonok:
    v_and_b32 v39, -16, v18
    v_or_b32 v39, s69, v39
    v_cndmask_b32 v36, v124, v112, s[66:67]
    v_cndmask_b32 v37, v128, v116, s[66:67]
    v_cndmask_b32 v38, v132, v120, s[66:67]
    s_mov_b64 exec, 0xffffffff
    buffer_store_dwordx4 v[36:39], v3, s[12:15], s68 offen sc1
    s_mov_b64 exec, -1
    s_cmp_eq_u32 s38, 3
    s_cbranch_scc1 L_xbw
    s_cmp_lt_u32 s79, 12
    s_cbranch_scc0 L_xb4
    s_barrier
    s_add_u32 s79, s79, 1
L_xb4:
    s_add_u32 m0, s73, 151552
    s_lshl_b32 s65, s37, 12
    s_add_u32 s65, s65, s73
    s_sub_u32 s65, s65, 4096
    buffer_load_dwordx4 v3, s[20:23], s65 offen offset:0 lds
    buffer_load_dwordx4 v3, s[20:23], s65 offen offset:1024 lds
    s_mov_b64 exec, 0
    s_branch L_hk16
L_hr16:
    s_branch L_hk17
L_hr17:
    s_branch L_hk18
L_hr18:
    s_branch L_hk19
L_hr19:
    s_mov_b64 exec, -1
    s_cmp_lt_u32 s79, 12
    s_cbranch_scc0 L_xb5
    s_barrier
    s_add_u32 s79, s79, 1
L_xb5:
    s_mov_b64 exec, 0
    s_branch L_hk20
L_hr20:
    s_branch L_hk21
L_hr21:
    s_mov_b64 exec, -1
L_xu6:
    s_cmp_ge_u32 s79, 5
    s_cbranch_scc1 L_xe6
    s_barrier
    s_add_u32 s79, s79, 1
    s_branch L_xu6
L_xe6:
    s_lshl_b32 s68, s37, 14
    s_add_u32 s68, s68, 1048576
L_cs:
    s_mov_b32 s3, s68
    buffer_load_dwordx4 v[112:115], v3, s[12:15], s3 offen offset:0 sc1
    buffer_load_dwordx4 v[116:119], v3, s[12:15], s3 offen offset:1024 sc1
    buffer_load_dwordx4 v[120:123], v3, s[12:15], s3 offen offset:2048 sc1
    buffer_load_dwordx4 v[124:127], v3, s[12:15], s3 offen offset:3072 sc1
    s_add_u32 s3, s3, 4096
    buffer_load_dwordx4 v[128:131], v3, s[12:15], s3 offen offset:0 sc1
    buffer_load_dwordx4 v[132:135], v3, s[12:15], s3 offen offset:1024 sc1
    s_cmp_lt_u32 s79, 12
    s_cbranch_scc0 L_xb7
    s_barrier
    s_add_u32 s79, s79, 1
L_xb7:
    buffer_load_dwordx4 v[136:139], v3, s[12:15], s3 offen offset:2048 sc1
    buffer_load_dwordx4 v[140:143], v3, s[12:15], s3 offen offset:3072 sc1
    s_add_u32 s3, s3, 4096
    buffer_load_dwordx4 v[144:147], v3, s[12:15], s3 offen offset:0 sc1
    buffer_load_dwordx4 v[148:151], v3, s[12:15], s3 offen offset:1024 sc1
    buffer_load_dwordx4 v[152:155], v3, s[12:15], s3 offen offset:2048 sc1
    s_cmp_lt_u32 s79, 12
    s_cbranch_scc0 L_xb8
    s_barrier
    s_add_u32 s79, s79, 1
L_xb8:
    buffer_load_dwordx4 v[156:159], v3, s[12:15], s3 offen offset:3072 sc1
    s_add_u32 s3, s3, 4096
    buffer_load_dwordx4 v[160:163], v3, s[12:15], s3 offen offset:0 sc1
    buffer_load_dwordx4 v[164:167], v3, s[12:15], s3 offen offset:1024 sc1
    buffer_load_dwordx4 v[168:171], v3, s[12:15], s3 offen offset:2048 sc1
    buffer_load_dwordx4 v[172:175], v3, s[12:15], s3 offen offset:3072 sc1
    s_cmp_lt_u32 s79, 12
    s_cbranch_scc0 L_xb9
    s_barrier
    s_add_u32 s79, s79, 1
L_xb9:
    s_waitcnt vmcnt(0)
    v_and_b32 v4, v115, v119
    v_or_b32 v5, v115, v119
    v_min3_u32 v4, v4, v123, v127
    v_max3_u32 v5, v5, v123, v127
    v_min3_u32 v4, v4, v131, v135
    v_max3_u32 v5, v5, v131, v135
    v_min3_u32 v4, v4, v139, v143
    v_max3_u32 v5, v5, v139, v143
    v_min3_u32 v4, v4, v147, v151
    v_max3_u32 v5, v5, v147, v151
    v_min3_u32 v4, v4, v155, v159
    v_max3_u32 v5, v5, v155, v159
    v_min3_u32 v4, v4, v163, v167
    v_max3_u32 v5, v5, v163, v167
    v_min3_u32 v4, v4, v171, v175
    v_max3_u32 v5, v5, v171, v175
    v_xor_b32 v6, v4, v18
    v_xor_b32 v7, v5, v18
    v_or_b32 v6, v6, v7
    v_and_b32 v6, -16, v6
    v_cmp_ne_u32 vcc, 0, v6
    s_add_u32 s70, s70, 1
    s_cmp_ge_u32 s70, 200000
    s_cbranch_scc1 L_csok
    s_cmp_lg_u64 vcc, 0
    s_cbranch_scc1 L_cs
L_csok:
    v_xor_b32 v4, v4, v5
    v_mov_b32 v5, 163072
    ds_write_b32 v5, v4 offset:16
    s_cmp_lt_u32 s79, 12
    s_cbranch_scc0 L_xb10
    s_barrier
    s_add_u32 s79, s79, 1
L_xb10:
    v_add_f32 v112, v112, v144
    v_add_f32 v113, v113, v145
    v_add_f32 v114, v114, v146
    v_add_f32 v116, v116, v148
    v_add_f32 v117, v117, v149
    v_add_f32 v118, v118, v150
    v_add_f32 v120, v120, v152
    v_add_f32 v121, v121, v153
    v_add_f32 v122, v122, v154
    v_add_f32 v124, v124, v156
    v_add_f32 v125, v125, v157
    v_add_f32 v126, v126, v158
    v_add_f32 v128, v128, v160
    v_add_f32 v129, v129, v161
    v_add_f32 v130, v130, v162
    v_add_f32 v132, v132, v164
    v_add_f32 v133, v133, v165
    v_add_f32 v134, v134, v166
    v_add_f32 v136, v136, v168
    v_add_f32 v137, v137, v169
    v_add_f32 v138, v138, v170
    v_add_f32 v140, v140, v172
    v_add_f32 v141, v141, v173
    v_add_f32 v142, v142, v174
    s_cmp_lt_u32 s79, 12
    s_cbranch_scc0 L_xb11
    s_barrier
    s_add_u32 s79, s79, 1
L_xb11:
    v_add_f32 v112, v112, v128
    v_add_f32 v113, v113, v129
    v_add_f32 v114, v114, v130
    v_add_f32 v116, v116, v132
    v_add_f32 v117, v117, v133
    v_add_f32 v118, v118, v134
    v_add_f32 v120, v120, v136
    v_add_f32 v121, v121, v137
    v_add_f32 v122, v122, v138
    v_add_f32 v124, v124, v140
    v_add_f32 v125, v125, v141
    v_add_f32 v126, v126, v142
    v_add_f32 v112, v112, v120
    v_add_f32 v113, v113, v121
    v_add_f32 v114, v114, v122
    v_add_f32 v116, v116, v124
    v_add_f32 v117, v117, v125
    v_add_f32 v118, v118, v126
    v_add_f32 v112, v112, v116
    v_add_f32 v113, v113, v117
    v_add_f32 v114, v114, v118
    v_lshlrev_b32 v5, 2, v1
    v_add_u32 v5, 162304, v5
    ds_write_b32 v5, v112
    ds_write_b32 v5, v113 offset:256
    ds_write_b32 v5, v114 offset:512
    s_branch L_xend
L_xbw:
    v_and_b32 v5, 7, v1
    v_lshlrev_b32 v5, 3, v5
    v_add_u32 v6, 163264, v5
    ds_read_b64 v[140:141], v6
    s_lshl_b32 s65, s36, 4
    s_add_u32 s65, s65, s37
    s_lshl_b32 s65, s65, 6
    s_add_u32 s65, s65, 0
    s_lshl_b32 s3, s2, 4
    s_add_u32 s3, s3, 65536
    v_mov_b32 v146, v18
    v_mov_b32 v147, v18
    s_waitcnt lgkmcnt(0)
    v_mov_b32 v144, v141
    v_mov_b32 v145, v140
    s_nop 0
    v_max_u32 v144, v144, v144 quad_perm:[1,0,3,2] row_mask:0xf bank_mask:0xf
    s_nop 1
    v_max_u32 v144, v144, v144 quad_perm:[2,3,0,1] row_mask:0xf bank_mask:0xf
    s_nop 1
    v_max_u32 v144, v144, v144 row_half_mirror row_mask:0xf bank_mask:0xf
    v_cmp_eq_u32 vcc, v144, v141
    v_mov_b32 v141, v18
    s_mov_b64 exec, 0xff
    buffer_store_dwordx2 v[140:141], v5, s[12:15], s65 offen sc1
    s_and_b64 exec, exec, vcc
    buffer_store_dwordx4 v[144:147], v34, s[12:15], s3 offen sc1
    s_mov_b64 exec, -1
    s_cmp_lt_u32 s79, 12
    s_cbranch_scc0 L_xb12
    s_barrier
    s_add_u32 s79, s79, 1
L_xb12:
    s_add_u32 m0, s73, 151552
    s_lshl_b32 s65, s37, 12
    s_add_u32 s65, s65, s73
    s_sub_u32 s65, s65, 4096
    buffer_load_dwordx4 v3, s[20:23], s65 offen offset:0 lds
    buffer_load_dwordx4 v3, s[20:23], s65 offen offset:1024 lds
    s_mov_b64 exec, 0
    s_branch L_hk0
L_hr0:
    s_branch L_hk1
L_hr1:
    s_branch L_hk2
L_hr2:
    s_branch L_hk3
L_hr3:
    s_mov_b64 exec, -1
    s_cmp_lt_u32 s79, 12
    s_cbranch_scc0 L_xb13
    s_barrier
    s_add_u32 s79, s79, 1
L_xb13:
    s_mov_b64 exec, 0
    s_branch L_hk4
L_hr4:
    s_branch L_hk5
L_hr5:
    s_branch L_hk6
L_hr6:
    s_branch L_hk7
L_hr7:
    s_mov_b64 exec, -1
    s_cmp_lt_u32 s79, 12
    s_cbranch_scc0 L_xb14
    s_barrier
    s_add_u32 s79, s79, 1
L_xb14:
    s_mov_b64 exec, 0
    s_branch L_hk8
L_hr8:
    s_branch L_hk9
L_hr9:
    s_branch L_hk10
L_hr10:
    s_branch L_hk11
L_hr11:
    s_mov_b64 exec, -1
    s_cmp_lt_u32 s79, 12
    s_cbranch_scc0 L_xb15
    s_barrier
    s_add_u32 s79, s79, 1
L_xb15:
    s_mov_b64 exec, 0
    s_branch L_hk12
L_hr12:
    s_branch L_hk13
L_hr13:
    s_branch L_hk14
L_hr14:
    s_branch L_hk15
L_hr15:
    s_mov_b64 exec, -1
    s_cmp_lt_u32 s79, 12
    s_cbranch_scc0 L_xb16
    s_barrier
    s_add_u32 s79, s79, 1
L_xb16:
L_xu17:
    s_cmp_ge_u32 s79, 7
    s_cbranch_scc1 L_xe17
    s_barrier
    s_add_u32 s79, s79, 1
    s_branch L_xu17
L_xe17:
    s_mov_b32 s68, 65536
    s_lshl_b32 s66, s36, 10
    s_lshl_b32 s67, s30, 10
L_st:
    buffer_load_dwordx4 v[112:115], v3, s[12:15], s68 offen offset:0 sc1
    buffer_load_dwordx4 v[116:119], v3, s[12:15], s68 offen offset:1024 sc1
    buffer_load_dwordx4 v[120:123], v3, s[12:15], s68 offen offset:2048 sc1
    buffer_load_dwordx4 v[124:127], v3, s[12:15], s68 offen offset:3072 sc1
    buffer_load_dwordx4 v[128:131], v3, s[12:15], s66 offen offset:0 sc1
    buffer_load_dwordx4 v[132:135], v3, s[12:15], s67 offen offset:0 sc1
    s_cmp_lt_u32 s79, 12
    s_cbranch_scc0 L_xb18
    s_barrier
    s_add_u32 s79, s79, 1
L_xb18:
    s_waitcnt vmcnt(0)
    v_and_b32 v6, v114, v118
    v_or_b32 v7, v114, v118
    v_min3_u32 v6, v6, v122, v126
    v_max3_u32 v7, v7, v122, v126
    v_min3_u32 v6, v6, v129, v131
    v_max3_u32 v7, v7, v129, v131
    v_min3_u32 v6, v6, v133, v135
    v_max3_u32 v7, v7, v133, v135
    v_xor_b32 v6, v6, v18
    v_xor_b32 v7, v7, v18
    v_or_b32 v6, v6, v7
    v_cmp_ne_u32 vcc, 0, v6
    s_add_u32 s70, s70, 1
    s_cmp_ge_u32 s70, 200000
    s_cbranch_scc1 L_stok
    s_cmp_lg_u64 vcc, 0
    s_cbranch_scc1 L_st
L_stok:
    s_cmp_lt_u32 s79, 12
    s_cbranch_scc0 L_xb19
    s_barrier
    s_add_u32 s79, s79, 1
L_xb19:
    v_and_b32 v140, 0xffff0000, v128
    v_and_b32 v141, 0xffff0000, v130
    v_and_b32 v142, 0xffff0000, v132
    v_and_b32 v143, 0xffff0000, v134
    v_rcp_f32 v144, v140
    v_rcp_f32 v145, v141
    v_rcp_f32 v146, v142
    v_rcp_f32 v147, v143
    v_lshlrev_b32 v136, 16, v128
    v_lshlrev_b32 v137, 16, v130
    v_lshlrev_b32 v138, 16, v132
    v_lshlrev_b32 v139, 16, v134
    v_lshrrev_b32 v7, 16, v128
    v_or_b32 v7, v7, v141
    v_lshlrev_b32 v5, 3, v1
    v_add_u32 v5, 159744, v5
    v_lshlrev_b32 v4, 2, v1
    v_add_u32 v4, 160768, v4
    v_fma_f32 v140, -v144, v140, 1.0
    v_fma_f32 v141, -v145, v141, 1.0
    v_fma_f32 v142, -v146, v142, 1.0
    v_fma_f32 v143, -v147, v143, 1.0
    v_fmac_f32 v144, v140, v144
    v_fmac_f32 v145, v141, v145
    v_fmac_f32 v146, v142, v146
    v_fmac_f32 v147, v143, v147
    v_xor_b32 v136, 0x80000000, v136
    v_xor_b32 v137, 0x80000000, v137
    v_mul_f32 v140, 0x3fb8aa3b, v144
    v_mul_f32 v141, 0x3fb8aa3b, v145
    s_cmp_lt_u32 s79, 12
    s_cbranch_scc0 L_xb20
    s_barrier
    s_add_u32 s79, s79, 1
L_xb20:
    ds_write_b64 v5, v[140:141] offset:3584
    ds_write_b64 v5, v[136:137]
    ds_write_b64 v5, v[144:145] offset:512
    ds_write_b64 v5, v[138:139] offset:1536
    ds_write_b64 v5, v[146:147] offset:2048
    ds_write_b32 v4, v7
    v_cmp_gt_u32 vcc, v116, v112
    s_nop 1
    v_cndmask_b32 v112, v112, v116, vcc
    v_cndmask_b32 v113, v113, v117, vcc
    v_cmp_gt_u32 vcc, v124, v120
    s_nop 1
    v_cndmask_b32 v120, v120, v124, vcc
    v_cndmask_b32 v121, v121, v125, vcc
    v_cmp_gt_u32 vcc, v120, v112
    s_nop 1
    v_cndmask_b32 v112, v112, v120, vcc
    v_cndmask_b32 v113, v113, v121, vcc
    v_mov_b32 v6, v112
    s_cmp_lt_u32 s79, 12
    s_cbranch_scc0 L_xb21
    s_barrier
    s_add_u32 s79, s79, 1
L_xb21:
    v_max_u32 v6, v6, v6 quad_perm:[1,0,3,2] row_mask:0xf bank_mask:0xf
    s_nop 1
    v_max_u32 v6, v6, v6 quad_perm:[2,3,0,1] row_mask:0xf bank_mask:0xf
    s_nop 1
    v_max_u32 v6, v6, v6 row_half_mirror row_mask:0xf bank_mask:0xf
    s_nop 1
    v_max_u32 v6, v6, v6 row_mirror row_mask:0xf bank_mask:0xf
    v_mov_b32 v7, v6
    s_nop 1
    v_permlane16_swap_b32 v6, v7
    v_max_u32 v6, v6, v7
    v_mov_b32 v7, v6
    s_nop 1
    v_permlane32_swap_b32 v6, v7
    v_max_u32 v6, v6, v7
    v_cmp_eq_u32 vcc, v6, v112
    v_mov_b32 v5, 163072
    s_mov_b64 exec, vcc
    ds_write_b128 v5, v[112:115]
    s_mov_b64 exec, -1
L_xend:
    s_waitcnt lgkmcnt(0)
    buffer_load_dwordx4 v[232:235], v248, s[4:7], 0 offen
    buffer_load_dwordx4 v[236:239], v248, s[4:7], s48 offen
    buffer_load_dwordx4 v[240:243], v248, s[4:7], s49 offen
    buffer_load_dwordx4 v[244:247], v248, s[4:7], s100 offen
L_xu22:
    s_cmp_ge_u32 s79, 12
    s_cbranch_scc1 L_xe22
    s_barrier
    s_add_u32 s79, s79, 1
    s_branch L_xu22
L_xe22:
    s_barrier
    s_sleep 6
L_join:
    s_add_u32 s76, s39, 15
    s_and_b32 s76, s76, 15
    s_mul_i32 s76, s76, 393216
    buffer_load_dwordx4 v[36:39], v16, s[8:11], s76 offen offset:0
    buffer_load_dwordx4 v[40:43], v17, s[8:11], s76 offen offset:1024
    s_waitcnt vmcnt(2)
L_hk0:
    s_cbranch_execz L_hr0
    v_mov_b32 v19, 15
    ds_write_b32 v27, v19
    buffer_load_dwordx4 v[128:131], v2, s[80:83], s77 offen nt
    buffer_load_dwordx4 v[160:163], v2, s[84:87], s77 offen nt
    s_add_u32 s77, s77, 7168
    buffer_load_dwordx4 v[132:135], v2, s[80:83], s77 offen nt
    buffer_load_dwordx4 v[164:167], v2, s[84:87], s77 offen nt
    s_add_u32 s77, s77, 7168
    v_mov_b32 v5, 163072
    ds_read_b128 v[80:83], v5
    ds_read_b32 v84, v5 offset:16
    s_and_b32 s65, s2, 15
    s_lshl_b32 s65, s65, 7
    v_lshrrev_b32 v5, 3, v1
    v_lshlrev_b32 v5, 4, v5
    s_waitcnt lgkmcnt(0)
    v_readfirstlane_b32 s33, v80
    v_readfirstlane_b32 s64, v81
    v_mov_b32 v18, v82
    v_readfirstlane_b32 s88, v84
    s_and_b32 s34, s33, 0x7ff
    s_sub_u32 s34, 2047, s34
    s_lshl_b32 s3, s34, 11
    s_add_u32 s3, s3, s65
    buffer_load_dwordx4 v[76:79], v5, s[4:7], s3 offen
    s_lshr_b32 s3, s34, 7
    s_cmp_eq_u32 s3, s30
    s_cselect_b32 s35, 1, 0
    s_mov_b32 s16, s46
    s_mov_b32 s17, s47
    s_mov_b32 s18, 2097152
    s_mov_b32 s19, 0x00020000
    s_lshl_b32 s3, s2, 2
    s_add_u32 s3, s3, s38
    s_lshl_b32 s3, s3, 11
    v_lshlrev_b32 v5, 7, v1
    s_mov_b64 exec, 0xffff
    buffer_load_dword v0, v5, s[16:19], s3 offen
    s_mov_b64 exec, -1
    buffer_load_dwordx4 v[136:139], v2, s[80:83], s77 offen nt
    buffer_load_dwordx4 v[168:171], v2, s[84:87], s77 offen nt
    s_add_u32 s77, s77, 7168
    buffer_load_dwordx4 v[140:143], v2, s[80:83], s77 offen nt
    buffer_load_dwordx4 v[172:175], v2, s[84:87], s77 offen nt
    s_add_u32 s77, s77, 7168
L_pe14:
    ds_read_b128 v[224:227], v26 offset:48
    s_waitcnt lgkmcnt(0)
    v_min_u32 v224, v224, v225
    v_min3_u32 v224, v224, v226, v227
    s_nop 0
    v_readfirstlane_b32 s3, v224
    s_nop 0
    s_cmp_ge_u32 s3, 14
    s_cbranch_scc1 L_pd14
    s_sleep 3
    s_branch L_pe14
L_pd14:
    s_waitcnt vmcnt(10)
    s_add_u32 s3, s73, 65536
    v_add_u32 v24, s3, v3
    ds_write_b128 v24, v[36:39] offset:16384
    ds_write_b128 v24, v[40:43] offset:17408
    s_lshl_b32 s3, s38, 2
    s_add_u32 s3, s3, 163120
    v_mov_b32 v5, s3
L_hk1:
    s_cbranch_execz L_hr1
    v_mov_b32 v6, 1
    ds_write_b32 v5, v6
    buffer_load_dwordx4 v[144:147], v2, s[80:83], s77 offen nt
    buffer_load_dwordx4 v[176:179], v2, s[84:87], s77 offen nt
    s_add_u32 s77, s77, 7168
    buffer_load_dwordx4 v[148:151], v2, s[80:83], s77 offen nt
    buffer_load_dwordx4 v[180:183], v2, s[84:87], s77 offen nt
    s_add_u32 s77, s77, 7168
    buffer_load_dwordx4 v[152:155], v2, s[80:83], s77 offen nt
    buffer_load_dwordx4 v[184:187], v2, s[84:87], s77 offen nt
    s_add_u32 s77, s77, 7168
    buffer_load_dwordx4 v[156:159], v2, s[80:83], s77 offen nt
    buffer_load_dwordx4 v[188:191], v2, s[84:87], s77 offen nt
    s_add_u32 s77, s77, 7168
    s_mov_b32 s20, s56
    s_mov_b32 s21, s57
    s_mov_b32 s22, 7340032
    s_mov_b32 s23, 0x00020000
    s_cmp_lt_u32 s2, 224
    s_cselect_b32 s22, s22, 0
    v_lshrrev_b32 v5, 4, v1
    v_lshlrev_b32 v5, 11, v5
    v_and_b32 v6, 15, v1
    v_lshl_add_u32 v109, v6, 4, v5
    s_lshl_b32 s93, s2, 15
    s_lshl_b32 s65, s38, 9
    s_add_u32 s93, s93, s65
    buffer_load_dwordx4 v[192:195], v109, s[20:23], s93 offen offset:0 nt
    buffer_load_dwordx4 v[196:199], v109, s[20:23], s93 offen offset:256 nt
    s_add_u32 s93, s93, 8192
    buffer_load_dwordx4 v[200:203], v109, s[20:23], s93 offen offset:0 nt
    buffer_load_dwordx4 v[204:207], v109, s[20:23], s93 offen offset:256 nt
    s_add_u32 s93, s93, 8192
    buffer_load_dwordx4 v[208:211], v109, s[20:23], s93 offen offset:0 nt
    buffer_load_dwordx4 v[212:215], v109, s[20:23], s93 offen offset:256 nt
    s_add_u32 s93, s93, 8192
    buffer_load_dwordx4 v[216:219], v109, s[20:23], s93 offen offset:0 nt
    buffer_load_dwordx4 v[220:223], v109, s[20:23], s93 offen offset:256 nt
    s_lshl_b32 s65, s37, 1
    s_and_b32 s3, s38, 1
    s_add_u32 s65, s65, s3
    s_lshl_b32 s3, s36, 9
    s_lshl_b32 s89, s65, 17
    s_add_u32 s89, s89, s3
    s_add_u32 s89, s89, 2097152
    s_add_u32 s90, s89, 32768
    s_add_u32 s91, s89, 65536
    s_add_u32 s92, s89, 98304
    s_lshl_b32 s69, s65, 13
    s_add_u32 s69, s69, 524288
    s_add_u32 s68, s69, s3
    s_add_u32 s71, s69, 4096
    s_mov_b32 s94, 0xffff
    s_mov_b32 s95, 0xffff
    v_lshrrev_b32 v5, 4, v1
    v_and_b32 v6, 15, v1
    v_lshlrev_b32 v6, 4, v6
    v_lshl_add_u32 v28, v5, 13, v6
    v_lshrrev_b32 v7, 5, v1
    v_lshl_add_u32 v29, v7, 8, v6
    s_lshl_b32 s3, s38, 12
    s_add_u32 s3, s3, 141312
    v_add_u32 v30, s3, v3
    s_lshl_b32 s3, s38, 7
    s_add_u32 s3, s3, 157440
L_hk2:
    s_cbranch_execz L_hr2
    v_lshl_add_u32 v31, v5, 3, s3
    v_and_b32 v5, 8, v1
    v_cmp_eq_u32 vcc, 0, v5
    s_nop 1
    v_cndmask_b32 v112, 0, v20, vcc
    v_cndmask_b32 v116, v20, 0, vcc
    v_cndmask_b32 v113, 0, v21, vcc
    v_cndmask_b32 v117, v21, 0, vcc
    v_cndmask_b32 v114, 0, v22, vcc
    v_cndmask_b32 v118, v22, 0, vcc
    v_cndmask_b32 v115, 0, v23, vcc
    v_cndmask_b32 v119, v23, 0, vcc
    v_mov_b32 v127, v18
    s_waitcnt vmcnt(21)
    s_lshl_b32 s65, s64, 16
    s_and_b32 s66, s64, 0xffff0000
    v_rcp_f32 v6, s66
    v_lshlrev_b32 v80, 16, v76
    v_and_b32 v81, 0xffff0000, v76
    v_lshlrev_b32 v82, 16, v77
    v_and_b32 v83, 0xffff0000, v77
    v_lshlrev_b32 v84, 16, v78
    v_and_b32 v85, 0xffff0000, v78
    v_lshlrev_b32 v86, 16, v79
    v_and_b32 v87, 0xffff0000, v79
    v_fma_f32 v4, -v6, s66, 1.0
    v_fmac_f32 v6, v4, v6
    v_subrev_f32 v80, s65, v80
    v_subrev_f32 v81, s65, v81
    v_subrev_f32 v82, s65, v82
    v_subrev_f32 v83, s65, v83
    v_subrev_f32 v84, s65, v84
    v_subrev_f32 v85, s65, v85
    v_subrev_f32 v86, s65, v86
    v_subrev_f32 v87, s65, v87
    v_cvt_pk_bf16_f32 v80, v80, v80
    v_cvt_pk_bf16_f32 v81, v81, v81
    v_cvt_pk_bf16_f32 v82, v82, v82
    v_cvt_pk_bf16_f32 v83, v83, v83
    v_cvt_pk_bf16_f32 v84, v84, v84
    v_cvt_pk_bf16_f32 v85, v85, v85
    v_cvt_pk_bf16_f32 v86, v86, v86
    v_cvt_pk_bf16_f32 v87, v87, v87
    v_lshlrev_b32 v80, 16, v80
    v_lshlrev_b32 v81, 16, v81
    v_lshlrev_b32 v82, 16, v82
    v_lshlrev_b32 v83, 16, v83
    v_lshlrev_b32 v84, 16, v84
    v_lshlrev_b32 v85, 16, v85
    v_lshlrev_b32 v86, 16, v86
    v_lshlrev_b32 v87, 16, v87
    v_mul_f32 v80, v80, v6
    v_mul_f32 v81, v81, v6
    v_mul_f32 v82, v82, v6
    v_mul_f32 v83, v83, v6
    v_mul_f32 v84, v84, v6
    v_mul_f32 v85, v85, v6
    v_mul_f32 v86, v86, v6
    v_mul_f32 v87, v87, v6
    v_cvt_pk_bf16_f32 v80, v80, v80
    v_cvt_pk_bf16_f32 v81, v81, v81
    v_cvt_pk_bf16_f32 v82, v82, v82
    v_cvt_pk_bf16_f32 v83, v83, v83
    v_cvt_pk_bf16_f32 v84, v84, v84
L_hk3:
    s_cbranch_execz L_hr3
    v_cvt_pk_bf16_f32 v85, v85, v85
    v_cvt_pk_bf16_f32 v86, v86, v86
    v_cvt_pk_bf16_f32 v87, v87, v87
    v_lshrrev_b32 v5, 5, v1
    v_and_b32 v6, 7, v1
    v_lshlrev_b32 v6, 1, v6
    v_lshl_add_u32 v6, v5, 4, v6
    v_bfe_u32 v5, v1, 4, 1
    v_add_u32 v6, v6, v5
    v_lshlrev_b32 v108, 4, v6
    s_lshr_b32 s3, s2, 4
    s_lshl_b32 s3, s3, 2
    s_add_u32 s3, s3, s38
    s_lshl_b32 s3, s3, 4
    s_and_b32 s65, s2, 15
    s_add_u32 s3, s3, s65
    s_lshl_b32 s3, s3, 10
    s_add_u32 s78, s3, 6291456
    s_mov_b32 s66, 0x00ff00ff
    s_mov_b32 s67, 0x00ff00ff
    v_mov_b32 v93, v18
    v_mov_b32 v95, v18
    v_mov_b32 v97, v18
    v_mov_b32 v99, v18
    v_lshrrev_b32 v5, 3, v1
    v_lshlrev_b32 v5, 11, v5
    v_lshrrev_b32 v6, 4, v1
    v_lshlrev_b32 v6, 1, v6
    v_and_b32 v7, 7, v1
    v_xor_b32 v6, v6, v7
    v_lshl_add_u32 v5, v6, 4, v5
    s_lshl_b32 s3, s31, 7
    s_lshl_b32 s65, s38, 15
    s_add_u32 s3, s3, s65
    v_add_u32 v110, s3, v5
    v_add_u32 v111, 15360, v110
    v_and_b32 v68, v80, v88
    v_and_b32 v69, v80, v89
    v_and_b32 v70, v80, v90
    v_and_b32 v71, v80, v91
    s_nop 1
    v_mfma_f32_16x16x32_bf16 v[100:103], v[68:71], v[128:131], 0
    v_mfma_f32_16x16x32_bf16 v[104:107], v[68:71], v[160:163], 0
    v_and_b32 v72, v81, v88
    v_and_b32 v73, v81, v89
    v_and_b32 v74, v81, v90
    v_and_b32 v75, v81, v91
    s_nop 1
    v_mfma_f32_16x16x32_bf16 v[100:103], v[72:75], v[132:135], v[100:103]
    v_mfma_f32_16x16x32_bf16 v[104:107], v[72:75], v[164:167], v[104:107]
    s_waitcnt vmcnt(18)
    v_and_b32 v68, v82, v88
    v_and_b32 v69, v82, v89
    v_and_b32 v70, v82, v90
    v_and_b32 v71, v82, v91
    s_nop 1
    v_mfma_f32_16x16x32_bf16 v[100:103], v[68:71], v[136:139], v[100:103]
    v_mfma_f32_16x16x32_bf16 v[104:107], v[68:71], v[168:171], v[104:107]
    s_waitcnt vmcnt(16)
    v_and_b32 v72, v83, v88
    v_and_b32 v73, v83, v89
    v_and_b32 v74, v83, v90
    v_and_b32 v75, v83, v91
    s_nop 1
    v_mfma_f32_16x16x32_bf16 v[100:103], v[72:75], v[140:143], v[100:103]
    v_mfma_f32_16x16x32_bf16 v[104:107], v[72:75], v[172:175], v[104:107]
    s_waitcnt vmcnt(14)
L_hk4:
    s_cbranch_execz L_hr4
    v_and_b32 v68, v84, v88
    v_and_b32 v69, v84, v89
    v_and_b32 v70, v84, v90
    v_and_b32 v71, v84, v91
    s_nop 1
    v_mfma_f32_16x16x32_bf16 v[100:103], v[68:71], v[144:147], v[100:103]
    v_mfma_f32_16x16x32_bf16 v[104:107], v[68:71], v[176:179], v[104:107]
    s_waitcnt vmcnt(12)
    v_and_b32 v72, v85, v88
    v_and_b32 v73, v85, v89
    v_and_b32 v74, v85, v90
    v_and_b32 v75, v85, v91
    s_nop 1
    v_mfma_f32_16x16x32_bf16 v[100:103], v[72:75], v[148:151], v[100:103]
    v_mfma_f32_16x16x32_bf16 v[104:107], v[72:75], v[180:183], v[104:107]
    s_waitcnt vmcnt(10)
    v_and_b32 v68, v86, v88
    v_and_b32 v69, v86, v89
    v_and_b32 v70, v86, v90
    v_and_b32 v71, v86, v91
    s_nop 1
    v_mfma_f32_16x16x32_bf16 v[100:103], v[68:71], v[152:155], v[100:103]
    v_mfma_f32_16x16x32_bf16 v[104:107], v[68:71], v[184:187], v[104:107]
    s_waitcnt vmcnt(8)
    v_and_b32 v72, v87, v88
    v_and_b32 v73, v87, v89
    v_and_b32 v74, v87, v90
    v_and_b32 v75, v87, v91
    s_nop 1
    v_mfma_f32_16x16x32_bf16 v[100:103], v[72:75], v[156:159], v[100:103]
    v_mfma_f32_16x16x32_bf16 v[104:107], v[72:75], v[188:191], v[104:107]
    s_nop 7
    v_permlane32_swap_b32 v100, v104
    v_permlane32_swap_b32 v101, v105
    v_permlane32_swap_b32 v102, v106
    v_permlane32_swap_b32 v103, v107
    v_add_f32 v92, v104, v100 row_ror:8 row_mask:0xf bank_mask:0xf
    v_add_f32 v94, v105, v101 row_ror:8 row_mask:0xf bank_mask:0xf
    v_add_f32 v96, v106, v102 row_ror:8 row_mask:0xf bank_mask:0xf
    v_add_f32 v98, v107, v103 row_ror:8 row_mask:0xf bank_mask:0xf
    s_mov_b64 exec, s[66:67]
    buffer_store_dwordx4 v[92:95], v108, s[12:15], s78 offen offset:0 sc1
    buffer_store_dwordx4 v[96:99], v108, s[12:15], s78 offen offset:512 sc1
    s_mov_b64 exec, -1
    s_cmp_ge_u32 s38, 2
    s_cbranch_scc1 L_xw2
L_pe17:
    ds_read_b128 v[224:227], v26 offset:48
    s_waitcnt lgkmcnt(0)
    v_min_u32 v224, v224, v225
    v_min3_u32 v224, v224, v226, v227
    s_nop 0
    v_readfirstlane_b32 s3, v224
    s_nop 0
    s_cmp_ge_u32 s3, 17
    s_cbranch_scc1 L_pd17
    s_sleep 3
    s_branch L_pe17
L_pd17:
    s_waitcnt vmcnt(8)
    s_add_u32 m0, s73, 0
    s_mov_b32 s3, 0
    buffer_load_dwordx4 v110, s[16:19], s3 offen offset:0  lds
    buffer_load_dwordx4 v111, s[16:19], s3 offen offset:1024  lds
    s_add_u32 m0, s73, 4096
    s_add_u32 s3, s3, 65536
    buffer_load_dwordx4 v110, s[16:19], s3 offen offset:0  lds
    buffer_load_dwordx4 v111, s[16:19], s3 offen offset:1024  lds
    s_waitcnt vmcnt(8)
    s_add_u32 m0, s73, 8192
    s_mov_b32 s3, 131072
    buffer_load_dwordx4 v110, s[16:19], s3 offen offset:0  lds
    buffer_load_dwordx4 v111, s[16:19], s3 offen offset:1024  lds
    s_add_u32 m0, s73, 12288
    s_add_u32 s3, s3, 65536
    buffer_load_dwordx4 v110, s[16:19], s3 offen offset:0  lds
    buffer_load_dwordx4 v111, s[16:19], s3 offen offset:1024  lds
    s_waitcnt vmcnt(8)
    s_add_u32 m0, s73, 65536
    s_mov_b32 s3, 1048576
    buffer_load_dwordx4 v110, s[16:19], s3 offen offset:0  lds
    buffer_load_dwordx4 v111, s[16:19], s3 offen offset:1024  lds
    s_add_u32 m0, s73, 69632
    s_add_u32 s3, s3, 65536
    buffer_load_dwordx4 v110, s[16:19], s3 offen offset:0  lds
    buffer_load_dwordx4 v111, s[16:19], s3 offen offset:1024  lds
    s_waitcnt vmcnt(8)
    s_add_u32 m0, s73, 73728
    s_mov_b32 s3, 1179648
    buffer_load_dwordx4 v110, s[16:19], s3 offen offset:0  lds
    buffer_load_dwordx4 v111, s[16:19], s3 offen offset:1024  lds
    s_add_u32 m0, s73, 77824
    s_add_u32 s3, s3, 65536
    buffer_load_dwordx4 v110, s[16:19], s3 offen offset:0  lds
    buffer_load_dwordx4 v111, s[16:19], s3 offen offset:1024  lds
    s_waitcnt vmcnt(8)
    s_add_u32 m0, s73, 90112
    s_mov_b32 s3, 1441792
    buffer_load_dwordx4 v110, s[16:19], s3 offen offset:0  lds
    buffer_load_dwordx4 v111, s[16:19], s3 offen offset:1024  lds
    s_add_u32 m0, s73, 94208
    s_add_u32 s3, s3, 65536
    buffer_load_dwordx4 v110, s[16:19], s3 offen offset:0  lds
    buffer_load_dwordx4 v111, s[16:19], s3 offen offset:1024  lds
    s_waitcnt vmcnt(8)
    s_add_u32 m0, s73, 98304
    s_mov_b32 s3, 1572864
    buffer_load_dwordx4 v110, s[16:19], s3 offen offset:0  lds
    buffer_load_dwordx4 v111, s[16:19], s3 offen offset:1024  lds
    s_add_u32 m0, s73, 102400
    s_add_u32 s3, s3, 65536
    buffer_load_dwordx4 v110, s[16:19], s3 offen offset:0  lds
    buffer_load_dwordx4 v111, s[16:19], s3 offen offset:1024  lds
    s_waitcnt vmcnt(8)
    s_add_u32 m0, s73, 106496
    s_mov_b32 s3, 1703936
    buffer_load_dwordx4 v110, s[16:19], s3 offen offset:0  lds
    buffer_load_dwordx4 v111, s[16:19], s3 offen offset:1024  lds
    s_add_u32 m0, s73, 110592
    s_add_u32 s3, s3, 65536
    buffer_load_dwordx4 v110, s[16:19], s3 offen offset:0  lds
    buffer_load_dwordx4 v111, s[16:19], s3 offen offset:1024  lds
    s_waitcnt vmcnt(8)
    s_add_u32 m0, s73, 114688
    s_mov_b32 s3, 1835008
    buffer_load_dwordx4 v110, s[16:19], s3 offen offset:0  lds
    buffer_load_dwordx4 v111, s[16:19], s3 offen offset:1024  lds
    s_add_u32 m0, s73, 118784
    s_add_u32 s3, s3, 65536
    buffer_load_dwordx4 v110, s[16:19], s3 offen offset:0  lds
    buffer_load_dwordx4 v111, s[16:19], s3 offen offset:1024  lds
    s_waitcnt vmcnt(8)
    s_add_u32 m0, s73, 122880
    s_mov_b32 s3, 1966080
    buffer_load_dwordx4 v110, s[16:19], s3 offen offset:0  lds
    buffer_load_dwordx4 v111, s[16:19], s3 offen offset:1024  lds
    s_add_u32 m0, s73, 126976
    s_add_u32 s3, s3, 65536
    buffer_load_dwordx4 v110, s[16:19], s3 offen offset:0  lds
    buffer_load_dwordx4 v111, s[16:19], s3 offen offset:1024  lds
L_pe18:
    ds_read_b128 v[224:227], v26 offset:48
    s_waitcnt lgkmcnt(0)
L_hk5:
    s_cbranch_execz L_hr5
    v_min_u32 v224, v224, v225
    v_min3_u32 v224, v224, v226, v227
    s_nop 0
    v_readfirstlane_b32 s3, v224
    s_nop 0
    s_cmp_ge_u32 s3, 18
    s_cbranch_scc1 L_pd18
    s_sleep 3
    s_branch L_pe18
L_pd18:
    s_waitcnt vmcnt(8)
    s_add_u32 m0, s73, 16384
    s_mov_b32 s3, 262144
    buffer_load_dwordx4 v110, s[16:19], s3 offen offset:0  lds
    buffer_load_dwordx4 v111, s[16:19], s3 offen offset:1024  lds
    s_add_u32 m0, s73, 20480
    s_add_u32 s3, s3, 65536
    buffer_load_dwordx4 v110, s[16:19], s3 offen offset:0  lds
    buffer_load_dwordx4 v111, s[16:19], s3 offen offset:1024  lds
    s_waitcnt vmcnt(8)
    s_add_u32 m0, s73, 24576
    s_mov_b32 s3, 393216
    buffer_load_dwordx4 v110, s[16:19], s3 offen offset:0  lds
    buffer_load_dwordx4 v111, s[16:19], s3 offen offset:1024  lds
    s_add_u32 m0, s73, 28672
    s_add_u32 s3, s3, 65536
    buffer_load_dwordx4 v110, s[16:19], s3 offen offset:0  lds
    buffer_load_dwordx4 v111, s[16:19], s3 offen offset:1024  lds
L_pe19:
    ds_read_b128 v[224:227], v26 offset:48
    s_waitcnt lgkmcnt(0)
    v_min_u32 v224, v224, v225
    v_min3_u32 v224, v224, v226, v227
    s_nop 0
    v_readfirstlane_b32 s3, v224
    s_nop 0
    s_cmp_ge_u32 s3, 19
    s_cbranch_scc1 L_pd19
    s_sleep 3
    s_branch L_pe19
L_pd19:
    s_waitcnt vmcnt(8)
    s_add_u32 m0, s73, 32768
    s_mov_b32 s3, 524288
    buffer_load_dwordx4 v110, s[16:19], s3 offen offset:0  lds
    buffer_load_dwordx4 v111, s[16:19], s3 offen offset:1024  lds
    s_add_u32 m0, s73, 36864
    s_add_u32 s3, s3, 65536
    buffer_load_dwordx4 v110, s[16:19], s3 offen offset:0  lds
    buffer_load_dwordx4 v111, s[16:19], s3 offen offset:1024  lds
    s_waitcnt vmcnt(8)
    s_add_u32 m0, s73, 40960
    s_mov_b32 s3, 655360
    buffer_load_dwordx4 v110, s[16:19], s3 offen offset:0  lds
    buffer_load_dwordx4 v111, s[16:19], s3 offen offset:1024  lds
    s_add_u32 m0, s73, 45056
    s_add_u32 s3, s3, 65536
    buffer_load_dwordx4 v110, s[16:19], s3 offen offset:0  lds
    buffer_load_dwordx4 v111, s[16:19], s3 offen offset:1024  lds
L_pe20:
    ds_read_b128 v[224:227], v26 offset:48
    s_waitcnt lgkmcnt(0)
    v_min_u32 v224, v224, v225
    v_min3_u32 v224, v224, v226, v227
    s_nop 0
    v_readfirstlane_b32 s3, v224
    s_nop 0
    s_cmp_ge_u32 s3, 20
    s_cbranch_scc1 L_pd20
    s_sleep 3
    s_branch L_pe20
L_pd20:
    s_waitcnt vmcnt(8)
    s_add_u32 m0, s73, 49152
    s_mov_b32 s3, 786432
    buffer_load_dwordx4 v110, s[16:19], s3 offen offset:0  lds
    buffer_load_dwordx4 v111, s[16:19], s3 offen offset:1024  lds
    s_add_u32 m0, s73, 53248
    s_add_u32 s3, s3, 65536
    buffer_load_dwordx4 v110, s[16:19], s3 offen offset:0  lds
    buffer_load_dwordx4 v111, s[16:19], s3 offen offset:1024  lds
    s_waitcnt vmcnt(8)
    s_add_u32 m0, s73, 57344
    s_mov_b32 s3, 917504
    buffer_load_dwordx4 v110, s[16:19], s3 offen offset:0  lds
    buffer_load_dwordx4 v111, s[16:19], s3 offen offset:1024  lds
    s_add_u32 m0, s73, 61440
    s_add_u32 s3, s3, 65536
    buffer_load_dwordx4 v110, s[16:19], s3 offen offset:0  lds
    buffer_load_dwordx4 v111, s[16:19], s3 offen offset:1024  lds
    s_waitcnt vmcnt(8)
    s_add_u32 m0, s73, 81920
    s_mov_b32 s3, 1310720
    buffer_load_dwordx4 v110, s[16:19], s3 offen offset:0  lds
    buffer_load_dwordx4 v111, s[16:19], s3 offen offset:1024  lds
    s_add_u32 m0, s73, 86016
    s_add_u32 s3, s3, 65536
    buffer_load_dwordx4 v110, s[16:19], s3 offen offset:0  lds
    buffer_load_dwordx4 v111, s[16:19], s3 offen offset:1024  lds
    s_branch L_join2
L_xw2:
L_es:
    ds_read_b128 v[224:227], v26 offset:80
    s_waitcnt lgkmcnt(0)
L_hk6:
    s_cbranch_execz L_hr6
    v_min_u32 v224, v224, v225
    v_min3_u32 v224, v224, v226, v227
    s_nop 0
    v_readfirstlane_b32 s3, v224
    s_nop 0
    s_cmp_ge_u32 s3, 3
    s_cbranch_scc1 L_esd
    s_sleep 2
    s_branch L_es
L_esd:
    s_setprio 3
    buffer_load_dwordx4 v[36:39], v28, s[12:15], s89 offen offset:0 sc1
    buffer_load_dwordx4 v[40:43], v28, s[12:15], s89 offen offset:256 sc1
    buffer_load_dwordx4 v[44:47], v28, s[12:15], s90 offen offset:0 sc1
    buffer_load_dwordx4 v[48:51], v28, s[12:15], s90 offen offset:256 sc1
    buffer_load_dwordx4 v[52:55], v28, s[12:15], s91 offen offset:0 sc1
    buffer_load_dwordx4 v[56:59], v28, s[12:15], s91 offen offset:256 sc1
    buffer_load_dwordx4 v[60:63], v28, s[12:15], s92 offen offset:0 sc1
    buffer_load_dwordx4 v[64:67], v28, s[12:15], s92 offen offset:256 sc1
    s_waitcnt vmcnt(0)
L_ha:
    v_mfma_f32_16x16x32_bf16 v[120:123], v[112:115], v[36:39], 0
    v_mfma_f32_16x16x32_bf16 v[120:123], v[116:119], v[40:43], v[120:123]
    v_mfma_f32_16x16x32_bf16 v[120:123], v[112:115], v[44:47], v[120:123]
    v_mfma_f32_16x16x32_bf16 v[120:123], v[116:119], v[48:51], v[120:123]
    v_mfma_f32_16x16x32_bf16 v[120:123], v[112:115], v[52:55], v[120:123]
    v_mfma_f32_16x16x32_bf16 v[120:123], v[116:119], v[56:59], v[120:123]
    v_mfma_f32_16x16x32_bf16 v[120:123], v[112:115], v[60:63], v[120:123]
    v_mfma_f32_16x16x32_bf16 v[120:123], v[116:119], v[64:67], v[120:123]
    v_and_b32 v6, v39, v43
    v_or_b32 v7, v39, v43
    v_min3_u32 v6, v6, v47, v51
    v_max3_u32 v7, v7, v47, v51
    v_min3_u32 v6, v6, v55, v59
    v_max3_u32 v7, v7, v55, v59
    v_min3_u32 v6, v6, v63, v67
    v_max3_u32 v7, v7, v63, v67
    v_xor_b32 v6, v6, v18
    v_xor_b32 v7, v7, v18
    v_or_b32 v6, v6, v7
    v_cmp_ne_u32 vcc, 0, v6
    s_nop 0
    s_cmp_eq_u64 vcc, 0
    s_cbranch_scc1 L_haok
    s_add_u32 s70, s70, 1
    s_cmp_ge_u32 s70, 200000
    s_cbranch_scc1 L_haok
    s_sleep 2
    buffer_load_dwordx4 v[36:39], v28, s[12:15], s89 offen offset:0 sc1
    buffer_load_dwordx4 v[40:43], v28, s[12:15], s89 offen offset:256 sc1
    buffer_load_dwordx4 v[44:47], v28, s[12:15], s90 offen offset:0 sc1
    buffer_load_dwordx4 v[48:51], v28, s[12:15], s90 offen offset:256 sc1
    buffer_load_dwordx4 v[52:55], v28, s[12:15], s91 offen offset:0 sc1
    buffer_load_dwordx4 v[56:59], v28, s[12:15], s91 offen offset:256 sc1
    buffer_load_dwordx4 v[60:63], v28, s[12:15], s92 offen offset:0 sc1
    buffer_load_dwordx4 v[64:67], v28, s[12:15], s92 offen offset:256 sc1
    s_waitcnt vmcnt(0)
    s_branch L_ha
L_haok:
    v_cvt_pk_bf16_f32 v6, v120, v121
    v_cvt_pk_bf16_f32 v124, v120, v121
    v_cvt_pk_bf16_f32 v125, v122, v123
    v_permlane16_swap_b32 v6, v126
    s_mov_b64 exec, s[94:95]
    s_cmp_lg_u32 s88, 0
    s_cbranch_scc1 L_hrm
    buffer_store_dwordx4 v[124:127], v29, s[12:15], s68 offen
    s_branch L_hs
L_hrm:
    buffer_store_dwordx4 v[124:127], v29, s[12:15], s68 offen sc1
L_hs:
    s_mov_b64 exec, -1
    buffer_load_dwordx4 v[36:39], v3, s[12:15], s69 offen offset:0 sc1
    buffer_load_dwordx4 v[40:43], v3, s[12:15], s69 offen offset:1024 sc1
    buffer_load_dwordx4 v[44:47], v3, s[12:15], s69 offen offset:2048 sc1
    buffer_load_dwordx4 v[48:51], v3, s[12:15], s69 offen offset:3072 sc1
    buffer_load_dwordx4 v[52:55], v3, s[12:15], s71 offen offset:0 sc1
    buffer_load_dwordx4 v[56:59], v3, s[12:15], s71 offen offset:1024 sc1
    buffer_load_dwordx4 v[60:63], v3, s[12:15], s71 offen offset:2048 sc1
    buffer_load_dwordx4 v[64:67], v3, s[12:15], s71 offen offset:3072 sc1
L_pe119:
    ds_read_b128 v[224:227], v26 offset:48
    s_waitcnt lgkmcnt(0)
L_hk7:
    s_cbranch_execz L_hr7
    v_min_u32 v224, v224, v225
    v_min3_u32 v224, v224, v226, v227
    s_nop 0
    v_readfirstlane_b32 s3, v224
    s_nop 0
    s_cmp_ge_u32 s3, 19
    s_cbranch_scc1 L_pd119
    s_sleep 3
    s_branch L_pe119
L_pd119:
    s_waitcnt vmcnt(0)
L_hb:
    v_and_b32 v6, v39, v43
    v_or_b32 v7, v39, v43
    v_min3_u32 v6, v6, v47, v51
    v_max3_u32 v7, v7, v47, v51
    v_min3_u32 v6, v6, v55, v59
    v_max3_u32 v7, v7, v55, v59
    v_min3_u32 v6, v6, v63, v67
    v_max3_u32 v7, v7, v63, v67
    v_xor_b32 v6, v6, v18
    v_xor_b32 v7, v7, v18
    v_or_b32 v6, v6, v7
    v_cmp_ne_u32 vcc, 0, v6
    s_nop 0
    s_cmp_eq_u64 vcc, 0
    s_cbranch_scc1 L_hbok
    s_add_u32 s70, s70, 1
    s_cmp_ge_u32 s70, 200000
    s_cbranch_scc1 L_hbok
    s_sleep 2
    buffer_load_dwordx4 v[36:39], v3, s[12:15], s69 offen offset:0 sc1
    buffer_load_dwordx4 v[40:43], v3, s[12:15], s69 offen offset:1024 sc1
    buffer_load_dwordx4 v[44:47], v3, s[12:15], s69 offen offset:2048 sc1
    buffer_load_dwordx4 v[48:51], v3, s[12:15], s69 offen offset:3072 sc1
    buffer_load_dwordx4 v[52:55], v3, s[12:15], s71 offen offset:0 sc1
    buffer_load_dwordx4 v[56:59], v3, s[12:15], s71 offen offset:1024 sc1
    buffer_load_dwordx4 v[60:63], v3, s[12:15], s71 offen offset:2048 sc1
    buffer_load_dwordx4 v[64:67], v3, s[12:15], s71 offen offset:3072 sc1
    s_waitcnt vmcnt(0)
    s_branch L_hb
L_hbok:
    ds_write_b64 v30, v[36:37] offset:0
    ds_write_b64 v30, v[40:41] offset:8
    ds_write_b64 v30, v[44:45] offset:1024
    ds_write_b64 v30, v[48:49] offset:1032
    ds_write_b64 v30, v[52:53] offset:2048
    ds_write_b64 v30, v[56:57] offset:2056
    ds_write_b64 v30, v[60:61] offset:3072
    ds_write_b64 v30, v[64:65] offset:3080
    ds_write_b32 v31, v38 offset:0
    ds_write_b32 v31, v42 offset:32
    ds_write_b32 v31, v46 offset:4
    ds_write_b32 v31, v50 offset:36
    ds_write_b32 v31, v54 offset:64
    ds_write_b32 v31, v58 offset:96
    ds_write_b32 v31, v62 offset:68
    ds_write_b32 v31, v66 offset:100
    s_lshl_b32 s3, s38, 2
    s_add_u32 s3, s3, 163096
    v_mov_b32 v5, s3
    v_mov_b32 v6, 1
    ds_write_b32 v5, v6
    s_setprio 0
L_join2:
    v_lshrrev_b32 v5, 2, v1
    v_lshlrev_b32 v5, 10, v5
    v_and_b32 v6, 3, v1
    v_lshl_add_u32 v5, v6, 4, v5
    s_lshr_b32 s3, s2, 2
    s_lshl_b32 s3, s3, 14
    s_and_b32 s65, s2, 3
    s_lshl_b32 s65, s65, 6
    s_add_u32 s3, s3, s65
    s_add_u32 s3, s3, 6291456
    buffer_load_dwordx4 v[52:55], v5, s[12:15], s3 offen offset:0 sc1
    buffer_load_dwordx4 v[56:59], v5, s[12:15], s3 offen offset:512 sc1
    buffer_load_dwordx4 v[60:63], v5, s[12:15], s3 offen offset:256 sc1
    buffer_load_dwordx4 v[64:67], v5, s[12:15], s3 offen offset:768 sc1
    s_waitcnt vmcnt(4)
    s_lshl_b32 s3, s38, 2
    s_add_u32 s3, s3, 163216
    v_mov_b32 v5, s3
    v_mov_b32 v6, 1
    ds_write_b32 v5, v6
    s_waitcnt vmcnt(0)
L_gu:
    v_xor_b32 v6, v53, v18
    v_xor_b32 v7, v55, v18
    v_or_b32 v6, v6, v7
    v_xor_b32 v7, v57, v18
    v_or_b32 v6, v6, v7
    v_xor_b32 v7, v59, v18
    v_or_b32 v6, v6, v7
    v_xor_b32 v7, v61, v18
    v_or_b32 v6, v6, v7
    v_xor_b32 v7, v63, v18
    v_or_b32 v6, v6, v7
    v_xor_b32 v7, v65, v18
    v_or_b32 v6, v6, v7
    v_xor_b32 v7, v67, v18
    v_or_b32 v6, v6, v7
    v_cmp_ne_u32 vcc, 0, v6
    s_nop 0
    s_cmp_eq_u64 vcc, 0
    s_cbranch_scc1 L_guok
    s_add_u32 s70, s70, 1
    s_cmp_ge_u32 s70, 200000
    s_cbranch_scc1 L_guok
    s_sleep 8
    v_lshrrev_b32 v5, 2, v1
    v_lshlrev_b32 v5, 10, v5
    v_and_b32 v6, 3, v1
    v_lshl_add_u32 v5, v6, 4, v5
    s_lshr_b32 s3, s2, 2
    s_lshl_b32 s3, s3, 14
    s_and_b32 s65, s2, 3
    s_lshl_b32 s65, s65, 6
    s_add_u32 s3, s3, s65
    s_add_u32 s3, s3, 6291456
    buffer_load_dwordx4 v[52:55], v5, s[12:15], s3 offen offset:0 sc1
    buffer_load_dwordx4 v[56:59], v5, s[12:15], s3 offen offset:512 sc1
    buffer_load_dwordx4 v[60:63], v5, s[12:15], s3 offen offset:256 sc1
    buffer_load_dwordx4 v[64:67], v5, s[12:15], s3 offen offset:768 sc1
    s_waitcnt vmcnt(0)
    s_branch L_gu
L_guok:
    v_permlane32_swap_b32 v52, v56
    v_permlane32_swap_b32 v54, v58
    v_permlane32_swap_b32 v60, v64
    v_permlane32_swap_b32 v62, v66
    v_add_f32 v52, v52, v56
    v_add_f32 v54, v54, v58
    v_add_f32 v60, v60, v64
    v_add_f32 v62, v62, v66
    v_permlane16_swap_b32 v52, v54
    s_nop 0
    v_permlane16_swap_b32 v60, v62
    v_add_f32 v52, v52, v54
    v_add_f32 v60, v60, v62
    s_nop 0
    v_add_f32 v52, v52, v52 row_ror:4 row_mask:0xf bank_mask:0xf
    v_add_f32 v60, v60, v60 row_ror:4 row_mask:0xf bank_mask:0xf
    s_nop 0
    v_add_f32 v52, v52, v52 row_ror:8 row_mask:0xf bank_mask:0xf
    v_add_f32 v60, v60, v60 row_ror:8 row_mask:0xf bank_mask:0xf
    v_cvt_pk_bf16_f32 v52, v52, v52
    v_lshlrev_b32 v52, 16, v52
    v_cvt_pk_bf16_f32 v60, v60, v60
    v_lshlrev_b32 v60, 16, v60
    v_mul_f32 v53, 0xbfb8aa3b, v52
    v_exp_f32 v53, v53
    s_nop 0
    v_add_f32 v53, 1.0, v53
    v_rcp_f32 v53, v53
    s_nop 0
    v_mul_f32 v52, v52, v53
    v_cvt_pk_bf16_f32 v52, v52, v52
    v_lshlrev_b32 v52, 16, v52
    v_mul_f32 v52, v52, v60
    v_cvt_pk_bf16_f32 v52, v52, v52
    s_nop 1
    v_mov_b32 v80, v52 quad_perm:[0,0,0,0] row_mask:0xf bank_mask:0xf
    v_mov_b32 v81, v52 quad_perm:[1,1,1,1] row_mask:0xf bank_mask:0xf
    v_mov_b32 v82, v52 quad_perm:[2,2,2,2] row_mask:0xf bank_mask:0xf
    v_mov_b32 v83, v52 quad_perm:[3,3,3,3] row_mask:0xf bank_mask:0xf
    s_waitcnt lgkmcnt(0)
    v_and_b32 v92, v80, v88
    v_and_b32 v93, v80, v89
    v_and_b32 v94, v80, v90
    v_and_b32 v95, v80, v91
    s_nop 1
    v_mfma_f32_16x16x32_bf16 v[100:103], v[92:95], v[192:195], 0
    v_mfma_f32_16x16x32_bf16 v[104:107], v[92:95], v[196:199], 0
    v_and_b32 v96, v81, v88
    v_and_b32 v97, v81, v89
    v_and_b32 v98, v81, v90
    v_and_b32 v99, v81, v91
    s_nop 1
    v_mfma_f32_16x16x32_bf16 v[100:103], v[96:99], v[200:203], v[100:103]
    v_mfma_f32_16x16x32_bf16 v[104:107], v[96:99], v[204:207], v[104:107]
    v_and_b32 v92, v82, v88
    v_and_b32 v93, v82, v89
    v_and_b32 v94, v82, v90
    v_and_b32 v95, v82, v91
    s_nop 1
    v_mfma_f32_16x16x32_bf16 v[100:103], v[92:95], v[208:211], v[100:103]
    v_mfma_f32_16x16x32_bf16 v[104:107], v[92:95], v[212:215], v[104:107]
    v_and_b32 v96, v83, v88
    v_and_b32 v97, v83, v89
    v_and_b32 v98, v83, v90
    v_and_b32 v99, v83, v91
    s_nop 1
    v_mfma_f32_16x16x32_bf16 v[100:103], v[96:99], v[216:219], v[100:103]
    v_mfma_f32_16x16x32_bf16 v[104:107], v[96:99], v[220:223], v[104:107]
    v_and_b32 v5, 15, v1
    v_lshlrev_b32 v5, 5, v5
    v_bfe_u32 v6, v1, 4, 1
    v_lshl_add_u32 v5, v6, 4, v5
    v_lshrrev_b32 v6, 5, v1
    v_lshl_add_u32 v5, v6, 9, v5
    v_cmp_eq_u32 vcc, 0, v6
    s_lshl_b32 s3, s2, 12
    s_lshl_b32 s65, s38, 10
    s_add_u32 s3, s3, s65
    s_add_u32 s3, s3, 8388608
    v_cndmask_b32 v100, v104, v100, vcc
    v_cndmask_b32 v101, v105, v101, vcc
    v_cndmask_b32 v102, v106, v102, vcc
    v_cndmask_b32 v103, v107, v103, vcc
    v_mov_b32 v28, v18
    v_lshrrev_b32 v29, 8, v18
    v_lshrrev_b32 v30, 16, v18
    v_lshrrev_b32 v31, 24, v18
    v_mov_b32 v6, 0xff
    v_bfi_b32 v100, v6, v28, v100
    v_bfi_b32 v101, v6, v29, v101
    v_bfi_b32 v102, v6, v30, v102
    v_bfi_b32 v103, v6, v31, v103
    s_cmp_ge_u32 s2, 224
    s_cbranch_scc1 L_noy
    buffer_store_dwordx4 v[100:103], v5, s[12:15], s3 offen sc1
L_noy:
    s_lshl_b32 s3, s38, 7
    s_add_u32 s3, s3, 161280
    v_lshl_add_u32 v6, v249, 2, s3
    ds_read_b32 v112, v6 offset:0
    ds_read_b32 v120, v6 offset:512
    ds_read_b32 v114, v6 offset:32
    ds_read_b32 v122, v6 offset:544
    ds_read_b32 v116, v6 offset:64
    ds_read_b32 v124, v6 offset:576
    ds_read_b32 v118, v6 offset:96
    ds_read_b32 v126, v6 offset:608
    s_mul_i32 s3, s38, 4608
    s_add_u32 s3, s3, 131072
    v_mul_u32_u24 v6, 144, v249
    v_lshl_add_u32 v6, v250, 4, v6
    v_add_u32 v15, s3, v6
    s_mov_b32 s71, 0xbfb8aa3b
    s_waitcnt lgkmcnt(0)
    v_lshlrev_b32 v36, 16, v232
    v_and_b32 v37, 0xffff0000, v232
    v_lshlrev_b32 v38, 16, v233
    v_and_b32 v39, 0xffff0000, v233
    v_lshlrev_b32 v40, 16, v234
    v_and_b32 v41, 0xffff0000, v234
    v_lshlrev_b32 v42, 16, v235
    v_and_b32 v43, 0xffff0000, v235
    v_lshlrev_b32 v44, 16, v236
    v_and_b32 v45, 0xffff0000, v236
    v_lshlrev_b32 v46, 16, v237
    v_and_b32 v47, 0xffff0000, v237
    v_lshlrev_b32 v48, 16, v238
    v_and_b32 v49, 0xffff0000, v238
    v_lshlrev_b32 v50, 16, v239
    v_and_b32 v51, 0xffff0000, v239
    v_lshlrev_b32 v52, 16, v240
    v_and_b32 v53, 0xffff0000, v240
    v_lshlrev_b32 v54, 16, v241
    v_and_b32 v55, 0xffff0000, v241
    v_lshlrev_b32 v56, 16, v242
    v_and_b32 v57, 0xffff0000, v242
    v_lshlrev_b32 v58, 16, v243
    v_and_b32 v59, 0xffff0000, v243
    v_lshlrev_b32 v60, 16, v244
    v_and_b32 v61, 0xffff0000, v244
    v_lshlrev_b32 v62, 16, v245
    v_and_b32 v63, 0xffff0000, v245
    v_lshlrev_b32 v64, 16, v246
    v_and_b32 v65, 0xffff0000, v246
    v_lshlrev_b32 v66, 16, v247
    v_and_b32 v67, 0xffff0000, v247
    v_pk_add_f32 v[68:69], v[36:37], v[112:113] op_sel_hi:[1,0] neg_lo:[0,1] neg_hi:[0,1]
    v_pk_add_f32 v[70:71], v[38:39], v[112:113] op_sel_hi:[1,0] neg_lo:[0,1] neg_hi:[0,1]
    v_pk_add_f32 v[72:73], v[40:41], v[112:113] op_sel_hi:[1,0] neg_lo:[0,1] neg_hi:[0,1]
    v_pk_add_f32 v[74:75], v[42:43], v[112:113] op_sel_hi:[1,0] neg_lo:[0,1] neg_hi:[0,1]
    v_pk_add_f32 v[76:77], v[44:45], v[114:115] op_sel_hi:[1,0] neg_lo:[0,1] neg_hi:[0,1]
    v_pk_add_f32 v[78:79], v[46:47], v[114:115] op_sel_hi:[1,0] neg_lo:[0,1] neg_hi:[0,1]
    v_pk_add_f32 v[80:81], v[48:49], v[114:115] op_sel_hi:[1,0] neg_lo:[0,1] neg_hi:[0,1]
    v_pk_add_f32 v[82:83], v[50:51], v[114:115] op_sel_hi:[1,0] neg_lo:[0,1] neg_hi:[0,1]
    v_pk_add_f32 v[84:85], v[52:53], v[116:117] op_sel_hi:[1,0] neg_lo:[0,1] neg_hi:[0,1]
    v_pk_add_f32 v[86:87], v[54:55], v[116:117] op_sel_hi:[1,0] neg_lo:[0,1] neg_hi:[0,1]
    v_pk_add_f32 v[88:89], v[56:57], v[116:117] op_sel_hi:[1,0] neg_lo:[0,1] neg_hi:[0,1]
    v_pk_add_f32 v[90:91], v[58:59], v[116:117] op_sel_hi:[1,0] neg_lo:[0,1] neg_hi:[0,1]
    v_pk_add_f32 v[92:93], v[60:61], v[118:119] op_sel_hi:[1,0] neg_lo:[0,1] neg_hi:[0,1]
    v_pk_add_f32 v[94:95], v[62:63], v[118:119] op_sel_hi:[1,0] neg_lo:[0,1] neg_hi:[0,1]
    v_pk_add_f32 v[96:97], v[64:65], v[118:119] op_sel_hi:[1,0] neg_lo:[0,1] neg_hi:[0,1]
    v_pk_add_f32 v[98:99], v[66:67], v[118:119] op_sel_hi:[1,0] neg_lo:[0,1] neg_hi:[0,1]
    v_cvt_pk_bf16_f32 v192, v68, v69
    v_cvt_pk_bf16_f32 v193, v70, v71
    v_cvt_pk_bf16_f32 v194, v72, v73
    v_cvt_pk_bf16_f32 v195, v74, v75
    v_cvt_pk_bf16_f32 v196, v76, v77
    v_cvt_pk_bf16_f32 v197, v78, v79
    v_cvt_pk_bf16_f32 v198, v80, v81
    v_cvt_pk_bf16_f32 v199, v82, v83
    v_cvt_pk_bf16_f32 v200, v84, v85
    v_cvt_pk_bf16_f32 v201, v86, v87
    v_cvt_pk_bf16_f32 v202, v88, v89
    v_cvt_pk_bf16_f32 v203, v90, v91
    v_cvt_pk_bf16_f32 v204, v92, v93
    v_cvt_pk_bf16_f32 v205, v94, v95
    v_cvt_pk_bf16_f32 v206, v96, v97
    v_cvt_pk_bf16_f32 v207, v98, v99
    v_lshlrev_b32 v68, 16, v192
    v_and_b32 v69, 0xffff0000, v192
    v_lshlrev_b32 v70, 16, v193
    v_and_b32 v71, 0xffff0000, v193
    v_lshlrev_b32 v72, 16, v194
    v_and_b32 v73, 0xffff0000, v194
    v_lshlrev_b32 v74, 16, v195
    v_and_b32 v75, 0xffff0000, v195
    v_lshlrev_b32 v76, 16, v196
    v_and_b32 v77, 0xffff0000, v196
    v_lshlrev_b32 v78, 16, v197
    v_and_b32 v79, 0xffff0000, v197
    v_lshlrev_b32 v80, 16, v198
    v_and_b32 v81, 0xffff0000, v198
    v_lshlrev_b32 v82, 16, v199
    v_and_b32 v83, 0xffff0000, v199
    v_lshlrev_b32 v84, 16, v200
    v_and_b32 v85, 0xffff0000, v200
    v_lshlrev_b32 v86, 16, v201
    v_and_b32 v87, 0xffff0000, v201
    v_lshlrev_b32 v88, 16, v202
    v_and_b32 v89, 0xffff0000, v202
    v_lshlrev_b32 v90, 16, v203
    v_and_b32 v91, 0xffff0000, v203
    v_lshlrev_b32 v92, 16, v204
    v_and_b32 v93, 0xffff0000, v204
    v_lshlrev_b32 v94, 16, v205
    v_and_b32 v95, 0xffff0000, v205
    v_lshlrev_b32 v96, 16, v206
    v_and_b32 v97, 0xffff0000, v206
    v_lshlrev_b32 v98, 16, v207
    v_and_b32 v99, 0xffff0000, v207
    v_pk_mul_f32 v[68:69], v[68:69], v[120:121] op_sel_hi:[1,0]
    v_pk_mul_f32 v[70:71], v[70:71], v[120:121] op_sel_hi:[1,0]
    v_pk_mul_f32 v[72:73], v[72:73], v[120:121] op_sel_hi:[1,0]
    v_pk_mul_f32 v[74:75], v[74:75], v[120:121] op_sel_hi:[1,0]
    v_pk_mul_f32 v[76:77], v[76:77], v[122:123] op_sel_hi:[1,0]
    v_pk_mul_f32 v[78:79], v[78:79], v[122:123] op_sel_hi:[1,0]
    v_pk_mul_f32 v[80:81], v[80:81], v[122:123] op_sel_hi:[1,0]
    v_pk_mul_f32 v[82:83], v[82:83], v[122:123] op_sel_hi:[1,0]
    v_pk_mul_f32 v[84:85], v[84:85], v[124:125] op_sel_hi:[1,0]
    v_pk_mul_f32 v[86:87], v[86:87], v[124:125] op_sel_hi:[1,0]
    v_pk_mul_f32 v[88:89], v[88:89], v[124:125] op_sel_hi:[1,0]
    v_pk_mul_f32 v[90:91], v[90:91], v[124:125] op_sel_hi:[1,0]
    v_pk_mul_f32 v[92:93], v[92:93], v[126:127] op_sel_hi:[1,0]
    v_pk_mul_f32 v[94:95], v[94:95], v[126:127] op_sel_hi:[1,0]
    v_pk_mul_f32 v[96:97], v[96:97], v[126:127] op_sel_hi:[1,0]
    v_pk_mul_f32 v[98:99], v[98:99], v[126:127] op_sel_hi:[1,0]
    v_cvt_pk_bf16_f32 v192, v68, v69
    v_cvt_pk_bf16_f32 v193, v70, v71
    v_cvt_pk_bf16_f32 v194, v72, v73
    v_cvt_pk_bf16_f32 v195, v74, v75
    v_cvt_pk_bf16_f32 v196, v76, v77
    v_cvt_pk_bf16_f32 v197, v78, v79
    v_cvt_pk_bf16_f32 v198, v80, v81
    v_cvt_pk_bf16_f32 v199, v82, v83
    v_cvt_pk_bf16_f32 v200, v84, v85
    v_cvt_pk_bf16_f32 v201, v86, v87
    v_cvt_pk_bf16_f32 v202, v88, v89
    v_cvt_pk_bf16_f32 v203, v90, v91
    v_cvt_pk_bf16_f32 v204, v92, v93
    v_cvt_pk_bf16_f32 v205, v94, v95
    v_cvt_pk_bf16_f32 v206, v96, v97
    v_cvt_pk_bf16_f32 v207, v98, v99
    v_lshlrev_b32 v68, 16, v192
    v_and_b32 v69, 0xffff0000, v192
    v_lshlrev_b32 v70, 16, v193
    v_and_b32 v71, 0xffff0000, v193
    v_lshlrev_b32 v72, 16, v194
    v_and_b32 v73, 0xffff0000, v194
    v_lshlrev_b32 v74, 16, v195
    v_and_b32 v75, 0xffff0000, v195
    v_lshlrev_b32 v76, 16, v196
    v_and_b32 v77, 0xffff0000, v196
    v_lshlrev_b32 v78, 16, v197
    v_and_b32 v79, 0xffff0000, v197
    v_lshlrev_b32 v80, 16, v198
    v_and_b32 v81, 0xffff0000, v198
    v_lshlrev_b32 v82, 16, v199
    v_and_b32 v83, 0xffff0000, v199
    v_lshlrev_b32 v84, 16, v200
    v_and_b32 v85, 0xffff0000, v200
    v_lshlrev_b32 v86, 16, v201
    v_and_b32 v87, 0xffff0000, v201
    v_lshlrev_b32 v88, 16, v202
    v_and_b32 v89, 0xffff0000, v202
    v_lshlrev_b32 v90, 16, v203
    v_and_b32 v91, 0xffff0000, v203
    v_lshlrev_b32 v92, 16, v204
    v_and_b32 v93, 0xffff0000, v204
    v_lshlrev_b32 v94, 16, v205
    v_and_b32 v95, 0xffff0000, v205
    v_lshlrev_b32 v96, 16, v206
    v_and_b32 v97, 0xffff0000, v206
    v_lshlrev_b32 v98, 16, v207
    v_and_b32 v99, 0xffff0000, v207
    v_mul_f32 v192, s71, v68
    v_mul_f32 v193, s71, v69
    v_mul_f32 v194, s71, v70
    v_mul_f32 v195, s71, v71
    v_mul_f32 v196, s71, v72
    v_mul_f32 v197, s71, v73
    v_mul_f32 v198, s71, v74
    v_mul_f32 v199, s71, v75
    v_mul_f32 v200, s71, v76
    v_mul_f32 v201, s71, v77
    v_mul_f32 v202, s71, v78
    v_mul_f32 v203, s71, v79
    v_mul_f32 v204, s71, v80
    v_mul_f32 v205, s71, v81
    v_mul_f32 v206, s71, v82
    v_mul_f32 v207, s71, v83
    v_mul_f32 v208, s71, v84
    v_mul_f32 v209, s71, v85
    v_mul_f32 v210, s71, v86
    v_mul_f32 v211, s71, v87
    v_mul_f32 v212, s71, v88
    v_mul_f32 v213, s71, v89
    v_mul_f32 v214, s71, v90
    v_mul_f32 v215, s71, v91
    v_mul_f32 v216, s71, v92
    v_mul_f32 v217, s71, v93
    v_mul_f32 v218, s71, v94
    v_mul_f32 v219, s71, v95
    v_mul_f32 v220, s71, v96
    v_mul_f32 v221, s71, v97
    v_mul_f32 v222, s71, v98
    v_mul_f32 v223, s71, v99
    v_exp_f32 v192, v192
    v_exp_f32 v193, v193
    v_exp_f32 v194, v194
    v_exp_f32 v195, v195
    v_exp_f32 v196, v196
    v_exp_f32 v197, v197
    v_exp_f32 v198, v198
    v_exp_f32 v199, v199
    v_exp_f32 v200, v200
    v_exp_f32 v201, v201
    v_exp_f32 v202, v202
    v_exp_f32 v203, v203
    v_exp_f32 v204, v204
    v_exp_f32 v205, v205
    v_exp_f32 v206, v206
    v_exp_f32 v207, v207
    v_exp_f32 v208, v208
    v_exp_f32 v209, v209
    v_exp_f32 v210, v210
    v_exp_f32 v211, v211
    v_exp_f32 v212, v212
    v_exp_f32 v213, v213
    v_exp_f32 v214, v214
    v_exp_f32 v215, v215
    v_exp_f32 v216, v216
    v_exp_f32 v217, v217
    v_exp_f32 v218, v218
    v_exp_f32 v219, v219
    v_exp_f32 v220, v220
    v_exp_f32 v221, v221
    v_exp_f32 v222, v222
    v_exp_f32 v223, v223
    v_add_f32 v192, 1.0, v192
    v_add_f32 v193, 1.0, v193
    v_add_f32 v194, 1.0, v194
    v_add_f32 v195, 1.0, v195
    v_add_f32 v196, 1.0, v196
    v_add_f32 v197, 1.0, v197
    v_add_f32 v198, 1.0, v198
    v_add_f32 v199, 1.0, v199
    v_add_f32 v200, 1.0, v200
    v_add_f32 v201, 1.0, v201
    v_add_f32 v202, 1.0, v202
    v_add_f32 v203, 1.0, v203
    v_add_f32 v204, 1.0, v204
    v_add_f32 v205, 1.0, v205
    v_add_f32 v206, 1.0, v206
    v_add_f32 v207, 1.0, v207
    v_add_f32 v208, 1.0, v208
    v_add_f32 v209, 1.0, v209
    v_add_f32 v210, 1.0, v210
    v_add_f32 v211, 1.0, v211
    v_add_f32 v212, 1.0, v212
    v_add_f32 v213, 1.0, v213
    v_add_f32 v214, 1.0, v214
    v_add_f32 v215, 1.0, v215
    v_add_f32 v216, 1.0, v216
    v_add_f32 v217, 1.0, v217
    v_add_f32 v218, 1.0, v218
    v_add_f32 v219, 1.0, v219
    v_add_f32 v220, 1.0, v220
    v_add_f32 v221, 1.0, v221
    v_add_f32 v222, 1.0, v222
    v_add_f32 v223, 1.0, v223
    v_rcp_f32 v192, v192
    v_rcp_f32 v193, v193
    v_rcp_f32 v194, v194
    v_rcp_f32 v195, v195
    v_rcp_f32 v196, v196
    v_rcp_f32 v197, v197
    v_rcp_f32 v198, v198
    v_rcp_f32 v199, v199
    v_rcp_f32 v200, v200
    v_rcp_f32 v201, v201
    v_rcp_f32 v202, v202
    v_rcp_f32 v203, v203
    v_rcp_f32 v204, v204
    v_rcp_f32 v205, v205
    v_rcp_f32 v206, v206
    v_rcp_f32 v207, v207
    v_rcp_f32 v208, v208
    v_rcp_f32 v209, v209
    v_rcp_f32 v210, v210
    v_rcp_f32 v211, v211
    v_rcp_f32 v212, v212
    v_rcp_f32 v213, v213
    v_rcp_f32 v214, v214
    v_rcp_f32 v215, v215
    v_rcp_f32 v216, v216
    v_rcp_f32 v217, v217
    v_rcp_f32 v218, v218
    v_rcp_f32 v219, v219
    v_rcp_f32 v220, v220
    v_rcp_f32 v221, v221
    v_rcp_f32 v222, v222
    v_rcp_f32 v223, v223
    v_pk_mul_f32 v[68:69], v[68:69], v[192:193]
    v_pk_mul_f32 v[70:71], v[70:71], v[194:195]
    v_pk_mul_f32 v[72:73], v[72:73], v[196:197]
    v_pk_mul_f32 v[74:75], v[74:75], v[198:199]
    v_pk_mul_f32 v[76:77], v[76:77], v[200:201]
    v_pk_mul_f32 v[78:79], v[78:79], v[202:203]
    v_pk_mul_f32 v[80:81], v[80:81], v[204:205]
    v_pk_mul_f32 v[82:83], v[82:83], v[206:207]
    v_pk_mul_f32 v[84:85], v[84:85], v[208:209]
    v_pk_mul_f32 v[86:87], v[86:87], v[210:211]
    v_pk_mul_f32 v[88:89], v[88:89], v[212:213]
    v_pk_mul_f32 v[90:91], v[90:91], v[214:215]
    v_pk_mul_f32 v[92:93], v[92:93], v[216:217]
    v_pk_mul_f32 v[94:95], v[94:95], v[218:219]
    v_pk_mul_f32 v[96:97], v[96:97], v[220:221]
    v_pk_mul_f32 v[98:99], v[98:99], v[222:223]
    s_cmp_eq_u32 s35, 0
    s_cbranch_scc1 L_fin
    s_lshl_b32 s65, s38, 2
    v_lshrrev_b32 v5, 4, v1
    v_add_u32 v5, s65, v5
    v_lshlrev_b32 v5, 12, v5
    v_and_b32 v6, 15, v1
    v_lshl_add_u32 v11, v6, 4, v5
    v_mov_b32 v5, 163104
L_yg:
    ds_read_b32 v6, v5 offset:96
    s_waitcnt lgkmcnt(0)
    v_readfirstlane_b32 s3, v6
    s_nop 0
    s_cmp_eq_u32 s3, 4
    s_cbranch_scc1 L_ygd
    s_sleep 2
    s_branch L_yg
L_ygd:
    s_sleep 10
    s_lshl_b32 s3, s31, 8
    s_add_u32 s3, s3, 8388608
    buffer_load_dwordx4 v[128:131], v11, s[12:15], s3 offen sc1
    s_add_u32 s3, s3, 65536
    buffer_load_dwordx4 v[132:135], v11, s[12:15], s3 offen sc1
    s_add_u32 s3, s3, 65536
    buffer_load_dwordx4 v[136:139], v11, s[12:15], s3 offen sc1
    s_add_u32 s3, s3, 65536
    buffer_load_dwordx4 v[140:143], v11, s[12:15], s3 offen sc1
    s_add_u32 s3, s3, 65536
    buffer_load_dwordx4 v[144:147], v11, s[12:15], s3 offen sc1
    s_add_u32 s3, s3, 65536
    buffer_load_dwordx4 v[148:151], v11, s[12:15], s3 offen sc1
    s_add_u32 s3, s3, 65536
    buffer_load_dwordx4 v[152:155], v11, s[12:15], s3 offen sc1
    s_add_u32 s3, s3, 65536
    buffer_load_dwordx4 v[156:159], v11, s[12:15], s3 offen sc1
    s_add_u32 s3, s3, 65536
    buffer_load_dwordx4 v[160:163], v11, s[12:15], s3 offen sc1
    s_add_u32 s3, s3, 65536
    buffer_load_dwordx4 v[164:167], v11, s[12:15], s3 offen sc1
    s_add_u32 s3, s3, 65536
    buffer_load_dwordx4 v[168:171], v11, s[12:15], s3 offen sc1
    s_add_u32 s3, s3, 65536
    buffer_load_dwordx4 v[172:175], v11, s[12:15], s3 offen sc1
    s_add_u32 s3, s3, 65536
    buffer_load_dwordx4 v[176:179], v11, s[12:15], s3 offen sc1
    s_add_u32 s3, s3, 65536
    buffer_load_dwordx4 v[180:183], v11, s[12:15], s3 offen sc1
    s_lshl_b32 s68, s34, 11
    s_lshl_b32 s3, s31, 7
    s_add_u32 s68, s68, s3
    v_lshlrev_b32 v7, 1, v1
    buffer_load_ushort v8, v7, s[4:7], s68 offen
    s_and_b32 s3, s33, 0xfffff800
    s_xor_b32 s65, s3, 0x80000000
    s_not_b32 s66, s3
    s_and_b32 s66, s66, 0xfffff800
    s_bitcmp1_b32 s3, 31
    s_cselect_b32 s3, s65, s66
    v_mov_b32 v5, s3
    v_cvt_pk_bf16_f32 v5, v5, v5
    v_lshlrev_b32 v5, 16, v5
    v_mul_f32 v5, 0xbfb8aa3b, v5
    v_exp_f32 v5, v5
    s_nop 0
    v_add_f32 v5, 1.0, v5
    v_rcp_f32 v5, v5
    s_nop 0
    v_cvt_pk_bf16_f32 v5, v5, v5
    v_lshlrev_b32 v5, 16, v5
    s_lshl_b32 s65, s64, 16
    s_and_b32 s66, s64, 0xffff0000
    v_rcp_f32 v10, s66
    s_nop 0
    v_fma_f32 v4, -v10, s66, 1.0
    v_fmac_f32 v10, v4, v10
    s_waitcnt vmcnt(0)
L_yf:
    v_and_b32 v184, v128, v132
    v_or_b32 v188, v128, v132
    v_and_b32 v185, v129, v133
    v_or_b32 v189, v129, v133
    v_and_b32 v186, v130, v134
    v_or_b32 v190, v130, v134
    v_and_b32 v187, v131, v135
    v_or_b32 v191, v131, v135
    v_bitop3_b32 v184, v184, v136, v140 bitop3:0x80
    v_or3_b32 v188, v188, v136, v140
    v_bitop3_b32 v185, v185, v137, v141 bitop3:0x80
    v_or3_b32 v189, v189, v137, v141
    v_bitop3_b32 v186, v186, v138, v142 bitop3:0x80
    v_or3_b32 v190, v190, v138, v142
    v_bitop3_b32 v187, v187, v139, v143 bitop3:0x80
    v_or3_b32 v191, v191, v139, v143
    v_bitop3_b32 v184, v184, v144, v148 bitop3:0x80
    v_or3_b32 v188, v188, v144, v148
    v_bitop3_b32 v185, v185, v145, v149 bitop3:0x80
    v_or3_b32 v189, v189, v145, v149
    v_bitop3_b32 v186, v186, v146, v150 bitop3:0x80
    v_or3_b32 v190, v190, v146, v150
    v_bitop3_b32 v187, v187, v147, v151 bitop3:0x80
    v_or3_b32 v191, v191, v147, v151
    v_bitop3_b32 v184, v184, v152, v156 bitop3:0x80
    v_or3_b32 v188, v188, v152, v156
    v_bitop3_b32 v185, v185, v153, v157 bitop3:0x80
    v_or3_b32 v189, v189, v153, v157
    v_bitop3_b32 v186, v186, v154, v158 bitop3:0x80
    v_or3_b32 v190, v190, v154, v158
    v_bitop3_b32 v187, v187, v155, v159 bitop3:0x80
    v_or3_b32 v191, v191, v155, v159
    v_bitop3_b32 v184, v184, v160, v164 bitop3:0x80
    v_or3_b32 v188, v188, v160, v164
    v_bitop3_b32 v185, v185, v161, v165 bitop3:0x80
    v_or3_b32 v189, v189, v161, v165
    v_bitop3_b32 v186, v186, v162, v166 bitop3:0x80
    v_or3_b32 v190, v190, v162, v166
    v_bitop3_b32 v187, v187, v163, v167 bitop3:0x80
    v_or3_b32 v191, v191, v163, v167
    v_bitop3_b32 v184, v184, v168, v172 bitop3:0x80
    v_or3_b32 v188, v188, v168, v172
    v_bitop3_b32 v185, v185, v169, v173 bitop3:0x80
    v_or3_b32 v189, v189, v169, v173
    v_bitop3_b32 v186, v186, v170, v174 bitop3:0x80
    v_or3_b32 v190, v190, v170, v174
    v_bitop3_b32 v187, v187, v171, v175 bitop3:0x80
    v_or3_b32 v191, v191, v171, v175
    v_bitop3_b32 v184, v184, v176, v180 bitop3:0x80
    v_or3_b32 v188, v188, v176, v180
    v_bitop3_b32 v185, v185, v177, v181 bitop3:0x80
    v_or3_b32 v189, v189, v177, v181
    v_bitop3_b32 v186, v186, v178, v182 bitop3:0x80
    v_or3_b32 v190, v190, v178, v182
    v_bitop3_b32 v187, v187, v179, v183 bitop3:0x80
    v_or3_b32 v191, v191, v179, v183
    v_xor_b32 v184, v184, v28
    v_xor_b32 v188, v188, v28
    v_xor_b32 v185, v185, v29
    v_xor_b32 v189, v189, v29
    v_xor_b32 v186, v186, v30
    v_xor_b32 v190, v190, v30
    v_xor_b32 v187, v187, v31
    v_xor_b32 v191, v191, v31
    v_or3_b32 v6, v184, v185, v186
    v_or3_b32 v6, v6, v187, v188
    v_or3_b32 v6, v6, v189, v190
    v_or_b32 v6, v6, v191
    v_and_b32 v6, 0xff, v6
    v_cmp_ne_u32 vcc, 0, v6
    s_nop 0
    s_cmp_eq_u64 vcc, 0
    s_cbranch_scc1 L_yfok
    s_add_u32 s70, s70, 1
    s_cmp_ge_u32 s70, 200000
    s_cbranch_scc1 L_yfok
    s_sleep 16
    s_lshl_b32 s3, s31, 8
    s_add_u32 s3, s3, 8388608
    buffer_load_dwordx4 v[128:131], v11, s[12:15], s3 offen sc1
    s_add_u32 s3, s3, 65536
    buffer_load_dwordx4 v[132:135], v11, s[12:15], s3 offen sc1
    s_add_u32 s3, s3, 65536
    buffer_load_dwordx4 v[136:139], v11, s[12:15], s3 offen sc1
    s_add_u32 s3, s3, 65536
    buffer_load_dwordx4 v[140:143], v11, s[12:15], s3 offen sc1
    s_add_u32 s3, s3, 65536
    buffer_load_dwordx4 v[144:147], v11, s[12:15], s3 offen sc1
    s_add_u32 s3, s3, 65536
    buffer_load_dwordx4 v[148:151], v11, s[12:15], s3 offen sc1
    s_add_u32 s3, s3, 65536
    buffer_load_dwordx4 v[152:155], v11, s[12:15], s3 offen sc1
    s_add_u32 s3, s3, 65536
    buffer_load_dwordx4 v[156:159], v11, s[12:15], s3 offen sc1
    s_add_u32 s3, s3, 65536
    buffer_load_dwordx4 v[160:163], v11, s[12:15], s3 offen sc1
    s_add_u32 s3, s3, 65536
    buffer_load_dwordx4 v[164:167], v11, s[12:15], s3 offen sc1
    s_add_u32 s3, s3, 65536
    buffer_load_dwordx4 v[168:171], v11, s[12:15], s3 offen sc1
    s_add_u32 s3, s3, 65536
    buffer_load_dwordx4 v[172:175], v11, s[12:15], s3 offen sc1
    s_add_u32 s3, s3, 65536
    buffer_load_dwordx4 v[176:179], v11, s[12:15], s3 offen sc1
    s_add_u32 s3, s3, 65536
    buffer_load_dwordx4 v[180:183], v11, s[12:15], s3 offen sc1
    s_waitcnt vmcnt(0)
    s_branch L_yf
L_yfok:
    v_and_b32 v6, 15, v1
    s_mov_b32 s3, 0xffffff00
    v_and_b32 v128, s3, v128
    v_and_b32 v129, s3, v129
    v_and_b32 v130, s3, v130
    v_and_b32 v131, s3, v131
    v_and_b32 v132, s3, v132
    v_and_b32 v133, s3, v133
    v_and_b32 v134, s3, v134
    v_and_b32 v135, s3, v135
    v_and_b32 v136, s3, v136
    v_and_b32 v137, s3, v137
    v_and_b32 v138, s3, v138
    v_and_b32 v139, s3, v139
    v_and_b32 v140, s3, v140
    v_and_b32 v141, s3, v141
    v_and_b32 v142, s3, v142
    v_and_b32 v143, s3, v143
    v_and_b32 v144, s3, v144
    v_and_b32 v145, s3, v145
    v_and_b32 v146, s3, v146
    v_and_b32 v147, s3, v147
    v_and_b32 v148, s3, v148
    v_and_b32 v149, s3, v149
    v_and_b32 v150, s3, v150
    v_and_b32 v151, s3, v151
    v_and_b32 v152, s3, v152
    v_and_b32 v153, s3, v153
    v_and_b32 v154, s3, v154
    v_and_b32 v155, s3, v155
    v_and_b32 v156, s3, v156
    v_and_b32 v157, s3, v157
    v_and_b32 v158, s3, v158
    v_and_b32 v159, s3, v159
    v_and_b32 v160, s3, v160
    v_and_b32 v161, s3, v161
    v_and_b32 v162, s3, v162
    v_and_b32 v163, s3, v163
    v_and_b32 v164, s3, v164
    v_and_b32 v165, s3, v165
    v_and_b32 v166, s3, v166
    v_and_b32 v167, s3, v167
    v_and_b32 v168, s3, v168
    v_and_b32 v169, s3, v169
    v_and_b32 v170, s3, v170
    v_and_b32 v171, s3, v171
    v_and_b32 v172, s3, v172
    v_and_b32 v173, s3, v173
    v_and_b32 v174, s3, v174
    v_and_b32 v175, s3, v175
    v_and_b32 v176, s3, v176
    v_and_b32 v177, s3, v177
    v_and_b32 v178, s3, v178
    v_and_b32 v179, s3, v179
    v_and_b32 v180, s3, v180
    v_and_b32 v181, s3, v181
    v_and_b32 v182, s3, v182
    v_and_b32 v183, s3, v183
    v_pk_add_f32 v[128:129], v[128:129], v[136:137]
    v_pk_add_f32 v[130:131], v[130:131], v[138:139]
    v_pk_add_f32 v[132:133], v[132:133], v[140:141]
    v_pk_add_f32 v[134:135], v[134:135], v[142:143]
    v_pk_add_f32 v[128:129], v[128:129], v[144:145]
    v_pk_add_f32 v[130:131], v[130:131], v[146:147]
    v_pk_add_f32 v[132:133], v[132:133], v[148:149]
    v_pk_add_f32 v[134:135], v[134:135], v[150:151]
    v_pk_add_f32 v[128:129], v[128:129], v[152:153]
    v_pk_add_f32 v[130:131], v[130:131], v[154:155]
    v_pk_add_f32 v[132:133], v[132:133], v[156:157]
    v_pk_add_f32 v[134:135], v[134:135], v[158:159]
    v_pk_add_f32 v[128:129], v[128:129], v[160:161]
    v_pk_add_f32 v[130:131], v[130:131], v[162:163]
    v_pk_add_f32 v[132:133], v[132:133], v[164:165]
    v_pk_add_f32 v[134:135], v[134:135], v[166:167]
    v_pk_add_f32 v[128:129], v[128:129], v[168:169]
    v_pk_add_f32 v[130:131], v[130:131], v[170:171]
    v_pk_add_f32 v[132:133], v[132:133], v[172:173]
    v_pk_add_f32 v[134:135], v[134:135], v[174:175]
    v_pk_add_f32 v[128:129], v[128:129], v[176:177]
    v_pk_add_f32 v[130:131], v[130:131], v[178:179]
    v_pk_add_f32 v[132:133], v[132:133], v[180:181]
    v_pk_add_f32 v[134:135], v[134:135], v[182:183]
    v_pk_add_f32 v[128:129], v[128:129], v[132:133]
    v_pk_add_f32 v[130:131], v[130:131], v[134:135]
    v_mov_b32 v132, v128
    v_mov_b32 v133, v129
    v_mov_b32 v134, v130
    v_mov_b32 v135, v131
    v_permlane16_swap_b32 v128, v132
    v_permlane16_swap_b32 v129, v133
    v_permlane16_swap_b32 v130, v134
    v_permlane16_swap_b32 v131, v135
    v_pk_add_f32 v[128:129], v[128:129], v[132:133]
    v_pk_add_f32 v[130:131], v[130:131], v[134:135]
    v_mov_b32 v132, v128
    v_mov_b32 v133, v129
    v_mov_b32 v134, v130
    v_mov_b32 v135, v131
    v_permlane32_swap_b32 v128, v132
    v_permlane32_swap_b32 v129, v133
    v_permlane32_swap_b32 v130, v134
    v_permlane32_swap_b32 v131, v135
    v_pk_add_f32 v[128:129], v[128:129], v[132:133]
    v_pk_add_f32 v[130:131], v[130:131], v[134:135]
    s_lshl_b32 s3, s38, 8
    s_add_u32 s3, s3, 157952
    v_lshl_add_u32 v6, v6, 4, s3
    ds_write_b128 v6, v[128:131]
    v_lshlrev_b32 v8, 16, v8
    v_subrev_f32 v9, s65, v8
    v_cvt_pk_bf16_f32 v9, v9, v9
    v_lshlrev_b32 v9, 16, v9
    v_mul_f32 v9, v9, v10
    v_cvt_pk_bf16_f32 v9, v9, v9
    v_lshlrev_b32 v9, 16, v9
    v_mov_b32 v16, v5
    s_lshl_b32 s3, s38, 2
    s_add_u32 s3, s3, 163168
    v_mov_b32 v5, s3
    v_mov_b32 v6, 1
    ds_write_b32 v5, v6
    v_mov_b32 v5, 163104
L_yr:
    ds_read_b128 v[20:23], v5 offset:64
    s_waitcnt lgkmcnt(0)
    v_and_b32 v20, v20, v21
    v_and_b32 v22, v22, v23
    v_and_b32 v20, v20, v22
    s_nop 0
    v_readfirstlane_b32 s3, v20
    s_nop 0
    s_cmp_eq_u32 s3, 1
    s_cbranch_scc1 L_yrd
    s_sleep 1
    s_branch L_yr
L_yrd:
    v_lshlrev_b32 v6, 2, v1
    v_add_u32 v6, 157952, v6
    ds_read_b32 v20, v6 offset:0
    ds_read_b32 v21, v6 offset:256
    ds_read_b32 v22, v6 offset:512
    ds_read_b32 v23, v6 offset:768
    s_bfe_u32 s3, s34, 0x20005
    s_and_b32 s65, s34, 7
    s_lshl_b32 s65, s65, 3
    s_lshl_b64 s[66:67], 0xff, s65
    s_bfe_u32 s65, s34, 0x20003
    s_cmp_lg_u32 s3, s38
    s_cbranch_scc1 L_fin
    s_waitcnt lgkmcnt(0)
    v_add_f32 v20, v20, v21
    v_add_f32 v22, v22, v23
    v_add_f32 v20, v20, v22
    v_cvt_pk_bf16_f32 v20, v20, v20
    v_lshlrev_b32 v20, 16, v20
    v_mul_f32 v20, v20, v16
    v_cvt_pk_bf16_f32 v20, v20, v20
    v_lshlrev_b32 v20, 16, v20
    v_add_f32 v20, v20, v9
    v_cvt_pk_bf16_f32 v20, v20, v20
    v_lshlrev_b32 v20, 16, v20
    v_mul_f32 v21, 0xbfb8aa3b, v20
    v_exp_f32 v21, v21
    s_nop 0
    v_add_f32 v21, 1.0, v21
    v_rcp_f32 v21, v21
    s_nop 0
    v_mul_f32 v20, v20, v21
    ds_write_b32 v6, v20 offset:1024
    v_lshlrev_b32 v6, 5, v250
    v_add_u32 v6, 158976, v6
    s_mov_b64 exec, s[66:67]
    s_cmp_lg_u32 s65, 0
    s_cbranch_scc1 L_gr0
    ds_read_b128 v[68:71], v6
    ds_read_b128 v[72:75], v6 offset:16
L_gr0:
    s_cmp_lg_u32 s65, 1
    s_cbranch_scc1 L_gr1
    ds_read_b128 v[76:79], v6
    ds_read_b128 v[80:83], v6 offset:16
L_gr1:
    s_cmp_lg_u32 s65, 2
    s_cbranch_scc1 L_gr2
    ds_read_b128 v[84:87], v6
    ds_read_b128 v[88:91], v6 offset:16
L_gr2:
    s_cmp_lg_u32 s65, 3
    s_cbranch_scc1 L_gr3
    ds_read_b128 v[92:95], v6
    ds_read_b128 v[96:99], v6 offset:16
L_gr3:
    s_mov_b64 exec, -1
L_fin:
    s_waitcnt lgkmcnt(0)
L_pf:
    ds_read_b32 v6, v27 offset:48
    ds_read_b128 v[232:235], v15 offset:0
    ds_read_b128 v[236:239], v15 offset:1152
    ds_read_b128 v[240:243], v15 offset:2304
    ds_read_b128 v[244:247], v15 offset:3456
    s_waitcnt lgkmcnt(4)
    v_readfirstlane_b32 s3, v6
    s_nop 0
    s_cmp_eq_u32 s3, 7
    s_cbranch_scc1 L_pfd
    s_waitcnt lgkmcnt(0)
    s_cmp_eq_u32 s3, 5
    s_cbranch_scc1 L_pf
L_pw:
    s_sleep 3
    ds_read_b32 v6, v27 offset:48
    s_waitcnt lgkmcnt(0)
    v_readfirstlane_b32 s3, v6
    s_nop 0
    s_cmp_ge_u32 s3, 5
    s_cbranch_scc1 L_pf
    s_branch L_pw
L_pfd:
    s_waitcnt lgkmcnt(3)
    v_lshlrev_b32 v192, 16, v232
    v_and_b32 v193, 0xffff0000, v232
    v_lshlrev_b32 v194, 16, v233
    v_and_b32 v195, 0xffff0000, v233
    v_lshlrev_b32 v196, 16, v234
    v_and_b32 v197, 0xffff0000, v234
    v_lshlrev_b32 v198, 16, v235
    v_and_b32 v199, 0xffff0000, v235
    v_pk_fma_f32 v[36:37], v[192:193], v[68:69], v[36:37]
    v_pk_fma_f32 v[38:39], v[194:195], v[70:71], v[38:39]
    v_pk_fma_f32 v[40:41], v[196:197], v[72:73], v[40:41]
    v_pk_fma_f32 v[42:43], v[198:199], v[74:75], v[42:43]
    v_cvt_pk_bf16_f32 v232, v36, v37
    v_cvt_pk_bf16_f32 v233, v38, v39
    v_cvt_pk_bf16_f32 v234, v40, v41
    v_cvt_pk_bf16_f32 v235, v42, v43
    buffer_store_dwordx4 v[232:235], v248, s[24:27], 0 offen nt
    s_waitcnt lgkmcnt(2)
    v_lshlrev_b32 v200, 16, v236
    v_and_b32 v201, 0xffff0000, v236
    v_lshlrev_b32 v202, 16, v237
    v_and_b32 v203, 0xffff0000, v237
    v_lshlrev_b32 v204, 16, v238
    v_and_b32 v205, 0xffff0000, v238
    v_lshlrev_b32 v206, 16, v239
    v_and_b32 v207, 0xffff0000, v239
    v_pk_fma_f32 v[44:45], v[200:201], v[76:77], v[44:45]
    v_pk_fma_f32 v[46:47], v[202:203], v[78:79], v[46:47]
    v_pk_fma_f32 v[48:49], v[204:205], v[80:81], v[48:49]
    v_pk_fma_f32 v[50:51], v[206:207], v[82:83], v[50:51]
    v_cvt_pk_bf16_f32 v236, v44, v45
    v_cvt_pk_bf16_f32 v237, v46, v47
    v_cvt_pk_bf16_f32 v238, v48, v49
    v_cvt_pk_bf16_f32 v239, v50, v51
    buffer_store_dwordx4 v[236:239], v248, s[24:27], s48 offen nt
    s_waitcnt lgkmcnt(1)
    v_lshlrev_b32 v208, 16, v240
    v_and_b32 v209, 0xffff0000, v240
    v_lshlrev_b32 v210, 16, v241
    v_and_b32 v211, 0xffff0000, v241
    v_lshlrev_b32 v212, 16, v242
    v_and_b32 v213, 0xffff0000, v242
    v_lshlrev_b32 v214, 16, v243
    v_and_b32 v215, 0xffff0000, v243
    v_pk_fma_f32 v[52:53], v[208:209], v[84:85], v[52:53]
    v_pk_fma_f32 v[54:55], v[210:211], v[86:87], v[54:55]
    v_pk_fma_f32 v[56:57], v[212:213], v[88:89], v[56:57]
    v_pk_fma_f32 v[58:59], v[214:215], v[90:91], v[58:59]
    v_cvt_pk_bf16_f32 v240, v52, v53
    v_cvt_pk_bf16_f32 v241, v54, v55
    v_cvt_pk_bf16_f32 v242, v56, v57
    v_cvt_pk_bf16_f32 v243, v58, v59
    buffer_store_dwordx4 v[240:243], v248, s[24:27], s49 offen nt
    s_waitcnt lgkmcnt(0)
    v_lshlrev_b32 v216, 16, v244
    v_and_b32 v217, 0xffff0000, v244
    v_lshlrev_b32 v218, 16, v245
    v_and_b32 v219, 0xffff0000, v245
    v_lshlrev_b32 v220, 16, v246
    v_and_b32 v221, 0xffff0000, v246
    v_lshlrev_b32 v222, 16, v247
    v_and_b32 v223, 0xffff0000, v247
    v_pk_fma_f32 v[60:61], v[216:217], v[92:93], v[60:61]
    v_pk_fma_f32 v[62:63], v[218:219], v[94:95], v[62:63]
    v_pk_fma_f32 v[64:65], v[220:221], v[96:97], v[64:65]
    v_pk_fma_f32 v[66:67], v[222:223], v[98:99], v[66:67]
    v_cvt_pk_bf16_f32 v244, v60, v61
    v_cvt_pk_bf16_f32 v245, v62, v63
    v_cvt_pk_bf16_f32 v246, v64, v65
    v_cvt_pk_bf16_f32 v247, v66, v67
    buffer_store_dwordx4 v[244:247], v248, s[24:27], s100 offen nt
L_done:
    s_endpgm
L_g1:
    s_and_b32 s28, s38, 1
    s_lshr_b32 s29, s38, 1
    s_lshl_b32 s3, s36, 7
    s_lshl_b32 s65, s37, 3
    s_add_u32 s3, s3, s65
    s_lshl_b32 s65, s38, 1
    s_add_u32 s68, s3, s65
    s_lshl_b32 s3, s68, 11
    v_and_b32 v3, 31, v1
    v_lshlrev_b32 v3, 4, v3
    v_lshrrev_b32 v4, 5, v1
    v_lshl_add_u32 v5, v4, 11, v3
    s_waitcnt lgkmcnt(0)
    s_mov_b32 s4, s40
    s_mov_b32 s5, s41
    s_mov_b32 s6, 4194304
    s_mov_b32 s7, 0x00020000
    s_mov_b32 s16, s50
    s_mov_b32 s17, s51
    s_mov_b32 s18, 2048
    s_mov_b32 s19, 0x00020000
    v_mov_b32 v224, v5
    v_mov_b32 v225, v3
    s_mov_b32 s69, s3
    buffer_load_dwordx4 v[192:195], v224, s[4:7], s69 offen offset:0
    buffer_load_dwordx4 v[196:199], v224, s[4:7], s69 offen offset:512
    buffer_load_dwordx4 v[200:203], v224, s[4:7], s69 offen offset:1024
    buffer_load_dwordx4 v[204:207], v224, s[4:7], s69 offen offset:1536
    buffer_load_dwordx4 v[208:211], v225, s[16:19], 0 offen offset:0
    buffer_load_dwordx4 v[212:215], v225, s[16:19], 0 offen offset:512
    buffer_load_dwordx4 v[216:219], v225, s[16:19], 0 offen offset:1024
    buffer_load_dwordx4 v[220:223], v225, s[16:19], 0 offen offset:1536
    s_or_b32 s3, s2, s38
    s_cmp_lg_u32 s3, 0
    s_cbranch_scc1 L_nn
    s_mov_b32 s20, s60
    s_mov_b32 s21, s61
    s_mov_b32 s22, 256
    s_mov_b32 s23, 0x00020000
    s_memrealtime s[66:67]
    s_memtime s[70:71]
    s_waitcnt lgkmcnt(0)
    s_lshl_b32 s70, s70, 20
    s_xor_b32 s66, s66, s70
    s_or_b32 s66, s66, 1
    s_and_b32 s66, s66, 0xbfffbfff
    v_mov_b32 v6, s66
    v_mov_b32 v7, 0
    s_mov_b64 exec, 1
    buffer_store_dword v6, v7, s[20:23], 0 offen sc1
    s_mov_b64 exec, -1
L_nn:
    s_getpc_b64 s[66:67]
L_pc:
    s_sub_u32 s66, s66, L_pc-recurrent_scan__linear_kernel_hedgehog__moe_arch_mod__prompt_kernel
    s_subb_u32 s67, s67, 0
    s_lshr_b32 s3, s2, 3
    s_lshl_b32 s3, s3, 2
    s_add_u32 s3, s3, s38
    s_lshl_b32 s3, s3, 6
    s_add_u32 s66, s66, s3
    s_addc_u32 s67, s67, 0
    s_load_dword s71, s[66:67], 0
    s_load_dword s71, s[66:67], 8192
    s_load_dword s71, s[66:67], 16384
    s_load_dword s71, s[66:67], 24576
    s_load_dword s71, s[66:67], 32768
    s_load_dword s71, s[66:67], 40960
    s_mov_b32 s12, s62
    s_mov_b32 s13, s63
    s_mov_b32 s14, 268435456
    s_mov_b32 s15, 0x00020000
    s_mov_b32 s8, s42
    s_mov_b32 s9, s43
    s_mov_b32 s10, 6291456
    s_mov_b32 s11, 0x00020000
    s_mov_b32 s20, s44
    s_mov_b32 s21, s45
    s_mov_b32 s22, 65536
    s_mov_b32 s23, 0x00020000
    s_mov_b32 s24, s58
    s_mov_b32 s25, s59
    s_mov_b32 s26, 4194304
    s_mov_b32 s27, 0x00020000
    s_mov_b32 s80, s52
    s_mov_b32 s81, s53
    s_mov_b32 s82, 0
    s_mov_b32 s83, 0x00020000
    s_mov_b32 s84, s54
    s_mov_b32 s85, s55
    s_mov_b32 s86, 0
    s_mov_b32 s87, 0x00020000
    s_and_b32 s30, s2, 3
    s_lshl_b32 s30, s30, 2
    s_bfe_u32 s3, s2, 0x20003
    s_add_u32 s30, s30, s3
    s_bfe_u32 s31, s2, 0x10002
    s_lshl_b32 s31, s31, 3
    s_lshr_b32 s3, s2, 5
    s_add_u32 s31, s31, s3
    s_mov_b32 s70, 0
    v_and_b32 v3, 15, v1
    v_lshlrev_b32 v6, 7, v3
    s_lshl_b32 s3, s28, 13
    v_add_u32 v6, s3, v6
    v_lshrrev_b32 v3, 1, v3
    v_lshrrev_b32 v2, 4, v1
    v_xor_b32 v3, v3, v2
    v_lshl_add_u32 v168, v3, 4, v6
    v_xor_b32 v3, 4, v3
    v_lshl_add_u32 v169, v3, 4, v6
    v_lshlrev_b32 v6, 3, v2
    v_bfe_u32 v7, v1, 2, 2
    v_add_u32 v6, v6, v7
    v_lshlrev_b32 v6, 7, v6
    v_and_b32 v7, 3, v1
    v_lshl_add_u32 v6, v7, 3, v6
    v_bfe_u32 v7, v1, 3, 2
    s_lshl_b32 s3, s29, 1
    v_xor_b32 v7, s3, v7
    v_add_u32 v6, 65536, v6
    v_lshl_add_u32 v170, v7, 5, v6
    v_xor_b32 v7, 1, v7
    v_lshl_add_u32 v171, v7, 5, v6
    v_add_u32 v189, 65536, v170
    v_add_u32 v191, 65536, v171
    v_mov_b32 v190, v4
    s_lshl_b32 s3, s38, 2
    s_add_u32 s3, s3, 163152
    v_mov_b32 v249, s3
    v_mov_b32 v251, 163072
    v_and_b32 v3, 15, v1
    s_lshl_b32 s3, s28, 8
    s_add_u32 s3, s3, 159744
    v_lshl_add_u32 v240, v3, 2, s3
    v_lshl_add_u32 v241, v1, 2, s3
    v_lshl_add_u32 v242, v2, 4, s3
    s_lshl_b32 s3, s29, 7
    s_add_u32 s3, s3, 162304
    v_lshl_add_u32 v243, v2, 4, s3
    v_lshl_add_u32 v244, v3, 2, s3
    s_lshl_b32 s3, s28, 7
    s_add_u32 s72, s3, 160768
    v_lshl_add_u32 v245, v2, 3, s72
    s_xor_b32 s3, s3, 128
    s_add_u32 s72, s3, 160768
    v_lshl_add_u32 v247, v2, 3, s72
    v_lshrrev_b32 v6, 2, v1
    v_lshlrev_b32 v4, 6, v6
    v_and_b32 v7, 3, v1
    v_lshl_add_u32 v4, v7, 3, v4
    s_lshl_b32 s3, s29, 11
    s_add_u32 s3, s3, 155648
    v_add_u32 v246, s3, v4
    v_mul_u32_u24 v4, 136, v3
    v_lshl_add_u32 v4, v2, 3, v4
    v_mul_u32_u24 v6, 136, v6
    v_lshl_add_u32 v6, v7, 3, v6
    s_lshl_b32 s3, s28, 6
    v_add_u32 v6, s3, v6
    v_lshlrev_b32 v5, 4, v1
    s_mul_i32 s72, s38, 8704
    s_add_u32 s72, s72, 96256
    s_xor_b32 s3, s38, 1
    s_mul_i32 s73, s3, 8704
    s_add_u32 s73, s73, 96256
    s_lshl_b32 s74, s38, 12
    s_add_u32 s74, s74, 65536
    s_lshl_b32 s75, s3, 12
    s_add_u32 s75, s75, 65536
    s_lshl_b32 s76, s3, 2
    s_add_u32 s76, s76, 163184
    s_lshl_b32 s3, s37, 1
    s_add_u32 s3, s3, s29
    s_lshl_b32 s3, s3, 4
    s_add_u32 s3, s3, s36
    s_lshl_b32 s3, s3, 1
    s_add_u32 s3, s3, s28
    s_lshl_b32 s3, s3, 12
    s_add_u32 s77, s3, 2097152
    v_mov_b64 v[8:9], 0
    v_mov_b64 v[10:11], 0
    v_mov_b64 v[12:13], 0
    v_mov_b64 v[14:15], 0
    v_mov_b64 v[16:17], 0
    v_mov_b64 v[18:19], 0
    v_mov_b64 v[20:21], 0
    v_mov_b64 v[22:23], 0
    v_mov_b64 v[24:25], 0
    v_mov_b64 v[26:27], 0
    v_mov_b64 v[28:29], 0
    v_mov_b64 v[30:31], 0
    v_mov_b64 v[32:33], 0
    v_mov_b64 v[34:35], 0
    v_mov_b64 v[36:37], 0
    v_mov_b64 v[38:39], 0
    v_mov_b64 v[40:41], 0
    v_mov_b64 v[42:43], 0
    v_mov_b64 v[44:45], 0
    v_mov_b64 v[46:47], 0
    v_mov_b64 v[48:49], 0
    v_mov_b64 v[50:51], 0
    v_mov_b64 v[52:53], 0
    v_mov_b64 v[54:55], 0
    v_mov_b64 v[56:57], 0
    v_mov_b64 v[58:59], 0
    v_mov_b64 v[60:61], 0
    v_mov_b64 v[62:63], 0
    v_mov_b64 v[64:65], 0
    v_mov_b64 v[66:67], 0
    v_mov_b64 v[68:69], 0
    v_mov_b64 v[70:71], 0
    v_mov_b64 v[72:73], 0
    v_mov_b64 v[74:75], 0
    v_mov_b64 v[76:77], 0
    v_mov_b64 v[78:79], 0
    v_mov_b64 v[80:81], 0
    v_mov_b64 v[82:83], 0
    v_mov_b64 v[84:85], 0
    v_mov_b64 v[86:87], 0
    v_mov_b64 v[88:89], 0
    v_mov_b64 v[90:91], 0
    v_mov_b64 v[92:93], 0
    v_mov_b64 v[94:95], 0
    v_mov_b64 v[96:97], 0
    v_mov_b64 v[98:99], 0
    v_mov_b64 v[100:101], 0
    v_mov_b64 v[102:103], 0
    v_mov_b32 v236, 0x3f803f80
    v_mov_b32 v232, 0
    v_mov_b32 v233, 0
    v_mov_b32 v234, 0
    v_mov_b32 v235, 0
    s_waitcnt vmcnt(0)
    v_dot2_f32_bf16 v232, v192, v236, v232
    v_dot2_f32_bf16 v233, v192, v192, v233
    v_dot2_f32_bf16 v234, v192, v208, v234
    v_dot2_f32_bf16 v235, v208, v236, v235
    v_dot2_f32_bf16 v232, v193, v236, v232
    v_dot2_f32_bf16 v233, v193, v193, v233
    v_dot2_f32_bf16 v234, v193, v209, v234
    v_dot2_f32_bf16 v235, v209, v236, v235
    v_dot2_f32_bf16 v232, v194, v236, v232
    v_dot2_f32_bf16 v233, v194, v194, v233
    v_dot2_f32_bf16 v234, v194, v210, v234
    v_dot2_f32_bf16 v235, v210, v236, v235
    v_dot2_f32_bf16 v232, v195, v236, v232
    v_dot2_f32_bf16 v233, v195, v195, v233
    v_dot2_f32_bf16 v234, v195, v211, v234
    v_dot2_f32_bf16 v235, v211, v236, v235
    v_dot2_f32_bf16 v232, v196, v236, v232
    v_dot2_f32_bf16 v233, v196, v196, v233
    v_dot2_f32_bf16 v234, v196, v212, v234
    v_dot2_f32_bf16 v235, v212, v236, v235
    v_dot2_f32_bf16 v232, v197, v236, v232
    v_dot2_f32_bf16 v233, v197, v197, v233
    v_dot2_f32_bf16 v234, v197, v213, v234
    v_dot2_f32_bf16 v235, v213, v236, v235
    v_dot2_f32_bf16 v232, v198, v236, v232
    v_dot2_f32_bf16 v233, v198, v198, v233
    v_dot2_f32_bf16 v234, v198, v214, v234
    v_dot2_f32_bf16 v235, v214, v236, v235
    v_dot2_f32_bf16 v232, v199, v236, v232
    v_dot2_f32_bf16 v233, v199, v199, v233
    v_dot2_f32_bf16 v234, v199, v215, v234
    v_dot2_f32_bf16 v235, v215, v236, v235
    v_dot2_f32_bf16 v232, v200, v236, v232
    v_dot2_f32_bf16 v233, v200, v200, v233
    v_dot2_f32_bf16 v234, v200, v216, v234
    v_dot2_f32_bf16 v235, v216, v236, v235
    v_dot2_f32_bf16 v232, v201, v236, v232
    v_dot2_f32_bf16 v233, v201, v201, v233
    v_dot2_f32_bf16 v234, v201, v217, v234
    v_dot2_f32_bf16 v235, v217, v236, v235
    v_dot2_f32_bf16 v232, v202, v236, v232
    v_dot2_f32_bf16 v233, v202, v202, v233
    v_dot2_f32_bf16 v234, v202, v218, v234
    v_dot2_f32_bf16 v235, v218, v236, v235
    v_dot2_f32_bf16 v232, v203, v236, v232
    v_dot2_f32_bf16 v233, v203, v203, v233
    v_dot2_f32_bf16 v234, v203, v219, v234
    v_dot2_f32_bf16 v235, v219, v236, v235
    v_dot2_f32_bf16 v232, v204, v236, v232
    v_dot2_f32_bf16 v233, v204, v204, v233
    v_dot2_f32_bf16 v234, v204, v220, v234
    v_dot2_f32_bf16 v235, v220, v236, v235
    v_dot2_f32_bf16 v232, v205, v236, v232
    v_dot2_f32_bf16 v233, v205, v205, v233
    v_dot2_f32_bf16 v234, v205, v221, v234
    v_dot2_f32_bf16 v235, v221, v236, v235
    v_dot2_f32_bf16 v232, v206, v236, v232
    v_dot2_f32_bf16 v233, v206, v206, v233
    v_dot2_f32_bf16 v234, v206, v222, v234
    v_dot2_f32_bf16 v235, v222, v236, v235
    v_dot2_f32_bf16 v232, v207, v236, v232
    v_dot2_f32_bf16 v233, v207, v207, v233
    v_dot2_f32_bf16 v234, v207, v223, v234
    v_dot2_f32_bf16 v235, v223, v236, v235
    v_add_f32 v232, v232, v232 quad_perm:[1,0,3,2] row_mask:0xf bank_mask:0xf
    v_add_f32 v233, v233, v233 quad_perm:[1,0,3,2] row_mask:0xf bank_mask:0xf
    v_add_f32 v234, v234, v234 quad_perm:[1,0,3,2] row_mask:0xf bank_mask:0xf
    v_add_f32 v235, v235, v235 quad_perm:[1,0,3,2] row_mask:0xf bank_mask:0xf
    v_add_f32 v232, v232, v232 quad_perm:[2,3,0,1] row_mask:0xf bank_mask:0xf
    v_add_f32 v233, v233, v233 quad_perm:[2,3,0,1] row_mask:0xf bank_mask:0xf
    v_add_f32 v234, v234, v234 quad_perm:[2,3,0,1] row_mask:0xf bank_mask:0xf
    v_add_f32 v235, v235, v235 quad_perm:[2,3,0,1] row_mask:0xf bank_mask:0xf
    v_add_f32 v232, v232, v232 row_half_mirror row_mask:0xf bank_mask:0xf
    v_add_f32 v233, v233, v233 row_half_mirror row_mask:0xf bank_mask:0xf
    v_add_f32 v234, v234, v234 row_half_mirror row_mask:0xf bank_mask:0xf
    v_add_f32 v235, v235, v235 row_half_mirror row_mask:0xf bank_mask:0xf
    v_add_f32 v232, v232, v232 row_mirror row_mask:0xf bank_mask:0xf
    v_add_f32 v233, v233, v233 row_mirror row_mask:0xf bank_mask:0xf
    v_add_f32 v234, v234, v234 row_mirror row_mask:0xf bank_mask:0xf
    v_add_f32 v235, v235, v235 row_mirror row_mask:0xf bank_mask:0xf
    v_mov_b32 v236, v232
    v_mov_b32 v237, v233
    v_mov_b32 v238, v234
    v_mov_b32 v239, v235
    v_permlane16_swap_b32 v232, v236
    v_permlane16_swap_b32 v233, v237
    v_permlane16_swap_b32 v234, v238
    v_permlane16_swap_b32 v235, v239
    v_add_f32 v232, v232, v236
    v_add_f32 v233, v233, v237
    v_add_f32 v234, v234, v238
    v_add_f32 v235, v235, v239
    v_mul_f32 v232, 0x3a800000, v232
    v_mul_f32 v233, 0x3a800000, v233
    v_fma_f32 v233, -v232, v232, v233
    v_max_f32 v233, 0, v233
    v_cvt_pk_bf16_f32 v232, v232, v232
    v_lshlrev_b32 v232, 16, v232
    v_cvt_pk_bf16_f32 v233, v233, v233
    v_lshlrev_b32 v233, 16, v233
    v_add_f32 v233, 0x3727c5ac, v233
    v_cvt_pk_bf16_f32 v233, v233, v233
    v_lshlrev_b32 v233, 16, v233
    v_sqrt_f32 v233, v233
    v_fma_f32 v234, -v232, v235, v234
    v_cvt_pk_bf16_f32 v233, v233, v233
    v_lshlrev_b32 v233, 16, v233
    v_rcp_f32 v235, v233
    v_lshrrev_b32 v232, 16, v232
    v_or_b32 v232, v232, v233
    v_mul_f32 v234, v234, v235
    v_ashrrev_i32 v235, 31, v234
    v_or_b32 v235, 0x80000000, v235
    v_xor_b32 v234, v234, v235
    v_and_b32 v234, 0xfffff800, v234
    s_sub_u32 s3, 2047, s68
    v_sub_u32 v235, s3, v190
    v_or_b32 v233, v234, v235
    s_lshl_b32 s3, s38, 4
    s_add_u32 s3, s3, 163264
    v_lshl_add_u32 v235, v190, 3, s3
    ds_write_b64 v235, v[232:233]
L_c1:
    s_waitcnt lgkmcnt(0)
    s_barrier
    ds_read_b128 v[104:107], v168 offset:0
    ds_read_b64_tr_b16 v[120:121], v170 offset:0
    ds_read_b64_tr_b16 v[122:123], v170 offset:512
    ds_read_b64_tr_b16 v[124:125], v171 offset:0
    ds_read_b64_tr_b16 v[126:127], v171 offset:512
    ds_read_b128 v[108:111], v168 offset:2048
    ds_read_b64_tr_b16 v[128:129], v170 offset:8192
    ds_read_b64_tr_b16 v[130:131], v170 offset:8704
    ds_read_b64_tr_b16 v[132:133], v171 offset:8192
    ds_read_b64_tr_b16 v[134:135], v171 offset:8704
    ds_read_b64_tr_b16 v[172:173], v189 offset:0
    ds_read_b64_tr_b16 v[174:175], v189 offset:512
    s_waitcnt lgkmcnt(8)
    ds_read_b64_tr_b16 v[176:177], v191 offset:0
    ds_read_b64_tr_b16 v[178:179], v191 offset:512
    ds_read_b128 v[112:115], v168 offset:4096
    ds_read_b128 v[116:119], v168 offset:6144
    s_waitcnt lgkmcnt(0)
    v_mfma_f32_16x16x32_bf16 v[8:11], v[120:123], v[104:107], v[8:11]
    ds_read_b128 v[136:139], v169 offset:0
    v_mfma_f32_16x16x32_bf16 v[12:15], v[124:127], v[104:107], v[12:15]
    ds_read_b64_tr_b16 v[152:153], v170 offset:4096
    v_mfma_f32_16x16x32_bf16 v[16:19], v[104:107], v[128:131], v[16:19]
    ds_read_b64_tr_b16 v[154:155], v170 offset:4608
    v_mfma_f32_16x16x32_bf16 v[20:23], v[104:107], v[132:135], v[20:23]
    ds_read_b64_tr_b16 v[156:157], v171 offset:4096
    v_mfma_f32_16x16x32_bf16 v[72:75], v[172:175], v[104:107], v[72:75]
    ds_read_b64_tr_b16 v[158:159], v171 offset:4608
    v_mfma_f32_16x16x32_bf16 v[76:79], v[176:179], v[104:107], v[76:79]
    ds_read_b128 v[140:143], v169 offset:2048
    v_mfma_f32_16x16x32_bf16 v[24:27], v[120:123], v[108:111], v[24:27]
    ds_read_b64_tr_b16 v[160:161], v170 offset:12288
    v_mfma_f32_16x16x32_bf16 v[28:31], v[124:127], v[108:111], v[28:31]
    ds_read_b64_tr_b16 v[162:163], v170 offset:12800
    v_mfma_f32_16x16x32_bf16 v[32:35], v[108:111], v[128:131], v[32:35]
    ds_read_b64_tr_b16 v[164:165], v171 offset:12288
    v_mfma_f32_16x16x32_bf16 v[36:39], v[108:111], v[132:135], v[36:39]
    ds_read_b64_tr_b16 v[166:167], v171 offset:12800
    v_mfma_f32_16x16x32_bf16 v[80:83], v[172:175], v[108:111], v[80:83]
    ds_read_b64_tr_b16 v[180:181], v189 offset:4096
    v_mfma_f32_16x16x32_bf16 v[84:87], v[176:179], v[108:111], v[84:87]
    ds_read_b64_tr_b16 v[182:183], v189 offset:4608
    v_mfma_f32_16x16x32_bf16 v[40:43], v[120:123], v[112:115], v[40:43]
    ds_read_b64_tr_b16 v[184:185], v191 offset:4096
    v_mfma_f32_16x16x32_bf16 v[44:47], v[124:127], v[112:115], v[44:47]
    ds_read_b64_tr_b16 v[186:187], v191 offset:4608
    v_mfma_f32_16x16x32_bf16 v[48:51], v[112:115], v[128:131], v[48:51]
    ds_read_b128 v[144:147], v169 offset:4096
    v_mfma_f32_16x16x32_bf16 v[52:55], v[112:115], v[132:135], v[52:55]
    ds_read_b128 v[148:151], v169 offset:6144
    v_mfma_f32_16x16x32_bf16 v[88:91], v[172:175], v[112:115], v[88:91]
    v_mfma_f32_16x16x32_bf16 v[92:95], v[176:179], v[112:115], v[92:95]
    v_mfma_f32_16x16x32_bf16 v[56:59], v[120:123], v[116:119], v[56:59]
    v_mfma_f32_16x16x32_bf16 v[60:63], v[124:127], v[116:119], v[60:63]
    v_mfma_f32_16x16x32_bf16 v[64:67], v[116:119], v[128:131], v[64:67]
    v_mfma_f32_16x16x32_bf16 v[68:71], v[116:119], v[132:135], v[68:71]
    v_mfma_f32_16x16x32_bf16 v[96:99], v[172:175], v[116:119], v[96:99]
    v_mfma_f32_16x16x32_bf16 v[100:103], v[176:179], v[116:119], v[100:103]
    s_waitcnt lgkmcnt(0)
    s_barrier
    v_mfma_f32_16x16x32_bf16 v[8:11], v[152:155], v[136:139], v[8:11]
    ds_read_b128 v[104:107], v168 offset:16384
    v_mfma_f32_16x16x32_bf16 v[12:15], v[156:159], v[136:139], v[12:15]
    ds_read_b64_tr_b16 v[120:121], v170 offset:16384
    v_mfma_f32_16x16x32_bf16 v[16:19], v[136:139], v[160:163], v[16:19]
    ds_read_b64_tr_b16 v[122:123], v170 offset:16896
    v_mfma_f32_16x16x32_bf16 v[20:23], v[136:139], v[164:167], v[20:23]
    ds_read_b64_tr_b16 v[124:125], v171 offset:16384
    v_mfma_f32_16x16x32_bf16 v[72:75], v[180:183], v[136:139], v[72:75]
    ds_read_b64_tr_b16 v[126:127], v171 offset:16896
    v_mfma_f32_16x16x32_bf16 v[76:79], v[184:187], v[136:139], v[76:79]
    ds_read_b128 v[108:111], v168 offset:18432
    v_mfma_f32_16x16x32_bf16 v[24:27], v[152:155], v[140:143], v[24:27]
    ds_read_b64_tr_b16 v[128:129], v170 offset:24576
    v_mfma_f32_16x16x32_bf16 v[28:31], v[156:159], v[140:143], v[28:31]
    ds_read_b64_tr_b16 v[130:131], v170 offset:25088
    v_mfma_f32_16x16x32_bf16 v[32:35], v[140:143], v[160:163], v[32:35]
    ds_read_b64_tr_b16 v[132:133], v171 offset:24576
    v_mfma_f32_16x16x32_bf16 v[36:39], v[140:143], v[164:167], v[36:39]
    ds_read_b64_tr_b16 v[134:135], v171 offset:25088
    v_mfma_f32_16x16x32_bf16 v[80:83], v[180:183], v[140:143], v[80:83]
    ds_read_b64_tr_b16 v[172:173], v189 offset:8192
    v_mfma_f32_16x16x32_bf16 v[84:87], v[184:187], v[140:143], v[84:87]
    ds_read_b64_tr_b16 v[174:175], v189 offset:8704
    v_mfma_f32_16x16x32_bf16 v[40:43], v[152:155], v[144:147], v[40:43]
    ds_read_b64_tr_b16 v[176:177], v191 offset:8192
    v_mfma_f32_16x16x32_bf16 v[44:47], v[156:159], v[144:147], v[44:47]
    ds_read_b64_tr_b16 v[178:179], v191 offset:8704
    v_mfma_f32_16x16x32_bf16 v[48:51], v[144:147], v[160:163], v[48:51]
    ds_read_b128 v[112:115], v168 offset:20480
    v_mfma_f32_16x16x32_bf16 v[52:55], v[144:147], v[164:167], v[52:55]
    ds_read_b128 v[116:119], v168 offset:22528
    v_mfma_f32_16x16x32_bf16 v[88:91], v[180:183], v[144:147], v[88:91]
    v_mfma_f32_16x16x32_bf16 v[92:95], v[184:187], v[144:147], v[92:95]
    v_mfma_f32_16x16x32_bf16 v[56:59], v[152:155], v[148:151], v[56:59]
    v_mfma_f32_16x16x32_bf16 v[60:63], v[156:159], v[148:151], v[60:63]
    v_mfma_f32_16x16x32_bf16 v[64:67], v[148:151], v[160:163], v[64:67]
    v_mfma_f32_16x16x32_bf16 v[68:71], v[148:151], v[164:167], v[68:71]
    v_mfma_f32_16x16x32_bf16 v[96:99], v[180:183], v[148:151], v[96:99]
    v_mfma_f32_16x16x32_bf16 v[100:103], v[184:187], v[148:151], v[100:103]
    s_waitcnt lgkmcnt(0)
    v_mfma_f32_16x16x32_bf16 v[8:11], v[120:123], v[104:107], v[8:11]
    ds_read_b128 v[136:139], v169 offset:16384
    v_mfma_f32_16x16x32_bf16 v[12:15], v[124:127], v[104:107], v[12:15]
    ds_read_b64_tr_b16 v[152:153], v170 offset:20480
    v_mfma_f32_16x16x32_bf16 v[16:19], v[104:107], v[128:131], v[16:19]
    ds_read_b64_tr_b16 v[154:155], v170 offset:20992
    v_mfma_f32_16x16x32_bf16 v[20:23], v[104:107], v[132:135], v[20:23]
    ds_read_b64_tr_b16 v[156:157], v171 offset:20480
    v_mfma_f32_16x16x32_bf16 v[72:75], v[172:175], v[104:107], v[72:75]
    ds_read_b64_tr_b16 v[158:159], v171 offset:20992
    v_mfma_f32_16x16x32_bf16 v[76:79], v[176:179], v[104:107], v[76:79]
    ds_read_b128 v[140:143], v169 offset:18432
    v_mfma_f32_16x16x32_bf16 v[24:27], v[120:123], v[108:111], v[24:27]
    ds_read_b64_tr_b16 v[160:161], v170 offset:28672
    v_mfma_f32_16x16x32_bf16 v[28:31], v[124:127], v[108:111], v[28:31]
    ds_read_b64_tr_b16 v[162:163], v170 offset:29184
    v_mfma_f32_16x16x32_bf16 v[32:35], v[108:111], v[128:131], v[32:35]
    ds_read_b64_tr_b16 v[164:165], v171 offset:28672
    v_mfma_f32_16x16x32_bf16 v[36:39], v[108:111], v[132:135], v[36:39]
    ds_read_b64_tr_b16 v[166:167], v171 offset:29184
    v_mfma_f32_16x16x32_bf16 v[80:83], v[172:175], v[108:111], v[80:83]
    ds_read_b64_tr_b16 v[180:181], v189 offset:12288
    v_mfma_f32_16x16x32_bf16 v[84:87], v[176:179], v[108:111], v[84:87]
    ds_read_b64_tr_b16 v[182:183], v189 offset:12800
    v_mfma_f32_16x16x32_bf16 v[40:43], v[120:123], v[112:115], v[40:43]
    ds_read_b64_tr_b16 v[184:185], v191 offset:12288
    v_mfma_f32_16x16x32_bf16 v[44:47], v[124:127], v[112:115], v[44:47]
    ds_read_b64_tr_b16 v[186:187], v191 offset:12800
    v_mfma_f32_16x16x32_bf16 v[48:51], v[112:115], v[128:131], v[48:51]
    ds_read_b128 v[144:147], v169 offset:20480
    v_mfma_f32_16x16x32_bf16 v[52:55], v[112:115], v[132:135], v[52:55]
    ds_read_b128 v[148:151], v169 offset:22528
    v_mfma_f32_16x16x32_bf16 v[88:91], v[172:175], v[112:115], v[88:91]
    v_mfma_f32_16x16x32_bf16 v[92:95], v[176:179], v[112:115], v[92:95]
    v_mfma_f32_16x16x32_bf16 v[56:59], v[120:123], v[116:119], v[56:59]
    v_mfma_f32_16x16x32_bf16 v[60:63], v[124:127], v[116:119], v[60:63]
    v_mfma_f32_16x16x32_bf16 v[64:67], v[116:119], v[128:131], v[64:67]
    v_mfma_f32_16x16x32_bf16 v[68:71], v[116:119], v[132:135], v[68:71]
    v_mfma_f32_16x16x32_bf16 v[96:99], v[172:175], v[116:119], v[96:99]
    v_mfma_f32_16x16x32_bf16 v[100:103], v[176:179], v[116:119], v[100:103]
    s_waitcnt lgkmcnt(0)
    s_barrier
    v_mfma_f32_16x16x32_bf16 v[8:11], v[152:155], v[136:139], v[8:11]
    ds_read_b128 v[104:107], v168 offset:32768
    v_mfma_f32_16x16x32_bf16 v[12:15], v[156:159], v[136:139], v[12:15]
    ds_read_b64_tr_b16 v[120:121], v170 offset:32768
    v_mfma_f32_16x16x32_bf16 v[16:19], v[136:139], v[160:163], v[16:19]
    ds_read_b64_tr_b16 v[122:123], v170 offset:33280
    v_mfma_f32_16x16x32_bf16 v[20:23], v[136:139], v[164:167], v[20:23]
    ds_read_b64_tr_b16 v[124:125], v171 offset:32768
    v_mfma_f32_16x16x32_bf16 v[72:75], v[180:183], v[136:139], v[72:75]
    ds_read_b64_tr_b16 v[126:127], v171 offset:33280
    v_mfma_f32_16x16x32_bf16 v[76:79], v[184:187], v[136:139], v[76:79]
    ds_read_b128 v[108:111], v168 offset:34816
    v_mfma_f32_16x16x32_bf16 v[24:27], v[152:155], v[140:143], v[24:27]
    ds_read_b64_tr_b16 v[128:129], v170 offset:40960
    v_mfma_f32_16x16x32_bf16 v[28:31], v[156:159], v[140:143], v[28:31]
    ds_read_b64_tr_b16 v[130:131], v170 offset:41472
    v_mfma_f32_16x16x32_bf16 v[32:35], v[140:143], v[160:163], v[32:35]
    ds_read_b64_tr_b16 v[132:133], v171 offset:40960
    v_mfma_f32_16x16x32_bf16 v[36:39], v[140:143], v[164:167], v[36:39]
    ds_read_b64_tr_b16 v[134:135], v171 offset:41472
    v_mfma_f32_16x16x32_bf16 v[80:83], v[180:183], v[140:143], v[80:83]
    ds_read_b64_tr_b16 v[172:173], v189 offset:16384
    v_mfma_f32_16x16x32_bf16 v[84:87], v[184:187], v[140:143], v[84:87]
    ds_read_b64_tr_b16 v[174:175], v189 offset:16896
    v_mfma_f32_16x16x32_bf16 v[40:43], v[152:155], v[144:147], v[40:43]
    ds_read_b64_tr_b16 v[176:177], v191 offset:16384
    v_mfma_f32_16x16x32_bf16 v[44:47], v[156:159], v[144:147], v[44:47]
    ds_read_b64_tr_b16 v[178:179], v191 offset:16896
    v_mfma_f32_16x16x32_bf16 v[48:51], v[144:147], v[160:163], v[48:51]
    ds_read_b128 v[112:115], v168 offset:36864
    v_mfma_f32_16x16x32_bf16 v[52:55], v[144:147], v[164:167], v[52:55]
    ds_read_b128 v[116:119], v168 offset:38912
    v_mfma_f32_16x16x32_bf16 v[88:91], v[180:183], v[144:147], v[88:91]
    v_mfma_f32_16x16x32_bf16 v[92:95], v[184:187], v[144:147], v[92:95]
    v_mfma_f32_16x16x32_bf16 v[56:59], v[152:155], v[148:151], v[56:59]
    v_mfma_f32_16x16x32_bf16 v[60:63], v[156:159], v[148:151], v[60:63]
    v_mfma_f32_16x16x32_bf16 v[64:67], v[148:151], v[160:163], v[64:67]
    v_mfma_f32_16x16x32_bf16 v[68:71], v[148:151], v[164:167], v[68:71]
    v_mfma_f32_16x16x32_bf16 v[96:99], v[180:183], v[148:151], v[96:99]
    v_mfma_f32_16x16x32_bf16 v[100:103], v[184:187], v[148:151], v[100:103]
    s_waitcnt lgkmcnt(0)
    v_mfma_f32_16x16x32_bf16 v[8:11], v[120:123], v[104:107], v[8:11]
    ds_read_b128 v[136:139], v169 offset:32768
    v_mfma_f32_16x16x32_bf16 v[12:15], v[124:127], v[104:107], v[12:15]
    ds_read_b64_tr_b16 v[152:153], v170 offset:36864
    v_mfma_f32_16x16x32_bf16 v[16:19], v[104:107], v[128:131], v[16:19]
    ds_read_b64_tr_b16 v[154:155], v170 offset:37376
    v_mfma_f32_16x16x32_bf16 v[20:23], v[104:107], v[132:135], v[20:23]
    ds_read_b64_tr_b16 v[156:157], v171 offset:36864
    v_mfma_f32_16x16x32_bf16 v[72:75], v[172:175], v[104:107], v[72:75]
    ds_read_b64_tr_b16 v[158:159], v171 offset:37376
    v_mfma_f32_16x16x32_bf16 v[76:79], v[176:179], v[104:107], v[76:79]
    ds_read_b128 v[140:143], v169 offset:34816
    v_mfma_f32_16x16x32_bf16 v[24:27], v[120:123], v[108:111], v[24:27]
    ds_read_b64_tr_b16 v[160:161], v170 offset:45056
    v_mfma_f32_16x16x32_bf16 v[28:31], v[124:127], v[108:111], v[28:31]
    ds_read_b64_tr_b16 v[162:163], v170 offset:45568
    v_mfma_f32_16x16x32_bf16 v[32:35], v[108:111], v[128:131], v[32:35]
    ds_read_b64_tr_b16 v[164:165], v171 offset:45056
    v_mfma_f32_16x16x32_bf16 v[36:39], v[108:111], v[132:135], v[36:39]
    ds_read_b64_tr_b16 v[166:167], v171 offset:45568
    v_mfma_f32_16x16x32_bf16 v[80:83], v[172:175], v[108:111], v[80:83]
    ds_read_b64_tr_b16 v[180:181], v189 offset:20480
    v_mfma_f32_16x16x32_bf16 v[84:87], v[176:179], v[108:111], v[84:87]
    ds_read_b64_tr_b16 v[182:183], v189 offset:20992
    v_mfma_f32_16x16x32_bf16 v[40:43], v[120:123], v[112:115], v[40:43]
    ds_read_b64_tr_b16 v[184:185], v191 offset:20480
    v_mfma_f32_16x16x32_bf16 v[44:47], v[124:127], v[112:115], v[44:47]
    ds_read_b64_tr_b16 v[186:187], v191 offset:20992
    v_mfma_f32_16x16x32_bf16 v[48:51], v[112:115], v[128:131], v[48:51]
    ds_read_b128 v[144:147], v169 offset:36864
    v_mfma_f32_16x16x32_bf16 v[52:55], v[112:115], v[132:135], v[52:55]
    ds_read_b128 v[148:151], v169 offset:38912
    v_mfma_f32_16x16x32_bf16 v[88:91], v[172:175], v[112:115], v[88:91]
    v_mfma_f32_16x16x32_bf16 v[92:95], v[176:179], v[112:115], v[92:95]
    v_mfma_f32_16x16x32_bf16 v[56:59], v[120:123], v[116:119], v[56:59]
    v_mfma_f32_16x16x32_bf16 v[60:63], v[124:127], v[116:119], v[60:63]
    v_mfma_f32_16x16x32_bf16 v[64:67], v[116:119], v[128:131], v[64:67]
    v_mfma_f32_16x16x32_bf16 v[68:71], v[116:119], v[132:135], v[68:71]
    v_mfma_f32_16x16x32_bf16 v[96:99], v[172:175], v[116:119], v[96:99]
    v_mfma_f32_16x16x32_bf16 v[100:103], v[176:179], v[116:119], v[100:103]
    s_waitcnt lgkmcnt(0)
    s_barrier
    v_mfma_f32_16x16x32_bf16 v[8:11], v[152:155], v[136:139], v[8:11]
    ds_read_b128 v[104:107], v168 offset:49152
    v_mfma_f32_16x16x32_bf16 v[12:15], v[156:159], v[136:139], v[12:15]
    ds_read_b64_tr_b16 v[120:121], v170 offset:49152
    v_mfma_f32_16x16x32_bf16 v[16:19], v[136:139], v[160:163], v[16:19]
    ds_read_b64_tr_b16 v[122:123], v170 offset:49664
    v_mfma_f32_16x16x32_bf16 v[20:23], v[136:139], v[164:167], v[20:23]
    ds_read_b64_tr_b16 v[124:125], v171 offset:49152
    v_mfma_f32_16x16x32_bf16 v[72:75], v[180:183], v[136:139], v[72:75]
    ds_read_b64_tr_b16 v[126:127], v171 offset:49664
    v_mfma_f32_16x16x32_bf16 v[76:79], v[184:187], v[136:139], v[76:79]
    ds_read_b128 v[108:111], v168 offset:51200
    v_mfma_f32_16x16x32_bf16 v[24:27], v[152:155], v[140:143], v[24:27]
    ds_read_b64_tr_b16 v[128:129], v170 offset:57344
    v_mfma_f32_16x16x32_bf16 v[28:31], v[156:159], v[140:143], v[28:31]
    ds_read_b64_tr_b16 v[130:131], v170 offset:57856
    v_mfma_f32_16x16x32_bf16 v[32:35], v[140:143], v[160:163], v[32:35]
    ds_read_b64_tr_b16 v[132:133], v171 offset:57344
    v_mfma_f32_16x16x32_bf16 v[36:39], v[140:143], v[164:167], v[36:39]
    ds_read_b64_tr_b16 v[134:135], v171 offset:57856
    v_mfma_f32_16x16x32_bf16 v[80:83], v[180:183], v[140:143], v[80:83]
    ds_read_b64_tr_b16 v[172:173], v189 offset:0
    v_mfma_f32_16x16x32_bf16 v[84:87], v[184:187], v[140:143], v[84:87]
    ds_read_b64_tr_b16 v[174:175], v189 offset:512
    v_mfma_f32_16x16x32_bf16 v[40:43], v[152:155], v[144:147], v[40:43]
    ds_read_b64_tr_b16 v[176:177], v191 offset:0
    v_mfma_f32_16x16x32_bf16 v[44:47], v[156:159], v[144:147], v[44:47]
    ds_read_b64_tr_b16 v[178:179], v191 offset:512
    v_mfma_f32_16x16x32_bf16 v[48:51], v[144:147], v[160:163], v[48:51]
    ds_read_b128 v[112:115], v168 offset:53248
    v_mfma_f32_16x16x32_bf16 v[52:55], v[144:147], v[164:167], v[52:55]
    ds_read_b128 v[116:119], v168 offset:55296
    v_mfma_f32_16x16x32_bf16 v[88:91], v[180:183], v[144:147], v[88:91]
    v_mfma_f32_16x16x32_bf16 v[92:95], v[184:187], v[144:147], v[92:95]
    v_mfma_f32_16x16x32_bf16 v[56:59], v[152:155], v[148:151], v[56:59]
    v_mfma_f32_16x16x32_bf16 v[60:63], v[156:159], v[148:151], v[60:63]
    v_mfma_f32_16x16x32_bf16 v[64:67], v[148:151], v[160:163], v[64:67]
    v_mfma_f32_16x16x32_bf16 v[68:71], v[148:151], v[164:167], v[68:71]
    v_mfma_f32_16x16x32_bf16 v[96:99], v[180:183], v[148:151], v[96:99]
    v_mfma_f32_16x16x32_bf16 v[100:103], v[184:187], v[148:151], v[100:103]
    s_waitcnt lgkmcnt(0)
    v_mfma_f32_16x16x32_bf16 v[8:11], v[120:123], v[104:107], v[8:11]
    ds_read_b128 v[136:139], v169 offset:49152
    v_mfma_f32_16x16x32_bf16 v[12:15], v[124:127], v[104:107], v[12:15]
    ds_read_b64_tr_b16 v[152:153], v170 offset:53248
    v_mfma_f32_16x16x32_bf16 v[16:19], v[104:107], v[128:131], v[16:19]
    ds_read_b64_tr_b16 v[154:155], v170 offset:53760
    v_mfma_f32_16x16x32_bf16 v[20:23], v[104:107], v[132:135], v[20:23]
    ds_read_b64_tr_b16 v[156:157], v171 offset:53248
    v_mfma_f32_16x16x32_bf16 v[72:75], v[172:175], v[104:107], v[72:75]
    ds_read_b64_tr_b16 v[158:159], v171 offset:53760
    v_mfma_f32_16x16x32_bf16 v[76:79], v[176:179], v[104:107], v[76:79]
    ds_read_b128 v[140:143], v169 offset:51200
    v_mfma_f32_16x16x32_bf16 v[24:27], v[120:123], v[108:111], v[24:27]
    ds_read_b64_tr_b16 v[160:161], v170 offset:61440
    v_mfma_f32_16x16x32_bf16 v[28:31], v[124:127], v[108:111], v[28:31]
    ds_read_b64_tr_b16 v[162:163], v170 offset:61952
    v_mfma_f32_16x16x32_bf16 v[32:35], v[108:111], v[128:131], v[32:35]
    ds_read_b64_tr_b16 v[164:165], v171 offset:61440
    v_mfma_f32_16x16x32_bf16 v[36:39], v[108:111], v[132:135], v[36:39]
    ds_read_b64_tr_b16 v[166:167], v171 offset:61952
    v_mfma_f32_16x16x32_bf16 v[80:83], v[172:175], v[108:111], v[80:83]
    ds_read_b64_tr_b16 v[180:181], v189 offset:4096
    v_mfma_f32_16x16x32_bf16 v[84:87], v[176:179], v[108:111], v[84:87]
    ds_read_b64_tr_b16 v[182:183], v189 offset:4608
    v_mfma_f32_16x16x32_bf16 v[40:43], v[120:123], v[112:115], v[40:43]
    ds_read_b64_tr_b16 v[184:185], v191 offset:4096
    v_mfma_f32_16x16x32_bf16 v[44:47], v[124:127], v[112:115], v[44:47]
    ds_read_b64_tr_b16 v[186:187], v191 offset:4608
    v_mfma_f32_16x16x32_bf16 v[48:51], v[112:115], v[128:131], v[48:51]
    ds_read_b128 v[144:147], v169 offset:53248
    v_mfma_f32_16x16x32_bf16 v[52:55], v[112:115], v[132:135], v[52:55]
    ds_read_b128 v[148:151], v169 offset:55296
    v_mfma_f32_16x16x32_bf16 v[88:91], v[172:175], v[112:115], v[88:91]
    v_mfma_f32_16x16x32_bf16 v[92:95], v[176:179], v[112:115], v[92:95]
    v_mfma_f32_16x16x32_bf16 v[56:59], v[120:123], v[116:119], v[56:59]
    v_mfma_f32_16x16x32_bf16 v[60:63], v[124:127], v[116:119], v[60:63]
    v_mfma_f32_16x16x32_bf16 v[64:67], v[116:119], v[128:131], v[64:67]
    v_mfma_f32_16x16x32_bf16 v[68:71], v[116:119], v[132:135], v[68:71]
    v_mfma_f32_16x16x32_bf16 v[96:99], v[172:175], v[116:119], v[96:99]
    v_mfma_f32_16x16x32_bf16 v[100:103], v[176:179], v[116:119], v[100:103]
    s_waitcnt lgkmcnt(0)
    s_barrier
    v_mfma_f32_16x16x32_bf16 v[8:11], v[152:155], v[136:139], v[8:11]
    ds_read_b128 v[104:107], v168 offset:0
    v_mfma_f32_16x16x32_bf16 v[12:15], v[156:159], v[136:139], v[12:15]
    ds_read_b64_tr_b16 v[120:121], v170 offset:0
    v_mfma_f32_16x16x32_bf16 v[16:19], v[136:139], v[160:163], v[16:19]
    ds_read_b64_tr_b16 v[122:123], v170 offset:512
    v_mfma_f32_16x16x32_bf16 v[20:23], v[136:139], v[164:167], v[20:23]
    ds_read_b64_tr_b16 v[124:125], v171 offset:0
    v_mfma_f32_16x16x32_bf16 v[72:75], v[180:183], v[136:139], v[72:75]
    ds_read_b64_tr_b16 v[126:127], v171 offset:512
    v_mfma_f32_16x16x32_bf16 v[76:79], v[184:187], v[136:139], v[76:79]
    ds_read_b128 v[108:111], v168 offset:2048
    v_mfma_f32_16x16x32_bf16 v[24:27], v[152:155], v[140:143], v[24:27]
    ds_read_b64_tr_b16 v[128:129], v170 offset:8192
    v_mfma_f32_16x16x32_bf16 v[28:31], v[156:159], v[140:143], v[28:31]
    ds_read_b64_tr_b16 v[130:131], v170 offset:8704
    v_mfma_f32_16x16x32_bf16 v[32:35], v[140:143], v[160:163], v[32:35]
    ds_read_b64_tr_b16 v[132:133], v171 offset:8192
    v_mfma_f32_16x16x32_bf16 v[36:39], v[140:143], v[164:167], v[36:39]
    ds_read_b64_tr_b16 v[134:135], v171 offset:8704
    v_mfma_f32_16x16x32_bf16 v[80:83], v[180:183], v[140:143], v[80:83]
    ds_read_b64_tr_b16 v[172:173], v189 offset:8192
    v_mfma_f32_16x16x32_bf16 v[84:87], v[184:187], v[140:143], v[84:87]
    ds_read_b64_tr_b16 v[174:175], v189 offset:8704
    v_mfma_f32_16x16x32_bf16 v[40:43], v[152:155], v[144:147], v[40:43]
    ds_read_b64_tr_b16 v[176:177], v191 offset:8192
    v_mfma_f32_16x16x32_bf16 v[44:47], v[156:159], v[144:147], v[44:47]
    ds_read_b64_tr_b16 v[178:179], v191 offset:8704
    v_mfma_f32_16x16x32_bf16 v[48:51], v[144:147], v[160:163], v[48:51]
    ds_read_b128 v[112:115], v168 offset:4096
    v_mfma_f32_16x16x32_bf16 v[52:55], v[144:147], v[164:167], v[52:55]
    ds_read_b128 v[116:119], v168 offset:6144
    v_mfma_f32_16x16x32_bf16 v[88:91], v[180:183], v[144:147], v[88:91]
    v_mfma_f32_16x16x32_bf16 v[92:95], v[184:187], v[144:147], v[92:95]
    v_mfma_f32_16x16x32_bf16 v[56:59], v[152:155], v[148:151], v[56:59]
    v_mfma_f32_16x16x32_bf16 v[60:63], v[156:159], v[148:151], v[60:63]
    v_mfma_f32_16x16x32_bf16 v[64:67], v[148:151], v[160:163], v[64:67]
    v_mfma_f32_16x16x32_bf16 v[68:71], v[148:151], v[164:167], v[68:71]
    v_mfma_f32_16x16x32_bf16 v[96:99], v[180:183], v[148:151], v[96:99]
    v_mfma_f32_16x16x32_bf16 v[100:103], v[184:187], v[148:151], v[100:103]
    s_waitcnt lgkmcnt(0)
    v_mfma_f32_16x16x32_bf16 v[8:11], v[120:123], v[104:107], v[8:11]
    ds_read_b128 v[136:139], v169 offset:0
    v_mfma_f32_16x16x32_bf16 v[12:15], v[124:127], v[104:107], v[12:15]
    ds_read_b64_tr_b16 v[152:153], v170 offset:4096
    v_mfma_f32_16x16x32_bf16 v[16:19], v[104:107], v[128:131], v[16:19]
    ds_read_b64_tr_b16 v[154:155], v170 offset:4608
    v_mfma_f32_16x16x32_bf16 v[20:23], v[104:107], v[132:135], v[20:23]
    ds_read_b64_tr_b16 v[156:157], v171 offset:4096
    v_mfma_f32_16x16x32_bf16 v[72:75], v[172:175], v[104:107], v[72:75]
    ds_read_b64_tr_b16 v[158:159], v171 offset:4608
    v_mfma_f32_16x16x32_bf16 v[76:79], v[176:179], v[104:107], v[76:79]
    ds_read_b128 v[140:143], v169 offset:2048
    v_mfma_f32_16x16x32_bf16 v[24:27], v[120:123], v[108:111], v[24:27]
    ds_read_b64_tr_b16 v[160:161], v170 offset:12288
    v_mfma_f32_16x16x32_bf16 v[28:31], v[124:127], v[108:111], v[28:31]
    ds_read_b64_tr_b16 v[162:163], v170 offset:12800
    v_mfma_f32_16x16x32_bf16 v[32:35], v[108:111], v[128:131], v[32:35]
    ds_read_b64_tr_b16 v[164:165], v171 offset:12288
    v_mfma_f32_16x16x32_bf16 v[36:39], v[108:111], v[132:135], v[36:39]
    ds_read_b64_tr_b16 v[166:167], v171 offset:12800
    v_mfma_f32_16x16x32_bf16 v[80:83], v[172:175], v[108:111], v[80:83]
    ds_read_b64_tr_b16 v[180:181], v189 offset:12288
    v_mfma_f32_16x16x32_bf16 v[84:87], v[176:179], v[108:111], v[84:87]
    ds_read_b64_tr_b16 v[182:183], v189 offset:12800
    v_mfma_f32_16x16x32_bf16 v[40:43], v[120:123], v[112:115], v[40:43]
    ds_read_b64_tr_b16 v[184:185], v191 offset:12288
    v_mfma_f32_16x16x32_bf16 v[44:47], v[124:127], v[112:115], v[44:47]
    ds_read_b64_tr_b16 v[186:187], v191 offset:12800
    v_mfma_f32_16x16x32_bf16 v[48:51], v[112:115], v[128:131], v[48:51]
    ds_read_b128 v[144:147], v169 offset:4096
    v_mfma_f32_16x16x32_bf16 v[52:55], v[112:115], v[132:135], v[52:55]
    ds_read_b128 v[148:151], v169 offset:6144
    v_mfma_f32_16x16x32_bf16 v[88:91], v[172:175], v[112:115], v[88:91]
    v_mfma_f32_16x16x32_bf16 v[92:95], v[176:179], v[112:115], v[92:95]
    v_mfma_f32_16x16x32_bf16 v[56:59], v[120:123], v[116:119], v[56:59]
    v_mfma_f32_16x16x32_bf16 v[60:63], v[124:127], v[116:119], v[60:63]
    v_mfma_f32_16x16x32_bf16 v[64:67], v[116:119], v[128:131], v[64:67]
    v_mfma_f32_16x16x32_bf16 v[68:71], v[116:119], v[132:135], v[68:71]
    v_mfma_f32_16x16x32_bf16 v[96:99], v[172:175], v[116:119], v[96:99]
    v_mfma_f32_16x16x32_bf16 v[100:103], v[176:179], v[116:119], v[100:103]
    s_waitcnt lgkmcnt(0)
    s_barrier
    v_mfma_f32_16x16x32_bf16 v[8:11], v[152:155], v[136:139], v[8:11]
    ds_read_b128 v[104:107], v168 offset:16384
    v_mfma_f32_16x16x32_bf16 v[12:15], v[156:159], v[136:139], v[12:15]
    ds_read_b64_tr_b16 v[120:121], v170 offset:16384
    v_mfma_f32_16x16x32_bf16 v[16:19], v[136:139], v[160:163], v[16:19]
    ds_read_b64_tr_b16 v[122:123], v170 offset:16896
    v_mfma_f32_16x16x32_bf16 v[20:23], v[136:139], v[164:167], v[20:23]
    ds_read_b64_tr_b16 v[124:125], v171 offset:16384
    v_mfma_f32_16x16x32_bf16 v[72:75], v[180:183], v[136:139], v[72:75]
    ds_read_b64_tr_b16 v[126:127], v171 offset:16896
    v_mfma_f32_16x16x32_bf16 v[76:79], v[184:187], v[136:139], v[76:79]
    ds_read_b128 v[108:111], v168 offset:18432
    v_mfma_f32_16x16x32_bf16 v[24:27], v[152:155], v[140:143], v[24:27]
    ds_read_b64_tr_b16 v[128:129], v170 offset:24576
    v_mfma_f32_16x16x32_bf16 v[28:31], v[156:159], v[140:143], v[28:31]
    ds_read_b64_tr_b16 v[130:131], v170 offset:25088
    v_mfma_f32_16x16x32_bf16 v[32:35], v[140:143], v[160:163], v[32:35]
    ds_read_b64_tr_b16 v[132:133], v171 offset:24576
    v_mfma_f32_16x16x32_bf16 v[36:39], v[140:143], v[164:167], v[36:39]
    ds_read_b64_tr_b16 v[134:135], v171 offset:25088
    v_mfma_f32_16x16x32_bf16 v[80:83], v[180:183], v[140:143], v[80:83]
    ds_read_b64_tr_b16 v[172:173], v189 offset:16384
    v_mfma_f32_16x16x32_bf16 v[84:87], v[184:187], v[140:143], v[84:87]
    ds_read_b64_tr_b16 v[174:175], v189 offset:16896
    v_mfma_f32_16x16x32_bf16 v[40:43], v[152:155], v[144:147], v[40:43]
    ds_read_b64_tr_b16 v[176:177], v191 offset:16384
    v_mfma_f32_16x16x32_bf16 v[44:47], v[156:159], v[144:147], v[44:47]
    ds_read_b64_tr_b16 v[178:179], v191 offset:16896
    v_mfma_f32_16x16x32_bf16 v[48:51], v[144:147], v[160:163], v[48:51]
    ds_read_b128 v[112:115], v168 offset:20480
    v_mfma_f32_16x16x32_bf16 v[52:55], v[144:147], v[164:167], v[52:55]
    ds_read_b128 v[116:119], v168 offset:22528
    v_mfma_f32_16x16x32_bf16 v[88:91], v[180:183], v[144:147], v[88:91]
    v_mfma_f32_16x16x32_bf16 v[92:95], v[184:187], v[144:147], v[92:95]
    v_mfma_f32_16x16x32_bf16 v[56:59], v[152:155], v[148:151], v[56:59]
    v_mfma_f32_16x16x32_bf16 v[60:63], v[156:159], v[148:151], v[60:63]
    v_mfma_f32_16x16x32_bf16 v[64:67], v[148:151], v[160:163], v[64:67]
    v_mfma_f32_16x16x32_bf16 v[68:71], v[148:151], v[164:167], v[68:71]
    v_mfma_f32_16x16x32_bf16 v[96:99], v[180:183], v[148:151], v[96:99]
    v_mfma_f32_16x16x32_bf16 v[100:103], v[184:187], v[148:151], v[100:103]
    s_waitcnt lgkmcnt(0)
    v_mfma_f32_16x16x32_bf16 v[8:11], v[120:123], v[104:107], v[8:11]
    ds_read_b128 v[136:139], v169 offset:16384
    v_mfma_f32_16x16x32_bf16 v[12:15], v[124:127], v[104:107], v[12:15]
    ds_read_b64_tr_b16 v[152:153], v170 offset:20480
    v_mfma_f32_16x16x32_bf16 v[16:19], v[104:107], v[128:131], v[16:19]
    ds_read_b64_tr_b16 v[154:155], v170 offset:20992
    v_mfma_f32_16x16x32_bf16 v[20:23], v[104:107], v[132:135], v[20:23]
    ds_read_b64_tr_b16 v[156:157], v171 offset:20480
    v_mfma_f32_16x16x32_bf16 v[72:75], v[172:175], v[104:107], v[72:75]
    ds_read_b64_tr_b16 v[158:159], v171 offset:20992
    v_mfma_f32_16x16x32_bf16 v[76:79], v[176:179], v[104:107], v[76:79]
    ds_read_b128 v[140:143], v169 offset:18432
    v_mfma_f32_16x16x32_bf16 v[24:27], v[120:123], v[108:111], v[24:27]
    ds_read_b64_tr_b16 v[160:161], v170 offset:28672
    v_mfma_f32_16x16x32_bf16 v[28:31], v[124:127], v[108:111], v[28:31]
    ds_read_b64_tr_b16 v[162:163], v170 offset:29184
    v_mfma_f32_16x16x32_bf16 v[32:35], v[108:111], v[128:131], v[32:35]
    ds_read_b64_tr_b16 v[164:165], v171 offset:28672
    v_mfma_f32_16x16x32_bf16 v[36:39], v[108:111], v[132:135], v[36:39]
    ds_read_b64_tr_b16 v[166:167], v171 offset:29184
    v_mfma_f32_16x16x32_bf16 v[80:83], v[172:175], v[108:111], v[80:83]
    ds_read_b64_tr_b16 v[180:181], v189 offset:20480
    v_mfma_f32_16x16x32_bf16 v[84:87], v[176:179], v[108:111], v[84:87]
    ds_read_b64_tr_b16 v[182:183], v189 offset:20992
    v_mfma_f32_16x16x32_bf16 v[40:43], v[120:123], v[112:115], v[40:43]
    ds_read_b64_tr_b16 v[184:185], v191 offset:20480
    v_mfma_f32_16x16x32_bf16 v[44:47], v[124:127], v[112:115], v[44:47]
    ds_read_b64_tr_b16 v[186:187], v191 offset:20992
    v_mfma_f32_16x16x32_bf16 v[48:51], v[112:115], v[128:131], v[48:51]
    ds_read_b128 v[144:147], v169 offset:20480
    v_mfma_f32_16x16x32_bf16 v[52:55], v[112:115], v[132:135], v[52:55]
    ds_read_b128 v[148:151], v169 offset:22528
    v_mfma_f32_16x16x32_bf16 v[88:91], v[172:175], v[112:115], v[88:91]
    v_mfma_f32_16x16x32_bf16 v[92:95], v[176:179], v[112:115], v[92:95]
    v_mfma_f32_16x16x32_bf16 v[56:59], v[120:123], v[116:119], v[56:59]
    v_mfma_f32_16x16x32_bf16 v[60:63], v[124:127], v[116:119], v[60:63]
    v_mfma_f32_16x16x32_bf16 v[64:67], v[116:119], v[128:131], v[64:67]
    v_mfma_f32_16x16x32_bf16 v[68:71], v[116:119], v[132:135], v[68:71]
    v_mfma_f32_16x16x32_bf16 v[96:99], v[172:175], v[116:119], v[96:99]
    v_mfma_f32_16x16x32_bf16 v[100:103], v[176:179], v[116:119], v[100:103]
    s_waitcnt lgkmcnt(0)
    s_barrier
    v_mfma_f32_16x16x32_bf16 v[8:11], v[152:155], v[136:139], v[8:11]
    ds_read_b128 v[104:107], v168 offset:32768
    v_mfma_f32_16x16x32_bf16 v[12:15], v[156:159], v[136:139], v[12:15]
    ds_read_b64_tr_b16 v[120:121], v170 offset:32768
    v_mfma_f32_16x16x32_bf16 v[16:19], v[136:139], v[160:163], v[16:19]
    ds_read_b64_tr_b16 v[122:123], v170 offset:33280
    v_mfma_f32_16x16x32_bf16 v[20:23], v[136:139], v[164:167], v[20:23]
    ds_read_b64_tr_b16 v[124:125], v171 offset:32768
    v_mfma_f32_16x16x32_bf16 v[72:75], v[180:183], v[136:139], v[72:75]
    ds_read_b64_tr_b16 v[126:127], v171 offset:33280
    v_mfma_f32_16x16x32_bf16 v[76:79], v[184:187], v[136:139], v[76:79]
    ds_read_b128 v[108:111], v168 offset:34816
    v_mfma_f32_16x16x32_bf16 v[24:27], v[152:155], v[140:143], v[24:27]
    ds_read_b64_tr_b16 v[128:129], v170 offset:40960
    v_mfma_f32_16x16x32_bf16 v[28:31], v[156:159], v[140:143], v[28:31]
    ds_read_b64_tr_b16 v[130:131], v170 offset:41472
    v_mfma_f32_16x16x32_bf16 v[32:35], v[140:143], v[160:163], v[32:35]
    ds_read_b64_tr_b16 v[132:133], v171 offset:40960
    v_mfma_f32_16x16x32_bf16 v[36:39], v[140:143], v[164:167], v[36:39]
    ds_read_b64_tr_b16 v[134:135], v171 offset:41472
    v_mfma_f32_16x16x32_bf16 v[80:83], v[180:183], v[140:143], v[80:83]
    ds_read_b64_tr_b16 v[172:173], v189 offset:0
    v_mfma_f32_16x16x32_bf16 v[84:87], v[184:187], v[140:143], v[84:87]
    ds_read_b64_tr_b16 v[174:175], v189 offset:512
    v_mfma_f32_16x16x32_bf16 v[40:43], v[152:155], v[144:147], v[40:43]
    ds_read_b64_tr_b16 v[176:177], v191 offset:0
    v_mfma_f32_16x16x32_bf16 v[44:47], v[156:159], v[144:147], v[44:47]
    ds_read_b64_tr_b16 v[178:179], v191 offset:512
    v_mfma_f32_16x16x32_bf16 v[48:51], v[144:147], v[160:163], v[48:51]
    ds_read_b128 v[112:115], v168 offset:36864
    v_mfma_f32_16x16x32_bf16 v[52:55], v[144:147], v[164:167], v[52:55]
    ds_read_b128 v[116:119], v168 offset:38912
    v_mfma_f32_16x16x32_bf16 v[88:91], v[180:183], v[144:147], v[88:91]
    v_mfma_f32_16x16x32_bf16 v[92:95], v[184:187], v[144:147], v[92:95]
    v_mfma_f32_16x16x32_bf16 v[56:59], v[152:155], v[148:151], v[56:59]
    v_mfma_f32_16x16x32_bf16 v[60:63], v[156:159], v[148:151], v[60:63]
    v_mfma_f32_16x16x32_bf16 v[64:67], v[148:151], v[160:163], v[64:67]
    v_mfma_f32_16x16x32_bf16 v[68:71], v[148:151], v[164:167], v[68:71]
    v_mfma_f32_16x16x32_bf16 v[96:99], v[180:183], v[148:151], v[96:99]
    v_mfma_f32_16x16x32_bf16 v[100:103], v[184:187], v[148:151], v[100:103]
    s_waitcnt lgkmcnt(0)
    v_mfma_f32_16x16x32_bf16 v[8:11], v[120:123], v[104:107], v[8:11]
    ds_read_b128 v[136:139], v169 offset:32768
    v_mfma_f32_16x16x32_bf16 v[12:15], v[124:127], v[104:107], v[12:15]
    ds_read_b64_tr_b16 v[152:153], v170 offset:36864
    v_mfma_f32_16x16x32_bf16 v[16:19], v[104:107], v[128:131], v[16:19]
    ds_read_b64_tr_b16 v[154:155], v170 offset:37376
    v_mfma_f32_16x16x32_bf16 v[20:23], v[104:107], v[132:135], v[20:23]
    ds_read_b64_tr_b16 v[156:157], v171 offset:36864
    v_mfma_f32_16x16x32_bf16 v[72:75], v[172:175], v[104:107], v[72:75]
    ds_read_b64_tr_b16 v[158:159], v171 offset:37376
    v_mfma_f32_16x16x32_bf16 v[76:79], v[176:179], v[104:107], v[76:79]
    ds_read_b128 v[140:143], v169 offset:34816
    v_mfma_f32_16x16x32_bf16 v[24:27], v[120:123], v[108:111], v[24:27]
    ds_read_b64_tr_b16 v[160:161], v170 offset:45056
    v_mfma_f32_16x16x32_bf16 v[28:31], v[124:127], v[108:111], v[28:31]
    ds_read_b64_tr_b16 v[162:163], v170 offset:45568
    v_mfma_f32_16x16x32_bf16 v[32:35], v[108:111], v[128:131], v[32:35]
    ds_read_b64_tr_b16 v[164:165], v171 offset:45056
    v_mfma_f32_16x16x32_bf16 v[36:39], v[108:111], v[132:135], v[36:39]
    ds_read_b64_tr_b16 v[166:167], v171 offset:45568
    v_mfma_f32_16x16x32_bf16 v[80:83], v[172:175], v[108:111], v[80:83]
    ds_read_b64_tr_b16 v[180:181], v189 offset:4096
    v_mfma_f32_16x16x32_bf16 v[84:87], v[176:179], v[108:111], v[84:87]
    ds_read_b64_tr_b16 v[182:183], v189 offset:4608
    v_mfma_f32_16x16x32_bf16 v[40:43], v[120:123], v[112:115], v[40:43]
    ds_read_b64_tr_b16 v[184:185], v191 offset:4096
    v_mfma_f32_16x16x32_bf16 v[44:47], v[124:127], v[112:115], v[44:47]
    ds_read_b64_tr_b16 v[186:187], v191 offset:4608
    v_mfma_f32_16x16x32_bf16 v[48:51], v[112:115], v[128:131], v[48:51]
    ds_read_b128 v[144:147], v169 offset:36864
    v_mfma_f32_16x16x32_bf16 v[52:55], v[112:115], v[132:135], v[52:55]
    ds_read_b128 v[148:151], v169 offset:38912
    v_mfma_f32_16x16x32_bf16 v[88:91], v[172:175], v[112:115], v[88:91]
    v_mfma_f32_16x16x32_bf16 v[92:95], v[176:179], v[112:115], v[92:95]
    v_mfma_f32_16x16x32_bf16 v[56:59], v[120:123], v[116:119], v[56:59]
    v_mfma_f32_16x16x32_bf16 v[60:63], v[124:127], v[116:119], v[60:63]
    v_mfma_f32_16x16x32_bf16 v[64:67], v[116:119], v[128:131], v[64:67]
    v_mfma_f32_16x16x32_bf16 v[68:71], v[116:119], v[132:135], v[68:71]
    v_mfma_f32_16x16x32_bf16 v[96:99], v[172:175], v[116:119], v[96:99]
    v_mfma_f32_16x16x32_bf16 v[100:103], v[176:179], v[116:119], v[100:103]
    s_waitcnt lgkmcnt(0)
    s_barrier
    v_mfma_f32_16x16x32_bf16 v[8:11], v[152:155], v[136:139], v[8:11]
    ds_read_b128 v[104:107], v168 offset:49152
    v_mfma_f32_16x16x32_bf16 v[12:15], v[156:159], v[136:139], v[12:15]
    ds_read_b64_tr_b16 v[120:121], v170 offset:49152
    v_mfma_f32_16x16x32_bf16 v[16:19], v[136:139], v[160:163], v[16:19]
    ds_read_b64_tr_b16 v[122:123], v170 offset:49664
    v_mfma_f32_16x16x32_bf16 v[20:23], v[136:139], v[164:167], v[20:23]
    ds_read_b64_tr_b16 v[124:125], v171 offset:49152
    v_mfma_f32_16x16x32_bf16 v[72:75], v[180:183], v[136:139], v[72:75]
    ds_read_b64_tr_b16 v[126:127], v171 offset:49664
    v_mfma_f32_16x16x32_bf16 v[76:79], v[184:187], v[136:139], v[76:79]
    ds_read_b128 v[108:111], v168 offset:51200
    v_mfma_f32_16x16x32_bf16 v[24:27], v[152:155], v[140:143], v[24:27]
    ds_read_b64_tr_b16 v[128:129], v170 offset:57344
    v_mfma_f32_16x16x32_bf16 v[28:31], v[156:159], v[140:143], v[28:31]
    ds_read_b64_tr_b16 v[130:131], v170 offset:57856
    v_mfma_f32_16x16x32_bf16 v[32:35], v[140:143], v[160:163], v[32:35]
    ds_read_b64_tr_b16 v[132:133], v171 offset:57344
    v_mfma_f32_16x16x32_bf16 v[36:39], v[140:143], v[164:167], v[36:39]
    ds_read_b64_tr_b16 v[134:135], v171 offset:57856
    v_mfma_f32_16x16x32_bf16 v[80:83], v[180:183], v[140:143], v[80:83]
    ds_read_b64_tr_b16 v[172:173], v189 offset:8192
    v_mfma_f32_16x16x32_bf16 v[84:87], v[184:187], v[140:143], v[84:87]
    ds_read_b64_tr_b16 v[174:175], v189 offset:8704
    v_mfma_f32_16x16x32_bf16 v[40:43], v[152:155], v[144:147], v[40:43]
    ds_read_b64_tr_b16 v[176:177], v191 offset:8192
    v_mfma_f32_16x16x32_bf16 v[44:47], v[156:159], v[144:147], v[44:47]
    ds_read_b64_tr_b16 v[178:179], v191 offset:8704
    v_mfma_f32_16x16x32_bf16 v[48:51], v[144:147], v[160:163], v[48:51]
    ds_read_b128 v[112:115], v168 offset:53248
    v_mfma_f32_16x16x32_bf16 v[52:55], v[144:147], v[164:167], v[52:55]
    ds_read_b128 v[116:119], v168 offset:55296
    v_mfma_f32_16x16x32_bf16 v[88:91], v[180:183], v[144:147], v[88:91]
    v_mfma_f32_16x16x32_bf16 v[92:95], v[184:187], v[144:147], v[92:95]
    v_mfma_f32_16x16x32_bf16 v[56:59], v[152:155], v[148:151], v[56:59]
    v_mfma_f32_16x16x32_bf16 v[60:63], v[156:159], v[148:151], v[60:63]
    v_mfma_f32_16x16x32_bf16 v[64:67], v[148:151], v[160:163], v[64:67]
    v_mfma_f32_16x16x32_bf16 v[68:71], v[148:151], v[164:167], v[68:71]
    v_mfma_f32_16x16x32_bf16 v[96:99], v[180:183], v[148:151], v[96:99]
    v_mfma_f32_16x16x32_bf16 v[100:103], v[184:187], v[148:151], v[100:103]
    s_waitcnt lgkmcnt(0)
    v_mfma_f32_16x16x32_bf16 v[8:11], v[120:123], v[104:107], v[8:11]
    ds_read_b128 v[136:139], v169 offset:49152
    v_mfma_f32_16x16x32_bf16 v[12:15], v[124:127], v[104:107], v[12:15]
    ds_read_b64_tr_b16 v[152:153], v170 offset:53248
    v_mfma_f32_16x16x32_bf16 v[16:19], v[104:107], v[128:131], v[16:19]
    ds_read_b64_tr_b16 v[154:155], v170 offset:53760
    v_mfma_f32_16x16x32_bf16 v[20:23], v[104:107], v[132:135], v[20:23]
    ds_read_b64_tr_b16 v[156:157], v171 offset:53248
    v_mfma_f32_16x16x32_bf16 v[72:75], v[172:175], v[104:107], v[72:75]
    ds_read_b64_tr_b16 v[158:159], v171 offset:53760
    v_mfma_f32_16x16x32_bf16 v[76:79], v[176:179], v[104:107], v[76:79]
    ds_read_b128 v[140:143], v169 offset:51200
    v_mfma_f32_16x16x32_bf16 v[24:27], v[120:123], v[108:111], v[24:27]
    ds_read_b64_tr_b16 v[160:161], v170 offset:61440
    v_mfma_f32_16x16x32_bf16 v[28:31], v[124:127], v[108:111], v[28:31]
    ds_read_b64_tr_b16 v[162:163], v170 offset:61952
    v_mfma_f32_16x16x32_bf16 v[32:35], v[108:111], v[128:131], v[32:35]
    ds_read_b64_tr_b16 v[164:165], v171 offset:61440
    v_mfma_f32_16x16x32_bf16 v[36:39], v[108:111], v[132:135], v[36:39]
    ds_read_b64_tr_b16 v[166:167], v171 offset:61952
    v_mfma_f32_16x16x32_bf16 v[80:83], v[172:175], v[108:111], v[80:83]
    ds_read_b64_tr_b16 v[180:181], v189 offset:12288
    v_mfma_f32_16x16x32_bf16 v[84:87], v[176:179], v[108:111], v[84:87]
    ds_read_b64_tr_b16 v[182:183], v189 offset:12800
    v_mfma_f32_16x16x32_bf16 v[40:43], v[120:123], v[112:115], v[40:43]
    ds_read_b64_tr_b16 v[184:185], v191 offset:12288
    v_mfma_f32_16x16x32_bf16 v[44:47], v[124:127], v[112:115], v[44:47]
    ds_read_b64_tr_b16 v[186:187], v191 offset:12800
    v_mfma_f32_16x16x32_bf16 v[48:51], v[112:115], v[128:131], v[48:51]
    ds_read_b128 v[144:147], v169 offset:53248
    v_mfma_f32_16x16x32_bf16 v[52:55], v[112:115], v[132:135], v[52:55]
    ds_read_b128 v[148:151], v169 offset:55296
    v_mfma_f32_16x16x32_bf16 v[88:91], v[172:175], v[112:115], v[88:91]
    v_mfma_f32_16x16x32_bf16 v[92:95], v[176:179], v[112:115], v[92:95]
    v_mfma_f32_16x16x32_bf16 v[56:59], v[120:123], v[116:119], v[56:59]
    v_mfma_f32_16x16x32_bf16 v[60:63], v[124:127], v[116:119], v[60:63]
    v_mfma_f32_16x16x32_bf16 v[64:67], v[116:119], v[128:131], v[64:67]
    v_mfma_f32_16x16x32_bf16 v[68:71], v[116:119], v[132:135], v[68:71]
    v_mfma_f32_16x16x32_bf16 v[96:99], v[172:175], v[116:119], v[96:99]
    v_mfma_f32_16x16x32_bf16 v[100:103], v[176:179], v[116:119], v[100:103]
    s_waitcnt lgkmcnt(0)
    s_barrier
    v_mfma_f32_16x16x32_bf16 v[8:11], v[152:155], v[136:139], v[8:11]
    ds_read_b128 v[104:107], v168 offset:0
    v_mfma_f32_16x16x32_bf16 v[12:15], v[156:159], v[136:139], v[12:15]
    ds_read_b64_tr_b16 v[120:121], v170 offset:0
    v_mfma_f32_16x16x32_bf16 v[16:19], v[136:139], v[160:163], v[16:19]
    ds_read_b64_tr_b16 v[122:123], v170 offset:512
    v_mfma_f32_16x16x32_bf16 v[20:23], v[136:139], v[164:167], v[20:23]
    ds_read_b64_tr_b16 v[124:125], v171 offset:0
    v_mfma_f32_16x16x32_bf16 v[72:75], v[180:183], v[136:139], v[72:75]
    ds_read_b64_tr_b16 v[126:127], v171 offset:512
    v_mfma_f32_16x16x32_bf16 v[76:79], v[184:187], v[136:139], v[76:79]
    ds_read_b128 v[108:111], v168 offset:2048
    v_mfma_f32_16x16x32_bf16 v[24:27], v[152:155], v[140:143], v[24:27]
    ds_read_b64_tr_b16 v[128:129], v170 offset:8192
    v_mfma_f32_16x16x32_bf16 v[28:31], v[156:159], v[140:143], v[28:31]
    ds_read_b64_tr_b16 v[130:131], v170 offset:8704
    v_mfma_f32_16x16x32_bf16 v[32:35], v[140:143], v[160:163], v[32:35]
    ds_read_b64_tr_b16 v[132:133], v171 offset:8192
    v_mfma_f32_16x16x32_bf16 v[36:39], v[140:143], v[164:167], v[36:39]
    ds_read_b64_tr_b16 v[134:135], v171 offset:8704
    v_mfma_f32_16x16x32_bf16 v[80:83], v[180:183], v[140:143], v[80:83]
    ds_read_b64_tr_b16 v[172:173], v189 offset:16384
    v_mfma_f32_16x16x32_bf16 v[84:87], v[184:187], v[140:143], v[84:87]
    ds_read_b64_tr_b16 v[174:175], v189 offset:16896
    v_mfma_f32_16x16x32_bf16 v[40:43], v[152:155], v[144:147], v[40:43]
    ds_read_b64_tr_b16 v[176:177], v191 offset:16384
    v_mfma_f32_16x16x32_bf16 v[44:47], v[156:159], v[144:147], v[44:47]
    ds_read_b64_tr_b16 v[178:179], v191 offset:16896
    v_mfma_f32_16x16x32_bf16 v[48:51], v[144:147], v[160:163], v[48:51]
    ds_read_b128 v[112:115], v168 offset:4096
    v_mfma_f32_16x16x32_bf16 v[52:55], v[144:147], v[164:167], v[52:55]
    ds_read_b128 v[116:119], v168 offset:6144
    v_mfma_f32_16x16x32_bf16 v[88:91], v[180:183], v[144:147], v[88:91]
    v_mfma_f32_16x16x32_bf16 v[92:95], v[184:187], v[144:147], v[92:95]
    v_mfma_f32_16x16x32_bf16 v[56:59], v[152:155], v[148:151], v[56:59]
    v_mfma_f32_16x16x32_bf16 v[60:63], v[156:159], v[148:151], v[60:63]
    v_mfma_f32_16x16x32_bf16 v[64:67], v[148:151], v[160:163], v[64:67]
    v_mfma_f32_16x16x32_bf16 v[68:71], v[148:151], v[164:167], v[68:71]
    v_mfma_f32_16x16x32_bf16 v[96:99], v[180:183], v[148:151], v[96:99]
    v_mfma_f32_16x16x32_bf16 v[100:103], v[184:187], v[148:151], v[100:103]
    s_waitcnt lgkmcnt(0)
    v_mfma_f32_16x16x32_bf16 v[8:11], v[120:123], v[104:107], v[8:11]
    ds_read_b128 v[136:139], v169 offset:0
    v_mfma_f32_16x16x32_bf16 v[12:15], v[124:127], v[104:107], v[12:15]
    ds_read_b64_tr_b16 v[152:153], v170 offset:4096
    v_mfma_f32_16x16x32_bf16 v[16:19], v[104:107], v[128:131], v[16:19]
    ds_read_b64_tr_b16 v[154:155], v170 offset:4608
    v_mfma_f32_16x16x32_bf16 v[20:23], v[104:107], v[132:135], v[20:23]
    ds_read_b64_tr_b16 v[156:157], v171 offset:4096
    v_mfma_f32_16x16x32_bf16 v[72:75], v[172:175], v[104:107], v[72:75]
    ds_read_b64_tr_b16 v[158:159], v171 offset:4608
    v_mfma_f32_16x16x32_bf16 v[76:79], v[176:179], v[104:107], v[76:79]
    ds_read_b128 v[140:143], v169 offset:2048
    v_mfma_f32_16x16x32_bf16 v[24:27], v[120:123], v[108:111], v[24:27]
    ds_read_b64_tr_b16 v[160:161], v170 offset:12288
    v_mfma_f32_16x16x32_bf16 v[28:31], v[124:127], v[108:111], v[28:31]
    ds_read_b64_tr_b16 v[162:163], v170 offset:12800
    v_mfma_f32_16x16x32_bf16 v[32:35], v[108:111], v[128:131], v[32:35]
    ds_read_b64_tr_b16 v[164:165], v171 offset:12288
    v_mfma_f32_16x16x32_bf16 v[36:39], v[108:111], v[132:135], v[36:39]
    ds_read_b64_tr_b16 v[166:167], v171 offset:12800
    v_mfma_f32_16x16x32_bf16 v[80:83], v[172:175], v[108:111], v[80:83]
    ds_read_b64_tr_b16 v[180:181], v189 offset:20480
    v_mfma_f32_16x16x32_bf16 v[84:87], v[176:179], v[108:111], v[84:87]
    ds_read_b64_tr_b16 v[182:183], v189 offset:20992
    v_mfma_f32_16x16x32_bf16 v[40:43], v[120:123], v[112:115], v[40:43]
    ds_read_b64_tr_b16 v[184:185], v191 offset:20480
    v_mfma_f32_16x16x32_bf16 v[44:47], v[124:127], v[112:115], v[44:47]
    ds_read_b64_tr_b16 v[186:187], v191 offset:20992
    v_mfma_f32_16x16x32_bf16 v[48:51], v[112:115], v[128:131], v[48:51]
    ds_read_b128 v[144:147], v169 offset:4096
    v_mfma_f32_16x16x32_bf16 v[52:55], v[112:115], v[132:135], v[52:55]
    ds_read_b128 v[148:151], v169 offset:6144
    v_mfma_f32_16x16x32_bf16 v[88:91], v[172:175], v[112:115], v[88:91]
    v_mfma_f32_16x16x32_bf16 v[92:95], v[176:179], v[112:115], v[92:95]
    v_mfma_f32_16x16x32_bf16 v[56:59], v[120:123], v[116:119], v[56:59]
    v_mfma_f32_16x16x32_bf16 v[60:63], v[124:127], v[116:119], v[60:63]
    v_mfma_f32_16x16x32_bf16 v[64:67], v[116:119], v[128:131], v[64:67]
    v_mfma_f32_16x16x32_bf16 v[68:71], v[116:119], v[132:135], v[68:71]
    v_mfma_f32_16x16x32_bf16 v[96:99], v[172:175], v[116:119], v[96:99]
    v_mfma_f32_16x16x32_bf16 v[100:103], v[176:179], v[116:119], v[100:103]
    s_waitcnt lgkmcnt(0)
    s_barrier
    v_mfma_f32_16x16x32_bf16 v[8:11], v[152:155], v[136:139], v[8:11]
    ds_read_b128 v[104:107], v168 offset:16384
    v_mfma_f32_16x16x32_bf16 v[12:15], v[156:159], v[136:139], v[12:15]
    ds_read_b64_tr_b16 v[120:121], v170 offset:16384
    v_mfma_f32_16x16x32_bf16 v[16:19], v[136:139], v[160:163], v[16:19]
    ds_read_b64_tr_b16 v[122:123], v170 offset:16896
    v_mfma_f32_16x16x32_bf16 v[20:23], v[136:139], v[164:167], v[20:23]
    ds_read_b64_tr_b16 v[124:125], v171 offset:16384
    v_mfma_f32_16x16x32_bf16 v[72:75], v[180:183], v[136:139], v[72:75]
    ds_read_b64_tr_b16 v[126:127], v171 offset:16896
    v_mfma_f32_16x16x32_bf16 v[76:79], v[184:187], v[136:139], v[76:79]
    ds_read_b128 v[108:111], v168 offset:18432
    v_mfma_f32_16x16x32_bf16 v[24:27], v[152:155], v[140:143], v[24:27]
    ds_read_b64_tr_b16 v[128:129], v170 offset:24576
    v_mfma_f32_16x16x32_bf16 v[28:31], v[156:159], v[140:143], v[28:31]
    ds_read_b64_tr_b16 v[130:131], v170 offset:25088
    v_mfma_f32_16x16x32_bf16 v[32:35], v[140:143], v[160:163], v[32:35]
    ds_read_b64_tr_b16 v[132:133], v171 offset:24576
    v_mfma_f32_16x16x32_bf16 v[36:39], v[140:143], v[164:167], v[36:39]
    ds_read_b64_tr_b16 v[134:135], v171 offset:25088
    v_mfma_f32_16x16x32_bf16 v[80:83], v[180:183], v[140:143], v[80:83]
    ds_read_b64_tr_b16 v[172:173], v189 offset:0
    v_mfma_f32_16x16x32_bf16 v[84:87], v[184:187], v[140:143], v[84:87]
    ds_read_b64_tr_b16 v[174:175], v189 offset:512
    v_mfma_f32_16x16x32_bf16 v[40:43], v[152:155], v[144:147], v[40:43]
    ds_read_b64_tr_b16 v[176:177], v191 offset:0
    v_mfma_f32_16x16x32_bf16 v[44:47], v[156:159], v[144:147], v[44:47]
    ds_read_b64_tr_b16 v[178:179], v191 offset:512
    v_mfma_f32_16x16x32_bf16 v[48:51], v[144:147], v[160:163], v[48:51]
    ds_read_b128 v[112:115], v168 offset:20480
    v_mfma_f32_16x16x32_bf16 v[52:55], v[144:147], v[164:167], v[52:55]
    ds_read_b128 v[116:119], v168 offset:22528
    v_mfma_f32_16x16x32_bf16 v[88:91], v[180:183], v[144:147], v[88:91]
    v_mfma_f32_16x16x32_bf16 v[92:95], v[184:187], v[144:147], v[92:95]
    v_mfma_f32_16x16x32_bf16 v[56:59], v[152:155], v[148:151], v[56:59]
    v_mfma_f32_16x16x32_bf16 v[60:63], v[156:159], v[148:151], v[60:63]
    v_mfma_f32_16x16x32_bf16 v[64:67], v[148:151], v[160:163], v[64:67]
    v_mfma_f32_16x16x32_bf16 v[68:71], v[148:151], v[164:167], v[68:71]
    v_mfma_f32_16x16x32_bf16 v[96:99], v[180:183], v[148:151], v[96:99]
    v_mfma_f32_16x16x32_bf16 v[100:103], v[184:187], v[148:151], v[100:103]
    s_waitcnt lgkmcnt(0)
    v_mfma_f32_16x16x32_bf16 v[8:11], v[120:123], v[104:107], v[8:11]
    ds_read_b128 v[136:139], v169 offset:16384
    v_mfma_f32_16x16x32_bf16 v[12:15], v[124:127], v[104:107], v[12:15]
    ds_read_b64_tr_b16 v[152:153], v170 offset:20480
    v_mfma_f32_16x16x32_bf16 v[16:19], v[104:107], v[128:131], v[16:19]
    ds_read_b64_tr_b16 v[154:155], v170 offset:20992
    v_mfma_f32_16x16x32_bf16 v[20:23], v[104:107], v[132:135], v[20:23]
    ds_read_b64_tr_b16 v[156:157], v171 offset:20480
    v_mfma_f32_16x16x32_bf16 v[72:75], v[172:175], v[104:107], v[72:75]
    ds_read_b64_tr_b16 v[158:159], v171 offset:20992
    v_mfma_f32_16x16x32_bf16 v[76:79], v[176:179], v[104:107], v[76:79]
    ds_read_b128 v[140:143], v169 offset:18432
    v_mfma_f32_16x16x32_bf16 v[24:27], v[120:123], v[108:111], v[24:27]
    ds_read_b64_tr_b16 v[160:161], v170 offset:28672
    v_mfma_f32_16x16x32_bf16 v[28:31], v[124:127], v[108:111], v[28:31]
    ds_read_b64_tr_b16 v[162:163], v170 offset:29184
    v_mfma_f32_16x16x32_bf16 v[32:35], v[108:111], v[128:131], v[32:35]
    ds_read_b64_tr_b16 v[164:165], v171 offset:28672
    v_mfma_f32_16x16x32_bf16 v[36:39], v[108:111], v[132:135], v[36:39]
    ds_read_b64_tr_b16 v[166:167], v171 offset:29184
    v_mfma_f32_16x16x32_bf16 v[80:83], v[172:175], v[108:111], v[80:83]
    ds_read_b64_tr_b16 v[180:181], v189 offset:4096
    v_mfma_f32_16x16x32_bf16 v[84:87], v[176:179], v[108:111], v[84:87]
    ds_read_b64_tr_b16 v[182:183], v189 offset:4608
    v_mfma_f32_16x16x32_bf16 v[40:43], v[120:123], v[112:115], v[40:43]
    ds_read_b64_tr_b16 v[184:185], v191 offset:4096
    v_mfma_f32_16x16x32_bf16 v[44:47], v[124:127], v[112:115], v[44:47]
    ds_read_b64_tr_b16 v[186:187], v191 offset:4608
    v_mfma_f32_16x16x32_bf16 v[48:51], v[112:115], v[128:131], v[48:51]
    ds_read_b128 v[144:147], v169 offset:20480
    v_mfma_f32_16x16x32_bf16 v[52:55], v[112:115], v[132:135], v[52:55]
    ds_read_b128 v[148:151], v169 offset:22528
    v_mfma_f32_16x16x32_bf16 v[88:91], v[172:175], v[112:115], v[88:91]
    v_mfma_f32_16x16x32_bf16 v[92:95], v[176:179], v[112:115], v[92:95]
    v_mfma_f32_16x16x32_bf16 v[56:59], v[120:123], v[116:119], v[56:59]
    v_mfma_f32_16x16x32_bf16 v[60:63], v[124:127], v[116:119], v[60:63]
    v_mfma_f32_16x16x32_bf16 v[64:67], v[116:119], v[128:131], v[64:67]
    v_mfma_f32_16x16x32_bf16 v[68:71], v[116:119], v[132:135], v[68:71]
    v_mfma_f32_16x16x32_bf16 v[96:99], v[172:175], v[116:119], v[96:99]
    v_mfma_f32_16x16x32_bf16 v[100:103], v[176:179], v[116:119], v[100:103]
    s_waitcnt lgkmcnt(0)
    s_barrier
    v_mfma_f32_16x16x32_bf16 v[8:11], v[152:155], v[136:139], v[8:11]
    ds_read_b128 v[104:107], v168 offset:32768
    v_mfma_f32_16x16x32_bf16 v[12:15], v[156:159], v[136:139], v[12:15]
    ds_read_b64_tr_b16 v[120:121], v170 offset:32768
    v_mfma_f32_16x16x32_bf16 v[16:19], v[136:139], v[160:163], v[16:19]
    ds_read_b64_tr_b16 v[122:123], v170 offset:33280
    v_mfma_f32_16x16x32_bf16 v[20:23], v[136:139], v[164:167], v[20:23]
    ds_read_b64_tr_b16 v[124:125], v171 offset:32768
    v_mfma_f32_16x16x32_bf16 v[72:75], v[180:183], v[136:139], v[72:75]
    ds_read_b64_tr_b16 v[126:127], v171 offset:33280
    v_mfma_f32_16x16x32_bf16 v[76:79], v[184:187], v[136:139], v[76:79]
    ds_read_b128 v[108:111], v168 offset:34816
    v_mfma_f32_16x16x32_bf16 v[24:27], v[152:155], v[140:143], v[24:27]
    ds_read_b64_tr_b16 v[128:129], v170 offset:40960
    v_mfma_f32_16x16x32_bf16 v[28:31], v[156:159], v[140:143], v[28:31]
    ds_read_b64_tr_b16 v[130:131], v170 offset:41472
    v_mfma_f32_16x16x32_bf16 v[32:35], v[140:143], v[160:163], v[32:35]
    ds_read_b64_tr_b16 v[132:133], v171 offset:40960
    v_mfma_f32_16x16x32_bf16 v[36:39], v[140:143], v[164:167], v[36:39]
    ds_read_b64_tr_b16 v[134:135], v171 offset:41472
    v_mfma_f32_16x16x32_bf16 v[80:83], v[180:183], v[140:143], v[80:83]
    ds_read_b64_tr_b16 v[172:173], v189 offset:8192
    v_mfma_f32_16x16x32_bf16 v[84:87], v[184:187], v[140:143], v[84:87]
    ds_read_b64_tr_b16 v[174:175], v189 offset:8704
    v_mfma_f32_16x16x32_bf16 v[40:43], v[152:155], v[144:147], v[40:43]
    ds_read_b64_tr_b16 v[176:177], v191 offset:8192
    v_mfma_f32_16x16x32_bf16 v[44:47], v[156:159], v[144:147], v[44:47]
    ds_read_b64_tr_b16 v[178:179], v191 offset:8704
    v_mfma_f32_16x16x32_bf16 v[48:51], v[144:147], v[160:163], v[48:51]
    ds_read_b128 v[112:115], v168 offset:36864
    v_mfma_f32_16x16x32_bf16 v[52:55], v[144:147], v[164:167], v[52:55]
    ds_read_b128 v[116:119], v168 offset:38912
    v_mfma_f32_16x16x32_bf16 v[88:91], v[180:183], v[144:147], v[88:91]
    v_mfma_f32_16x16x32_bf16 v[92:95], v[184:187], v[144:147], v[92:95]
    v_mfma_f32_16x16x32_bf16 v[56:59], v[152:155], v[148:151], v[56:59]
    v_mfma_f32_16x16x32_bf16 v[60:63], v[156:159], v[148:151], v[60:63]
    v_mfma_f32_16x16x32_bf16 v[64:67], v[148:151], v[160:163], v[64:67]
    v_mfma_f32_16x16x32_bf16 v[68:71], v[148:151], v[164:167], v[68:71]
    v_mfma_f32_16x16x32_bf16 v[96:99], v[180:183], v[148:151], v[96:99]
    v_mfma_f32_16x16x32_bf16 v[100:103], v[184:187], v[148:151], v[100:103]
    s_waitcnt lgkmcnt(0)
    v_mfma_f32_16x16x32_bf16 v[8:11], v[120:123], v[104:107], v[8:11]
    ds_read_b128 v[136:139], v169 offset:32768
    v_mfma_f32_16x16x32_bf16 v[12:15], v[124:127], v[104:107], v[12:15]
    ds_read_b64_tr_b16 v[152:153], v170 offset:36864
    v_mfma_f32_16x16x32_bf16 v[16:19], v[104:107], v[128:131], v[16:19]
    ds_read_b64_tr_b16 v[154:155], v170 offset:37376
    v_mfma_f32_16x16x32_bf16 v[20:23], v[104:107], v[132:135], v[20:23]
    ds_read_b64_tr_b16 v[156:157], v171 offset:36864
    v_mfma_f32_16x16x32_bf16 v[72:75], v[172:175], v[104:107], v[72:75]
    ds_read_b64_tr_b16 v[158:159], v171 offset:37376
    v_mfma_f32_16x16x32_bf16 v[76:79], v[176:179], v[104:107], v[76:79]
    ds_read_b128 v[140:143], v169 offset:34816
    v_mfma_f32_16x16x32_bf16 v[24:27], v[120:123], v[108:111], v[24:27]
    ds_read_b64_tr_b16 v[160:161], v170 offset:45056
    v_mfma_f32_16x16x32_bf16 v[28:31], v[124:127], v[108:111], v[28:31]
    ds_read_b64_tr_b16 v[162:163], v170 offset:45568
    v_mfma_f32_16x16x32_bf16 v[32:35], v[108:111], v[128:131], v[32:35]
    ds_read_b64_tr_b16 v[164:165], v171 offset:45056
    v_mfma_f32_16x16x32_bf16 v[36:39], v[108:111], v[132:135], v[36:39]
    ds_read_b64_tr_b16 v[166:167], v171 offset:45568
    v_mfma_f32_16x16x32_bf16 v[80:83], v[172:175], v[108:111], v[80:83]
    ds_read_b64_tr_b16 v[180:181], v189 offset:12288
    v_mfma_f32_16x16x32_bf16 v[84:87], v[176:179], v[108:111], v[84:87]
    ds_read_b64_tr_b16 v[182:183], v189 offset:12800
    v_mfma_f32_16x16x32_bf16 v[40:43], v[120:123], v[112:115], v[40:43]
    ds_read_b64_tr_b16 v[184:185], v191 offset:12288
    v_mfma_f32_16x16x32_bf16 v[44:47], v[124:127], v[112:115], v[44:47]
    ds_read_b64_tr_b16 v[186:187], v191 offset:12800
    v_mfma_f32_16x16x32_bf16 v[48:51], v[112:115], v[128:131], v[48:51]
    ds_read_b128 v[144:147], v169 offset:36864
    v_mfma_f32_16x16x32_bf16 v[52:55], v[112:115], v[132:135], v[52:55]
    ds_read_b128 v[148:151], v169 offset:38912
    v_mfma_f32_16x16x32_bf16 v[88:91], v[172:175], v[112:115], v[88:91]
    v_mfma_f32_16x16x32_bf16 v[92:95], v[176:179], v[112:115], v[92:95]
    v_mfma_f32_16x16x32_bf16 v[56:59], v[120:123], v[116:119], v[56:59]
    v_mfma_f32_16x16x32_bf16 v[60:63], v[124:127], v[116:119], v[60:63]
    v_mfma_f32_16x16x32_bf16 v[64:67], v[116:119], v[128:131], v[64:67]
    v_mfma_f32_16x16x32_bf16 v[68:71], v[116:119], v[132:135], v[68:71]
    v_mfma_f32_16x16x32_bf16 v[96:99], v[172:175], v[116:119], v[96:99]
    v_mfma_f32_16x16x32_bf16 v[100:103], v[176:179], v[116:119], v[100:103]
    s_waitcnt lgkmcnt(0)
    s_barrier
    v_mfma_f32_16x16x32_bf16 v[8:11], v[152:155], v[136:139], v[8:11]
    ds_read_b128 v[104:107], v168 offset:49152
    v_mfma_f32_16x16x32_bf16 v[12:15], v[156:159], v[136:139], v[12:15]
    ds_read_b64_tr_b16 v[120:121], v170 offset:49152
    v_mfma_f32_16x16x32_bf16 v[16:19], v[136:139], v[160:163], v[16:19]
    ds_read_b64_tr_b16 v[122:123], v170 offset:49664
    v_mfma_f32_16x16x32_bf16 v[20:23], v[136:139], v[164:167], v[20:23]
    ds_read_b64_tr_b16 v[124:125], v171 offset:49152
    v_mfma_f32_16x16x32_bf16 v[72:75], v[180:183], v[136:139], v[72:75]
    ds_read_b64_tr_b16 v[126:127], v171 offset:49664
    v_mfma_f32_16x16x32_bf16 v[76:79], v[184:187], v[136:139], v[76:79]
    ds_read_b128 v[108:111], v168 offset:51200
    v_mfma_f32_16x16x32_bf16 v[24:27], v[152:155], v[140:143], v[24:27]
    ds_read_b64_tr_b16 v[128:129], v170 offset:57344
    v_mfma_f32_16x16x32_bf16 v[28:31], v[156:159], v[140:143], v[28:31]
    ds_read_b64_tr_b16 v[130:131], v170 offset:57856
    v_mfma_f32_16x16x32_bf16 v[32:35], v[140:143], v[160:163], v[32:35]
    ds_read_b64_tr_b16 v[132:133], v171 offset:57344
    v_mfma_f32_16x16x32_bf16 v[36:39], v[140:143], v[164:167], v[36:39]
    ds_read_b64_tr_b16 v[134:135], v171 offset:57856
    v_mfma_f32_16x16x32_bf16 v[80:83], v[180:183], v[140:143], v[80:83]
    ds_read_b64_tr_b16 v[172:173], v189 offset:16384
    v_mfma_f32_16x16x32_bf16 v[84:87], v[184:187], v[140:143], v[84:87]
    ds_read_b64_tr_b16 v[174:175], v189 offset:16896
    v_mfma_f32_16x16x32_bf16 v[40:43], v[152:155], v[144:147], v[40:43]
    ds_read_b64_tr_b16 v[176:177], v191 offset:16384
    v_mfma_f32_16x16x32_bf16 v[44:47], v[156:159], v[144:147], v[44:47]
    ds_read_b64_tr_b16 v[178:179], v191 offset:16896
    v_mfma_f32_16x16x32_bf16 v[48:51], v[144:147], v[160:163], v[48:51]
    ds_read_b128 v[112:115], v168 offset:53248
    v_mfma_f32_16x16x32_bf16 v[52:55], v[144:147], v[164:167], v[52:55]
    ds_read_b128 v[116:119], v168 offset:55296
    v_mfma_f32_16x16x32_bf16 v[88:91], v[180:183], v[144:147], v[88:91]
    v_mfma_f32_16x16x32_bf16 v[92:95], v[184:187], v[144:147], v[92:95]
    v_mfma_f32_16x16x32_bf16 v[56:59], v[152:155], v[148:151], v[56:59]
    v_mfma_f32_16x16x32_bf16 v[60:63], v[156:159], v[148:151], v[60:63]
    v_mfma_f32_16x16x32_bf16 v[64:67], v[148:151], v[160:163], v[64:67]
    v_mfma_f32_16x16x32_bf16 v[68:71], v[148:151], v[164:167], v[68:71]
    v_mfma_f32_16x16x32_bf16 v[96:99], v[180:183], v[148:151], v[96:99]
    v_mfma_f32_16x16x32_bf16 v[100:103], v[184:187], v[148:151], v[100:103]
    s_waitcnt lgkmcnt(0)
    v_mfma_f32_16x16x32_bf16 v[8:11], v[120:123], v[104:107], v[8:11]
    ds_read_b128 v[136:139], v169 offset:49152
    v_mfma_f32_16x16x32_bf16 v[12:15], v[124:127], v[104:107], v[12:15]
    ds_read_b64_tr_b16 v[152:153], v170 offset:53248
    v_mfma_f32_16x16x32_bf16 v[16:19], v[104:107], v[128:131], v[16:19]
    ds_read_b64_tr_b16 v[154:155], v170 offset:53760
    v_mfma_f32_16x16x32_bf16 v[20:23], v[104:107], v[132:135], v[20:23]
    ds_read_b64_tr_b16 v[156:157], v171 offset:53248
    v_mfma_f32_16x16x32_bf16 v[72:75], v[172:175], v[104:107], v[72:75]
    ds_read_b64_tr_b16 v[158:159], v171 offset:53760
    v_mfma_f32_16x16x32_bf16 v[76:79], v[176:179], v[104:107], v[76:79]
    ds_read_b128 v[140:143], v169 offset:51200
    v_mfma_f32_16x16x32_bf16 v[24:27], v[120:123], v[108:111], v[24:27]
    ds_read_b64_tr_b16 v[160:161], v170 offset:61440
    v_mfma_f32_16x16x32_bf16 v[28:31], v[124:127], v[108:111], v[28:31]
    ds_read_b64_tr_b16 v[162:163], v170 offset:61952
    v_mfma_f32_16x16x32_bf16 v[32:35], v[108:111], v[128:131], v[32:35]
    ds_read_b64_tr_b16 v[164:165], v171 offset:61440
    v_mfma_f32_16x16x32_bf16 v[36:39], v[108:111], v[132:135], v[36:39]
    ds_read_b64_tr_b16 v[166:167], v171 offset:61952
    v_mfma_f32_16x16x32_bf16 v[80:83], v[172:175], v[108:111], v[80:83]
    ds_read_b64_tr_b16 v[180:181], v189 offset:20480
    v_mfma_f32_16x16x32_bf16 v[84:87], v[176:179], v[108:111], v[84:87]
    ds_read_b64_tr_b16 v[182:183], v189 offset:20992
    v_mfma_f32_16x16x32_bf16 v[40:43], v[120:123], v[112:115], v[40:43]
    ds_read_b64_tr_b16 v[184:185], v191 offset:20480
    v_mfma_f32_16x16x32_bf16 v[44:47], v[124:127], v[112:115], v[44:47]
    ds_read_b64_tr_b16 v[186:187], v191 offset:20992
    v_mfma_f32_16x16x32_bf16 v[48:51], v[112:115], v[128:131], v[48:51]
    ds_read_b128 v[144:147], v169 offset:53248
    v_mfma_f32_16x16x32_bf16 v[52:55], v[112:115], v[132:135], v[52:55]
    ds_read_b128 v[148:151], v169 offset:55296
    v_mfma_f32_16x16x32_bf16 v[88:91], v[172:175], v[112:115], v[88:91]
    v_mfma_f32_16x16x32_bf16 v[92:95], v[176:179], v[112:115], v[92:95]
    v_mfma_f32_16x16x32_bf16 v[56:59], v[120:123], v[116:119], v[56:59]
    v_mfma_f32_16x16x32_bf16 v[60:63], v[124:127], v[116:119], v[60:63]
    v_mfma_f32_16x16x32_bf16 v[64:67], v[116:119], v[128:131], v[64:67]
    v_mfma_f32_16x16x32_bf16 v[68:71], v[116:119], v[132:135], v[68:71]
    v_mfma_f32_16x16x32_bf16 v[96:99], v[172:175], v[116:119], v[96:99]
    v_mfma_f32_16x16x32_bf16 v[100:103], v[176:179], v[116:119], v[100:103]
L_e1:
    s_waitcnt lgkmcnt(0)
    s_barrier
    v_mfma_f32_16x16x32_bf16 v[8:11], v[152:155], v[136:139], v[8:11]
    ds_read_b128 v[104:107], v168 offset:0
    v_mfma_f32_16x16x32_bf16 v[12:15], v[156:159], v[136:139], v[12:15]
    ds_read_b64_tr_b16 v[120:121], v170 offset:0
    v_mfma_f32_16x16x32_bf16 v[16:19], v[136:139], v[160:163], v[16:19]
    ds_read_b64_tr_b16 v[122:123], v170 offset:512
    v_mfma_f32_16x16x32_bf16 v[20:23], v[136:139], v[164:167], v[20:23]
    ds_read_b64_tr_b16 v[124:125], v171 offset:0
    v_mfma_f32_16x16x32_bf16 v[72:75], v[180:183], v[136:139], v[72:75]
    ds_read_b64_tr_b16 v[126:127], v171 offset:512
    v_mfma_f32_16x16x32_bf16 v[76:79], v[184:187], v[136:139], v[76:79]
    ds_read_b128 v[108:111], v168 offset:2048
    v_mfma_f32_16x16x32_bf16 v[24:27], v[152:155], v[140:143], v[24:27]
    ds_read_b64_tr_b16 v[128:129], v170 offset:8192
    v_mfma_f32_16x16x32_bf16 v[28:31], v[156:159], v[140:143], v[28:31]
    ds_read_b64_tr_b16 v[130:131], v170 offset:8704
    v_mfma_f32_16x16x32_bf16 v[32:35], v[140:143], v[160:163], v[32:35]
    ds_read_b64_tr_b16 v[132:133], v171 offset:8192
    v_mfma_f32_16x16x32_bf16 v[36:39], v[140:143], v[164:167], v[36:39]
    ds_read_b64_tr_b16 v[134:135], v171 offset:8704
    v_mfma_f32_16x16x32_bf16 v[80:83], v[180:183], v[140:143], v[80:83]
    ds_read_b128 v[112:115], v168 offset:4096
    v_mfma_f32_16x16x32_bf16 v[84:87], v[184:187], v[140:143], v[84:87]
    ds_read_b128 v[116:119], v168 offset:6144
    v_mfma_f32_16x16x32_bf16 v[40:43], v[152:155], v[144:147], v[40:43]
    v_mfma_f32_16x16x32_bf16 v[44:47], v[156:159], v[144:147], v[44:47]
    v_mfma_f32_16x16x32_bf16 v[48:51], v[144:147], v[160:163], v[48:51]
    v_mfma_f32_16x16x32_bf16 v[52:55], v[144:147], v[164:167], v[52:55]
    v_mfma_f32_16x16x32_bf16 v[88:91], v[180:183], v[144:147], v[88:91]
    v_mfma_f32_16x16x32_bf16 v[92:95], v[184:187], v[144:147], v[92:95]
    v_mfma_f32_16x16x32_bf16 v[56:59], v[152:155], v[148:151], v[56:59]
    v_mfma_f32_16x16x32_bf16 v[60:63], v[156:159], v[148:151], v[60:63]
    v_mfma_f32_16x16x32_bf16 v[64:67], v[148:151], v[160:163], v[64:67]
    v_mfma_f32_16x16x32_bf16 v[68:71], v[148:151], v[164:167], v[68:71]
    v_mfma_f32_16x16x32_bf16 v[96:99], v[180:183], v[148:151], v[96:99]
    v_mfma_f32_16x16x32_bf16 v[100:103], v[184:187], v[148:151], v[100:103]
    s_waitcnt lgkmcnt(0)
    v_mfma_f32_16x16x32_bf16 v[8:11], v[120:123], v[104:107], v[8:11]
    ds_read_b128 v[136:139], v169 offset:0
    v_mfma_f32_16x16x32_bf16 v[12:15], v[124:127], v[104:107], v[12:15]
    ds_read_b64_tr_b16 v[152:153], v170 offset:4096
    v_mfma_f32_16x16x32_bf16 v[16:19], v[104:107], v[128:131], v[16:19]
    ds_read_b64_tr_b16 v[154:155], v170 offset:4608
    v_mfma_f32_16x16x32_bf16 v[20:23], v[104:107], v[132:135], v[20:23]
    ds_read_b64_tr_b16 v[156:157], v171 offset:4096
    v_mfma_f32_16x16x32_bf16 v[24:27], v[120:123], v[108:111], v[24:27]
    ds_read_b64_tr_b16 v[158:159], v171 offset:4608
    v_mfma_f32_16x16x32_bf16 v[28:31], v[124:127], v[108:111], v[28:31]
    ds_read_b128 v[140:143], v169 offset:2048
    v_mfma_f32_16x16x32_bf16 v[32:35], v[108:111], v[128:131], v[32:35]
    ds_read_b64_tr_b16 v[160:161], v170 offset:12288
    v_mfma_f32_16x16x32_bf16 v[36:39], v[108:111], v[132:135], v[36:39]
    ds_read_b64_tr_b16 v[162:163], v170 offset:12800
    v_mfma_f32_16x16x32_bf16 v[40:43], v[120:123], v[112:115], v[40:43]
    ds_read_b64_tr_b16 v[164:165], v171 offset:12288
    ds_read_b128 v[196:199], v243 offset:320
    v_mfma_f32_16x16x32_bf16 v[44:47], v[124:127], v[112:115], v[44:47]
    ds_read_b64_tr_b16 v[166:167], v171 offset:12800
    ds_read_b128 v[192:195], v243 offset:256
    v_mfma_f32_16x16x32_bf16 v[48:51], v[112:115], v[128:131], v[48:51]
    ds_read_b128 v[144:147], v169 offset:4096
    ds_read_b128 v[220:223], v243 offset:64
    v_mfma_f32_16x16x32_bf16 v[52:55], v[112:115], v[132:135], v[52:55]
    ds_read_b128 v[148:151], v169 offset:6144
    ds_read_b128 v[216:219], v243 offset:0
    v_mfma_f32_16x16x32_bf16 v[56:59], v[120:123], v[116:119], v[56:59]
    ds_read_b32 v186, v240 offset:192
    v_mfma_f32_16x16x32_bf16 v[60:63], v[124:127], v[116:119], v[60:63]
    ds_read_b32 v184, v240 offset:128
    v_mfma_f32_16x16x32_bf16 v[64:67], v[116:119], v[128:131], v[64:67]
    ds_read_b32 v182, v240 offset:64
    v_mfma_f32_16x16x32_bf16 v[68:71], v[116:119], v[132:135], v[68:71]
    ds_read_b32 v180, v240 offset:0
    s_waitcnt lgkmcnt(0)
    v_mov_b32 v7, 13
    ds_write_b32 v249, v7
    v_mfma_f32_16x16x32_bf16 v[8:11], v[152:155], v[136:139], v[8:11]
    ds_read_b128 v[104:107], v168 offset:16384
    v_mfma_f32_16x16x32_bf16 v[12:15], v[156:159], v[136:139], v[12:15]
    ds_read_b64_tr_b16 v[120:121], v170 offset:16384
    v_mfma_f32_16x16x32_bf16 v[16:19], v[136:139], v[160:163], v[16:19]
    ds_read_b64_tr_b16 v[122:123], v170 offset:16896
    v_mfma_f32_16x16x32_bf16 v[20:23], v[136:139], v[164:167], v[20:23]
    ds_read_b64_tr_b16 v[124:125], v171 offset:16384
    v_mfma_f32_16x16x32_bf16 v[24:27], v[152:155], v[140:143], v[24:27]
    ds_read_b64_tr_b16 v[126:127], v171 offset:16896
    v_mfma_f32_16x16x32_bf16 v[28:31], v[156:159], v[140:143], v[28:31]
    ds_read_b128 v[108:111], v168 offset:18432
    v_mfma_f32_16x16x32_bf16 v[32:35], v[140:143], v[160:163], v[32:35]
    ds_read_b64_tr_b16 v[128:129], v170 offset:24576
    v_mfma_f32_16x16x32_bf16 v[36:39], v[140:143], v[164:167], v[36:39]
    ds_read_b64_tr_b16 v[130:131], v170 offset:25088
    v_mfma_f32_16x16x32_bf16 v[40:43], v[152:155], v[144:147], v[40:43]
    ds_read_b64_tr_b16 v[132:133], v171 offset:24576
    v_mfma_f32_16x16x32_bf16 v[44:47], v[156:159], v[144:147], v[44:47]
    ds_read_b64_tr_b16 v[134:135], v171 offset:25088
    v_mfma_f32_16x16x32_bf16 v[48:51], v[144:147], v[160:163], v[48:51]
    ds_read_b128 v[112:115], v168 offset:20480
    ds_read_b128 v[212:215], v242 offset:192
    v_mfma_f32_16x16x32_bf16 v[52:55], v[144:147], v[164:167], v[52:55]
    ds_read_b128 v[116:119], v168 offset:22528
    ds_read_b128 v[208:211], v242 offset:128
    v_mfma_f32_16x16x32_bf16 v[56:59], v[152:155], v[148:151], v[56:59]
    ds_read_b128 v[204:207], v242 offset:64
    v_mfma_f32_16x16x32_bf16 v[60:63], v[156:159], v[148:151], v[60:63]
    ds_read_b128 v[200:203], v242 offset:0
    v_mfma_f32_16x16x32_bf16 v[64:67], v[148:151], v[160:163], v[64:67]
    ds_read_b32 v190, v244 offset:576
    v_mfma_f32_16x16x32_bf16 v[68:71], v[148:151], v[164:167], v[68:71]
    ds_read_b32 v188, v244 offset:512
    s_waitcnt lgkmcnt(0)
    v_mfma_f32_16x16x32_bf16 v[8:11], v[120:123], v[104:107], v[8:11]
    ds_read_b128 v[136:139], v169 offset:16384
    v_fmac_f32 v40, v184, v192
    v_mfma_f32_16x16x32_bf16 v[12:15], v[124:127], v[104:107], v[12:15]
    ds_read_b64_tr_b16 v[152:153], v170 offset:20480
    v_fmac_f32 v44, v184, v196
    v_mfma_f32_16x16x32_bf16 v[16:19], v[104:107], v[128:131], v[16:19]
    ds_read_b64_tr_b16 v[154:155], v170 offset:20992
    v_fmac_f32 v48, v208, v188
    v_mfma_f32_16x16x32_bf16 v[20:23], v[104:107], v[132:135], v[20:23]
    ds_read_b64_tr_b16 v[156:157], v171 offset:20480
    v_fmac_f32 v52, v208, v190
    v_mfma_f32_16x16x32_bf16 v[24:27], v[120:123], v[108:111], v[24:27]
    ds_read_b64_tr_b16 v[158:159], v171 offset:20992
    v_fmac_f32 v56, v186, v192
    v_mfma_f32_16x16x32_bf16 v[28:31], v[124:127], v[108:111], v[28:31]
    ds_read_b128 v[140:143], v169 offset:18432
    v_fmac_f32 v60, v186, v196
    v_mfma_f32_16x16x32_bf16 v[32:35], v[108:111], v[128:131], v[32:35]
    ds_read_b64_tr_b16 v[160:161], v170 offset:28672
    v_fmac_f32 v64, v212, v188
    v_mfma_f32_16x16x32_bf16 v[36:39], v[108:111], v[132:135], v[36:39]
    ds_read_b64_tr_b16 v[162:163], v170 offset:29184
    v_fmac_f32 v68, v212, v190
    v_mfma_f32_16x16x32_bf16 v[40:43], v[120:123], v[112:115], v[40:43]
    ds_read_b64_tr_b16 v[164:165], v171 offset:28672
    v_fmac_f32 v8, v180, v192
    v_mfma_f32_16x16x32_bf16 v[44:47], v[124:127], v[112:115], v[44:47]
    ds_read_b64_tr_b16 v[166:167], v171 offset:29184
    v_fmac_f32 v12, v180, v196
    v_mfma_f32_16x16x32_bf16 v[48:51], v[112:115], v[128:131], v[48:51]
    ds_read_b128 v[144:147], v169 offset:20480
    v_fmac_f32 v16, v200, v188
    v_mfma_f32_16x16x32_bf16 v[52:55], v[112:115], v[132:135], v[52:55]
    ds_read_b128 v[148:151], v169 offset:22528
    v_fmac_f32 v20, v200, v190
    v_mfma_f32_16x16x32_bf16 v[56:59], v[120:123], v[116:119], v[56:59]
    ds_read_b64 v[238:239], v251 offset:64
    v_fmac_f32 v24, v182, v192
    ds_read_b64_tr_b16 v[178:179], v246 offset:1056
    v_mfma_f32_16x16x32_bf16 v[60:63], v[124:127], v[116:119], v[60:63]
    v_fmac_f32 v28, v182, v196
    ds_read_b64_tr_b16 v[176:177], v246 offset:32
    v_mfma_f32_16x16x32_bf16 v[64:67], v[116:119], v[128:131], v[64:67]
    v_fmac_f32 v32, v204, v188
    ds_read_b64_tr_b16 v[174:175], v246 offset:1024
    v_mfma_f32_16x16x32_bf16 v[68:71], v[116:119], v[132:135], v[68:71]
    v_fmac_f32 v36, v204, v190
    ds_read_b64_tr_b16 v[172:173], v246 offset:0
    s_waitcnt lgkmcnt(0)
    v_mov_b32 v7, 14
    ds_write_b32 v249, v7
L_la14:
    v_min_u32 v238, v238, v239
    s_nop 0
    v_readfirstlane_b32 s3, v238
    s_nop 0
    s_cmp_ge_u32 s3, 14
    s_cbranch_scc1 L_lad14
    ds_read_b64 v[238:239], v251 offset:64
    s_waitcnt lgkmcnt(0)
    s_branch L_la14
L_lad14:
    v_mfma_f32_16x16x32_bf16 v[8:11], v[152:155], v[136:139], v[8:11]
    ds_read_b128 v[104:107], v168 offset:32768
    v_fmac_f32 v41, v184, v193
    v_mfma_f32_16x16x32_bf16 v[12:15], v[156:159], v[136:139], v[12:15]
    ds_read_b64_tr_b16 v[120:121], v170 offset:32768
    v_fmac_f32 v45, v184, v197
    v_mfma_f32_16x16x32_bf16 v[16:19], v[136:139], v[160:163], v[16:19]
    ds_read_b64_tr_b16 v[122:123], v170 offset:33280
    v_fmac_f32 v49, v209, v188
    v_mfma_f32_16x16x32_bf16 v[20:23], v[136:139], v[164:167], v[20:23]
    ds_read_b64_tr_b16 v[124:125], v171 offset:32768
    v_fmac_f32 v53, v209, v190
    v_mfma_f32_16x16x32_bf16 v[24:27], v[152:155], v[140:143], v[24:27]
    ds_read_b64_tr_b16 v[126:127], v171 offset:33280
    v_fmac_f32 v57, v186, v193
    v_mfma_f32_16x16x32_bf16 v[28:31], v[156:159], v[140:143], v[28:31]
    ds_read_b128 v[108:111], v168 offset:34816
    v_fmac_f32 v61, v186, v197
    v_mfma_f32_16x16x32_bf16 v[32:35], v[140:143], v[160:163], v[32:35]
    ds_read_b64_tr_b16 v[128:129], v170 offset:40960
    v_fmac_f32 v65, v213, v188
    v_mfma_f32_16x16x32_bf16 v[36:39], v[140:143], v[164:167], v[36:39]
    ds_read_b64_tr_b16 v[130:131], v170 offset:41472
    v_fmac_f32 v69, v213, v190
    v_mfma_f32_16x16x32_bf16 v[40:43], v[152:155], v[144:147], v[40:43]
    ds_read_b64_tr_b16 v[132:133], v171 offset:40960
    v_fmac_f32 v9, v180, v193
    v_mfma_f32_16x16x32_bf16 v[44:47], v[156:159], v[144:147], v[44:47]
    ds_read_b64_tr_b16 v[134:135], v171 offset:41472
    v_fmac_f32 v13, v180, v197
    v_mfma_f32_16x16x32_bf16 v[48:51], v[144:147], v[160:163], v[48:51]
    ds_read_b128 v[112:115], v168 offset:36864
    v_fmac_f32 v17, v201, v188
    v_mfma_f32_16x16x32_bf16 v[52:55], v[144:147], v[164:167], v[52:55]
    ds_read_b128 v[116:119], v168 offset:38912
    v_fmac_f32 v21, v201, v190
    v_mfma_f32_16x16x32_bf16 v[56:59], v[152:155], v[148:151], v[56:59]
    v_fmac_f32 v25, v182, v193
    ds_read_b32 v254, v240 offset:3776
    v_mfma_f32_16x16x32_bf16 v[60:63], v[156:159], v[148:151], v[60:63]
    v_fmac_f32 v29, v182, v197
    ds_read_b32 v252, v240 offset:3712
    v_mfma_f32_16x16x32_bf16 v[64:67], v[148:151], v[160:163], v[64:67]
    v_fmac_f32 v33, v205, v188
    ds_read_b32 v250, v240 offset:3648
    v_mfma_f32_16x16x32_bf16 v[68:71], v[148:151], v[164:167], v[68:71]
    v_fmac_f32 v37, v205, v190
    ds_read_b32 v248, v240 offset:3584
    s_waitcnt lgkmcnt(0)
    v_mfma_f32_16x16x32_bf16 v[8:11], v[120:123], v[104:107], v[8:11]
    ds_read_b128 v[136:139], v169 offset:32768
    v_fmac_f32 v42, v184, v194
    v_mfma_f32_16x16x32_bf16 v[12:15], v[124:127], v[104:107], v[12:15]
    ds_read_b64_tr_b16 v[152:153], v170 offset:36864
    v_fmac_f32 v46, v184, v198
    v_mfma_f32_16x16x32_bf16 v[16:19], v[104:107], v[128:131], v[16:19]
    ds_read_b64_tr_b16 v[154:155], v170 offset:37376
    v_fmac_f32 v50, v210, v188
    v_mfma_f32_16x16x32_bf16 v[20:23], v[104:107], v[132:135], v[20:23]
    ds_read_b64_tr_b16 v[156:157], v171 offset:36864
    v_fmac_f32 v54, v210, v190
    v_mfma_f32_16x16x32_bf16 v[24:27], v[120:123], v[108:111], v[24:27]
    ds_read_b64_tr_b16 v[158:159], v171 offset:37376
    v_fmac_f32 v58, v186, v194
    v_mfma_f32_16x16x32_bf16 v[28:31], v[124:127], v[108:111], v[28:31]
    ds_read_b128 v[140:143], v169 offset:34816
    v_fmac_f32 v62, v186, v198
    v_mfma_f32_16x16x32_bf16 v[32:35], v[108:111], v[128:131], v[32:35]
    ds_read_b64_tr_b16 v[160:161], v170 offset:45056
    v_fmac_f32 v66, v214, v188
    v_mfma_f32_16x16x32_bf16 v[36:39], v[108:111], v[132:135], v[36:39]
    ds_read_b64_tr_b16 v[162:163], v170 offset:45568
    v_fmac_f32 v70, v214, v190
    v_mfma_f32_16x16x32_bf16 v[40:43], v[120:123], v[112:115], v[40:43]
    ds_read_b64_tr_b16 v[164:165], v171 offset:45056
    v_fmac_f32 v10, v180, v194
    v_mfma_f32_16x16x32_bf16 v[44:47], v[124:127], v[112:115], v[44:47]
    ds_read_b64_tr_b16 v[166:167], v171 offset:45568
    v_fmac_f32 v14, v180, v198
    v_mfma_f32_16x16x32_bf16 v[48:51], v[112:115], v[128:131], v[48:51]
    ds_read_b128 v[144:147], v169 offset:36864
    v_fmac_f32 v18, v202, v188
    v_mfma_f32_16x16x32_bf16 v[52:55], v[112:115], v[132:135], v[52:55]
    ds_read_b128 v[148:151], v169 offset:38912
    v_fmac_f32 v22, v202, v190
    v_mfma_f32_16x16x32_bf16 v[56:59], v[120:123], v[116:119], v[56:59]
    ds_read_b64 v[238:239], v251 offset:64
    v_fmac_f32 v26, v182, v194
    ds_read_b32 v181, v241 offset:3584
    v_mfma_f32_16x16x32_bf16 v[60:63], v[124:127], v[116:119], v[60:63]
    v_fmac_f32 v30, v182, v198
    ds_read_b32 v183, v241 offset:512
    v_mfma_f32_16x16x32_bf16 v[64:67], v[116:119], v[128:131], v[64:67]
    v_fmac_f32 v34, v206, v188
    ds_read_b32 v187, v251 offset:8
    v_mfma_f32_16x16x32_bf16 v[68:71], v[116:119], v[132:135], v[68:71]
    v_fmac_f32 v38, v206, v190
    ds_read_b32 v185, v251 offset:16
    s_waitcnt lgkmcnt(0)
    v_mov_b32 v7, 15
    ds_write_b32 v249, v7
L_la15:
    v_min_u32 v238, v238, v239
    s_nop 0
    v_readfirstlane_b32 s3, v238
    s_nop 0
    s_cmp_ge_u32 s3, 15
    s_cbranch_scc1 L_lad15
    ds_read_b64 v[238:239], v251 offset:64
    s_waitcnt lgkmcnt(0)
    s_branch L_la15
L_lad15:
    v_mfma_f32_16x16x32_bf16 v[8:11], v[152:155], v[136:139], v[8:11]
    ds_read_b128 v[104:107], v168 offset:49152
    v_fmac_f32 v43, v184, v195
    v_mfma_f32_16x16x32_bf16 v[12:15], v[156:159], v[136:139], v[12:15]
    ds_read_b64_tr_b16 v[120:121], v170 offset:49152
    v_fmac_f32 v47, v184, v199
    v_mfma_f32_16x16x32_bf16 v[16:19], v[136:139], v[160:163], v[16:19]
    ds_read_b64_tr_b16 v[122:123], v170 offset:49664
    v_fmac_f32 v51, v211, v188
    v_mfma_f32_16x16x32_bf16 v[20:23], v[136:139], v[164:167], v[20:23]
    ds_read_b64_tr_b16 v[124:125], v171 offset:49152
    v_fmac_f32 v55, v211, v190
    v_mfma_f32_16x16x32_bf16 v[24:27], v[152:155], v[140:143], v[24:27]
    ds_read_b64_tr_b16 v[126:127], v171 offset:49664
    v_fmac_f32 v59, v186, v195
    v_mfma_f32_16x16x32_bf16 v[28:31], v[156:159], v[140:143], v[28:31]
    ds_read_b128 v[108:111], v168 offset:51200
    v_fmac_f32 v63, v186, v199
    v_mfma_f32_16x16x32_bf16 v[32:35], v[140:143], v[160:163], v[32:35]
    ds_read_b64_tr_b16 v[128:129], v170 offset:57344
    v_fmac_f32 v67, v215, v188
    v_mfma_f32_16x16x32_bf16 v[36:39], v[140:143], v[164:167], v[36:39]
    ds_read_b64_tr_b16 v[130:131], v170 offset:57856
    v_fmac_f32 v71, v215, v190
    v_mfma_f32_16x16x32_bf16 v[40:43], v[152:155], v[144:147], v[40:43]
    ds_read_b64_tr_b16 v[132:133], v171 offset:57344
    v_fmac_f32 v11, v180, v195
    v_mfma_f32_16x16x32_bf16 v[44:47], v[156:159], v[144:147], v[44:47]
    ds_read_b64_tr_b16 v[134:135], v171 offset:57856
    v_fmac_f32 v15, v180, v199
    v_mfma_f32_16x16x32_bf16 v[48:51], v[144:147], v[160:163], v[48:51]
    ds_read_b128 v[112:115], v168 offset:53248
    v_fmac_f32 v19, v203, v188
    v_mfma_f32_16x16x32_bf16 v[52:55], v[144:147], v[164:167], v[52:55]
    ds_read_b128 v[116:119], v168 offset:55296
    v_fmac_f32 v23, v203, v190
    v_mfma_f32_16x16x32_bf16 v[56:59], v[152:155], v[148:151], v[56:59]
    v_fmac_f32 v27, v182, v195
    v_mfma_f32_16x16x32_bf16 v[60:63], v[156:159], v[148:151], v[60:63]
    v_fmac_f32 v31, v182, v199
    v_mfma_f32_16x16x32_bf16 v[64:67], v[148:151], v[160:163], v[64:67]
    v_fmac_f32 v35, v207, v188
    v_mfma_f32_16x16x32_bf16 v[68:71], v[148:151], v[164:167], v[68:71]
    v_fmac_f32 v39, v207, v190
    s_waitcnt lgkmcnt(0)
    v_mfma_f32_16x16x32_bf16 v[8:11], v[120:123], v[104:107], v[8:11]
    ds_read_b128 v[136:139], v169 offset:49152
    v_mfma_f32_16x16x32_bf16 v[12:15], v[124:127], v[104:107], v[12:15]
    ds_read_b64_tr_b16 v[152:153], v170 offset:53248
    v_mfma_f32_16x16x32_bf16 v[16:19], v[104:107], v[128:131], v[16:19]
    ds_read_b64_tr_b16 v[154:155], v170 offset:53760
    v_mfma_f32_16x16x32_bf16 v[20:23], v[104:107], v[132:135], v[20:23]
    ds_read_b64_tr_b16 v[156:157], v171 offset:53248
    v_mfma_f32_16x16x32_bf16 v[24:27], v[120:123], v[108:111], v[24:27]
    ds_read_b64_tr_b16 v[158:159], v171 offset:53760
    v_mfma_f32_16x16x32_bf16 v[28:31], v[124:127], v[108:111], v[28:31]
    ds_read_b128 v[140:143], v169 offset:51200
    v_mfma_f32_16x16x32_bf16 v[32:35], v[108:111], v[128:131], v[32:35]
    ds_read_b64_tr_b16 v[160:161], v170 offset:61440
    v_mfma_f32_16x16x32_bf16 v[36:39], v[108:111], v[132:135], v[36:39]
    ds_read_b64_tr_b16 v[162:163], v170 offset:61952
    v_mfma_f32_16x16x32_bf16 v[40:43], v[120:123], v[112:115], v[40:43]
    ds_read_b64_tr_b16 v[164:165], v171 offset:61440
    v_mfma_f32_16x16x32_bf16 v[44:47], v[124:127], v[112:115], v[44:47]
    ds_read_b64_tr_b16 v[166:167], v171 offset:61952
    v_mfma_f32_16x16x32_bf16 v[48:51], v[112:115], v[128:131], v[48:51]
    ds_read_b128 v[144:147], v169 offset:53248
    v_mov_b32 v246, s76
    v_mfma_f32_16x16x32_bf16 v[52:55], v[112:115], v[132:135], v[52:55]
    ds_read_b128 v[148:151], v169 offset:55296
    v_add_u32 v244, s75, v5
    v_mfma_f32_16x16x32_bf16 v[56:59], v[120:123], v[116:119], v[56:59]
    v_add_u32 v243, s74, v5
    v_mfma_f32_16x16x32_bf16 v[60:63], v[124:127], v[116:119], v[60:63]
    v_add_u32 v242, s73, v6
    v_mfma_f32_16x16x32_bf16 v[64:67], v[116:119], v[128:131], v[64:67]
    v_add_u32 v241, s72, v6
    v_mfma_f32_16x16x32_bf16 v[68:71], v[116:119], v[132:135], v[68:71]
    v_add_u32 v240, s72, v4
    s_waitcnt lgkmcnt(0)
    v_mov_b32 v7, 16
    ds_write_b32 v249, v7
    v_mfma_f32_16x16x32_bf16 v[8:11], v[152:155], v[136:139], v[8:11]
    ds_read_b64 v[200:201], v245 offset:0
    v_mfma_f32_16x16x32_bf16 v[12:15], v[156:159], v[136:139], v[12:15]
    ds_read_b64 v[202:203], v245 offset:32
    v_mfma_f32_16x16x32_bf16 v[24:27], v[152:155], v[140:143], v[24:27]
    ds_read_b64 v[204:205], v245 offset:64
    v_mfma_f32_16x16x32_bf16 v[28:31], v[156:159], v[140:143], v[28:31]
    ds_read_b64 v[206:207], v245 offset:96
    v_mfma_f32_16x16x32_bf16 v[40:43], v[152:155], v[144:147], v[40:43]
    ds_read_b64 v[208:209], v247 offset:0
    v_mfma_f32_16x16x32_bf16 v[44:47], v[156:159], v[144:147], v[44:47]
    ds_read_b64 v[210:211], v247 offset:32
    v_mfma_f32_16x16x32_bf16 v[56:59], v[152:155], v[148:151], v[56:59]
    ds_read_b64 v[212:213], v247 offset:64
    v_mfma_f32_16x16x32_bf16 v[60:63], v[156:159], v[148:151], v[60:63]
    ds_read_b64 v[214:215], v247 offset:96
    v_mfma_f32_16x16x32_bf16 v[16:19], v[136:139], v[160:163], v[16:19]
    v_cvt_pk_bf16_f32 v104, v8, v9
L_hk8:
    s_cbranch_execz L_hr8
    v_cvt_pk_bf16_f32 v105, v10, v11
    v_mfma_f32_16x16x32_bf16 v[20:23], v[136:139], v[164:167], v[20:23]
    v_cvt_pk_bf16_f32 v106, v12, v13
    v_cvt_pk_bf16_f32 v107, v14, v15
    v_mfma_f32_16x16x32_bf16 v[32:35], v[140:143], v[160:163], v[32:35]
    v_cvt_pk_bf16_f32 v108, v24, v25
    v_cvt_pk_bf16_f32 v109, v26, v27
    v_mfma_f32_16x16x32_bf16 v[36:39], v[140:143], v[164:167], v[36:39]
    v_cvt_pk_bf16_f32 v110, v28, v29
    v_cvt_pk_bf16_f32 v111, v30, v31
    v_mfma_f32_16x16x32_bf16 v[48:51], v[144:147], v[160:163], v[48:51]
    v_cvt_pk_bf16_f32 v112, v40, v41
    v_cvt_pk_bf16_f32 v113, v42, v43
    v_mfma_f32_16x16x32_bf16 v[52:55], v[144:147], v[164:167], v[52:55]
    v_cvt_pk_bf16_f32 v114, v44, v45
    v_cvt_pk_bf16_f32 v115, v46, v47
    v_mfma_f32_16x16x32_bf16 v[64:67], v[148:151], v[160:163], v[64:67]
    v_cvt_pk_bf16_f32 v116, v56, v57
    v_cvt_pk_bf16_f32 v117, v58, v59
    v_mfma_f32_16x16x32_bf16 v[68:71], v[148:151], v[164:167], v[68:71]
    v_cvt_pk_bf16_f32 v118, v60, v61
    v_cvt_pk_bf16_f32 v119, v62, v63
    v_readfirstlane_b32 s88, v185
    v_readfirstlane_b32 s32, v187
    v_mfma_f32_16x16x32_bf16 v[120:123], v[172:175], v[104:107], 0
    v_cvt_pk_bf16_f32 v152, v16, v17
    v_cvt_pk_bf16_f32 v153, v18, v19
    v_mfma_f32_16x16x32_bf16 v[124:127], v[176:179], v[104:107], 0
    v_cvt_pk_bf16_f32 v156, v20, v21
    v_cvt_pk_bf16_f32 v157, v22, v23
    v_mfma_f32_16x16x32_bf16 v[128:131], v[172:175], v[108:111], 0
    v_cvt_pk_bf16_f32 v154, v32, v33
L_hk9:
    s_cbranch_execz L_hr9
    v_cvt_pk_bf16_f32 v155, v34, v35
    v_mfma_f32_16x16x32_bf16 v[132:135], v[176:179], v[108:111], 0
    v_cvt_pk_bf16_f32 v158, v36, v37
    v_cvt_pk_bf16_f32 v159, v38, v39
    v_mfma_f32_16x16x32_bf16 v[136:139], v[172:175], v[112:115], 0
    v_cvt_pk_bf16_f32 v160, v48, v49
    v_cvt_pk_bf16_f32 v161, v50, v51
    v_mfma_f32_16x16x32_bf16 v[140:143], v[176:179], v[112:115], 0
    v_cvt_pk_bf16_f32 v164, v52, v53
    v_cvt_pk_bf16_f32 v165, v54, v55
    v_mfma_f32_16x16x32_bf16 v[144:147], v[172:175], v[116:119], 0
    v_cvt_pk_bf16_f32 v162, v64, v65
    v_cvt_pk_bf16_f32 v163, v66, v67
    v_mfma_f32_16x16x32_bf16 v[148:151], v[176:179], v[116:119], 0
    v_cvt_pk_bf16_f32 v166, v68, v69
    v_cvt_pk_bf16_f32 v167, v70, v71
    ds_read_b128 v[192:195], v251 offset:80
    v_max3_f32 v224, v120, v121, v122
    v_min3_f32 v232, v120, v121, v122
    v_max3_f32 v224, v224, v123, v124
    v_min3_f32 v232, v232, v123, v124
    v_max3_f32 v224, v224, v125, v126
    v_min3_f32 v232, v232, v125, v126
    v_max_f32 v224, v224, v127
    v_min_f32 v232, v232, v127
    v_max3_f32 v226, v128, v129, v130
    v_min3_f32 v234, v128, v129, v130
    v_max3_f32 v226, v226, v131, v132
    v_min3_f32 v234, v234, v131, v132
    v_max3_f32 v226, v226, v133, v134
    v_min3_f32 v234, v234, v133, v134
    v_max_f32 v226, v226, v135
L_hk10:
    s_cbranch_execz L_hr10
    v_min_f32 v234, v234, v135
    v_max3_f32 v228, v136, v137, v138
    v_min3_f32 v236, v136, v137, v138
    v_max3_f32 v228, v228, v139, v140
    v_min3_f32 v236, v236, v139, v140
    v_max3_f32 v228, v228, v141, v142
    v_min3_f32 v236, v236, v141, v142
    v_max_f32 v228, v228, v143
    v_min_f32 v236, v236, v143
    v_max3_f32 v230, v144, v145, v146
    v_min3_f32 v238, v144, v145, v146
    v_max3_f32 v230, v230, v147, v148
    v_min3_f32 v238, v238, v147, v148
    v_max3_f32 v230, v230, v149, v150
    v_min3_f32 v238, v238, v149, v150
    v_max_f32 v230, v230, v151
    v_min_f32 v238, v238, v151
    v_permlane32_swap_b32 v224, v228
    v_permlane32_swap_b32 v226, v230
    v_permlane32_swap_b32 v232, v236
    v_permlane32_swap_b32 v234, v238
    v_max_f32 v224, v224, v228
    v_max_f32 v226, v226, v230
    v_min_f32 v232, v232, v236
    v_min_f32 v234, v234, v238
    v_permlane16_swap_b32 v224, v226
    s_nop 0
    v_permlane16_swap_b32 v232, v234
    v_max_f32 v224, v224, v226
    v_min_f32 v232, v232, v234
    v_mul_f32 v224, v224, v181
    v_mul_f32 v232, v232, v181
L_hk11:
    s_cbranch_execz L_hr11
    v_mov_b32 v226, v224
    v_mov_b32 v234, v232
    s_nop 0
    v_permlane16_swap_b32 v224, v226
    v_permlane16_swap_b32 v232, v234
    v_mov_b32 v228, v224
    v_mov_b32 v230, v226
    v_mov_b32 v236, v232
    v_mov_b32 v238, v234
    v_permlane32_swap_b32 v224, v228
    v_permlane32_swap_b32 v226, v230
    v_permlane32_swap_b32 v232, v236
    v_permlane32_swap_b32 v234, v238
    v_pk_fma_f32 v[8:9], v[120:121], v[248:249], v[224:225] op_sel_hi:[1,0,0] neg_lo:[0,0,1] neg_hi:[0,0,1]
    v_pk_fma_f32 v[16:17], v[120:121], v[248:249], v[232:233] op_sel_hi:[1,0,0] neg_lo:[1,0,0] neg_hi:[1,0,0]
    v_pk_fma_f32 v[10:11], v[122:123], v[248:249], v[224:225] op_sel_hi:[1,0,0] neg_lo:[0,0,1] neg_hi:[0,0,1]
    v_pk_fma_f32 v[18:19], v[122:123], v[248:249], v[232:233] op_sel_hi:[1,0,0] neg_lo:[1,0,0] neg_hi:[1,0,0]
    v_pk_fma_f32 v[12:13], v[124:125], v[248:249], v[224:225] op_sel_hi:[1,0,0] neg_lo:[0,0,1] neg_hi:[0,0,1]
    v_pk_fma_f32 v[20:21], v[124:125], v[248:249], v[232:233] op_sel_hi:[1,0,0] neg_lo:[1,0,0] neg_hi:[1,0,0]
    v_pk_fma_f32 v[14:15], v[126:127], v[248:249], v[224:225] op_sel_hi:[1,0,0] neg_lo:[0,0,1] neg_hi:[0,0,1]
    v_pk_fma_f32 v[22:23], v[126:127], v[248:249], v[232:233] op_sel_hi:[1,0,0] neg_lo:[1,0,0] neg_hi:[1,0,0]
L_sf:
    s_waitcnt lgkmcnt(0)
    v_min_u32 v192, v192, v193
    v_min3_u32 v192, v192, v194, v195
    s_nop 0
    v_readfirstlane_b32 s3, v192
    s_nop 0
    s_cmp_ge_u32 s3, 16
    s_cbranch_scc1 L_sfd
    ds_read_b128 v[192:195], v251 offset:80
    s_branch L_sf
L_sfd:
    ds_write_b128 v243, v[152:155] offset:0
    v_exp_f32 v8, v8
L_hk12:
    s_cbranch_execz L_hr12
    v_exp_f32 v9, v9
    v_exp_f32 v10, v10
    v_exp_f32 v11, v11
    v_exp_f32 v12, v12
    v_exp_f32 v13, v13
    v_exp_f32 v14, v14
    v_exp_f32 v15, v15
    v_exp_f32 v16, v16
    v_exp_f32 v17, v17
    v_exp_f32 v18, v18
    v_exp_f32 v19, v19
    v_exp_f32 v20, v20
    v_exp_f32 v21, v21
    v_exp_f32 v22, v22
    v_exp_f32 v23, v23
    v_pk_fma_f32 v[24:25], v[128:129], v[250:251], v[226:227] op_sel_hi:[1,0,0] neg_lo:[0,0,1] neg_hi:[0,0,1]
    v_pk_fma_f32 v[32:33], v[128:129], v[250:251], v[234:235] op_sel_hi:[1,0,0] neg_lo:[1,0,0] neg_hi:[1,0,0]
    v_pk_fma_f32 v[26:27], v[130:131], v[250:251], v[226:227] op_sel_hi:[1,0,0] neg_lo:[0,0,1] neg_hi:[0,0,1]
    v_pk_fma_f32 v[34:35], v[130:131], v[250:251], v[234:235] op_sel_hi:[1,0,0] neg_lo:[1,0,0] neg_hi:[1,0,0]
    v_pk_fma_f32 v[28:29], v[132:133], v[250:251], v[226:227] op_sel_hi:[1,0,0] neg_lo:[0,0,1] neg_hi:[0,0,1]
    v_pk_fma_f32 v[36:37], v[132:133], v[250:251], v[234:235] op_sel_hi:[1,0,0] neg_lo:[1,0,0] neg_hi:[1,0,0]
    v_pk_fma_f32 v[30:31], v[134:135], v[250:251], v[226:227] op_sel_hi:[1,0,0] neg_lo:[0,0,1] neg_hi:[0,0,1]
    v_pk_fma_f32 v[38:39], v[134:135], v[250:251], v[234:235] op_sel_hi:[1,0,0] neg_lo:[1,0,0] neg_hi:[1,0,0]
    ds_write_b128 v243, v[156:159] offset:1024
    v_exp_f32 v24, v24
    v_exp_f32 v25, v25
    v_exp_f32 v26, v26
    v_exp_f32 v27, v27
    v_exp_f32 v28, v28
    v_exp_f32 v29, v29
    v_exp_f32 v30, v30
    v_exp_f32 v31, v31
L_hk13:
    s_cbranch_execz L_hr13
    v_exp_f32 v32, v32
    v_exp_f32 v33, v33
    v_exp_f32 v34, v34
    v_exp_f32 v35, v35
    v_exp_f32 v36, v36
    v_exp_f32 v37, v37
    v_exp_f32 v38, v38
    v_exp_f32 v39, v39
    v_pk_fma_f32 v[40:41], v[136:137], v[252:253], v[228:229] op_sel_hi:[1,0,0] neg_lo:[0,0,1] neg_hi:[0,0,1]
    v_pk_fma_f32 v[48:49], v[136:137], v[252:253], v[236:237] op_sel_hi:[1,0,0] neg_lo:[1,0,0] neg_hi:[1,0,0]
    v_pk_fma_f32 v[42:43], v[138:139], v[252:253], v[228:229] op_sel_hi:[1,0,0] neg_lo:[0,0,1] neg_hi:[0,0,1]
    v_pk_fma_f32 v[50:51], v[138:139], v[252:253], v[236:237] op_sel_hi:[1,0,0] neg_lo:[1,0,0] neg_hi:[1,0,0]
    v_pk_fma_f32 v[44:45], v[140:141], v[252:253], v[228:229] op_sel_hi:[1,0,0] neg_lo:[0,0,1] neg_hi:[0,0,1]
    v_pk_fma_f32 v[52:53], v[140:141], v[252:253], v[236:237] op_sel_hi:[1,0,0] neg_lo:[1,0,0] neg_hi:[1,0,0]
    v_pk_fma_f32 v[46:47], v[142:143], v[252:253], v[228:229] op_sel_hi:[1,0,0] neg_lo:[0,0,1] neg_hi:[0,0,1]
    v_pk_fma_f32 v[54:55], v[142:143], v[252:253], v[236:237] op_sel_hi:[1,0,0] neg_lo:[1,0,0] neg_hi:[1,0,0]
    ds_write_b128 v243, v[160:163] offset:2048
    v_exp_f32 v40, v40
    v_exp_f32 v41, v41
    v_exp_f32 v42, v42
    v_exp_f32 v43, v43
    v_exp_f32 v44, v44
    v_exp_f32 v45, v45
    v_exp_f32 v46, v46
    v_exp_f32 v47, v47
    v_exp_f32 v48, v48
    v_exp_f32 v49, v49
    v_exp_f32 v50, v50
    v_exp_f32 v51, v51
    v_exp_f32 v52, v52
    v_exp_f32 v53, v53
    v_exp_f32 v54, v54
L_hk14:
    s_cbranch_execz L_hr14
    v_exp_f32 v55, v55
    v_pk_fma_f32 v[56:57], v[144:145], v[254:255], v[230:231] op_sel_hi:[1,0,0] neg_lo:[0,0,1] neg_hi:[0,0,1]
    v_pk_fma_f32 v[64:65], v[144:145], v[254:255], v[238:239] op_sel_hi:[1,0,0] neg_lo:[1,0,0] neg_hi:[1,0,0]
    v_pk_fma_f32 v[58:59], v[146:147], v[254:255], v[230:231] op_sel_hi:[1,0,0] neg_lo:[0,0,1] neg_hi:[0,0,1]
    v_pk_fma_f32 v[66:67], v[146:147], v[254:255], v[238:239] op_sel_hi:[1,0,0] neg_lo:[1,0,0] neg_hi:[1,0,0]
    v_pk_fma_f32 v[60:61], v[148:149], v[254:255], v[230:231] op_sel_hi:[1,0,0] neg_lo:[0,0,1] neg_hi:[0,0,1]
    v_pk_fma_f32 v[68:69], v[148:149], v[254:255], v[238:239] op_sel_hi:[1,0,0] neg_lo:[1,0,0] neg_hi:[1,0,0]
    v_pk_fma_f32 v[62:63], v[150:151], v[254:255], v[230:231] op_sel_hi:[1,0,0] neg_lo:[0,0,1] neg_hi:[0,0,1]
    v_pk_fma_f32 v[70:71], v[150:151], v[254:255], v[238:239] op_sel_hi:[1,0,0] neg_lo:[1,0,0] neg_hi:[1,0,0]
    ds_write_b128 v243, v[164:167] offset:3072
    v_exp_f32 v56, v56
    v_exp_f32 v57, v57
    v_exp_f32 v58, v58
    v_exp_f32 v59, v59
    v_exp_f32 v60, v60
    v_exp_f32 v61, v61
    v_exp_f32 v62, v62
    v_exp_f32 v63, v63
    v_exp_f32 v64, v64
    v_exp_f32 v65, v65
    v_exp_f32 v66, v66
    v_exp_f32 v67, v67
    v_exp_f32 v68, v68
    v_exp_f32 v69, v69
    v_exp_f32 v70, v70
    v_exp_f32 v71, v71
    v_pk_add_f32 v[120:121], v[8:9], v[10:11]
    v_pk_add_f32 v[122:123], v[12:13], v[14:15]
    v_pk_add_f32 v[124:125], v[16:17], v[18:19]
    v_pk_add_f32 v[126:127], v[20:21], v[22:23]
    v_pk_add_f32 v[128:129], v[24:25], v[26:27]
    v_pk_add_f32 v[130:131], v[28:29], v[30:31]
L_hk15:
    s_cbranch_execz L_hr15
    v_pk_add_f32 v[132:133], v[32:33], v[34:35]
    v_pk_add_f32 v[134:135], v[36:37], v[38:39]
    v_pk_add_f32 v[136:137], v[40:41], v[42:43]
    v_pk_add_f32 v[138:139], v[44:45], v[46:47]
    v_pk_add_f32 v[140:141], v[48:49], v[50:51]
    v_pk_add_f32 v[142:143], v[52:53], v[54:55]
    v_pk_add_f32 v[144:145], v[56:57], v[58:59]
    v_pk_add_f32 v[146:147], v[60:61], v[62:63]
    v_pk_add_f32 v[148:149], v[64:65], v[66:67]
    v_pk_add_f32 v[150:151], v[68:69], v[70:71]
    v_pk_add_f32 v[120:121], v[120:121], v[122:123]
    v_pk_add_f32 v[124:125], v[124:125], v[126:127]
    v_pk_add_f32 v[128:129], v[128:129], v[130:131]
    v_pk_add_f32 v[132:133], v[132:133], v[134:135]
    v_pk_add_f32 v[136:137], v[136:137], v[138:139]
    v_pk_add_f32 v[140:141], v[140:141], v[142:143]
    v_pk_add_f32 v[144:145], v[144:145], v[146:147]
    v_pk_add_f32 v[148:149], v[148:149], v[150:151]
    v_add_f32 v224, v120, v121
    v_add_f32 v232, v124, v125
    v_add_f32 v226, v128, v129
    v_add_f32 v234, v132, v133
    v_add_f32 v228, v136, v137
    v_add_f32 v236, v140, v141
    v_add_f32 v230, v144, v145
    v_add_f32 v238, v148, v149
    v_permlane32_swap_b32 v224, v228
    v_permlane32_swap_b32 v226, v230
    v_permlane32_swap_b32 v232, v236
    v_permlane32_swap_b32 v234, v238
    v_add_f32 v224, v224, v228
    v_add_f32 v226, v226, v230
L_hk16:
    s_cbranch_execz L_hr16
    v_add_f32 v232, v232, v236
    v_add_f32 v234, v234, v238
    v_permlane16_swap_b32 v224, v226
    s_nop 0
    v_permlane16_swap_b32 v232, v234
    v_add_f32 v224, v224, v226
    v_add_f32 v232, v232, v234
    v_rcp_f32 v224, v224
    v_rcp_f32 v232, v232
    v_mul_f32 v224, v224, v183
    v_mul_f32 v232, v232, v183
    v_mov_b32 v226, v224
    v_mov_b32 v234, v232
    s_nop 0
    v_permlane16_swap_b32 v224, v226
    v_permlane16_swap_b32 v232, v234
    v_mov_b32 v228, v224
    v_mov_b32 v230, v226
    v_mov_b32 v236, v232
    v_mov_b32 v238, v234
    v_permlane32_swap_b32 v224, v228
    v_permlane32_swap_b32 v226, v230
    v_permlane32_swap_b32 v232, v236
    v_permlane32_swap_b32 v234, v238
    v_pk_mul_f32 v[8:9], v[8:9], v[224:225] op_sel_hi:[1,0]
    v_pk_mul_f32 v[10:11], v[10:11], v[224:225] op_sel_hi:[1,0]
    v_pk_mul_f32 v[12:13], v[12:13], v[224:225] op_sel_hi:[1,0]
    v_pk_mul_f32 v[14:15], v[14:15], v[224:225] op_sel_hi:[1,0]
    v_cvt_pk_bf16_f32 v104, v8, v9
    v_cvt_pk_bf16_f32 v105, v10, v11
    ds_write_b64 v240, v[104:105] offset:0
    v_cvt_pk_bf16_f32 v106, v12, v13
L_hk17:
    s_cbranch_execz L_hr17
    v_cvt_pk_bf16_f32 v107, v14, v15
    ds_write_b64 v240, v[106:107] offset:32
    v_pk_mul_f32 v[16:17], v[16:17], v[232:233] op_sel_hi:[1,0]
    v_pk_mul_f32 v[18:19], v[18:19], v[232:233] op_sel_hi:[1,0]
    v_pk_mul_f32 v[20:21], v[20:21], v[232:233] op_sel_hi:[1,0]
    v_pk_mul_f32 v[22:23], v[22:23], v[232:233] op_sel_hi:[1,0]
    v_cvt_pk_bf16_f32 v108, v16, v17
    v_cvt_pk_bf16_f32 v109, v18, v19
    ds_write_b64 v240, v[108:109] offset:64
    v_cvt_pk_bf16_f32 v110, v20, v21
    v_cvt_pk_bf16_f32 v111, v22, v23
    ds_write_b64 v240, v[110:111] offset:96
    v_pk_mul_f32 v[24:25], v[24:25], v[226:227] op_sel_hi:[1,0]
    v_pk_mul_f32 v[26:27], v[26:27], v[226:227] op_sel_hi:[1,0]
    v_pk_mul_f32 v[28:29], v[28:29], v[226:227] op_sel_hi:[1,0]
    v_pk_mul_f32 v[30:31], v[30:31], v[226:227] op_sel_hi:[1,0]
    v_cvt_pk_bf16_f32 v112, v24, v25
    v_cvt_pk_bf16_f32 v113, v26, v27
    ds_write_b64 v240, v[112:113] offset:2176
    v_cvt_pk_bf16_f32 v114, v28, v29
    v_cvt_pk_bf16_f32 v115, v30, v31
    ds_write_b64 v240, v[114:115] offset:2208
    v_pk_mul_f32 v[32:33], v[32:33], v[234:235] op_sel_hi:[1,0]
    v_pk_mul_f32 v[34:35], v[34:35], v[234:235] op_sel_hi:[1,0]
    v_pk_mul_f32 v[36:37], v[36:37], v[234:235] op_sel_hi:[1,0]
    v_pk_mul_f32 v[38:39], v[38:39], v[234:235] op_sel_hi:[1,0]
    v_cvt_pk_bf16_f32 v116, v32, v33
    v_cvt_pk_bf16_f32 v117, v34, v35
    ds_write_b64 v240, v[116:117] offset:2240
    v_cvt_pk_bf16_f32 v118, v36, v37
    v_cvt_pk_bf16_f32 v119, v38, v39
    ds_write_b64 v240, v[118:119] offset:2272
    ds_read_b64_tr_b16 v[120:121], v241 offset:0
    ds_read_b64_tr_b16 v[122:123], v241 offset:2176
    ds_read_b64_tr_b16 v[124:125], v241 offset:32
    ds_read_b64_tr_b16 v[126:127], v241 offset:2208
    v_pk_mul_f32 v[40:41], v[40:41], v[228:229] op_sel_hi:[1,0]
L_hk18:
    s_cbranch_execz L_hr18
    v_pk_mul_f32 v[42:43], v[42:43], v[228:229] op_sel_hi:[1,0]
    v_pk_mul_f32 v[44:45], v[44:45], v[228:229] op_sel_hi:[1,0]
    v_pk_mul_f32 v[46:47], v[46:47], v[228:229] op_sel_hi:[1,0]
    v_cvt_pk_bf16_f32 v104, v40, v41
    v_cvt_pk_bf16_f32 v105, v42, v43
    ds_write_b64 v240, v[104:105] offset:4352
    v_cvt_pk_bf16_f32 v106, v44, v45
    v_cvt_pk_bf16_f32 v107, v46, v47
    ds_write_b64 v240, v[106:107] offset:4384
    v_pk_mul_f32 v[48:49], v[48:49], v[236:237] op_sel_hi:[1,0]
    v_pk_mul_f32 v[50:51], v[50:51], v[236:237] op_sel_hi:[1,0]
    v_pk_mul_f32 v[52:53], v[52:53], v[236:237] op_sel_hi:[1,0]
    v_pk_mul_f32 v[54:55], v[54:55], v[236:237] op_sel_hi:[1,0]
    v_cvt_pk_bf16_f32 v108, v48, v49
    v_cvt_pk_bf16_f32 v109, v50, v51
    ds_write_b64 v240, v[108:109] offset:4416
    v_cvt_pk_bf16_f32 v110, v52, v53
    v_cvt_pk_bf16_f32 v111, v54, v55
    ds_write_b64 v240, v[110:111] offset:4448
    v_pk_mul_f32 v[56:57], v[56:57], v[230:231] op_sel_hi:[1,0]
    v_pk_mul_f32 v[58:59], v[58:59], v[230:231] op_sel_hi:[1,0]
    v_pk_mul_f32 v[60:61], v[60:61], v[230:231] op_sel_hi:[1,0]
    v_pk_mul_f32 v[62:63], v[62:63], v[230:231] op_sel_hi:[1,0]
    v_cvt_pk_bf16_f32 v112, v56, v57
    v_cvt_pk_bf16_f32 v113, v58, v59
    ds_write_b64 v240, v[112:113] offset:6528
    v_cvt_pk_bf16_f32 v114, v60, v61
    v_cvt_pk_bf16_f32 v115, v62, v63
    ds_write_b64 v240, v[114:115] offset:6560
    v_pk_mul_f32 v[64:65], v[64:65], v[238:239] op_sel_hi:[1,0]
    v_pk_mul_f32 v[66:67], v[66:67], v[238:239] op_sel_hi:[1,0]
    v_pk_mul_f32 v[68:69], v[68:69], v[238:239] op_sel_hi:[1,0]
L_hk19:
    s_cbranch_execz L_hr19
    v_pk_mul_f32 v[70:71], v[70:71], v[238:239] op_sel_hi:[1,0]
    v_cvt_pk_bf16_f32 v116, v64, v65
    v_cvt_pk_bf16_f32 v117, v66, v67
    ds_write_b64 v240, v[116:117] offset:6592
    v_cvt_pk_bf16_f32 v118, v68, v69
    v_cvt_pk_bf16_f32 v119, v70, v71
    ds_write_b64 v240, v[118:119] offset:6624
    v_mov_b32 v7, 1
    ds_write_b32 v249, v7 offset:32
    ds_read_b32 v7, v246
    ds_read_b64_tr_b16 v[128:129], v241 offset:4352
    ds_read_b64_tr_b16 v[130:131], v241 offset:6528
    ds_read_b64_tr_b16 v[132:133], v241 offset:4384
    ds_read_b64_tr_b16 v[134:135], v241 offset:6560
    ds_read_b128 v[192:195], v251 offset:48
    s_waitcnt lgkmcnt(14)
    v_mfma_f32_16x16x32_bf16 v[8:11], v[120:123], v[152:155], 0
    v_mov_b32 v59, s32
    v_mfma_f32_16x16x32_bf16 v[12:15], v[120:123], v[156:159], 0
    v_mov_b32 v63, s32
    v_mfma_f32_16x16x32_bf16 v[24:27], v[120:123], v[200:203], 0
    v_mov_b32 v67, s32
    v_mfma_f32_16x16x32_bf16 v[16:19], v[124:127], v[152:155], 0
    v_mov_b32 v71, s32
    v_mfma_f32_16x16x32_bf16 v[20:23], v[124:127], v[156:159], 0
    v_mfma_f32_16x16x32_bf16 v[28:31], v[124:127], v[200:203], 0
    s_waitcnt lgkmcnt(0)
L_ex:
    v_readfirstlane_b32 s65, v7
    s_nop 0
    s_cmp_ge_u32 s65, 1
    s_cbranch_scc1 L_exd
    ds_read_b32 v7, v246
    s_waitcnt lgkmcnt(0)
    s_branch L_ex
L_exd:
    v_mfma_f32_16x16x32_bf16 v[8:11], v[128:131], v[160:163], v[8:11]
    ds_read_b64_tr_b16 v[136:137], v242 offset:0
    ds_read_b64_tr_b16 v[138:139], v242 offset:2176
    v_mfma_f32_16x16x32_bf16 v[12:15], v[128:131], v[164:167], v[12:15]
    ds_read_b64_tr_b16 v[140:141], v242 offset:32
    ds_read_b64_tr_b16 v[142:143], v242 offset:2208
    v_mfma_f32_16x16x32_bf16 v[24:27], v[128:131], v[204:207], v[24:27]
    ds_read_b128 v[32:35], v244 offset:0
    ds_read_b128 v[36:39], v244 offset:1024
    v_mfma_f32_16x16x32_bf16 v[16:19], v[132:135], v[160:163], v[16:19]
    ds_read_b64_tr_b16 v[144:145], v242 offset:4352
    ds_read_b64_tr_b16 v[146:147], v242 offset:6528
    v_mfma_f32_16x16x32_bf16 v[20:23], v[132:135], v[164:167], v[20:23]
    ds_read_b64_tr_b16 v[148:149], v242 offset:4384
    ds_read_b64_tr_b16 v[150:151], v242 offset:6560
    v_mfma_f32_16x16x32_bf16 v[28:31], v[132:135], v[204:207], v[28:31]
    ds_read_b128 v[40:43], v244 offset:2048
    ds_read_b128 v[44:47], v244 offset:3072
    s_waitcnt lgkmcnt(6)
    v_mfma_f32_16x16x32_bf16 v[8:11], v[136:139], v[32:35], v[8:11]
    v_mfma_f32_16x16x32_bf16 v[12:15], v[136:139], v[36:39], v[12:15]
    v_mfma_f32_16x16x32_bf16 v[24:27], v[136:139], v[208:211], v[24:27]
    v_mfma_f32_16x16x32_bf16 v[16:19], v[140:143], v[32:35], v[16:19]
    v_mfma_f32_16x16x32_bf16 v[20:23], v[140:143], v[36:39], v[20:23]
    v_mfma_f32_16x16x32_bf16 v[28:31], v[140:143], v[208:211], v[28:31]
    s_waitcnt lgkmcnt(0)
    v_mfma_f32_16x16x32_bf16 v[8:11], v[144:147], v[40:43], v[8:11]
    v_mfma_f32_16x16x32_bf16 v[12:15], v[144:147], v[44:47], v[12:15]
    v_mfma_f32_16x16x32_bf16 v[24:27], v[144:147], v[212:215], v[24:27]
    v_mfma_f32_16x16x32_bf16 v[16:19], v[148:151], v[40:43], v[16:19]
    v_mfma_f32_16x16x32_bf16 v[20:23], v[148:151], v[44:47], v[20:23]
    v_mfma_f32_16x16x32_bf16 v[28:31], v[148:151], v[212:215], v[28:31]
L_qr:
L_hk20:
    s_cbranch_execz L_hr20
    v_and_b32 v192, v192, v193
    v_and_b32 v194, v194, v195
    v_and_b32 v192, v192, v194
    s_nop 0
    v_readfirstlane_b32 s65, v192
    s_nop 0
    s_cmp_eq_u32 s65, 1
    s_cbranch_scc1 L_qrd
    ds_read_b128 v[192:195], v251 offset:48
    s_waitcnt lgkmcnt(0)
    s_branch L_qr
L_qrd:
    ds_read_b128 v[104:107], v168 offset:0
    ds_read_b64_tr_b16 v[120:121], v189 offset:0
    ds_read_b64_tr_b16 v[122:123], v189 offset:512
    ds_read_b64_tr_b16 v[124:125], v191 offset:0
    ds_read_b64_tr_b16 v[126:127], v191 offset:512
    ds_read_b128 v[108:111], v168 offset:2048
    ds_read_b128 v[112:115], v168 offset:4096
    ds_read_b128 v[116:119], v168 offset:6144
    v_cvt_pk_bf16_f32 v56, v8, v9
    v_cvt_pk_bf16_f32 v57, v10, v11
    v_cvt_pk_bf16_f32 v58, v24, v25
    v_cvt_pk_bf16_f32 v64, v12, v13
    v_cvt_pk_bf16_f32 v65, v14, v15
    v_cvt_pk_bf16_f32 v66, v26, v27
    v_cvt_pk_bf16_f32 v60, v16, v17
    v_cvt_pk_bf16_f32 v61, v18, v19
    v_cvt_pk_bf16_f32 v62, v28, v29
    v_cvt_pk_bf16_f32 v68, v20, v21
    v_cvt_pk_bf16_f32 v69, v22, v23
    v_cvt_pk_bf16_f32 v70, v30, v31
    s_cmp_lg_u32 s88, 0
    s_cbranch_scc1 L_kr
    buffer_store_dwordx4 v[56:59], v5, s[12:15], s77 offen offset:0
    buffer_store_dwordx4 v[60:63], v5, s[12:15], s77 offen offset:1024
    buffer_store_dwordx4 v[64:67], v5, s[12:15], s77 offen offset:2048
    buffer_store_dwordx4 v[68:71], v5, s[12:15], s77 offen offset:3072
    s_branch L_ks
L_kr:
    buffer_store_dwordx4 v[56:59], v5, s[12:15], s77 offen offset:0 sc1
    buffer_store_dwordx4 v[60:63], v5, s[12:15], s77 offen offset:1024 sc1
    buffer_store_dwordx4 v[64:67], v5, s[12:15], s77 offen offset:2048 sc1
    buffer_store_dwordx4 v[68:71], v5, s[12:15], s77 offen offset:3072 sc1
L_ks:
L_hk21:
    s_cbranch_execz L_hr21
    v_mov_b32 v7, 3
    ds_write_b32 v249, v7 offset:32
    s_waitcnt lgkmcnt(0)
    v_mfma_f32_16x16x32_bf16 v[72:75], v[120:123], v[104:107], v[72:75]
    ds_read_b128 v[136:139], v169 offset:0
    v_mfma_f32_16x16x32_bf16 v[76:79], v[124:127], v[104:107], v[76:79]
    ds_read_b64_tr_b16 v[152:153], v189 offset:4096
    v_mfma_f32_16x16x32_bf16 v[80:83], v[120:123], v[108:111], v[80:83]
    ds_read_b64_tr_b16 v[154:155], v189 offset:4608
    v_mfma_f32_16x16x32_bf16 v[84:87], v[124:127], v[108:111], v[84:87]
    ds_read_b64_tr_b16 v[156:157], v191 offset:4096
    v_mfma_f32_16x16x32_bf16 v[88:91], v[120:123], v[112:115], v[88:91]
    ds_read_b64_tr_b16 v[158:159], v191 offset:4608
    v_mfma_f32_16x16x32_bf16 v[92:95], v[124:127], v[112:115], v[92:95]
    ds_read_b128 v[140:143], v169 offset:2048
    v_mfma_f32_16x16x32_bf16 v[96:99], v[120:123], v[116:119], v[96:99]
    ds_read_b128 v[144:147], v169 offset:4096
    v_mfma_f32_16x16x32_bf16 v[100:103], v[124:127], v[116:119], v[100:103]
    ds_read_b128 v[148:151], v169 offset:6144
    s_waitcnt lgkmcnt(0)
    v_mov_b32 v7, 17
    ds_write_b32 v249, v7
    v_mfma_f32_16x16x32_bf16 v[72:75], v[152:155], v[136:139], v[72:75]
    ds_read_b128 v[104:107], v168 offset:16384
    v_mfma_f32_16x16x32_bf16 v[76:79], v[156:159], v[136:139], v[76:79]
    ds_read_b64_tr_b16 v[120:121], v189 offset:8192
    v_mfma_f32_16x16x32_bf16 v[80:83], v[152:155], v[140:143], v[80:83]
    ds_read_b64_tr_b16 v[122:123], v189 offset:8704
    v_mfma_f32_16x16x32_bf16 v[84:87], v[156:159], v[140:143], v[84:87]
    ds_read_b64_tr_b16 v[124:125], v191 offset:8192
    v_mfma_f32_16x16x32_bf16 v[88:91], v[152:155], v[144:147], v[88:91]
    ds_read_b64_tr_b16 v[126:127], v191 offset:8704
    v_mfma_f32_16x16x32_bf16 v[92:95], v[156:159], v[144:147], v[92:95]
    ds_read_b128 v[108:111], v168 offset:18432
    v_mfma_f32_16x16x32_bf16 v[96:99], v[152:155], v[148:151], v[96:99]
    ds_read_b128 v[112:115], v168 offset:20480
    v_mfma_f32_16x16x32_bf16 v[100:103], v[156:159], v[148:151], v[100:103]
    ds_read_b128 v[116:119], v168 offset:22528
    s_waitcnt lgkmcnt(0)
    v_mfma_f32_16x16x32_bf16 v[72:75], v[120:123], v[104:107], v[72:75]
    ds_read_b128 v[136:139], v169 offset:16384
    v_mfma_f32_16x16x32_bf16 v[76:79], v[124:127], v[104:107], v[76:79]
    ds_read_b64_tr_b16 v[152:153], v189 offset:12288
    v_mfma_f32_16x16x32_bf16 v[80:83], v[120:123], v[108:111], v[80:83]
    ds_read_b64_tr_b16 v[154:155], v189 offset:12800
    v_mfma_f32_16x16x32_bf16 v[84:87], v[124:127], v[108:111], v[84:87]
    ds_read_b64_tr_b16 v[156:157], v191 offset:12288
    v_mfma_f32_16x16x32_bf16 v[88:91], v[120:123], v[112:115], v[88:91]
    ds_read_b64_tr_b16 v[158:159], v191 offset:12800
    v_mfma_f32_16x16x32_bf16 v[92:95], v[124:127], v[112:115], v[92:95]
    ds_read_b128 v[140:143], v169 offset:18432
    v_mfma_f32_16x16x32_bf16 v[96:99], v[120:123], v[116:119], v[96:99]
    ds_read_b128 v[144:147], v169 offset:20480
    v_mfma_f32_16x16x32_bf16 v[100:103], v[124:127], v[116:119], v[100:103]
    ds_read_b128 v[148:151], v169 offset:22528
    s_waitcnt lgkmcnt(0)
    v_mov_b32 v7, 18
    ds_write_b32 v249, v7
    v_mfma_f32_16x16x32_bf16 v[72:75], v[152:155], v[136:139], v[72:75]
    ds_read_b128 v[104:107], v168 offset:32768
    v_mfma_f32_16x16x32_bf16 v[76:79], v[156:159], v[136:139], v[76:79]
    ds_read_b64_tr_b16 v[120:121], v189 offset:16384
    v_mfma_f32_16x16x32_bf16 v[80:83], v[152:155], v[140:143], v[80:83]
    ds_read_b64_tr_b16 v[122:123], v189 offset:16896
    v_mfma_f32_16x16x32_bf16 v[84:87], v[156:159], v[140:143], v[84:87]
    ds_read_b64_tr_b16 v[124:125], v191 offset:16384
    v_mfma_f32_16x16x32_bf16 v[88:91], v[152:155], v[144:147], v[88:91]
    ds_read_b64_tr_b16 v[126:127], v191 offset:16896
    v_mfma_f32_16x16x32_bf16 v[92:95], v[156:159], v[144:147], v[92:95]
    ds_read_b128 v[108:111], v168 offset:34816
    v_mfma_f32_16x16x32_bf16 v[96:99], v[152:155], v[148:151], v[96:99]
    ds_read_b128 v[112:115], v168 offset:36864
    v_mfma_f32_16x16x32_bf16 v[100:103], v[156:159], v[148:151], v[100:103]
    ds_read_b128 v[116:119], v168 offset:38912
    s_waitcnt lgkmcnt(0)
    v_mfma_f32_16x16x32_bf16 v[72:75], v[120:123], v[104:107], v[72:75]
    ds_read_b128 v[136:139], v169 offset:32768
    v_mfma_f32_16x16x32_bf16 v[76:79], v[124:127], v[104:107], v[76:79]
    ds_read_b64_tr_b16 v[152:153], v189 offset:20480
    v_mfma_f32_16x16x32_bf16 v[80:83], v[120:123], v[108:111], v[80:83]
    ds_read_b64_tr_b16 v[154:155], v189 offset:20992
    v_mfma_f32_16x16x32_bf16 v[84:87], v[124:127], v[108:111], v[84:87]
    ds_read_b64_tr_b16 v[156:157], v191 offset:20480
    v_mfma_f32_16x16x32_bf16 v[88:91], v[120:123], v[112:115], v[88:91]
    ds_read_b64_tr_b16 v[158:159], v191 offset:20992
    v_mfma_f32_16x16x32_bf16 v[92:95], v[124:127], v[112:115], v[92:95]
    ds_read_b128 v[140:143], v169 offset:34816
    v_mfma_f32_16x16x32_bf16 v[96:99], v[120:123], v[116:119], v[96:99]
    ds_read_b128 v[144:147], v169 offset:36864
    v_mfma_f32_16x16x32_bf16 v[100:103], v[124:127], v[116:119], v[100:103]
    ds_read_b128 v[148:151], v169 offset:38912
    s_waitcnt lgkmcnt(0)
    v_mov_b32 v7, 19
    ds_write_b32 v249, v7
    v_mfma_f32_16x16x32_bf16 v[72:75], v[152:155], v[136:139], v[72:75]
    ds_read_b128 v[104:107], v168 offset:49152
    v_mfma_f32_16x16x32_bf16 v[76:79], v[156:159], v[136:139], v[76:79]
    ds_read_b64_tr_b16 v[120:121], v170 offset:16384
    v_mfma_f32_16x16x32_bf16 v[80:83], v[152:155], v[140:143], v[80:83]
    ds_read_b64_tr_b16 v[122:123], v170 offset:16896
    v_mfma_f32_16x16x32_bf16 v[84:87], v[156:159], v[140:143], v[84:87]
    ds_read_b64_tr_b16 v[124:125], v171 offset:16384
    v_mfma_f32_16x16x32_bf16 v[88:91], v[152:155], v[144:147], v[88:91]
    ds_read_b64_tr_b16 v[126:127], v171 offset:16896
    v_mfma_f32_16x16x32_bf16 v[92:95], v[156:159], v[144:147], v[92:95]
    ds_read_b128 v[108:111], v168 offset:51200
    v_mfma_f32_16x16x32_bf16 v[96:99], v[152:155], v[148:151], v[96:99]
    ds_read_b128 v[112:115], v168 offset:53248
    v_mfma_f32_16x16x32_bf16 v[100:103], v[156:159], v[148:151], v[100:103]
    ds_read_b128 v[116:119], v168 offset:55296
    s_waitcnt lgkmcnt(0)
    v_mfma_f32_16x16x32_bf16 v[72:75], v[120:123], v[104:107], v[72:75]
    ds_read_b128 v[136:139], v169 offset:49152
    v_mfma_f32_16x16x32_bf16 v[76:79], v[124:127], v[104:107], v[76:79]
    ds_read_b64_tr_b16 v[152:153], v170 offset:20480
    v_mfma_f32_16x16x32_bf16 v[80:83], v[120:123], v[108:111], v[80:83]
    ds_read_b64_tr_b16 v[154:155], v170 offset:20992
    v_mfma_f32_16x16x32_bf16 v[84:87], v[124:127], v[108:111], v[84:87]
    ds_read_b64_tr_b16 v[156:157], v171 offset:20480
    v_mfma_f32_16x16x32_bf16 v[88:91], v[120:123], v[112:115], v[88:91]
    ds_read_b64_tr_b16 v[158:159], v171 offset:20992
    v_mfma_f32_16x16x32_bf16 v[92:95], v[124:127], v[112:115], v[92:95]
    ds_read_b128 v[140:143], v169 offset:51200
    v_mfma_f32_16x16x32_bf16 v[96:99], v[120:123], v[116:119], v[96:99]
    ds_read_b128 v[144:147], v169 offset:53248
    v_mfma_f32_16x16x32_bf16 v[100:103], v[124:127], v[116:119], v[100:103]
    ds_read_b128 v[148:151], v169 offset:55296
    s_waitcnt lgkmcnt(0)
    v_mov_b32 v7, 20
    ds_write_b32 v249, v7
    v_mfma_f32_16x16x32_bf16 v[72:75], v[152:155], v[136:139], v[72:75]
    v_mfma_f32_16x16x32_bf16 v[76:79], v[156:159], v[136:139], v[76:79]
    v_mfma_f32_16x16x32_bf16 v[80:83], v[152:155], v[140:143], v[80:83]
    v_mfma_f32_16x16x32_bf16 v[84:87], v[156:159], v[140:143], v[84:87]
    v_mfma_f32_16x16x32_bf16 v[88:91], v[152:155], v[144:147], v[88:91]
    v_mfma_f32_16x16x32_bf16 v[92:95], v[156:159], v[144:147], v[92:95]
    v_mfma_f32_16x16x32_bf16 v[96:99], v[152:155], v[148:151], v[96:99]
    v_mfma_f32_16x16x32_bf16 v[100:103], v[156:159], v[148:151], v[100:103]
    s_nop 0
    v_pk_fma_f32 v[72:73], v[180:181], v[216:217], v[72:73] op_sel_hi:[0,1,1]
    v_pk_fma_f32 v[74:75], v[180:181], v[218:219], v[74:75] op_sel_hi:[0,1,1]
    v_pk_fma_f32 v[76:77], v[180:181], v[220:221], v[76:77] op_sel_hi:[0,1,1]
    v_pk_fma_f32 v[78:79], v[180:181], v[222:223], v[78:79] op_sel_hi:[0,1,1]
    v_pk_fma_f32 v[80:81], v[182:183], v[216:217], v[80:81] op_sel_hi:[0,1,1]
    v_pk_fma_f32 v[82:83], v[182:183], v[218:219], v[82:83] op_sel_hi:[0,1,1]
    v_pk_fma_f32 v[84:85], v[182:183], v[220:221], v[84:85] op_sel_hi:[0,1,1]
    v_pk_fma_f32 v[86:87], v[182:183], v[222:223], v[86:87] op_sel_hi:[0,1,1]
    v_pk_fma_f32 v[88:89], v[184:185], v[216:217], v[88:89] op_sel_hi:[0,1,1]
    v_pk_fma_f32 v[90:91], v[184:185], v[218:219], v[90:91] op_sel_hi:[0,1,1]
    v_pk_fma_f32 v[92:93], v[184:185], v[220:221], v[92:93] op_sel_hi:[0,1,1]
    v_pk_fma_f32 v[94:95], v[184:185], v[222:223], v[94:95] op_sel_hi:[0,1,1]
    v_pk_fma_f32 v[96:97], v[186:187], v[216:217], v[96:97] op_sel_hi:[0,1,1]
    v_pk_fma_f32 v[98:99], v[186:187], v[218:219], v[98:99] op_sel_hi:[0,1,1]
    v_pk_fma_f32 v[100:101], v[186:187], v[220:221], v[100:101] op_sel_hi:[0,1,1]
    v_pk_fma_f32 v[102:103], v[186:187], v[222:223], v[102:103] op_sel_hi:[0,1,1]
    v_cvt_pk_bf16_f32 v104, v72, v73
    v_cvt_pk_bf16_f32 v105, v74, v75
    v_cvt_pk_bf16_f32 v106, v76, v77
    v_cvt_pk_bf16_f32 v107, v78, v79
    s_nop 1
    v_mfma_f32_16x16x32_bf16 v[120:123], v[172:175], v[104:107], 0
    v_cvt_pk_bf16_f32 v108, v80, v81
    v_cvt_pk_bf16_f32 v109, v82, v83
    v_mfma_f32_16x16x32_bf16 v[124:127], v[176:179], v[104:107], 0
    v_cvt_pk_bf16_f32 v110, v84, v85
    v_cvt_pk_bf16_f32 v111, v86, v87
    s_nop 1
    v_mfma_f32_16x16x32_bf16 v[128:131], v[172:175], v[108:111], 0
    v_cvt_pk_bf16_f32 v112, v88, v89
    v_cvt_pk_bf16_f32 v113, v90, v91
    v_mfma_f32_16x16x32_bf16 v[132:135], v[176:179], v[108:111], 0
    v_cvt_pk_bf16_f32 v114, v92, v93
    v_cvt_pk_bf16_f32 v115, v94, v95
    s_nop 1
    v_mfma_f32_16x16x32_bf16 v[136:139], v[172:175], v[112:115], 0
    v_cvt_pk_bf16_f32 v116, v96, v97
    v_cvt_pk_bf16_f32 v117, v98, v99
    v_mfma_f32_16x16x32_bf16 v[140:143], v[176:179], v[112:115], 0
    v_cvt_pk_bf16_f32 v118, v100, v101
    v_cvt_pk_bf16_f32 v119, v102, v103
    s_nop 1
    v_mfma_f32_16x16x32_bf16 v[144:147], v[172:175], v[116:119], 0
    v_mfma_f32_16x16x32_bf16 v[148:151], v[176:179], v[116:119], 0
    v_max3_f32 v224, v120, v121, v122
    v_min3_f32 v232, v120, v121, v122
    v_max3_f32 v224, v224, v123, v124
    v_min3_f32 v232, v232, v123, v124
    v_max3_f32 v224, v224, v125, v126
    v_min3_f32 v232, v232, v125, v126
    v_max_f32 v224, v224, v127
    v_min_f32 v232, v232, v127
    v_max3_f32 v226, v128, v129, v130
    v_min3_f32 v234, v128, v129, v130
    v_max3_f32 v226, v226, v131, v132
    v_min3_f32 v234, v234, v131, v132
    v_max3_f32 v226, v226, v133, v134
    v_min3_f32 v234, v234, v133, v134
    v_max_f32 v226, v226, v135
    v_min_f32 v234, v234, v135
    v_max3_f32 v228, v136, v137, v138
    v_min3_f32 v236, v136, v137, v138
    v_max3_f32 v228, v228, v139, v140
    v_min3_f32 v236, v236, v139, v140
    v_max3_f32 v228, v228, v141, v142
    v_min3_f32 v236, v236, v141, v142
    v_max_f32 v228, v228, v143
    v_min_f32 v236, v236, v143
    v_max3_f32 v230, v144, v145, v146
    v_min3_f32 v238, v144, v145, v146
    v_max3_f32 v230, v230, v147, v148
    v_min3_f32 v238, v238, v147, v148
    v_max3_f32 v230, v230, v149, v150
    v_min3_f32 v238, v238, v149, v150
    v_max_f32 v230, v230, v151
    v_min_f32 v238, v238, v151
    v_permlane32_swap_b32 v224, v228
    v_permlane32_swap_b32 v226, v230
    v_permlane32_swap_b32 v232, v236
    v_permlane32_swap_b32 v234, v238
    v_max_f32 v224, v224, v228
    v_max_f32 v226, v226, v230
    v_min_f32 v232, v232, v236
    v_min_f32 v234, v234, v238
    v_permlane16_swap_b32 v224, v226
    s_nop 0
    v_permlane16_swap_b32 v232, v234
    v_max_f32 v224, v224, v226
    v_min_f32 v232, v232, v234
    v_mul_f32 v224, v224, v181
    v_mul_f32 v232, v232, v181
    v_mov_b32 v226, v224
    v_mov_b32 v234, v232
    s_nop 0
    v_permlane16_swap_b32 v224, v226
    v_permlane16_swap_b32 v232, v234
    v_mov_b32 v228, v224
    v_mov_b32 v230, v226
    v_mov_b32 v236, v232
    v_mov_b32 v238, v234
    v_permlane32_swap_b32 v224, v228
    v_permlane32_swap_b32 v226, v230
    v_permlane32_swap_b32 v232, v236
    v_permlane32_swap_b32 v234, v238
    v_pk_fma_f32 v[8:9], v[120:121], v[248:249], v[224:225] op_sel_hi:[1,0,0] neg_lo:[0,0,1] neg_hi:[0,0,1]
    v_pk_fma_f32 v[16:17], v[120:121], v[248:249], v[232:233] op_sel_hi:[1,0,0] neg_lo:[1,0,0] neg_hi:[1,0,0]
    v_pk_fma_f32 v[10:11], v[122:123], v[248:249], v[224:225] op_sel_hi:[1,0,0] neg_lo:[0,0,1] neg_hi:[0,0,1]
    v_pk_fma_f32 v[18:19], v[122:123], v[248:249], v[232:233] op_sel_hi:[1,0,0] neg_lo:[1,0,0] neg_hi:[1,0,0]
    v_pk_fma_f32 v[12:13], v[124:125], v[248:249], v[224:225] op_sel_hi:[1,0,0] neg_lo:[0,0,1] neg_hi:[0,0,1]
    v_pk_fma_f32 v[20:21], v[124:125], v[248:249], v[232:233] op_sel_hi:[1,0,0] neg_lo:[1,0,0] neg_hi:[1,0,0]
    v_pk_fma_f32 v[14:15], v[126:127], v[248:249], v[224:225] op_sel_hi:[1,0,0] neg_lo:[0,0,1] neg_hi:[0,0,1]
    v_pk_fma_f32 v[22:23], v[126:127], v[248:249], v[232:233] op_sel_hi:[1,0,0] neg_lo:[1,0,0] neg_hi:[1,0,0]
    v_exp_f32 v8, v8
    v_exp_f32 v9, v9
    v_exp_f32 v10, v10
    v_exp_f32 v11, v11
    v_exp_f32 v12, v12
    v_exp_f32 v13, v13
    v_exp_f32 v14, v14
    v_exp_f32 v15, v15
    v_exp_f32 v16, v16
    v_exp_f32 v17, v17
    v_exp_f32 v18, v18
    v_exp_f32 v19, v19
    v_exp_f32 v20, v20
    v_exp_f32 v21, v21
    v_exp_f32 v22, v22
    v_exp_f32 v23, v23
    v_pk_fma_f32 v[24:25], v[128:129], v[250:251], v[226:227] op_sel_hi:[1,0,0] neg_lo:[0,0,1] neg_hi:[0,0,1]
    v_pk_fma_f32 v[32:33], v[128:129], v[250:251], v[234:235] op_sel_hi:[1,0,0] neg_lo:[1,0,0] neg_hi:[1,0,0]
    v_pk_fma_f32 v[26:27], v[130:131], v[250:251], v[226:227] op_sel_hi:[1,0,0] neg_lo:[0,0,1] neg_hi:[0,0,1]
    v_pk_fma_f32 v[34:35], v[130:131], v[250:251], v[234:235] op_sel_hi:[1,0,0] neg_lo:[1,0,0] neg_hi:[1,0,0]
    v_pk_fma_f32 v[28:29], v[132:133], v[250:251], v[226:227] op_sel_hi:[1,0,0] neg_lo:[0,0,1] neg_hi:[0,0,1]
    v_pk_fma_f32 v[36:37], v[132:133], v[250:251], v[234:235] op_sel_hi:[1,0,0] neg_lo:[1,0,0] neg_hi:[1,0,0]
    v_pk_fma_f32 v[30:31], v[134:135], v[250:251], v[226:227] op_sel_hi:[1,0,0] neg_lo:[0,0,1] neg_hi:[0,0,1]
    v_pk_fma_f32 v[38:39], v[134:135], v[250:251], v[234:235] op_sel_hi:[1,0,0] neg_lo:[1,0,0] neg_hi:[1,0,0]
    v_exp_f32 v24, v24
    v_exp_f32 v25, v25
    v_exp_f32 v26, v26
    v_exp_f32 v27, v27
    v_exp_f32 v28, v28
    v_exp_f32 v29, v29
    v_exp_f32 v30, v30
    v_exp_f32 v31, v31
    v_exp_f32 v32, v32
    v_exp_f32 v33, v33
    v_exp_f32 v34, v34
    v_exp_f32 v35, v35
    v_exp_f32 v36, v36
    v_exp_f32 v37, v37
    v_exp_f32 v38, v38
    v_exp_f32 v39, v39
    v_pk_fma_f32 v[40:41], v[136:137], v[252:253], v[228:229] op_sel_hi:[1,0,0] neg_lo:[0,0,1] neg_hi:[0,0,1]
    v_pk_fma_f32 v[48:49], v[136:137], v[252:253], v[236:237] op_sel_hi:[1,0,0] neg_lo:[1,0,0] neg_hi:[1,0,0]
    v_pk_fma_f32 v[42:43], v[138:139], v[252:253], v[228:229] op_sel_hi:[1,0,0] neg_lo:[0,0,1] neg_hi:[0,0,1]
    v_pk_fma_f32 v[50:51], v[138:139], v[252:253], v[236:237] op_sel_hi:[1,0,0] neg_lo:[1,0,0] neg_hi:[1,0,0]
    v_pk_fma_f32 v[44:45], v[140:141], v[252:253], v[228:229] op_sel_hi:[1,0,0] neg_lo:[0,0,1] neg_hi:[0,0,1]
    v_pk_fma_f32 v[52:53], v[140:141], v[252:253], v[236:237] op_sel_hi:[1,0,0] neg_lo:[1,0,0] neg_hi:[1,0,0]
    v_pk_fma_f32 v[46:47], v[142:143], v[252:253], v[228:229] op_sel_hi:[1,0,0] neg_lo:[0,0,1] neg_hi:[0,0,1]
    v_pk_fma_f32 v[54:55], v[142:143], v[252:253], v[236:237] op_sel_hi:[1,0,0] neg_lo:[1,0,0] neg_hi:[1,0,0]
    v_exp_f32 v40, v40
    v_exp_f32 v41, v41
    v_exp_f32 v42, v42
    v_exp_f32 v43, v43
    v_exp_f32 v44, v44
    v_exp_f32 v45, v45
    v_exp_f32 v46, v46
    v_exp_f32 v47, v47
    v_exp_f32 v48, v48
    v_exp_f32 v49, v49
    v_exp_f32 v50, v50
    v_exp_f32 v51, v51
    v_exp_f32 v52, v52
    v_exp_f32 v53, v53
    v_exp_f32 v54, v54
    v_exp_f32 v55, v55
    v_pk_fma_f32 v[56:57], v[144:145], v[254:255], v[230:231] op_sel_hi:[1,0,0] neg_lo:[0,0,1] neg_hi:[0,0,1]
    v_pk_fma_f32 v[64:65], v[144:145], v[254:255], v[238:239] op_sel_hi:[1,0,0] neg_lo:[1,0,0] neg_hi:[1,0,0]
    v_pk_fma_f32 v[58:59], v[146:147], v[254:255], v[230:231] op_sel_hi:[1,0,0] neg_lo:[0,0,1] neg_hi:[0,0,1]
    v_pk_fma_f32 v[66:67], v[146:147], v[254:255], v[238:239] op_sel_hi:[1,0,0] neg_lo:[1,0,0] neg_hi:[1,0,0]
    v_pk_fma_f32 v[60:61], v[148:149], v[254:255], v[230:231] op_sel_hi:[1,0,0] neg_lo:[0,0,1] neg_hi:[0,0,1]
    v_pk_fma_f32 v[68:69], v[148:149], v[254:255], v[238:239] op_sel_hi:[1,0,0] neg_lo:[1,0,0] neg_hi:[1,0,0]
    v_pk_fma_f32 v[62:63], v[150:151], v[254:255], v[230:231] op_sel_hi:[1,0,0] neg_lo:[0,0,1] neg_hi:[0,0,1]
    v_pk_fma_f32 v[70:71], v[150:151], v[254:255], v[238:239] op_sel_hi:[1,0,0] neg_lo:[1,0,0] neg_hi:[1,0,0]
    v_exp_f32 v56, v56
    v_exp_f32 v57, v57
    v_exp_f32 v58, v58
    v_exp_f32 v59, v59
    v_exp_f32 v60, v60
    v_exp_f32 v61, v61
    v_exp_f32 v62, v62
    v_exp_f32 v63, v63
    v_exp_f32 v64, v64
    v_exp_f32 v65, v65
    v_exp_f32 v66, v66
    v_exp_f32 v67, v67
    v_exp_f32 v68, v68
    v_exp_f32 v69, v69
    v_exp_f32 v70, v70
    v_exp_f32 v71, v71
    v_pk_add_f32 v[120:121], v[8:9], v[10:11]
    v_pk_add_f32 v[122:123], v[12:13], v[14:15]
    v_pk_add_f32 v[124:125], v[16:17], v[18:19]
    v_pk_add_f32 v[126:127], v[20:21], v[22:23]
    v_pk_add_f32 v[128:129], v[24:25], v[26:27]
    v_pk_add_f32 v[130:131], v[28:29], v[30:31]
    v_pk_add_f32 v[132:133], v[32:33], v[34:35]
    v_pk_add_f32 v[134:135], v[36:37], v[38:39]
    v_pk_add_f32 v[136:137], v[40:41], v[42:43]
    v_pk_add_f32 v[138:139], v[44:45], v[46:47]
    v_pk_add_f32 v[140:141], v[48:49], v[50:51]
    v_pk_add_f32 v[142:143], v[52:53], v[54:55]
    v_pk_add_f32 v[144:145], v[56:57], v[58:59]
    v_pk_add_f32 v[146:147], v[60:61], v[62:63]
    v_pk_add_f32 v[148:149], v[64:65], v[66:67]
    v_pk_add_f32 v[150:151], v[68:69], v[70:71]
    v_pk_add_f32 v[120:121], v[120:121], v[122:123]
    v_pk_add_f32 v[124:125], v[124:125], v[126:127]
    v_pk_add_f32 v[128:129], v[128:129], v[130:131]
    v_pk_add_f32 v[132:133], v[132:133], v[134:135]
    v_pk_add_f32 v[136:137], v[136:137], v[138:139]
    v_pk_add_f32 v[140:141], v[140:141], v[142:143]
    v_pk_add_f32 v[144:145], v[144:145], v[146:147]
    v_pk_add_f32 v[148:149], v[148:149], v[150:151]
    v_add_f32 v224, v120, v121
    v_add_f32 v232, v124, v125
    v_add_f32 v226, v128, v129
    v_add_f32 v234, v132, v133
    v_add_f32 v228, v136, v137
    v_add_f32 v236, v140, v141
    v_add_f32 v230, v144, v145
    v_add_f32 v238, v148, v149
    v_permlane32_swap_b32 v224, v228
    v_permlane32_swap_b32 v226, v230
    v_permlane32_swap_b32 v232, v236
    v_permlane32_swap_b32 v234, v238
    v_add_f32 v224, v224, v228
    v_add_f32 v226, v226, v230
    v_add_f32 v232, v232, v236
    v_add_f32 v234, v234, v238
    v_permlane16_swap_b32 v224, v226
    s_nop 0
    v_permlane16_swap_b32 v232, v234
    v_add_f32 v224, v224, v226
    v_add_f32 v232, v232, v234
    v_rcp_f32 v232, v232
    s_lshl_b32 s3, s29, 12
    s_add_u32 s3, s3, 149504
    v_add_u32 v240, s3, v5
    s_lshl_b32 s3, s29, 7
    s_add_u32 s3, s3, 157696
    v_lshl_add_u32 v241, v2, 3, s3
    v_mul_f32 v232, v232, v224
    v_mul_f32 v224, 0x358637bd, v224
    v_mov_b32 v226, v224
    v_mov_b32 v234, v232
    s_nop 0
    v_permlane16_swap_b32 v224, v226
    v_permlane16_swap_b32 v232, v234
    v_mov_b32 v228, v224
    v_mov_b32 v230, v226
    v_mov_b32 v236, v232
    v_mov_b32 v238, v234
    v_permlane32_swap_b32 v224, v228
    v_permlane32_swap_b32 v226, v230
    v_permlane32_swap_b32 v232, v236
    v_permlane32_swap_b32 v234, v238
    v_pk_mul_f32 v[16:17], v[16:17], v[232:233] op_sel_hi:[1,0]
    v_pk_mul_f32 v[18:19], v[18:19], v[232:233] op_sel_hi:[1,0]
    v_pk_mul_f32 v[20:21], v[20:21], v[232:233] op_sel_hi:[1,0]
    v_pk_mul_f32 v[22:23], v[22:23], v[232:233] op_sel_hi:[1,0]
    v_cvt_pk_bf16_f32 v72, v8, v9
    v_cvt_pk_bf16_f32 v73, v10, v11
    v_cvt_pk_bf16_f32 v74, v12, v13
    v_cvt_pk_bf16_f32 v75, v14, v15
    v_cvt_pk_bf16_f32 v76, v16, v17
    v_cvt_pk_bf16_f32 v77, v18, v19
    v_cvt_pk_bf16_f32 v78, v20, v21
    v_cvt_pk_bf16_f32 v79, v22, v23
    v_pk_mul_f32 v[32:33], v[32:33], v[234:235] op_sel_hi:[1,0]
    v_pk_mul_f32 v[34:35], v[34:35], v[234:235] op_sel_hi:[1,0]
    v_pk_mul_f32 v[36:37], v[36:37], v[234:235] op_sel_hi:[1,0]
    v_pk_mul_f32 v[38:39], v[38:39], v[234:235] op_sel_hi:[1,0]
    v_cvt_pk_bf16_f32 v80, v24, v25
    v_cvt_pk_bf16_f32 v81, v26, v27
    v_cvt_pk_bf16_f32 v82, v28, v29
    v_cvt_pk_bf16_f32 v83, v30, v31
    v_cvt_pk_bf16_f32 v84, v32, v33
    v_cvt_pk_bf16_f32 v85, v34, v35
    v_cvt_pk_bf16_f32 v86, v36, v37
    v_cvt_pk_bf16_f32 v87, v38, v39
    v_pk_mul_f32 v[48:49], v[48:49], v[236:237] op_sel_hi:[1,0]
    v_pk_mul_f32 v[50:51], v[50:51], v[236:237] op_sel_hi:[1,0]
    v_pk_mul_f32 v[52:53], v[52:53], v[236:237] op_sel_hi:[1,0]
    v_pk_mul_f32 v[54:55], v[54:55], v[236:237] op_sel_hi:[1,0]
    v_cvt_pk_bf16_f32 v88, v40, v41
    v_cvt_pk_bf16_f32 v89, v42, v43
    v_cvt_pk_bf16_f32 v90, v44, v45
    v_cvt_pk_bf16_f32 v91, v46, v47
    v_cvt_pk_bf16_f32 v92, v48, v49
    v_cvt_pk_bf16_f32 v93, v50, v51
    v_cvt_pk_bf16_f32 v94, v52, v53
    v_cvt_pk_bf16_f32 v95, v54, v55
    v_pk_mul_f32 v[64:65], v[64:65], v[238:239] op_sel_hi:[1,0]
    v_pk_mul_f32 v[66:67], v[66:67], v[238:239] op_sel_hi:[1,0]
    v_pk_mul_f32 v[68:69], v[68:69], v[238:239] op_sel_hi:[1,0]
    v_pk_mul_f32 v[70:71], v[70:71], v[238:239] op_sel_hi:[1,0]
    v_cvt_pk_bf16_f32 v96, v56, v57
    v_cvt_pk_bf16_f32 v97, v58, v59
    v_cvt_pk_bf16_f32 v98, v60, v61
    v_cvt_pk_bf16_f32 v99, v62, v63
    v_cvt_pk_bf16_f32 v100, v64, v65
    v_cvt_pk_bf16_f32 v101, v66, v67
    v_cvt_pk_bf16_f32 v102, v68, v69
    v_cvt_pk_bf16_f32 v103, v70, v71
    v_mov_b32 v40, v224
    v_mov_b32 v44, v226
    v_mov_b32 v48, v228
    v_mov_b32 v52, v230
    s_lshl_b32 s3, s36, 3
    s_lshl_b32 s65, s28, 2
    s_add_u32 s3, s3, s65
    s_lshl_b32 s3, s3, 5
    s_lshl_b32 s65, s37, 1
    s_add_u32 s65, s65, s29
    s_add_u32 s3, s3, s65
    s_lshl_b32 s3, s3, 10
    s_add_u32 s3, s3, 12582912
    s_lshl_b32 s66, s36, 4
    s_add_u32 s66, s66, s37
    s_lshl_b32 s66, s66, 7
    s_add_u32 s66, s66, 1310720
    s_lshl_b32 s65, s29, 2
    s_add_u32 s65, s65, 163104
    v_mov_b32 v6, s65
L_kv:
    ds_read_b32 v7, v6
    ds_read_b64 v[120:121], v241 offset:0
    ds_read_b64 v[122:123], v241 offset:32
    ds_read_b64 v[124:125], v241 offset:64
    ds_read_b64 v[126:127], v241 offset:96
    ds_read_b128 v[104:107], v240 offset:0
    ds_read_b128 v[108:111], v240 offset:1024
    ds_read_b128 v[112:115], v240 offset:2048
    ds_read_b128 v[116:119], v240 offset:3072
    s_waitcnt lgkmcnt(4)
    v_readfirstlane_b32 s65, v7
    s_nop 0
    s_cmp_eq_u32 s65, 1
    s_cbranch_scc1 L_kvd
L_kw:
    ds_read_b32 v7, v6
    s_waitcnt lgkmcnt(0)
    v_readfirstlane_b32 s65, v7
    s_nop 0
    s_cmp_eq_u32 s65, 1
    s_cbranch_scc1 L_kv
    s_branch L_kw
L_kvd:
    v_mfma_f32_16x16x32_bf16 v[40:43], v[120:123], v[72:75], v[40:43]
    v_mfma_f32_16x16x32_bf16 v[44:47], v[120:123], v[80:83], v[44:47]
    v_mfma_f32_16x16x32_bf16 v[48:51], v[120:123], v[88:91], v[48:51]
    v_mfma_f32_16x16x32_bf16 v[52:55], v[120:123], v[96:99], v[52:55]
    v_mfma_f32_16x16x32_bf16 v[40:43], v[124:127], v[76:79], v[40:43]
    v_mfma_f32_16x16x32_bf16 v[44:47], v[124:127], v[84:87], v[44:47]
    v_mfma_f32_16x16x32_bf16 v[48:51], v[124:127], v[92:95], v[48:51]
    v_mfma_f32_16x16x32_bf16 v[52:55], v[124:127], v[100:103], v[52:55]
    s_waitcnt lgkmcnt(0)
    v_mfma_f32_16x16x32_bf16 v[8:11], v[104:107], v[72:75], 0
    v_mfma_f32_16x16x32_bf16 v[12:15], v[108:111], v[72:75], 0
    v_mfma_f32_16x16x32_bf16 v[8:11], v[112:115], v[76:79], v[8:11]
    v_mfma_f32_16x16x32_bf16 v[12:15], v[116:119], v[76:79], v[12:15]
    v_mfma_f32_16x16x32_bf16 v[16:19], v[104:107], v[80:83], 0
    v_rcp_f32 v40, v40
    v_mfma_f32_16x16x32_bf16 v[20:23], v[108:111], v[80:83], 0
    v_rcp_f32 v44, v44
    v_mfma_f32_16x16x32_bf16 v[16:19], v[112:115], v[84:87], v[16:19]
    v_rcp_f32 v48, v48
    v_mfma_f32_16x16x32_bf16 v[20:23], v[116:119], v[84:87], v[20:23]
    v_rcp_f32 v52, v52
    v_mfma_f32_16x16x32_bf16 v[24:27], v[104:107], v[88:91], 0
    v_mfma_f32_16x16x32_bf16 v[28:31], v[108:111], v[88:91], 0
    v_mul_f32 v8, v8, v40
    v_mul_f32 v9, v9, v40
    v_mul_f32 v10, v10, v40
    v_mfma_f32_16x16x32_bf16 v[24:27], v[112:115], v[92:95], v[24:27]
    v_mul_f32 v11, v11, v40
    v_mul_f32 v12, v12, v40
    v_mul_f32 v13, v13, v40
    v_mfma_f32_16x16x32_bf16 v[28:31], v[116:119], v[92:95], v[28:31]
    v_mul_f32 v14, v14, v40
    v_mul_f32 v15, v15, v40
    v_cvt_pk_bf16_f32 v128, v8, v9
    v_mfma_f32_16x16x32_bf16 v[32:35], v[104:107], v[96:99], 0
    v_cvt_pk_bf16_f32 v129, v10, v11
    v_cvt_pk_bf16_f32 v130, v12, v13
    v_cvt_pk_bf16_f32 v131, v14, v15
    v_mfma_f32_16x16x32_bf16 v[36:39], v[108:111], v[96:99], 0
    buffer_store_dwordx4 v[128:131], v5, s[12:15], s3 offen sc1
    s_add_u32 s3, s3, 32768
    v_mul_f32 v16, v16, v44
    v_mfma_f32_16x16x32_bf16 v[32:35], v[112:115], v[100:103], v[32:35]
    v_mul_f32 v17, v17, v44
    v_mul_f32 v18, v18, v44
    v_mul_f32 v19, v19, v44
    v_mfma_f32_16x16x32_bf16 v[36:39], v[116:119], v[100:103], v[36:39]
    v_mul_f32 v20, v20, v44
    v_mul_f32 v21, v21, v44
    v_mul_f32 v22, v22, v44
    v_mul_f32 v23, v23, v44
    v_cvt_pk_bf16_f32 v132, v16, v17
    v_cvt_pk_bf16_f32 v133, v18, v19
    v_cvt_pk_bf16_f32 v134, v20, v21
    v_cvt_pk_bf16_f32 v135, v22, v23
    buffer_store_dwordx4 v[132:135], v5, s[12:15], s3 offen sc1
    s_add_u32 s3, s3, 32768
    v_pk_mul_f32 v[24:25], v[24:25], v[48:49] op_sel_hi:[1,0]
    v_pk_mul_f32 v[26:27], v[26:27], v[48:49] op_sel_hi:[1,0]
    v_pk_mul_f32 v[28:29], v[28:29], v[48:49] op_sel_hi:[1,0]
    v_pk_mul_f32 v[30:31], v[30:31], v[48:49] op_sel_hi:[1,0]
    v_cvt_pk_bf16_f32 v136, v24, v25
    v_cvt_pk_bf16_f32 v137, v26, v27
    v_cvt_pk_bf16_f32 v138, v28, v29
    v_cvt_pk_bf16_f32 v139, v30, v31
    buffer_store_dwordx4 v[136:139], v5, s[12:15], s3 offen sc1
    s_add_u32 s3, s3, 32768
    v_pk_mul_f32 v[32:33], v[32:33], v[52:53] op_sel_hi:[1,0]
    v_pk_mul_f32 v[34:35], v[34:35], v[52:53] op_sel_hi:[1,0]
    v_pk_mul_f32 v[36:37], v[36:37], v[52:53] op_sel_hi:[1,0]
    v_pk_mul_f32 v[38:39], v[38:39], v[52:53] op_sel_hi:[1,0]
    v_cvt_pk_bf16_f32 v140, v32, v33
    v_cvt_pk_bf16_f32 v141, v34, v35
    v_cvt_pk_bf16_f32 v142, v36, v37
    v_cvt_pk_bf16_f32 v143, v38, v39
    buffer_store_dwordx4 v[140:143], v5, s[12:15], s3 offen sc1
    s_add_u32 s3, s3, 32768
    v_lshrrev_b32 v6, 2, v1
    v_lshlrev_b32 v6, 7, v6
    v_and_b32 v7, 3, v1
    v_lshl_add_u32 v6, v7, 3, v6
    v_bfe_u32 v7, v1, 3, 2
    v_xor_b32 v4, 0, v7
    v_lshl_add_u32 v250, v4, 5, v6
    v_xor_b32 v4, 1, v7
    v_lshl_add_u32 v251, v4, 5, v6
    v_xor_b32 v4, 2, v7
    v_lshl_add_u32 v252, v4, 5, v6
    v_xor_b32 v4, 3, v7
    v_lshl_add_u32 v253, v4, 5, v6
    s_lshl_b32 s72, s30, 3
    s_lshl_b32 s3, s38, 1
    s_add_u32 s72, s72, s3
    s_lshl_b32 s72, s72, 15
    s_add_u32 s72, s72, 12582912
    v_add_u32 v4, 32768, v5
    s_mul_i32 s3, s38, 4608
    s_add_u32 s3, s3, 131072
    v_mul_u32_u24 v6, 144, v3
    v_lshl_add_u32 v6, v2, 3, v6
    v_add_u32 v240, s3, v6
    v_mov_b32 v160, s32
    v_mov_b32 v161, s32
    v_mov_b32 v162, s32
    v_mov_b32 v163, s32
    v_mov_b32 v164, 163104
    v_mov_b32 v165, 1
    s_waitcnt vmcnt(0)
    s_mov_b64 exec, 1
    ds_add_rtn_u32 v166, v164, v165 offset:96
    s_waitcnt lgkmcnt(0)
    v_readfirstlane_b32 s3, v166
    s_mov_b64 exec, 0xff
    s_cmp_lg_u32 s3, 3
    s_cbranch_scc1 L_nof
    buffer_store_dwordx4 v[160:163], v5, s[12:15], s66 offen sc1
L_nof:
    s_mov_b64 exec, -1
    s_cmp_lg_u32 s38, 0
    s_cbranch_scc1 L_gw
    s_lshl_b32 s73, s30, 11
    s_add_u32 s73, s73, 1310720
    v_lshlrev_b32 v6, 7, v3
    s_sleep 8
    buffer_load_dword v7, v6, s[12:15], s73 offen sc1
    s_waitcnt vmcnt(0)
L_op:
    v_xor_b32 v7, s32, v7
    v_cmp_ne_u32 vcc, 0, v7
    s_nop 0
    s_cmp_eq_u64 vcc, 0
    s_cbranch_scc1 L_opok
    s_add_u32 s70, s70, 1
    s_cmp_ge_u32 s70, 200000
    s_cbranch_scc1 L_opok
    s_sleep 4
    buffer_load_dword v7, v6, s[12:15], s73 offen sc1
    s_waitcnt vmcnt(0)
    s_branch L_op
L_opok:
    ds_write_b32 v164, v165 offset:100
    s_branch L_gd
L_gw:
    ds_read_b32 v166, v164 offset:100
    s_waitcnt lgkmcnt(0)
    v_readfirstlane_b32 s3, v166
    s_nop 0
    s_cmp_eq_u32 s3, 1
    s_cbranch_scc1 L_gd
    s_sleep 1
    s_branch L_gw
L_gd:
    buffer_load_dwordx4 v[72:75], v5, s[12:15], s72 offen offset:0 sc1
    buffer_load_dwordx4 v[76:79], v4, s[12:15], s72 offen offset:0 sc1
    buffer_load_dwordx4 v[80:83], v5, s[12:15], s72 offen offset:1024 sc1
    buffer_load_dwordx4 v[84:87], v4, s[12:15], s72 offen offset:1024 sc1
    buffer_load_dwordx4 v[88:91], v5, s[12:15], s72 offen offset:2048 sc1
    buffer_load_dwordx4 v[92:95], v4, s[12:15], s72 offen offset:2048 sc1
    buffer_load_dwordx4 v[96:99], v5, s[12:15], s72 offen offset:3072 sc1
    buffer_load_dwordx4 v[100:103], v4, s[12:15], s72 offen offset:3072 sc1
    s_add_u32 s72, s72, 4096
    buffer_load_dwordx4 v[104:107], v5, s[12:15], s72 offen offset:0 sc1
    buffer_load_dwordx4 v[108:111], v4, s[12:15], s72 offen offset:0 sc1
    buffer_load_dwordx4 v[112:115], v5, s[12:15], s72 offen offset:1024 sc1
    buffer_load_dwordx4 v[116:119], v4, s[12:15], s72 offen offset:1024 sc1
    v_mov_b32 v6, 163104
L_wl:
    ds_read_b128 v[40:43], v6 offset:112
    s_waitcnt lgkmcnt(0)
    v_and_b32 v40, v40, v41
    v_and_b32 v42, v42, v43
    v_and_b32 v40, v40, v42
    s_nop 0
    v_readfirstlane_b32 s65, v40
    s_nop 0
    s_cmp_eq_u32 s65, 1
    s_cbranch_scc0 L_wl
    ds_read_b64_tr_b16 v[40:41], v250 offset:0
    ds_read_b64_tr_b16 v[42:43], v250 offset:2048
    ds_read_b64_tr_b16 v[44:45], v251 offset:0
    ds_read_b64_tr_b16 v[46:47], v251 offset:2048
    ds_read_b64_tr_b16 v[48:49], v252 offset:0
    ds_read_b64_tr_b16 v[50:51], v252 offset:2048
    ds_read_b64_tr_b16 v[52:53], v253 offset:0
    ds_read_b64_tr_b16 v[54:55], v253 offset:2048
    buffer_load_dwordx4 v[120:123], v5, s[12:15], s72 offen offset:2048 sc1
    buffer_load_dwordx4 v[124:127], v4, s[12:15], s72 offen offset:2048 sc1
    s_waitcnt vmcnt(12)
    s_waitcnt lgkmcnt(0)
    v_mfma_f32_16x16x32_bf16 v[8:11], v[40:43], v[72:75], 0
    ds_read_b64_tr_b16 v[56:57], v250 offset:4096
    v_mfma_f32_16x16x32_bf16 v[12:15], v[44:47], v[72:75], 0
    ds_read_b64_tr_b16 v[58:59], v250 offset:6144
    v_mfma_f32_16x16x32_bf16 v[16:19], v[48:51], v[72:75], 0
    ds_read_b64_tr_b16 v[60:61], v251 offset:4096
    v_mfma_f32_16x16x32_bf16 v[20:23], v[52:55], v[72:75], 0
    ds_read_b64_tr_b16 v[62:63], v251 offset:6144
    v_mfma_f32_16x16x32_bf16 v[24:27], v[40:43], v[76:79], 0
    ds_read_b64_tr_b16 v[64:65], v252 offset:4096
    v_mfma_f32_16x16x32_bf16 v[28:31], v[44:47], v[76:79], 0
    ds_read_b64_tr_b16 v[66:67], v252 offset:6144
    v_mfma_f32_16x16x32_bf16 v[32:35], v[48:51], v[76:79], 0
    ds_read_b64_tr_b16 v[68:69], v253 offset:4096
    v_mfma_f32_16x16x32_bf16 v[36:39], v[52:55], v[76:79], 0
    ds_read_b64_tr_b16 v[70:71], v253 offset:6144
    buffer_load_dwordx4 v[72:75], v5, s[12:15], s72 offen offset:3072 sc1
    buffer_load_dwordx4 v[76:79], v4, s[12:15], s72 offen offset:3072 sc1
    s_add_u32 s72, s72, 4096
    s_waitcnt vmcnt(12)
    s_waitcnt lgkmcnt(0)
    v_mfma_f32_16x16x32_bf16 v[8:11], v[56:59], v[80:83], v[8:11]
    ds_read_b64_tr_b16 v[40:41], v250 offset:8192
    v_mfma_f32_16x16x32_bf16 v[12:15], v[60:63], v[80:83], v[12:15]
    ds_read_b64_tr_b16 v[42:43], v250 offset:10240
    v_mfma_f32_16x16x32_bf16 v[16:19], v[64:67], v[80:83], v[16:19]
    ds_read_b64_tr_b16 v[44:45], v251 offset:8192
    v_mfma_f32_16x16x32_bf16 v[20:23], v[68:71], v[80:83], v[20:23]
    ds_read_b64_tr_b16 v[46:47], v251 offset:10240
    v_mfma_f32_16x16x32_bf16 v[24:27], v[56:59], v[84:87], v[24:27]
    ds_read_b64_tr_b16 v[48:49], v252 offset:8192
    v_mfma_f32_16x16x32_bf16 v[28:31], v[60:63], v[84:87], v[28:31]
    ds_read_b64_tr_b16 v[50:51], v252 offset:10240
    v_mfma_f32_16x16x32_bf16 v[32:35], v[64:67], v[84:87], v[32:35]
    ds_read_b64_tr_b16 v[52:53], v253 offset:8192
    v_mfma_f32_16x16x32_bf16 v[36:39], v[68:71], v[84:87], v[36:39]
    ds_read_b64_tr_b16 v[54:55], v253 offset:10240
    buffer_load_dwordx4 v[80:83], v5, s[12:15], s72 offen offset:0 sc1
    buffer_load_dwordx4 v[84:87], v4, s[12:15], s72 offen offset:0 sc1
    s_waitcnt vmcnt(12)
    s_waitcnt lgkmcnt(0)
    v_mfma_f32_16x16x32_bf16 v[8:11], v[40:43], v[88:91], v[8:11]
    ds_read_b64_tr_b16 v[56:57], v250 offset:12288
    v_mfma_f32_16x16x32_bf16 v[12:15], v[44:47], v[88:91], v[12:15]
    ds_read_b64_tr_b16 v[58:59], v250 offset:14336
    v_mfma_f32_16x16x32_bf16 v[16:19], v[48:51], v[88:91], v[16:19]
    ds_read_b64_tr_b16 v[60:61], v251 offset:12288
    v_mfma_f32_16x16x32_bf16 v[20:23], v[52:55], v[88:91], v[20:23]
    ds_read_b64_tr_b16 v[62:63], v251 offset:14336
    v_mfma_f32_16x16x32_bf16 v[24:27], v[40:43], v[92:95], v[24:27]
    ds_read_b64_tr_b16 v[64:65], v252 offset:12288
    v_mfma_f32_16x16x32_bf16 v[28:31], v[44:47], v[92:95], v[28:31]
    ds_read_b64_tr_b16 v[66:67], v252 offset:14336
    v_mfma_f32_16x16x32_bf16 v[32:35], v[48:51], v[92:95], v[32:35]
    ds_read_b64_tr_b16 v[68:69], v253 offset:12288
    v_mfma_f32_16x16x32_bf16 v[36:39], v[52:55], v[92:95], v[36:39]
    ds_read_b64_tr_b16 v[70:71], v253 offset:14336
    buffer_load_dwordx4 v[88:91], v5, s[12:15], s72 offen offset:1024 sc1
    buffer_load_dwordx4 v[92:95], v4, s[12:15], s72 offen offset:1024 sc1
    s_waitcnt vmcnt(12)
    s_waitcnt lgkmcnt(0)
    v_mfma_f32_16x16x32_bf16 v[8:11], v[56:59], v[96:99], v[8:11]
    ds_read_b64_tr_b16 v[40:41], v250 offset:16384
    v_mfma_f32_16x16x32_bf16 v[12:15], v[60:63], v[96:99], v[12:15]
    ds_read_b64_tr_b16 v[42:43], v250 offset:18432
    v_mfma_f32_16x16x32_bf16 v[16:19], v[64:67], v[96:99], v[16:19]
    ds_read_b64_tr_b16 v[44:45], v251 offset:16384
    v_mfma_f32_16x16x32_bf16 v[20:23], v[68:71], v[96:99], v[20:23]
    ds_read_b64_tr_b16 v[46:47], v251 offset:18432
    v_mfma_f32_16x16x32_bf16 v[24:27], v[56:59], v[100:103], v[24:27]
    ds_read_b64_tr_b16 v[48:49], v252 offset:16384
    v_mfma_f32_16x16x32_bf16 v[28:31], v[60:63], v[100:103], v[28:31]
    ds_read_b64_tr_b16 v[50:51], v252 offset:18432
    v_mfma_f32_16x16x32_bf16 v[32:35], v[64:67], v[100:103], v[32:35]
    ds_read_b64_tr_b16 v[52:53], v253 offset:16384
    v_mfma_f32_16x16x32_bf16 v[36:39], v[68:71], v[100:103], v[36:39]
    ds_read_b64_tr_b16 v[54:55], v253 offset:18432
    buffer_load_dwordx4 v[96:99], v5, s[12:15], s72 offen offset:2048 sc1
    buffer_load_dwordx4 v[100:103], v4, s[12:15], s72 offen offset:2048 sc1
    s_waitcnt vmcnt(12)
    s_waitcnt lgkmcnt(0)
    v_mfma_f32_16x16x32_bf16 v[8:11], v[40:43], v[104:107], v[8:11]
    ds_read_b64_tr_b16 v[56:57], v250 offset:20480
    v_mfma_f32_16x16x32_bf16 v[12:15], v[44:47], v[104:107], v[12:15]
    ds_read_b64_tr_b16 v[58:59], v250 offset:22528
    v_mfma_f32_16x16x32_bf16 v[16:19], v[48:51], v[104:107], v[16:19]
    ds_read_b64_tr_b16 v[60:61], v251 offset:20480
    v_mfma_f32_16x16x32_bf16 v[20:23], v[52:55], v[104:107], v[20:23]
    ds_read_b64_tr_b16 v[62:63], v251 offset:22528
    v_mfma_f32_16x16x32_bf16 v[24:27], v[40:43], v[108:111], v[24:27]
    ds_read_b64_tr_b16 v[64:65], v252 offset:20480
    v_mfma_f32_16x16x32_bf16 v[28:31], v[44:47], v[108:111], v[28:31]
    ds_read_b64_tr_b16 v[66:67], v252 offset:22528
    v_mfma_f32_16x16x32_bf16 v[32:35], v[48:51], v[108:111], v[32:35]
    ds_read_b64_tr_b16 v[68:69], v253 offset:20480
    v_mfma_f32_16x16x32_bf16 v[36:39], v[52:55], v[108:111], v[36:39]
    ds_read_b64_tr_b16 v[70:71], v253 offset:22528
    buffer_load_dwordx4 v[104:107], v5, s[12:15], s72 offen offset:3072 sc1
    buffer_load_dwordx4 v[108:111], v4, s[12:15], s72 offen offset:3072 sc1
    s_add_u32 s72, s72, 4096
    s_waitcnt vmcnt(12)
    s_waitcnt lgkmcnt(0)
    v_mfma_f32_16x16x32_bf16 v[8:11], v[56:59], v[112:115], v[8:11]
    ds_read_b64_tr_b16 v[40:41], v250 offset:24576
    v_mfma_f32_16x16x32_bf16 v[12:15], v[60:63], v[112:115], v[12:15]
    ds_read_b64_tr_b16 v[42:43], v250 offset:26624
    v_mfma_f32_16x16x32_bf16 v[16:19], v[64:67], v[112:115], v[16:19]
    ds_read_b64_tr_b16 v[44:45], v251 offset:24576
    v_mfma_f32_16x16x32_bf16 v[20:23], v[68:71], v[112:115], v[20:23]
    ds_read_b64_tr_b16 v[46:47], v251 offset:26624
    v_mfma_f32_16x16x32_bf16 v[24:27], v[56:59], v[116:119], v[24:27]
    ds_read_b64_tr_b16 v[48:49], v252 offset:24576
    v_mfma_f32_16x16x32_bf16 v[28:31], v[60:63], v[116:119], v[28:31]
    ds_read_b64_tr_b16 v[50:51], v252 offset:26624
    v_mfma_f32_16x16x32_bf16 v[32:35], v[64:67], v[116:119], v[32:35]
    ds_read_b64_tr_b16 v[52:53], v253 offset:24576
    v_mfma_f32_16x16x32_bf16 v[36:39], v[68:71], v[116:119], v[36:39]
    ds_read_b64_tr_b16 v[54:55], v253 offset:26624
    buffer_load_dwordx4 v[112:115], v5, s[12:15], s72 offen offset:0 sc1
    buffer_load_dwordx4 v[116:119], v4, s[12:15], s72 offen offset:0 sc1
    s_waitcnt vmcnt(12)
    s_waitcnt lgkmcnt(0)
    v_mfma_f32_16x16x32_bf16 v[8:11], v[40:43], v[120:123], v[8:11]
    ds_read_b64_tr_b16 v[56:57], v250 offset:28672
    v_mfma_f32_16x16x32_bf16 v[12:15], v[44:47], v[120:123], v[12:15]
    ds_read_b64_tr_b16 v[58:59], v250 offset:30720
    v_mfma_f32_16x16x32_bf16 v[16:19], v[48:51], v[120:123], v[16:19]
    ds_read_b64_tr_b16 v[60:61], v251 offset:28672
    v_mfma_f32_16x16x32_bf16 v[20:23], v[52:55], v[120:123], v[20:23]
    ds_read_b64_tr_b16 v[62:63], v251 offset:30720
    v_mfma_f32_16x16x32_bf16 v[24:27], v[40:43], v[124:127], v[24:27]
    ds_read_b64_tr_b16 v[64:65], v252 offset:28672
    v_mfma_f32_16x16x32_bf16 v[28:31], v[44:47], v[124:127], v[28:31]
    ds_read_b64_tr_b16 v[66:67], v252 offset:30720
    v_mfma_f32_16x16x32_bf16 v[32:35], v[48:51], v[124:127], v[32:35]
    ds_read_b64_tr_b16 v[68:69], v253 offset:28672
    v_mfma_f32_16x16x32_bf16 v[36:39], v[52:55], v[124:127], v[36:39]
    ds_read_b64_tr_b16 v[70:71], v253 offset:30720
    buffer_load_dwordx4 v[120:123], v5, s[12:15], s72 offen offset:1024 sc1
    buffer_load_dwordx4 v[124:127], v4, s[12:15], s72 offen offset:1024 sc1
    s_waitcnt vmcnt(12)
    s_waitcnt lgkmcnt(0)
    v_mfma_f32_16x16x32_bf16 v[8:11], v[56:59], v[72:75], v[8:11]
    ds_read_b64_tr_b16 v[40:41], v250 offset:32768
    v_mfma_f32_16x16x32_bf16 v[12:15], v[60:63], v[72:75], v[12:15]
    ds_read_b64_tr_b16 v[42:43], v250 offset:34816
    v_mfma_f32_16x16x32_bf16 v[16:19], v[64:67], v[72:75], v[16:19]
    ds_read_b64_tr_b16 v[44:45], v251 offset:32768
    v_mfma_f32_16x16x32_bf16 v[20:23], v[68:71], v[72:75], v[20:23]
    ds_read_b64_tr_b16 v[46:47], v251 offset:34816
    v_mfma_f32_16x16x32_bf16 v[24:27], v[56:59], v[76:79], v[24:27]
    ds_read_b64_tr_b16 v[48:49], v252 offset:32768
    v_mfma_f32_16x16x32_bf16 v[28:31], v[60:63], v[76:79], v[28:31]
    ds_read_b64_tr_b16 v[50:51], v252 offset:34816
    v_mfma_f32_16x16x32_bf16 v[32:35], v[64:67], v[76:79], v[32:35]
    ds_read_b64_tr_b16 v[52:53], v253 offset:32768
    v_mfma_f32_16x16x32_bf16 v[36:39], v[68:71], v[76:79], v[36:39]
    ds_read_b64_tr_b16 v[54:55], v253 offset:34816
    buffer_load_dwordx4 v[72:75], v5, s[12:15], s72 offen offset:2048 sc1
    buffer_load_dwordx4 v[76:79], v4, s[12:15], s72 offen offset:2048 sc1
    s_waitcnt vmcnt(12)
    s_waitcnt lgkmcnt(0)
    v_mfma_f32_16x16x32_bf16 v[8:11], v[40:43], v[80:83], v[8:11]
    ds_read_b64_tr_b16 v[56:57], v250 offset:36864
    v_mfma_f32_16x16x32_bf16 v[12:15], v[44:47], v[80:83], v[12:15]
    ds_read_b64_tr_b16 v[58:59], v250 offset:38912
    v_mfma_f32_16x16x32_bf16 v[16:19], v[48:51], v[80:83], v[16:19]
    ds_read_b64_tr_b16 v[60:61], v251 offset:36864
    v_mfma_f32_16x16x32_bf16 v[20:23], v[52:55], v[80:83], v[20:23]
    ds_read_b64_tr_b16 v[62:63], v251 offset:38912
    v_mfma_f32_16x16x32_bf16 v[24:27], v[40:43], v[84:87], v[24:27]
    ds_read_b64_tr_b16 v[64:65], v252 offset:36864
    v_mfma_f32_16x16x32_bf16 v[28:31], v[44:47], v[84:87], v[28:31]
    ds_read_b64_tr_b16 v[66:67], v252 offset:38912
    v_mfma_f32_16x16x32_bf16 v[32:35], v[48:51], v[84:87], v[32:35]
    ds_read_b64_tr_b16 v[68:69], v253 offset:36864
    v_mfma_f32_16x16x32_bf16 v[36:39], v[52:55], v[84:87], v[36:39]
    ds_read_b64_tr_b16 v[70:71], v253 offset:38912
    buffer_load_dwordx4 v[80:83], v5, s[12:15], s72 offen offset:3072 sc1
    buffer_load_dwordx4 v[84:87], v4, s[12:15], s72 offen offset:3072 sc1
    s_add_u32 s72, s72, 4096
    s_waitcnt vmcnt(12)
    s_waitcnt lgkmcnt(0)
    v_mfma_f32_16x16x32_bf16 v[8:11], v[56:59], v[88:91], v[8:11]
    ds_read_b64_tr_b16 v[40:41], v250 offset:40960
    v_mfma_f32_16x16x32_bf16 v[12:15], v[60:63], v[88:91], v[12:15]
    ds_read_b64_tr_b16 v[42:43], v250 offset:43008
    v_mfma_f32_16x16x32_bf16 v[16:19], v[64:67], v[88:91], v[16:19]
    ds_read_b64_tr_b16 v[44:45], v251 offset:40960
    v_mfma_f32_16x16x32_bf16 v[20:23], v[68:71], v[88:91], v[20:23]
    ds_read_b64_tr_b16 v[46:47], v251 offset:43008
    v_mfma_f32_16x16x32_bf16 v[24:27], v[56:59], v[92:95], v[24:27]
    ds_read_b64_tr_b16 v[48:49], v252 offset:40960
    v_mfma_f32_16x16x32_bf16 v[28:31], v[60:63], v[92:95], v[28:31]
    ds_read_b64_tr_b16 v[50:51], v252 offset:43008
    v_mfma_f32_16x16x32_bf16 v[32:35], v[64:67], v[92:95], v[32:35]
    ds_read_b64_tr_b16 v[52:53], v253 offset:40960
    v_mfma_f32_16x16x32_bf16 v[36:39], v[68:71], v[92:95], v[36:39]
    ds_read_b64_tr_b16 v[54:55], v253 offset:43008
    buffer_load_dwordx4 v[88:91], v5, s[12:15], s72 offen offset:0 sc1
    buffer_load_dwordx4 v[92:95], v4, s[12:15], s72 offen offset:0 sc1
    s_waitcnt vmcnt(12)
    s_waitcnt lgkmcnt(0)
    v_mfma_f32_16x16x32_bf16 v[8:11], v[40:43], v[96:99], v[8:11]
    ds_read_b64_tr_b16 v[56:57], v250 offset:45056
    v_mfma_f32_16x16x32_bf16 v[12:15], v[44:47], v[96:99], v[12:15]
    ds_read_b64_tr_b16 v[58:59], v250 offset:47104
    v_mfma_f32_16x16x32_bf16 v[16:19], v[48:51], v[96:99], v[16:19]
    ds_read_b64_tr_b16 v[60:61], v251 offset:45056
    v_mfma_f32_16x16x32_bf16 v[20:23], v[52:55], v[96:99], v[20:23]
    ds_read_b64_tr_b16 v[62:63], v251 offset:47104
    v_mfma_f32_16x16x32_bf16 v[24:27], v[40:43], v[100:103], v[24:27]
    ds_read_b64_tr_b16 v[64:65], v252 offset:45056
    v_mfma_f32_16x16x32_bf16 v[28:31], v[44:47], v[100:103], v[28:31]
    ds_read_b64_tr_b16 v[66:67], v252 offset:47104
    v_mfma_f32_16x16x32_bf16 v[32:35], v[48:51], v[100:103], v[32:35]
    ds_read_b64_tr_b16 v[68:69], v253 offset:45056
    v_mfma_f32_16x16x32_bf16 v[36:39], v[52:55], v[100:103], v[36:39]
    ds_read_b64_tr_b16 v[70:71], v253 offset:47104
    buffer_load_dwordx4 v[96:99], v5, s[12:15], s72 offen offset:1024 sc1
    buffer_load_dwordx4 v[100:103], v4, s[12:15], s72 offen offset:1024 sc1
    s_waitcnt vmcnt(12)
    s_waitcnt lgkmcnt(0)
    v_mfma_f32_16x16x32_bf16 v[8:11], v[56:59], v[104:107], v[8:11]
    ds_read_b64_tr_b16 v[40:41], v250 offset:49152
    v_mfma_f32_16x16x32_bf16 v[12:15], v[60:63], v[104:107], v[12:15]
    ds_read_b64_tr_b16 v[42:43], v250 offset:51200
    v_mfma_f32_16x16x32_bf16 v[16:19], v[64:67], v[104:107], v[16:19]
    ds_read_b64_tr_b16 v[44:45], v251 offset:49152
    v_mfma_f32_16x16x32_bf16 v[20:23], v[68:71], v[104:107], v[20:23]
    ds_read_b64_tr_b16 v[46:47], v251 offset:51200
    v_mfma_f32_16x16x32_bf16 v[24:27], v[56:59], v[108:111], v[24:27]
    ds_read_b64_tr_b16 v[48:49], v252 offset:49152
    v_mfma_f32_16x16x32_bf16 v[28:31], v[60:63], v[108:111], v[28:31]
    ds_read_b64_tr_b16 v[50:51], v252 offset:51200
    v_mfma_f32_16x16x32_bf16 v[32:35], v[64:67], v[108:111], v[32:35]
    ds_read_b64_tr_b16 v[52:53], v253 offset:49152
    v_mfma_f32_16x16x32_bf16 v[36:39], v[68:71], v[108:111], v[36:39]
    ds_read_b64_tr_b16 v[54:55], v253 offset:51200
    buffer_load_dwordx4 v[104:107], v5, s[12:15], s72 offen offset:2048 sc1
    buffer_load_dwordx4 v[108:111], v4, s[12:15], s72 offen offset:2048 sc1
    s_waitcnt vmcnt(12)
    s_waitcnt lgkmcnt(0)
    v_mfma_f32_16x16x32_bf16 v[8:11], v[40:43], v[112:115], v[8:11]
    ds_read_b64_tr_b16 v[56:57], v250 offset:53248
    v_mfma_f32_16x16x32_bf16 v[12:15], v[44:47], v[112:115], v[12:15]
    ds_read_b64_tr_b16 v[58:59], v250 offset:55296
    v_mfma_f32_16x16x32_bf16 v[16:19], v[48:51], v[112:115], v[16:19]
    ds_read_b64_tr_b16 v[60:61], v251 offset:53248
    v_mfma_f32_16x16x32_bf16 v[20:23], v[52:55], v[112:115], v[20:23]
    ds_read_b64_tr_b16 v[62:63], v251 offset:55296
    v_mfma_f32_16x16x32_bf16 v[24:27], v[40:43], v[116:119], v[24:27]
    ds_read_b64_tr_b16 v[64:65], v252 offset:53248
    v_mfma_f32_16x16x32_bf16 v[28:31], v[44:47], v[116:119], v[28:31]
    ds_read_b64_tr_b16 v[66:67], v252 offset:55296
    v_mfma_f32_16x16x32_bf16 v[32:35], v[48:51], v[116:119], v[32:35]
    ds_read_b64_tr_b16 v[68:69], v253 offset:53248
    v_mfma_f32_16x16x32_bf16 v[36:39], v[52:55], v[116:119], v[36:39]
    ds_read_b64_tr_b16 v[70:71], v253 offset:55296
    buffer_load_dwordx4 v[112:115], v5, s[12:15], s72 offen offset:3072 sc1
    buffer_load_dwordx4 v[116:119], v4, s[12:15], s72 offen offset:3072 sc1
    s_add_u32 s72, s72, 4096
    s_waitcnt vmcnt(12)
    s_waitcnt lgkmcnt(0)
    v_mfma_f32_16x16x32_bf16 v[8:11], v[56:59], v[120:123], v[8:11]
    ds_read_b64_tr_b16 v[40:41], v250 offset:57344
    v_mfma_f32_16x16x32_bf16 v[12:15], v[60:63], v[120:123], v[12:15]
    ds_read_b64_tr_b16 v[42:43], v250 offset:59392
    v_mfma_f32_16x16x32_bf16 v[16:19], v[64:67], v[120:123], v[16:19]
    ds_read_b64_tr_b16 v[44:45], v251 offset:57344
    v_mfma_f32_16x16x32_bf16 v[20:23], v[68:71], v[120:123], v[20:23]
    ds_read_b64_tr_b16 v[46:47], v251 offset:59392
    v_mfma_f32_16x16x32_bf16 v[24:27], v[56:59], v[124:127], v[24:27]
    ds_read_b64_tr_b16 v[48:49], v252 offset:57344
    v_mfma_f32_16x16x32_bf16 v[28:31], v[60:63], v[124:127], v[28:31]
    ds_read_b64_tr_b16 v[50:51], v252 offset:59392
    v_mfma_f32_16x16x32_bf16 v[32:35], v[64:67], v[124:127], v[32:35]
    ds_read_b64_tr_b16 v[52:53], v253 offset:57344
    v_mfma_f32_16x16x32_bf16 v[36:39], v[68:71], v[124:127], v[36:39]
    ds_read_b64_tr_b16 v[54:55], v253 offset:59392
    buffer_load_dwordx4 v[120:123], v5, s[12:15], s72 offen offset:0 sc1
    buffer_load_dwordx4 v[124:127], v4, s[12:15], s72 offen offset:0 sc1
    s_waitcnt vmcnt(12)
    s_waitcnt lgkmcnt(0)
    v_mfma_f32_16x16x32_bf16 v[8:11], v[40:43], v[72:75], v[8:11]
    ds_read_b64_tr_b16 v[56:57], v250 offset:61440
    v_mfma_f32_16x16x32_bf16 v[12:15], v[44:47], v[72:75], v[12:15]
    ds_read_b64_tr_b16 v[58:59], v250 offset:63488
    v_mfma_f32_16x16x32_bf16 v[16:19], v[48:51], v[72:75], v[16:19]
    ds_read_b64_tr_b16 v[60:61], v251 offset:61440
    v_mfma_f32_16x16x32_bf16 v[20:23], v[52:55], v[72:75], v[20:23]
    ds_read_b64_tr_b16 v[62:63], v251 offset:63488
    v_mfma_f32_16x16x32_bf16 v[24:27], v[40:43], v[76:79], v[24:27]
    ds_read_b64_tr_b16 v[64:65], v252 offset:61440
    v_mfma_f32_16x16x32_bf16 v[28:31], v[44:47], v[76:79], v[28:31]
    ds_read_b64_tr_b16 v[66:67], v252 offset:63488
    v_mfma_f32_16x16x32_bf16 v[32:35], v[48:51], v[76:79], v[32:35]
    ds_read_b64_tr_b16 v[68:69], v253 offset:61440
    v_mfma_f32_16x16x32_bf16 v[36:39], v[52:55], v[76:79], v[36:39]
    ds_read_b64_tr_b16 v[70:71], v253 offset:63488
    buffer_load_dwordx4 v[72:75], v5, s[12:15], s72 offen offset:1024 sc1
    buffer_load_dwordx4 v[76:79], v4, s[12:15], s72 offen offset:1024 sc1
    s_waitcnt vmcnt(12)
    s_waitcnt lgkmcnt(0)
    v_add_u32 v250, 0x10000, v250
    v_add_u32 v251, 0x10000, v251
    v_add_u32 v252, 0x10000, v252
    v_add_u32 v253, 0x10000, v253
    v_mfma_f32_16x16x32_bf16 v[8:11], v[56:59], v[80:83], v[8:11]
    ds_read_b64_tr_b16 v[40:41], v250 offset:0
    v_mfma_f32_16x16x32_bf16 v[12:15], v[60:63], v[80:83], v[12:15]
    ds_read_b64_tr_b16 v[42:43], v250 offset:2048
    v_mfma_f32_16x16x32_bf16 v[16:19], v[64:67], v[80:83], v[16:19]
    ds_read_b64_tr_b16 v[44:45], v251 offset:0
    v_mfma_f32_16x16x32_bf16 v[20:23], v[68:71], v[80:83], v[20:23]
    ds_read_b64_tr_b16 v[46:47], v251 offset:2048
    v_mfma_f32_16x16x32_bf16 v[24:27], v[56:59], v[84:87], v[24:27]
    ds_read_b64_tr_b16 v[48:49], v252 offset:0
    v_mfma_f32_16x16x32_bf16 v[28:31], v[60:63], v[84:87], v[28:31]
    ds_read_b64_tr_b16 v[50:51], v252 offset:2048
    v_mfma_f32_16x16x32_bf16 v[32:35], v[64:67], v[84:87], v[32:35]
    ds_read_b64_tr_b16 v[52:53], v253 offset:0
    v_mfma_f32_16x16x32_bf16 v[36:39], v[68:71], v[84:87], v[36:39]
    ds_read_b64_tr_b16 v[54:55], v253 offset:2048
    buffer_load_dwordx4 v[80:83], v5, s[12:15], s72 offen offset:2048 sc1
    buffer_load_dwordx4 v[84:87], v4, s[12:15], s72 offen offset:2048 sc1
    s_waitcnt vmcnt(12)
    s_waitcnt lgkmcnt(0)
    v_mfma_f32_16x16x32_bf16 v[8:11], v[40:43], v[88:91], v[8:11]
    ds_read_b64_tr_b16 v[56:57], v250 offset:4096
    v_mfma_f32_16x16x32_bf16 v[12:15], v[44:47], v[88:91], v[12:15]
    ds_read_b64_tr_b16 v[58:59], v250 offset:6144
    v_mfma_f32_16x16x32_bf16 v[16:19], v[48:51], v[88:91], v[16:19]
    ds_read_b64_tr_b16 v[60:61], v251 offset:4096
    v_mfma_f32_16x16x32_bf16 v[20:23], v[52:55], v[88:91], v[20:23]
    ds_read_b64_tr_b16 v[62:63], v251 offset:6144
    v_mfma_f32_16x16x32_bf16 v[24:27], v[40:43], v[92:95], v[24:27]
    ds_read_b64_tr_b16 v[64:65], v252 offset:4096
    v_mfma_f32_16x16x32_bf16 v[28:31], v[44:47], v[92:95], v[28:31]
    ds_read_b64_tr_b16 v[66:67], v252 offset:6144
    v_mfma_f32_16x16x32_bf16 v[32:35], v[48:51], v[92:95], v[32:35]
    ds_read_b64_tr_b16 v[68:69], v253 offset:4096
    v_mfma_f32_16x16x32_bf16 v[36:39], v[52:55], v[92:95], v[36:39]
    ds_read_b64_tr_b16 v[70:71], v253 offset:6144
    buffer_load_dwordx4 v[88:91], v5, s[12:15], s72 offen offset:3072 sc1
    buffer_load_dwordx4 v[92:95], v4, s[12:15], s72 offen offset:3072 sc1
    s_add_u32 s72, s72, 4096
    s_waitcnt vmcnt(12)
    s_waitcnt lgkmcnt(0)
    v_mfma_f32_16x16x32_bf16 v[8:11], v[56:59], v[96:99], v[8:11]
    ds_read_b64_tr_b16 v[40:41], v250 offset:8192
    v_mfma_f32_16x16x32_bf16 v[12:15], v[60:63], v[96:99], v[12:15]
    ds_read_b64_tr_b16 v[42:43], v250 offset:10240
    v_mfma_f32_16x16x32_bf16 v[16:19], v[64:67], v[96:99], v[16:19]
    ds_read_b64_tr_b16 v[44:45], v251 offset:8192
    v_mfma_f32_16x16x32_bf16 v[20:23], v[68:71], v[96:99], v[20:23]
    ds_read_b64_tr_b16 v[46:47], v251 offset:10240
    v_mfma_f32_16x16x32_bf16 v[24:27], v[56:59], v[100:103], v[24:27]
    ds_read_b64_tr_b16 v[48:49], v252 offset:8192
    v_mfma_f32_16x16x32_bf16 v[28:31], v[60:63], v[100:103], v[28:31]
    ds_read_b64_tr_b16 v[50:51], v252 offset:10240
    v_mfma_f32_16x16x32_bf16 v[32:35], v[64:67], v[100:103], v[32:35]
    ds_read_b64_tr_b16 v[52:53], v253 offset:8192
    v_mfma_f32_16x16x32_bf16 v[36:39], v[68:71], v[100:103], v[36:39]
    ds_read_b64_tr_b16 v[54:55], v253 offset:10240
    buffer_load_dwordx4 v[96:99], v5, s[12:15], s72 offen offset:0 sc1
    buffer_load_dwordx4 v[100:103], v4, s[12:15], s72 offen offset:0 sc1
    s_waitcnt vmcnt(12)
    s_waitcnt lgkmcnt(0)
    v_mfma_f32_16x16x32_bf16 v[8:11], v[40:43], v[104:107], v[8:11]
    ds_read_b64_tr_b16 v[56:57], v250 offset:12288
    v_mfma_f32_16x16x32_bf16 v[12:15], v[44:47], v[104:107], v[12:15]
    ds_read_b64_tr_b16 v[58:59], v250 offset:14336
    v_mfma_f32_16x16x32_bf16 v[16:19], v[48:51], v[104:107], v[16:19]
    ds_read_b64_tr_b16 v[60:61], v251 offset:12288
    v_mfma_f32_16x16x32_bf16 v[20:23], v[52:55], v[104:107], v[20:23]
    ds_read_b64_tr_b16 v[62:63], v251 offset:14336
    v_mfma_f32_16x16x32_bf16 v[24:27], v[40:43], v[108:111], v[24:27]
    ds_read_b64_tr_b16 v[64:65], v252 offset:12288
    v_mfma_f32_16x16x32_bf16 v[28:31], v[44:47], v[108:111], v[28:31]
    ds_read_b64_tr_b16 v[66:67], v252 offset:14336
    v_mfma_f32_16x16x32_bf16 v[32:35], v[48:51], v[108:111], v[32:35]
    ds_read_b64_tr_b16 v[68:69], v253 offset:12288
    v_mfma_f32_16x16x32_bf16 v[36:39], v[52:55], v[108:111], v[36:39]
    ds_read_b64_tr_b16 v[70:71], v253 offset:14336
    buffer_load_dwordx4 v[104:107], v5, s[12:15], s72 offen offset:1024 sc1
    buffer_load_dwordx4 v[108:111], v4, s[12:15], s72 offen offset:1024 sc1
    s_waitcnt vmcnt(12)
    s_waitcnt lgkmcnt(0)
    v_mfma_f32_16x16x32_bf16 v[8:11], v[56:59], v[112:115], v[8:11]
    ds_read_b64_tr_b16 v[40:41], v250 offset:16384
    v_mfma_f32_16x16x32_bf16 v[12:15], v[60:63], v[112:115], v[12:15]
    ds_read_b64_tr_b16 v[42:43], v250 offset:18432
    v_mfma_f32_16x16x32_bf16 v[16:19], v[64:67], v[112:115], v[16:19]
    ds_read_b64_tr_b16 v[44:45], v251 offset:16384
    v_mfma_f32_16x16x32_bf16 v[20:23], v[68:71], v[112:115], v[20:23]
    ds_read_b64_tr_b16 v[46:47], v251 offset:18432
    v_mfma_f32_16x16x32_bf16 v[24:27], v[56:59], v[116:119], v[24:27]
    ds_read_b64_tr_b16 v[48:49], v252 offset:16384
    v_mfma_f32_16x16x32_bf16 v[28:31], v[60:63], v[116:119], v[28:31]
    ds_read_b64_tr_b16 v[50:51], v252 offset:18432
    v_mfma_f32_16x16x32_bf16 v[32:35], v[64:67], v[116:119], v[32:35]
    ds_read_b64_tr_b16 v[52:53], v253 offset:16384
    v_mfma_f32_16x16x32_bf16 v[36:39], v[68:71], v[116:119], v[36:39]
    ds_read_b64_tr_b16 v[54:55], v253 offset:18432
    buffer_load_dwordx4 v[112:115], v5, s[12:15], s72 offen offset:2048 sc1
    buffer_load_dwordx4 v[116:119], v4, s[12:15], s72 offen offset:2048 sc1
    s_waitcnt vmcnt(12)
    s_waitcnt lgkmcnt(0)
    v_mfma_f32_16x16x32_bf16 v[8:11], v[40:43], v[120:123], v[8:11]
    ds_read_b64_tr_b16 v[56:57], v250 offset:20480
    v_mfma_f32_16x16x32_bf16 v[12:15], v[44:47], v[120:123], v[12:15]
    ds_read_b64_tr_b16 v[58:59], v250 offset:22528
    v_mfma_f32_16x16x32_bf16 v[16:19], v[48:51], v[120:123], v[16:19]
    ds_read_b64_tr_b16 v[60:61], v251 offset:20480
    v_mfma_f32_16x16x32_bf16 v[20:23], v[52:55], v[120:123], v[20:23]
    ds_read_b64_tr_b16 v[62:63], v251 offset:22528
    v_mfma_f32_16x16x32_bf16 v[24:27], v[40:43], v[124:127], v[24:27]
    ds_read_b64_tr_b16 v[64:65], v252 offset:20480
    v_mfma_f32_16x16x32_bf16 v[28:31], v[44:47], v[124:127], v[28:31]
    ds_read_b64_tr_b16 v[66:67], v252 offset:22528
    v_mfma_f32_16x16x32_bf16 v[32:35], v[48:51], v[124:127], v[32:35]
    ds_read_b64_tr_b16 v[68:69], v253 offset:20480
    v_mfma_f32_16x16x32_bf16 v[36:39], v[52:55], v[124:127], v[36:39]
    ds_read_b64_tr_b16 v[70:71], v253 offset:22528
    buffer_load_dwordx4 v[120:123], v5, s[12:15], s72 offen offset:3072 sc1
    buffer_load_dwordx4 v[124:127], v4, s[12:15], s72 offen offset:3072 sc1
    s_add_u32 s72, s72, 4096
    s_waitcnt vmcnt(12)
    s_waitcnt lgkmcnt(0)
    v_mfma_f32_16x16x32_bf16 v[8:11], v[56:59], v[72:75], v[8:11]
    ds_read_b64_tr_b16 v[40:41], v250 offset:24576
    v_mfma_f32_16x16x32_bf16 v[12:15], v[60:63], v[72:75], v[12:15]
    ds_read_b64_tr_b16 v[42:43], v250 offset:26624
    v_mfma_f32_16x16x32_bf16 v[16:19], v[64:67], v[72:75], v[16:19]
    ds_read_b64_tr_b16 v[44:45], v251 offset:24576
    v_mfma_f32_16x16x32_bf16 v[20:23], v[68:71], v[72:75], v[20:23]
    ds_read_b64_tr_b16 v[46:47], v251 offset:26624
    v_mfma_f32_16x16x32_bf16 v[24:27], v[56:59], v[76:79], v[24:27]
    ds_read_b64_tr_b16 v[48:49], v252 offset:24576
    v_mfma_f32_16x16x32_bf16 v[28:31], v[60:63], v[76:79], v[28:31]
    ds_read_b64_tr_b16 v[50:51], v252 offset:26624
    v_mfma_f32_16x16x32_bf16 v[32:35], v[64:67], v[76:79], v[32:35]
    ds_read_b64_tr_b16 v[52:53], v253 offset:24576
    v_mfma_f32_16x16x32_bf16 v[36:39], v[68:71], v[76:79], v[36:39]
    ds_read_b64_tr_b16 v[54:55], v253 offset:26624
    buffer_load_dwordx4 v[72:75], v5, s[12:15], s72 offen offset:0 sc1
    buffer_load_dwordx4 v[76:79], v4, s[12:15], s72 offen offset:0 sc1
    s_waitcnt vmcnt(12)
    s_waitcnt lgkmcnt(0)
    v_mfma_f32_16x16x32_bf16 v[8:11], v[40:43], v[80:83], v[8:11]
    ds_read_b64_tr_b16 v[56:57], v250 offset:28672
    v_mfma_f32_16x16x32_bf16 v[12:15], v[44:47], v[80:83], v[12:15]
    ds_read_b64_tr_b16 v[58:59], v250 offset:30720
    v_mfma_f32_16x16x32_bf16 v[16:19], v[48:51], v[80:83], v[16:19]
    ds_read_b64_tr_b16 v[60:61], v251 offset:28672
    v_mfma_f32_16x16x32_bf16 v[20:23], v[52:55], v[80:83], v[20:23]
    ds_read_b64_tr_b16 v[62:63], v251 offset:30720
    v_mfma_f32_16x16x32_bf16 v[24:27], v[40:43], v[84:87], v[24:27]
    ds_read_b64_tr_b16 v[64:65], v252 offset:28672
    v_mfma_f32_16x16x32_bf16 v[28:31], v[44:47], v[84:87], v[28:31]
    ds_read_b64_tr_b16 v[66:67], v252 offset:30720
    v_mfma_f32_16x16x32_bf16 v[32:35], v[48:51], v[84:87], v[32:35]
    ds_read_b64_tr_b16 v[68:69], v253 offset:28672
    v_mfma_f32_16x16x32_bf16 v[36:39], v[52:55], v[84:87], v[36:39]
    ds_read_b64_tr_b16 v[70:71], v253 offset:30720
    buffer_load_dwordx4 v[80:83], v5, s[12:15], s72 offen offset:1024 sc1
    buffer_load_dwordx4 v[84:87], v4, s[12:15], s72 offen offset:1024 sc1
    s_waitcnt vmcnt(12)
    s_waitcnt lgkmcnt(0)
    v_mfma_f32_16x16x32_bf16 v[8:11], v[56:59], v[88:91], v[8:11]
    ds_read_b64_tr_b16 v[40:41], v250 offset:32768
    v_mfma_f32_16x16x32_bf16 v[12:15], v[60:63], v[88:91], v[12:15]
    ds_read_b64_tr_b16 v[42:43], v250 offset:34816
    v_mfma_f32_16x16x32_bf16 v[16:19], v[64:67], v[88:91], v[16:19]
    ds_read_b64_tr_b16 v[44:45], v251 offset:32768
    v_mfma_f32_16x16x32_bf16 v[20:23], v[68:71], v[88:91], v[20:23]
    ds_read_b64_tr_b16 v[46:47], v251 offset:34816
    v_mfma_f32_16x16x32_bf16 v[24:27], v[56:59], v[92:95], v[24:27]
    ds_read_b64_tr_b16 v[48:49], v252 offset:32768
    v_mfma_f32_16x16x32_bf16 v[28:31], v[60:63], v[92:95], v[28:31]
    ds_read_b64_tr_b16 v[50:51], v252 offset:34816
    v_mfma_f32_16x16x32_bf16 v[32:35], v[64:67], v[92:95], v[32:35]
    ds_read_b64_tr_b16 v[52:53], v253 offset:32768
    v_mfma_f32_16x16x32_bf16 v[36:39], v[68:71], v[92:95], v[36:39]
    ds_read_b64_tr_b16 v[54:55], v253 offset:34816
    buffer_load_dwordx4 v[88:91], v5, s[12:15], s72 offen offset:2048 sc1
    buffer_load_dwordx4 v[92:95], v4, s[12:15], s72 offen offset:2048 sc1
    s_waitcnt vmcnt(12)
    s_waitcnt lgkmcnt(0)
    v_mfma_f32_16x16x32_bf16 v[8:11], v[40:43], v[96:99], v[8:11]
    ds_read_b64_tr_b16 v[56:57], v250 offset:36864
    v_mfma_f32_16x16x32_bf16 v[12:15], v[44:47], v[96:99], v[12:15]
    ds_read_b64_tr_b16 v[58:59], v250 offset:38912
    v_mfma_f32_16x16x32_bf16 v[16:19], v[48:51], v[96:99], v[16:19]
    ds_read_b64_tr_b16 v[60:61], v251 offset:36864
    v_mfma_f32_16x16x32_bf16 v[20:23], v[52:55], v[96:99], v[20:23]
    ds_read_b64_tr_b16 v[62:63], v251 offset:38912
    v_mfma_f32_16x16x32_bf16 v[24:27], v[40:43], v[100:103], v[24:27]
    ds_read_b64_tr_b16 v[64:65], v252 offset:36864
    v_mfma_f32_16x16x32_bf16 v[28:31], v[44:47], v[100:103], v[28:31]
    ds_read_b64_tr_b16 v[66:67], v252 offset:38912
    v_mfma_f32_16x16x32_bf16 v[32:35], v[48:51], v[100:103], v[32:35]
    ds_read_b64_tr_b16 v[68:69], v253 offset:36864
    v_mfma_f32_16x16x32_bf16 v[36:39], v[52:55], v[100:103], v[36:39]
    ds_read_b64_tr_b16 v[70:71], v253 offset:38912
    buffer_load_dwordx4 v[96:99], v5, s[12:15], s72 offen offset:3072 sc1
    buffer_load_dwordx4 v[100:103], v4, s[12:15], s72 offen offset:3072 sc1
    s_add_u32 s72, s72, 4096
    s_waitcnt vmcnt(12)
    s_waitcnt lgkmcnt(0)
    v_mfma_f32_16x16x32_bf16 v[8:11], v[56:59], v[104:107], v[8:11]
    ds_read_b64_tr_b16 v[40:41], v250 offset:40960
    v_mfma_f32_16x16x32_bf16 v[12:15], v[60:63], v[104:107], v[12:15]
    ds_read_b64_tr_b16 v[42:43], v250 offset:43008
    v_mfma_f32_16x16x32_bf16 v[16:19], v[64:67], v[104:107], v[16:19]
    ds_read_b64_tr_b16 v[44:45], v251 offset:40960
    v_mfma_f32_16x16x32_bf16 v[20:23], v[68:71], v[104:107], v[20:23]
    ds_read_b64_tr_b16 v[46:47], v251 offset:43008
    v_mfma_f32_16x16x32_bf16 v[24:27], v[56:59], v[108:111], v[24:27]
    ds_read_b64_tr_b16 v[48:49], v252 offset:40960
    v_mfma_f32_16x16x32_bf16 v[28:31], v[60:63], v[108:111], v[28:31]
    ds_read_b64_tr_b16 v[50:51], v252 offset:43008
    v_mfma_f32_16x16x32_bf16 v[32:35], v[64:67], v[108:111], v[32:35]
    ds_read_b64_tr_b16 v[52:53], v253 offset:40960
    v_mfma_f32_16x16x32_bf16 v[36:39], v[68:71], v[108:111], v[36:39]
    ds_read_b64_tr_b16 v[54:55], v253 offset:43008
    s_waitcnt vmcnt(10)
    s_waitcnt lgkmcnt(0)
    v_mfma_f32_16x16x32_bf16 v[8:11], v[40:43], v[112:115], v[8:11]
    ds_read_b64_tr_b16 v[56:57], v250 offset:45056
    v_mfma_f32_16x16x32_bf16 v[12:15], v[44:47], v[112:115], v[12:15]
    ds_read_b64_tr_b16 v[58:59], v250 offset:47104
    v_mfma_f32_16x16x32_bf16 v[16:19], v[48:51], v[112:115], v[16:19]
    ds_read_b64_tr_b16 v[60:61], v251 offset:45056
    v_mfma_f32_16x16x32_bf16 v[20:23], v[52:55], v[112:115], v[20:23]
    ds_read_b64_tr_b16 v[62:63], v251 offset:47104
    v_mfma_f32_16x16x32_bf16 v[24:27], v[40:43], v[116:119], v[24:27]
    ds_read_b64_tr_b16 v[64:65], v252 offset:45056
    v_mfma_f32_16x16x32_bf16 v[28:31], v[44:47], v[116:119], v[28:31]
    ds_read_b64_tr_b16 v[66:67], v252 offset:47104
    v_mfma_f32_16x16x32_bf16 v[32:35], v[48:51], v[116:119], v[32:35]
    ds_read_b64_tr_b16 v[68:69], v253 offset:45056
    v_mfma_f32_16x16x32_bf16 v[36:39], v[52:55], v[116:119], v[36:39]
    ds_read_b64_tr_b16 v[70:71], v253 offset:47104
    s_waitcnt vmcnt(8)
    s_waitcnt lgkmcnt(0)
    v_mfma_f32_16x16x32_bf16 v[8:11], v[56:59], v[120:123], v[8:11]
    ds_read_b64_tr_b16 v[40:41], v250 offset:49152
    v_mfma_f32_16x16x32_bf16 v[12:15], v[60:63], v[120:123], v[12:15]
    ds_read_b64_tr_b16 v[42:43], v250 offset:51200
    v_mfma_f32_16x16x32_bf16 v[16:19], v[64:67], v[120:123], v[16:19]
    ds_read_b64_tr_b16 v[44:45], v251 offset:49152
    v_mfma_f32_16x16x32_bf16 v[20:23], v[68:71], v[120:123], v[20:23]
    ds_read_b64_tr_b16 v[46:47], v251 offset:51200
    v_mfma_f32_16x16x32_bf16 v[24:27], v[56:59], v[124:127], v[24:27]
    ds_read_b64_tr_b16 v[48:49], v252 offset:49152
    v_mfma_f32_16x16x32_bf16 v[28:31], v[60:63], v[124:127], v[28:31]
    ds_read_b64_tr_b16 v[50:51], v252 offset:51200
    v_mfma_f32_16x16x32_bf16 v[32:35], v[64:67], v[124:127], v[32:35]
    ds_read_b64_tr_b16 v[52:53], v253 offset:49152
    v_mfma_f32_16x16x32_bf16 v[36:39], v[68:71], v[124:127], v[36:39]
    ds_read_b64_tr_b16 v[54:55], v253 offset:51200
    s_waitcnt vmcnt(6)
    s_waitcnt lgkmcnt(0)
    v_mfma_f32_16x16x32_bf16 v[8:11], v[40:43], v[72:75], v[8:11]
    ds_read_b64_tr_b16 v[56:57], v250 offset:53248
    v_mfma_f32_16x16x32_bf16 v[12:15], v[44:47], v[72:75], v[12:15]
    ds_read_b64_tr_b16 v[58:59], v250 offset:55296
    v_mfma_f32_16x16x32_bf16 v[16:19], v[48:51], v[72:75], v[16:19]
    ds_read_b64_tr_b16 v[60:61], v251 offset:53248
    v_mfma_f32_16x16x32_bf16 v[20:23], v[52:55], v[72:75], v[20:23]
    ds_read_b64_tr_b16 v[62:63], v251 offset:55296
    v_mfma_f32_16x16x32_bf16 v[24:27], v[40:43], v[76:79], v[24:27]
    ds_read_b64_tr_b16 v[64:65], v252 offset:53248
    v_mfma_f32_16x16x32_bf16 v[28:31], v[44:47], v[76:79], v[28:31]
    ds_read_b64_tr_b16 v[66:67], v252 offset:55296
    v_mfma_f32_16x16x32_bf16 v[32:35], v[48:51], v[76:79], v[32:35]
    ds_read_b64_tr_b16 v[68:69], v253 offset:53248
    v_mfma_f32_16x16x32_bf16 v[36:39], v[52:55], v[76:79], v[36:39]
    ds_read_b64_tr_b16 v[70:71], v253 offset:55296
    s_waitcnt vmcnt(4)
    s_waitcnt lgkmcnt(0)
    v_mfma_f32_16x16x32_bf16 v[8:11], v[56:59], v[80:83], v[8:11]
    ds_read_b64_tr_b16 v[40:41], v250 offset:57344
    v_mfma_f32_16x16x32_bf16 v[12:15], v[60:63], v[80:83], v[12:15]
    ds_read_b64_tr_b16 v[42:43], v250 offset:59392
    v_mfma_f32_16x16x32_bf16 v[16:19], v[64:67], v[80:83], v[16:19]
    ds_read_b64_tr_b16 v[44:45], v251 offset:57344
    v_mfma_f32_16x16x32_bf16 v[20:23], v[68:71], v[80:83], v[20:23]
    ds_read_b64_tr_b16 v[46:47], v251 offset:59392
    v_mfma_f32_16x16x32_bf16 v[24:27], v[56:59], v[84:87], v[24:27]
    ds_read_b64_tr_b16 v[48:49], v252 offset:57344
    v_mfma_f32_16x16x32_bf16 v[28:31], v[60:63], v[84:87], v[28:31]
    ds_read_b64_tr_b16 v[50:51], v252 offset:59392
    v_mfma_f32_16x16x32_bf16 v[32:35], v[64:67], v[84:87], v[32:35]
    ds_read_b64_tr_b16 v[52:53], v253 offset:57344
    v_mfma_f32_16x16x32_bf16 v[36:39], v[68:71], v[84:87], v[36:39]
    ds_read_b64_tr_b16 v[54:55], v253 offset:59392
    s_waitcnt vmcnt(2)
    s_waitcnt lgkmcnt(0)
    v_mov_b32 v7, 5
    ds_write_b32 v249, v7 offset:32
    v_mfma_f32_16x16x32_bf16 v[8:11], v[40:43], v[88:91], v[8:11]
    ds_read_b64_tr_b16 v[56:57], v250 offset:61440
    v_mfma_f32_16x16x32_bf16 v[12:15], v[44:47], v[88:91], v[12:15]
    ds_read_b64_tr_b16 v[58:59], v250 offset:63488
    v_mfma_f32_16x16x32_bf16 v[16:19], v[48:51], v[88:91], v[16:19]
    ds_read_b64_tr_b16 v[60:61], v251 offset:61440
    v_mfma_f32_16x16x32_bf16 v[20:23], v[52:55], v[88:91], v[20:23]
    ds_read_b64_tr_b16 v[62:63], v251 offset:63488
    v_mfma_f32_16x16x32_bf16 v[24:27], v[40:43], v[92:95], v[24:27]
    ds_read_b64_tr_b16 v[64:65], v252 offset:61440
    v_mfma_f32_16x16x32_bf16 v[28:31], v[44:47], v[92:95], v[28:31]
    ds_read_b64_tr_b16 v[66:67], v252 offset:63488
    v_mfma_f32_16x16x32_bf16 v[32:35], v[48:51], v[92:95], v[32:35]
    ds_read_b64_tr_b16 v[68:69], v253 offset:61440
    v_mfma_f32_16x16x32_bf16 v[36:39], v[52:55], v[92:95], v[36:39]
    ds_read_b64_tr_b16 v[70:71], v253 offset:63488
    s_waitcnt vmcnt(0)
    s_waitcnt lgkmcnt(0)
    v_mfma_f32_16x16x32_bf16 v[8:11], v[56:59], v[96:99], v[8:11]
    v_mfma_f32_16x16x32_bf16 v[12:15], v[60:63], v[96:99], v[12:15]
    v_mfma_f32_16x16x32_bf16 v[16:19], v[64:67], v[96:99], v[16:19]
    v_mfma_f32_16x16x32_bf16 v[20:23], v[68:71], v[96:99], v[20:23]
    v_mfma_f32_16x16x32_bf16 v[24:27], v[56:59], v[100:103], v[24:27]
    v_mfma_f32_16x16x32_bf16 v[28:31], v[60:63], v[100:103], v[28:31]
    v_mfma_f32_16x16x32_bf16 v[32:35], v[64:67], v[100:103], v[32:35]
    v_mfma_f32_16x16x32_bf16 v[36:39], v[68:71], v[100:103], v[36:39]
    s_nop 0
    v_cvt_pk_bf16_f32 v72, v8, v9
    v_cvt_pk_bf16_f32 v73, v10, v11
    ds_write_b64 v240, v[72:73] offset:0
    v_cvt_pk_bf16_f32 v74, v12, v13
    v_cvt_pk_bf16_f32 v75, v14, v15
    ds_write_b64 v240, v[74:75] offset:32
    v_cvt_pk_bf16_f32 v76, v16, v17
    v_cvt_pk_bf16_f32 v77, v18, v19
    ds_write_b64 v240, v[76:77] offset:64
    v_cvt_pk_bf16_f32 v78, v20, v21
    v_cvt_pk_bf16_f32 v79, v22, v23
    ds_write_b64 v240, v[78:79] offset:96
    v_cvt_pk_bf16_f32 v80, v24, v25
    v_cvt_pk_bf16_f32 v81, v26, v27
    ds_write_b64 v240, v[80:81] offset:2304
    v_cvt_pk_bf16_f32 v82, v28, v29
    v_cvt_pk_bf16_f32 v83, v30, v31
    ds_write_b64 v240, v[82:83] offset:2336
    v_cvt_pk_bf16_f32 v84, v32, v33
    v_cvt_pk_bf16_f32 v85, v34, v35
    ds_write_b64 v240, v[84:85] offset:2368
    v_cvt_pk_bf16_f32 v86, v36, v37
    v_cvt_pk_bf16_f32 v87, v38, v39
    ds_write_b64 v240, v[86:87] offset:2400
    v_mov_b32 v7, 7
    ds_write_b32 v249, v7 offset:32
    s_endpgm
.p2align 8
L_code_end:
.fill 3072, 4, 0xbf800000
.section .rodata,"a"
.p2align 6
.amdhsa_kernel recurrent_scan__linear_kernel_hedgehog__moe_arch_mod__prompt_kernel
  .amdhsa_next_free_vgpr 256
  .amdhsa_next_free_sgpr 102
  .amdhsa_accum_offset 256
  .amdhsa_group_segment_fixed_size 0
  .amdhsa_kernarg_size 96
  .amdhsa_user_sgpr_count 2
  .amdhsa_user_sgpr_kernarg_segment_ptr 1
  .amdhsa_system_sgpr_workgroup_id_x 1
.end_amdhsa_kernel
```

```asm
; @launch grid=(256,1,1) block=(512,1,1) lds=163840
.amdgcn_target "amdgcn-amd-amdhsa--gfx950"
.text
.globl recurrent_scan__linear_kernel_hedgehog__moe_arch_mod__prompt_kernel
.p2align 8
.type recurrent_scan__linear_kernel_hedgehog__moe_arch_mod__prompt_kernel,@function
recurrent_scan__linear_kernel_hedgehog__moe_arch_mod__prompt_kernel:
    s_cmp_ge_u32 s2, 256
    s_cbranch_scc1 L_done
    s_load_dwordx16 s[40:55], s[0:1], 0
    s_load_dwordx8 s[56:63], s[0:1], 64
    v_and_b32 v1, 63, v0
    v_lshrrev_b32 v2, 6, v0
    s_nop 0
    v_readfirstlane_b32 s38, v2
    s_and_b32 s65, s2, 1
    s_bfe_u32 s66, s2, 0x30003
    s_bfe_u32 s67, s2, 0x20001
    s_lshl_b32 s67, s67, 2
    s_lshl_b32 s36, s65, 3
    s_add_u32 s36, s36, s66
    s_lshr_b32 s3, s2, 6
    s_add_u32 s37, s67, s3
    s_lshr_b32 s39, s66, 0
    s_lshl_b32 s39, s39, 1
    s_add_u32 s39, s39, s65
    s_lshl_b32 s39, s39, 0
    s_and_b32 s101, s66, 0
    s_add_u32 s39, s39, s67
    s_and_b32 s39, s39, 15
    s_and_b32 s67, s2, 7
    s_lshl_b32 s67, s67, 1
    s_bfe_u32 s3, s2, 0x10003
    s_add_u32 s37, s67, s3
    s_lshr_b32 s36, s2, 4
    s_and_b32 s101, s36, 0
    s_sub_u32 s39, s36, s101
    s_add_u32 s39, s39, s67
    s_and_b32 s39, s39, 15
    s_cmp_lt_u32 s38, 4
    s_cbranch_scc1 L_g1
    s_sub_u32 s38, s38, 4
    s_lshl_b32 s3, s38, 4
    v_lshrrev_b32 v7, 3, v1
    v_add_u32 v3, s3, v7
    v_mul_u32_u24 v3, 6144, v3
    s_lshl_b32 s3, s37, 7
    v_add_u32 v3, s3, v3
    v_and_b32 v6, 7, v1
    v_bfe_u32 v5, v1, 4, 1
    v_lshlrev_b32 v5, 1, v5
    v_xor_b32 v5, v6, v5
    v_lshl_add_u32 v16, v5, 4, v3
    v_xor_b32 v5, 4, v5
    v_lshl_add_u32 v5, v5, 4, v3
    v_add_u32 v17, 48128, v5
    v_add_u32 v12, 2048, v16
    v_add_u32 v13, 2048, v17
    v_add_u32 v14, 4096, v16
    v_add_u32 v15, 4096, v17
    s_lshl_b32 s3, s36, 7
    s_lshl_b32 s65, s38, 5
    s_add_u32 s3, s3, s65
    v_add_u32 v3, s3, v7
    v_lshlrev_b32 v3, 11, v3
    v_lshrrev_b32 v5, 4, v1
    v_xor_b32 v6, v6, v5
    v_xor_b32 v5, 4, v6
    v_lshl_add_u32 v8, v6, 4, v3
    v_lshl_add_u32 v5, v5, 4, v3
    v_add_u32 v9, 15360, v5
    v_add_u32 v10, 30720, v8
    v_add_u32 v11, 46080, v5
    s_lshl_b32 s72, s38, 12
    s_lshl_b32 s73, s38, 11
    s_lshl_b32 s74, s39, 7
    s_mul_i32 s75, s39, 393216
    s_mov_b32 s76, s75
    s_waitcnt lgkmcnt(0)
    s_mov_b32 s8, s42
    s_mov_b32 s9, s43
    s_mov_b32 s10, 6291456
    s_mov_b32 s11, 0x00020000
    s_mov_b32 s4, s40
    s_mov_b32 s5, s41
    s_mov_b32 s6, 4194304
    s_mov_b32 s7, 0x00020000
    s_cmp_ge_u32 s38, 2
    s_cbranch_scc1 L_xw
    s_add_u32 s3, s75, 196608
    s_add_u32 m0, s73, 65536
    s_nop 0
    buffer_load_dwordx4 v12, s[8:11], s75 offen offset:0  lds
    buffer_load_dwordx4 v13, s[8:11], s75 offen offset:1024  lds
    s_add_u32 m0, s73, 73728
    s_nop 0
    buffer_load_dwordx4 v14, s[8:11], s75 offen offset:0  lds
    buffer_load_dwordx4 v15, s[8:11], s75 offen offset:1024  lds
    s_add_u32 m0, s73, 69632
    s_nop 0
    buffer_load_dwordx4 v12, s[8:11], s3 offen offset:0  lds
    buffer_load_dwordx4 v13, s[8:11], s3 offen offset:1024  lds
    s_add_u32 m0, s73, 77824
    s_nop 0
    buffer_load_dwordx4 v14, s[8:11], s3 offen offset:0  lds
    buffer_load_dwordx4 v15, s[8:11], s3 offen offset:1024  lds
    s_add_u32 s75, s75, 393216
    s_cmp_eq_u32 s75, 6291456
    s_cselect_b32 s75, 0, s75
    s_add_u32 m0, s73, 131072
    s_nop 0
    buffer_load_dwordx4 v16, s[8:11], s76 offen offset:0  lds
    buffer_load_dwordx4 v17, s[8:11], s76 offen offset:1024  lds
    s_add_u32 m0, s73, 135168
    s_add_u32 s3, s76, 196608
    buffer_load_dwordx4 v16, s[8:11], s3 offen offset:0  lds
    buffer_load_dwordx4 v17, s[8:11], s3 offen offset:1024  lds
    s_add_u32 s76, s76, 393216
    s_cmp_eq_u32 s76, 6291456
    s_cselect_b32 s76, 0, s76
    s_add_u32 m0, s72, 0
    s_nop 0
    buffer_load_dwordx4 v8, s[4:7], s74 offen offset:0  lds
    buffer_load_dwordx4 v9, s[4:7], s74 offen offset:1024  lds
    buffer_load_dwordx4 v10, s[4:7], s74 offen offset:2048  lds
    buffer_load_dwordx4 v11, s[4:7], s74 offen offset:3072  lds
    s_add_u32 m0, s72, 8192
    s_add_u32 s3, s74, 131072
    buffer_load_dwordx4 v8, s[4:7], s3 offen offset:0  lds
    buffer_load_dwordx4 v9, s[4:7], s3 offen offset:1024  lds
    buffer_load_dwordx4 v10, s[4:7], s3 offen offset:2048  lds
    buffer_load_dwordx4 v11, s[4:7], s3 offen offset:3072  lds
    s_add_u32 s74, s74, 128
    s_and_b32 s74, s74, 2047
    v_lshlrev_b32 v3, 4, v1
    s_mov_b32 s12, s62
    s_mov_b32 s13, s63
    s_mov_b32 s14, 268435456
    s_mov_b32 s15, 0x00020000
    s_mov_b32 s24, s58
    s_mov_b32 s25, s59
    s_mov_b32 s26, 4194304
    s_mov_b32 s27, 0x00020000
    s_mov_b32 s16, s60
    s_mov_b32 s17, s61
    s_mov_b32 s18, 256
    s_mov_b32 s19, 0x00020000
    s_mov_b32 s20, s44
    s_mov_b32 s21, s45
    s_mov_b32 s22, 65536
    s_mov_b32 s23, 0x00020000
    s_and_b32 s30, s2, 3
    s_lshl_b32 s30, s30, 2
    s_bfe_u32 s3, s2, 0x20003
    s_add_u32 s30, s30, s3
    s_bfe_u32 s31, s2, 0x10002
    s_lshl_b32 s31, s31, 3
    s_lshr_b32 s3, s2, 5
    s_add_u32 s31, s31, s3
    s_mov_b32 s70, 0
    s_mov_b32 s80, s52
    s_mov_b32 s81, s53
    s_mov_b32 s82, 7340032
    s_mov_b32 s83, 0x00020000
    s_mov_b32 s84, s54
    s_mov_b32 s85, s55
    s_mov_b32 s86, 7340032
    s_mov_b32 s87, 0x00020000
    s_cmp_lt_u32 s2, 224
    s_cselect_b32 s82, s82, 0
    s_cselect_b32 s86, s86, 0
    s_and_b32 s3, s2, 15
    s_lshl_b32 s3, s3, 6
    v_and_b32 v5, 0x38, v1
    v_add_u32 v5, s3, v5
    v_mul_u32_u24 v5, 7168, v5
    v_and_b32 v6, 7, v1
    v_lshl_add_u32 v2, v6, 4, v5
    s_lshr_b32 s77, s2, 4
    s_lshl_b32 s77, s77, 2
    s_add_u32 s77, s77, s38
    s_lshl_b32 s77, s77, 7
    v_and_b32 v5, 1, v1
    v_cmp_eq_u32 vcc, 0, v5
    v_mov_b32 v6, 0xffff0000
    v_mov_b32 v7, 0xffff
    v_cndmask_b32 v6, v6, v7, vcc
    v_bfe_u32 v5, v1, 1, 2
    v_cmp_eq_u32 vcc, 0, v5
    s_nop 1
    v_cndmask_b32 v88, 0, v6, vcc
    v_cmp_eq_u32 vcc, 1, v5
    s_nop 1
    v_cndmask_b32 v89, 0, v6, vcc
    v_cmp_eq_u32 vcc, 2, v5
    s_nop 1
    v_cndmask_b32 v90, 0, v6, vcc
    v_cmp_eq_u32 vcc, 3, v5
    s_nop 1
    v_cndmask_b32 v91, 0, v6, vcc
    v_and_b32 v20, 0x3f803f80, v88
    v_and_b32 v21, 0x3f803f80, v89
    v_and_b32 v22, 0x3f803f80, v90
    v_and_b32 v23, 0x3f803f80, v91
    s_lshl_b32 s3, s30, 7
    s_lshl_b32 s65, s38, 5
    s_add_u32 s3, s3, s65
    v_lshrrev_b32 v249, 3, v1
    v_add_u32 v6, s3, v249
    v_lshlrev_b32 v6, 11, v6
    v_and_b32 v250, 7, v1
    v_lshl_add_u32 v6, v250, 4, v6
    s_lshl_b32 s3, s31, 7
    v_add_u32 v248, s3, v6
    s_mov_b32 s48, 16384
    s_mov_b32 s49, 32768
    s_mov_b32 s100, 49152
    s_lshl_b32 s3, s38, 2
    s_add_u32 s3, s3, 163136
    v_mov_b32 v27, s3
    v_mov_b32 v26, 163104
    s_add_u32 m0, s72, 16384
    s_nop 0
    buffer_load_dwordx4 v8, s[4:7], s74 offen offset:0  lds
    buffer_load_dwordx4 v9, s[4:7], s74 offen offset:1024  lds
    buffer_load_dwordx4 v10, s[4:7], s74 offen offset:2048  lds
    buffer_load_dwordx4 v11, s[4:7], s74 offen offset:3072  lds
    s_add_u32 m0, s72, 24576
    s_add_u32 s3, s74, 131072
    buffer_load_dwordx4 v8, s[4:7], s3 offen offset:0  lds
    buffer_load_dwordx4 v9, s[4:7], s3 offen offset:1024  lds
    buffer_load_dwordx4 v10, s[4:7], s3 offen offset:2048  lds
    buffer_load_dwordx4 v11, s[4:7], s3 offen offset:3072  lds
    s_add_u32 s74, s74, 128
    s_and_b32 s74, s74, 2047
    s_add_u32 s3, s75, 196608
    s_add_u32 m0, s73, 81920
    s_nop 0
    buffer_load_dwordx4 v12, s[8:11], s75 offen offset:0  lds
    buffer_load_dwordx4 v13, s[8:11], s75 offen offset:1024  lds
    s_add_u32 m0, s73, 90112
    s_nop 0
    buffer_load_dwordx4 v14, s[8:11], s75 offen offset:0  lds
    buffer_load_dwordx4 v15, s[8:11], s75 offen offset:1024  lds
    s_add_u32 m0, s73, 86016
    s_nop 0
    buffer_load_dwordx4 v12, s[8:11], s3 offen offset:0  lds
    buffer_load_dwordx4 v13, s[8:11], s3 offen offset:1024  lds
    s_add_u32 m0, s73, 94208
    s_nop 0
    buffer_load_dwordx4 v14, s[8:11], s3 offen offset:0  lds
    buffer_load_dwordx4 v15, s[8:11], s3 offen offset:1024  lds
    s_add_u32 s75, s75, 393216
    s_cmp_eq_u32 s75, 6291456
    s_cselect_b32 s75, 0, s75
    s_add_u32 m0, s73, 139264
    s_nop 0
    buffer_load_dwordx4 v16, s[8:11], s76 offen offset:0  lds
    buffer_load_dwordx4 v17, s[8:11], s76 offen offset:1024  lds
    s_add_u32 m0, s73, 143360
    s_add_u32 s3, s76, 196608
    buffer_load_dwordx4 v16, s[8:11], s3 offen offset:0  lds
    buffer_load_dwordx4 v17, s[8:11], s3 offen offset:1024  lds
    s_add_u32 s76, s76, 393216
    s_cmp_eq_u32 s76, 6291456
    s_cselect_b32 s76, 0, s76
    s_waitcnt vmcnt(20)
    s_barrier
    s_add_u32 m0, s72, 32768
    s_nop 0
    buffer_load_dwordx4 v8, s[4:7], s74 offen offset:0  lds
    buffer_load_dwordx4 v9, s[4:7], s74 offen offset:1024  lds
    buffer_load_dwordx4 v10, s[4:7], s74 offen offset:2048  lds
    buffer_load_dwordx4 v11, s[4:7], s74 offen offset:3072  lds
    s_add_u32 m0, s72, 40960
    s_add_u32 s3, s74, 131072
    buffer_load_dwordx4 v8, s[4:7], s3 offen offset:0  lds
    buffer_load_dwordx4 v9, s[4:7], s3 offen offset:1024  lds
    buffer_load_dwordx4 v10, s[4:7], s3 offen offset:2048  lds
    buffer_load_dwordx4 v11, s[4:7], s3 offen offset:3072  lds
    s_add_u32 s74, s74, 128
    s_and_b32 s74, s74, 2047
    s_add_u32 s3, s75, 196608
    s_add_u32 m0, s73, 98304
    s_nop 0
    buffer_load_dwordx4 v12, s[8:11], s75 offen offset:0  lds
    buffer_load_dwordx4 v13, s[8:11], s75 offen offset:1024  lds
    s_add_u32 m0, s73, 106496
    s_nop 0
    buffer_load_dwordx4 v14, s[8:11], s75 offen offset:0  lds
    buffer_load_dwordx4 v15, s[8:11], s75 offen offset:1024  lds
    s_add_u32 m0, s73, 102400
    s_nop 0
    buffer_load_dwordx4 v12, s[8:11], s3 offen offset:0  lds
    buffer_load_dwordx4 v13, s[8:11], s3 offen offset:1024  lds
    s_add_u32 m0, s73, 110592
    s_nop 0
    buffer_load_dwordx4 v14, s[8:11], s3 offen offset:0  lds
    buffer_load_dwordx4 v15, s[8:11], s3 offen offset:1024  lds
    s_add_u32 s75, s75, 393216
    s_cmp_eq_u32 s75, 6291456
    s_cselect_b32 s75, 0, s75
    s_add_u32 m0, s73, 147456
    s_nop 0
    buffer_load_dwordx4 v16, s[8:11], s76 offen offset:0  lds
    buffer_load_dwordx4 v17, s[8:11], s76 offen offset:1024  lds
    s_add_u32 m0, s73, 151552
    s_add_u32 s3, s76, 196608
    buffer_load_dwordx4 v16, s[8:11], s3 offen offset:0  lds
    buffer_load_dwordx4 v17, s[8:11], s3 offen offset:1024  lds
    s_add_u32 s76, s76, 393216
    s_cmp_eq_u32 s76, 6291456
    s_cselect_b32 s76, 0, s76
    s_add_u32 m0, s72, 49152
    s_nop 0
    buffer_load_dwordx4 v8, s[4:7], s74 offen offset:0  lds
    buffer_load_dwordx4 v9, s[4:7], s74 offen offset:1024  lds
    buffer_load_dwordx4 v10, s[4:7], s74 offen offset:2048  lds
    buffer_load_dwordx4 v11, s[4:7], s74 offen offset:3072  lds
    s_add_u32 m0, s72, 57344
    s_add_u32 s3, s74, 131072
    buffer_load_dwordx4 v8, s[4:7], s3 offen offset:0  lds
    buffer_load_dwordx4 v9, s[4:7], s3 offen offset:1024  lds
    buffer_load_dwordx4 v10, s[4:7], s3 offen offset:2048  lds
    buffer_load_dwordx4 v11, s[4:7], s3 offen offset:3072  lds
    s_add_u32 s74, s74, 128
    s_and_b32 s74, s74, 2047
    s_waitcnt vmcnt(28)
    s_barrier
    s_add_u32 s3, s75, 196608
    s_add_u32 m0, s73, 114688
    s_nop 0
    buffer_load_dwordx4 v12, s[8:11], s75 offen offset:0  lds
    buffer_load_dwordx4 v13, s[8:11], s75 offen offset:1024  lds
    s_add_u32 m0, s73, 122880
    s_nop 0
    buffer_load_dwordx4 v14, s[8:11], s75 offen offset:0  lds
    buffer_load_dwordx4 v15, s[8:11], s75 offen offset:1024  lds
    s_add_u32 m0, s73, 118784
    s_nop 0
    buffer_load_dwordx4 v12, s[8:11], s3 offen offset:0  lds
    buffer_load_dwordx4 v13, s[8:11], s3 offen offset:1024  lds
    s_add_u32 m0, s73, 126976
    s_nop 0
    buffer_load_dwordx4 v14, s[8:11], s3 offen offset:0  lds
    buffer_load_dwordx4 v15, s[8:11], s3 offen offset:1024  lds
    s_add_u32 s75, s75, 393216
    s_cmp_eq_u32 s75, 6291456
    s_cselect_b32 s75, 0, s75
    s_add_u32 m0, s73, 131072
    s_nop 0
    buffer_load_dwordx4 v16, s[8:11], s76 offen offset:0  lds
    buffer_load_dwordx4 v17, s[8:11], s76 offen offset:1024  lds
    s_add_u32 m0, s73, 135168
    s_add_u32 s3, s76, 196608
    buffer_load_dwordx4 v16, s[8:11], s3 offen offset:0  lds
    buffer_load_dwordx4 v17, s[8:11], s3 offen offset:1024  lds
    s_add_u32 s76, s76, 393216
    s_cmp_eq_u32 s76, 6291456
    s_cselect_b32 s76, 0, s76
    s_add_u32 m0, s72, 0
    s_nop 0
    buffer_load_dwordx4 v8, s[4:7], s74 offen offset:0  lds
    buffer_load_dwordx4 v9, s[4:7], s74 offen offset:1024  lds
    buffer_load_dwordx4 v10, s[4:7], s74 offen offset:2048  lds
    buffer_load_dwordx4 v11, s[4:7], s74 offen offset:3072  lds
    s_add_u32 m0, s72, 8192
    s_add_u32 s3, s74, 131072
    buffer_load_dwordx4 v8, s[4:7], s3 offen offset:0  lds
    buffer_load_dwordx4 v9, s[4:7], s3 offen offset:1024  lds
    buffer_load_dwordx4 v10, s[4:7], s3 offen offset:2048  lds
    buffer_load_dwordx4 v11, s[4:7], s3 offen offset:3072  lds
    s_add_u32 s74, s74, 128
    s_and_b32 s74, s74, 2047
    s_add_u32 s3, s75, 196608
    s_add_u32 m0, s73, 65536
    s_nop 0
    buffer_load_dwordx4 v12, s[8:11], s75 offen offset:0  lds
    buffer_load_dwordx4 v13, s[8:11], s75 offen offset:1024  lds
    s_add_u32 m0, s73, 73728
    s_nop 0
    buffer_load_dwordx4 v14, s[8:11], s75 offen offset:0  lds
    buffer_load_dwordx4 v15, s[8:11], s75 offen offset:1024  lds
    s_add_u32 m0, s73, 69632
    s_nop 0
    buffer_load_dwordx4 v12, s[8:11], s3 offen offset:0  lds
    buffer_load_dwordx4 v13, s[8:11], s3 offen offset:1024  lds
    s_add_u32 m0, s73, 77824
    s_nop 0
    buffer_load_dwordx4 v14, s[8:11], s3 offen offset:0  lds
    buffer_load_dwordx4 v15, s[8:11], s3 offen offset:1024  lds
    s_add_u32 s75, s75, 393216
    s_cmp_eq_u32 s75, 6291456
    s_cselect_b32 s75, 0, s75
    s_waitcnt vmcnt(36)
    s_barrier
    s_add_u32 m0, s73, 139264
    s_nop 0
    buffer_load_dwordx4 v16, s[8:11], s76 offen offset:0  lds
    buffer_load_dwordx4 v17, s[8:11], s76 offen offset:1024  lds
    s_add_u32 m0, s73, 143360
    s_add_u32 s3, s76, 196608
    buffer_load_dwordx4 v16, s[8:11], s3 offen offset:0  lds
    buffer_load_dwordx4 v17, s[8:11], s3 offen offset:1024  lds
    s_add_u32 s76, s76, 393216
    s_cmp_eq_u32 s76, 6291456
    s_cselect_b32 s76, 0, s76
    s_add_u32 m0, s72, 16384
    s_nop 0
    buffer_load_dwordx4 v8, s[4:7], s74 offen offset:0  lds
    buffer_load_dwordx4 v9, s[4:7], s74 offen offset:1024  lds
    buffer_load_dwordx4 v10, s[4:7], s74 offen offset:2048  lds
    buffer_load_dwordx4 v11, s[4:7], s74 offen offset:3072  lds
    s_add_u32 m0, s72, 24576
    s_add_u32 s3, s74, 131072
    buffer_load_dwordx4 v8, s[4:7], s3 offen offset:0  lds
    buffer_load_dwordx4 v9, s[4:7], s3 offen offset:1024  lds
    buffer_load_dwordx4 v10, s[4:7], s3 offen offset:2048  lds
    buffer_load_dwordx4 v11, s[4:7], s3 offen offset:3072  lds
    s_add_u32 s74, s74, 128
    s_and_b32 s74, s74, 2047
    s_add_u32 s3, s75, 196608
    s_add_u32 m0, s73, 81920
    s_nop 0
    buffer_load_dwordx4 v12, s[8:11], s75 offen offset:0  lds
    buffer_load_dwordx4 v13, s[8:11], s75 offen offset:1024  lds
    s_add_u32 m0, s73, 90112
    s_nop 0
    buffer_load_dwordx4 v14, s[8:11], s75 offen offset:0  lds
    buffer_load_dwordx4 v15, s[8:11], s75 offen offset:1024  lds
    s_add_u32 m0, s73, 86016
    s_nop 0
    buffer_load_dwordx4 v12, s[8:11], s3 offen offset:0  lds
    buffer_load_dwordx4 v13, s[8:11], s3 offen offset:1024  lds
    s_add_u32 m0, s73, 94208
    s_nop 0
    buffer_load_dwordx4 v14, s[8:11], s3 offen offset:0  lds
    buffer_load_dwordx4 v15, s[8:11], s3 offen offset:1024  lds
    s_add_u32 s75, s75, 393216
    s_cmp_eq_u32 s75, 6291456
    s_cselect_b32 s75, 0, s75
    s_waitcnt vmcnt(36)
    s_barrier
    s_add_u32 m0, s73, 147456
    s_nop 0
    buffer_load_dwordx4 v16, s[8:11], s76 offen offset:0  lds
    buffer_load_dwordx4 v17, s[8:11], s76 offen offset:1024  lds
    s_add_u32 m0, s73, 151552
    s_add_u32 s3, s76, 196608
    buffer_load_dwordx4 v16, s[8:11], s3 offen offset:0  lds
    buffer_load_dwordx4 v17, s[8:11], s3 offen offset:1024  lds
    s_add_u32 s76, s76, 393216
    s_cmp_eq_u32 s76, 6291456
    s_cselect_b32 s76, 0, s76
    s_add_u32 m0, s72, 32768
    s_nop 0
    buffer_load_dwordx4 v8, s[4:7], s74 offen offset:0  lds
    buffer_load_dwordx4 v9, s[4:7], s74 offen offset:1024  lds
    buffer_load_dwordx4 v10, s[4:7], s74 offen offset:2048  lds
    buffer_load_dwordx4 v11, s[4:7], s74 offen offset:3072  lds
    s_add_u32 m0, s72, 40960
    s_add_u32 s3, s74, 131072
    buffer_load_dwordx4 v8, s[4:7], s3 offen offset:0  lds
    buffer_load_dwordx4 v9, s[4:7], s3 offen offset:1024  lds
    buffer_load_dwordx4 v10, s[4:7], s3 offen offset:2048  lds
    buffer_load_dwordx4 v11, s[4:7], s3 offen offset:3072  lds
    s_add_u32 s74, s74, 128
    s_and_b32 s74, s74, 2047
    s_add_u32 s3, s75, 196608
    s_add_u32 m0, s73, 98304
    s_nop 0
    buffer_load_dwordx4 v12, s[8:11], s75 offen offset:0  lds
    buffer_load_dwordx4 v13, s[8:11], s75 offen offset:1024  lds
    s_add_u32 m0, s73, 106496
    s_nop 0
    buffer_load_dwordx4 v14, s[8:11], s75 offen offset:0  lds
    buffer_load_dwordx4 v15, s[8:11], s75 offen offset:1024  lds
    s_add_u32 m0, s73, 102400
    s_nop 0
    buffer_load_dwordx4 v12, s[8:11], s3 offen offset:0  lds
    buffer_load_dwordx4 v13, s[8:11], s3 offen offset:1024  lds
    s_add_u32 m0, s73, 110592
    s_nop 0
    buffer_load_dwordx4 v14, s[8:11], s3 offen offset:0  lds
    buffer_load_dwordx4 v15, s[8:11], s3 offen offset:1024  lds
    s_add_u32 s75, s75, 393216
    s_cmp_eq_u32 s75, 6291456
    s_cselect_b32 s75, 0, s75
    s_waitcnt vmcnt(36)
    s_barrier
    s_add_u32 m0, s73, 131072
    s_nop 0
    buffer_load_dwordx4 v16, s[8:11], s76 offen offset:0  lds
    buffer_load_dwordx4 v17, s[8:11], s76 offen offset:1024  lds
    s_add_u32 m0, s73, 135168
    s_add_u32 s3, s76, 196608
    buffer_load_dwordx4 v16, s[8:11], s3 offen offset:0  lds
    buffer_load_dwordx4 v17, s[8:11], s3 offen offset:1024  lds
    s_add_u32 s76, s76, 393216
    s_cmp_eq_u32 s76, 6291456
    s_cselect_b32 s76, 0, s76
    s_add_u32 m0, s72, 49152
    s_nop 0
    buffer_load_dwordx4 v8, s[4:7], s74 offen offset:0  lds
    buffer_load_dwordx4 v9, s[4:7], s74 offen offset:1024  lds
    buffer_load_dwordx4 v10, s[4:7], s74 offen offset:2048  lds
    buffer_load_dwordx4 v11, s[4:7], s74 offen offset:3072  lds
    s_add_u32 m0, s72, 57344
    s_add_u32 s3, s74, 131072
    buffer_load_dwordx4 v8, s[4:7], s3 offen offset:0  lds
    buffer_load_dwordx4 v9, s[4:7], s3 offen offset:1024  lds
    buffer_load_dwordx4 v10, s[4:7], s3 offen offset:2048  lds
    buffer_load_dwordx4 v11, s[4:7], s3 offen offset:3072  lds
    s_add_u32 s74, s74, 128
    s_and_b32 s74, s74, 2047
    s_add_u32 s3, s75, 196608
    s_add_u32 m0, s73, 114688
    s_nop 0
    buffer_load_dwordx4 v12, s[8:11], s75 offen offset:0  lds
    buffer_load_dwordx4 v13, s[8:11], s75 offen offset:1024  lds
    s_add_u32 m0, s73, 122880
    s_nop 0
    buffer_load_dwordx4 v14, s[8:11], s75 offen offset:0  lds
    buffer_load_dwordx4 v15, s[8:11], s75 offen offset:1024  lds
    s_add_u32 m0, s73, 118784
    s_nop 0
    buffer_load_dwordx4 v12, s[8:11], s3 offen offset:0  lds
    buffer_load_dwordx4 v13, s[8:11], s3 offen offset:1024  lds
    s_add_u32 m0, s73, 126976
    s_nop 0
    buffer_load_dwordx4 v14, s[8:11], s3 offen offset:0  lds
    buffer_load_dwordx4 v15, s[8:11], s3 offen offset:1024  lds
    s_add_u32 s75, s75, 393216
    s_cmp_eq_u32 s75, 6291456
    s_cselect_b32 s75, 0, s75
    s_waitcnt vmcnt(36)
    s_barrier
    s_add_u32 m0, s73, 139264
    s_nop 0
    buffer_load_dwordx4 v16, s[8:11], s76 offen offset:0  lds
    buffer_load_dwordx4 v17, s[8:11], s76 offen offset:1024  lds
    s_add_u32 m0, s73, 143360
    s_add_u32 s3, s76, 196608
    buffer_load_dwordx4 v16, s[8:11], s3 offen offset:0  lds
    buffer_load_dwordx4 v17, s[8:11], s3 offen offset:1024  lds
    s_add_u32 s76, s76, 393216
    s_cmp_eq_u32 s76, 6291456
    s_cselect_b32 s76, 0, s76
    s_add_u32 m0, s72, 0
    s_nop 0
    buffer_load_dwordx4 v8, s[4:7], s74 offen offset:0  lds
    buffer_load_dwordx4 v9, s[4:7], s74 offen offset:1024  lds
    buffer_load_dwordx4 v10, s[4:7], s74 offen offset:2048  lds
    buffer_load_dwordx4 v11, s[4:7], s74 offen offset:3072  lds
    s_add_u32 m0, s72, 8192
    s_add_u32 s3, s74, 131072
    buffer_load_dwordx4 v8, s[4:7], s3 offen offset:0  lds
    buffer_load_dwordx4 v9, s[4:7], s3 offen offset:1024  lds
    buffer_load_dwordx4 v10, s[4:7], s3 offen offset:2048  lds
    buffer_load_dwordx4 v11, s[4:7], s3 offen offset:3072  lds
    s_add_u32 s74, s74, 128
    s_and_b32 s74, s74, 2047
    s_add_u32 s3, s75, 196608
    s_add_u32 m0, s73, 65536
    s_nop 0
    buffer_load_dwordx4 v12, s[8:11], s75 offen offset:0  lds
    buffer_load_dwordx4 v13, s[8:11], s75 offen offset:1024  lds
    s_add_u32 m0, s73, 73728
    s_nop 0
    buffer_load_dwordx4 v14, s[8:11], s75 offen offset:0  lds
    buffer_load_dwordx4 v15, s[8:11], s75 offen offset:1024  lds
    s_add_u32 m0, s73, 69632
    s_nop 0
    buffer_load_dwordx4 v12, s[8:11], s3 offen offset:0  lds
    buffer_load_dwordx4 v13, s[8:11], s3 offen offset:1024  lds
    s_add_u32 m0, s73, 77824
    s_nop 0
    buffer_load_dwordx4 v14, s[8:11], s3 offen offset:0  lds
    buffer_load_dwordx4 v15, s[8:11], s3 offen offset:1024  lds
    s_add_u32 s75, s75, 393216
    s_cmp_eq_u32 s75, 6291456
    s_cselect_b32 s75, 0, s75
    s_waitcnt vmcnt(36)
    s_barrier
    s_add_u32 m0, s73, 147456
    s_nop 0
    buffer_load_dwordx4 v16, s[8:11], s76 offen offset:0  lds
    buffer_load_dwordx4 v17, s[8:11], s76 offen offset:1024  lds
    s_add_u32 m0, s73, 151552
    s_add_u32 s3, s76, 196608
    buffer_load_dwordx4 v16, s[8:11], s3 offen offset:0  lds
    buffer_load_dwordx4 v17, s[8:11], s3 offen offset:1024  lds
    s_add_u32 s76, s76, 393216
    s_cmp_eq_u32 s76, 6291456
    s_cselect_b32 s76, 0, s76
    s_add_u32 m0, s72, 16384
    s_nop 0
    buffer_load_dwordx4 v8, s[4:7], s74 offen offset:0  lds
    buffer_load_dwordx4 v9, s[4:7], s74 offen offset:1024  lds
    buffer_load_dwordx4 v10, s[4:7], s74 offen offset:2048  lds
    buffer_load_dwordx4 v11, s[4:7], s74 offen offset:3072  lds
    s_add_u32 m0, s72, 24576
    s_add_u32 s3, s74, 131072
    buffer_load_dwordx4 v8, s[4:7], s3 offen offset:0  lds
    buffer_load_dwordx4 v9, s[4:7], s3 offen offset:1024  lds
    buffer_load_dwordx4 v10, s[4:7], s3 offen offset:2048  lds
    buffer_load_dwordx4 v11, s[4:7], s3 offen offset:3072  lds
    s_add_u32 s74, s74, 128
    s_and_b32 s74, s74, 2047
    s_add_u32 s3, s75, 196608
    s_add_u32 m0, s73, 81920
    s_nop 0
    buffer_load_dwordx4 v12, s[8:11], s75 offen offset:0  lds
    buffer_load_dwordx4 v13, s[8:11], s75 offen offset:1024  lds
    s_add_u32 m0, s73, 90112
    s_nop 0
    buffer_load_dwordx4 v14, s[8:11], s75 offen offset:0  lds
    buffer_load_dwordx4 v15, s[8:11], s75 offen offset:1024  lds
    s_add_u32 m0, s73, 86016
    s_nop 0
    buffer_load_dwordx4 v12, s[8:11], s3 offen offset:0  lds
    buffer_load_dwordx4 v13, s[8:11], s3 offen offset:1024  lds
    s_add_u32 m0, s73, 94208
    s_nop 0
    buffer_load_dwordx4 v14, s[8:11], s3 offen offset:0  lds
    buffer_load_dwordx4 v15, s[8:11], s3 offen offset:1024  lds
    s_add_u32 s75, s75, 393216
    s_cmp_eq_u32 s75, 6291456
    s_cselect_b32 s75, 0, s75
    s_waitcnt vmcnt(36)
    s_barrier
    s_add_u32 m0, s73, 131072
    s_nop 0
    buffer_load_dwordx4 v16, s[8:11], s76 offen offset:0  lds
    buffer_load_dwordx4 v17, s[8:11], s76 offen offset:1024  lds
    s_add_u32 m0, s73, 135168
    s_add_u32 s3, s76, 196608
    buffer_load_dwordx4 v16, s[8:11], s3 offen offset:0  lds
    buffer_load_dwordx4 v17, s[8:11], s3 offen offset:1024  lds
    s_add_u32 s76, s76, 393216
    s_cmp_eq_u32 s76, 6291456
    s_cselect_b32 s76, 0, s76
    s_add_u32 m0, s72, 32768
    s_nop 0
    buffer_load_dwordx4 v8, s[4:7], s74 offen offset:0  lds
    buffer_load_dwordx4 v9, s[4:7], s74 offen offset:1024  lds
    buffer_load_dwordx4 v10, s[4:7], s74 offen offset:2048  lds
    buffer_load_dwordx4 v11, s[4:7], s74 offen offset:3072  lds
    s_add_u32 m0, s72, 40960
    s_add_u32 s3, s74, 131072
    buffer_load_dwordx4 v8, s[4:7], s3 offen offset:0  lds
    buffer_load_dwordx4 v9, s[4:7], s3 offen offset:1024  lds
    buffer_load_dwordx4 v10, s[4:7], s3 offen offset:2048  lds
    buffer_load_dwordx4 v11, s[4:7], s3 offen offset:3072  lds
    s_add_u32 s74, s74, 128
    s_and_b32 s74, s74, 2047
    s_add_u32 s3, s75, 196608
    s_add_u32 m0, s73, 98304
    s_nop 0
    buffer_load_dwordx4 v12, s[8:11], s75 offen offset:0  lds
    buffer_load_dwordx4 v13, s[8:11], s75 offen offset:1024  lds
    s_add_u32 m0, s73, 106496
    s_nop 0
    buffer_load_dwordx4 v14, s[8:11], s75 offen offset:0  lds
    buffer_load_dwordx4 v15, s[8:11], s75 offen offset:1024  lds
    s_add_u32 m0, s73, 102400
    s_nop 0
    buffer_load_dwordx4 v12, s[8:11], s3 offen offset:0  lds
    buffer_load_dwordx4 v13, s[8:11], s3 offen offset:1024  lds
    s_add_u32 m0, s73, 110592
    s_nop 0
    buffer_load_dwordx4 v14, s[8:11], s3 offen offset:0  lds
    buffer_load_dwordx4 v15, s[8:11], s3 offen offset:1024  lds
    s_add_u32 s75, s75, 393216
    s_cmp_eq_u32 s75, 6291456
    s_cselect_b32 s75, 0, s75
    s_waitcnt vmcnt(36)
    s_barrier
    s_add_u32 m0, s73, 139264
    s_nop 0
    buffer_load_dwordx4 v16, s[8:11], s76 offen offset:0  lds
    buffer_load_dwordx4 v17, s[8:11], s76 offen offset:1024  lds
    s_add_u32 m0, s73, 143360
    s_add_u32 s3, s76, 196608
    buffer_load_dwordx4 v16, s[8:11], s3 offen offset:0  lds
    buffer_load_dwordx4 v17, s[8:11], s3 offen offset:1024  lds
    s_add_u32 s76, s76, 393216
    s_cmp_eq_u32 s76, 6291456
    s_cselect_b32 s76, 0, s76
    s_add_u32 m0, s72, 49152
    s_nop 0
    buffer_load_dwordx4 v8, s[4:7], s74 offen offset:0  lds
    buffer_load_dwordx4 v9, s[4:7], s74 offen offset:1024  lds
    buffer_load_dwordx4 v10, s[4:7], s74 offen offset:2048  lds
    buffer_load_dwordx4 v11, s[4:7], s74 offen offset:3072  lds
    s_add_u32 m0, s72, 57344
    s_add_u32 s3, s74, 131072
    buffer_load_dwordx4 v8, s[4:7], s3 offen offset:0  lds
    buffer_load_dwordx4 v9, s[4:7], s3 offen offset:1024  lds
    buffer_load_dwordx4 v10, s[4:7], s3 offen offset:2048  lds
    buffer_load_dwordx4 v11, s[4:7], s3 offen offset:3072  lds
    s_add_u32 s74, s74, 128
    s_and_b32 s74, s74, 2047
    s_add_u32 s3, s75, 196608
    s_add_u32 m0, s73, 114688
    s_nop 0
    buffer_load_dwordx4 v12, s[8:11], s75 offen offset:0  lds
    buffer_load_dwordx4 v13, s[8:11], s75 offen offset:1024  lds
    s_add_u32 m0, s73, 122880
    s_nop 0
    buffer_load_dwordx4 v14, s[8:11], s75 offen offset:0  lds
    buffer_load_dwordx4 v15, s[8:11], s75 offen offset:1024  lds
    s_add_u32 m0, s73, 118784
    s_nop 0
    buffer_load_dwordx4 v12, s[8:11], s3 offen offset:0  lds
    buffer_load_dwordx4 v13, s[8:11], s3 offen offset:1024  lds
    s_add_u32 m0, s73, 126976
    s_nop 0
    buffer_load_dwordx4 v14, s[8:11], s3 offen offset:0  lds
    buffer_load_dwordx4 v15, s[8:11], s3 offen offset:1024  lds
    s_add_u32 s75, s75, 393216
    s_cmp_eq_u32 s75, 6291456
    s_cselect_b32 s75, 0, s75
    s_waitcnt vmcnt(36)
    s_barrier
    s_getpc_b64 s[66:67]
L_pc2:
    s_add_u32 s66, s66, L_e1-L_pc2
    s_addc_u32 s67, s67, 0
    s_lshr_b32 s3, s2, 3
    s_lshl_b32 s3, s3, 1
    s_add_u32 s3, s3, s38
    s_lshl_b32 s3, s3, 6
    s_add_u32 s66, s66, s3
    s_addc_u32 s67, s67, 0
    s_load_dword s65, s[66:67], 0
    s_load_dword s65, s[66:67], 4096
    s_load_dword s65, s[66:67], 8192
    s_load_dword s65, s[66:67], 12288
    s_add_u32 m0, s73, 147456
    s_nop 0
    buffer_load_dwordx4 v16, s[8:11], s76 offen offset:0  lds
    buffer_load_dwordx4 v17, s[8:11], s76 offen offset:1024  lds
    s_add_u32 m0, s73, 151552
    s_add_u32 s3, s76, 196608
    buffer_load_dwordx4 v16, s[8:11], s3 offen offset:0  lds
    buffer_load_dwordx4 v17, s[8:11], s3 offen offset:1024  lds
    s_add_u32 s76, s76, 393216
    s_cmp_eq_u32 s76, 6291456
    s_cselect_b32 s76, 0, s76
    s_add_u32 m0, s72, 0
    s_nop 0
    buffer_load_dwordx4 v8, s[4:7], s74 offen offset:0  lds
    buffer_load_dwordx4 v9, s[4:7], s74 offen offset:1024  lds
    buffer_load_dwordx4 v10, s[4:7], s74 offen offset:2048  lds
    buffer_load_dwordx4 v11, s[4:7], s74 offen offset:3072  lds
    s_add_u32 m0, s72, 8192
    s_add_u32 s3, s74, 131072
    buffer_load_dwordx4 v8, s[4:7], s3 offen offset:0  lds
    buffer_load_dwordx4 v9, s[4:7], s3 offen offset:1024  lds
    buffer_load_dwordx4 v10, s[4:7], s3 offen offset:2048  lds
    buffer_load_dwordx4 v11, s[4:7], s3 offen offset:3072  lds
    s_add_u32 s74, s74, 128
    s_and_b32 s74, s74, 2047
    s_add_u32 s3, s75, 196608
    s_add_u32 m0, s73, 65536
    s_nop 0
    buffer_load_dwordx4 v12, s[8:11], s75 offen offset:0  lds
    buffer_load_dwordx4 v13, s[8:11], s75 offen offset:1024  lds
    s_add_u32 m0, s73, 73728
    s_nop 0
    buffer_load_dwordx4 v14, s[8:11], s75 offen offset:0  lds
    buffer_load_dwordx4 v15, s[8:11], s75 offen offset:1024  lds
    s_add_u32 m0, s73, 69632
    s_nop 0
    buffer_load_dwordx4 v12, s[8:11], s3 offen offset:0  lds
    buffer_load_dwordx4 v13, s[8:11], s3 offen offset:1024  lds
    s_add_u32 m0, s73, 77824
    s_nop 0
    buffer_load_dwordx4 v14, s[8:11], s3 offen offset:0  lds
    buffer_load_dwordx4 v15, s[8:11], s3 offen offset:1024  lds
    s_add_u32 s75, s75, 393216
    s_cmp_eq_u32 s75, 6291456
    s_cselect_b32 s75, 0, s75
    buffer_load_dwordx4 v[232:235], v248, s[4:7], 0 offen
    buffer_load_dwordx4 v[236:239], v248, s[4:7], s48 offen
    buffer_load_dwordx4 v[240:243], v248, s[4:7], s49 offen
    buffer_load_dwordx4 v[244:247], v248, s[4:7], s100 offen
    s_waitcnt vmcnt(40)
    s_barrier
    s_add_u32 m0, s73, 131072
    s_nop 0
    buffer_load_dwordx4 v16, s[8:11], s76 offen offset:0  lds
    buffer_load_dwordx4 v17, s[8:11], s76 offen offset:1024  lds
    s_add_u32 m0, s73, 135168
    s_add_u32 s3, s76, 196608
    buffer_load_dwordx4 v16, s[8:11], s3 offen offset:0  lds
    buffer_load_dwordx4 v17, s[8:11], s3 offen offset:1024  lds
    s_add_u32 s76, s76, 393216
    s_cmp_eq_u32 s76, 6291456
    s_cselect_b32 s76, 0, s76
    s_add_u32 m0, s72, 16384
    s_nop 0
    buffer_load_dwordx4 v8, s[4:7], s74 offen offset:0  lds
    buffer_load_dwordx4 v9, s[4:7], s74 offen offset:1024  lds
    buffer_load_dwordx4 v10, s[4:7], s74 offen offset:2048  lds
    buffer_load_dwordx4 v11, s[4:7], s74 offen offset:3072  lds
    s_add_u32 m0, s72, 24576
    s_add_u32 s3, s74, 131072
    buffer_load_dwordx4 v8, s[4:7], s3 offen offset:0  lds
    buffer_load_dwordx4 v9, s[4:7], s3 offen offset:1024  lds
    buffer_load_dwordx4 v10, s[4:7], s3 offen offset:2048  lds
    buffer_load_dwordx4 v11, s[4:7], s3 offen offset:3072  lds
    s_add_u32 s74, s74, 128
    s_and_b32 s74, s74, 2047
    s_add_u32 s3, s75, 196608
    s_add_u32 m0, s73, 81920
    s_nop 0
    buffer_load_dwordx4 v12, s[8:11], s75 offen offset:0  lds
    buffer_load_dwordx4 v13, s[8:11], s75 offen offset:1024  lds
    s_add_u32 m0, s73, 90112
    s_nop 0
    buffer_load_dwordx4 v14, s[8:11], s75 offen offset:0  lds
    buffer_load_dwordx4 v15, s[8:11], s75 offen offset:1024  lds
    s_add_u32 m0, s73, 86016
    s_nop 0
    buffer_load_dwordx4 v12, s[8:11], s3 offen offset:0  lds
    buffer_load_dwordx4 v13, s[8:11], s3 offen offset:1024  lds
    s_add_u32 m0, s73, 94208
    s_nop 0
    buffer_load_dwordx4 v14, s[8:11], s3 offen offset:0  lds
    buffer_load_dwordx4 v15, s[8:11], s3 offen offset:1024  lds
    s_add_u32 s75, s75, 393216
    s_cmp_eq_u32 s75, 6291456
    s_cselect_b32 s75, 0, s75
    s_waitcnt vmcnt(40)
    s_barrier
    s_add_u32 m0, s73, 139264
    s_nop 0
    buffer_load_dwordx4 v16, s[8:11], s76 offen offset:0  lds
    buffer_load_dwordx4 v17, s[8:11], s76 offen offset:1024  lds
    s_add_u32 m0, s73, 143360
    s_add_u32 s3, s76, 196608
    buffer_load_dwordx4 v16, s[8:11], s3 offen offset:0  lds
    buffer_load_dwordx4 v17, s[8:11], s3 offen offset:1024  lds
    s_add_u32 s76, s76, 393216
    s_cmp_eq_u32 s76, 6291456
    s_cselect_b32 s76, 0, s76
    s_add_u32 m0, s72, 32768
    s_nop 0
    buffer_load_dwordx4 v8, s[4:7], s74 offen offset:0  lds
    buffer_load_dwordx4 v9, s[4:7], s74 offen offset:1024  lds
    buffer_load_dwordx4 v10, s[4:7], s74 offen offset:2048  lds
    buffer_load_dwordx4 v11, s[4:7], s74 offen offset:3072  lds
    s_add_u32 m0, s72, 40960
    s_add_u32 s3, s74, 131072
    buffer_load_dwordx4 v8, s[4:7], s3 offen offset:0  lds
    buffer_load_dwordx4 v9, s[4:7], s3 offen offset:1024  lds
    buffer_load_dwordx4 v10, s[4:7], s3 offen offset:2048  lds
    buffer_load_dwordx4 v11, s[4:7], s3 offen offset:3072  lds
    s_add_u32 s74, s74, 128
    s_and_b32 s74, s74, 2047
    s_add_u32 s3, s75, 196608
    s_add_u32 m0, s73, 98304
    s_nop 0
    buffer_load_dwordx4 v12, s[8:11], s75 offen offset:0  lds
    buffer_load_dwordx4 v13, s[8:11], s75 offen offset:1024  lds
    s_add_u32 m0, s73, 106496
    s_nop 0
    buffer_load_dwordx4 v14, s[8:11], s75 offen offset:0  lds
    buffer_load_dwordx4 v15, s[8:11], s75 offen offset:1024  lds
    s_add_u32 m0, s73, 102400
    s_nop 0
    buffer_load_dwordx4 v12, s[8:11], s3 offen offset:0  lds
    buffer_load_dwordx4 v13, s[8:11], s3 offen offset:1024  lds
    s_add_u32 m0, s73, 110592
    s_nop 0
    buffer_load_dwordx4 v14, s[8:11], s3 offen offset:0  lds
    buffer_load_dwordx4 v15, s[8:11], s3 offen offset:1024  lds
    s_add_u32 s75, s75, 393216
    s_cmp_eq_u32 s75, 6291456
    s_cselect_b32 s75, 0, s75
    s_waitcnt vmcnt(44)
    s_waitcnt vmcnt(20)
    s_barrier
    s_add_u32 m0, s72, 49152
    s_nop 0
    buffer_load_dwordx4 v8, s[4:7], s74 offen offset:0  lds
    buffer_load_dwordx4 v9, s[4:7], s74 offen offset:1024  lds
    buffer_load_dwordx4 v10, s[4:7], s74 offen offset:2048  lds
    buffer_load_dwordx4 v11, s[4:7], s74 offen offset:3072  lds
    s_add_u32 m0, s72, 57344
    s_add_u32 s3, s74, 131072
    buffer_load_dwordx4 v8, s[4:7], s3 offen offset:0  lds
    buffer_load_dwordx4 v9, s[4:7], s3 offen offset:1024  lds
    buffer_load_dwordx4 v10, s[4:7], s3 offen offset:2048  lds
    buffer_load_dwordx4 v11, s[4:7], s3 offen offset:3072  lds
    s_add_u32 s74, s74, 128
    s_and_b32 s74, s74, 2047
    s_waitcnt vmcnt(8)
    v_mov_b32 v19, 14
    ds_write_b32 v27, v19
    s_add_u32 s3, s75, 196608
    s_add_u32 m0, s73, 114688
    s_nop 0
    buffer_load_dwordx4 v12, s[8:11], s75 offen offset:0  lds
    buffer_load_dwordx4 v13, s[8:11], s75 offen offset:1024  lds
    s_add_u32 m0, s73, 122880
    s_nop 0
    buffer_load_dwordx4 v14, s[8:11], s75 offen offset:0  lds
    buffer_load_dwordx4 v15, s[8:11], s75 offen offset:1024  lds
    s_add_u32 m0, s73, 118784
    s_nop 0
    buffer_load_dwordx4 v12, s[8:11], s3 offen offset:0  lds
    buffer_load_dwordx4 v13, s[8:11], s3 offen offset:1024  lds
    s_add_u32 m0, s73, 126976
    s_nop 0
    buffer_load_dwordx4 v14, s[8:11], s3 offen offset:0  lds
    buffer_load_dwordx4 v15, s[8:11], s3 offen offset:1024  lds
    s_add_u32 s75, s75, 393216
    s_cmp_eq_u32 s75, 6291456
    s_cselect_b32 s75, 0, s75
    s_add_u32 m0, s73, 147456
    s_nop 0
    buffer_load_dwordx4 v16, s[8:11], s76 offen offset:0  lds
    buffer_load_dwordx4 v17, s[8:11], s76 offen offset:1024  lds
    s_add_u32 m0, s73, 151552
    s_add_u32 s3, s76, 196608
    buffer_load_dwordx4 v16, s[8:11], s3 offen offset:0  lds
    buffer_load_dwordx4 v17, s[8:11], s3 offen offset:1024  lds
    s_add_u32 s76, s76, 393216
    s_cmp_eq_u32 s76, 6291456
    s_cselect_b32 s76, 0, s76
    s_waitcnt lgkmcnt(0)
    s_branch L_join
L_xw:
    v_lshlrev_b32 v3, 4, v1
    s_mov_b32 s12, s62
    s_mov_b32 s13, s63
    s_mov_b32 s14, 268435456
    s_mov_b32 s15, 0x00020000
    s_mov_b32 s24, s58
    s_mov_b32 s25, s59
    s_mov_b32 s26, 4194304
    s_mov_b32 s27, 0x00020000
    s_mov_b32 s16, s60
    s_mov_b32 s17, s61
    s_mov_b32 s18, 256
    s_mov_b32 s19, 0x00020000
    s_mov_b32 s20, s44
    s_mov_b32 s21, s45
    s_mov_b32 s22, 65536
    s_mov_b32 s23, 0x00020000
    s_and_b32 s30, s2, 3
    s_lshl_b32 s30, s30, 2
    s_bfe_u32 s3, s2, 0x20003
    s_add_u32 s30, s30, s3
    s_bfe_u32 s31, s2, 0x10002
    s_lshl_b32 s31, s31, 3
    s_lshr_b32 s3, s2, 5
    s_add_u32 s31, s31, s3
    s_mov_b32 s70, 0
    s_mov_b32 s80, s52
    s_mov_b32 s81, s53
    s_mov_b32 s82, 7340032
    s_mov_b32 s83, 0x00020000
    s_mov_b32 s84, s54
    s_mov_b32 s85, s55
    s_mov_b32 s86, 7340032
    s_mov_b32 s87, 0x00020000
    s_cmp_lt_u32 s2, 224
    s_cselect_b32 s82, s82, 0
    s_cselect_b32 s86, s86, 0
    s_and_b32 s3, s2, 15
    s_lshl_b32 s3, s3, 6
    v_and_b32 v5, 0x38, v1
    v_add_u32 v5, s3, v5
    v_mul_u32_u24 v5, 7168, v5
    v_and_b32 v6, 7, v1
    v_lshl_add_u32 v2, v6, 4, v5
    s_lshr_b32 s77, s2, 4
    s_lshl_b32 s77, s77, 2
    s_add_u32 s77, s77, s38
    s_lshl_b32 s77, s77, 7
    v_and_b32 v5, 1, v1
    v_cmp_eq_u32 vcc, 0, v5
    v_mov_b32 v6, 0xffff0000
    v_mov_b32 v7, 0xffff
    v_cndmask_b32 v6, v6, v7, vcc
    v_bfe_u32 v5, v1, 1, 2
    v_cmp_eq_u32 vcc, 0, v5
    s_nop 1
    v_cndmask_b32 v88, 0, v6, vcc
    v_cmp_eq_u32 vcc, 1, v5
    s_nop 1
    v_cndmask_b32 v89, 0, v6, vcc
    v_cmp_eq_u32 vcc, 2, v5
    s_nop 1
    v_cndmask_b32 v90, 0, v6, vcc
    v_cmp_eq_u32 vcc, 3, v5
    s_nop 1
    v_cndmask_b32 v91, 0, v6, vcc
    v_and_b32 v20, 0x3f803f80, v88
    v_and_b32 v21, 0x3f803f80, v89
    v_and_b32 v22, 0x3f803f80, v90
    v_and_b32 v23, 0x3f803f80, v91
    s_lshl_b32 s3, s30, 7
    s_lshl_b32 s65, s38, 5
    s_add_u32 s3, s3, s65
    v_lshrrev_b32 v249, 3, v1
    v_add_u32 v6, s3, v249
    v_lshlrev_b32 v6, 11, v6
    v_and_b32 v250, 7, v1
    v_lshl_add_u32 v6, v250, 4, v6
    s_lshl_b32 s3, s31, 7
    v_add_u32 v248, s3, v6
    s_mov_b32 s48, 16384
    s_mov_b32 s49, 32768
    s_mov_b32 s100, 49152
    s_lshl_b32 s3, s38, 2
    s_add_u32 s3, s3, 163136
    v_mov_b32 v27, s3
    v_mov_b32 v26, 163104
    v_mov_b32 v28, 0x3f803f80
    v_mov_b32 v29, 0x3f803f80
    v_mov_b32 v30, 0x3f803f80
    v_mov_b32 v31, 0x3f803f80
    v_lshrrev_b32 v5, 4, v1
    v_lshlrev_b32 v4, 3, v5
    v_bfe_u32 v6, v1, 2, 2
    v_add_u32 v4, v4, v6
    v_lshlrev_b32 v4, 7, v4
    v_and_b32 v5, 3, v1
    v_lshl_add_u32 v4, v5, 3, v4
    v_add_u32 v4, 65536, v4
    s_and_b32 s3, s38, 1
    s_lshl_b32 s3, s3, 1
    v_bfe_u32 v6, v1, 3, 2
    v_xor_b32 v6, s3, v6
    v_lshl_add_u32 v252, v6, 5, v4
    v_xor_b32 v6, 1, v6
    v_lshl_add_u32 v253, v6, 5, v4
    s_mul_i32 s3, s101, 43
    s_lshr_b32 s3, s3, 7
    s_mul_i32 s3, s3, 3
    s_sub_u32 s3, s101, s3
    s_lshl_b32 s65, s3, 13
    s_add_u32 s65, s65, 65536
    v_add_u32 v32, s65, v252
    v_add_u32 v33, s65, v253
    s_and_b32 s3, s101, 3
    s_lshl_b32 s3, s3, 14
    v_add_u32 v252, s3, v252
    v_add_u32 v253, s3, v253
    s_lshl_b32 s3, s37, 4
    s_add_u32 s3, s3, s36
    s_lshl_b32 s3, s3, 10
    s_and_b32 s65, s38, 1
    s_lshl_b32 s65, s65, 9
    s_add_u32 s3, s3, s65
    s_add_u32 s68, s3, 1048576
    s_mov_b32 s79, 0
    v_mov_b32 v34, 0
    v_mov_b32 v35, 0
    v_mov_b32 v5, 163104
    ds_write_b64 v5, v[34:35]
    ds_write_b64 v5, v[34:35] offset:8
    ds_write_b64 v5, v[34:35] offset:16
    ds_write_b64 v5, v[34:35] offset:24
    ds_write_b64 v5, v[34:35] offset:32
    ds_write_b64 v5, v[34:35] offset:40
    ds_write_b64 v5, v[34:35] offset:48
    ds_write_b64 v5, v[34:35] offset:56
    ds_write_b64 v5, v[34:35] offset:64
    ds_write_b64 v5, v[34:35] offset:72
    ds_write_b64 v5, v[34:35] offset:80
    ds_write_b64 v5, v[34:35] offset:88
    ds_write_b64 v5, v[34:35] offset:96
    ds_write_b64 v5, v[34:35] offset:112
    ds_write_b64 v5, v[34:35] offset:120
    v_and_b32 v5, 16, v1
    v_cmp_eq_u32 s[66:67], 0, v5
    s_getreg_b32 s69, hwreg(HW_REG_XCC_ID, 0, 4)
L_x0:
    s_barrier
    s_add_u32 s79, s79, 1
    s_cmp_le_u32 s79, s101
    s_cbranch_scc1 L_x0
    buffer_load_dword v18, v34, s[16:19], 0 offen sc1
    ds_read_b64_tr_b16 v[144:145], v252 offset:0
    ds_read_b64_tr_b16 v[146:147], v252 offset:512
    ds_read_b64_tr_b16 v[148:149], v252 offset:4096
    ds_read_b64_tr_b16 v[150:151], v252 offset:4608
    ds_read_b64_tr_b16 v[168:169], v253 offset:0
    ds_read_b64_tr_b16 v[170:171], v253 offset:512
    ds_read_b64_tr_b16 v[172:173], v253 offset:4096
    ds_read_b64_tr_b16 v[174:175], v253 offset:4608
    s_waitcnt lgkmcnt(4)
    ds_read_b64_tr_b16 v[152:153], v252 offset:8192
    ds_read_b64_tr_b16 v[154:155], v252 offset:8704
    ds_read_b64_tr_b16 v[156:157], v252 offset:12288
    ds_read_b64_tr_b16 v[158:159], v252 offset:12800
    ds_read_b64_tr_b16 v[176:177], v253 offset:8192
    ds_read_b64_tr_b16 v[178:179], v253 offset:8704
    ds_read_b64_tr_b16 v[180:181], v253 offset:12288
    ds_read_b64_tr_b16 v[182:183], v253 offset:12800
    s_waitcnt lgkmcnt(4)
    ds_read_b64_tr_b16 v[136:137], v32 offset:0
    ds_read_b64_tr_b16 v[138:139], v32 offset:512
    ds_read_b64_tr_b16 v[140:141], v32 offset:4096
    ds_read_b64_tr_b16 v[142:143], v32 offset:4608
    ds_read_b64_tr_b16 v[160:161], v33 offset:0
    ds_read_b64_tr_b16 v[162:163], v33 offset:512
    ds_read_b64_tr_b16 v[164:165], v33 offset:4096
    ds_read_b64_tr_b16 v[166:167], v33 offset:4608
    s_waitcnt lgkmcnt(0)
    s_barrier
    s_add_u32 s79, s79, 1
    v_mfma_f32_16x16x32_bf16 v[116:119], v[28:31], v[144:147], 0
    v_mfma_f32_16x16x32_bf16 v[120:123], v[28:31], v[152:155], 0
    v_mfma_f32_16x16x32_bf16 v[112:115], v[28:31], v[136:139], 0
    v_mfma_f32_16x16x32_bf16 v[128:131], v[28:31], v[168:171], 0
    v_mfma_f32_16x16x32_bf16 v[132:135], v[28:31], v[176:179], 0
    v_mfma_f32_16x16x32_bf16 v[124:127], v[28:31], v[160:163], 0
    v_mfma_f32_16x16x32_bf16 v[116:119], v[28:31], v[148:151], v[116:119]
    v_mfma_f32_16x16x32_bf16 v[120:123], v[28:31], v[156:159], v[120:123]
    v_mfma_f32_16x16x32_bf16 v[112:115], v[28:31], v[140:143], v[112:115]
    v_mfma_f32_16x16x32_bf16 v[128:131], v[28:31], v[172:175], v[128:131]
    v_mfma_f32_16x16x32_bf16 v[132:135], v[28:31], v[180:183], v[132:135]
    v_mfma_f32_16x16x32_bf16 v[124:127], v[28:31], v[164:167], v[124:127]
    s_barrier
    s_add_u32 s79, s79, 1
    s_waitcnt vmcnt(0)
    v_readfirstlane_b32 s3, v18
    s_nop 0
    s_cmp_lg_u32 s3, 0
    s_cbranch_scc1 L_nonok
L_non:
    buffer_load_dword v18, v34, s[16:19], 0 offen sc1
    s_cmp_lt_u32 s79, 12
    s_cbranch_scc0 L_xb3
    s_barrier
    s_add_u32 s79, s79, 1
L_xb3:
    s_waitcnt vmcnt(0)
    v_cmp_eq_u32 vcc, 0, v18
    s_nop 1
    v_cndmask_b32 v6, 0, 1, vcc
    v_cmp_ne_u32 vcc, 0, v6
    s_add_u32 s70, s70, 1
    s_cmp_ge_u32 s70, 200000
    s_cbranch_scc1 L_nonok
    s_cmp_lg_u64 vcc, 0
    s_cbranch_scc1 L_non
L_nonok:
    v_and_b32 v39, -16, v18
    v_or_b32 v39, s69, v39
    v_cndmask_b32 v36, v124, v112, s[66:67]
    v_cndmask_b32 v37, v128, v116, s[66:67]
    v_cndmask_b32 v38, v132, v120, s[66:67]
    s_mov_b64 exec, 0xffffffff
    buffer_store_dwordx4 v[36:39], v3, s[12:15], s68 offen sc1
    s_mov_b64 exec, -1
    s_cmp_eq_u32 s38, 3
    s_cbranch_scc1 L_xbw
    s_cmp_lt_u32 s79, 12
    s_cbranch_scc0 L_xb4
    s_barrier
    s_add_u32 s79, s79, 1
L_xb4:
    s_add_u32 m0, s73, 151552
    s_lshl_b32 s65, s37, 12
    s_add_u32 s65, s65, s73
    s_sub_u32 s65, s65, 4096
    buffer_load_dwordx4 v3, s[20:23], s65 offen offset:0 lds
    buffer_load_dwordx4 v3, s[20:23], s65 offen offset:1024 lds
    s_lshl_b32 s3, s36, 4
    s_add_u32 s3, s3, s37
    s_lshl_b32 s3, s3, 7
    s_add_u32 s3, s3, 1310720
    v_lshlrev_b32 v5, 3, v1
    s_mov_b64 exec, 0xffff
    buffer_store_dwordx2 v[34:35], v5, s[12:15], s3 offen sc1
    s_mov_b64 exec, -1
    s_mov_b64 exec, 0
    s_branch L_hk16
L_hr16:
    s_branch L_hk17
L_hr17:
    s_branch L_hk18
L_hr18:
    s_branch L_hk19
L_hr19:
    s_mov_b64 exec, -1
    s_cmp_lt_u32 s79, 12
    s_cbranch_scc0 L_xb5
    s_barrier
    s_add_u32 s79, s79, 1
L_xb5:
    s_mov_b64 exec, 0
    s_branch L_hk20
L_hr20:
    s_branch L_hk21
L_hr21:
    s_mov_b64 exec, -1
L_xu6:
    s_cmp_ge_u32 s79, 5
    s_cbranch_scc1 L_xe6
    s_barrier
    s_add_u32 s79, s79, 1
    s_branch L_xu6
L_xe6:
    s_lshl_b32 s68, s37, 14
    s_add_u32 s68, s68, 1048576
L_cs:
    s_mov_b32 s3, s68
    buffer_load_dwordx4 v[112:115], v3, s[12:15], s3 offen offset:0 sc1
    buffer_load_dwordx4 v[116:119], v3, s[12:15], s3 offen offset:1024 sc1
    buffer_load_dwordx4 v[120:123], v3, s[12:15], s3 offen offset:2048 sc1
    buffer_load_dwordx4 v[124:127], v3, s[12:15], s3 offen offset:3072 sc1
    s_add_u32 s3, s3, 4096
    buffer_load_dwordx4 v[128:131], v3, s[12:15], s3 offen offset:0 sc1
    buffer_load_dwordx4 v[132:135], v3, s[12:15], s3 offen offset:1024 sc1
    s_cmp_lt_u32 s79, 12
    s_cbranch_scc0 L_xb7
    s_barrier
    s_add_u32 s79, s79, 1
L_xb7:
    buffer_load_dwordx4 v[136:139], v3, s[12:15], s3 offen offset:2048 sc1
    buffer_load_dwordx4 v[140:143], v3, s[12:15], s3 offen offset:3072 sc1
    s_add_u32 s3, s3, 4096
    buffer_load_dwordx4 v[144:147], v3, s[12:15], s3 offen offset:0 sc1
    buffer_load_dwordx4 v[148:151], v3, s[12:15], s3 offen offset:1024 sc1
    buffer_load_dwordx4 v[152:155], v3, s[12:15], s3 offen offset:2048 sc1
    s_cmp_lt_u32 s79, 12
    s_cbranch_scc0 L_xb8
    s_barrier
    s_add_u32 s79, s79, 1
L_xb8:
    buffer_load_dwordx4 v[156:159], v3, s[12:15], s3 offen offset:3072 sc1
    s_add_u32 s3, s3, 4096
    buffer_load_dwordx4 v[160:163], v3, s[12:15], s3 offen offset:0 sc1
    buffer_load_dwordx4 v[164:167], v3, s[12:15], s3 offen offset:1024 sc1
    buffer_load_dwordx4 v[168:171], v3, s[12:15], s3 offen offset:2048 sc1
    buffer_load_dwordx4 v[172:175], v3, s[12:15], s3 offen offset:3072 sc1
    s_cmp_lt_u32 s79, 12
    s_cbranch_scc0 L_xb9
    s_barrier
    s_add_u32 s79, s79, 1
L_xb9:
    s_waitcnt vmcnt(0)
    v_and_b32 v4, v115, v119
    v_or_b32 v5, v115, v119
    v_min3_u32 v4, v4, v123, v127
    v_max3_u32 v5, v5, v123, v127
    v_min3_u32 v4, v4, v131, v135
    v_max3_u32 v5, v5, v131, v135
    v_min3_u32 v4, v4, v139, v143
    v_max3_u32 v5, v5, v139, v143
    v_min3_u32 v4, v4, v147, v151
    v_max3_u32 v5, v5, v147, v151
    v_min3_u32 v4, v4, v155, v159
    v_max3_u32 v5, v5, v155, v159
    v_min3_u32 v4, v4, v163, v167
    v_max3_u32 v5, v5, v163, v167
    v_min3_u32 v4, v4, v171, v175
    v_max3_u32 v5, v5, v171, v175
    v_xor_b32 v6, v4, v18
    v_xor_b32 v7, v5, v18
    v_or_b32 v6, v6, v7
    v_and_b32 v6, -16, v6
    v_cmp_ne_u32 vcc, 0, v6
    s_add_u32 s70, s70, 1
    s_cmp_ge_u32 s70, 200000
    s_cbranch_scc1 L_csok
    s_cmp_lg_u64 vcc, 0
    s_cbranch_scc1 L_cs
L_csok:
    v_xor_b32 v4, v4, v5
    v_mov_b32 v5, 163072
    ds_write_b32 v5, v4 offset:16
    s_cmp_lt_u32 s79, 12
    s_cbranch_scc0 L_xb10
    s_barrier
    s_add_u32 s79, s79, 1
L_xb10:
    v_add_f32 v112, v112, v144
    v_add_f32 v113, v113, v145
    v_add_f32 v114, v114, v146
    v_add_f32 v116, v116, v148
    v_add_f32 v117, v117, v149
    v_add_f32 v118, v118, v150
    v_add_f32 v120, v120, v152
    v_add_f32 v121, v121, v153
    v_add_f32 v122, v122, v154
    v_add_f32 v124, v124, v156
    v_add_f32 v125, v125, v157
    v_add_f32 v126, v126, v158
    v_add_f32 v128, v128, v160
    v_add_f32 v129, v129, v161
    v_add_f32 v130, v130, v162
    v_add_f32 v132, v132, v164
    v_add_f32 v133, v133, v165
    v_add_f32 v134, v134, v166
    v_add_f32 v136, v136, v168
    v_add_f32 v137, v137, v169
    v_add_f32 v138, v138, v170
    v_add_f32 v140, v140, v172
    v_add_f32 v141, v141, v173
    v_add_f32 v142, v142, v174
    s_cmp_lt_u32 s79, 12
    s_cbranch_scc0 L_xb11
    s_barrier
    s_add_u32 s79, s79, 1
L_xb11:
    v_add_f32 v112, v112, v128
    v_add_f32 v113, v113, v129
    v_add_f32 v114, v114, v130
    v_add_f32 v116, v116, v132
    v_add_f32 v117, v117, v133
    v_add_f32 v118, v118, v134
    v_add_f32 v120, v120, v136
    v_add_f32 v121, v121, v137
    v_add_f32 v122, v122, v138
    v_add_f32 v124, v124, v140
    v_add_f32 v125, v125, v141
    v_add_f32 v126, v126, v142
    v_add_f32 v112, v112, v120
    v_add_f32 v113, v113, v121
    v_add_f32 v114, v114, v122
    v_add_f32 v116, v116, v124
    v_add_f32 v117, v117, v125
    v_add_f32 v118, v118, v126
    v_add_f32 v112, v112, v116
    v_add_f32 v113, v113, v117
    v_add_f32 v114, v114, v118
    v_lshlrev_b32 v5, 2, v1
    v_add_u32 v5, 162304, v5
    ds_write_b32 v5, v112
    ds_write_b32 v5, v113 offset:256
    ds_write_b32 v5, v114 offset:512
    s_branch L_xend
L_xbw:
    v_and_b32 v5, 7, v1
    v_lshlrev_b32 v5, 3, v5
    v_add_u32 v6, 163264, v5
    ds_read_b64 v[140:141], v6
    s_lshl_b32 s65, s36, 4
    s_add_u32 s65, s65, s37
    s_lshl_b32 s65, s65, 6
    s_add_u32 s65, s65, 0
    s_lshl_b32 s3, s2, 4
    s_add_u32 s3, s3, 65536
    v_mov_b32 v146, v18
    v_mov_b32 v147, v18
    s_waitcnt lgkmcnt(0)
    v_mov_b32 v144, v141
    v_mov_b32 v145, v140
    s_nop 0
    v_max_u32 v144, v144, v144 quad_perm:[1,0,3,2] row_mask:0xf bank_mask:0xf
    s_nop 1
    v_max_u32 v144, v144, v144 quad_perm:[2,3,0,1] row_mask:0xf bank_mask:0xf
    s_nop 1
    v_max_u32 v144, v144, v144 row_half_mirror row_mask:0xf bank_mask:0xf
    v_cmp_eq_u32 vcc, v144, v141
    v_mov_b32 v141, v18
    s_mov_b64 exec, 0xff
    buffer_store_dwordx2 v[140:141], v5, s[12:15], s65 offen sc1
    s_and_b64 exec, exec, vcc
    buffer_store_dwordx4 v[144:147], v34, s[12:15], s3 offen sc1
    s_mov_b64 exec, -1
    s_cmp_lt_u32 s79, 12
    s_cbranch_scc0 L_xb12
    s_barrier
    s_add_u32 s79, s79, 1
L_xb12:
    s_add_u32 m0, s73, 151552
    s_lshl_b32 s65, s37, 12
    s_add_u32 s65, s65, s73
    s_sub_u32 s65, s65, 4096
    buffer_load_dwordx4 v3, s[20:23], s65 offen offset:0 lds
    buffer_load_dwordx4 v3, s[20:23], s65 offen offset:1024 lds
    s_mov_b64 exec, 0
    s_branch L_hk0
L_hr0:
    s_branch L_hk1
L_hr1:
    s_branch L_hk2
L_hr2:
    s_branch L_hk3
L_hr3:
    s_mov_b64 exec, -1
    s_cmp_lt_u32 s79, 12
    s_cbranch_scc0 L_xb13
    s_barrier
    s_add_u32 s79, s79, 1
L_xb13:
    s_mov_b64 exec, 0
    s_branch L_hk4
L_hr4:
    s_branch L_hk5
L_hr5:
    s_branch L_hk6
L_hr6:
    s_branch L_hk7
L_hr7:
    s_mov_b64 exec, -1
    s_cmp_lt_u32 s79, 12
    s_cbranch_scc0 L_xb14
    s_barrier
    s_add_u32 s79, s79, 1
L_xb14:
    s_mov_b64 exec, 0
    s_branch L_hk8
L_hr8:
    s_branch L_hk9
L_hr9:
    s_branch L_hk10
L_hr10:
    s_branch L_hk11
L_hr11:
    s_mov_b64 exec, -1
    s_cmp_lt_u32 s79, 12
    s_cbranch_scc0 L_xb15
    s_barrier
    s_add_u32 s79, s79, 1
L_xb15:
    s_mov_b64 exec, 0
    s_branch L_hk12
L_hr12:
    s_branch L_hk13
L_hr13:
    s_branch L_hk14
L_hr14:
    s_branch L_hk15
L_hr15:
    s_mov_b64 exec, -1
    s_cmp_lt_u32 s79, 12
    s_cbranch_scc0 L_xb16
    s_barrier
    s_add_u32 s79, s79, 1
L_xb16:
L_xu17:
    s_cmp_ge_u32 s79, 7
    s_cbranch_scc1 L_xe17
    s_barrier
    s_add_u32 s79, s79, 1
    s_branch L_xu17
L_xe17:
    s_mov_b32 s68, 65536
    s_lshl_b32 s66, s36, 10
    s_lshl_b32 s67, s30, 10
L_st:
    buffer_load_dwordx4 v[112:115], v3, s[12:15], s68 offen offset:0 sc1
    buffer_load_dwordx4 v[116:119], v3, s[12:15], s68 offen offset:1024 sc1
    buffer_load_dwordx4 v[120:123], v3, s[12:15], s68 offen offset:2048 sc1
    buffer_load_dwordx4 v[124:127], v3, s[12:15], s68 offen offset:3072 sc1
    buffer_load_dwordx4 v[128:131], v3, s[12:15], s66 offen offset:0 sc1
    buffer_load_dwordx4 v[132:135], v3, s[12:15], s67 offen offset:0 sc1
    s_cmp_lt_u32 s79, 12
    s_cbranch_scc0 L_xb18
    s_barrier
    s_add_u32 s79, s79, 1
L_xb18:
    s_waitcnt vmcnt(0)
    v_and_b32 v6, v114, v118
    v_or_b32 v7, v114, v118
    v_min3_u32 v6, v6, v122, v126
    v_max3_u32 v7, v7, v122, v126
    v_min3_u32 v6, v6, v129, v131
    v_max3_u32 v7, v7, v129, v131
    v_min3_u32 v6, v6, v133, v135
    v_max3_u32 v7, v7, v133, v135
    v_xor_b32 v6, v6, v18
    v_xor_b32 v7, v7, v18
    v_or_b32 v6, v6, v7
    v_cmp_ne_u32 vcc, 0, v6
    s_add_u32 s70, s70, 1
    s_cmp_ge_u32 s70, 200000
    s_cbranch_scc1 L_stok
    s_cmp_lg_u64 vcc, 0
    s_cbranch_scc1 L_st
L_stok:
    s_cmp_lt_u32 s79, 12
    s_cbranch_scc0 L_xb19
    s_barrier
    s_add_u32 s79, s79, 1
L_xb19:
    v_and_b32 v140, 0xffff0000, v128
    v_and_b32 v141, 0xffff0000, v130
    v_and_b32 v142, 0xffff0000, v132
    v_and_b32 v143, 0xffff0000, v134
    v_rcp_f32 v144, v140
    v_rcp_f32 v145, v141
    v_rcp_f32 v146, v142
    v_rcp_f32 v147, v143
    v_lshlrev_b32 v136, 16, v128
    v_lshlrev_b32 v137, 16, v130
    v_lshlrev_b32 v138, 16, v132
    v_lshlrev_b32 v139, 16, v134
    v_lshrrev_b32 v7, 16, v128
    v_or_b32 v7, v7, v141
    v_lshlrev_b32 v5, 3, v1
    v_add_u32 v5, 159744, v5
    v_lshlrev_b32 v4, 2, v1
    v_add_u32 v4, 160768, v4
    v_fma_f32 v140, -v144, v140, 1.0
    v_fma_f32 v141, -v145, v141, 1.0
    v_fma_f32 v142, -v146, v142, 1.0
    v_fma_f32 v143, -v147, v143, 1.0
    v_fmac_f32 v144, v140, v144
    v_fmac_f32 v145, v141, v145
    v_fmac_f32 v146, v142, v146
    v_fmac_f32 v147, v143, v147
    v_xor_b32 v136, 0x80000000, v136
    v_xor_b32 v137, 0x80000000, v137
    v_mul_f32 v140, 0x3fb8aa3b, v144
    v_mul_f32 v141, 0x3fb8aa3b, v145
    s_cmp_lt_u32 s79, 12
    s_cbranch_scc0 L_xb20
    s_barrier
    s_add_u32 s79, s79, 1
L_xb20:
    ds_write_b64 v5, v[140:141] offset:3584
    ds_write_b64 v5, v[136:137]
    ds_write_b64 v5, v[144:145] offset:512
    ds_write_b64 v5, v[138:139] offset:1536
    ds_write_b64 v5, v[146:147] offset:2048
    ds_write_b32 v4, v7
    v_cmp_gt_u32 vcc, v116, v112
    s_nop 1
    v_cndmask_b32 v112, v112, v116, vcc
    v_cndmask_b32 v113, v113, v117, vcc
    v_cmp_gt_u32 vcc, v124, v120
    s_nop 1
    v_cndmask_b32 v120, v120, v124, vcc
    v_cndmask_b32 v121, v121, v125, vcc
    v_cmp_gt_u32 vcc, v120, v112
    s_nop 1
    v_cndmask_b32 v112, v112, v120, vcc
    v_cndmask_b32 v113, v113, v121, vcc
    v_mov_b32 v6, v112
    s_cmp_lt_u32 s79, 12
    s_cbranch_scc0 L_xb21
    s_barrier
    s_add_u32 s79, s79, 1
L_xb21:
    v_max_u32 v6, v6, v6 quad_perm:[1,0,3,2] row_mask:0xf bank_mask:0xf
    s_nop 1
    v_max_u32 v6, v6, v6 quad_perm:[2,3,0,1] row_mask:0xf bank_mask:0xf
    s_nop 1
    v_max_u32 v6, v6, v6 row_half_mirror row_mask:0xf bank_mask:0xf
    s_nop 1
    v_max_u32 v6, v6, v6 row_mirror row_mask:0xf bank_mask:0xf
    v_mov_b32 v7, v6
    s_nop 1
    v_permlane16_swap_b32 v6, v7
    v_max_u32 v6, v6, v7
    v_mov_b32 v7, v6
    s_nop 1
    v_permlane32_swap_b32 v6, v7
    v_max_u32 v6, v6, v7
    v_cmp_eq_u32 vcc, v6, v112
    v_mov_b32 v5, 163072
    s_mov_b64 exec, vcc
    ds_write_b128 v5, v[112:115]
    s_mov_b64 exec, -1
L_xend:
    s_waitcnt lgkmcnt(0)
    buffer_load_dwordx4 v[232:235], v248, s[4:7], 0 offen
    buffer_load_dwordx4 v[236:239], v248, s[4:7], s48 offen
    buffer_load_dwordx4 v[240:243], v248, s[4:7], s49 offen
    buffer_load_dwordx4 v[244:247], v248, s[4:7], s100 offen
L_xu22:
    s_cmp_ge_u32 s79, 12
    s_cbranch_scc1 L_xe22
    s_barrier
    s_add_u32 s79, s79, 1
    s_branch L_xu22
L_xe22:
    s_barrier
    s_sleep 6
L_join:
    s_add_u32 s76, s39, 15
    s_and_b32 s76, s76, 15
    s_mul_i32 s76, s76, 393216
    buffer_load_dwordx4 v[36:39], v16, s[8:11], s76 offen offset:0
    buffer_load_dwordx4 v[40:43], v17, s[8:11], s76 offen offset:1024
    s_waitcnt vmcnt(2)
L_hk0:
    s_cbranch_execz L_hr0
    v_mov_b32 v19, 15
    ds_write_b32 v27, v19
    buffer_load_dwordx4 v[128:131], v2, s[80:83], s77 offen nt
    buffer_load_dwordx4 v[160:163], v2, s[84:87], s77 offen nt
    s_add_u32 s77, s77, 7168
    buffer_load_dwordx4 v[132:135], v2, s[80:83], s77 offen nt
    buffer_load_dwordx4 v[164:167], v2, s[84:87], s77 offen nt
    s_add_u32 s77, s77, 7168
    v_mov_b32 v5, 163072
    ds_read_b128 v[80:83], v5
    ds_read_b32 v84, v5 offset:16
    s_and_b32 s65, s2, 15
    s_lshl_b32 s65, s65, 7
    v_lshrrev_b32 v5, 3, v1
    v_lshlrev_b32 v5, 4, v5
    s_waitcnt lgkmcnt(0)
    v_readfirstlane_b32 s33, v80
    v_readfirstlane_b32 s64, v81
    v_mov_b32 v18, v82
    v_readfirstlane_b32 s88, v84
    s_and_b32 s34, s33, 0x7ff
    s_sub_u32 s34, 2047, s34
    s_lshl_b32 s3, s34, 11
    s_add_u32 s3, s3, s65
    buffer_load_dwordx4 v[76:79], v5, s[4:7], s3 offen
    s_lshr_b32 s3, s34, 7
    s_cmp_eq_u32 s3, s30
    s_cselect_b32 s35, 1, 0
    s_mov_b32 s16, s46
    s_mov_b32 s17, s47
    s_mov_b32 s18, 2097152
    s_mov_b32 s19, 0x00020000
    s_lshl_b32 s3, s2, 2
    s_add_u32 s3, s3, s38
    s_lshl_b32 s3, s3, 11
    v_lshlrev_b32 v5, 7, v1
    s_mov_b64 exec, 0xffff
    buffer_load_dword v0, v5, s[16:19], s3 offen
    s_mov_b64 exec, -1
    buffer_load_dwordx4 v[136:139], v2, s[80:83], s77 offen nt
    buffer_load_dwordx4 v[168:171], v2, s[84:87], s77 offen nt
    s_add_u32 s77, s77, 7168
    buffer_load_dwordx4 v[140:143], v2, s[80:83], s77 offen nt
    buffer_load_dwordx4 v[172:175], v2, s[84:87], s77 offen nt
    s_add_u32 s77, s77, 7168
L_pe14:
    ds_read_b128 v[224:227], v26 offset:48
    s_waitcnt lgkmcnt(0)
    v_min_u32 v224, v224, v225
    v_min3_u32 v224, v224, v226, v227
    s_nop 0
    v_readfirstlane_b32 s3, v224
    s_nop 0
    s_cmp_ge_u32 s3, 14
    s_cbranch_scc1 L_pd14
    s_sleep 3
    s_branch L_pe14
L_pd14:
    s_waitcnt vmcnt(10)
    s_add_u32 s3, s73, 65536
    v_add_u32 v24, s3, v3
    ds_write_b128 v24, v[36:39] offset:16384
    ds_write_b128 v24, v[40:43] offset:17408
    s_lshl_b32 s3, s38, 2
    s_add_u32 s3, s3, 163120
    v_mov_b32 v5, s3
L_hk1:
    s_cbranch_execz L_hr1
    v_mov_b32 v6, 1
    ds_write_b32 v5, v6
    buffer_load_dwordx4 v[144:147], v2, s[80:83], s77 offen nt
    buffer_load_dwordx4 v[176:179], v2, s[84:87], s77 offen nt
    s_add_u32 s77, s77, 7168
    buffer_load_dwordx4 v[148:151], v2, s[80:83], s77 offen nt
    buffer_load_dwordx4 v[180:183], v2, s[84:87], s77 offen nt
    s_add_u32 s77, s77, 7168
    buffer_load_dwordx4 v[152:155], v2, s[80:83], s77 offen nt
    buffer_load_dwordx4 v[184:187], v2, s[84:87], s77 offen nt
    s_add_u32 s77, s77, 7168
    buffer_load_dwordx4 v[156:159], v2, s[80:83], s77 offen nt
    buffer_load_dwordx4 v[188:191], v2, s[84:87], s77 offen nt
    s_add_u32 s77, s77, 7168
    s_mov_b32 s20, s56
    s_mov_b32 s21, s57
    s_mov_b32 s22, 7340032
    s_mov_b32 s23, 0x00020000
    s_cmp_lt_u32 s2, 224
    s_cselect_b32 s22, s22, 0
    v_lshrrev_b32 v5, 4, v1
    v_lshlrev_b32 v5, 11, v5
    v_and_b32 v6, 15, v1
    v_lshl_add_u32 v109, v6, 4, v5
    s_lshl_b32 s93, s2, 15
    s_lshl_b32 s65, s38, 9
    s_add_u32 s93, s93, s65
    buffer_load_dwordx4 v[192:195], v109, s[20:23], s93 offen offset:0 nt
    buffer_load_dwordx4 v[196:199], v109, s[20:23], s93 offen offset:256 nt
    s_add_u32 s93, s93, 8192
    buffer_load_dwordx4 v[200:203], v109, s[20:23], s93 offen offset:0 nt
    buffer_load_dwordx4 v[204:207], v109, s[20:23], s93 offen offset:256 nt
    s_add_u32 s93, s93, 8192
    buffer_load_dwordx4 v[208:211], v109, s[20:23], s93 offen offset:0 nt
    buffer_load_dwordx4 v[212:215], v109, s[20:23], s93 offen offset:256 nt
    s_add_u32 s93, s93, 8192
    buffer_load_dwordx4 v[216:219], v109, s[20:23], s93 offen offset:0 nt
    buffer_load_dwordx4 v[220:223], v109, s[20:23], s93 offen offset:256 nt
    s_lshl_b32 s65, s37, 1
    s_and_b32 s3, s38, 1
    s_add_u32 s65, s65, s3
    s_lshl_b32 s3, s36, 9
    s_lshl_b32 s89, s65, 17
    s_add_u32 s89, s89, s3
    s_add_u32 s89, s89, 2097152
    s_add_u32 s90, s89, 32768
    s_add_u32 s91, s89, 65536
    s_add_u32 s92, s89, 98304
    s_lshl_b32 s69, s65, 13
    s_add_u32 s69, s69, 524288
    s_add_u32 s68, s69, s3
    s_add_u32 s71, s69, 4096
    s_mov_b32 s94, 0xffff
    s_mov_b32 s95, 0xffff
    v_lshrrev_b32 v5, 4, v1
    v_and_b32 v6, 15, v1
    v_lshlrev_b32 v6, 4, v6
    v_lshl_add_u32 v28, v5, 13, v6
    v_lshrrev_b32 v7, 5, v1
    v_lshl_add_u32 v29, v7, 8, v6
    s_lshl_b32 s3, s38, 12
    s_add_u32 s3, s3, 141312
    v_add_u32 v30, s3, v3
    s_lshl_b32 s3, s38, 7
    s_add_u32 s3, s3, 157440
L_hk2:
    s_cbranch_execz L_hr2
    v_lshl_add_u32 v31, v5, 3, s3
    v_and_b32 v5, 8, v1
    v_cmp_eq_u32 vcc, 0, v5
    s_nop 1
    v_cndmask_b32 v112, 0, v20, vcc
    v_cndmask_b32 v116, v20, 0, vcc
    v_cndmask_b32 v113, 0, v21, vcc
    v_cndmask_b32 v117, v21, 0, vcc
    v_cndmask_b32 v114, 0, v22, vcc
    v_cndmask_b32 v118, v22, 0, vcc
    v_cndmask_b32 v115, 0, v23, vcc
    v_cndmask_b32 v119, v23, 0, vcc
    v_mov_b32 v127, v18
    s_waitcnt vmcnt(21)
    s_lshl_b32 s65, s64, 16
    s_and_b32 s66, s64, 0xffff0000
    v_rcp_f32 v6, s66
    v_lshlrev_b32 v80, 16, v76
    v_and_b32 v81, 0xffff0000, v76
    v_lshlrev_b32 v82, 16, v77
    v_and_b32 v83, 0xffff0000, v77
    v_lshlrev_b32 v84, 16, v78
    v_and_b32 v85, 0xffff0000, v78
    v_lshlrev_b32 v86, 16, v79
    v_and_b32 v87, 0xffff0000, v79
    v_fma_f32 v4, -v6, s66, 1.0
    v_fmac_f32 v6, v4, v6
    v_subrev_f32 v80, s65, v80
    v_subrev_f32 v81, s65, v81
    v_subrev_f32 v82, s65, v82
    v_subrev_f32 v83, s65, v83
    v_subrev_f32 v84, s65, v84
    v_subrev_f32 v85, s65, v85
    v_subrev_f32 v86, s65, v86
    v_subrev_f32 v87, s65, v87
    v_cvt_pk_bf16_f32 v80, v80, v80
    v_cvt_pk_bf16_f32 v81, v81, v81
    v_cvt_pk_bf16_f32 v82, v82, v82
    v_cvt_pk_bf16_f32 v83, v83, v83
    v_cvt_pk_bf16_f32 v84, v84, v84
    v_cvt_pk_bf16_f32 v85, v85, v85
    v_cvt_pk_bf16_f32 v86, v86, v86
    v_cvt_pk_bf16_f32 v87, v87, v87
    v_lshlrev_b32 v80, 16, v80
    v_lshlrev_b32 v81, 16, v81
    v_lshlrev_b32 v82, 16, v82
    v_lshlrev_b32 v83, 16, v83
    v_lshlrev_b32 v84, 16, v84
    v_lshlrev_b32 v85, 16, v85
    v_lshlrev_b32 v86, 16, v86
    v_lshlrev_b32 v87, 16, v87
    v_mul_f32 v80, v80, v6
    v_mul_f32 v81, v81, v6
    v_mul_f32 v82, v82, v6
    v_mul_f32 v83, v83, v6
    v_mul_f32 v84, v84, v6
    v_mul_f32 v85, v85, v6
    v_mul_f32 v86, v86, v6
    v_mul_f32 v87, v87, v6
    v_cvt_pk_bf16_f32 v80, v80, v80
    v_cvt_pk_bf16_f32 v81, v81, v81
    v_cvt_pk_bf16_f32 v82, v82, v82
    v_cvt_pk_bf16_f32 v83, v83, v83
    v_cvt_pk_bf16_f32 v84, v84, v84
L_hk3:
    s_cbranch_execz L_hr3
    v_cvt_pk_bf16_f32 v85, v85, v85
    v_cvt_pk_bf16_f32 v86, v86, v86
    v_cvt_pk_bf16_f32 v87, v87, v87
    v_lshrrev_b32 v5, 5, v1
    v_and_b32 v6, 7, v1
    v_lshlrev_b32 v6, 1, v6
    v_lshl_add_u32 v6, v5, 4, v6
    v_bfe_u32 v5, v1, 4, 1
    v_add_u32 v6, v6, v5
    v_lshlrev_b32 v108, 4, v6
    s_lshr_b32 s3, s2, 4
    s_lshl_b32 s3, s3, 2
    s_add_u32 s3, s3, s38
    s_lshl_b32 s3, s3, 4
    s_and_b32 s65, s2, 15
    s_add_u32 s3, s3, s65
    s_lshl_b32 s3, s3, 10
    s_add_u32 s78, s3, 6291456
    s_mov_b32 s66, 0x00ff00ff
    s_mov_b32 s67, 0x00ff00ff
    v_mov_b32 v93, v18
    v_mov_b32 v95, v18
    v_mov_b32 v97, v18
    v_mov_b32 v99, v18
    v_lshrrev_b32 v5, 3, v1
    v_lshlrev_b32 v5, 11, v5
    v_lshrrev_b32 v6, 4, v1
    v_lshlrev_b32 v6, 1, v6
    v_and_b32 v7, 7, v1
    v_xor_b32 v6, v6, v7
    v_lshl_add_u32 v5, v6, 4, v5
    s_lshl_b32 s3, s31, 7
    s_lshl_b32 s65, s38, 15
    s_add_u32 s3, s3, s65
    v_add_u32 v110, s3, v5
    v_add_u32 v111, 15360, v110
    v_and_b32 v68, v80, v88
    v_and_b32 v69, v80, v89
    v_and_b32 v70, v80, v90
    v_and_b32 v71, v80, v91
    s_nop 1
    v_mfma_f32_16x16x32_bf16 v[100:103], v[68:71], v[128:131], 0
    v_mfma_f32_16x16x32_bf16 v[104:107], v[68:71], v[160:163], 0
    v_and_b32 v72, v81, v88
    v_and_b32 v73, v81, v89
    v_and_b32 v74, v81, v90
    v_and_b32 v75, v81, v91
    s_nop 1
    v_mfma_f32_16x16x32_bf16 v[100:103], v[72:75], v[132:135], v[100:103]
    v_mfma_f32_16x16x32_bf16 v[104:107], v[72:75], v[164:167], v[104:107]
    s_waitcnt vmcnt(18)
    v_and_b32 v68, v82, v88
    v_and_b32 v69, v82, v89
    v_and_b32 v70, v82, v90
    v_and_b32 v71, v82, v91
    s_nop 1
    v_mfma_f32_16x16x32_bf16 v[100:103], v[68:71], v[136:139], v[100:103]
    v_mfma_f32_16x16x32_bf16 v[104:107], v[68:71], v[168:171], v[104:107]
    s_waitcnt vmcnt(16)
    v_and_b32 v72, v83, v88
    v_and_b32 v73, v83, v89
    v_and_b32 v74, v83, v90
    v_and_b32 v75, v83, v91
    s_nop 1
    v_mfma_f32_16x16x32_bf16 v[100:103], v[72:75], v[140:143], v[100:103]
    v_mfma_f32_16x16x32_bf16 v[104:107], v[72:75], v[172:175], v[104:107]
    s_waitcnt vmcnt(14)
L_hk4:
    s_cbranch_execz L_hr4
    v_and_b32 v68, v84, v88
    v_and_b32 v69, v84, v89
    v_and_b32 v70, v84, v90
    v_and_b32 v71, v84, v91
    s_nop 1
    v_mfma_f32_16x16x32_bf16 v[100:103], v[68:71], v[144:147], v[100:103]
    v_mfma_f32_16x16x32_bf16 v[104:107], v[68:71], v[176:179], v[104:107]
    s_waitcnt vmcnt(12)
    v_and_b32 v72, v85, v88
    v_and_b32 v73, v85, v89
    v_and_b32 v74, v85, v90
    v_and_b32 v75, v85, v91
    s_nop 1
    v_mfma_f32_16x16x32_bf16 v[100:103], v[72:75], v[148:151], v[100:103]
    v_mfma_f32_16x16x32_bf16 v[104:107], v[72:75], v[180:183], v[104:107]
    s_waitcnt vmcnt(10)
    v_and_b32 v68, v86, v88
    v_and_b32 v69, v86, v89
    v_and_b32 v70, v86, v90
    v_and_b32 v71, v86, v91
    s_nop 1
    v_mfma_f32_16x16x32_bf16 v[100:103], v[68:71], v[152:155], v[100:103]
    v_mfma_f32_16x16x32_bf16 v[104:107], v[68:71], v[184:187], v[104:107]
    s_waitcnt vmcnt(8)
    v_and_b32 v72, v87, v88
    v_and_b32 v73, v87, v89
    v_and_b32 v74, v87, v90
    v_and_b32 v75, v87, v91
    s_nop 1
    v_mfma_f32_16x16x32_bf16 v[100:103], v[72:75], v[156:159], v[100:103]
    v_mfma_f32_16x16x32_bf16 v[104:107], v[72:75], v[188:191], v[104:107]
    s_nop 7
    v_permlane32_swap_b32 v100, v104
    v_permlane32_swap_b32 v101, v105
    v_permlane32_swap_b32 v102, v106
    v_permlane32_swap_b32 v103, v107
    v_add_f32 v92, v104, v100 row_ror:8 row_mask:0xf bank_mask:0xf
    v_add_f32 v94, v105, v101 row_ror:8 row_mask:0xf bank_mask:0xf
    v_add_f32 v96, v106, v102 row_ror:8 row_mask:0xf bank_mask:0xf
    v_add_f32 v98, v107, v103 row_ror:8 row_mask:0xf bank_mask:0xf
    s_mov_b64 exec, s[66:67]
    buffer_store_dwordx4 v[92:95], v108, s[12:15], s78 offen offset:0 sc1
    buffer_store_dwordx4 v[96:99], v108, s[12:15], s78 offen offset:512 sc1
    s_mov_b64 exec, -1
    s_cmp_ge_u32 s38, 2
    s_cbranch_scc1 L_xw2
L_pe17:
    ds_read_b128 v[224:227], v26 offset:48
    s_waitcnt lgkmcnt(0)
    v_min_u32 v224, v224, v225
    v_min3_u32 v224, v224, v226, v227
    s_nop 0
    v_readfirstlane_b32 s3, v224
    s_nop 0
    s_cmp_ge_u32 s3, 17
    s_cbranch_scc1 L_pd17
    s_sleep 3
    s_branch L_pe17
L_pd17:
    s_waitcnt vmcnt(8)
    s_add_u32 m0, s73, 0
    s_mov_b32 s3, 0
    buffer_load_dwordx4 v110, s[16:19], s3 offen offset:0  lds
    buffer_load_dwordx4 v111, s[16:19], s3 offen offset:1024  lds
    s_add_u32 m0, s73, 4096
    s_add_u32 s3, s3, 65536
    buffer_load_dwordx4 v110, s[16:19], s3 offen offset:0  lds
    buffer_load_dwordx4 v111, s[16:19], s3 offen offset:1024  lds
    s_waitcnt vmcnt(8)
    s_add_u32 m0, s73, 8192
    s_mov_b32 s3, 131072
    buffer_load_dwordx4 v110, s[16:19], s3 offen offset:0  lds
    buffer_load_dwordx4 v111, s[16:19], s3 offen offset:1024  lds
    s_add_u32 m0, s73, 12288
    s_add_u32 s3, s3, 65536
    buffer_load_dwordx4 v110, s[16:19], s3 offen offset:0  lds
    buffer_load_dwordx4 v111, s[16:19], s3 offen offset:1024  lds
    s_waitcnt vmcnt(8)
    s_add_u32 m0, s73, 65536
    s_mov_b32 s3, 1048576
    buffer_load_dwordx4 v110, s[16:19], s3 offen offset:0  lds
    buffer_load_dwordx4 v111, s[16:19], s3 offen offset:1024  lds
    s_add_u32 m0, s73, 69632
    s_add_u32 s3, s3, 65536
    buffer_load_dwordx4 v110, s[16:19], s3 offen offset:0  lds
    buffer_load_dwordx4 v111, s[16:19], s3 offen offset:1024  lds
    s_waitcnt vmcnt(8)
    s_add_u32 m0, s73, 73728
    s_mov_b32 s3, 1179648
    buffer_load_dwordx4 v110, s[16:19], s3 offen offset:0  lds
    buffer_load_dwordx4 v111, s[16:19], s3 offen offset:1024  lds
    s_add_u32 m0, s73, 77824
    s_add_u32 s3, s3, 65536
    buffer_load_dwordx4 v110, s[16:19], s3 offen offset:0  lds
    buffer_load_dwordx4 v111, s[16:19], s3 offen offset:1024  lds
    s_waitcnt vmcnt(8)
    s_add_u32 m0, s73, 90112
    s_mov_b32 s3, 1441792
    buffer_load_dwordx4 v110, s[16:19], s3 offen offset:0  lds
    buffer_load_dwordx4 v111, s[16:19], s3 offen offset:1024  lds
    s_add_u32 m0, s73, 94208
    s_add_u32 s3, s3, 65536
    buffer_load_dwordx4 v110, s[16:19], s3 offen offset:0  lds
    buffer_load_dwordx4 v111, s[16:19], s3 offen offset:1024  lds
    s_waitcnt vmcnt(8)
    s_add_u32 m0, s73, 98304
    s_mov_b32 s3, 1572864
    buffer_load_dwordx4 v110, s[16:19], s3 offen offset:0  lds
    buffer_load_dwordx4 v111, s[16:19], s3 offen offset:1024  lds
    s_add_u32 m0, s73, 102400
    s_add_u32 s3, s3, 65536
    buffer_load_dwordx4 v110, s[16:19], s3 offen offset:0  lds
    buffer_load_dwordx4 v111, s[16:19], s3 offen offset:1024  lds
    s_waitcnt vmcnt(8)
    s_add_u32 m0, s73, 106496
    s_mov_b32 s3, 1703936
    buffer_load_dwordx4 v110, s[16:19], s3 offen offset:0  lds
    buffer_load_dwordx4 v111, s[16:19], s3 offen offset:1024  lds
    s_add_u32 m0, s73, 110592
    s_add_u32 s3, s3, 65536
    buffer_load_dwordx4 v110, s[16:19], s3 offen offset:0  lds
    buffer_load_dwordx4 v111, s[16:19], s3 offen offset:1024  lds
    s_waitcnt vmcnt(8)
    s_add_u32 m0, s73, 114688
    s_mov_b32 s3, 1835008
    buffer_load_dwordx4 v110, s[16:19], s3 offen offset:0  lds
    buffer_load_dwordx4 v111, s[16:19], s3 offen offset:1024  lds
    s_add_u32 m0, s73, 118784
    s_add_u32 s3, s3, 65536
    buffer_load_dwordx4 v110, s[16:19], s3 offen offset:0  lds
    buffer_load_dwordx4 v111, s[16:19], s3 offen offset:1024  lds
    s_waitcnt vmcnt(8)
    s_add_u32 m0, s73, 122880
    s_mov_b32 s3, 1966080
    buffer_load_dwordx4 v110, s[16:19], s3 offen offset:0  lds
    buffer_load_dwordx4 v111, s[16:19], s3 offen offset:1024  lds
    s_add_u32 m0, s73, 126976
    s_add_u32 s3, s3, 65536
    buffer_load_dwordx4 v110, s[16:19], s3 offen offset:0  lds
    buffer_load_dwordx4 v111, s[16:19], s3 offen offset:1024  lds
L_pe18:
    ds_read_b128 v[224:227], v26 offset:48
    s_waitcnt lgkmcnt(0)
L_hk5:
    s_cbranch_execz L_hr5
    v_min_u32 v224, v224, v225
    v_min3_u32 v224, v224, v226, v227
    s_nop 0
    v_readfirstlane_b32 s3, v224
    s_nop 0
    s_cmp_ge_u32 s3, 18
    s_cbranch_scc1 L_pd18
    s_sleep 3
    s_branch L_pe18
L_pd18:
    s_waitcnt vmcnt(8)
    s_add_u32 m0, s73, 16384
    s_mov_b32 s3, 262144
    buffer_load_dwordx4 v110, s[16:19], s3 offen offset:0  lds
    buffer_load_dwordx4 v111, s[16:19], s3 offen offset:1024  lds
    s_add_u32 m0, s73, 20480
    s_add_u32 s3, s3, 65536
    buffer_load_dwordx4 v110, s[16:19], s3 offen offset:0  lds
    buffer_load_dwordx4 v111, s[16:19], s3 offen offset:1024  lds
    s_waitcnt vmcnt(8)
    s_add_u32 m0, s73, 24576
    s_mov_b32 s3, 393216
    buffer_load_dwordx4 v110, s[16:19], s3 offen offset:0  lds
    buffer_load_dwordx4 v111, s[16:19], s3 offen offset:1024  lds
    s_add_u32 m0, s73, 28672
    s_add_u32 s3, s3, 65536
    buffer_load_dwordx4 v110, s[16:19], s3 offen offset:0  lds
    buffer_load_dwordx4 v111, s[16:19], s3 offen offset:1024  lds
L_pe19:
    ds_read_b128 v[224:227], v26 offset:48
    s_waitcnt lgkmcnt(0)
    v_min_u32 v224, v224, v225
    v_min3_u32 v224, v224, v226, v227
    s_nop 0
    v_readfirstlane_b32 s3, v224
    s_nop 0
    s_cmp_ge_u32 s3, 19
    s_cbranch_scc1 L_pd19
    s_sleep 3
    s_branch L_pe19
L_pd19:
    s_waitcnt vmcnt(8)
    s_add_u32 m0, s73, 32768
    s_mov_b32 s3, 524288
    buffer_load_dwordx4 v110, s[16:19], s3 offen offset:0  lds
    buffer_load_dwordx4 v111, s[16:19], s3 offen offset:1024  lds
    s_add_u32 m0, s73, 36864
    s_add_u32 s3, s3, 65536
    buffer_load_dwordx4 v110, s[16:19], s3 offen offset:0  lds
    buffer_load_dwordx4 v111, s[16:19], s3 offen offset:1024  lds
    s_waitcnt vmcnt(8)
    s_add_u32 m0, s73, 40960
    s_mov_b32 s3, 655360
    buffer_load_dwordx4 v110, s[16:19], s3 offen offset:0  lds
    buffer_load_dwordx4 v111, s[16:19], s3 offen offset:1024  lds
    s_add_u32 m0, s73, 45056
    s_add_u32 s3, s3, 65536
    buffer_load_dwordx4 v110, s[16:19], s3 offen offset:0  lds
    buffer_load_dwordx4 v111, s[16:19], s3 offen offset:1024  lds
L_pe20:
    ds_read_b128 v[224:227], v26 offset:48
    s_waitcnt lgkmcnt(0)
    v_min_u32 v224, v224, v225
    v_min3_u32 v224, v224, v226, v227
    s_nop 0
    v_readfirstlane_b32 s3, v224
    s_nop 0
    s_cmp_ge_u32 s3, 20
    s_cbranch_scc1 L_pd20
    s_sleep 3
    s_branch L_pe20
L_pd20:
    s_waitcnt vmcnt(8)
    s_add_u32 m0, s73, 49152
    s_mov_b32 s3, 786432
    buffer_load_dwordx4 v110, s[16:19], s3 offen offset:0  lds
    buffer_load_dwordx4 v111, s[16:19], s3 offen offset:1024  lds
    s_add_u32 m0, s73, 53248
    s_add_u32 s3, s3, 65536
    buffer_load_dwordx4 v110, s[16:19], s3 offen offset:0  lds
    buffer_load_dwordx4 v111, s[16:19], s3 offen offset:1024  lds
    s_waitcnt vmcnt(8)
    s_add_u32 m0, s73, 57344
    s_mov_b32 s3, 917504
    buffer_load_dwordx4 v110, s[16:19], s3 offen offset:0  lds
    buffer_load_dwordx4 v111, s[16:19], s3 offen offset:1024  lds
    s_add_u32 m0, s73, 61440
    s_add_u32 s3, s3, 65536
    buffer_load_dwordx4 v110, s[16:19], s3 offen offset:0  lds
    buffer_load_dwordx4 v111, s[16:19], s3 offen offset:1024  lds
    s_waitcnt vmcnt(8)
    s_add_u32 m0, s73, 81920
    s_mov_b32 s3, 1310720
    buffer_load_dwordx4 v110, s[16:19], s3 offen offset:0  lds
    buffer_load_dwordx4 v111, s[16:19], s3 offen offset:1024  lds
    s_add_u32 m0, s73, 86016
    s_add_u32 s3, s3, 65536
    buffer_load_dwordx4 v110, s[16:19], s3 offen offset:0  lds
    buffer_load_dwordx4 v111, s[16:19], s3 offen offset:1024  lds
    s_branch L_join2
L_xw2:
L_es:
    ds_read_b128 v[224:227], v26 offset:80
    s_waitcnt lgkmcnt(0)
L_hk6:
    s_cbranch_execz L_hr6
    v_min_u32 v224, v224, v225
    v_min3_u32 v224, v224, v226, v227
    s_nop 0
    v_readfirstlane_b32 s3, v224
    s_nop 0
    s_cmp_ge_u32 s3, 3
    s_cbranch_scc1 L_esd
    s_sleep 2
    s_branch L_es
L_esd:
    s_setprio 3
    buffer_load_dwordx4 v[36:39], v28, s[12:15], s89 offen offset:0 sc1 nt
    buffer_load_dwordx4 v[40:43], v28, s[12:15], s89 offen offset:256 sc1 nt
    buffer_load_dwordx4 v[44:47], v28, s[12:15], s90 offen offset:0 sc1 nt
    buffer_load_dwordx4 v[48:51], v28, s[12:15], s90 offen offset:256 sc1 nt
    buffer_load_dwordx4 v[52:55], v28, s[12:15], s91 offen offset:0 sc1 nt
    buffer_load_dwordx4 v[56:59], v28, s[12:15], s91 offen offset:256 sc1 nt
    buffer_load_dwordx4 v[60:63], v28, s[12:15], s92 offen offset:0 sc1 nt
    buffer_load_dwordx4 v[64:67], v28, s[12:15], s92 offen offset:256 sc1 nt
    s_waitcnt vmcnt(0)
L_ha:
    v_mfma_f32_16x16x32_bf16 v[120:123], v[112:115], v[36:39], 0
    v_mfma_f32_16x16x32_bf16 v[120:123], v[116:119], v[40:43], v[120:123]
    v_mfma_f32_16x16x32_bf16 v[120:123], v[112:115], v[44:47], v[120:123]
    v_mfma_f32_16x16x32_bf16 v[120:123], v[116:119], v[48:51], v[120:123]
    v_mfma_f32_16x16x32_bf16 v[120:123], v[112:115], v[52:55], v[120:123]
    v_mfma_f32_16x16x32_bf16 v[120:123], v[116:119], v[56:59], v[120:123]
    v_mfma_f32_16x16x32_bf16 v[120:123], v[112:115], v[60:63], v[120:123]
    v_mfma_f32_16x16x32_bf16 v[120:123], v[116:119], v[64:67], v[120:123]
    v_and_b32 v6, v39, v43
    v_or_b32 v7, v39, v43
    v_min3_u32 v6, v6, v47, v51
    v_max3_u32 v7, v7, v47, v51
    v_min3_u32 v6, v6, v55, v59
    v_max3_u32 v7, v7, v55, v59
    v_min3_u32 v6, v6, v63, v67
    v_max3_u32 v7, v7, v63, v67
    v_xor_b32 v6, v6, v18
    v_xor_b32 v7, v7, v18
    v_or_b32 v6, v6, v7
    v_cmp_ne_u32 vcc, 0, v6
    s_nop 0
    s_cmp_eq_u64 vcc, 0
    s_cbranch_scc1 L_haok
    s_add_u32 s70, s70, 1
    s_cmp_ge_u32 s70, 200000
    s_cbranch_scc1 L_haok
    s_sleep 2
    buffer_load_dwordx4 v[36:39], v28, s[12:15], s89 offen offset:0 sc1 nt
    buffer_load_dwordx4 v[40:43], v28, s[12:15], s89 offen offset:256 sc1 nt
    buffer_load_dwordx4 v[44:47], v28, s[12:15], s90 offen offset:0 sc1 nt
    buffer_load_dwordx4 v[48:51], v28, s[12:15], s90 offen offset:256 sc1 nt
    buffer_load_dwordx4 v[52:55], v28, s[12:15], s91 offen offset:0 sc1 nt
    buffer_load_dwordx4 v[56:59], v28, s[12:15], s91 offen offset:256 sc1 nt
    buffer_load_dwordx4 v[60:63], v28, s[12:15], s92 offen offset:0 sc1 nt
    buffer_load_dwordx4 v[64:67], v28, s[12:15], s92 offen offset:256 sc1 nt
    s_waitcnt vmcnt(0)
    s_branch L_ha
L_haok:
    v_cvt_pk_bf16_f32 v6, v120, v121
    v_cvt_pk_bf16_f32 v124, v120, v121
    v_cvt_pk_bf16_f32 v125, v122, v123
    v_permlane16_swap_b32 v6, v126
    s_mov_b64 exec, s[94:95]
    s_cmp_lg_u32 s88, 0
    s_cbranch_scc1 L_hrm
    buffer_store_dwordx4 v[124:127], v29, s[12:15], s68 offen
    s_branch L_hs
L_hrm:
    buffer_store_dwordx4 v[124:127], v29, s[12:15], s68 offen sc1
L_hs:
    s_mov_b64 exec, -1
    buffer_load_dwordx4 v[36:39], v3, s[12:15], s69 offen offset:0 sc1 nt
    buffer_load_dwordx4 v[40:43], v3, s[12:15], s69 offen offset:1024 sc1 nt
    buffer_load_dwordx4 v[44:47], v3, s[12:15], s69 offen offset:2048 sc1 nt
    buffer_load_dwordx4 v[48:51], v3, s[12:15], s69 offen offset:3072 sc1 nt
    buffer_load_dwordx4 v[52:55], v3, s[12:15], s71 offen offset:0 sc1 nt
    buffer_load_dwordx4 v[56:59], v3, s[12:15], s71 offen offset:1024 sc1 nt
    buffer_load_dwordx4 v[60:63], v3, s[12:15], s71 offen offset:2048 sc1 nt
    buffer_load_dwordx4 v[64:67], v3, s[12:15], s71 offen offset:3072 sc1 nt
L_pe119:
    ds_read_b128 v[224:227], v26 offset:48
    s_waitcnt lgkmcnt(0)
L_hk7:
    s_cbranch_execz L_hr7
    v_min_u32 v224, v224, v225
    v_min3_u32 v224, v224, v226, v227
    s_nop 0
    v_readfirstlane_b32 s3, v224
    s_nop 0
    s_cmp_ge_u32 s3, 19
    s_cbranch_scc1 L_pd119
    s_sleep 3
    s_branch L_pe119
L_pd119:
    s_waitcnt vmcnt(0)
L_hb:
    v_and_b32 v6, v39, v43
    v_or_b32 v7, v39, v43
    v_min3_u32 v6, v6, v47, v51
    v_max3_u32 v7, v7, v47, v51
    v_min3_u32 v6, v6, v55, v59
    v_max3_u32 v7, v7, v55, v59
    v_min3_u32 v6, v6, v63, v67
    v_max3_u32 v7, v7, v63, v67
    v_xor_b32 v6, v6, v18
    v_xor_b32 v7, v7, v18
    v_or_b32 v6, v6, v7
    v_cmp_ne_u32 vcc, 0, v6
    s_nop 0
    s_cmp_eq_u64 vcc, 0
    s_cbranch_scc1 L_hbok
    s_add_u32 s70, s70, 1
    s_cmp_ge_u32 s70, 200000
    s_cbranch_scc1 L_hbok
    s_sleep 2
    buffer_load_dwordx4 v[36:39], v3, s[12:15], s69 offen offset:0 sc1 nt
    buffer_load_dwordx4 v[40:43], v3, s[12:15], s69 offen offset:1024 sc1 nt
    buffer_load_dwordx4 v[44:47], v3, s[12:15], s69 offen offset:2048 sc1 nt
    buffer_load_dwordx4 v[48:51], v3, s[12:15], s69 offen offset:3072 sc1 nt
    buffer_load_dwordx4 v[52:55], v3, s[12:15], s71 offen offset:0 sc1 nt
    buffer_load_dwordx4 v[56:59], v3, s[12:15], s71 offen offset:1024 sc1 nt
    buffer_load_dwordx4 v[60:63], v3, s[12:15], s71 offen offset:2048 sc1 nt
    buffer_load_dwordx4 v[64:67], v3, s[12:15], s71 offen offset:3072 sc1 nt
    s_waitcnt vmcnt(0)
    s_branch L_hb
L_hbok:
    ds_write_b64 v30, v[36:37] offset:0
    ds_write_b64 v30, v[40:41] offset:8
    ds_write_b64 v30, v[44:45] offset:1024
    ds_write_b64 v30, v[48:49] offset:1032
    ds_write_b64 v30, v[52:53] offset:2048
    ds_write_b64 v30, v[56:57] offset:2056
    ds_write_b64 v30, v[60:61] offset:3072
    ds_write_b64 v30, v[64:65] offset:3080
    ds_write_b32 v31, v38 offset:0
    ds_write_b32 v31, v42 offset:32
    ds_write_b32 v31, v46 offset:4
    ds_write_b32 v31, v50 offset:36
    ds_write_b32 v31, v54 offset:64
    ds_write_b32 v31, v58 offset:96
    ds_write_b32 v31, v62 offset:68
    ds_write_b32 v31, v66 offset:100
    s_lshl_b32 s3, s38, 2
    s_add_u32 s3, s3, 163096
    v_mov_b32 v5, s3
    v_mov_b32 v6, 1
    ds_write_b32 v5, v6
    s_setprio 0
L_join2:
    v_lshrrev_b32 v5, 2, v1
    v_lshlrev_b32 v5, 10, v5
    v_and_b32 v6, 3, v1
    v_lshl_add_u32 v5, v6, 4, v5
    s_lshr_b32 s3, s2, 2
    s_lshl_b32 s3, s3, 14
    s_and_b32 s65, s2, 3
    s_lshl_b32 s65, s65, 6
    s_add_u32 s3, s3, s65
    s_add_u32 s3, s3, 6291456
    buffer_load_dwordx4 v[52:55], v5, s[12:15], s3 offen offset:0 sc1
    buffer_load_dwordx4 v[56:59], v5, s[12:15], s3 offen offset:512 sc1
    buffer_load_dwordx4 v[60:63], v5, s[12:15], s3 offen offset:256 sc1
    buffer_load_dwordx4 v[64:67], v5, s[12:15], s3 offen offset:768 sc1
    s_waitcnt vmcnt(4)
    s_lshl_b32 s3, s38, 2
    s_add_u32 s3, s3, 163216
    v_mov_b32 v5, s3
    v_mov_b32 v6, 1
    ds_write_b32 v5, v6
    s_waitcnt vmcnt(0)
L_gu:
    v_xor_b32 v6, v53, v18
    v_xor_b32 v7, v55, v18
    v_or_b32 v6, v6, v7
    v_xor_b32 v7, v57, v18
    v_or_b32 v6, v6, v7
    v_xor_b32 v7, v59, v18
    v_or_b32 v6, v6, v7
    v_xor_b32 v7, v61, v18
    v_or_b32 v6, v6, v7
    v_xor_b32 v7, v63, v18
    v_or_b32 v6, v6, v7
    v_xor_b32 v7, v65, v18
    v_or_b32 v6, v6, v7
    v_xor_b32 v7, v67, v18
    v_or_b32 v6, v6, v7
    v_cmp_ne_u32 vcc, 0, v6
    s_nop 0
    s_cmp_eq_u64 vcc, 0
    s_cbranch_scc1 L_guok
    s_add_u32 s70, s70, 1
    s_cmp_ge_u32 s70, 200000
    s_cbranch_scc1 L_guok
    s_sleep 8
    v_lshrrev_b32 v5, 2, v1
    v_lshlrev_b32 v5, 10, v5
    v_and_b32 v6, 3, v1
    v_lshl_add_u32 v5, v6, 4, v5
    s_lshr_b32 s3, s2, 2
    s_lshl_b32 s3, s3, 14
    s_and_b32 s65, s2, 3
    s_lshl_b32 s65, s65, 6
    s_add_u32 s3, s3, s65
    s_add_u32 s3, s3, 6291456
    buffer_load_dwordx4 v[52:55], v5, s[12:15], s3 offen offset:0 sc1
    buffer_load_dwordx4 v[56:59], v5, s[12:15], s3 offen offset:512 sc1
    buffer_load_dwordx4 v[60:63], v5, s[12:15], s3 offen offset:256 sc1
    buffer_load_dwordx4 v[64:67], v5, s[12:15], s3 offen offset:768 sc1
    s_waitcnt vmcnt(0)
    s_branch L_gu
L_guok:
    v_permlane32_swap_b32 v52, v56
    v_permlane32_swap_b32 v54, v58
    v_permlane32_swap_b32 v60, v64
    v_permlane32_swap_b32 v62, v66
    v_add_f32 v52, v52, v56
    v_add_f32 v54, v54, v58
    v_add_f32 v60, v60, v64
    v_add_f32 v62, v62, v66
    v_permlane16_swap_b32 v52, v54
    s_nop 0
    v_permlane16_swap_b32 v60, v62
    v_add_f32 v52, v52, v54
    v_add_f32 v60, v60, v62
    s_nop 0
    v_add_f32 v52, v52, v52 row_ror:4 row_mask:0xf bank_mask:0xf
    v_add_f32 v60, v60, v60 row_ror:4 row_mask:0xf bank_mask:0xf
    s_nop 0
    v_add_f32 v52, v52, v52 row_ror:8 row_mask:0xf bank_mask:0xf
    v_add_f32 v60, v60, v60 row_ror:8 row_mask:0xf bank_mask:0xf
    v_cvt_pk_bf16_f32 v52, v52, v52
    v_lshlrev_b32 v52, 16, v52
    v_cvt_pk_bf16_f32 v60, v60, v60
    v_lshlrev_b32 v60, 16, v60
    v_mul_f32 v53, 0xbfb8aa3b, v52
    v_exp_f32 v53, v53
    s_nop 0
    v_add_f32 v53, 1.0, v53
    v_rcp_f32 v53, v53
    s_nop 0
    v_mul_f32 v52, v52, v53
    v_cvt_pk_bf16_f32 v52, v52, v52
    v_lshlrev_b32 v52, 16, v52
    v_mul_f32 v52, v52, v60
    v_cvt_pk_bf16_f32 v52, v52, v52
    s_nop 1
    v_mov_b32 v80, v52 quad_perm:[0,0,0,0] row_mask:0xf bank_mask:0xf
    v_mov_b32 v81, v52 quad_perm:[1,1,1,1] row_mask:0xf bank_mask:0xf
    v_mov_b32 v82, v52 quad_perm:[2,2,2,2] row_mask:0xf bank_mask:0xf
    v_mov_b32 v83, v52 quad_perm:[3,3,3,3] row_mask:0xf bank_mask:0xf
    s_waitcnt lgkmcnt(0)
    v_and_b32 v92, v80, v88
    v_and_b32 v93, v80, v89
    v_and_b32 v94, v80, v90
    v_and_b32 v95, v80, v91
    s_nop 1
    v_mfma_f32_16x16x32_bf16 v[100:103], v[92:95], v[192:195], 0
    v_mfma_f32_16x16x32_bf16 v[104:107], v[92:95], v[196:199], 0
    v_and_b32 v96, v81, v88
    v_and_b32 v97, v81, v89
    v_and_b32 v98, v81, v90
    v_and_b32 v99, v81, v91
    s_nop 1
    v_mfma_f32_16x16x32_bf16 v[100:103], v[96:99], v[200:203], v[100:103]
    v_mfma_f32_16x16x32_bf16 v[104:107], v[96:99], v[204:207], v[104:107]
    v_and_b32 v92, v82, v88
    v_and_b32 v93, v82, v89
    v_and_b32 v94, v82, v90
    v_and_b32 v95, v82, v91
    s_nop 1
    v_mfma_f32_16x16x32_bf16 v[100:103], v[92:95], v[208:211], v[100:103]
    v_mfma_f32_16x16x32_bf16 v[104:107], v[92:95], v[212:215], v[104:107]
    v_and_b32 v96, v83, v88
    v_and_b32 v97, v83, v89
    v_and_b32 v98, v83, v90
    v_and_b32 v99, v83, v91
    s_nop 1
    v_mfma_f32_16x16x32_bf16 v[100:103], v[96:99], v[216:219], v[100:103]
    v_mfma_f32_16x16x32_bf16 v[104:107], v[96:99], v[220:223], v[104:107]
    v_and_b32 v5, 15, v1
    v_lshlrev_b32 v5, 5, v5
    v_bfe_u32 v6, v1, 4, 1
    v_lshl_add_u32 v5, v6, 4, v5
    v_lshrrev_b32 v6, 5, v1
    v_lshl_add_u32 v5, v6, 9, v5
    v_cmp_eq_u32 vcc, 0, v6
    s_lshl_b32 s3, s2, 12
    s_lshl_b32 s65, s38, 10
    s_add_u32 s3, s3, s65
    s_add_u32 s3, s3, 8388608
    v_cndmask_b32 v100, v104, v100, vcc
    v_cndmask_b32 v101, v105, v101, vcc
    v_cndmask_b32 v102, v106, v102, vcc
    v_cndmask_b32 v103, v107, v103, vcc
    v_mov_b32 v28, v18
    v_lshrrev_b32 v29, 8, v18
    v_lshrrev_b32 v30, 16, v18
    v_lshrrev_b32 v31, 24, v18
    v_mov_b32 v6, 0xff
    v_bfi_b32 v100, v6, v28, v100
    v_bfi_b32 v101, v6, v29, v101
    v_bfi_b32 v102, v6, v30, v102
    v_bfi_b32 v103, v6, v31, v103
    s_cmp_ge_u32 s2, 224
    s_cbranch_scc1 L_noy
    buffer_store_dwordx4 v[100:103], v5, s[12:15], s3 offen sc1
L_noy:
    s_lshl_b32 s3, s38, 7
    s_add_u32 s3, s3, 161280
    v_lshl_add_u32 v6, v249, 2, s3
    ds_read_b32 v112, v6 offset:0
    ds_read_b32 v120, v6 offset:512
    ds_read_b32 v114, v6 offset:32
    ds_read_b32 v122, v6 offset:544
    ds_read_b32 v116, v6 offset:64
    ds_read_b32 v124, v6 offset:576
    ds_read_b32 v118, v6 offset:96
    ds_read_b32 v126, v6 offset:608
    s_mul_i32 s3, s38, 4608
    s_add_u32 s3, s3, 131072
    v_mul_u32_u24 v6, 144, v249
    v_lshl_add_u32 v6, v250, 4, v6
    v_add_u32 v15, s3, v6
    s_mov_b32 s71, 0xbfb8aa3b
    s_waitcnt lgkmcnt(0)
    v_lshlrev_b32 v36, 16, v232
    v_and_b32 v37, 0xffff0000, v232
    v_lshlrev_b32 v38, 16, v233
    v_and_b32 v39, 0xffff0000, v233
    v_lshlrev_b32 v40, 16, v234
    v_and_b32 v41, 0xffff0000, v234
    v_lshlrev_b32 v42, 16, v235
    v_and_b32 v43, 0xffff0000, v235
    v_lshlrev_b32 v44, 16, v236
    v_and_b32 v45, 0xffff0000, v236
    v_lshlrev_b32 v46, 16, v237
    v_and_b32 v47, 0xffff0000, v237
    v_lshlrev_b32 v48, 16, v238
    v_and_b32 v49, 0xffff0000, v238
    v_lshlrev_b32 v50, 16, v239
    v_and_b32 v51, 0xffff0000, v239
    v_lshlrev_b32 v52, 16, v240
    v_and_b32 v53, 0xffff0000, v240
    v_lshlrev_b32 v54, 16, v241
    v_and_b32 v55, 0xffff0000, v241
    v_lshlrev_b32 v56, 16, v242
    v_and_b32 v57, 0xffff0000, v242
    v_lshlrev_b32 v58, 16, v243
    v_and_b32 v59, 0xffff0000, v243
    v_lshlrev_b32 v60, 16, v244
    v_and_b32 v61, 0xffff0000, v244
    v_lshlrev_b32 v62, 16, v245
    v_and_b32 v63, 0xffff0000, v245
    v_lshlrev_b32 v64, 16, v246
    v_and_b32 v65, 0xffff0000, v246
    v_lshlrev_b32 v66, 16, v247
    v_and_b32 v67, 0xffff0000, v247
    v_pk_add_f32 v[68:69], v[36:37], v[112:113] op_sel_hi:[1,0] neg_lo:[0,1] neg_hi:[0,1]
    v_pk_add_f32 v[70:71], v[38:39], v[112:113] op_sel_hi:[1,0] neg_lo:[0,1] neg_hi:[0,1]
    v_pk_add_f32 v[72:73], v[40:41], v[112:113] op_sel_hi:[1,0] neg_lo:[0,1] neg_hi:[0,1]
    v_pk_add_f32 v[74:75], v[42:43], v[112:113] op_sel_hi:[1,0] neg_lo:[0,1] neg_hi:[0,1]
    v_pk_add_f32 v[76:77], v[44:45], v[114:115] op_sel_hi:[1,0] neg_lo:[0,1] neg_hi:[0,1]
    v_pk_add_f32 v[78:79], v[46:47], v[114:115] op_sel_hi:[1,0] neg_lo:[0,1] neg_hi:[0,1]
    v_pk_add_f32 v[80:81], v[48:49], v[114:115] op_sel_hi:[1,0] neg_lo:[0,1] neg_hi:[0,1]
    v_pk_add_f32 v[82:83], v[50:51], v[114:115] op_sel_hi:[1,0] neg_lo:[0,1] neg_hi:[0,1]
    v_pk_add_f32 v[84:85], v[52:53], v[116:117] op_sel_hi:[1,0] neg_lo:[0,1] neg_hi:[0,1]
    v_pk_add_f32 v[86:87], v[54:55], v[116:117] op_sel_hi:[1,0] neg_lo:[0,1] neg_hi:[0,1]
    v_pk_add_f32 v[88:89], v[56:57], v[116:117] op_sel_hi:[1,0] neg_lo:[0,1] neg_hi:[0,1]
    v_pk_add_f32 v[90:91], v[58:59], v[116:117] op_sel_hi:[1,0] neg_lo:[0,1] neg_hi:[0,1]
    v_pk_add_f32 v[92:93], v[60:61], v[118:119] op_sel_hi:[1,0] neg_lo:[0,1] neg_hi:[0,1]
    v_pk_add_f32 v[94:95], v[62:63], v[118:119] op_sel_hi:[1,0] neg_lo:[0,1] neg_hi:[0,1]
    v_pk_add_f32 v[96:97], v[64:65], v[118:119] op_sel_hi:[1,0] neg_lo:[0,1] neg_hi:[0,1]
    v_pk_add_f32 v[98:99], v[66:67], v[118:119] op_sel_hi:[1,0] neg_lo:[0,1] neg_hi:[0,1]
    v_cvt_pk_bf16_f32 v192, v68, v69
    v_cvt_pk_bf16_f32 v193, v70, v71
    v_cvt_pk_bf16_f32 v194, v72, v73
    v_cvt_pk_bf16_f32 v195, v74, v75
    v_cvt_pk_bf16_f32 v196, v76, v77
    v_cvt_pk_bf16_f32 v197, v78, v79
    v_cvt_pk_bf16_f32 v198, v80, v81
    v_cvt_pk_bf16_f32 v199, v82, v83
    v_cvt_pk_bf16_f32 v200, v84, v85
    v_cvt_pk_bf16_f32 v201, v86, v87
    v_cvt_pk_bf16_f32 v202, v88, v89
    v_cvt_pk_bf16_f32 v203, v90, v91
    v_cvt_pk_bf16_f32 v204, v92, v93
    v_cvt_pk_bf16_f32 v205, v94, v95
    v_cvt_pk_bf16_f32 v206, v96, v97
    v_cvt_pk_bf16_f32 v207, v98, v99
    v_lshlrev_b32 v68, 16, v192
    v_and_b32 v69, 0xffff0000, v192
    v_lshlrev_b32 v70, 16, v193
    v_and_b32 v71, 0xffff0000, v193
    v_lshlrev_b32 v72, 16, v194
    v_and_b32 v73, 0xffff0000, v194
    v_lshlrev_b32 v74, 16, v195
    v_and_b32 v75, 0xffff0000, v195
    v_lshlrev_b32 v76, 16, v196
    v_and_b32 v77, 0xffff0000, v196
    v_lshlrev_b32 v78, 16, v197
    v_and_b32 v79, 0xffff0000, v197
    v_lshlrev_b32 v80, 16, v198
    v_and_b32 v81, 0xffff0000, v198
    v_lshlrev_b32 v82, 16, v199
    v_and_b32 v83, 0xffff0000, v199
    v_lshlrev_b32 v84, 16, v200
    v_and_b32 v85, 0xffff0000, v200
    v_lshlrev_b32 v86, 16, v201
    v_and_b32 v87, 0xffff0000, v201
    v_lshlrev_b32 v88, 16, v202
    v_and_b32 v89, 0xffff0000, v202
    v_lshlrev_b32 v90, 16, v203
    v_and_b32 v91, 0xffff0000, v203
    v_lshlrev_b32 v92, 16, v204
    v_and_b32 v93, 0xffff0000, v204
    v_lshlrev_b32 v94, 16, v205
    v_and_b32 v95, 0xffff0000, v205
    v_lshlrev_b32 v96, 16, v206
    v_and_b32 v97, 0xffff0000, v206
    v_lshlrev_b32 v98, 16, v207
    v_and_b32 v99, 0xffff0000, v207
    v_pk_mul_f32 v[68:69], v[68:69], v[120:121] op_sel_hi:[1,0]
    v_pk_mul_f32 v[70:71], v[70:71], v[120:121] op_sel_hi:[1,0]
    v_pk_mul_f32 v[72:73], v[72:73], v[120:121] op_sel_hi:[1,0]
    v_pk_mul_f32 v[74:75], v[74:75], v[120:121] op_sel_hi:[1,0]
    v_pk_mul_f32 v[76:77], v[76:77], v[122:123] op_sel_hi:[1,0]
    v_pk_mul_f32 v[78:79], v[78:79], v[122:123] op_sel_hi:[1,0]
    v_pk_mul_f32 v[80:81], v[80:81], v[122:123] op_sel_hi:[1,0]
    v_pk_mul_f32 v[82:83], v[82:83], v[122:123] op_sel_hi:[1,0]
    v_pk_mul_f32 v[84:85], v[84:85], v[124:125] op_sel_hi:[1,0]
    v_pk_mul_f32 v[86:87], v[86:87], v[124:125] op_sel_hi:[1,0]
    v_pk_mul_f32 v[88:89], v[88:89], v[124:125] op_sel_hi:[1,0]
    v_pk_mul_f32 v[90:91], v[90:91], v[124:125] op_sel_hi:[1,0]
    v_pk_mul_f32 v[92:93], v[92:93], v[126:127] op_sel_hi:[1,0]
    v_pk_mul_f32 v[94:95], v[94:95], v[126:127] op_sel_hi:[1,0]
    v_pk_mul_f32 v[96:97], v[96:97], v[126:127] op_sel_hi:[1,0]
    v_pk_mul_f32 v[98:99], v[98:99], v[126:127] op_sel_hi:[1,0]
    v_cvt_pk_bf16_f32 v192, v68, v69
    v_cvt_pk_bf16_f32 v193, v70, v71
    v_cvt_pk_bf16_f32 v194, v72, v73
    v_cvt_pk_bf16_f32 v195, v74, v75
    v_cvt_pk_bf16_f32 v196, v76, v77
    v_cvt_pk_bf16_f32 v197, v78, v79
    v_cvt_pk_bf16_f32 v198, v80, v81
    v_cvt_pk_bf16_f32 v199, v82, v83
    v_cvt_pk_bf16_f32 v200, v84, v85
    v_cvt_pk_bf16_f32 v201, v86, v87
    v_cvt_pk_bf16_f32 v202, v88, v89
    v_cvt_pk_bf16_f32 v203, v90, v91
    v_cvt_pk_bf16_f32 v204, v92, v93
    v_cvt_pk_bf16_f32 v205, v94, v95
    v_cvt_pk_bf16_f32 v206, v96, v97
    v_cvt_pk_bf16_f32 v207, v98, v99
    v_lshlrev_b32 v68, 16, v192
    v_and_b32 v69, 0xffff0000, v192
    v_lshlrev_b32 v70, 16, v193
    v_and_b32 v71, 0xffff0000, v193
    v_lshlrev_b32 v72, 16, v194
    v_and_b32 v73, 0xffff0000, v194
    v_lshlrev_b32 v74, 16, v195
    v_and_b32 v75, 0xffff0000, v195
    v_lshlrev_b32 v76, 16, v196
    v_and_b32 v77, 0xffff0000, v196
    v_lshlrev_b32 v78, 16, v197
    v_and_b32 v79, 0xffff0000, v197
    v_lshlrev_b32 v80, 16, v198
    v_and_b32 v81, 0xffff0000, v198
    v_lshlrev_b32 v82, 16, v199
    v_and_b32 v83, 0xffff0000, v199
    v_lshlrev_b32 v84, 16, v200
    v_and_b32 v85, 0xffff0000, v200
    v_lshlrev_b32 v86, 16, v201
    v_and_b32 v87, 0xffff0000, v201
    v_lshlrev_b32 v88, 16, v202
    v_and_b32 v89, 0xffff0000, v202
    v_lshlrev_b32 v90, 16, v203
    v_and_b32 v91, 0xffff0000, v203
    v_lshlrev_b32 v92, 16, v204
    v_and_b32 v93, 0xffff0000, v204
    v_lshlrev_b32 v94, 16, v205
    v_and_b32 v95, 0xffff0000, v205
    v_lshlrev_b32 v96, 16, v206
    v_and_b32 v97, 0xffff0000, v206
    v_lshlrev_b32 v98, 16, v207
    v_and_b32 v99, 0xffff0000, v207
    v_mul_f32 v192, s71, v68
    v_mul_f32 v193, s71, v69
    v_mul_f32 v194, s71, v70
    v_mul_f32 v195, s71, v71
    v_mul_f32 v196, s71, v72
    v_mul_f32 v197, s71, v73
    v_mul_f32 v198, s71, v74
    v_mul_f32 v199, s71, v75
    v_mul_f32 v200, s71, v76
    v_mul_f32 v201, s71, v77
    v_mul_f32 v202, s71, v78
    v_mul_f32 v203, s71, v79
    v_mul_f32 v204, s71, v80
    v_mul_f32 v205, s71, v81
    v_mul_f32 v206, s71, v82
    v_mul_f32 v207, s71, v83
    v_mul_f32 v208, s71, v84
    v_mul_f32 v209, s71, v85
    v_mul_f32 v210, s71, v86
    v_mul_f32 v211, s71, v87
    v_mul_f32 v212, s71, v88
    v_mul_f32 v213, s71, v89
    v_mul_f32 v214, s71, v90
    v_mul_f32 v215, s71, v91
    v_mul_f32 v216, s71, v92
    v_mul_f32 v217, s71, v93
    v_mul_f32 v218, s71, v94
    v_mul_f32 v219, s71, v95
    v_mul_f32 v220, s71, v96
    v_mul_f32 v221, s71, v97
    v_mul_f32 v222, s71, v98
    v_mul_f32 v223, s71, v99
    v_exp_f32 v192, v192
    v_exp_f32 v193, v193
    v_exp_f32 v194, v194
    v_exp_f32 v195, v195
    v_exp_f32 v196, v196
    v_exp_f32 v197, v197
    v_exp_f32 v198, v198
    v_exp_f32 v199, v199
    v_exp_f32 v200, v200
    v_exp_f32 v201, v201
    v_exp_f32 v202, v202
    v_exp_f32 v203, v203
    v_exp_f32 v204, v204
    v_exp_f32 v205, v205
    v_exp_f32 v206, v206
    v_exp_f32 v207, v207
    v_exp_f32 v208, v208
    v_exp_f32 v209, v209
    v_exp_f32 v210, v210
    v_exp_f32 v211, v211
    v_exp_f32 v212, v212
    v_exp_f32 v213, v213
    v_exp_f32 v214, v214
    v_exp_f32 v215, v215
    v_exp_f32 v216, v216
    v_exp_f32 v217, v217
    v_exp_f32 v218, v218
    v_exp_f32 v219, v219
    v_exp_f32 v220, v220
    v_exp_f32 v221, v221
    v_exp_f32 v222, v222
    v_exp_f32 v223, v223
    v_add_f32 v192, 1.0, v192
    v_add_f32 v193, 1.0, v193
    v_add_f32 v194, 1.0, v194
    v_add_f32 v195, 1.0, v195
    v_add_f32 v196, 1.0, v196
    v_add_f32 v197, 1.0, v197
    v_add_f32 v198, 1.0, v198
    v_add_f32 v199, 1.0, v199
    v_add_f32 v200, 1.0, v200
    v_add_f32 v201, 1.0, v201
    v_add_f32 v202, 1.0, v202
    v_add_f32 v203, 1.0, v203
    v_add_f32 v204, 1.0, v204
    v_add_f32 v205, 1.0, v205
    v_add_f32 v206, 1.0, v206
    v_add_f32 v207, 1.0, v207
    v_add_f32 v208, 1.0, v208
    v_add_f32 v209, 1.0, v209
    v_add_f32 v210, 1.0, v210
    v_add_f32 v211, 1.0, v211
    v_add_f32 v212, 1.0, v212
    v_add_f32 v213, 1.0, v213
    v_add_f32 v214, 1.0, v214
    v_add_f32 v215, 1.0, v215
    v_add_f32 v216, 1.0, v216
    v_add_f32 v217, 1.0, v217
    v_add_f32 v218, 1.0, v218
    v_add_f32 v219, 1.0, v219
    v_add_f32 v220, 1.0, v220
    v_add_f32 v221, 1.0, v221
    v_add_f32 v222, 1.0, v222
    v_add_f32 v223, 1.0, v223
    v_rcp_f32 v192, v192
    v_rcp_f32 v193, v193
    v_rcp_f32 v194, v194
    v_rcp_f32 v195, v195
    v_rcp_f32 v196, v196
    v_rcp_f32 v197, v197
    v_rcp_f32 v198, v198
    v_rcp_f32 v199, v199
    v_rcp_f32 v200, v200
    v_rcp_f32 v201, v201
    v_rcp_f32 v202, v202
    v_rcp_f32 v203, v203
    v_rcp_f32 v204, v204
    v_rcp_f32 v205, v205
    v_rcp_f32 v206, v206
    v_rcp_f32 v207, v207
    v_rcp_f32 v208, v208
    v_rcp_f32 v209, v209
    v_rcp_f32 v210, v210
    v_rcp_f32 v211, v211
    v_rcp_f32 v212, v212
    v_rcp_f32 v213, v213
    v_rcp_f32 v214, v214
    v_rcp_f32 v215, v215
    v_rcp_f32 v216, v216
    v_rcp_f32 v217, v217
    v_rcp_f32 v218, v218
    v_rcp_f32 v219, v219
    v_rcp_f32 v220, v220
    v_rcp_f32 v221, v221
    v_rcp_f32 v222, v222
    v_rcp_f32 v223, v223
    v_pk_mul_f32 v[68:69], v[68:69], v[192:193]
    v_pk_mul_f32 v[70:71], v[70:71], v[194:195]
    v_pk_mul_f32 v[72:73], v[72:73], v[196:197]
    v_pk_mul_f32 v[74:75], v[74:75], v[198:199]
    v_pk_mul_f32 v[76:77], v[76:77], v[200:201]
    v_pk_mul_f32 v[78:79], v[78:79], v[202:203]
    v_pk_mul_f32 v[80:81], v[80:81], v[204:205]
    v_pk_mul_f32 v[82:83], v[82:83], v[206:207]
    v_pk_mul_f32 v[84:85], v[84:85], v[208:209]
    v_pk_mul_f32 v[86:87], v[86:87], v[210:211]
    v_pk_mul_f32 v[88:89], v[88:89], v[212:213]
    v_pk_mul_f32 v[90:91], v[90:91], v[214:215]
    v_pk_mul_f32 v[92:93], v[92:93], v[216:217]
    v_pk_mul_f32 v[94:95], v[94:95], v[218:219]
    v_pk_mul_f32 v[96:97], v[96:97], v[220:221]
    v_pk_mul_f32 v[98:99], v[98:99], v[222:223]
    s_cmp_eq_u32 s35, 0
    s_cbranch_scc1 L_fin
    s_lshl_b32 s65, s38, 2
    v_lshrrev_b32 v5, 4, v1
    v_add_u32 v5, s65, v5
    v_lshlrev_b32 v5, 12, v5
    v_and_b32 v6, 15, v1
    v_lshl_add_u32 v11, v6, 4, v5
    v_mov_b32 v5, 163104
L_yg:
    ds_read_b32 v6, v5 offset:96
    s_waitcnt lgkmcnt(0)
    v_readfirstlane_b32 s3, v6
    s_nop 0
    s_cmp_eq_u32 s3, 4
    s_cbranch_scc1 L_ygd
    s_sleep 2
    s_branch L_yg
L_ygd:
    s_sleep 10
    s_lshl_b32 s3, s31, 8
    s_add_u32 s3, s3, 8388608
    buffer_load_dwordx4 v[128:131], v11, s[12:15], s3 offen sc1
    s_add_u32 s3, s3, 65536
    buffer_load_dwordx4 v[132:135], v11, s[12:15], s3 offen sc1
    s_add_u32 s3, s3, 65536
    buffer_load_dwordx4 v[136:139], v11, s[12:15], s3 offen sc1
    s_add_u32 s3, s3, 65536
    buffer_load_dwordx4 v[140:143], v11, s[12:15], s3 offen sc1
    s_add_u32 s3, s3, 65536
    buffer_load_dwordx4 v[144:147], v11, s[12:15], s3 offen sc1
    s_add_u32 s3, s3, 65536
    buffer_load_dwordx4 v[148:151], v11, s[12:15], s3 offen sc1
    s_add_u32 s3, s3, 65536
    buffer_load_dwordx4 v[152:155], v11, s[12:15], s3 offen sc1
    s_add_u32 s3, s3, 65536
    buffer_load_dwordx4 v[156:159], v11, s[12:15], s3 offen sc1
    s_add_u32 s3, s3, 65536
    buffer_load_dwordx4 v[160:163], v11, s[12:15], s3 offen sc1
    s_add_u32 s3, s3, 65536
    buffer_load_dwordx4 v[164:167], v11, s[12:15], s3 offen sc1
    s_add_u32 s3, s3, 65536
    buffer_load_dwordx4 v[168:171], v11, s[12:15], s3 offen sc1
    s_add_u32 s3, s3, 65536
    buffer_load_dwordx4 v[172:175], v11, s[12:15], s3 offen sc1
    s_add_u32 s3, s3, 65536
    buffer_load_dwordx4 v[176:179], v11, s[12:15], s3 offen sc1
    s_add_u32 s3, s3, 65536
    buffer_load_dwordx4 v[180:183], v11, s[12:15], s3 offen sc1
    s_lshl_b32 s68, s34, 11
    s_lshl_b32 s3, s31, 7
    s_add_u32 s68, s68, s3
    v_lshlrev_b32 v7, 1, v1
    buffer_load_ushort v8, v7, s[4:7], s68 offen
    s_and_b32 s3, s33, 0xfffff800
    s_xor_b32 s65, s3, 0x80000000
    s_not_b32 s66, s3
    s_and_b32 s66, s66, 0xfffff800
    s_bitcmp1_b32 s3, 31
    s_cselect_b32 s3, s65, s66
    v_mov_b32 v5, s3
    v_cvt_pk_bf16_f32 v5, v5, v5
    v_lshlrev_b32 v5, 16, v5
    v_mul_f32 v5, 0xbfb8aa3b, v5
    v_exp_f32 v5, v5
    s_nop 0
    v_add_f32 v5, 1.0, v5
    v_rcp_f32 v5, v5
    s_nop 0
    v_cvt_pk_bf16_f32 v5, v5, v5
    v_lshlrev_b32 v5, 16, v5
    s_lshl_b32 s65, s64, 16
    s_and_b32 s66, s64, 0xffff0000
    v_rcp_f32 v10, s66
    s_nop 0
    v_fma_f32 v4, -v10, s66, 1.0
    v_fmac_f32 v10, v4, v10
    s_waitcnt vmcnt(0)
L_yf:
    v_and_b32 v184, v128, v132
    v_or_b32 v188, v128, v132
    v_and_b32 v185, v129, v133
    v_or_b32 v189, v129, v133
    v_and_b32 v186, v130, v134
    v_or_b32 v190, v130, v134
    v_and_b32 v187, v131, v135
    v_or_b32 v191, v131, v135
    v_bitop3_b32 v184, v184, v136, v140 bitop3:0x80
    v_or3_b32 v188, v188, v136, v140
    v_bitop3_b32 v185, v185, v137, v141 bitop3:0x80
    v_or3_b32 v189, v189, v137, v141
    v_bitop3_b32 v186, v186, v138, v142 bitop3:0x80
    v_or3_b32 v190, v190, v138, v142
    v_bitop3_b32 v187, v187, v139, v143 bitop3:0x80
    v_or3_b32 v191, v191, v139, v143
    v_bitop3_b32 v184, v184, v144, v148 bitop3:0x80
    v_or3_b32 v188, v188, v144, v148
    v_bitop3_b32 v185, v185, v145, v149 bitop3:0x80
    v_or3_b32 v189, v189, v145, v149
    v_bitop3_b32 v186, v186, v146, v150 bitop3:0x80
    v_or3_b32 v190, v190, v146, v150
    v_bitop3_b32 v187, v187, v147, v151 bitop3:0x80
    v_or3_b32 v191, v191, v147, v151
    v_bitop3_b32 v184, v184, v152, v156 bitop3:0x80
    v_or3_b32 v188, v188, v152, v156
    v_bitop3_b32 v185, v185, v153, v157 bitop3:0x80
    v_or3_b32 v189, v189, v153, v157
    v_bitop3_b32 v186, v186, v154, v158 bitop3:0x80
    v_or3_b32 v190, v190, v154, v158
    v_bitop3_b32 v187, v187, v155, v159 bitop3:0x80
    v_or3_b32 v191, v191, v155, v159
    v_bitop3_b32 v184, v184, v160, v164 bitop3:0x80
    v_or3_b32 v188, v188, v160, v164
    v_bitop3_b32 v185, v185, v161, v165 bitop3:0x80
    v_or3_b32 v189, v189, v161, v165
    v_bitop3_b32 v186, v186, v162, v166 bitop3:0x80
    v_or3_b32 v190, v190, v162, v166
    v_bitop3_b32 v187, v187, v163, v167 bitop3:0x80
    v_or3_b32 v191, v191, v163, v167
    v_bitop3_b32 v184, v184, v168, v172 bitop3:0x80
    v_or3_b32 v188, v188, v168, v172
    v_bitop3_b32 v185, v185, v169, v173 bitop3:0x80
    v_or3_b32 v189, v189, v169, v173
    v_bitop3_b32 v186, v186, v170, v174 bitop3:0x80
    v_or3_b32 v190, v190, v170, v174
    v_bitop3_b32 v187, v187, v171, v175 bitop3:0x80
    v_or3_b32 v191, v191, v171, v175
    v_bitop3_b32 v184, v184, v176, v180 bitop3:0x80
    v_or3_b32 v188, v188, v176, v180
    v_bitop3_b32 v185, v185, v177, v181 bitop3:0x80
    v_or3_b32 v189, v189, v177, v181
    v_bitop3_b32 v186, v186, v178, v182 bitop3:0x80
    v_or3_b32 v190, v190, v178, v182
    v_bitop3_b32 v187, v187, v179, v183 bitop3:0x80
    v_or3_b32 v191, v191, v179, v183
    v_xor_b32 v184, v184, v28
    v_xor_b32 v188, v188, v28
    v_xor_b32 v185, v185, v29
    v_xor_b32 v189, v189, v29
    v_xor_b32 v186, v186, v30
    v_xor_b32 v190, v190, v30
    v_xor_b32 v187, v187, v31
    v_xor_b32 v191, v191, v31
    v_or3_b32 v6, v184, v185, v186
    v_or3_b32 v6, v6, v187, v188
    v_or3_b32 v6, v6, v189, v190
    v_or_b32 v6, v6, v191
    v_and_b32 v6, 0xff, v6
    v_cmp_ne_u32 vcc, 0, v6
    s_nop 0
    s_cmp_eq_u64 vcc, 0
    s_cbranch_scc1 L_yfok
    s_add_u32 s70, s70, 1
    s_cmp_ge_u32 s70, 200000
    s_cbranch_scc1 L_yfok
    s_sleep 16
    s_lshl_b32 s3, s31, 8
    s_add_u32 s3, s3, 8388608
    buffer_load_dwordx4 v[128:131], v11, s[12:15], s3 offen sc1
    s_add_u32 s3, s3, 65536
    buffer_load_dwordx4 v[132:135], v11, s[12:15], s3 offen sc1
    s_add_u32 s3, s3, 65536
    buffer_load_dwordx4 v[136:139], v11, s[12:15], s3 offen sc1
    s_add_u32 s3, s3, 65536
    buffer_load_dwordx4 v[140:143], v11, s[12:15], s3 offen sc1
    s_add_u32 s3, s3, 65536
    buffer_load_dwordx4 v[144:147], v11, s[12:15], s3 offen sc1
    s_add_u32 s3, s3, 65536
    buffer_load_dwordx4 v[148:151], v11, s[12:15], s3 offen sc1
    s_add_u32 s3, s3, 65536
    buffer_load_dwordx4 v[152:155], v11, s[12:15], s3 offen sc1
    s_add_u32 s3, s3, 65536
    buffer_load_dwordx4 v[156:159], v11, s[12:15], s3 offen sc1
    s_add_u32 s3, s3, 65536
    buffer_load_dwordx4 v[160:163], v11, s[12:15], s3 offen sc1
    s_add_u32 s3, s3, 65536
    buffer_load_dwordx4 v[164:167], v11, s[12:15], s3 offen sc1
    s_add_u32 s3, s3, 65536
    buffer_load_dwordx4 v[168:171], v11, s[12:15], s3 offen sc1
    s_add_u32 s3, s3, 65536
    buffer_load_dwordx4 v[172:175], v11, s[12:15], s3 offen sc1
    s_add_u32 s3, s3, 65536
    buffer_load_dwordx4 v[176:179], v11, s[12:15], s3 offen sc1
    s_add_u32 s3, s3, 65536
    buffer_load_dwordx4 v[180:183], v11, s[12:15], s3 offen sc1
    s_waitcnt vmcnt(0)
    s_branch L_yf
L_yfok:
    v_and_b32 v6, 15, v1
    s_mov_b32 s3, 0xffffff00
    v_and_b32 v128, s3, v128
    v_and_b32 v129, s3, v129
    v_and_b32 v130, s3, v130
    v_and_b32 v131, s3, v131
    v_and_b32 v132, s3, v132
    v_and_b32 v133, s3, v133
    v_and_b32 v134, s3, v134
    v_and_b32 v135, s3, v135
    v_and_b32 v136, s3, v136
    v_and_b32 v137, s3, v137
    v_and_b32 v138, s3, v138
    v_and_b32 v139, s3, v139
    v_and_b32 v140, s3, v140
    v_and_b32 v141, s3, v141
    v_and_b32 v142, s3, v142
    v_and_b32 v143, s3, v143
    v_and_b32 v144, s3, v144
    v_and_b32 v145, s3, v145
    v_and_b32 v146, s3, v146
    v_and_b32 v147, s3, v147
    v_and_b32 v148, s3, v148
    v_and_b32 v149, s3, v149
    v_and_b32 v150, s3, v150
    v_and_b32 v151, s3, v151
    v_and_b32 v152, s3, v152
    v_and_b32 v153, s3, v153
    v_and_b32 v154, s3, v154
    v_and_b32 v155, s3, v155
    v_and_b32 v156, s3, v156
    v_and_b32 v157, s3, v157
    v_and_b32 v158, s3, v158
    v_and_b32 v159, s3, v159
    v_and_b32 v160, s3, v160
    v_and_b32 v161, s3, v161
    v_and_b32 v162, s3, v162
    v_and_b32 v163, s3, v163
    v_and_b32 v164, s3, v164
    v_and_b32 v165, s3, v165
    v_and_b32 v166, s3, v166
    v_and_b32 v167, s3, v167
    v_and_b32 v168, s3, v168
    v_and_b32 v169, s3, v169
    v_and_b32 v170, s3, v170
    v_and_b32 v171, s3, v171
    v_and_b32 v172, s3, v172
    v_and_b32 v173, s3, v173
    v_and_b32 v174, s3, v174
    v_and_b32 v175, s3, v175
    v_and_b32 v176, s3, v176
    v_and_b32 v177, s3, v177
    v_and_b32 v178, s3, v178
    v_and_b32 v179, s3, v179
    v_and_b32 v180, s3, v180
    v_and_b32 v181, s3, v181
    v_and_b32 v182, s3, v182
    v_and_b32 v183, s3, v183
    v_pk_add_f32 v[128:129], v[128:129], v[136:137]
    v_pk_add_f32 v[130:131], v[130:131], v[138:139]
    v_pk_add_f32 v[132:133], v[132:133], v[140:141]
    v_pk_add_f32 v[134:135], v[134:135], v[142:143]
    v_pk_add_f32 v[128:129], v[128:129], v[144:145]
    v_pk_add_f32 v[130:131], v[130:131], v[146:147]
    v_pk_add_f32 v[132:133], v[132:133], v[148:149]
    v_pk_add_f32 v[134:135], v[134:135], v[150:151]
    v_pk_add_f32 v[128:129], v[128:129], v[152:153]
    v_pk_add_f32 v[130:131], v[130:131], v[154:155]
    v_pk_add_f32 v[132:133], v[132:133], v[156:157]
    v_pk_add_f32 v[134:135], v[134:135], v[158:159]
    v_pk_add_f32 v[128:129], v[128:129], v[160:161]
    v_pk_add_f32 v[130:131], v[130:131], v[162:163]
    v_pk_add_f32 v[132:133], v[132:133], v[164:165]
    v_pk_add_f32 v[134:135], v[134:135], v[166:167]
    v_pk_add_f32 v[128:129], v[128:129], v[168:169]
    v_pk_add_f32 v[130:131], v[130:131], v[170:171]
    v_pk_add_f32 v[132:133], v[132:133], v[172:173]
    v_pk_add_f32 v[134:135], v[134:135], v[174:175]
    v_pk_add_f32 v[128:129], v[128:129], v[176:177]
    v_pk_add_f32 v[130:131], v[130:131], v[178:179]
    v_pk_add_f32 v[132:133], v[132:133], v[180:181]
    v_pk_add_f32 v[134:135], v[134:135], v[182:183]
    v_pk_add_f32 v[128:129], v[128:129], v[132:133]
    v_pk_add_f32 v[130:131], v[130:131], v[134:135]
    v_mov_b32 v132, v128
    v_mov_b32 v133, v129
    v_mov_b32 v134, v130
    v_mov_b32 v135, v131
    v_permlane16_swap_b32 v128, v132
    v_permlane16_swap_b32 v129, v133
    v_permlane16_swap_b32 v130, v134
    v_permlane16_swap_b32 v131, v135
    v_pk_add_f32 v[128:129], v[128:129], v[132:133]
    v_pk_add_f32 v[130:131], v[130:131], v[134:135]
    v_mov_b32 v132, v128
    v_mov_b32 v133, v129
    v_mov_b32 v134, v130
    v_mov_b32 v135, v131
    v_permlane32_swap_b32 v128, v132
    v_permlane32_swap_b32 v129, v133
    v_permlane32_swap_b32 v130, v134
    v_permlane32_swap_b32 v131, v135
    v_pk_add_f32 v[128:129], v[128:129], v[132:133]
    v_pk_add_f32 v[130:131], v[130:131], v[134:135]
    s_lshl_b32 s3, s38, 8
    s_add_u32 s3, s3, 157952
    v_lshl_add_u32 v6, v6, 4, s3
    ds_write_b128 v6, v[128:131]
    v_lshlrev_b32 v8, 16, v8
    v_subrev_f32 v9, s65, v8
    v_cvt_pk_bf16_f32 v9, v9, v9
    v_lshlrev_b32 v9, 16, v9
    v_mul_f32 v9, v9, v10
    v_cvt_pk_bf16_f32 v9, v9, v9
    v_lshlrev_b32 v9, 16, v9
    v_mov_b32 v16, v5
    s_lshl_b32 s3, s38, 2
    s_add_u32 s3, s3, 163168
    v_mov_b32 v5, s3
    v_mov_b32 v6, 1
    ds_write_b32 v5, v6
    v_mov_b32 v5, 163104
L_yr:
    ds_read_b128 v[20:23], v5 offset:64
    s_waitcnt lgkmcnt(0)
    v_and_b32 v20, v20, v21
    v_and_b32 v22, v22, v23
    v_and_b32 v20, v20, v22
    s_nop 0
    v_readfirstlane_b32 s3, v20
    s_nop 0
    s_cmp_eq_u32 s3, 1
    s_cbranch_scc1 L_yrd
    s_sleep 1
    s_branch L_yr
L_yrd:
    v_lshlrev_b32 v6, 2, v1
    v_add_u32 v6, 157952, v6
    ds_read_b32 v20, v6 offset:0
    ds_read_b32 v21, v6 offset:256
    ds_read_b32 v22, v6 offset:512
    ds_read_b32 v23, v6 offset:768
    s_bfe_u32 s3, s34, 0x20005
    s_and_b32 s65, s34, 7
    s_lshl_b32 s65, s65, 3
    s_lshl_b64 s[66:67], 0xff, s65
    s_bfe_u32 s65, s34, 0x20003
    s_cmp_lg_u32 s3, s38
    s_cbranch_scc1 L_fin
    s_waitcnt lgkmcnt(0)
    v_add_f32 v20, v20, v21
    v_add_f32 v22, v22, v23
    v_add_f32 v20, v20, v22
    v_cvt_pk_bf16_f32 v20, v20, v20
    v_lshlrev_b32 v20, 16, v20
    v_mul_f32 v20, v20, v16
    v_cvt_pk_bf16_f32 v20, v20, v20
    v_lshlrev_b32 v20, 16, v20
    v_add_f32 v20, v20, v9
    v_cvt_pk_bf16_f32 v20, v20, v20
    v_lshlrev_b32 v20, 16, v20
    v_mul_f32 v21, 0xbfb8aa3b, v20
    v_exp_f32 v21, v21
    s_nop 0
    v_add_f32 v21, 1.0, v21
    v_rcp_f32 v21, v21
    s_nop 0
    v_mul_f32 v20, v20, v21
    ds_write_b32 v6, v20 offset:1024
    v_lshlrev_b32 v6, 5, v250
    v_add_u32 v6, 158976, v6
    s_mov_b64 exec, s[66:67]
    s_cmp_lg_u32 s65, 0
    s_cbranch_scc1 L_gr0
    ds_read_b128 v[68:71], v6
    ds_read_b128 v[72:75], v6 offset:16
L_gr0:
    s_cmp_lg_u32 s65, 1
    s_cbranch_scc1 L_gr1
    ds_read_b128 v[76:79], v6
    ds_read_b128 v[80:83], v6 offset:16
L_gr1:
    s_cmp_lg_u32 s65, 2
    s_cbranch_scc1 L_gr2
    ds_read_b128 v[84:87], v6
    ds_read_b128 v[88:91], v6 offset:16
L_gr2:
    s_cmp_lg_u32 s65, 3
    s_cbranch_scc1 L_gr3
    ds_read_b128 v[92:95], v6
    ds_read_b128 v[96:99], v6 offset:16
L_gr3:
    s_mov_b64 exec, -1
L_fin:
    s_waitcnt lgkmcnt(0)
L_pf:
    ds_read_b32 v6, v27 offset:48
    ds_read_b128 v[232:235], v15 offset:0
    ds_read_b128 v[236:239], v15 offset:1152
    ds_read_b128 v[240:243], v15 offset:2304
    ds_read_b128 v[244:247], v15 offset:3456
    s_waitcnt lgkmcnt(4)
    v_readfirstlane_b32 s3, v6
    s_nop 0
    s_cmp_eq_u32 s3, 7
    s_cbranch_scc1 L_pfd
    s_waitcnt lgkmcnt(0)
    s_cmp_eq_u32 s3, 5
    s_cbranch_scc1 L_pf
L_pw:
    s_sleep 3
    ds_read_b32 v6, v27 offset:48
    s_waitcnt lgkmcnt(0)
    v_readfirstlane_b32 s3, v6
    s_nop 0
    s_cmp_ge_u32 s3, 5
    s_cbranch_scc1 L_pf
    s_branch L_pw
L_pfd:
    s_waitcnt lgkmcnt(3)
    v_lshlrev_b32 v192, 16, v232
    v_and_b32 v193, 0xffff0000, v232
    v_lshlrev_b32 v194, 16, v233
    v_and_b32 v195, 0xffff0000, v233
    v_lshlrev_b32 v196, 16, v234
    v_and_b32 v197, 0xffff0000, v234
    v_lshlrev_b32 v198, 16, v235
    v_and_b32 v199, 0xffff0000, v235
    v_pk_fma_f32 v[36:37], v[192:193], v[68:69], v[36:37]
    v_pk_fma_f32 v[38:39], v[194:195], v[70:71], v[38:39]
    v_pk_fma_f32 v[40:41], v[196:197], v[72:73], v[40:41]
    v_pk_fma_f32 v[42:43], v[198:199], v[74:75], v[42:43]
    v_cvt_pk_bf16_f32 v232, v36, v37
    v_cvt_pk_bf16_f32 v233, v38, v39
    v_cvt_pk_bf16_f32 v234, v40, v41
    v_cvt_pk_bf16_f32 v235, v42, v43
    buffer_store_dwordx4 v[232:235], v248, s[24:27], 0 offen nt
    s_waitcnt lgkmcnt(2)
    v_lshlrev_b32 v200, 16, v236
    v_and_b32 v201, 0xffff0000, v236
    v_lshlrev_b32 v202, 16, v237
    v_and_b32 v203, 0xffff0000, v237
    v_lshlrev_b32 v204, 16, v238
    v_and_b32 v205, 0xffff0000, v238
    v_lshlrev_b32 v206, 16, v239
    v_and_b32 v207, 0xffff0000, v239
    v_pk_fma_f32 v[44:45], v[200:201], v[76:77], v[44:45]
    v_pk_fma_f32 v[46:47], v[202:203], v[78:79], v[46:47]
    v_pk_fma_f32 v[48:49], v[204:205], v[80:81], v[48:49]
    v_pk_fma_f32 v[50:51], v[206:207], v[82:83], v[50:51]
    v_cvt_pk_bf16_f32 v236, v44, v45
    v_cvt_pk_bf16_f32 v237, v46, v47
    v_cvt_pk_bf16_f32 v238, v48, v49
    v_cvt_pk_bf16_f32 v239, v50, v51
    buffer_store_dwordx4 v[236:239], v248, s[24:27], s48 offen nt
    s_waitcnt lgkmcnt(1)
    v_lshlrev_b32 v208, 16, v240
    v_and_b32 v209, 0xffff0000, v240
    v_lshlrev_b32 v210, 16, v241
    v_and_b32 v211, 0xffff0000, v241
    v_lshlrev_b32 v212, 16, v242
    v_and_b32 v213, 0xffff0000, v242
    v_lshlrev_b32 v214, 16, v243
    v_and_b32 v215, 0xffff0000, v243
    v_pk_fma_f32 v[52:53], v[208:209], v[84:85], v[52:53]
    v_pk_fma_f32 v[54:55], v[210:211], v[86:87], v[54:55]
    v_pk_fma_f32 v[56:57], v[212:213], v[88:89], v[56:57]
    v_pk_fma_f32 v[58:59], v[214:215], v[90:91], v[58:59]
    v_cvt_pk_bf16_f32 v240, v52, v53
    v_cvt_pk_bf16_f32 v241, v54, v55
    v_cvt_pk_bf16_f32 v242, v56, v57
    v_cvt_pk_bf16_f32 v243, v58, v59
    buffer_store_dwordx4 v[240:243], v248, s[24:27], s49 offen nt
    s_waitcnt lgkmcnt(0)
    v_lshlrev_b32 v216, 16, v244
    v_and_b32 v217, 0xffff0000, v244
    v_lshlrev_b32 v218, 16, v245
    v_and_b32 v219, 0xffff0000, v245
    v_lshlrev_b32 v220, 16, v246
    v_and_b32 v221, 0xffff0000, v246
    v_lshlrev_b32 v222, 16, v247
    v_and_b32 v223, 0xffff0000, v247
    v_pk_fma_f32 v[60:61], v[216:217], v[92:93], v[60:61]
    v_pk_fma_f32 v[62:63], v[218:219], v[94:95], v[62:63]
    v_pk_fma_f32 v[64:65], v[220:221], v[96:97], v[64:65]
    v_pk_fma_f32 v[66:67], v[222:223], v[98:99], v[66:67]
    v_cvt_pk_bf16_f32 v244, v60, v61
    v_cvt_pk_bf16_f32 v245, v62, v63
    v_cvt_pk_bf16_f32 v246, v64, v65
    v_cvt_pk_bf16_f32 v247, v66, v67
    buffer_store_dwordx4 v[244:247], v248, s[24:27], s100 offen nt
L_done:
    s_endpgm
L_g1:
    s_and_b32 s28, s38, 1
    s_lshr_b32 s29, s38, 1
    s_lshl_b32 s3, s36, 7
    s_lshl_b32 s65, s37, 3
    s_add_u32 s3, s3, s65
    s_lshl_b32 s65, s38, 1
    s_add_u32 s68, s3, s65
    s_lshl_b32 s3, s68, 11
    v_and_b32 v3, 31, v1
    v_lshlrev_b32 v3, 4, v3
    v_lshrrev_b32 v4, 5, v1
    v_lshl_add_u32 v5, v4, 11, v3
    s_waitcnt lgkmcnt(0)
    s_mov_b32 s4, s40
    s_mov_b32 s5, s41
    s_mov_b32 s6, 4194304
    s_mov_b32 s7, 0x00020000
    s_mov_b32 s16, s50
    s_mov_b32 s17, s51
    s_mov_b32 s18, 2048
    s_mov_b32 s19, 0x00020000
    v_mov_b32 v224, v5
    v_mov_b32 v225, v3
    s_mov_b32 s69, s3
    buffer_load_dwordx4 v[192:195], v224, s[4:7], s69 offen offset:0
    buffer_load_dwordx4 v[196:199], v224, s[4:7], s69 offen offset:512
    buffer_load_dwordx4 v[200:203], v224, s[4:7], s69 offen offset:1024
    buffer_load_dwordx4 v[204:207], v224, s[4:7], s69 offen offset:1536
    buffer_load_dwordx4 v[208:211], v225, s[16:19], 0 offen offset:0
    buffer_load_dwordx4 v[212:215], v225, s[16:19], 0 offen offset:512
    buffer_load_dwordx4 v[216:219], v225, s[16:19], 0 offen offset:1024
    buffer_load_dwordx4 v[220:223], v225, s[16:19], 0 offen offset:1536
    s_or_b32 s3, s2, s38
    s_cmp_lg_u32 s3, 0
    s_cbranch_scc1 L_nn
    s_mov_b32 s20, s60
    s_mov_b32 s21, s61
    s_mov_b32 s22, 256
    s_mov_b32 s23, 0x00020000
    s_memrealtime s[66:67]
    s_memtime s[70:71]
    s_waitcnt lgkmcnt(0)
    s_lshl_b32 s70, s70, 20
    s_xor_b32 s66, s66, s70
    s_or_b32 s66, s66, 1
    s_and_b32 s66, s66, 0xbfffbfff
    v_mov_b32 v6, s66
    v_mov_b32 v7, 0
    s_mov_b64 exec, 1
    buffer_store_dword v6, v7, s[20:23], 0 offen sc1
    s_mov_b64 exec, -1
L_nn:
    s_getpc_b64 s[66:67]
L_pc:
    s_sub_u32 s66, s66, L_pc-recurrent_scan__linear_kernel_hedgehog__moe_arch_mod__prompt_kernel
    s_subb_u32 s67, s67, 0
    s_lshr_b32 s3, s2, 3
    s_lshl_b32 s3, s3, 2
    s_add_u32 s3, s3, s38
    s_lshl_b32 s3, s3, 6
    s_add_u32 s66, s66, s3
    s_addc_u32 s67, s67, 0
    s_load_dword s71, s[66:67], 0
    s_load_dword s71, s[66:67], 8192
    s_load_dword s71, s[66:67], 16384
    s_load_dword s71, s[66:67], 24576
    s_load_dword s71, s[66:67], 32768
    s_load_dword s71, s[66:67], 40960
    s_mov_b32 s12, s62
    s_mov_b32 s13, s63
    s_mov_b32 s14, 268435456
    s_mov_b32 s15, 0x00020000
    s_mov_b32 s8, s42
    s_mov_b32 s9, s43
    s_mov_b32 s10, 6291456
    s_mov_b32 s11, 0x00020000
    s_mov_b32 s20, s44
    s_mov_b32 s21, s45
    s_mov_b32 s22, 65536
    s_mov_b32 s23, 0x00020000
    s_mov_b32 s24, s58
    s_mov_b32 s25, s59
    s_mov_b32 s26, 4194304
    s_mov_b32 s27, 0x00020000
    s_mov_b32 s80, s52
    s_mov_b32 s81, s53
    s_mov_b32 s82, 0
    s_mov_b32 s83, 0x00020000
    s_mov_b32 s84, s54
    s_mov_b32 s85, s55
    s_mov_b32 s86, 0
    s_mov_b32 s87, 0x00020000
    s_and_b32 s30, s2, 3
    s_lshl_b32 s30, s30, 2
    s_bfe_u32 s3, s2, 0x20003
    s_add_u32 s30, s30, s3
    s_bfe_u32 s31, s2, 0x10002
    s_lshl_b32 s31, s31, 3
    s_lshr_b32 s3, s2, 5
    s_add_u32 s31, s31, s3
    s_mov_b32 s70, 0
    v_and_b32 v3, 15, v1
    v_lshlrev_b32 v6, 7, v3
    s_lshl_b32 s3, s28, 13
    v_add_u32 v6, s3, v6
    v_lshrrev_b32 v3, 1, v3
    v_lshrrev_b32 v2, 4, v1
    v_xor_b32 v3, v3, v2
    v_lshl_add_u32 v168, v3, 4, v6
    v_xor_b32 v3, 4, v3
    v_lshl_add_u32 v169, v3, 4, v6
    v_lshlrev_b32 v6, 3, v2
    v_bfe_u32 v7, v1, 2, 2
    v_add_u32 v6, v6, v7
    v_lshlrev_b32 v6, 7, v6
    v_and_b32 v7, 3, v1
    v_lshl_add_u32 v6, v7, 3, v6
    v_bfe_u32 v7, v1, 3, 2
    s_lshl_b32 s3, s29, 1
    v_xor_b32 v7, s3, v7
    v_add_u32 v6, 65536, v6
    v_lshl_add_u32 v170, v7, 5, v6
    v_xor_b32 v7, 1, v7
    v_lshl_add_u32 v171, v7, 5, v6
    v_add_u32 v189, 65536, v170
    v_add_u32 v191, 65536, v171
    v_mov_b32 v190, v4
    s_lshl_b32 s3, s38, 2
    s_add_u32 s3, s3, 163152
    v_mov_b32 v249, s3
    v_mov_b32 v251, 163072
    v_and_b32 v3, 15, v1
    s_lshl_b32 s3, s28, 8
    s_add_u32 s3, s3, 159744
    v_lshl_add_u32 v240, v3, 2, s3
    v_lshl_add_u32 v241, v1, 2, s3
    v_lshl_add_u32 v242, v2, 4, s3
    s_lshl_b32 s3, s29, 7
    s_add_u32 s3, s3, 162304
    v_lshl_add_u32 v243, v2, 4, s3
    v_lshl_add_u32 v244, v3, 2, s3
    s_lshl_b32 s3, s28, 7
    s_add_u32 s72, s3, 160768
    v_lshl_add_u32 v245, v2, 3, s72
    s_xor_b32 s3, s3, 128
    s_add_u32 s72, s3, 160768
    v_lshl_add_u32 v247, v2, 3, s72
    v_lshrrev_b32 v6, 2, v1
    v_lshlrev_b32 v4, 6, v6
    v_and_b32 v7, 3, v1
    v_lshl_add_u32 v4, v7, 3, v4
    s_lshl_b32 s3, s29, 11
    s_add_u32 s3, s3, 155648
    v_add_u32 v246, s3, v4
    v_mul_u32_u24 v4, 136, v3
    v_lshl_add_u32 v4, v2, 3, v4
    v_mul_u32_u24 v6, 136, v6
    v_lshl_add_u32 v6, v7, 3, v6
    s_lshl_b32 s3, s28, 6
    v_add_u32 v6, s3, v6
    v_lshlrev_b32 v5, 4, v1
    s_mul_i32 s72, s38, 8704
    s_add_u32 s72, s72, 96256
    s_xor_b32 s3, s38, 1
    s_mul_i32 s73, s3, 8704
    s_add_u32 s73, s73, 96256
    s_lshl_b32 s74, s38, 12
    s_add_u32 s74, s74, 65536
    s_lshl_b32 s75, s3, 12
    s_add_u32 s75, s75, 65536
    s_lshl_b32 s76, s3, 2
    s_add_u32 s76, s76, 163184
    s_lshl_b32 s3, s37, 1
    s_add_u32 s3, s3, s29
    s_lshl_b32 s3, s3, 4
    s_add_u32 s3, s3, s36
    s_lshl_b32 s3, s3, 1
    s_add_u32 s3, s3, s28
    s_lshl_b32 s3, s3, 12
    s_add_u32 s77, s3, 2097152
    v_mov_b64 v[8:9], 0
    v_mov_b64 v[10:11], 0
    v_mov_b64 v[12:13], 0
    v_mov_b64 v[14:15], 0
    v_mov_b64 v[16:17], 0
    v_mov_b64 v[18:19], 0
    v_mov_b64 v[20:21], 0
    v_mov_b64 v[22:23], 0
    v_mov_b64 v[24:25], 0
    v_mov_b64 v[26:27], 0
    v_mov_b64 v[28:29], 0
    v_mov_b64 v[30:31], 0
    v_mov_b64 v[32:33], 0
    v_mov_b64 v[34:35], 0
    v_mov_b64 v[36:37], 0
    v_mov_b64 v[38:39], 0
    v_mov_b64 v[40:41], 0
    v_mov_b64 v[42:43], 0
    v_mov_b64 v[44:45], 0
    v_mov_b64 v[46:47], 0
    v_mov_b64 v[48:49], 0
    v_mov_b64 v[50:51], 0
    v_mov_b64 v[52:53], 0
    v_mov_b64 v[54:55], 0
    v_mov_b64 v[56:57], 0
    v_mov_b64 v[58:59], 0
    v_mov_b64 v[60:61], 0
    v_mov_b64 v[62:63], 0
    v_mov_b64 v[64:65], 0
    v_mov_b64 v[66:67], 0
    v_mov_b64 v[68:69], 0
    v_mov_b64 v[70:71], 0
    v_mov_b64 v[72:73], 0
    v_mov_b64 v[74:75], 0
    v_mov_b64 v[76:77], 0
    v_mov_b64 v[78:79], 0
    v_mov_b64 v[80:81], 0
    v_mov_b64 v[82:83], 0
    v_mov_b64 v[84:85], 0
    v_mov_b64 v[86:87], 0
    v_mov_b64 v[88:89], 0
    v_mov_b64 v[90:91], 0
    v_mov_b64 v[92:93], 0
    v_mov_b64 v[94:95], 0
    v_mov_b64 v[96:97], 0
    v_mov_b64 v[98:99], 0
    v_mov_b64 v[100:101], 0
    v_mov_b64 v[102:103], 0
    v_mov_b32 v236, 0x3f803f80
    v_mov_b32 v232, 0
    v_mov_b32 v233, 0
    v_mov_b32 v234, 0
    v_mov_b32 v235, 0
    s_waitcnt vmcnt(0)
    v_dot2_f32_bf16 v232, v192, v236, v232
    v_dot2_f32_bf16 v233, v192, v192, v233
    v_dot2_f32_bf16 v234, v192, v208, v234
    v_dot2_f32_bf16 v235, v208, v236, v235
    v_dot2_f32_bf16 v232, v193, v236, v232
    v_dot2_f32_bf16 v233, v193, v193, v233
    v_dot2_f32_bf16 v234, v193, v209, v234
    v_dot2_f32_bf16 v235, v209, v236, v235
    v_dot2_f32_bf16 v232, v194, v236, v232
    v_dot2_f32_bf16 v233, v194, v194, v233
    v_dot2_f32_bf16 v234, v194, v210, v234
    v_dot2_f32_bf16 v235, v210, v236, v235
    v_dot2_f32_bf16 v232, v195, v236, v232
    v_dot2_f32_bf16 v233, v195, v195, v233
    v_dot2_f32_bf16 v234, v195, v211, v234
    v_dot2_f32_bf16 v235, v211, v236, v235
    v_dot2_f32_bf16 v232, v196, v236, v232
    v_dot2_f32_bf16 v233, v196, v196, v233
    v_dot2_f32_bf16 v234, v196, v212, v234
    v_dot2_f32_bf16 v235, v212, v236, v235
    v_dot2_f32_bf16 v232, v197, v236, v232
    v_dot2_f32_bf16 v233, v197, v197, v233
    v_dot2_f32_bf16 v234, v197, v213, v234
    v_dot2_f32_bf16 v235, v213, v236, v235
    v_dot2_f32_bf16 v232, v198, v236, v232
    v_dot2_f32_bf16 v233, v198, v198, v233
    v_dot2_f32_bf16 v234, v198, v214, v234
    v_dot2_f32_bf16 v235, v214, v236, v235
    v_dot2_f32_bf16 v232, v199, v236, v232
    v_dot2_f32_bf16 v233, v199, v199, v233
    v_dot2_f32_bf16 v234, v199, v215, v234
    v_dot2_f32_bf16 v235, v215, v236, v235
    v_dot2_f32_bf16 v232, v200, v236, v232
    v_dot2_f32_bf16 v233, v200, v200, v233
    v_dot2_f32_bf16 v234, v200, v216, v234
    v_dot2_f32_bf16 v235, v216, v236, v235
    v_dot2_f32_bf16 v232, v201, v236, v232
    v_dot2_f32_bf16 v233, v201, v201, v233
    v_dot2_f32_bf16 v234, v201, v217, v234
    v_dot2_f32_bf16 v235, v217, v236, v235
    v_dot2_f32_bf16 v232, v202, v236, v232
    v_dot2_f32_bf16 v233, v202, v202, v233
    v_dot2_f32_bf16 v234, v202, v218, v234
    v_dot2_f32_bf16 v235, v218, v236, v235
    v_dot2_f32_bf16 v232, v203, v236, v232
    v_dot2_f32_bf16 v233, v203, v203, v233
    v_dot2_f32_bf16 v234, v203, v219, v234
    v_dot2_f32_bf16 v235, v219, v236, v235
    v_dot2_f32_bf16 v232, v204, v236, v232
    v_dot2_f32_bf16 v233, v204, v204, v233
    v_dot2_f32_bf16 v234, v204, v220, v234
    v_dot2_f32_bf16 v235, v220, v236, v235
    v_dot2_f32_bf16 v232, v205, v236, v232
    v_dot2_f32_bf16 v233, v205, v205, v233
    v_dot2_f32_bf16 v234, v205, v221, v234
    v_dot2_f32_bf16 v235, v221, v236, v235
    v_dot2_f32_bf16 v232, v206, v236, v232
    v_dot2_f32_bf16 v233, v206, v206, v233
    v_dot2_f32_bf16 v234, v206, v222, v234
    v_dot2_f32_bf16 v235, v222, v236, v235
    v_dot2_f32_bf16 v232, v207, v236, v232
    v_dot2_f32_bf16 v233, v207, v207, v233
    v_dot2_f32_bf16 v234, v207, v223, v234
    v_dot2_f32_bf16 v235, v223, v236, v235
    v_add_f32 v232, v232, v232 quad_perm:[1,0,3,2] row_mask:0xf bank_mask:0xf
    v_add_f32 v233, v233, v233 quad_perm:[1,0,3,2] row_mask:0xf bank_mask:0xf
    v_add_f32 v234, v234, v234 quad_perm:[1,0,3,2] row_mask:0xf bank_mask:0xf
    v_add_f32 v235, v235, v235 quad_perm:[1,0,3,2] row_mask:0xf bank_mask:0xf
    v_add_f32 v232, v232, v232 quad_perm:[2,3,0,1] row_mask:0xf bank_mask:0xf
    v_add_f32 v233, v233, v233 quad_perm:[2,3,0,1] row_mask:0xf bank_mask:0xf
    v_add_f32 v234, v234, v234 quad_perm:[2,3,0,1] row_mask:0xf bank_mask:0xf
    v_add_f32 v235, v235, v235 quad_perm:[2,3,0,1] row_mask:0xf bank_mask:0xf
    v_add_f32 v232, v232, v232 row_half_mirror row_mask:0xf bank_mask:0xf
    v_add_f32 v233, v233, v233 row_half_mirror row_mask:0xf bank_mask:0xf
    v_add_f32 v234, v234, v234 row_half_mirror row_mask:0xf bank_mask:0xf
    v_add_f32 v235, v235, v235 row_half_mirror row_mask:0xf bank_mask:0xf
    v_add_f32 v232, v232, v232 row_mirror row_mask:0xf bank_mask:0xf
    v_add_f32 v233, v233, v233 row_mirror row_mask:0xf bank_mask:0xf
    v_add_f32 v234, v234, v234 row_mirror row_mask:0xf bank_mask:0xf
    v_add_f32 v235, v235, v235 row_mirror row_mask:0xf bank_mask:0xf
    v_mov_b32 v236, v232
    v_mov_b32 v237, v233
    v_mov_b32 v238, v234
    v_mov_b32 v239, v235
    v_permlane16_swap_b32 v232, v236
    v_permlane16_swap_b32 v233, v237
    v_permlane16_swap_b32 v234, v238
    v_permlane16_swap_b32 v235, v239
    v_add_f32 v232, v232, v236
    v_add_f32 v233, v233, v237
    v_add_f32 v234, v234, v238
    v_add_f32 v235, v235, v239
    v_mul_f32 v232, 0x3a800000, v232
    v_mul_f32 v233, 0x3a800000, v233
    v_fma_f32 v233, -v232, v232, v233
    v_max_f32 v233, 0, v233
    v_cvt_pk_bf16_f32 v232, v232, v232
    v_lshlrev_b32 v232, 16, v232
    v_cvt_pk_bf16_f32 v233, v233, v233
    v_lshlrev_b32 v233, 16, v233
    v_add_f32 v233, 0x3727c5ac, v233
    v_cvt_pk_bf16_f32 v233, v233, v233
    v_lshlrev_b32 v233, 16, v233
    v_sqrt_f32 v233, v233
    v_fma_f32 v234, -v232, v235, v234
    v_cvt_pk_bf16_f32 v233, v233, v233
    v_lshlrev_b32 v233, 16, v233
    v_rcp_f32 v235, v233
    v_lshrrev_b32 v232, 16, v232
    v_or_b32 v232, v232, v233
    v_mul_f32 v234, v234, v235
    v_ashrrev_i32 v235, 31, v234
    v_or_b32 v235, 0x80000000, v235
    v_xor_b32 v234, v234, v235
    v_and_b32 v234, 0xfffff800, v234
    s_sub_u32 s3, 2047, s68
    v_sub_u32 v235, s3, v190
    v_or_b32 v233, v234, v235
    s_lshl_b32 s3, s38, 4
    s_add_u32 s3, s3, 163264
    v_lshl_add_u32 v235, v190, 3, s3
    ds_write_b64 v235, v[232:233]
L_c1:
    s_waitcnt lgkmcnt(0)
    s_barrier
    ds_read_b128 v[104:107], v168 offset:0
    ds_read_b64_tr_b16 v[120:121], v170 offset:0
    ds_read_b64_tr_b16 v[122:123], v170 offset:512
    ds_read_b64_tr_b16 v[124:125], v171 offset:0
    ds_read_b64_tr_b16 v[126:127], v171 offset:512
    ds_read_b128 v[108:111], v168 offset:2048
    ds_read_b64_tr_b16 v[128:129], v170 offset:8192
    ds_read_b64_tr_b16 v[130:131], v170 offset:8704
    ds_read_b64_tr_b16 v[132:133], v171 offset:8192
    ds_read_b64_tr_b16 v[134:135], v171 offset:8704
    ds_read_b64_tr_b16 v[172:173], v189 offset:0
    ds_read_b64_tr_b16 v[174:175], v189 offset:512
    s_waitcnt lgkmcnt(8)
    ds_read_b64_tr_b16 v[176:177], v191 offset:0
    ds_read_b64_tr_b16 v[178:179], v191 offset:512
    ds_read_b128 v[112:115], v168 offset:4096
    ds_read_b128 v[116:119], v168 offset:6144
    s_waitcnt lgkmcnt(0)
    v_mfma_f32_16x16x32_bf16 v[8:11], v[120:123], v[104:107], v[8:11]
    ds_read_b128 v[136:139], v169 offset:0
    v_mfma_f32_16x16x32_bf16 v[12:15], v[124:127], v[104:107], v[12:15]
    ds_read_b64_tr_b16 v[152:153], v170 offset:4096
    v_mfma_f32_16x16x32_bf16 v[16:19], v[104:107], v[128:131], v[16:19]
    ds_read_b64_tr_b16 v[154:155], v170 offset:4608
    v_mfma_f32_16x16x32_bf16 v[20:23], v[104:107], v[132:135], v[20:23]
    ds_read_b64_tr_b16 v[156:157], v171 offset:4096
    v_mfma_f32_16x16x32_bf16 v[72:75], v[172:175], v[104:107], v[72:75]
    ds_read_b64_tr_b16 v[158:159], v171 offset:4608
    v_mfma_f32_16x16x32_bf16 v[76:79], v[176:179], v[104:107], v[76:79]
    ds_read_b128 v[140:143], v169 offset:2048
    v_mfma_f32_16x16x32_bf16 v[24:27], v[120:123], v[108:111], v[24:27]
    ds_read_b64_tr_b16 v[160:161], v170 offset:12288
    v_mfma_f32_16x16x32_bf16 v[28:31], v[124:127], v[108:111], v[28:31]
    ds_read_b64_tr_b16 v[162:163], v170 offset:12800
    v_mfma_f32_16x16x32_bf16 v[32:35], v[108:111], v[128:131], v[32:35]
    ds_read_b64_tr_b16 v[164:165], v171 offset:12288
    v_mfma_f32_16x16x32_bf16 v[36:39], v[108:111], v[132:135], v[36:39]
    ds_read_b64_tr_b16 v[166:167], v171 offset:12800
    v_mfma_f32_16x16x32_bf16 v[80:83], v[172:175], v[108:111], v[80:83]
    ds_read_b64_tr_b16 v[180:181], v189 offset:4096
    v_mfma_f32_16x16x32_bf16 v[84:87], v[176:179], v[108:111], v[84:87]
    ds_read_b64_tr_b16 v[182:183], v189 offset:4608
    v_mfma_f32_16x16x32_bf16 v[40:43], v[120:123], v[112:115], v[40:43]
    ds_read_b64_tr_b16 v[184:185], v191 offset:4096
    v_mfma_f32_16x16x32_bf16 v[44:47], v[124:127], v[112:115], v[44:47]
    ds_read_b64_tr_b16 v[186:187], v191 offset:4608
    v_mfma_f32_16x16x32_bf16 v[48:51], v[112:115], v[128:131], v[48:51]
    ds_read_b128 v[144:147], v169 offset:4096
    v_mfma_f32_16x16x32_bf16 v[52:55], v[112:115], v[132:135], v[52:55]
    ds_read_b128 v[148:151], v169 offset:6144
    v_mfma_f32_16x16x32_bf16 v[88:91], v[172:175], v[112:115], v[88:91]
    v_mfma_f32_16x16x32_bf16 v[92:95], v[176:179], v[112:115], v[92:95]
    v_mfma_f32_16x16x32_bf16 v[56:59], v[120:123], v[116:119], v[56:59]
    v_mfma_f32_16x16x32_bf16 v[60:63], v[124:127], v[116:119], v[60:63]
    v_mfma_f32_16x16x32_bf16 v[64:67], v[116:119], v[128:131], v[64:67]
    v_mfma_f32_16x16x32_bf16 v[68:71], v[116:119], v[132:135], v[68:71]
    v_mfma_f32_16x16x32_bf16 v[96:99], v[172:175], v[116:119], v[96:99]
    v_mfma_f32_16x16x32_bf16 v[100:103], v[176:179], v[116:119], v[100:103]
    s_waitcnt lgkmcnt(0)
    s_barrier
    v_mfma_f32_16x16x32_bf16 v[8:11], v[152:155], v[136:139], v[8:11]
    ds_read_b128 v[104:107], v168 offset:16384
    v_mfma_f32_16x16x32_bf16 v[12:15], v[156:159], v[136:139], v[12:15]
    ds_read_b64_tr_b16 v[120:121], v170 offset:16384
    v_mfma_f32_16x16x32_bf16 v[16:19], v[136:139], v[160:163], v[16:19]
    ds_read_b64_tr_b16 v[122:123], v170 offset:16896
    v_mfma_f32_16x16x32_bf16 v[20:23], v[136:139], v[164:167], v[20:23]
    ds_read_b64_tr_b16 v[124:125], v171 offset:16384
    v_mfma_f32_16x16x32_bf16 v[72:75], v[180:183], v[136:139], v[72:75]
    ds_read_b64_tr_b16 v[126:127], v171 offset:16896
    v_mfma_f32_16x16x32_bf16 v[76:79], v[184:187], v[136:139], v[76:79]
    ds_read_b128 v[108:111], v168 offset:18432
    v_mfma_f32_16x16x32_bf16 v[24:27], v[152:155], v[140:143], v[24:27]
    ds_read_b64_tr_b16 v[128:129], v170 offset:24576
    v_mfma_f32_16x16x32_bf16 v[28:31], v[156:159], v[140:143], v[28:31]
    ds_read_b64_tr_b16 v[130:131], v170 offset:25088
    v_mfma_f32_16x16x32_bf16 v[32:35], v[140:143], v[160:163], v[32:35]
    ds_read_b64_tr_b16 v[132:133], v171 offset:24576
    v_mfma_f32_16x16x32_bf16 v[36:39], v[140:143], v[164:167], v[36:39]
    ds_read_b64_tr_b16 v[134:135], v171 offset:25088
    v_mfma_f32_16x16x32_bf16 v[80:83], v[180:183], v[140:143], v[80:83]
    ds_read_b64_tr_b16 v[172:173], v189 offset:8192
    v_mfma_f32_16x16x32_bf16 v[84:87], v[184:187], v[140:143], v[84:87]
    ds_read_b64_tr_b16 v[174:175], v189 offset:8704
    v_mfma_f32_16x16x32_bf16 v[40:43], v[152:155], v[144:147], v[40:43]
    ds_read_b64_tr_b16 v[176:177], v191 offset:8192
    v_mfma_f32_16x16x32_bf16 v[44:47], v[156:159], v[144:147], v[44:47]
    ds_read_b64_tr_b16 v[178:179], v191 offset:8704
    v_mfma_f32_16x16x32_bf16 v[48:51], v[144:147], v[160:163], v[48:51]
    ds_read_b128 v[112:115], v168 offset:20480
    v_mfma_f32_16x16x32_bf16 v[52:55], v[144:147], v[164:167], v[52:55]
    ds_read_b128 v[116:119], v168 offset:22528
    v_mfma_f32_16x16x32_bf16 v[88:91], v[180:183], v[144:147], v[88:91]
    v_mfma_f32_16x16x32_bf16 v[92:95], v[184:187], v[144:147], v[92:95]
    v_mfma_f32_16x16x32_bf16 v[56:59], v[152:155], v[148:151], v[56:59]
    v_mfma_f32_16x16x32_bf16 v[60:63], v[156:159], v[148:151], v[60:63]
    v_mfma_f32_16x16x32_bf16 v[64:67], v[148:151], v[160:163], v[64:67]
    v_mfma_f32_16x16x32_bf16 v[68:71], v[148:151], v[164:167], v[68:71]
    v_mfma_f32_16x16x32_bf16 v[96:99], v[180:183], v[148:151], v[96:99]
    v_mfma_f32_16x16x32_bf16 v[100:103], v[184:187], v[148:151], v[100:103]
    s_waitcnt lgkmcnt(0)
    v_mfma_f32_16x16x32_bf16 v[8:11], v[120:123], v[104:107], v[8:11]
    ds_read_b128 v[136:139], v169 offset:16384
    v_mfma_f32_16x16x32_bf16 v[12:15], v[124:127], v[104:107], v[12:15]
    ds_read_b64_tr_b16 v[152:153], v170 offset:20480
    v_mfma_f32_16x16x32_bf16 v[16:19], v[104:107], v[128:131], v[16:19]
    ds_read_b64_tr_b16 v[154:155], v170 offset:20992
    v_mfma_f32_16x16x32_bf16 v[20:23], v[104:107], v[132:135], v[20:23]
    ds_read_b64_tr_b16 v[156:157], v171 offset:20480
    v_mfma_f32_16x16x32_bf16 v[72:75], v[172:175], v[104:107], v[72:75]
    ds_read_b64_tr_b16 v[158:159], v171 offset:20992
    v_mfma_f32_16x16x32_bf16 v[76:79], v[176:179], v[104:107], v[76:79]
    ds_read_b128 v[140:143], v169 offset:18432
    v_mfma_f32_16x16x32_bf16 v[24:27], v[120:123], v[108:111], v[24:27]
    ds_read_b64_tr_b16 v[160:161], v170 offset:28672
    v_mfma_f32_16x16x32_bf16 v[28:31], v[124:127], v[108:111], v[28:31]
    ds_read_b64_tr_b16 v[162:163], v170 offset:29184
    v_mfma_f32_16x16x32_bf16 v[32:35], v[108:111], v[128:131], v[32:35]
    ds_read_b64_tr_b16 v[164:165], v171 offset:28672
    v_mfma_f32_16x16x32_bf16 v[36:39], v[108:111], v[132:135], v[36:39]
    ds_read_b64_tr_b16 v[166:167], v171 offset:29184
    v_mfma_f32_16x16x32_bf16 v[80:83], v[172:175], v[108:111], v[80:83]
    ds_read_b64_tr_b16 v[180:181], v189 offset:12288
    v_mfma_f32_16x16x32_bf16 v[84:87], v[176:179], v[108:111], v[84:87]
    ds_read_b64_tr_b16 v[182:183], v189 offset:12800
    v_mfma_f32_16x16x32_bf16 v[40:43], v[120:123], v[112:115], v[40:43]
    ds_read_b64_tr_b16 v[184:185], v191 offset:12288
    v_mfma_f32_16x16x32_bf16 v[44:47], v[124:127], v[112:115], v[44:47]
    ds_read_b64_tr_b16 v[186:187], v191 offset:12800
    v_mfma_f32_16x16x32_bf16 v[48:51], v[112:115], v[128:131], v[48:51]
    ds_read_b128 v[144:147], v169 offset:20480
    v_mfma_f32_16x16x32_bf16 v[52:55], v[112:115], v[132:135], v[52:55]
    ds_read_b128 v[148:151], v169 offset:22528
    v_mfma_f32_16x16x32_bf16 v[88:91], v[172:175], v[112:115], v[88:91]
    v_mfma_f32_16x16x32_bf16 v[92:95], v[176:179], v[112:115], v[92:95]
    v_mfma_f32_16x16x32_bf16 v[56:59], v[120:123], v[116:119], v[56:59]
    v_mfma_f32_16x16x32_bf16 v[60:63], v[124:127], v[116:119], v[60:63]
    v_mfma_f32_16x16x32_bf16 v[64:67], v[116:119], v[128:131], v[64:67]
    v_mfma_f32_16x16x32_bf16 v[68:71], v[116:119], v[132:135], v[68:71]
    v_mfma_f32_16x16x32_bf16 v[96:99], v[172:175], v[116:119], v[96:99]
    v_mfma_f32_16x16x32_bf16 v[100:103], v[176:179], v[116:119], v[100:103]
    s_waitcnt lgkmcnt(0)
    s_barrier
    v_mfma_f32_16x16x32_bf16 v[8:11], v[152:155], v[136:139], v[8:11]
    ds_read_b128 v[104:107], v168 offset:32768
    v_mfma_f32_16x16x32_bf16 v[12:15], v[156:159], v[136:139], v[12:15]
    ds_read_b64_tr_b16 v[120:121], v170 offset:32768
    v_mfma_f32_16x16x32_bf16 v[16:19], v[136:139], v[160:163], v[16:19]
    ds_read_b64_tr_b16 v[122:123], v170 offset:33280
    v_mfma_f32_16x16x32_bf16 v[20:23], v[136:139], v[164:167], v[20:23]
    ds_read_b64_tr_b16 v[124:125], v171 offset:32768
    v_mfma_f32_16x16x32_bf16 v[72:75], v[180:183], v[136:139], v[72:75]
    ds_read_b64_tr_b16 v[126:127], v171 offset:33280
    v_mfma_f32_16x16x32_bf16 v[76:79], v[184:187], v[136:139], v[76:79]
    ds_read_b128 v[108:111], v168 offset:34816
    v_mfma_f32_16x16x32_bf16 v[24:27], v[152:155], v[140:143], v[24:27]
    ds_read_b64_tr_b16 v[128:129], v170 offset:40960
    v_mfma_f32_16x16x32_bf16 v[28:31], v[156:159], v[140:143], v[28:31]
    ds_read_b64_tr_b16 v[130:131], v170 offset:41472
    v_mfma_f32_16x16x32_bf16 v[32:35], v[140:143], v[160:163], v[32:35]
    ds_read_b64_tr_b16 v[132:133], v171 offset:40960
    v_mfma_f32_16x16x32_bf16 v[36:39], v[140:143], v[164:167], v[36:39]
    ds_read_b64_tr_b16 v[134:135], v171 offset:41472
    v_mfma_f32_16x16x32_bf16 v[80:83], v[180:183], v[140:143], v[80:83]
    ds_read_b64_tr_b16 v[172:173], v189 offset:16384
    v_mfma_f32_16x16x32_bf16 v[84:87], v[184:187], v[140:143], v[84:87]
    ds_read_b64_tr_b16 v[174:175], v189 offset:16896
    v_mfma_f32_16x16x32_bf16 v[40:43], v[152:155], v[144:147], v[40:43]
    ds_read_b64_tr_b16 v[176:177], v191 offset:16384
    v_mfma_f32_16x16x32_bf16 v[44:47], v[156:159], v[144:147], v[44:47]
    ds_read_b64_tr_b16 v[178:179], v191 offset:16896
    v_mfma_f32_16x16x32_bf16 v[48:51], v[144:147], v[160:163], v[48:51]
    ds_read_b128 v[112:115], v168 offset:36864
    v_mfma_f32_16x16x32_bf16 v[52:55], v[144:147], v[164:167], v[52:55]
    ds_read_b128 v[116:119], v168 offset:38912
    v_mfma_f32_16x16x32_bf16 v[88:91], v[180:183], v[144:147], v[88:91]
    v_mfma_f32_16x16x32_bf16 v[92:95], v[184:187], v[144:147], v[92:95]
    v_mfma_f32_16x16x32_bf16 v[56:59], v[152:155], v[148:151], v[56:59]
    v_mfma_f32_16x16x32_bf16 v[60:63], v[156:159], v[148:151], v[60:63]
    v_mfma_f32_16x16x32_bf16 v[64:67], v[148:151], v[160:163], v[64:67]
    v_mfma_f32_16x16x32_bf16 v[68:71], v[148:151], v[164:167], v[68:71]
    v_mfma_f32_16x16x32_bf16 v[96:99], v[180:183], v[148:151], v[96:99]
    v_mfma_f32_16x16x32_bf16 v[100:103], v[184:187], v[148:151], v[100:103]
    s_waitcnt lgkmcnt(0)
    v_mfma_f32_16x16x32_bf16 v[8:11], v[120:123], v[104:107], v[8:11]
    ds_read_b128 v[136:139], v169 offset:32768
    v_mfma_f32_16x16x32_bf16 v[12:15], v[124:127], v[104:107], v[12:15]
    ds_read_b64_tr_b16 v[152:153], v170 offset:36864
    v_mfma_f32_16x16x32_bf16 v[16:19], v[104:107], v[128:131], v[16:19]
    ds_read_b64_tr_b16 v[154:155], v170 offset:37376
    v_mfma_f32_16x16x32_bf16 v[20:23], v[104:107], v[132:135], v[20:23]
    ds_read_b64_tr_b16 v[156:157], v171 offset:36864
    v_mfma_f32_16x16x32_bf16 v[72:75], v[172:175], v[104:107], v[72:75]
    ds_read_b64_tr_b16 v[158:159], v171 offset:37376
    v_mfma_f32_16x16x32_bf16 v[76:79], v[176:179], v[104:107], v[76:79]
    ds_read_b128 v[140:143], v169 offset:34816
    v_mfma_f32_16x16x32_bf16 v[24:27], v[120:123], v[108:111], v[24:27]
    ds_read_b64_tr_b16 v[160:161], v170 offset:45056
    v_mfma_f32_16x16x32_bf16 v[28:31], v[124:127], v[108:111], v[28:31]
    ds_read_b64_tr_b16 v[162:163], v170 offset:45568
    v_mfma_f32_16x16x32_bf16 v[32:35], v[108:111], v[128:131], v[32:35]
    ds_read_b64_tr_b16 v[164:165], v171 offset:45056
    v_mfma_f32_16x16x32_bf16 v[36:39], v[108:111], v[132:135], v[36:39]
    ds_read_b64_tr_b16 v[166:167], v171 offset:45568
    v_mfma_f32_16x16x32_bf16 v[80:83], v[172:175], v[108:111], v[80:83]
    ds_read_b64_tr_b16 v[180:181], v189 offset:20480
    v_mfma_f32_16x16x32_bf16 v[84:87], v[176:179], v[108:111], v[84:87]
    ds_read_b64_tr_b16 v[182:183], v189 offset:20992
    v_mfma_f32_16x16x32_bf16 v[40:43], v[120:123], v[112:115], v[40:43]
    ds_read_b64_tr_b16 v[184:185], v191 offset:20480
    v_mfma_f32_16x16x32_bf16 v[44:47], v[124:127], v[112:115], v[44:47]
    ds_read_b64_tr_b16 v[186:187], v191 offset:20992
    v_mfma_f32_16x16x32_bf16 v[48:51], v[112:115], v[128:131], v[48:51]
    ds_read_b128 v[144:147], v169 offset:36864
    v_mfma_f32_16x16x32_bf16 v[52:55], v[112:115], v[132:135], v[52:55]
    ds_read_b128 v[148:151], v169 offset:38912
    v_mfma_f32_16x16x32_bf16 v[88:91], v[172:175], v[112:115], v[88:91]
    v_mfma_f32_16x16x32_bf16 v[92:95], v[176:179], v[112:115], v[92:95]
    v_mfma_f32_16x16x32_bf16 v[56:59], v[120:123], v[116:119], v[56:59]
    v_mfma_f32_16x16x32_bf16 v[60:63], v[124:127], v[116:119], v[60:63]
    v_mfma_f32_16x16x32_bf16 v[64:67], v[116:119], v[128:131], v[64:67]
    v_mfma_f32_16x16x32_bf16 v[68:71], v[116:119], v[132:135], v[68:71]
    v_mfma_f32_16x16x32_bf16 v[96:99], v[172:175], v[116:119], v[96:99]
    v_mfma_f32_16x16x32_bf16 v[100:103], v[176:179], v[116:119], v[100:103]
    s_waitcnt lgkmcnt(0)
    s_barrier
    v_mfma_f32_16x16x32_bf16 v[8:11], v[152:155], v[136:139], v[8:11]
    ds_read_b128 v[104:107], v168 offset:49152
    v_mfma_f32_16x16x32_bf16 v[12:15], v[156:159], v[136:139], v[12:15]
    ds_read_b64_tr_b16 v[120:121], v170 offset:49152
    v_mfma_f32_16x16x32_bf16 v[16:19], v[136:139], v[160:163], v[16:19]
    ds_read_b64_tr_b16 v[122:123], v170 offset:49664
    v_mfma_f32_16x16x32_bf16 v[20:23], v[136:139], v[164:167], v[20:23]
    ds_read_b64_tr_b16 v[124:125], v171 offset:49152
    v_mfma_f32_16x16x32_bf16 v[72:75], v[180:183], v[136:139], v[72:75]
    ds_read_b64_tr_b16 v[126:127], v171 offset:49664
    v_mfma_f32_16x16x32_bf16 v[76:79], v[184:187], v[136:139], v[76:79]
    ds_read_b128 v[108:111], v168 offset:51200
    v_mfma_f32_16x16x32_bf16 v[24:27], v[152:155], v[140:143], v[24:27]
    ds_read_b64_tr_b16 v[128:129], v170 offset:57344
    v_mfma_f32_16x16x32_bf16 v[28:31], v[156:159], v[140:143], v[28:31]
    ds_read_b64_tr_b16 v[130:131], v170 offset:57856
    v_mfma_f32_16x16x32_bf16 v[32:35], v[140:143], v[160:163], v[32:35]
    ds_read_b64_tr_b16 v[132:133], v171 offset:57344
    v_mfma_f32_16x16x32_bf16 v[36:39], v[140:143], v[164:167], v[36:39]
    ds_read_b64_tr_b16 v[134:135], v171 offset:57856
    v_mfma_f32_16x16x32_bf16 v[80:83], v[180:183], v[140:143], v[80:83]
    ds_read_b64_tr_b16 v[172:173], v189 offset:0
    v_mfma_f32_16x16x32_bf16 v[84:87], v[184:187], v[140:143], v[84:87]
    ds_read_b64_tr_b16 v[174:175], v189 offset:512
    v_mfma_f32_16x16x32_bf16 v[40:43], v[152:155], v[144:147], v[40:43]
    ds_read_b64_tr_b16 v[176:177], v191 offset:0
    v_mfma_f32_16x16x32_bf16 v[44:47], v[156:159], v[144:147], v[44:47]
    ds_read_b64_tr_b16 v[178:179], v191 offset:512
    v_mfma_f32_16x16x32_bf16 v[48:51], v[144:147], v[160:163], v[48:51]
    ds_read_b128 v[112:115], v168 offset:53248
    v_mfma_f32_16x16x32_bf16 v[52:55], v[144:147], v[164:167], v[52:55]
    ds_read_b128 v[116:119], v168 offset:55296
    v_mfma_f32_16x16x32_bf16 v[88:91], v[180:183], v[144:147], v[88:91]
    v_mfma_f32_16x16x32_bf16 v[92:95], v[184:187], v[144:147], v[92:95]
    v_mfma_f32_16x16x32_bf16 v[56:59], v[152:155], v[148:151], v[56:59]
    v_mfma_f32_16x16x32_bf16 v[60:63], v[156:159], v[148:151], v[60:63]
    v_mfma_f32_16x16x32_bf16 v[64:67], v[148:151], v[160:163], v[64:67]
    v_mfma_f32_16x16x32_bf16 v[68:71], v[148:151], v[164:167], v[68:71]
    v_mfma_f32_16x16x32_bf16 v[96:99], v[180:183], v[148:151], v[96:99]
    v_mfma_f32_16x16x32_bf16 v[100:103], v[184:187], v[148:151], v[100:103]
    s_waitcnt lgkmcnt(0)
    v_mfma_f32_16x16x32_bf16 v[8:11], v[120:123], v[104:107], v[8:11]
    ds_read_b128 v[136:139], v169 offset:49152
    v_mfma_f32_16x16x32_bf16 v[12:15], v[124:127], v[104:107], v[12:15]
    ds_read_b64_tr_b16 v[152:153], v170 offset:53248
    v_mfma_f32_16x16x32_bf16 v[16:19], v[104:107], v[128:131], v[16:19]
    ds_read_b64_tr_b16 v[154:155], v170 offset:53760
    v_mfma_f32_16x16x32_bf16 v[20:23], v[104:107], v[132:135], v[20:23]
    ds_read_b64_tr_b16 v[156:157], v171 offset:53248
    v_mfma_f32_16x16x32_bf16 v[72:75], v[172:175], v[104:107], v[72:75]
    ds_read_b64_tr_b16 v[158:159], v171 offset:53760
    v_mfma_f32_16x16x32_bf16 v[76:79], v[176:179], v[104:107], v[76:79]
    ds_read_b128 v[140:143], v169 offset:51200
    v_mfma_f32_16x16x32_bf16 v[24:27], v[120:123], v[108:111], v[24:27]
    ds_read_b64_tr_b16 v[160:161], v170 offset:61440
    v_mfma_f32_16x16x32_bf16 v[28:31], v[124:127], v[108:111], v[28:31]
    ds_read_b64_tr_b16 v[162:163], v170 offset:61952
    v_mfma_f32_16x16x32_bf16 v[32:35], v[108:111], v[128:131], v[32:35]
    ds_read_b64_tr_b16 v[164:165], v171 offset:61440
    v_mfma_f32_16x16x32_bf16 v[36:39], v[108:111], v[132:135], v[36:39]
    ds_read_b64_tr_b16 v[166:167], v171 offset:61952
    v_mfma_f32_16x16x32_bf16 v[80:83], v[172:175], v[108:111], v[80:83]
    ds_read_b64_tr_b16 v[180:181], v189 offset:4096
    v_mfma_f32_16x16x32_bf16 v[84:87], v[176:179], v[108:111], v[84:87]
    ds_read_b64_tr_b16 v[182:183], v189 offset:4608
    v_mfma_f32_16x16x32_bf16 v[40:43], v[120:123], v[112:115], v[40:43]
    ds_read_b64_tr_b16 v[184:185], v191 offset:4096
    v_mfma_f32_16x16x32_bf16 v[44:47], v[124:127], v[112:115], v[44:47]
    ds_read_b64_tr_b16 v[186:187], v191 offset:4608
    v_mfma_f32_16x16x32_bf16 v[48:51], v[112:115], v[128:131], v[48:51]
    ds_read_b128 v[144:147], v169 offset:53248
    v_mfma_f32_16x16x32_bf16 v[52:55], v[112:115], v[132:135], v[52:55]
    ds_read_b128 v[148:151], v169 offset:55296
    v_mfma_f32_16x16x32_bf16 v[88:91], v[172:175], v[112:115], v[88:91]
    v_mfma_f32_16x16x32_bf16 v[92:95], v[176:179], v[112:115], v[92:95]
    v_mfma_f32_16x16x32_bf16 v[56:59], v[120:123], v[116:119], v[56:59]
    v_mfma_f32_16x16x32_bf16 v[60:63], v[124:127], v[116:119], v[60:63]
    v_mfma_f32_16x16x32_bf16 v[64:67], v[116:119], v[128:131], v[64:67]
    v_mfma_f32_16x16x32_bf16 v[68:71], v[116:119], v[132:135], v[68:71]
    v_mfma_f32_16x16x32_bf16 v[96:99], v[172:175], v[116:119], v[96:99]
    v_mfma_f32_16x16x32_bf16 v[100:103], v[176:179], v[116:119], v[100:103]
    s_waitcnt lgkmcnt(0)
    s_barrier
    v_mfma_f32_16x16x32_bf16 v[8:11], v[152:155], v[136:139], v[8:11]
    ds_read_b128 v[104:107], v168 offset:0
    v_mfma_f32_16x16x32_bf16 v[12:15], v[156:159], v[136:139], v[12:15]
    ds_read_b64_tr_b16 v[120:121], v170 offset:0
    v_mfma_f32_16x16x32_bf16 v[16:19], v[136:139], v[160:163], v[16:19]
    ds_read_b64_tr_b16 v[122:123], v170 offset:512
    v_mfma_f32_16x16x32_bf16 v[20:23], v[136:139], v[164:167], v[20:23]
    ds_read_b64_tr_b16 v[124:125], v171 offset:0
    v_mfma_f32_16x16x32_bf16 v[72:75], v[180:183], v[136:139], v[72:75]
    ds_read_b64_tr_b16 v[126:127], v171 offset:512
    v_mfma_f32_16x16x32_bf16 v[76:79], v[184:187], v[136:139], v[76:79]
    ds_read_b128 v[108:111], v168 offset:2048
    v_mfma_f32_16x16x32_bf16 v[24:27], v[152:155], v[140:143], v[24:27]
    ds_read_b64_tr_b16 v[128:129], v170 offset:8192
    v_mfma_f32_16x16x32_bf16 v[28:31], v[156:159], v[140:143], v[28:31]
    ds_read_b64_tr_b16 v[130:131], v170 offset:8704
    v_mfma_f32_16x16x32_bf16 v[32:35], v[140:143], v[160:163], v[32:35]
    ds_read_b64_tr_b16 v[132:133], v171 offset:8192
    v_mfma_f32_16x16x32_bf16 v[36:39], v[140:143], v[164:167], v[36:39]
    ds_read_b64_tr_b16 v[134:135], v171 offset:8704
    v_mfma_f32_16x16x32_bf16 v[80:83], v[180:183], v[140:143], v[80:83]
    ds_read_b64_tr_b16 v[172:173], v189 offset:8192
    v_mfma_f32_16x16x32_bf16 v[84:87], v[184:187], v[140:143], v[84:87]
    ds_read_b64_tr_b16 v[174:175], v189 offset:8704
    v_mfma_f32_16x16x32_bf16 v[40:43], v[152:155], v[144:147], v[40:43]
    ds_read_b64_tr_b16 v[176:177], v191 offset:8192
    v_mfma_f32_16x16x32_bf16 v[44:47], v[156:159], v[144:147], v[44:47]
    ds_read_b64_tr_b16 v[178:179], v191 offset:8704
    v_mfma_f32_16x16x32_bf16 v[48:51], v[144:147], v[160:163], v[48:51]
    ds_read_b128 v[112:115], v168 offset:4096
    v_mfma_f32_16x16x32_bf16 v[52:55], v[144:147], v[164:167], v[52:55]
    ds_read_b128 v[116:119], v168 offset:6144
    v_mfma_f32_16x16x32_bf16 v[88:91], v[180:183], v[144:147], v[88:91]
    v_mfma_f32_16x16x32_bf16 v[92:95], v[184:187], v[144:147], v[92:95]
    v_mfma_f32_16x16x32_bf16 v[56:59], v[152:155], v[148:151], v[56:59]
    v_mfma_f32_16x16x32_bf16 v[60:63], v[156:159], v[148:151], v[60:63]
    v_mfma_f32_16x16x32_bf16 v[64:67], v[148:151], v[160:163], v[64:67]
    v_mfma_f32_16x16x32_bf16 v[68:71], v[148:151], v[164:167], v[68:71]
    v_mfma_f32_16x16x32_bf16 v[96:99], v[180:183], v[148:151], v[96:99]
    v_mfma_f32_16x16x32_bf16 v[100:103], v[184:187], v[148:151], v[100:103]
    s_waitcnt lgkmcnt(0)
    v_mfma_f32_16x16x32_bf16 v[8:11], v[120:123], v[104:107], v[8:11]
    ds_read_b128 v[136:139], v169 offset:0
    v_mfma_f32_16x16x32_bf16 v[12:15], v[124:127], v[104:107], v[12:15]
    ds_read_b64_tr_b16 v[152:153], v170 offset:4096
    v_mfma_f32_16x16x32_bf16 v[16:19], v[104:107], v[128:131], v[16:19]
    ds_read_b64_tr_b16 v[154:155], v170 offset:4608
    v_mfma_f32_16x16x32_bf16 v[20:23], v[104:107], v[132:135], v[20:23]
    ds_read_b64_tr_b16 v[156:157], v171 offset:4096
    v_mfma_f32_16x16x32_bf16 v[72:75], v[172:175], v[104:107], v[72:75]
    ds_read_b64_tr_b16 v[158:159], v171 offset:4608
    v_mfma_f32_16x16x32_bf16 v[76:79], v[176:179], v[104:107], v[76:79]
    ds_read_b128 v[140:143], v169 offset:2048
    v_mfma_f32_16x16x32_bf16 v[24:27], v[120:123], v[108:111], v[24:27]
    ds_read_b64_tr_b16 v[160:161], v170 offset:12288
    v_mfma_f32_16x16x32_bf16 v[28:31], v[124:127], v[108:111], v[28:31]
    ds_read_b64_tr_b16 v[162:163], v170 offset:12800
    v_mfma_f32_16x16x32_bf16 v[32:35], v[108:111], v[128:131], v[32:35]
    ds_read_b64_tr_b16 v[164:165], v171 offset:12288
    v_mfma_f32_16x16x32_bf16 v[36:39], v[108:111], v[132:135], v[36:39]
    ds_read_b64_tr_b16 v[166:167], v171 offset:12800
    v_mfma_f32_16x16x32_bf16 v[80:83], v[172:175], v[108:111], v[80:83]
    ds_read_b64_tr_b16 v[180:181], v189 offset:12288
    v_mfma_f32_16x16x32_bf16 v[84:87], v[176:179], v[108:111], v[84:87]
    ds_read_b64_tr_b16 v[182:183], v189 offset:12800
    v_mfma_f32_16x16x32_bf16 v[40:43], v[120:123], v[112:115], v[40:43]
    ds_read_b64_tr_b16 v[184:185], v191 offset:12288
    v_mfma_f32_16x16x32_bf16 v[44:47], v[124:127], v[112:115], v[44:47]
    ds_read_b64_tr_b16 v[186:187], v191 offset:12800
    v_mfma_f32_16x16x32_bf16 v[48:51], v[112:115], v[128:131], v[48:51]
    ds_read_b128 v[144:147], v169 offset:4096
    v_mfma_f32_16x16x32_bf16 v[52:55], v[112:115], v[132:135], v[52:55]
    ds_read_b128 v[148:151], v169 offset:6144
    v_mfma_f32_16x16x32_bf16 v[88:91], v[172:175], v[112:115], v[88:91]
    v_mfma_f32_16x16x32_bf16 v[92:95], v[176:179], v[112:115], v[92:95]
    v_mfma_f32_16x16x32_bf16 v[56:59], v[120:123], v[116:119], v[56:59]
    v_mfma_f32_16x16x32_bf16 v[60:63], v[124:127], v[116:119], v[60:63]
    v_mfma_f32_16x16x32_bf16 v[64:67], v[116:119], v[128:131], v[64:67]
    v_mfma_f32_16x16x32_bf16 v[68:71], v[116:119], v[132:135], v[68:71]
    v_mfma_f32_16x16x32_bf16 v[96:99], v[172:175], v[116:119], v[96:99]
    v_mfma_f32_16x16x32_bf16 v[100:103], v[176:179], v[116:119], v[100:103]
    s_waitcnt lgkmcnt(0)
    s_barrier
    v_mfma_f32_16x16x32_bf16 v[8:11], v[152:155], v[136:139], v[8:11]
    ds_read_b128 v[104:107], v168 offset:16384
    v_mfma_f32_16x16x32_bf16 v[12:15], v[156:159], v[136:139], v[12:15]
    ds_read_b64_tr_b16 v[120:121], v170 offset:16384
    v_mfma_f32_16x16x32_bf16 v[16:19], v[136:139], v[160:163], v[16:19]
    ds_read_b64_tr_b16 v[122:123], v170 offset:16896
    v_mfma_f32_16x16x32_bf16 v[20:23], v[136:139], v[164:167], v[20:23]
    ds_read_b64_tr_b16 v[124:125], v171 offset:16384
    v_mfma_f32_16x16x32_bf16 v[72:75], v[180:183], v[136:139], v[72:75]
    ds_read_b64_tr_b16 v[126:127], v171 offset:16896
    v_mfma_f32_16x16x32_bf16 v[76:79], v[184:187], v[136:139], v[76:79]
    ds_read_b128 v[108:111], v168 offset:18432
    v_mfma_f32_16x16x32_bf16 v[24:27], v[152:155], v[140:143], v[24:27]
    ds_read_b64_tr_b16 v[128:129], v170 offset:24576
    v_mfma_f32_16x16x32_bf16 v[28:31], v[156:159], v[140:143], v[28:31]
    ds_read_b64_tr_b16 v[130:131], v170 offset:25088
    v_mfma_f32_16x16x32_bf16 v[32:35], v[140:143], v[160:163], v[32:35]
    ds_read_b64_tr_b16 v[132:133], v171 offset:24576
    v_mfma_f32_16x16x32_bf16 v[36:39], v[140:143], v[164:167], v[36:39]
    ds_read_b64_tr_b16 v[134:135], v171 offset:25088
    v_mfma_f32_16x16x32_bf16 v[80:83], v[180:183], v[140:143], v[80:83]
    ds_read_b64_tr_b16 v[172:173], v189 offset:16384
    v_mfma_f32_16x16x32_bf16 v[84:87], v[184:187], v[140:143], v[84:87]
    ds_read_b64_tr_b16 v[174:175], v189 offset:16896
    v_mfma_f32_16x16x32_bf16 v[40:43], v[152:155], v[144:147], v[40:43]
    ds_read_b64_tr_b16 v[176:177], v191 offset:16384
    v_mfma_f32_16x16x32_bf16 v[44:47], v[156:159], v[144:147], v[44:47]
    ds_read_b64_tr_b16 v[178:179], v191 offset:16896
    v_mfma_f32_16x16x32_bf16 v[48:51], v[144:147], v[160:163], v[48:51]
    ds_read_b128 v[112:115], v168 offset:20480
    v_mfma_f32_16x16x32_bf16 v[52:55], v[144:147], v[164:167], v[52:55]
    ds_read_b128 v[116:119], v168 offset:22528
    v_mfma_f32_16x16x32_bf16 v[88:91], v[180:183], v[144:147], v[88:91]
    v_mfma_f32_16x16x32_bf16 v[92:95], v[184:187], v[144:147], v[92:95]
    v_mfma_f32_16x16x32_bf16 v[56:59], v[152:155], v[148:151], v[56:59]
    v_mfma_f32_16x16x32_bf16 v[60:63], v[156:159], v[148:151], v[60:63]
    v_mfma_f32_16x16x32_bf16 v[64:67], v[148:151], v[160:163], v[64:67]
    v_mfma_f32_16x16x32_bf16 v[68:71], v[148:151], v[164:167], v[68:71]
    v_mfma_f32_16x16x32_bf16 v[96:99], v[180:183], v[148:151], v[96:99]
    v_mfma_f32_16x16x32_bf16 v[100:103], v[184:187], v[148:151], v[100:103]
    s_waitcnt lgkmcnt(0)
    v_mfma_f32_16x16x32_bf16 v[8:11], v[120:123], v[104:107], v[8:11]
    ds_read_b128 v[136:139], v169 offset:16384
    v_mfma_f32_16x16x32_bf16 v[12:15], v[124:127], v[104:107], v[12:15]
    ds_read_b64_tr_b16 v[152:153], v170 offset:20480
    v_mfma_f32_16x16x32_bf16 v[16:19], v[104:107], v[128:131], v[16:19]
    ds_read_b64_tr_b16 v[154:155], v170 offset:20992
    v_mfma_f32_16x16x32_bf16 v[20:23], v[104:107], v[132:135], v[20:23]
    ds_read_b64_tr_b16 v[156:157], v171 offset:20480
    v_mfma_f32_16x16x32_bf16 v[72:75], v[172:175], v[104:107], v[72:75]
    ds_read_b64_tr_b16 v[158:159], v171 offset:20992
    v_mfma_f32_16x16x32_bf16 v[76:79], v[176:179], v[104:107], v[76:79]
    ds_read_b128 v[140:143], v169 offset:18432
    v_mfma_f32_16x16x32_bf16 v[24:27], v[120:123], v[108:111], v[24:27]
    ds_read_b64_tr_b16 v[160:161], v170 offset:28672
    v_mfma_f32_16x16x32_bf16 v[28:31], v[124:127], v[108:111], v[28:31]
    ds_read_b64_tr_b16 v[162:163], v170 offset:29184
    v_mfma_f32_16x16x32_bf16 v[32:35], v[108:111], v[128:131], v[32:35]
    ds_read_b64_tr_b16 v[164:165], v171 offset:28672
    v_mfma_f32_16x16x32_bf16 v[36:39], v[108:111], v[132:135], v[36:39]
    ds_read_b64_tr_b16 v[166:167], v171 offset:29184
    v_mfma_f32_16x16x32_bf16 v[80:83], v[172:175], v[108:111], v[80:83]
    ds_read_b64_tr_b16 v[180:181], v189 offset:20480
    v_mfma_f32_16x16x32_bf16 v[84:87], v[176:179], v[108:111], v[84:87]
    ds_read_b64_tr_b16 v[182:183], v189 offset:20992
    v_mfma_f32_16x16x32_bf16 v[40:43], v[120:123], v[112:115], v[40:43]
    ds_read_b64_tr_b16 v[184:185], v191 offset:20480
    v_mfma_f32_16x16x32_bf16 v[44:47], v[124:127], v[112:115], v[44:47]
    ds_read_b64_tr_b16 v[186:187], v191 offset:20992
    v_mfma_f32_16x16x32_bf16 v[48:51], v[112:115], v[128:131], v[48:51]
    ds_read_b128 v[144:147], v169 offset:20480
    v_mfma_f32_16x16x32_bf16 v[52:55], v[112:115], v[132:135], v[52:55]
    ds_read_b128 v[148:151], v169 offset:22528
    v_mfma_f32_16x16x32_bf16 v[88:91], v[172:175], v[112:115], v[88:91]
    v_mfma_f32_16x16x32_bf16 v[92:95], v[176:179], v[112:115], v[92:95]
    v_mfma_f32_16x16x32_bf16 v[56:59], v[120:123], v[116:119], v[56:59]
    v_mfma_f32_16x16x32_bf16 v[60:63], v[124:127], v[116:119], v[60:63]
    v_mfma_f32_16x16x32_bf16 v[64:67], v[116:119], v[128:131], v[64:67]
    v_mfma_f32_16x16x32_bf16 v[68:71], v[116:119], v[132:135], v[68:71]
    v_mfma_f32_16x16x32_bf16 v[96:99], v[172:175], v[116:119], v[96:99]
    v_mfma_f32_16x16x32_bf16 v[100:103], v[176:179], v[116:119], v[100:103]
    s_waitcnt lgkmcnt(0)
    s_barrier
    v_mfma_f32_16x16x32_bf16 v[8:11], v[152:155], v[136:139], v[8:11]
    ds_read_b128 v[104:107], v168 offset:32768
    v_mfma_f32_16x16x32_bf16 v[12:15], v[156:159], v[136:139], v[12:15]
    ds_read_b64_tr_b16 v[120:121], v170 offset:32768
    v_mfma_f32_16x16x32_bf16 v[16:19], v[136:139], v[160:163], v[16:19]
    ds_read_b64_tr_b16 v[122:123], v170 offset:33280
    v_mfma_f32_16x16x32_bf16 v[20:23], v[136:139], v[164:167], v[20:23]
    ds_read_b64_tr_b16 v[124:125], v171 offset:32768
    v_mfma_f32_16x16x32_bf16 v[72:75], v[180:183], v[136:139], v[72:75]
    ds_read_b64_tr_b16 v[126:127], v171 offset:33280
    v_mfma_f32_16x16x32_bf16 v[76:79], v[184:187], v[136:139], v[76:79]
    ds_read_b128 v[108:111], v168 offset:34816
    v_mfma_f32_16x16x32_bf16 v[24:27], v[152:155], v[140:143], v[24:27]
    ds_read_b64_tr_b16 v[128:129], v170 offset:40960
    v_mfma_f32_16x16x32_bf16 v[28:31], v[156:159], v[140:143], v[28:31]
    ds_read_b64_tr_b16 v[130:131], v170 offset:41472
    v_mfma_f32_16x16x32_bf16 v[32:35], v[140:143], v[160:163], v[32:35]
    ds_read_b64_tr_b16 v[132:133], v171 offset:40960
    v_mfma_f32_16x16x32_bf16 v[36:39], v[140:143], v[164:167], v[36:39]
    ds_read_b64_tr_b16 v[134:135], v171 offset:41472
    v_mfma_f32_16x16x32_bf16 v[80:83], v[180:183], v[140:143], v[80:83]
    ds_read_b64_tr_b16 v[172:173], v189 offset:0
    v_mfma_f32_16x16x32_bf16 v[84:87], v[184:187], v[140:143], v[84:87]
    ds_read_b64_tr_b16 v[174:175], v189 offset:512
    v_mfma_f32_16x16x32_bf16 v[40:43], v[152:155], v[144:147], v[40:43]
    ds_read_b64_tr_b16 v[176:177], v191 offset:0
    v_mfma_f32_16x16x32_bf16 v[44:47], v[156:159], v[144:147], v[44:47]
    ds_read_b64_tr_b16 v[178:179], v191 offset:512
    v_mfma_f32_16x16x32_bf16 v[48:51], v[144:147], v[160:163], v[48:51]
    ds_read_b128 v[112:115], v168 offset:36864
    v_mfma_f32_16x16x32_bf16 v[52:55], v[144:147], v[164:167], v[52:55]
    ds_read_b128 v[116:119], v168 offset:38912
    v_mfma_f32_16x16x32_bf16 v[88:91], v[180:183], v[144:147], v[88:91]
    v_mfma_f32_16x16x32_bf16 v[92:95], v[184:187], v[144:147], v[92:95]
    v_mfma_f32_16x16x32_bf16 v[56:59], v[152:155], v[148:151], v[56:59]
    v_mfma_f32_16x16x32_bf16 v[60:63], v[156:159], v[148:151], v[60:63]
    v_mfma_f32_16x16x32_bf16 v[64:67], v[148:151], v[160:163], v[64:67]
    v_mfma_f32_16x16x32_bf16 v[68:71], v[148:151], v[164:167], v[68:71]
    v_mfma_f32_16x16x32_bf16 v[96:99], v[180:183], v[148:151], v[96:99]
    v_mfma_f32_16x16x32_bf16 v[100:103], v[184:187], v[148:151], v[100:103]
    s_waitcnt lgkmcnt(0)
    v_mfma_f32_16x16x32_bf16 v[8:11], v[120:123], v[104:107], v[8:11]
    ds_read_b128 v[136:139], v169 offset:32768
    v_mfma_f32_16x16x32_bf16 v[12:15], v[124:127], v[104:107], v[12:15]
    ds_read_b64_tr_b16 v[152:153], v170 offset:36864
    v_mfma_f32_16x16x32_bf16 v[16:19], v[104:107], v[128:131], v[16:19]
    ds_read_b64_tr_b16 v[154:155], v170 offset:37376
    v_mfma_f32_16x16x32_bf16 v[20:23], v[104:107], v[132:135], v[20:23]
    ds_read_b64_tr_b16 v[156:157], v171 offset:36864
    v_mfma_f32_16x16x32_bf16 v[72:75], v[172:175], v[104:107], v[72:75]
    ds_read_b64_tr_b16 v[158:159], v171 offset:37376
    v_mfma_f32_16x16x32_bf16 v[76:79], v[176:179], v[104:107], v[76:79]
    ds_read_b128 v[140:143], v169 offset:34816
    v_mfma_f32_16x16x32_bf16 v[24:27], v[120:123], v[108:111], v[24:27]
    ds_read_b64_tr_b16 v[160:161], v170 offset:45056
    v_mfma_f32_16x16x32_bf16 v[28:31], v[124:127], v[108:111], v[28:31]
    ds_read_b64_tr_b16 v[162:163], v170 offset:45568
    v_mfma_f32_16x16x32_bf16 v[32:35], v[108:111], v[128:131], v[32:35]
    ds_read_b64_tr_b16 v[164:165], v171 offset:45056
    v_mfma_f32_16x16x32_bf16 v[36:39], v[108:111], v[132:135], v[36:39]
    ds_read_b64_tr_b16 v[166:167], v171 offset:45568
    v_mfma_f32_16x16x32_bf16 v[80:83], v[172:175], v[108:111], v[80:83]
    ds_read_b64_tr_b16 v[180:181], v189 offset:4096
    v_mfma_f32_16x16x32_bf16 v[84:87], v[176:179], v[108:111], v[84:87]
    ds_read_b64_tr_b16 v[182:183], v189 offset:4608
    v_mfma_f32_16x16x32_bf16 v[40:43], v[120:123], v[112:115], v[40:43]
    ds_read_b64_tr_b16 v[184:185], v191 offset:4096
    v_mfma_f32_16x16x32_bf16 v[44:47], v[124:127], v[112:115], v[44:47]
    ds_read_b64_tr_b16 v[186:187], v191 offset:4608
    v_mfma_f32_16x16x32_bf16 v[48:51], v[112:115], v[128:131], v[48:51]
    ds_read_b128 v[144:147], v169 offset:36864
    v_mfma_f32_16x16x32_bf16 v[52:55], v[112:115], v[132:135], v[52:55]
    ds_read_b128 v[148:151], v169 offset:38912
    v_mfma_f32_16x16x32_bf16 v[88:91], v[172:175], v[112:115], v[88:91]
    v_mfma_f32_16x16x32_bf16 v[92:95], v[176:179], v[112:115], v[92:95]
    v_mfma_f32_16x16x32_bf16 v[56:59], v[120:123], v[116:119], v[56:59]
    v_mfma_f32_16x16x32_bf16 v[60:63], v[124:127], v[116:119], v[60:63]
    v_mfma_f32_16x16x32_bf16 v[64:67], v[116:119], v[128:131], v[64:67]
    v_mfma_f32_16x16x32_bf16 v[68:71], v[116:119], v[132:135], v[68:71]
    v_mfma_f32_16x16x32_bf16 v[96:99], v[172:175], v[116:119], v[96:99]
    v_mfma_f32_16x16x32_bf16 v[100:103], v[176:179], v[116:119], v[100:103]
    s_waitcnt lgkmcnt(0)
    s_barrier
    v_mfma_f32_16x16x32_bf16 v[8:11], v[152:155], v[136:139], v[8:11]
    ds_read_b128 v[104:107], v168 offset:49152
    v_mfma_f32_16x16x32_bf16 v[12:15], v[156:159], v[136:139], v[12:15]
    ds_read_b64_tr_b16 v[120:121], v170 offset:49152
    v_mfma_f32_16x16x32_bf16 v[16:19], v[136:139], v[160:163], v[16:19]
    ds_read_b64_tr_b16 v[122:123], v170 offset:49664
    v_mfma_f32_16x16x32_bf16 v[20:23], v[136:139], v[164:167], v[20:23]
    ds_read_b64_tr_b16 v[124:125], v171 offset:49152
    v_mfma_f32_16x16x32_bf16 v[72:75], v[180:183], v[136:139], v[72:75]
    ds_read_b64_tr_b16 v[126:127], v171 offset:49664
    v_mfma_f32_16x16x32_bf16 v[76:79], v[184:187], v[136:139], v[76:79]
    ds_read_b128 v[108:111], v168 offset:51200
    v_mfma_f32_16x16x32_bf16 v[24:27], v[152:155], v[140:143], v[24:27]
    ds_read_b64_tr_b16 v[128:129], v170 offset:57344
    v_mfma_f32_16x16x32_bf16 v[28:31], v[156:159], v[140:143], v[28:31]
    ds_read_b64_tr_b16 v[130:131], v170 offset:57856
    v_mfma_f32_16x16x32_bf16 v[32:35], v[140:143], v[160:163], v[32:35]
    ds_read_b64_tr_b16 v[132:133], v171 offset:57344
    v_mfma_f32_16x16x32_bf16 v[36:39], v[140:143], v[164:167], v[36:39]
    ds_read_b64_tr_b16 v[134:135], v171 offset:57856
    v_mfma_f32_16x16x32_bf16 v[80:83], v[180:183], v[140:143], v[80:83]
    ds_read_b64_tr_b16 v[172:173], v189 offset:8192
    v_mfma_f32_16x16x32_bf16 v[84:87], v[184:187], v[140:143], v[84:87]
    ds_read_b64_tr_b16 v[174:175], v189 offset:8704
    v_mfma_f32_16x16x32_bf16 v[40:43], v[152:155], v[144:147], v[40:43]
    ds_read_b64_tr_b16 v[176:177], v191 offset:8192
    v_mfma_f32_16x16x32_bf16 v[44:47], v[156:159], v[144:147], v[44:47]
    ds_read_b64_tr_b16 v[178:179], v191 offset:8704
    v_mfma_f32_16x16x32_bf16 v[48:51], v[144:147], v[160:163], v[48:51]
    ds_read_b128 v[112:115], v168 offset:53248
    v_mfma_f32_16x16x32_bf16 v[52:55], v[144:147], v[164:167], v[52:55]
    ds_read_b128 v[116:119], v168 offset:55296
    v_mfma_f32_16x16x32_bf16 v[88:91], v[180:183], v[144:147], v[88:91]
    v_mfma_f32_16x16x32_bf16 v[92:95], v[184:187], v[144:147], v[92:95]
    v_mfma_f32_16x16x32_bf16 v[56:59], v[152:155], v[148:151], v[56:59]
    v_mfma_f32_16x16x32_bf16 v[60:63], v[156:159], v[148:151], v[60:63]
    v_mfma_f32_16x16x32_bf16 v[64:67], v[148:151], v[160:163], v[64:67]
    v_mfma_f32_16x16x32_bf16 v[68:71], v[148:151], v[164:167], v[68:71]
    v_mfma_f32_16x16x32_bf16 v[96:99], v[180:183], v[148:151], v[96:99]
    v_mfma_f32_16x16x32_bf16 v[100:103], v[184:187], v[148:151], v[100:103]
    s_waitcnt lgkmcnt(0)
    v_mfma_f32_16x16x32_bf16 v[8:11], v[120:123], v[104:107], v[8:11]
    ds_read_b128 v[136:139], v169 offset:49152
    v_mfma_f32_16x16x32_bf16 v[12:15], v[124:127], v[104:107], v[12:15]
    ds_read_b64_tr_b16 v[152:153], v170 offset:53248
    v_mfma_f32_16x16x32_bf16 v[16:19], v[104:107], v[128:131], v[16:19]
    ds_read_b64_tr_b16 v[154:155], v170 offset:53760
    v_mfma_f32_16x16x32_bf16 v[20:23], v[104:107], v[132:135], v[20:23]
    ds_read_b64_tr_b16 v[156:157], v171 offset:53248
    v_mfma_f32_16x16x32_bf16 v[72:75], v[172:175], v[104:107], v[72:75]
    ds_read_b64_tr_b16 v[158:159], v171 offset:53760
    v_mfma_f32_16x16x32_bf16 v[76:79], v[176:179], v[104:107], v[76:79]
    ds_read_b128 v[140:143], v169 offset:51200
    v_mfma_f32_16x16x32_bf16 v[24:27], v[120:123], v[108:111], v[24:27]
    ds_read_b64_tr_b16 v[160:161], v170 offset:61440
    v_mfma_f32_16x16x32_bf16 v[28:31], v[124:127], v[108:111], v[28:31]
    ds_read_b64_tr_b16 v[162:163], v170 offset:61952
    v_mfma_f32_16x16x32_bf16 v[32:35], v[108:111], v[128:131], v[32:35]
    ds_read_b64_tr_b16 v[164:165], v171 offset:61440
    v_mfma_f32_16x16x32_bf16 v[36:39], v[108:111], v[132:135], v[36:39]
    ds_read_b64_tr_b16 v[166:167], v171 offset:61952
    v_mfma_f32_16x16x32_bf16 v[80:83], v[172:175], v[108:111], v[80:83]
    ds_read_b64_tr_b16 v[180:181], v189 offset:12288
    v_mfma_f32_16x16x32_bf16 v[84:87], v[176:179], v[108:111], v[84:87]
    ds_read_b64_tr_b16 v[182:183], v189 offset:12800
    v_mfma_f32_16x16x32_bf16 v[40:43], v[120:123], v[112:115], v[40:43]
    ds_read_b64_tr_b16 v[184:185], v191 offset:12288
    v_mfma_f32_16x16x32_bf16 v[44:47], v[124:127], v[112:115], v[44:47]
    ds_read_b64_tr_b16 v[186:187], v191 offset:12800
    v_mfma_f32_16x16x32_bf16 v[48:51], v[112:115], v[128:131], v[48:51]
    ds_read_b128 v[144:147], v169 offset:53248
    v_mfma_f32_16x16x32_bf16 v[52:55], v[112:115], v[132:135], v[52:55]
    ds_read_b128 v[148:151], v169 offset:55296
    v_mfma_f32_16x16x32_bf16 v[88:91], v[172:175], v[112:115], v[88:91]
    v_mfma_f32_16x16x32_bf16 v[92:95], v[176:179], v[112:115], v[92:95]
    v_mfma_f32_16x16x32_bf16 v[56:59], v[120:123], v[116:119], v[56:59]
    v_mfma_f32_16x16x32_bf16 v[60:63], v[124:127], v[116:119], v[60:63]
    v_mfma_f32_16x16x32_bf16 v[64:67], v[116:119], v[128:131], v[64:67]
    v_mfma_f32_16x16x32_bf16 v[68:71], v[116:119], v[132:135], v[68:71]
    v_mfma_f32_16x16x32_bf16 v[96:99], v[172:175], v[116:119], v[96:99]
    v_mfma_f32_16x16x32_bf16 v[100:103], v[176:179], v[116:119], v[100:103]
    s_waitcnt lgkmcnt(0)
    s_barrier
    v_mfma_f32_16x16x32_bf16 v[8:11], v[152:155], v[136:139], v[8:11]
    ds_read_b128 v[104:107], v168 offset:0
    v_mfma_f32_16x16x32_bf16 v[12:15], v[156:159], v[136:139], v[12:15]
    ds_read_b64_tr_b16 v[120:121], v170 offset:0
    v_mfma_f32_16x16x32_bf16 v[16:19], v[136:139], v[160:163], v[16:19]
    ds_read_b64_tr_b16 v[122:123], v170 offset:512
    v_mfma_f32_16x16x32_bf16 v[20:23], v[136:139], v[164:167], v[20:23]
    ds_read_b64_tr_b16 v[124:125], v171 offset:0
    v_mfma_f32_16x16x32_bf16 v[72:75], v[180:183], v[136:139], v[72:75]
    ds_read_b64_tr_b16 v[126:127], v171 offset:512
    v_mfma_f32_16x16x32_bf16 v[76:79], v[184:187], v[136:139], v[76:79]
    ds_read_b128 v[108:111], v168 offset:2048
    v_mfma_f32_16x16x32_bf16 v[24:27], v[152:155], v[140:143], v[24:27]
    ds_read_b64_tr_b16 v[128:129], v170 offset:8192
    v_mfma_f32_16x16x32_bf16 v[28:31], v[156:159], v[140:143], v[28:31]
    ds_read_b64_tr_b16 v[130:131], v170 offset:8704
    v_mfma_f32_16x16x32_bf16 v[32:35], v[140:143], v[160:163], v[32:35]
    ds_read_b64_tr_b16 v[132:133], v171 offset:8192
    v_mfma_f32_16x16x32_bf16 v[36:39], v[140:143], v[164:167], v[36:39]
    ds_read_b64_tr_b16 v[134:135], v171 offset:8704
    v_mfma_f32_16x16x32_bf16 v[80:83], v[180:183], v[140:143], v[80:83]
    ds_read_b64_tr_b16 v[172:173], v189 offset:16384
    v_mfma_f32_16x16x32_bf16 v[84:87], v[184:187], v[140:143], v[84:87]
    ds_read_b64_tr_b16 v[174:175], v189 offset:16896
    v_mfma_f32_16x16x32_bf16 v[40:43], v[152:155], v[144:147], v[40:43]
    ds_read_b64_tr_b16 v[176:177], v191 offset:16384
    v_mfma_f32_16x16x32_bf16 v[44:47], v[156:159], v[144:147], v[44:47]
    ds_read_b64_tr_b16 v[178:179], v191 offset:16896
    v_mfma_f32_16x16x32_bf16 v[48:51], v[144:147], v[160:163], v[48:51]
    ds_read_b128 v[112:115], v168 offset:4096
    v_mfma_f32_16x16x32_bf16 v[52:55], v[144:147], v[164:167], v[52:55]
    ds_read_b128 v[116:119], v168 offset:6144
    v_mfma_f32_16x16x32_bf16 v[88:91], v[180:183], v[144:147], v[88:91]
    v_mfma_f32_16x16x32_bf16 v[92:95], v[184:187], v[144:147], v[92:95]
    v_mfma_f32_16x16x32_bf16 v[56:59], v[152:155], v[148:151], v[56:59]
    v_mfma_f32_16x16x32_bf16 v[60:63], v[156:159], v[148:151], v[60:63]
    v_mfma_f32_16x16x32_bf16 v[64:67], v[148:151], v[160:163], v[64:67]
    v_mfma_f32_16x16x32_bf16 v[68:71], v[148:151], v[164:167], v[68:71]
    v_mfma_f32_16x16x32_bf16 v[96:99], v[180:183], v[148:151], v[96:99]
    v_mfma_f32_16x16x32_bf16 v[100:103], v[184:187], v[148:151], v[100:103]
    s_waitcnt lgkmcnt(0)
    v_mfma_f32_16x16x32_bf16 v[8:11], v[120:123], v[104:107], v[8:11]
    ds_read_b128 v[136:139], v169 offset:0
    v_mfma_f32_16x16x32_bf16 v[12:15], v[124:127], v[104:107], v[12:15]
    ds_read_b64_tr_b16 v[152:153], v170 offset:4096
    v_mfma_f32_16x16x32_bf16 v[16:19], v[104:107], v[128:131], v[16:19]
    ds_read_b64_tr_b16 v[154:155], v170 offset:4608
    v_mfma_f32_16x16x32_bf16 v[20:23], v[104:107], v[132:135], v[20:23]
    ds_read_b64_tr_b16 v[156:157], v171 offset:4096
    v_mfma_f32_16x16x32_bf16 v[72:75], v[172:175], v[104:107], v[72:75]
    ds_read_b64_tr_b16 v[158:159], v171 offset:4608
    v_mfma_f32_16x16x32_bf16 v[76:79], v[176:179], v[104:107], v[76:79]
    ds_read_b128 v[140:143], v169 offset:2048
    v_mfma_f32_16x16x32_bf16 v[24:27], v[120:123], v[108:111], v[24:27]
    ds_read_b64_tr_b16 v[160:161], v170 offset:12288
    v_mfma_f32_16x16x32_bf16 v[28:31], v[124:127], v[108:111], v[28:31]
    ds_read_b64_tr_b16 v[162:163], v170 offset:12800
    v_mfma_f32_16x16x32_bf16 v[32:35], v[108:111], v[128:131], v[32:35]
    ds_read_b64_tr_b16 v[164:165], v171 offset:12288
    v_mfma_f32_16x16x32_bf16 v[36:39], v[108:111], v[132:135], v[36:39]
    ds_read_b64_tr_b16 v[166:167], v171 offset:12800
    v_mfma_f32_16x16x32_bf16 v[80:83], v[172:175], v[108:111], v[80:83]
    ds_read_b64_tr_b16 v[180:181], v189 offset:20480
    v_mfma_f32_16x16x32_bf16 v[84:87], v[176:179], v[108:111], v[84:87]
    ds_read_b64_tr_b16 v[182:183], v189 offset:20992
    v_mfma_f32_16x16x32_bf16 v[40:43], v[120:123], v[112:115], v[40:43]
    ds_read_b64_tr_b16 v[184:185], v191 offset:20480
    v_mfma_f32_16x16x32_bf16 v[44:47], v[124:127], v[112:115], v[44:47]
    ds_read_b64_tr_b16 v[186:187], v191 offset:20992
    v_mfma_f32_16x16x32_bf16 v[48:51], v[112:115], v[128:131], v[48:51]
    ds_read_b128 v[144:147], v169 offset:4096
    v_mfma_f32_16x16x32_bf16 v[52:55], v[112:115], v[132:135], v[52:55]
    ds_read_b128 v[148:151], v169 offset:6144
    v_mfma_f32_16x16x32_bf16 v[88:91], v[172:175], v[112:115], v[88:91]
    v_mfma_f32_16x16x32_bf16 v[92:95], v[176:179], v[112:115], v[92:95]
    v_mfma_f32_16x16x32_bf16 v[56:59], v[120:123], v[116:119], v[56:59]
    v_mfma_f32_16x16x32_bf16 v[60:63], v[124:127], v[116:119], v[60:63]
    v_mfma_f32_16x16x32_bf16 v[64:67], v[116:119], v[128:131], v[64:67]
    v_mfma_f32_16x16x32_bf16 v[68:71], v[116:119], v[132:135], v[68:71]
    v_mfma_f32_16x16x32_bf16 v[96:99], v[172:175], v[116:119], v[96:99]
    v_mfma_f32_16x16x32_bf16 v[100:103], v[176:179], v[116:119], v[100:103]
    s_waitcnt lgkmcnt(0)
    s_barrier
    v_mfma_f32_16x16x32_bf16 v[8:11], v[152:155], v[136:139], v[8:11]
    ds_read_b128 v[104:107], v168 offset:16384
    v_mfma_f32_16x16x32_bf16 v[12:15], v[156:159], v[136:139], v[12:15]
    ds_read_b64_tr_b16 v[120:121], v170 offset:16384
    v_mfma_f32_16x16x32_bf16 v[16:19], v[136:139], v[160:163], v[16:19]
    ds_read_b64_tr_b16 v[122:123], v170 offset:16896
    v_mfma_f32_16x16x32_bf16 v[20:23], v[136:139], v[164:167], v[20:23]
    ds_read_b64_tr_b16 v[124:125], v171 offset:16384
    v_mfma_f32_16x16x32_bf16 v[72:75], v[180:183], v[136:139], v[72:75]
    ds_read_b64_tr_b16 v[126:127], v171 offset:16896
    v_mfma_f32_16x16x32_bf16 v[76:79], v[184:187], v[136:139], v[76:79]
    ds_read_b128 v[108:111], v168 offset:18432
    v_mfma_f32_16x16x32_bf16 v[24:27], v[152:155], v[140:143], v[24:27]
    ds_read_b64_tr_b16 v[128:129], v170 offset:24576
    v_mfma_f32_16x16x32_bf16 v[28:31], v[156:159], v[140:143], v[28:31]
    ds_read_b64_tr_b16 v[130:131], v170 offset:25088
    v_mfma_f32_16x16x32_bf16 v[32:35], v[140:143], v[160:163], v[32:35]
    ds_read_b64_tr_b16 v[132:133], v171 offset:24576
    v_mfma_f32_16x16x32_bf16 v[36:39], v[140:143], v[164:167], v[36:39]
    ds_read_b64_tr_b16 v[134:135], v171 offset:25088
    v_mfma_f32_16x16x32_bf16 v[80:83], v[180:183], v[140:143], v[80:83]
    ds_read_b64_tr_b16 v[172:173], v189 offset:0
    v_mfma_f32_16x16x32_bf16 v[84:87], v[184:187], v[140:143], v[84:87]
    ds_read_b64_tr_b16 v[174:175], v189 offset:512
    v_mfma_f32_16x16x32_bf16 v[40:43], v[152:155], v[144:147], v[40:43]
    ds_read_b64_tr_b16 v[176:177], v191 offset:0
    v_mfma_f32_16x16x32_bf16 v[44:47], v[156:159], v[144:147], v[44:47]
    ds_read_b64_tr_b16 v[178:179], v191 offset:512
    v_mfma_f32_16x16x32_bf16 v[48:51], v[144:147], v[160:163], v[48:51]
    ds_read_b128 v[112:115], v168 offset:20480
    v_mfma_f32_16x16x32_bf16 v[52:55], v[144:147], v[164:167], v[52:55]
    ds_read_b128 v[116:119], v168 offset:22528
    v_mfma_f32_16x16x32_bf16 v[88:91], v[180:183], v[144:147], v[88:91]
    v_mfma_f32_16x16x32_bf16 v[92:95], v[184:187], v[144:147], v[92:95]
    v_mfma_f32_16x16x32_bf16 v[56:59], v[152:155], v[148:151], v[56:59]
    v_mfma_f32_16x16x32_bf16 v[60:63], v[156:159], v[148:151], v[60:63]
    v_mfma_f32_16x16x32_bf16 v[64:67], v[148:151], v[160:163], v[64:67]
    v_mfma_f32_16x16x32_bf16 v[68:71], v[148:151], v[164:167], v[68:71]
    v_mfma_f32_16x16x32_bf16 v[96:99], v[180:183], v[148:151], v[96:99]
    v_mfma_f32_16x16x32_bf16 v[100:103], v[184:187], v[148:151], v[100:103]
    s_waitcnt lgkmcnt(0)
    v_mfma_f32_16x16x32_bf16 v[8:11], v[120:123], v[104:107], v[8:11]
    ds_read_b128 v[136:139], v169 offset:16384
    v_mfma_f32_16x16x32_bf16 v[12:15], v[124:127], v[104:107], v[12:15]
    ds_read_b64_tr_b16 v[152:153], v170 offset:20480
    v_mfma_f32_16x16x32_bf16 v[16:19], v[104:107], v[128:131], v[16:19]
    ds_read_b64_tr_b16 v[154:155], v170 offset:20992
    v_mfma_f32_16x16x32_bf16 v[20:23], v[104:107], v[132:135], v[20:23]
    ds_read_b64_tr_b16 v[156:157], v171 offset:20480
    v_mfma_f32_16x16x32_bf16 v[72:75], v[172:175], v[104:107], v[72:75]
    ds_read_b64_tr_b16 v[158:159], v171 offset:20992
    v_mfma_f32_16x16x32_bf16 v[76:79], v[176:179], v[104:107], v[76:79]
    ds_read_b128 v[140:143], v169 offset:18432
    v_mfma_f32_16x16x32_bf16 v[24:27], v[120:123], v[108:111], v[24:27]
    ds_read_b64_tr_b16 v[160:161], v170 offset:28672
    v_mfma_f32_16x16x32_bf16 v[28:31], v[124:127], v[108:111], v[28:31]
    ds_read_b64_tr_b16 v[162:163], v170 offset:29184
    v_mfma_f32_16x16x32_bf16 v[32:35], v[108:111], v[128:131], v[32:35]
    ds_read_b64_tr_b16 v[164:165], v171 offset:28672
    v_mfma_f32_16x16x32_bf16 v[36:39], v[108:111], v[132:135], v[36:39]
    ds_read_b64_tr_b16 v[166:167], v171 offset:29184
    v_mfma_f32_16x16x32_bf16 v[80:83], v[172:175], v[108:111], v[80:83]
    ds_read_b64_tr_b16 v[180:181], v189 offset:4096
    v_mfma_f32_16x16x32_bf16 v[84:87], v[176:179], v[108:111], v[84:87]
    ds_read_b64_tr_b16 v[182:183], v189 offset:4608
    v_mfma_f32_16x16x32_bf16 v[40:43], v[120:123], v[112:115], v[40:43]
    ds_read_b64_tr_b16 v[184:185], v191 offset:4096
    v_mfma_f32_16x16x32_bf16 v[44:47], v[124:127], v[112:115], v[44:47]
    ds_read_b64_tr_b16 v[186:187], v191 offset:4608
    v_mfma_f32_16x16x32_bf16 v[48:51], v[112:115], v[128:131], v[48:51]
    ds_read_b128 v[144:147], v169 offset:20480
    v_mfma_f32_16x16x32_bf16 v[52:55], v[112:115], v[132:135], v[52:55]
    ds_read_b128 v[148:151], v169 offset:22528
    v_mfma_f32_16x16x32_bf16 v[88:91], v[172:175], v[112:115], v[88:91]
    v_mfma_f32_16x16x32_bf16 v[92:95], v[176:179], v[112:115], v[92:95]
    v_mfma_f32_16x16x32_bf16 v[56:59], v[120:123], v[116:119], v[56:59]
    v_mfma_f32_16x16x32_bf16 v[60:63], v[124:127], v[116:119], v[60:63]
    v_mfma_f32_16x16x32_bf16 v[64:67], v[116:119], v[128:131], v[64:67]
    v_mfma_f32_16x16x32_bf16 v[68:71], v[116:119], v[132:135], v[68:71]
    v_mfma_f32_16x16x32_bf16 v[96:99], v[172:175], v[116:119], v[96:99]
    v_mfma_f32_16x16x32_bf16 v[100:103], v[176:179], v[116:119], v[100:103]
    s_waitcnt lgkmcnt(0)
    s_barrier
    v_mfma_f32_16x16x32_bf16 v[8:11], v[152:155], v[136:139], v[8:11]
    ds_read_b128 v[104:107], v168 offset:32768
    v_mfma_f32_16x16x32_bf16 v[12:15], v[156:159], v[136:139], v[12:15]
    ds_read_b64_tr_b16 v[120:121], v170 offset:32768
    v_mfma_f32_16x16x32_bf16 v[16:19], v[136:139], v[160:163], v[16:19]
    ds_read_b64_tr_b16 v[122:123], v170 offset:33280
    v_mfma_f32_16x16x32_bf16 v[20:23], v[136:139], v[164:167], v[20:23]
    ds_read_b64_tr_b16 v[124:125], v171 offset:32768
    v_mfma_f32_16x16x32_bf16 v[72:75], v[180:183], v[136:139], v[72:75]
    ds_read_b64_tr_b16 v[126:127], v171 offset:33280
    v_mfma_f32_16x16x32_bf16 v[76:79], v[184:187], v[136:139], v[76:79]
    ds_read_b128 v[108:111], v168 offset:34816
    v_mfma_f32_16x16x32_bf16 v[24:27], v[152:155], v[140:143], v[24:27]
    ds_read_b64_tr_b16 v[128:129], v170 offset:40960
    v_mfma_f32_16x16x32_bf16 v[28:31], v[156:159], v[140:143], v[28:31]
    ds_read_b64_tr_b16 v[130:131], v170 offset:41472
    v_mfma_f32_16x16x32_bf16 v[32:35], v[140:143], v[160:163], v[32:35]
    ds_read_b64_tr_b16 v[132:133], v171 offset:40960
    v_mfma_f32_16x16x32_bf16 v[36:39], v[140:143], v[164:167], v[36:39]
    ds_read_b64_tr_b16 v[134:135], v171 offset:41472
    v_mfma_f32_16x16x32_bf16 v[80:83], v[180:183], v[140:143], v[80:83]
    ds_read_b64_tr_b16 v[172:173], v189 offset:8192
    v_mfma_f32_16x16x32_bf16 v[84:87], v[184:187], v[140:143], v[84:87]
    ds_read_b64_tr_b16 v[174:175], v189 offset:8704
    v_mfma_f32_16x16x32_bf16 v[40:43], v[152:155], v[144:147], v[40:43]
    ds_read_b64_tr_b16 v[176:177], v191 offset:8192
    v_mfma_f32_16x16x32_bf16 v[44:47], v[156:159], v[144:147], v[44:47]
    ds_read_b64_tr_b16 v[178:179], v191 offset:8704
    v_mfma_f32_16x16x32_bf16 v[48:51], v[144:147], v[160:163], v[48:51]
    ds_read_b128 v[112:115], v168 offset:36864
    v_mfma_f32_16x16x32_bf16 v[52:55], v[144:147], v[164:167], v[52:55]
    ds_read_b128 v[116:119], v168 offset:38912
    v_mfma_f32_16x16x32_bf16 v[88:91], v[180:183], v[144:147], v[88:91]
    v_mfma_f32_16x16x32_bf16 v[92:95], v[184:187], v[144:147], v[92:95]
    v_mfma_f32_16x16x32_bf16 v[56:59], v[152:155], v[148:151], v[56:59]
    v_mfma_f32_16x16x32_bf16 v[60:63], v[156:159], v[148:151], v[60:63]
    v_mfma_f32_16x16x32_bf16 v[64:67], v[148:151], v[160:163], v[64:67]
    v_mfma_f32_16x16x32_bf16 v[68:71], v[148:151], v[164:167], v[68:71]
    v_mfma_f32_16x16x32_bf16 v[96:99], v[180:183], v[148:151], v[96:99]
    v_mfma_f32_16x16x32_bf16 v[100:103], v[184:187], v[148:151], v[100:103]
    s_waitcnt lgkmcnt(0)
    v_mfma_f32_16x16x32_bf16 v[8:11], v[120:123], v[104:107], v[8:11]
    ds_read_b128 v[136:139], v169 offset:32768
    v_mfma_f32_16x16x32_bf16 v[12:15], v[124:127], v[104:107], v[12:15]
    ds_read_b64_tr_b16 v[152:153], v170 offset:36864
    v_mfma_f32_16x16x32_bf16 v[16:19], v[104:107], v[128:131], v[16:19]
    ds_read_b64_tr_b16 v[154:155], v170 offset:37376
    v_mfma_f32_16x16x32_bf16 v[20:23], v[104:107], v[132:135], v[20:23]
    ds_read_b64_tr_b16 v[156:157], v171 offset:36864
    v_mfma_f32_16x16x32_bf16 v[72:75], v[172:175], v[104:107], v[72:75]
    ds_read_b64_tr_b16 v[158:159], v171 offset:37376
    v_mfma_f32_16x16x32_bf16 v[76:79], v[176:179], v[104:107], v[76:79]
    ds_read_b128 v[140:143], v169 offset:34816
    v_mfma_f32_16x16x32_bf16 v[24:27], v[120:123], v[108:111], v[24:27]
    ds_read_b64_tr_b16 v[160:161], v170 offset:45056
    v_mfma_f32_16x16x32_bf16 v[28:31], v[124:127], v[108:111], v[28:31]
    ds_read_b64_tr_b16 v[162:163], v170 offset:45568
    v_mfma_f32_16x16x32_bf16 v[32:35], v[108:111], v[128:131], v[32:35]
    ds_read_b64_tr_b16 v[164:165], v171 offset:45056
    v_mfma_f32_16x16x32_bf16 v[36:39], v[108:111], v[132:135], v[36:39]
    ds_read_b64_tr_b16 v[166:167], v171 offset:45568
    v_mfma_f32_16x16x32_bf16 v[80:83], v[172:175], v[108:111], v[80:83]
    ds_read_b64_tr_b16 v[180:181], v189 offset:12288
    v_mfma_f32_16x16x32_bf16 v[84:87], v[176:179], v[108:111], v[84:87]
    ds_read_b64_tr_b16 v[182:183], v189 offset:12800
    v_mfma_f32_16x16x32_bf16 v[40:43], v[120:123], v[112:115], v[40:43]
    ds_read_b64_tr_b16 v[184:185], v191 offset:12288
    v_mfma_f32_16x16x32_bf16 v[44:47], v[124:127], v[112:115], v[44:47]
    ds_read_b64_tr_b16 v[186:187], v191 offset:12800
    v_mfma_f32_16x16x32_bf16 v[48:51], v[112:115], v[128:131], v[48:51]
    ds_read_b128 v[144:147], v169 offset:36864
    v_mfma_f32_16x16x32_bf16 v[52:55], v[112:115], v[132:135], v[52:55]
    ds_read_b128 v[148:151], v169 offset:38912
    v_mfma_f32_16x16x32_bf16 v[88:91], v[172:175], v[112:115], v[88:91]
    v_mfma_f32_16x16x32_bf16 v[92:95], v[176:179], v[112:115], v[92:95]
    v_mfma_f32_16x16x32_bf16 v[56:59], v[120:123], v[116:119], v[56:59]
    v_mfma_f32_16x16x32_bf16 v[60:63], v[124:127], v[116:119], v[60:63]
    v_mfma_f32_16x16x32_bf16 v[64:67], v[116:119], v[128:131], v[64:67]
    v_mfma_f32_16x16x32_bf16 v[68:71], v[116:119], v[132:135], v[68:71]
    v_mfma_f32_16x16x32_bf16 v[96:99], v[172:175], v[116:119], v[96:99]
    v_mfma_f32_16x16x32_bf16 v[100:103], v[176:179], v[116:119], v[100:103]
    s_waitcnt lgkmcnt(0)
    s_barrier
    v_mfma_f32_16x16x32_bf16 v[8:11], v[152:155], v[136:139], v[8:11]
    ds_read_b128 v[104:107], v168 offset:49152
    v_mfma_f32_16x16x32_bf16 v[12:15], v[156:159], v[136:139], v[12:15]
    ds_read_b64_tr_b16 v[120:121], v170 offset:49152
    v_mfma_f32_16x16x32_bf16 v[16:19], v[136:139], v[160:163], v[16:19]
    ds_read_b64_tr_b16 v[122:123], v170 offset:49664
    v_mfma_f32_16x16x32_bf16 v[20:23], v[136:139], v[164:167], v[20:23]
    ds_read_b64_tr_b16 v[124:125], v171 offset:49152
    v_mfma_f32_16x16x32_bf16 v[72:75], v[180:183], v[136:139], v[72:75]
    ds_read_b64_tr_b16 v[126:127], v171 offset:49664
    v_mfma_f32_16x16x32_bf16 v[76:79], v[184:187], v[136:139], v[76:79]
    ds_read_b128 v[108:111], v168 offset:51200
    v_mfma_f32_16x16x32_bf16 v[24:27], v[152:155], v[140:143], v[24:27]
    ds_read_b64_tr_b16 v[128:129], v170 offset:57344
    v_mfma_f32_16x16x32_bf16 v[28:31], v[156:159], v[140:143], v[28:31]
    ds_read_b64_tr_b16 v[130:131], v170 offset:57856
    v_mfma_f32_16x16x32_bf16 v[32:35], v[140:143], v[160:163], v[32:35]
    ds_read_b64_tr_b16 v[132:133], v171 offset:57344
    v_mfma_f32_16x16x32_bf16 v[36:39], v[140:143], v[164:167], v[36:39]
    ds_read_b64_tr_b16 v[134:135], v171 offset:57856
    v_mfma_f32_16x16x32_bf16 v[80:83], v[180:183], v[140:143], v[80:83]
    ds_read_b64_tr_b16 v[172:173], v189 offset:16384
    v_mfma_f32_16x16x32_bf16 v[84:87], v[184:187], v[140:143], v[84:87]
    ds_read_b64_tr_b16 v[174:175], v189 offset:16896
    v_mfma_f32_16x16x32_bf16 v[40:43], v[152:155], v[144:147], v[40:43]
    ds_read_b64_tr_b16 v[176:177], v191 offset:16384
    v_mfma_f32_16x16x32_bf16 v[44:47], v[156:159], v[144:147], v[44:47]
    ds_read_b64_tr_b16 v[178:179], v191 offset:16896
    v_mfma_f32_16x16x32_bf16 v[48:51], v[144:147], v[160:163], v[48:51]
    ds_read_b128 v[112:115], v168 offset:53248
    v_mfma_f32_16x16x32_bf16 v[52:55], v[144:147], v[164:167], v[52:55]
    ds_read_b128 v[116:119], v168 offset:55296
    v_mfma_f32_16x16x32_bf16 v[88:91], v[180:183], v[144:147], v[88:91]
    v_mfma_f32_16x16x32_bf16 v[92:95], v[184:187], v[144:147], v[92:95]
    v_mfma_f32_16x16x32_bf16 v[56:59], v[152:155], v[148:151], v[56:59]
    v_mfma_f32_16x16x32_bf16 v[60:63], v[156:159], v[148:151], v[60:63]
    v_mfma_f32_16x16x32_bf16 v[64:67], v[148:151], v[160:163], v[64:67]
    v_mfma_f32_16x16x32_bf16 v[68:71], v[148:151], v[164:167], v[68:71]
    v_mfma_f32_16x16x32_bf16 v[96:99], v[180:183], v[148:151], v[96:99]
    v_mfma_f32_16x16x32_bf16 v[100:103], v[184:187], v[148:151], v[100:103]
    s_waitcnt lgkmcnt(0)
    v_mfma_f32_16x16x32_bf16 v[8:11], v[120:123], v[104:107], v[8:11]
    ds_read_b128 v[136:139], v169 offset:49152
    v_mfma_f32_16x16x32_bf16 v[12:15], v[124:127], v[104:107], v[12:15]
    ds_read_b64_tr_b16 v[152:153], v170 offset:53248
    v_mfma_f32_16x16x32_bf16 v[16:19], v[104:107], v[128:131], v[16:19]
    ds_read_b64_tr_b16 v[154:155], v170 offset:53760
    v_mfma_f32_16x16x32_bf16 v[20:23], v[104:107], v[132:135], v[20:23]
    ds_read_b64_tr_b16 v[156:157], v171 offset:53248
    v_mfma_f32_16x16x32_bf16 v[72:75], v[172:175], v[104:107], v[72:75]
    ds_read_b64_tr_b16 v[158:159], v171 offset:53760
    v_mfma_f32_16x16x32_bf16 v[76:79], v[176:179], v[104:107], v[76:79]
    ds_read_b128 v[140:143], v169 offset:51200
    v_mfma_f32_16x16x32_bf16 v[24:27], v[120:123], v[108:111], v[24:27]
    ds_read_b64_tr_b16 v[160:161], v170 offset:61440
    v_mfma_f32_16x16x32_bf16 v[28:31], v[124:127], v[108:111], v[28:31]
    ds_read_b64_tr_b16 v[162:163], v170 offset:61952
    v_mfma_f32_16x16x32_bf16 v[32:35], v[108:111], v[128:131], v[32:35]
    ds_read_b64_tr_b16 v[164:165], v171 offset:61440
    v_mfma_f32_16x16x32_bf16 v[36:39], v[108:111], v[132:135], v[36:39]
    ds_read_b64_tr_b16 v[166:167], v171 offset:61952
    v_mfma_f32_16x16x32_bf16 v[80:83], v[172:175], v[108:111], v[80:83]
    ds_read_b64_tr_b16 v[180:181], v189 offset:20480
    v_mfma_f32_16x16x32_bf16 v[84:87], v[176:179], v[108:111], v[84:87]
    ds_read_b64_tr_b16 v[182:183], v189 offset:20992
    v_mfma_f32_16x16x32_bf16 v[40:43], v[120:123], v[112:115], v[40:43]
    ds_read_b64_tr_b16 v[184:185], v191 offset:20480
    v_mfma_f32_16x16x32_bf16 v[44:47], v[124:127], v[112:115], v[44:47]
    ds_read_b64_tr_b16 v[186:187], v191 offset:20992
    v_mfma_f32_16x16x32_bf16 v[48:51], v[112:115], v[128:131], v[48:51]
    ds_read_b128 v[144:147], v169 offset:53248
    v_mfma_f32_16x16x32_bf16 v[52:55], v[112:115], v[132:135], v[52:55]
    ds_read_b128 v[148:151], v169 offset:55296
    v_mfma_f32_16x16x32_bf16 v[88:91], v[172:175], v[112:115], v[88:91]
    v_mfma_f32_16x16x32_bf16 v[92:95], v[176:179], v[112:115], v[92:95]
    v_mfma_f32_16x16x32_bf16 v[56:59], v[120:123], v[116:119], v[56:59]
    v_mfma_f32_16x16x32_bf16 v[60:63], v[124:127], v[116:119], v[60:63]
    v_mfma_f32_16x16x32_bf16 v[64:67], v[116:119], v[128:131], v[64:67]
    v_mfma_f32_16x16x32_bf16 v[68:71], v[116:119], v[132:135], v[68:71]
    v_mfma_f32_16x16x32_bf16 v[96:99], v[172:175], v[116:119], v[96:99]
    v_mfma_f32_16x16x32_bf16 v[100:103], v[176:179], v[116:119], v[100:103]
L_e1:
    s_waitcnt lgkmcnt(0)
    s_barrier
    v_mfma_f32_16x16x32_bf16 v[8:11], v[152:155], v[136:139], v[8:11]
    ds_read_b128 v[104:107], v168 offset:0
    v_mfma_f32_16x16x32_bf16 v[12:15], v[156:159], v[136:139], v[12:15]
    ds_read_b64_tr_b16 v[120:121], v170 offset:0
    v_mfma_f32_16x16x32_bf16 v[16:19], v[136:139], v[160:163], v[16:19]
    ds_read_b64_tr_b16 v[122:123], v170 offset:512
    v_mfma_f32_16x16x32_bf16 v[20:23], v[136:139], v[164:167], v[20:23]
    ds_read_b64_tr_b16 v[124:125], v171 offset:0
    v_mfma_f32_16x16x32_bf16 v[72:75], v[180:183], v[136:139], v[72:75]
    ds_read_b64_tr_b16 v[126:127], v171 offset:512
    v_mfma_f32_16x16x32_bf16 v[76:79], v[184:187], v[136:139], v[76:79]
    ds_read_b128 v[108:111], v168 offset:2048
    v_mfma_f32_16x16x32_bf16 v[24:27], v[152:155], v[140:143], v[24:27]
    ds_read_b64_tr_b16 v[128:129], v170 offset:8192
    v_mfma_f32_16x16x32_bf16 v[28:31], v[156:159], v[140:143], v[28:31]
    ds_read_b64_tr_b16 v[130:131], v170 offset:8704
    v_mfma_f32_16x16x32_bf16 v[32:35], v[140:143], v[160:163], v[32:35]
    ds_read_b64_tr_b16 v[132:133], v171 offset:8192
    v_mfma_f32_16x16x32_bf16 v[36:39], v[140:143], v[164:167], v[36:39]
    ds_read_b64_tr_b16 v[134:135], v171 offset:8704
    v_mfma_f32_16x16x32_bf16 v[80:83], v[180:183], v[140:143], v[80:83]
    ds_read_b128 v[112:115], v168 offset:4096
    v_mfma_f32_16x16x32_bf16 v[84:87], v[184:187], v[140:143], v[84:87]
    ds_read_b128 v[116:119], v168 offset:6144
    v_mfma_f32_16x16x32_bf16 v[40:43], v[152:155], v[144:147], v[40:43]
    v_mfma_f32_16x16x32_bf16 v[44:47], v[156:159], v[144:147], v[44:47]
    v_mfma_f32_16x16x32_bf16 v[48:51], v[144:147], v[160:163], v[48:51]
    v_mfma_f32_16x16x32_bf16 v[52:55], v[144:147], v[164:167], v[52:55]
    v_mfma_f32_16x16x32_bf16 v[88:91], v[180:183], v[144:147], v[88:91]
    v_mfma_f32_16x16x32_bf16 v[92:95], v[184:187], v[144:147], v[92:95]
    v_mfma_f32_16x16x32_bf16 v[56:59], v[152:155], v[148:151], v[56:59]
    v_mfma_f32_16x16x32_bf16 v[60:63], v[156:159], v[148:151], v[60:63]
    v_mfma_f32_16x16x32_bf16 v[64:67], v[148:151], v[160:163], v[64:67]
    v_mfma_f32_16x16x32_bf16 v[68:71], v[148:151], v[164:167], v[68:71]
    v_mfma_f32_16x16x32_bf16 v[96:99], v[180:183], v[148:151], v[96:99]
    v_mfma_f32_16x16x32_bf16 v[100:103], v[184:187], v[148:151], v[100:103]
    s_waitcnt lgkmcnt(0)
    v_mfma_f32_16x16x32_bf16 v[8:11], v[120:123], v[104:107], v[8:11]
    ds_read_b128 v[136:139], v169 offset:0
    v_mfma_f32_16x16x32_bf16 v[12:15], v[124:127], v[104:107], v[12:15]
    ds_read_b64_tr_b16 v[152:153], v170 offset:4096
    v_mfma_f32_16x16x32_bf16 v[16:19], v[104:107], v[128:131], v[16:19]
    ds_read_b64_tr_b16 v[154:155], v170 offset:4608
    v_mfma_f32_16x16x32_bf16 v[20:23], v[104:107], v[132:135], v[20:23]
    ds_read_b64_tr_b16 v[156:157], v171 offset:4096
    v_mfma_f32_16x16x32_bf16 v[24:27], v[120:123], v[108:111], v[24:27]
    ds_read_b64_tr_b16 v[158:159], v171 offset:4608
    v_mfma_f32_16x16x32_bf16 v[28:31], v[124:127], v[108:111], v[28:31]
    ds_read_b128 v[140:143], v169 offset:2048
    v_mfma_f32_16x16x32_bf16 v[32:35], v[108:111], v[128:131], v[32:35]
    ds_read_b64_tr_b16 v[160:161], v170 offset:12288
    v_mfma_f32_16x16x32_bf16 v[36:39], v[108:111], v[132:135], v[36:39]
    ds_read_b64_tr_b16 v[162:163], v170 offset:12800
    v_mfma_f32_16x16x32_bf16 v[40:43], v[120:123], v[112:115], v[40:43]
    ds_read_b64_tr_b16 v[164:165], v171 offset:12288
    ds_read_b128 v[196:199], v243 offset:320
    v_mfma_f32_16x16x32_bf16 v[44:47], v[124:127], v[112:115], v[44:47]
    ds_read_b64_tr_b16 v[166:167], v171 offset:12800
    ds_read_b128 v[192:195], v243 offset:256
    v_mfma_f32_16x16x32_bf16 v[48:51], v[112:115], v[128:131], v[48:51]
    ds_read_b128 v[144:147], v169 offset:4096
    ds_read_b128 v[220:223], v243 offset:64
    v_mfma_f32_16x16x32_bf16 v[52:55], v[112:115], v[132:135], v[52:55]
    ds_read_b128 v[148:151], v169 offset:6144
    ds_read_b128 v[216:219], v243 offset:0
    v_mfma_f32_16x16x32_bf16 v[56:59], v[120:123], v[116:119], v[56:59]
    ds_read_b32 v186, v240 offset:192
    v_mfma_f32_16x16x32_bf16 v[60:63], v[124:127], v[116:119], v[60:63]
    ds_read_b32 v184, v240 offset:128
    v_mfma_f32_16x16x32_bf16 v[64:67], v[116:119], v[128:131], v[64:67]
    ds_read_b32 v182, v240 offset:64
    v_mfma_f32_16x16x32_bf16 v[68:71], v[116:119], v[132:135], v[68:71]
    ds_read_b32 v180, v240 offset:0
    s_waitcnt lgkmcnt(0)
    v_mov_b32 v7, 13
    ds_write_b32 v249, v7
    v_mfma_f32_16x16x32_bf16 v[8:11], v[152:155], v[136:139], v[8:11]
    ds_read_b128 v[104:107], v168 offset:16384
    v_mfma_f32_16x16x32_bf16 v[12:15], v[156:159], v[136:139], v[12:15]
    ds_read_b64_tr_b16 v[120:121], v170 offset:16384
    v_mfma_f32_16x16x32_bf16 v[16:19], v[136:139], v[160:163], v[16:19]
    ds_read_b64_tr_b16 v[122:123], v170 offset:16896
    v_mfma_f32_16x16x32_bf16 v[20:23], v[136:139], v[164:167], v[20:23]
    ds_read_b64_tr_b16 v[124:125], v171 offset:16384
    v_mfma_f32_16x16x32_bf16 v[24:27], v[152:155], v[140:143], v[24:27]
    ds_read_b64_tr_b16 v[126:127], v171 offset:16896
    v_mfma_f32_16x16x32_bf16 v[28:31], v[156:159], v[140:143], v[28:31]
    ds_read_b128 v[108:111], v168 offset:18432
    v_mfma_f32_16x16x32_bf16 v[32:35], v[140:143], v[160:163], v[32:35]
    ds_read_b64_tr_b16 v[128:129], v170 offset:24576
    v_mfma_f32_16x16x32_bf16 v[36:39], v[140:143], v[164:167], v[36:39]
    ds_read_b64_tr_b16 v[130:131], v170 offset:25088
    v_mfma_f32_16x16x32_bf16 v[40:43], v[152:155], v[144:147], v[40:43]
    ds_read_b64_tr_b16 v[132:133], v171 offset:24576
    v_mfma_f32_16x16x32_bf16 v[44:47], v[156:159], v[144:147], v[44:47]
    ds_read_b64_tr_b16 v[134:135], v171 offset:25088
    v_mfma_f32_16x16x32_bf16 v[48:51], v[144:147], v[160:163], v[48:51]
    ds_read_b128 v[112:115], v168 offset:20480
    ds_read_b128 v[212:215], v242 offset:192
    v_mfma_f32_16x16x32_bf16 v[52:55], v[144:147], v[164:167], v[52:55]
    ds_read_b128 v[116:119], v168 offset:22528
    ds_read_b128 v[208:211], v242 offset:128
    v_mfma_f32_16x16x32_bf16 v[56:59], v[152:155], v[148:151], v[56:59]
    ds_read_b128 v[204:207], v242 offset:64
    v_mfma_f32_16x16x32_bf16 v[60:63], v[156:159], v[148:151], v[60:63]
    ds_read_b128 v[200:203], v242 offset:0
    v_mfma_f32_16x16x32_bf16 v[64:67], v[148:151], v[160:163], v[64:67]
    ds_read_b32 v190, v244 offset:576
    v_mfma_f32_16x16x32_bf16 v[68:71], v[148:151], v[164:167], v[68:71]
    ds_read_b32 v188, v244 offset:512
    s_waitcnt lgkmcnt(0)
    v_mfma_f32_16x16x32_bf16 v[8:11], v[120:123], v[104:107], v[8:11]
    ds_read_b128 v[136:139], v169 offset:16384
    v_fmac_f32 v40, v184, v192
    v_mfma_f32_16x16x32_bf16 v[12:15], v[124:127], v[104:107], v[12:15]
    ds_read_b64_tr_b16 v[152:153], v170 offset:20480
    v_fmac_f32 v44, v184, v196
    v_mfma_f32_16x16x32_bf16 v[16:19], v[104:107], v[128:131], v[16:19]
    ds_read_b64_tr_b16 v[154:155], v170 offset:20992
    v_fmac_f32 v48, v208, v188
    v_mfma_f32_16x16x32_bf16 v[20:23], v[104:107], v[132:135], v[20:23]
    ds_read_b64_tr_b16 v[156:157], v171 offset:20480
    v_fmac_f32 v52, v208, v190
    v_mfma_f32_16x16x32_bf16 v[24:27], v[120:123], v[108:111], v[24:27]
    ds_read_b64_tr_b16 v[158:159], v171 offset:20992
    v_fmac_f32 v56, v186, v192
    v_mfma_f32_16x16x32_bf16 v[28:31], v[124:127], v[108:111], v[28:31]
    ds_read_b128 v[140:143], v169 offset:18432
    v_fmac_f32 v60, v186, v196
    v_mfma_f32_16x16x32_bf16 v[32:35], v[108:111], v[128:131], v[32:35]
    ds_read_b64_tr_b16 v[160:161], v170 offset:28672
    v_fmac_f32 v64, v212, v188
    v_mfma_f32_16x16x32_bf16 v[36:39], v[108:111], v[132:135], v[36:39]
    ds_read_b64_tr_b16 v[162:163], v170 offset:29184
    v_fmac_f32 v68, v212, v190
    v_mfma_f32_16x16x32_bf16 v[40:43], v[120:123], v[112:115], v[40:43]
    ds_read_b64_tr_b16 v[164:165], v171 offset:28672
    v_fmac_f32 v8, v180, v192
    v_mfma_f32_16x16x32_bf16 v[44:47], v[124:127], v[112:115], v[44:47]
    ds_read_b64_tr_b16 v[166:167], v171 offset:29184
    v_fmac_f32 v12, v180, v196
    v_mfma_f32_16x16x32_bf16 v[48:51], v[112:115], v[128:131], v[48:51]
    ds_read_b128 v[144:147], v169 offset:20480
    v_fmac_f32 v16, v200, v188
    v_mfma_f32_16x16x32_bf16 v[52:55], v[112:115], v[132:135], v[52:55]
    ds_read_b128 v[148:151], v169 offset:22528
    v_fmac_f32 v20, v200, v190
    v_mfma_f32_16x16x32_bf16 v[56:59], v[120:123], v[116:119], v[56:59]
    ds_read_b64 v[238:239], v251 offset:64
    v_fmac_f32 v24, v182, v192
    ds_read_b64_tr_b16 v[178:179], v246 offset:1056
    v_mfma_f32_16x16x32_bf16 v[60:63], v[124:127], v[116:119], v[60:63]
    v_fmac_f32 v28, v182, v196
    ds_read_b64_tr_b16 v[176:177], v246 offset:32
    v_mfma_f32_16x16x32_bf16 v[64:67], v[116:119], v[128:131], v[64:67]
    v_fmac_f32 v32, v204, v188
    ds_read_b64_tr_b16 v[174:175], v246 offset:1024
    v_mfma_f32_16x16x32_bf16 v[68:71], v[116:119], v[132:135], v[68:71]
    v_fmac_f32 v36, v204, v190
    ds_read_b64_tr_b16 v[172:173], v246 offset:0
    s_waitcnt lgkmcnt(0)
    v_mov_b32 v7, 14
    ds_write_b32 v249, v7
L_la14:
    v_min_u32 v238, v238, v239
    s_nop 0
    v_readfirstlane_b32 s3, v238
    s_nop 0
    s_cmp_ge_u32 s3, 14
    s_cbranch_scc1 L_lad14
    ds_read_b64 v[238:239], v251 offset:64
    s_waitcnt lgkmcnt(0)
    s_branch L_la14
L_lad14:
    v_mfma_f32_16x16x32_bf16 v[8:11], v[152:155], v[136:139], v[8:11]
    ds_read_b128 v[104:107], v168 offset:32768
    v_fmac_f32 v41, v184, v193
    v_mfma_f32_16x16x32_bf16 v[12:15], v[156:159], v[136:139], v[12:15]
    ds_read_b64_tr_b16 v[120:121], v170 offset:32768
    v_fmac_f32 v45, v184, v197
    v_mfma_f32_16x16x32_bf16 v[16:19], v[136:139], v[160:163], v[16:19]
    ds_read_b64_tr_b16 v[122:123], v170 offset:33280
    v_fmac_f32 v49, v209, v188
    v_mfma_f32_16x16x32_bf16 v[20:23], v[136:139], v[164:167], v[20:23]
    ds_read_b64_tr_b16 v[124:125], v171 offset:32768
    v_fmac_f32 v53, v209, v190
    v_mfma_f32_16x16x32_bf16 v[24:27], v[152:155], v[140:143], v[24:27]
    ds_read_b64_tr_b16 v[126:127], v171 offset:33280
    v_fmac_f32 v57, v186, v193
    v_mfma_f32_16x16x32_bf16 v[28:31], v[156:159], v[140:143], v[28:31]
    ds_read_b128 v[108:111], v168 offset:34816
    v_fmac_f32 v61, v186, v197
    v_mfma_f32_16x16x32_bf16 v[32:35], v[140:143], v[160:163], v[32:35]
    ds_read_b64_tr_b16 v[128:129], v170 offset:40960
    v_fmac_f32 v65, v213, v188
    v_mfma_f32_16x16x32_bf16 v[36:39], v[140:143], v[164:167], v[36:39]
    ds_read_b64_tr_b16 v[130:131], v170 offset:41472
    v_fmac_f32 v69, v213, v190
    v_mfma_f32_16x16x32_bf16 v[40:43], v[152:155], v[144:147], v[40:43]
    ds_read_b64_tr_b16 v[132:133], v171 offset:40960
    v_fmac_f32 v9, v180, v193
    v_mfma_f32_16x16x32_bf16 v[44:47], v[156:159], v[144:147], v[44:47]
    ds_read_b64_tr_b16 v[134:135], v171 offset:41472
    v_fmac_f32 v13, v180, v197
    v_mfma_f32_16x16x32_bf16 v[48:51], v[144:147], v[160:163], v[48:51]
    ds_read_b128 v[112:115], v168 offset:36864
    v_fmac_f32 v17, v201, v188
    v_mfma_f32_16x16x32_bf16 v[52:55], v[144:147], v[164:167], v[52:55]
    ds_read_b128 v[116:119], v168 offset:38912
    v_fmac_f32 v21, v201, v190
    v_mfma_f32_16x16x32_bf16 v[56:59], v[152:155], v[148:151], v[56:59]
    v_fmac_f32 v25, v182, v193
    ds_read_b32 v254, v240 offset:3776
    v_mfma_f32_16x16x32_bf16 v[60:63], v[156:159], v[148:151], v[60:63]
    v_fmac_f32 v29, v182, v197
    ds_read_b32 v252, v240 offset:3712
    v_mfma_f32_16x16x32_bf16 v[64:67], v[148:151], v[160:163], v[64:67]
    v_fmac_f32 v33, v205, v188
    ds_read_b32 v250, v240 offset:3648
    v_mfma_f32_16x16x32_bf16 v[68:71], v[148:151], v[164:167], v[68:71]
    v_fmac_f32 v37, v205, v190
    ds_read_b32 v248, v240 offset:3584
    s_waitcnt lgkmcnt(0)
    v_mfma_f32_16x16x32_bf16 v[8:11], v[120:123], v[104:107], v[8:11]
    ds_read_b128 v[136:139], v169 offset:32768
    v_fmac_f32 v42, v184, v194
    v_mfma_f32_16x16x32_bf16 v[12:15], v[124:127], v[104:107], v[12:15]
    ds_read_b64_tr_b16 v[152:153], v170 offset:36864
    v_fmac_f32 v46, v184, v198
    v_mfma_f32_16x16x32_bf16 v[16:19], v[104:107], v[128:131], v[16:19]
    ds_read_b64_tr_b16 v[154:155], v170 offset:37376
    v_fmac_f32 v50, v210, v188
    v_mfma_f32_16x16x32_bf16 v[20:23], v[104:107], v[132:135], v[20:23]
    ds_read_b64_tr_b16 v[156:157], v171 offset:36864
    v_fmac_f32 v54, v210, v190
    v_mfma_f32_16x16x32_bf16 v[24:27], v[120:123], v[108:111], v[24:27]
    ds_read_b64_tr_b16 v[158:159], v171 offset:37376
    v_fmac_f32 v58, v186, v194
    v_mfma_f32_16x16x32_bf16 v[28:31], v[124:127], v[108:111], v[28:31]
    ds_read_b128 v[140:143], v169 offset:34816
    v_fmac_f32 v62, v186, v198
    v_mfma_f32_16x16x32_bf16 v[32:35], v[108:111], v[128:131], v[32:35]
    ds_read_b64_tr_b16 v[160:161], v170 offset:45056
    v_fmac_f32 v66, v214, v188
    v_mfma_f32_16x16x32_bf16 v[36:39], v[108:111], v[132:135], v[36:39]
    ds_read_b64_tr_b16 v[162:163], v170 offset:45568
    v_fmac_f32 v70, v214, v190
    v_mfma_f32_16x16x32_bf16 v[40:43], v[120:123], v[112:115], v[40:43]
    ds_read_b64_tr_b16 v[164:165], v171 offset:45056
    v_fmac_f32 v10, v180, v194
    v_mfma_f32_16x16x32_bf16 v[44:47], v[124:127], v[112:115], v[44:47]
    ds_read_b64_tr_b16 v[166:167], v171 offset:45568
    v_fmac_f32 v14, v180, v198
    v_mfma_f32_16x16x32_bf16 v[48:51], v[112:115], v[128:131], v[48:51]
    ds_read_b128 v[144:147], v169 offset:36864
    v_fmac_f32 v18, v202, v188
    v_mfma_f32_16x16x32_bf16 v[52:55], v[112:115], v[132:135], v[52:55]
    ds_read_b128 v[148:151], v169 offset:38912
    v_fmac_f32 v22, v202, v190
    v_mfma_f32_16x16x32_bf16 v[56:59], v[120:123], v[116:119], v[56:59]
    ds_read_b64 v[238:239], v251 offset:64
    v_fmac_f32 v26, v182, v194
    ds_read_b32 v181, v241 offset:3584
    v_mfma_f32_16x16x32_bf16 v[60:63], v[124:127], v[116:119], v[60:63]
    v_fmac_f32 v30, v182, v198
    ds_read_b32 v183, v241 offset:512
    v_mfma_f32_16x16x32_bf16 v[64:67], v[116:119], v[128:131], v[64:67]
    v_fmac_f32 v34, v206, v188
    ds_read_b32 v187, v251 offset:8
    v_mfma_f32_16x16x32_bf16 v[68:71], v[116:119], v[132:135], v[68:71]
    v_fmac_f32 v38, v206, v190
    ds_read_b32 v185, v251 offset:16
    s_waitcnt lgkmcnt(0)
    v_mov_b32 v7, 15
    ds_write_b32 v249, v7
L_la15:
    v_min_u32 v238, v238, v239
    s_nop 0
    v_readfirstlane_b32 s3, v238
    s_nop 0
    s_cmp_ge_u32 s3, 15
    s_cbranch_scc1 L_lad15
    ds_read_b64 v[238:239], v251 offset:64
    s_waitcnt lgkmcnt(0)
    s_branch L_la15
L_lad15:
    v_mfma_f32_16x16x32_bf16 v[8:11], v[152:155], v[136:139], v[8:11]
    ds_read_b128 v[104:107], v168 offset:49152
    v_fmac_f32 v43, v184, v195
    v_mfma_f32_16x16x32_bf16 v[12:15], v[156:159], v[136:139], v[12:15]
    ds_read_b64_tr_b16 v[120:121], v170 offset:49152
    v_fmac_f32 v47, v184, v199
    v_mfma_f32_16x16x32_bf16 v[16:19], v[136:139], v[160:163], v[16:19]
    ds_read_b64_tr_b16 v[122:123], v170 offset:49664
    v_fmac_f32 v51, v211, v188
    v_mfma_f32_16x16x32_bf16 v[20:23], v[136:139], v[164:167], v[20:23]
    ds_read_b64_tr_b16 v[124:125], v171 offset:49152
    v_fmac_f32 v55, v211, v190
    v_mfma_f32_16x16x32_bf16 v[24:27], v[152:155], v[140:143], v[24:27]
    ds_read_b64_tr_b16 v[126:127], v171 offset:49664
    v_fmac_f32 v59, v186, v195
    v_mfma_f32_16x16x32_bf16 v[28:31], v[156:159], v[140:143], v[28:31]
    ds_read_b128 v[108:111], v168 offset:51200
    v_fmac_f32 v63, v186, v199
    v_mfma_f32_16x16x32_bf16 v[32:35], v[140:143], v[160:163], v[32:35]
    ds_read_b64_tr_b16 v[128:129], v170 offset:57344
    v_fmac_f32 v67, v215, v188
    v_mfma_f32_16x16x32_bf16 v[36:39], v[140:143], v[164:167], v[36:39]
    ds_read_b64_tr_b16 v[130:131], v170 offset:57856
    v_fmac_f32 v71, v215, v190
    v_mfma_f32_16x16x32_bf16 v[40:43], v[152:155], v[144:147], v[40:43]
    ds_read_b64_tr_b16 v[132:133], v171 offset:57344
    v_fmac_f32 v11, v180, v195
    v_mfma_f32_16x16x32_bf16 v[44:47], v[156:159], v[144:147], v[44:47]
    ds_read_b64_tr_b16 v[134:135], v171 offset:57856
    v_fmac_f32 v15, v180, v199
    v_mfma_f32_16x16x32_bf16 v[48:51], v[144:147], v[160:163], v[48:51]
    ds_read_b128 v[112:115], v168 offset:53248
    v_fmac_f32 v19, v203, v188
    v_mfma_f32_16x16x32_bf16 v[52:55], v[144:147], v[164:167], v[52:55]
    ds_read_b128 v[116:119], v168 offset:55296
    v_fmac_f32 v23, v203, v190
    v_mfma_f32_16x16x32_bf16 v[56:59], v[152:155], v[148:151], v[56:59]
    v_fmac_f32 v27, v182, v195
    v_mfma_f32_16x16x32_bf16 v[60:63], v[156:159], v[148:151], v[60:63]
    v_fmac_f32 v31, v182, v199
    v_mfma_f32_16x16x32_bf16 v[64:67], v[148:151], v[160:163], v[64:67]
    v_fmac_f32 v35, v207, v188
    v_mfma_f32_16x16x32_bf16 v[68:71], v[148:151], v[164:167], v[68:71]
    v_fmac_f32 v39, v207, v190
    s_waitcnt lgkmcnt(0)
    v_mfma_f32_16x16x32_bf16 v[8:11], v[120:123], v[104:107], v[8:11]
    ds_read_b128 v[136:139], v169 offset:49152
    v_mfma_f32_16x16x32_bf16 v[12:15], v[124:127], v[104:107], v[12:15]
    ds_read_b64_tr_b16 v[152:153], v170 offset:53248
    v_mfma_f32_16x16x32_bf16 v[16:19], v[104:107], v[128:131], v[16:19]
    ds_read_b64_tr_b16 v[154:155], v170 offset:53760
    v_mfma_f32_16x16x32_bf16 v[20:23], v[104:107], v[132:135], v[20:23]
    ds_read_b64_tr_b16 v[156:157], v171 offset:53248
    v_mfma_f32_16x16x32_bf16 v[24:27], v[120:123], v[108:111], v[24:27]
    ds_read_b64_tr_b16 v[158:159], v171 offset:53760
    v_mfma_f32_16x16x32_bf16 v[28:31], v[124:127], v[108:111], v[28:31]
    ds_read_b128 v[140:143], v169 offset:51200
    v_mfma_f32_16x16x32_bf16 v[32:35], v[108:111], v[128:131], v[32:35]
    ds_read_b64_tr_b16 v[160:161], v170 offset:61440
    v_mfma_f32_16x16x32_bf16 v[36:39], v[108:111], v[132:135], v[36:39]
    ds_read_b64_tr_b16 v[162:163], v170 offset:61952
    v_mfma_f32_16x16x32_bf16 v[40:43], v[120:123], v[112:115], v[40:43]
    ds_read_b64_tr_b16 v[164:165], v171 offset:61440
    v_mfma_f32_16x16x32_bf16 v[44:47], v[124:127], v[112:115], v[44:47]
    ds_read_b64_tr_b16 v[166:167], v171 offset:61952
    v_mfma_f32_16x16x32_bf16 v[48:51], v[112:115], v[128:131], v[48:51]
    ds_read_b128 v[144:147], v169 offset:53248
    v_mov_b32 v246, s76
    v_mfma_f32_16x16x32_bf16 v[52:55], v[112:115], v[132:135], v[52:55]
    ds_read_b128 v[148:151], v169 offset:55296
    v_add_u32 v244, s75, v5
    v_mfma_f32_16x16x32_bf16 v[56:59], v[120:123], v[116:119], v[56:59]
    v_add_u32 v243, s74, v5
    v_mfma_f32_16x16x32_bf16 v[60:63], v[124:127], v[116:119], v[60:63]
    v_add_u32 v242, s73, v6
    v_mfma_f32_16x16x32_bf16 v[64:67], v[116:119], v[128:131], v[64:67]
    v_add_u32 v241, s72, v6
    v_mfma_f32_16x16x32_bf16 v[68:71], v[116:119], v[132:135], v[68:71]
    v_add_u32 v240, s72, v4
    s_waitcnt lgkmcnt(0)
    v_mov_b32 v7, 16
    ds_write_b32 v249, v7
    v_mfma_f32_16x16x32_bf16 v[8:11], v[152:155], v[136:139], v[8:11]
    ds_read_b64 v[200:201], v245 offset:0
    v_mfma_f32_16x16x32_bf16 v[12:15], v[156:159], v[136:139], v[12:15]
    ds_read_b64 v[202:203], v245 offset:32
    v_mfma_f32_16x16x32_bf16 v[24:27], v[152:155], v[140:143], v[24:27]
    ds_read_b64 v[204:205], v245 offset:64
    v_mfma_f32_16x16x32_bf16 v[28:31], v[156:159], v[140:143], v[28:31]
    ds_read_b64 v[206:207], v245 offset:96
    v_mfma_f32_16x16x32_bf16 v[40:43], v[152:155], v[144:147], v[40:43]
    ds_read_b64 v[208:209], v247 offset:0
    v_mfma_f32_16x16x32_bf16 v[44:47], v[156:159], v[144:147], v[44:47]
    ds_read_b64 v[210:211], v247 offset:32
    v_mfma_f32_16x16x32_bf16 v[56:59], v[152:155], v[148:151], v[56:59]
    ds_read_b64 v[212:213], v247 offset:64
    v_mfma_f32_16x16x32_bf16 v[60:63], v[156:159], v[148:151], v[60:63]
    ds_read_b64 v[214:215], v247 offset:96
    v_mfma_f32_16x16x32_bf16 v[16:19], v[136:139], v[160:163], v[16:19]
    v_cvt_pk_bf16_f32 v104, v8, v9
L_hk8:
    s_cbranch_execz L_hr8
    v_cvt_pk_bf16_f32 v105, v10, v11
    v_mfma_f32_16x16x32_bf16 v[20:23], v[136:139], v[164:167], v[20:23]
    v_cvt_pk_bf16_f32 v106, v12, v13
    v_cvt_pk_bf16_f32 v107, v14, v15
    v_mfma_f32_16x16x32_bf16 v[32:35], v[140:143], v[160:163], v[32:35]
    v_cvt_pk_bf16_f32 v108, v24, v25
    v_cvt_pk_bf16_f32 v109, v26, v27
    v_mfma_f32_16x16x32_bf16 v[36:39], v[140:143], v[164:167], v[36:39]
    v_cvt_pk_bf16_f32 v110, v28, v29
    v_cvt_pk_bf16_f32 v111, v30, v31
    v_mfma_f32_16x16x32_bf16 v[48:51], v[144:147], v[160:163], v[48:51]
    v_cvt_pk_bf16_f32 v112, v40, v41
    v_cvt_pk_bf16_f32 v113, v42, v43
    v_mfma_f32_16x16x32_bf16 v[52:55], v[144:147], v[164:167], v[52:55]
    v_cvt_pk_bf16_f32 v114, v44, v45
    v_cvt_pk_bf16_f32 v115, v46, v47
    v_mfma_f32_16x16x32_bf16 v[64:67], v[148:151], v[160:163], v[64:67]
    v_cvt_pk_bf16_f32 v116, v56, v57
    v_cvt_pk_bf16_f32 v117, v58, v59
    v_mfma_f32_16x16x32_bf16 v[68:71], v[148:151], v[164:167], v[68:71]
    v_cvt_pk_bf16_f32 v118, v60, v61
    v_cvt_pk_bf16_f32 v119, v62, v63
    v_readfirstlane_b32 s88, v185
    v_readfirstlane_b32 s32, v187
    v_mfma_f32_16x16x32_bf16 v[120:123], v[172:175], v[104:107], 0
    v_cvt_pk_bf16_f32 v152, v16, v17
    v_cvt_pk_bf16_f32 v153, v18, v19
    v_mfma_f32_16x16x32_bf16 v[124:127], v[176:179], v[104:107], 0
    v_cvt_pk_bf16_f32 v156, v20, v21
    v_cvt_pk_bf16_f32 v157, v22, v23
    v_mfma_f32_16x16x32_bf16 v[128:131], v[172:175], v[108:111], 0
    v_cvt_pk_bf16_f32 v154, v32, v33
L_hk9:
    s_cbranch_execz L_hr9
    v_cvt_pk_bf16_f32 v155, v34, v35
    v_mfma_f32_16x16x32_bf16 v[132:135], v[176:179], v[108:111], 0
    v_cvt_pk_bf16_f32 v158, v36, v37
    v_cvt_pk_bf16_f32 v159, v38, v39
    v_mfma_f32_16x16x32_bf16 v[136:139], v[172:175], v[112:115], 0
    v_cvt_pk_bf16_f32 v160, v48, v49
    v_cvt_pk_bf16_f32 v161, v50, v51
    v_mfma_f32_16x16x32_bf16 v[140:143], v[176:179], v[112:115], 0
    v_cvt_pk_bf16_f32 v164, v52, v53
    v_cvt_pk_bf16_f32 v165, v54, v55
    v_mfma_f32_16x16x32_bf16 v[144:147], v[172:175], v[116:119], 0
    v_cvt_pk_bf16_f32 v162, v64, v65
    v_cvt_pk_bf16_f32 v163, v66, v67
    v_mfma_f32_16x16x32_bf16 v[148:151], v[176:179], v[116:119], 0
    v_cvt_pk_bf16_f32 v166, v68, v69
    v_cvt_pk_bf16_f32 v167, v70, v71
    ds_read_b128 v[192:195], v251 offset:80
    v_max3_f32 v224, v120, v121, v122
    v_min3_f32 v232, v120, v121, v122
    v_max3_f32 v224, v224, v123, v124
    v_min3_f32 v232, v232, v123, v124
    v_max3_f32 v224, v224, v125, v126
    v_min3_f32 v232, v232, v125, v126
    v_max_f32 v224, v224, v127
    v_min_f32 v232, v232, v127
    v_max3_f32 v226, v128, v129, v130
    v_min3_f32 v234, v128, v129, v130
    v_max3_f32 v226, v226, v131, v132
    v_min3_f32 v234, v234, v131, v132
    v_max3_f32 v226, v226, v133, v134
    v_min3_f32 v234, v234, v133, v134
    v_max_f32 v226, v226, v135
L_hk10:
    s_cbranch_execz L_hr10
    v_min_f32 v234, v234, v135
    v_max3_f32 v228, v136, v137, v138
    v_min3_f32 v236, v136, v137, v138
    v_max3_f32 v228, v228, v139, v140
    v_min3_f32 v236, v236, v139, v140
    v_max3_f32 v228, v228, v141, v142
    v_min3_f32 v236, v236, v141, v142
    v_max_f32 v228, v228, v143
    v_min_f32 v236, v236, v143
    v_max3_f32 v230, v144, v145, v146
    v_min3_f32 v238, v144, v145, v146
    v_max3_f32 v230, v230, v147, v148
    v_min3_f32 v238, v238, v147, v148
    v_max3_f32 v230, v230, v149, v150
    v_min3_f32 v238, v238, v149, v150
    v_max_f32 v230, v230, v151
    v_min_f32 v238, v238, v151
    v_permlane32_swap_b32 v224, v228
    v_permlane32_swap_b32 v226, v230
    v_permlane32_swap_b32 v232, v236
    v_permlane32_swap_b32 v234, v238
    v_max_f32 v224, v224, v228
    v_max_f32 v226, v226, v230
    v_min_f32 v232, v232, v236
    v_min_f32 v234, v234, v238
    v_permlane16_swap_b32 v224, v226
    s_nop 0
    v_permlane16_swap_b32 v232, v234
    v_max_f32 v224, v224, v226
    v_min_f32 v232, v232, v234
    v_mul_f32 v224, v224, v181
    v_mul_f32 v232, v232, v181
L_hk11:
    s_cbranch_execz L_hr11
    v_mov_b32 v226, v224
    v_mov_b32 v234, v232
    s_nop 0
    v_permlane16_swap_b32 v224, v226
    v_permlane16_swap_b32 v232, v234
    v_mov_b32 v228, v224
    v_mov_b32 v230, v226
    v_mov_b32 v236, v232
    v_mov_b32 v238, v234
    v_permlane32_swap_b32 v224, v228
    v_permlane32_swap_b32 v226, v230
    v_permlane32_swap_b32 v232, v236
    v_permlane32_swap_b32 v234, v238
    v_pk_fma_f32 v[8:9], v[120:121], v[248:249], v[224:225] op_sel_hi:[1,0,0] neg_lo:[0,0,1] neg_hi:[0,0,1]
    v_pk_fma_f32 v[16:17], v[120:121], v[248:249], v[232:233] op_sel_hi:[1,0,0] neg_lo:[1,0,0] neg_hi:[1,0,0]
    v_pk_fma_f32 v[10:11], v[122:123], v[248:249], v[224:225] op_sel_hi:[1,0,0] neg_lo:[0,0,1] neg_hi:[0,0,1]
    v_pk_fma_f32 v[18:19], v[122:123], v[248:249], v[232:233] op_sel_hi:[1,0,0] neg_lo:[1,0,0] neg_hi:[1,0,0]
    v_pk_fma_f32 v[12:13], v[124:125], v[248:249], v[224:225] op_sel_hi:[1,0,0] neg_lo:[0,0,1] neg_hi:[0,0,1]
    v_pk_fma_f32 v[20:21], v[124:125], v[248:249], v[232:233] op_sel_hi:[1,0,0] neg_lo:[1,0,0] neg_hi:[1,0,0]
    v_pk_fma_f32 v[14:15], v[126:127], v[248:249], v[224:225] op_sel_hi:[1,0,0] neg_lo:[0,0,1] neg_hi:[0,0,1]
    v_pk_fma_f32 v[22:23], v[126:127], v[248:249], v[232:233] op_sel_hi:[1,0,0] neg_lo:[1,0,0] neg_hi:[1,0,0]
L_sf:
    s_waitcnt lgkmcnt(0)
    v_min_u32 v192, v192, v193
    v_min3_u32 v192, v192, v194, v195
    s_nop 0
    v_readfirstlane_b32 s3, v192
    s_nop 0
    s_cmp_ge_u32 s3, 16
    s_cbranch_scc1 L_sfd
    ds_read_b128 v[192:195], v251 offset:80
    s_branch L_sf
L_sfd:
    ds_write_b128 v243, v[152:155] offset:0
    v_exp_f32 v8, v8
L_hk12:
    s_cbranch_execz L_hr12
    v_exp_f32 v9, v9
    v_exp_f32 v10, v10
    v_exp_f32 v11, v11
    v_exp_f32 v12, v12
    v_exp_f32 v13, v13
    v_exp_f32 v14, v14
    v_exp_f32 v15, v15
    v_exp_f32 v16, v16
    v_exp_f32 v17, v17
    v_exp_f32 v18, v18
    v_exp_f32 v19, v19
    v_exp_f32 v20, v20
    v_exp_f32 v21, v21
    v_exp_f32 v22, v22
    v_exp_f32 v23, v23
    v_pk_fma_f32 v[24:25], v[128:129], v[250:251], v[226:227] op_sel_hi:[1,0,0] neg_lo:[0,0,1] neg_hi:[0,0,1]
    v_pk_fma_f32 v[32:33], v[128:129], v[250:251], v[234:235] op_sel_hi:[1,0,0] neg_lo:[1,0,0] neg_hi:[1,0,0]
    v_pk_fma_f32 v[26:27], v[130:131], v[250:251], v[226:227] op_sel_hi:[1,0,0] neg_lo:[0,0,1] neg_hi:[0,0,1]
    v_pk_fma_f32 v[34:35], v[130:131], v[250:251], v[234:235] op_sel_hi:[1,0,0] neg_lo:[1,0,0] neg_hi:[1,0,0]
    v_pk_fma_f32 v[28:29], v[132:133], v[250:251], v[226:227] op_sel_hi:[1,0,0] neg_lo:[0,0,1] neg_hi:[0,0,1]
    v_pk_fma_f32 v[36:37], v[132:133], v[250:251], v[234:235] op_sel_hi:[1,0,0] neg_lo:[1,0,0] neg_hi:[1,0,0]
    v_pk_fma_f32 v[30:31], v[134:135], v[250:251], v[226:227] op_sel_hi:[1,0,0] neg_lo:[0,0,1] neg_hi:[0,0,1]
    v_pk_fma_f32 v[38:39], v[134:135], v[250:251], v[234:235] op_sel_hi:[1,0,0] neg_lo:[1,0,0] neg_hi:[1,0,0]
    ds_write_b128 v243, v[156:159] offset:1024
    v_exp_f32 v24, v24
    v_exp_f32 v25, v25
    v_exp_f32 v26, v26
    v_exp_f32 v27, v27
    v_exp_f32 v28, v28
    v_exp_f32 v29, v29
    v_exp_f32 v30, v30
    v_exp_f32 v31, v31
L_hk13:
    s_cbranch_execz L_hr13
    v_exp_f32 v32, v32
    v_exp_f32 v33, v33
    v_exp_f32 v34, v34
    v_exp_f32 v35, v35
    v_exp_f32 v36, v36
    v_exp_f32 v37, v37
    v_exp_f32 v38, v38
    v_exp_f32 v39, v39
    v_pk_fma_f32 v[40:41], v[136:137], v[252:253], v[228:229] op_sel_hi:[1,0,0] neg_lo:[0,0,1] neg_hi:[0,0,1]
    v_pk_fma_f32 v[48:49], v[136:137], v[252:253], v[236:237] op_sel_hi:[1,0,0] neg_lo:[1,0,0] neg_hi:[1,0,0]
    v_pk_fma_f32 v[42:43], v[138:139], v[252:253], v[228:229] op_sel_hi:[1,0,0] neg_lo:[0,0,1] neg_hi:[0,0,1]
    v_pk_fma_f32 v[50:51], v[138:139], v[252:253], v[236:237] op_sel_hi:[1,0,0] neg_lo:[1,0,0] neg_hi:[1,0,0]
    v_pk_fma_f32 v[44:45], v[140:141], v[252:253], v[228:229] op_sel_hi:[1,0,0] neg_lo:[0,0,1] neg_hi:[0,0,1]
    v_pk_fma_f32 v[52:53], v[140:141], v[252:253], v[236:237] op_sel_hi:[1,0,0] neg_lo:[1,0,0] neg_hi:[1,0,0]
    v_pk_fma_f32 v[46:47], v[142:143], v[252:253], v[228:229] op_sel_hi:[1,0,0] neg_lo:[0,0,1] neg_hi:[0,0,1]
    v_pk_fma_f32 v[54:55], v[142:143], v[252:253], v[236:237] op_sel_hi:[1,0,0] neg_lo:[1,0,0] neg_hi:[1,0,0]
    ds_write_b128 v243, v[160:163] offset:2048
    v_exp_f32 v40, v40
    v_exp_f32 v41, v41
    v_exp_f32 v42, v42
    v_exp_f32 v43, v43
    v_exp_f32 v44, v44
    v_exp_f32 v45, v45
    v_exp_f32 v46, v46
    v_exp_f32 v47, v47
    v_exp_f32 v48, v48
    v_exp_f32 v49, v49
    v_exp_f32 v50, v50
    v_exp_f32 v51, v51
    v_exp_f32 v52, v52
    v_exp_f32 v53, v53
    v_exp_f32 v54, v54
L_hk14:
    s_cbranch_execz L_hr14
    v_exp_f32 v55, v55
    v_pk_fma_f32 v[56:57], v[144:145], v[254:255], v[230:231] op_sel_hi:[1,0,0] neg_lo:[0,0,1] neg_hi:[0,0,1]
    v_pk_fma_f32 v[64:65], v[144:145], v[254:255], v[238:239] op_sel_hi:[1,0,0] neg_lo:[1,0,0] neg_hi:[1,0,0]
    v_pk_fma_f32 v[58:59], v[146:147], v[254:255], v[230:231] op_sel_hi:[1,0,0] neg_lo:[0,0,1] neg_hi:[0,0,1]
    v_pk_fma_f32 v[66:67], v[146:147], v[254:255], v[238:239] op_sel_hi:[1,0,0] neg_lo:[1,0,0] neg_hi:[1,0,0]
    v_pk_fma_f32 v[60:61], v[148:149], v[254:255], v[230:231] op_sel_hi:[1,0,0] neg_lo:[0,0,1] neg_hi:[0,0,1]
    v_pk_fma_f32 v[68:69], v[148:149], v[254:255], v[238:239] op_sel_hi:[1,0,0] neg_lo:[1,0,0] neg_hi:[1,0,0]
    v_pk_fma_f32 v[62:63], v[150:151], v[254:255], v[230:231] op_sel_hi:[1,0,0] neg_lo:[0,0,1] neg_hi:[0,0,1]
    v_pk_fma_f32 v[70:71], v[150:151], v[254:255], v[238:239] op_sel_hi:[1,0,0] neg_lo:[1,0,0] neg_hi:[1,0,0]
    ds_write_b128 v243, v[164:167] offset:3072
    v_exp_f32 v56, v56
    v_exp_f32 v57, v57
    v_exp_f32 v58, v58
    v_exp_f32 v59, v59
    v_exp_f32 v60, v60
    v_exp_f32 v61, v61
    v_exp_f32 v62, v62
    v_exp_f32 v63, v63
    v_exp_f32 v64, v64
    v_exp_f32 v65, v65
    v_exp_f32 v66, v66
    v_exp_f32 v67, v67
    v_exp_f32 v68, v68
    v_exp_f32 v69, v69
    v_exp_f32 v70, v70
    v_exp_f32 v71, v71
    v_pk_add_f32 v[120:121], v[8:9], v[10:11]
    v_pk_add_f32 v[122:123], v[12:13], v[14:15]
    v_pk_add_f32 v[124:125], v[16:17], v[18:19]
    v_pk_add_f32 v[126:127], v[20:21], v[22:23]
    v_pk_add_f32 v[128:129], v[24:25], v[26:27]
    v_pk_add_f32 v[130:131], v[28:29], v[30:31]
L_hk15:
    s_cbranch_execz L_hr15
    v_pk_add_f32 v[132:133], v[32:33], v[34:35]
    v_pk_add_f32 v[134:135], v[36:37], v[38:39]
    v_pk_add_f32 v[136:137], v[40:41], v[42:43]
    v_pk_add_f32 v[138:139], v[44:45], v[46:47]
    v_pk_add_f32 v[140:141], v[48:49], v[50:51]
    v_pk_add_f32 v[142:143], v[52:53], v[54:55]
    v_pk_add_f32 v[144:145], v[56:57], v[58:59]
    v_pk_add_f32 v[146:147], v[60:61], v[62:63]
    v_pk_add_f32 v[148:149], v[64:65], v[66:67]
    v_pk_add_f32 v[150:151], v[68:69], v[70:71]
    v_pk_add_f32 v[120:121], v[120:121], v[122:123]
    v_pk_add_f32 v[124:125], v[124:125], v[126:127]
    v_pk_add_f32 v[128:129], v[128:129], v[130:131]
    v_pk_add_f32 v[132:133], v[132:133], v[134:135]
    v_pk_add_f32 v[136:137], v[136:137], v[138:139]
    v_pk_add_f32 v[140:141], v[140:141], v[142:143]
    v_pk_add_f32 v[144:145], v[144:145], v[146:147]
    v_pk_add_f32 v[148:149], v[148:149], v[150:151]
    v_add_f32 v224, v120, v121
    v_add_f32 v232, v124, v125
    v_add_f32 v226, v128, v129
    v_add_f32 v234, v132, v133
    v_add_f32 v228, v136, v137
    v_add_f32 v236, v140, v141
    v_add_f32 v230, v144, v145
    v_add_f32 v238, v148, v149
    v_permlane32_swap_b32 v224, v228
    v_permlane32_swap_b32 v226, v230
    v_permlane32_swap_b32 v232, v236
    v_permlane32_swap_b32 v234, v238
    v_add_f32 v224, v224, v228
    v_add_f32 v226, v226, v230
L_hk16:
    s_cbranch_execz L_hr16
    v_add_f32 v232, v232, v236
    v_add_f32 v234, v234, v238
    v_permlane16_swap_b32 v224, v226
    s_nop 0
    v_permlane16_swap_b32 v232, v234
    v_add_f32 v224, v224, v226
    v_add_f32 v232, v232, v234
    v_rcp_f32 v224, v224
    v_rcp_f32 v232, v232
    v_mul_f32 v224, v224, v183
    v_mul_f32 v232, v232, v183
    v_mov_b32 v226, v224
    v_mov_b32 v234, v232
    s_nop 0
    v_permlane16_swap_b32 v224, v226
    v_permlane16_swap_b32 v232, v234
    v_mov_b32 v228, v224
    v_mov_b32 v230, v226
    v_mov_b32 v236, v232
    v_mov_b32 v238, v234
    v_permlane32_swap_b32 v224, v228
    v_permlane32_swap_b32 v226, v230
    v_permlane32_swap_b32 v232, v236
    v_permlane32_swap_b32 v234, v238
    v_pk_mul_f32 v[8:9], v[8:9], v[224:225] op_sel_hi:[1,0]
    v_pk_mul_f32 v[10:11], v[10:11], v[224:225] op_sel_hi:[1,0]
    v_pk_mul_f32 v[12:13], v[12:13], v[224:225] op_sel_hi:[1,0]
    v_pk_mul_f32 v[14:15], v[14:15], v[224:225] op_sel_hi:[1,0]
    v_cvt_pk_bf16_f32 v104, v8, v9
    v_cvt_pk_bf16_f32 v105, v10, v11
    ds_write_b64 v240, v[104:105] offset:0
    v_cvt_pk_bf16_f32 v106, v12, v13
L_hk17:
    s_cbranch_execz L_hr17
    v_cvt_pk_bf16_f32 v107, v14, v15
    ds_write_b64 v240, v[106:107] offset:32
    v_pk_mul_f32 v[16:17], v[16:17], v[232:233] op_sel_hi:[1,0]
    v_pk_mul_f32 v[18:19], v[18:19], v[232:233] op_sel_hi:[1,0]
    v_pk_mul_f32 v[20:21], v[20:21], v[232:233] op_sel_hi:[1,0]
    v_pk_mul_f32 v[22:23], v[22:23], v[232:233] op_sel_hi:[1,0]
    v_cvt_pk_bf16_f32 v108, v16, v17
    v_cvt_pk_bf16_f32 v109, v18, v19
    ds_write_b64 v240, v[108:109] offset:64
    v_cvt_pk_bf16_f32 v110, v20, v21
    v_cvt_pk_bf16_f32 v111, v22, v23
    ds_write_b64 v240, v[110:111] offset:96
    v_pk_mul_f32 v[24:25], v[24:25], v[226:227] op_sel_hi:[1,0]
    v_pk_mul_f32 v[26:27], v[26:27], v[226:227] op_sel_hi:[1,0]
    v_pk_mul_f32 v[28:29], v[28:29], v[226:227] op_sel_hi:[1,0]
    v_pk_mul_f32 v[30:31], v[30:31], v[226:227] op_sel_hi:[1,0]
    v_cvt_pk_bf16_f32 v112, v24, v25
    v_cvt_pk_bf16_f32 v113, v26, v27
    ds_write_b64 v240, v[112:113] offset:2176
    v_cvt_pk_bf16_f32 v114, v28, v29
    v_cvt_pk_bf16_f32 v115, v30, v31
    ds_write_b64 v240, v[114:115] offset:2208
    v_pk_mul_f32 v[32:33], v[32:33], v[234:235] op_sel_hi:[1,0]
    v_pk_mul_f32 v[34:35], v[34:35], v[234:235] op_sel_hi:[1,0]
    v_pk_mul_f32 v[36:37], v[36:37], v[234:235] op_sel_hi:[1,0]
    v_pk_mul_f32 v[38:39], v[38:39], v[234:235] op_sel_hi:[1,0]
    v_cvt_pk_bf16_f32 v116, v32, v33
    v_cvt_pk_bf16_f32 v117, v34, v35
    ds_write_b64 v240, v[116:117] offset:2240
    v_cvt_pk_bf16_f32 v118, v36, v37
    v_cvt_pk_bf16_f32 v119, v38, v39
    ds_write_b64 v240, v[118:119] offset:2272
    ds_read_b64_tr_b16 v[120:121], v241 offset:0
    ds_read_b64_tr_b16 v[122:123], v241 offset:2176
    ds_read_b64_tr_b16 v[124:125], v241 offset:32
    ds_read_b64_tr_b16 v[126:127], v241 offset:2208
    v_pk_mul_f32 v[40:41], v[40:41], v[228:229] op_sel_hi:[1,0]
L_hk18:
    s_cbranch_execz L_hr18
    v_pk_mul_f32 v[42:43], v[42:43], v[228:229] op_sel_hi:[1,0]
    v_pk_mul_f32 v[44:45], v[44:45], v[228:229] op_sel_hi:[1,0]
    v_pk_mul_f32 v[46:47], v[46:47], v[228:229] op_sel_hi:[1,0]
    v_cvt_pk_bf16_f32 v104, v40, v41
    v_cvt_pk_bf16_f32 v105, v42, v43
    ds_write_b64 v240, v[104:105] offset:4352
    v_cvt_pk_bf16_f32 v106, v44, v45
    v_cvt_pk_bf16_f32 v107, v46, v47
    ds_write_b64 v240, v[106:107] offset:4384
    v_pk_mul_f32 v[48:49], v[48:49], v[236:237] op_sel_hi:[1,0]
    v_pk_mul_f32 v[50:51], v[50:51], v[236:237] op_sel_hi:[1,0]
    v_pk_mul_f32 v[52:53], v[52:53], v[236:237] op_sel_hi:[1,0]
    v_pk_mul_f32 v[54:55], v[54:55], v[236:237] op_sel_hi:[1,0]
    v_cvt_pk_bf16_f32 v108, v48, v49
    v_cvt_pk_bf16_f32 v109, v50, v51
    ds_write_b64 v240, v[108:109] offset:4416
    v_cvt_pk_bf16_f32 v110, v52, v53
    v_cvt_pk_bf16_f32 v111, v54, v55
    ds_write_b64 v240, v[110:111] offset:4448
    v_pk_mul_f32 v[56:57], v[56:57], v[230:231] op_sel_hi:[1,0]
    v_pk_mul_f32 v[58:59], v[58:59], v[230:231] op_sel_hi:[1,0]
    v_pk_mul_f32 v[60:61], v[60:61], v[230:231] op_sel_hi:[1,0]
    v_pk_mul_f32 v[62:63], v[62:63], v[230:231] op_sel_hi:[1,0]
    v_cvt_pk_bf16_f32 v112, v56, v57
    v_cvt_pk_bf16_f32 v113, v58, v59
    ds_write_b64 v240, v[112:113] offset:6528
    v_cvt_pk_bf16_f32 v114, v60, v61
    v_cvt_pk_bf16_f32 v115, v62, v63
    ds_write_b64 v240, v[114:115] offset:6560
    v_pk_mul_f32 v[64:65], v[64:65], v[238:239] op_sel_hi:[1,0]
    v_pk_mul_f32 v[66:67], v[66:67], v[238:239] op_sel_hi:[1,0]
    v_pk_mul_f32 v[68:69], v[68:69], v[238:239] op_sel_hi:[1,0]
L_hk19:
    s_cbranch_execz L_hr19
    v_pk_mul_f32 v[70:71], v[70:71], v[238:239] op_sel_hi:[1,0]
    v_cvt_pk_bf16_f32 v116, v64, v65
    v_cvt_pk_bf16_f32 v117, v66, v67
    ds_write_b64 v240, v[116:117] offset:6592
    v_cvt_pk_bf16_f32 v118, v68, v69
    v_cvt_pk_bf16_f32 v119, v70, v71
    ds_write_b64 v240, v[118:119] offset:6624
    v_mov_b32 v7, 1
    ds_write_b32 v249, v7 offset:32
    ds_read_b32 v7, v246
    ds_read_b64_tr_b16 v[128:129], v241 offset:4352
    ds_read_b64_tr_b16 v[130:131], v241 offset:6528
    ds_read_b64_tr_b16 v[132:133], v241 offset:4384
    ds_read_b64_tr_b16 v[134:135], v241 offset:6560
    ds_read_b128 v[192:195], v251 offset:48
    s_waitcnt lgkmcnt(14)
    v_mfma_f32_16x16x32_bf16 v[8:11], v[120:123], v[152:155], 0
    v_mov_b32 v59, s32
    v_mfma_f32_16x16x32_bf16 v[12:15], v[120:123], v[156:159], 0
    v_mov_b32 v63, s32
    v_mfma_f32_16x16x32_bf16 v[24:27], v[120:123], v[200:203], 0
    v_mov_b32 v67, s32
    v_mfma_f32_16x16x32_bf16 v[16:19], v[124:127], v[152:155], 0
    v_mov_b32 v71, s32
    v_mfma_f32_16x16x32_bf16 v[20:23], v[124:127], v[156:159], 0
    v_mfma_f32_16x16x32_bf16 v[28:31], v[124:127], v[200:203], 0
    s_waitcnt lgkmcnt(0)
L_ex:
    v_readfirstlane_b32 s65, v7
    s_nop 0
    s_cmp_ge_u32 s65, 1
    s_cbranch_scc1 L_exd
    ds_read_b32 v7, v246
    s_waitcnt lgkmcnt(0)
    s_branch L_ex
L_exd:
    v_mfma_f32_16x16x32_bf16 v[8:11], v[128:131], v[160:163], v[8:11]
    ds_read_b64_tr_b16 v[136:137], v242 offset:0
    ds_read_b64_tr_b16 v[138:139], v242 offset:2176
    v_mfma_f32_16x16x32_bf16 v[12:15], v[128:131], v[164:167], v[12:15]
    ds_read_b64_tr_b16 v[140:141], v242 offset:32
    ds_read_b64_tr_b16 v[142:143], v242 offset:2208
    v_mfma_f32_16x16x32_bf16 v[24:27], v[128:131], v[204:207], v[24:27]
    ds_read_b128 v[32:35], v244 offset:0
    ds_read_b128 v[36:39], v244 offset:1024
    v_mfma_f32_16x16x32_bf16 v[16:19], v[132:135], v[160:163], v[16:19]
    ds_read_b64_tr_b16 v[144:145], v242 offset:4352
    ds_read_b64_tr_b16 v[146:147], v242 offset:6528
    v_mfma_f32_16x16x32_bf16 v[20:23], v[132:135], v[164:167], v[20:23]
    ds_read_b64_tr_b16 v[148:149], v242 offset:4384
    ds_read_b64_tr_b16 v[150:151], v242 offset:6560
    v_mfma_f32_16x16x32_bf16 v[28:31], v[132:135], v[204:207], v[28:31]
    ds_read_b128 v[40:43], v244 offset:2048
    ds_read_b128 v[44:47], v244 offset:3072
    s_waitcnt lgkmcnt(6)
    v_mfma_f32_16x16x32_bf16 v[8:11], v[136:139], v[32:35], v[8:11]
    v_mfma_f32_16x16x32_bf16 v[12:15], v[136:139], v[36:39], v[12:15]
    v_mfma_f32_16x16x32_bf16 v[24:27], v[136:139], v[208:211], v[24:27]
    v_mfma_f32_16x16x32_bf16 v[16:19], v[140:143], v[32:35], v[16:19]
    v_mfma_f32_16x16x32_bf16 v[20:23], v[140:143], v[36:39], v[20:23]
    v_mfma_f32_16x16x32_bf16 v[28:31], v[140:143], v[208:211], v[28:31]
    s_waitcnt lgkmcnt(0)
    v_mfma_f32_16x16x32_bf16 v[8:11], v[144:147], v[40:43], v[8:11]
    v_mfma_f32_16x16x32_bf16 v[12:15], v[144:147], v[44:47], v[12:15]
    v_mfma_f32_16x16x32_bf16 v[24:27], v[144:147], v[212:215], v[24:27]
    v_mfma_f32_16x16x32_bf16 v[16:19], v[148:151], v[40:43], v[16:19]
    v_mfma_f32_16x16x32_bf16 v[20:23], v[148:151], v[44:47], v[20:23]
    v_mfma_f32_16x16x32_bf16 v[28:31], v[148:151], v[212:215], v[28:31]
L_qr:
L_hk20:
    s_cbranch_execz L_hr20
    v_and_b32 v192, v192, v193
    v_and_b32 v194, v194, v195
    v_and_b32 v192, v192, v194
    s_nop 0
    v_readfirstlane_b32 s65, v192
    s_nop 0
    s_cmp_eq_u32 s65, 1
    s_cbranch_scc1 L_qrd
    ds_read_b128 v[192:195], v251 offset:48
    s_waitcnt lgkmcnt(0)
    s_branch L_qr
L_qrd:
    ds_read_b128 v[104:107], v168 offset:0
    ds_read_b64_tr_b16 v[120:121], v189 offset:0
    ds_read_b64_tr_b16 v[122:123], v189 offset:512
    ds_read_b64_tr_b16 v[124:125], v191 offset:0
    ds_read_b64_tr_b16 v[126:127], v191 offset:512
    ds_read_b128 v[108:111], v168 offset:2048
    ds_read_b128 v[112:115], v168 offset:4096
    ds_read_b128 v[116:119], v168 offset:6144
    v_cvt_pk_bf16_f32 v56, v8, v9
    v_cvt_pk_bf16_f32 v57, v10, v11
    v_cvt_pk_bf16_f32 v58, v24, v25
    v_cvt_pk_bf16_f32 v64, v12, v13
    v_cvt_pk_bf16_f32 v65, v14, v15
    v_cvt_pk_bf16_f32 v66, v26, v27
    v_cvt_pk_bf16_f32 v60, v16, v17
    v_cvt_pk_bf16_f32 v61, v18, v19
    v_cvt_pk_bf16_f32 v62, v28, v29
    v_cvt_pk_bf16_f32 v68, v20, v21
    v_cvt_pk_bf16_f32 v69, v22, v23
    v_cvt_pk_bf16_f32 v70, v30, v31
    s_cmp_lg_u32 s88, 0
    s_cbranch_scc1 L_kr
    buffer_store_dwordx4 v[56:59], v5, s[12:15], s77 offen offset:0
    buffer_store_dwordx4 v[60:63], v5, s[12:15], s77 offen offset:1024
    buffer_store_dwordx4 v[64:67], v5, s[12:15], s77 offen offset:2048
    buffer_store_dwordx4 v[68:71], v5, s[12:15], s77 offen offset:3072
    s_branch L_ks
L_kr:
    buffer_store_dwordx4 v[56:59], v5, s[12:15], s77 offen offset:0 sc1
    buffer_store_dwordx4 v[60:63], v5, s[12:15], s77 offen offset:1024 sc1
    buffer_store_dwordx4 v[64:67], v5, s[12:15], s77 offen offset:2048 sc1
    buffer_store_dwordx4 v[68:71], v5, s[12:15], s77 offen offset:3072 sc1
L_ks:
L_hk21:
    s_cbranch_execz L_hr21
    v_mov_b32 v7, 3
    ds_write_b32 v249, v7 offset:32
    s_waitcnt lgkmcnt(0)
    v_mfma_f32_16x16x32_bf16 v[72:75], v[120:123], v[104:107], v[72:75]
    ds_read_b128 v[136:139], v169 offset:0
    v_mfma_f32_16x16x32_bf16 v[76:79], v[124:127], v[104:107], v[76:79]
    ds_read_b64_tr_b16 v[152:153], v189 offset:4096
    v_mfma_f32_16x16x32_bf16 v[80:83], v[120:123], v[108:111], v[80:83]
    ds_read_b64_tr_b16 v[154:155], v189 offset:4608
    v_mfma_f32_16x16x32_bf16 v[84:87], v[124:127], v[108:111], v[84:87]
    ds_read_b64_tr_b16 v[156:157], v191 offset:4096
    v_mfma_f32_16x16x32_bf16 v[88:91], v[120:123], v[112:115], v[88:91]
    ds_read_b64_tr_b16 v[158:159], v191 offset:4608
    v_mfma_f32_16x16x32_bf16 v[92:95], v[124:127], v[112:115], v[92:95]
    ds_read_b128 v[140:143], v169 offset:2048
    v_mfma_f32_16x16x32_bf16 v[96:99], v[120:123], v[116:119], v[96:99]
    ds_read_b128 v[144:147], v169 offset:4096
    v_mfma_f32_16x16x32_bf16 v[100:103], v[124:127], v[116:119], v[100:103]
    ds_read_b128 v[148:151], v169 offset:6144
    s_waitcnt lgkmcnt(0)
    v_mov_b32 v7, 17
    ds_write_b32 v249, v7
    v_mfma_f32_16x16x32_bf16 v[72:75], v[152:155], v[136:139], v[72:75]
    ds_read_b128 v[104:107], v168 offset:16384
    v_mfma_f32_16x16x32_bf16 v[76:79], v[156:159], v[136:139], v[76:79]
    ds_read_b64_tr_b16 v[120:121], v189 offset:8192
    v_mfma_f32_16x16x32_bf16 v[80:83], v[152:155], v[140:143], v[80:83]
    ds_read_b64_tr_b16 v[122:123], v189 offset:8704
    v_mfma_f32_16x16x32_bf16 v[84:87], v[156:159], v[140:143], v[84:87]
    ds_read_b64_tr_b16 v[124:125], v191 offset:8192
    v_mfma_f32_16x16x32_bf16 v[88:91], v[152:155], v[144:147], v[88:91]
    ds_read_b64_tr_b16 v[126:127], v191 offset:8704
    v_mfma_f32_16x16x32_bf16 v[92:95], v[156:159], v[144:147], v[92:95]
    ds_read_b128 v[108:111], v168 offset:18432
    v_mfma_f32_16x16x32_bf16 v[96:99], v[152:155], v[148:151], v[96:99]
    ds_read_b128 v[112:115], v168 offset:20480
    v_mfma_f32_16x16x32_bf16 v[100:103], v[156:159], v[148:151], v[100:103]
    ds_read_b128 v[116:119], v168 offset:22528
    s_waitcnt lgkmcnt(0)
    v_mfma_f32_16x16x32_bf16 v[72:75], v[120:123], v[104:107], v[72:75]
    ds_read_b128 v[136:139], v169 offset:16384
    v_mfma_f32_16x16x32_bf16 v[76:79], v[124:127], v[104:107], v[76:79]
    ds_read_b64_tr_b16 v[152:153], v189 offset:12288
    v_mfma_f32_16x16x32_bf16 v[80:83], v[120:123], v[108:111], v[80:83]
    ds_read_b64_tr_b16 v[154:155], v189 offset:12800
    v_mfma_f32_16x16x32_bf16 v[84:87], v[124:127], v[108:111], v[84:87]
    ds_read_b64_tr_b16 v[156:157], v191 offset:12288
    v_mfma_f32_16x16x32_bf16 v[88:91], v[120:123], v[112:115], v[88:91]
    ds_read_b64_tr_b16 v[158:159], v191 offset:12800
    v_mfma_f32_16x16x32_bf16 v[92:95], v[124:127], v[112:115], v[92:95]
    ds_read_b128 v[140:143], v169 offset:18432
    v_mfma_f32_16x16x32_bf16 v[96:99], v[120:123], v[116:119], v[96:99]
    ds_read_b128 v[144:147], v169 offset:20480
    v_mfma_f32_16x16x32_bf16 v[100:103], v[124:127], v[116:119], v[100:103]
    ds_read_b128 v[148:151], v169 offset:22528
    s_waitcnt lgkmcnt(0)
    v_mov_b32 v7, 18
    ds_write_b32 v249, v7
    v_mfma_f32_16x16x32_bf16 v[72:75], v[152:155], v[136:139], v[72:75]
    ds_read_b128 v[104:107], v168 offset:32768
    v_mfma_f32_16x16x32_bf16 v[76:79], v[156:159], v[136:139], v[76:79]
    ds_read_b64_tr_b16 v[120:121], v189 offset:16384
    v_mfma_f32_16x16x32_bf16 v[80:83], v[152:155], v[140:143], v[80:83]
    ds_read_b64_tr_b16 v[122:123], v189 offset:16896
    v_mfma_f32_16x16x32_bf16 v[84:87], v[156:159], v[140:143], v[84:87]
    ds_read_b64_tr_b16 v[124:125], v191 offset:16384
    v_mfma_f32_16x16x32_bf16 v[88:91], v[152:155], v[144:147], v[88:91]
    ds_read_b64_tr_b16 v[126:127], v191 offset:16896
    v_mfma_f32_16x16x32_bf16 v[92:95], v[156:159], v[144:147], v[92:95]
    ds_read_b128 v[108:111], v168 offset:34816
    v_mfma_f32_16x16x32_bf16 v[96:99], v[152:155], v[148:151], v[96:99]
    ds_read_b128 v[112:115], v168 offset:36864
    v_mfma_f32_16x16x32_bf16 v[100:103], v[156:159], v[148:151], v[100:103]
    ds_read_b128 v[116:119], v168 offset:38912
    s_waitcnt lgkmcnt(0)
    v_mfma_f32_16x16x32_bf16 v[72:75], v[120:123], v[104:107], v[72:75]
    ds_read_b128 v[136:139], v169 offset:32768
    v_mfma_f32_16x16x32_bf16 v[76:79], v[124:127], v[104:107], v[76:79]
    ds_read_b64_tr_b16 v[152:153], v189 offset:20480
    v_mfma_f32_16x16x32_bf16 v[80:83], v[120:123], v[108:111], v[80:83]
    ds_read_b64_tr_b16 v[154:155], v189 offset:20992
    v_mfma_f32_16x16x32_bf16 v[84:87], v[124:127], v[108:111], v[84:87]
    ds_read_b64_tr_b16 v[156:157], v191 offset:20480
    v_mfma_f32_16x16x32_bf16 v[88:91], v[120:123], v[112:115], v[88:91]
    ds_read_b64_tr_b16 v[158:159], v191 offset:20992
    v_mfma_f32_16x16x32_bf16 v[92:95], v[124:127], v[112:115], v[92:95]
    ds_read_b128 v[140:143], v169 offset:34816
    v_mfma_f32_16x16x32_bf16 v[96:99], v[120:123], v[116:119], v[96:99]
    ds_read_b128 v[144:147], v169 offset:36864
    v_mfma_f32_16x16x32_bf16 v[100:103], v[124:127], v[116:119], v[100:103]
    ds_read_b128 v[148:151], v169 offset:38912
    s_waitcnt lgkmcnt(0)
    v_mov_b32 v7, 19
    ds_write_b32 v249, v7
    v_mfma_f32_16x16x32_bf16 v[72:75], v[152:155], v[136:139], v[72:75]
    ds_read_b128 v[104:107], v168 offset:49152
    v_mfma_f32_16x16x32_bf16 v[76:79], v[156:159], v[136:139], v[76:79]
    ds_read_b64_tr_b16 v[120:121], v170 offset:16384
    v_mfma_f32_16x16x32_bf16 v[80:83], v[152:155], v[140:143], v[80:83]
    ds_read_b64_tr_b16 v[122:123], v170 offset:16896
    v_mfma_f32_16x16x32_bf16 v[84:87], v[156:159], v[140:143], v[84:87]
    ds_read_b64_tr_b16 v[124:125], v171 offset:16384
    v_mfma_f32_16x16x32_bf16 v[88:91], v[152:155], v[144:147], v[88:91]
    ds_read_b64_tr_b16 v[126:127], v171 offset:16896
    v_mfma_f32_16x16x32_bf16 v[92:95], v[156:159], v[144:147], v[92:95]
    ds_read_b128 v[108:111], v168 offset:51200
    v_mfma_f32_16x16x32_bf16 v[96:99], v[152:155], v[148:151], v[96:99]
    ds_read_b128 v[112:115], v168 offset:53248
    v_mfma_f32_16x16x32_bf16 v[100:103], v[156:159], v[148:151], v[100:103]
    ds_read_b128 v[116:119], v168 offset:55296
    s_waitcnt lgkmcnt(0)
    v_mfma_f32_16x16x32_bf16 v[72:75], v[120:123], v[104:107], v[72:75]
    ds_read_b128 v[136:139], v169 offset:49152
    v_mfma_f32_16x16x32_bf16 v[76:79], v[124:127], v[104:107], v[76:79]
    ds_read_b64_tr_b16 v[152:153], v170 offset:20480
    v_mfma_f32_16x16x32_bf16 v[80:83], v[120:123], v[108:111], v[80:83]
    ds_read_b64_tr_b16 v[154:155], v170 offset:20992
    v_mfma_f32_16x16x32_bf16 v[84:87], v[124:127], v[108:111], v[84:87]
    ds_read_b64_tr_b16 v[156:157], v171 offset:20480
    v_mfma_f32_16x16x32_bf16 v[88:91], v[120:123], v[112:115], v[88:91]
    ds_read_b64_tr_b16 v[158:159], v171 offset:20992
    v_mfma_f32_16x16x32_bf16 v[92:95], v[124:127], v[112:115], v[92:95]
    ds_read_b128 v[140:143], v169 offset:51200
    v_mfma_f32_16x16x32_bf16 v[96:99], v[120:123], v[116:119], v[96:99]
    ds_read_b128 v[144:147], v169 offset:53248
    v_mfma_f32_16x16x32_bf16 v[100:103], v[124:127], v[116:119], v[100:103]
    ds_read_b128 v[148:151], v169 offset:55296
    s_waitcnt lgkmcnt(0)
    v_mov_b32 v7, 20
    ds_write_b32 v249, v7
    v_mfma_f32_16x16x32_bf16 v[72:75], v[152:155], v[136:139], v[72:75]
    v_mfma_f32_16x16x32_bf16 v[76:79], v[156:159], v[136:139], v[76:79]
    v_mfma_f32_16x16x32_bf16 v[80:83], v[152:155], v[140:143], v[80:83]
    v_mfma_f32_16x16x32_bf16 v[84:87], v[156:159], v[140:143], v[84:87]
    v_mfma_f32_16x16x32_bf16 v[88:91], v[152:155], v[144:147], v[88:91]
    v_mfma_f32_16x16x32_bf16 v[92:95], v[156:159], v[144:147], v[92:95]
    v_mfma_f32_16x16x32_bf16 v[96:99], v[152:155], v[148:151], v[96:99]
    v_mfma_f32_16x16x32_bf16 v[100:103], v[156:159], v[148:151], v[100:103]
    s_nop 0
    v_pk_fma_f32 v[72:73], v[180:181], v[216:217], v[72:73] op_sel_hi:[0,1,1]
    v_pk_fma_f32 v[74:75], v[180:181], v[218:219], v[74:75] op_sel_hi:[0,1,1]
    v_pk_fma_f32 v[76:77], v[180:181], v[220:221], v[76:77] op_sel_hi:[0,1,1]
    v_pk_fma_f32 v[78:79], v[180:181], v[222:223], v[78:79] op_sel_hi:[0,1,1]
    v_pk_fma_f32 v[80:81], v[182:183], v[216:217], v[80:81] op_sel_hi:[0,1,1]
    v_pk_fma_f32 v[82:83], v[182:183], v[218:219], v[82:83] op_sel_hi:[0,1,1]
    v_pk_fma_f32 v[84:85], v[182:183], v[220:221], v[84:85] op_sel_hi:[0,1,1]
    v_pk_fma_f32 v[86:87], v[182:183], v[222:223], v[86:87] op_sel_hi:[0,1,1]
    v_pk_fma_f32 v[88:89], v[184:185], v[216:217], v[88:89] op_sel_hi:[0,1,1]
    v_pk_fma_f32 v[90:91], v[184:185], v[218:219], v[90:91] op_sel_hi:[0,1,1]
    v_pk_fma_f32 v[92:93], v[184:185], v[220:221], v[92:93] op_sel_hi:[0,1,1]
    v_pk_fma_f32 v[94:95], v[184:185], v[222:223], v[94:95] op_sel_hi:[0,1,1]
    v_pk_fma_f32 v[96:97], v[186:187], v[216:217], v[96:97] op_sel_hi:[0,1,1]
    v_pk_fma_f32 v[98:99], v[186:187], v[218:219], v[98:99] op_sel_hi:[0,1,1]
    v_pk_fma_f32 v[100:101], v[186:187], v[220:221], v[100:101] op_sel_hi:[0,1,1]
    v_pk_fma_f32 v[102:103], v[186:187], v[222:223], v[102:103] op_sel_hi:[0,1,1]
    v_cvt_pk_bf16_f32 v104, v72, v73
    v_cvt_pk_bf16_f32 v105, v74, v75
    v_cvt_pk_bf16_f32 v106, v76, v77
    v_cvt_pk_bf16_f32 v107, v78, v79
    s_nop 1
    v_mfma_f32_16x16x32_bf16 v[120:123], v[172:175], v[104:107], 0
    v_cvt_pk_bf16_f32 v108, v80, v81
    v_cvt_pk_bf16_f32 v109, v82, v83
    v_mfma_f32_16x16x32_bf16 v[124:127], v[176:179], v[104:107], 0
    v_cvt_pk_bf16_f32 v110, v84, v85
    v_cvt_pk_bf16_f32 v111, v86, v87
    s_nop 1
    v_mfma_f32_16x16x32_bf16 v[128:131], v[172:175], v[108:111], 0
    v_cvt_pk_bf16_f32 v112, v88, v89
    v_cvt_pk_bf16_f32 v113, v90, v91
    v_mfma_f32_16x16x32_bf16 v[132:135], v[176:179], v[108:111], 0
    v_cvt_pk_bf16_f32 v114, v92, v93
    v_cvt_pk_bf16_f32 v115, v94, v95
    s_nop 1
    v_mfma_f32_16x16x32_bf16 v[136:139], v[172:175], v[112:115], 0
    v_cvt_pk_bf16_f32 v116, v96, v97
    v_cvt_pk_bf16_f32 v117, v98, v99
    v_mfma_f32_16x16x32_bf16 v[140:143], v[176:179], v[112:115], 0
    v_cvt_pk_bf16_f32 v118, v100, v101
    v_cvt_pk_bf16_f32 v119, v102, v103
    s_nop 1
    v_mfma_f32_16x16x32_bf16 v[144:147], v[172:175], v[116:119], 0
    v_mfma_f32_16x16x32_bf16 v[148:151], v[176:179], v[116:119], 0
    v_max3_f32 v224, v120, v121, v122
    v_min3_f32 v232, v120, v121, v122
    v_max3_f32 v224, v224, v123, v124
    v_min3_f32 v232, v232, v123, v124
    v_max3_f32 v224, v224, v125, v126
    v_min3_f32 v232, v232, v125, v126
    v_max_f32 v224, v224, v127
    v_min_f32 v232, v232, v127
    v_max3_f32 v226, v128, v129, v130
    v_min3_f32 v234, v128, v129, v130
    v_max3_f32 v226, v226, v131, v132
    v_min3_f32 v234, v234, v131, v132
    v_max3_f32 v226, v226, v133, v134
    v_min3_f32 v234, v234, v133, v134
    v_max_f32 v226, v226, v135
    v_min_f32 v234, v234, v135
    v_max3_f32 v228, v136, v137, v138
    v_min3_f32 v236, v136, v137, v138
    v_max3_f32 v228, v228, v139, v140
    v_min3_f32 v236, v236, v139, v140
    v_max3_f32 v228, v228, v141, v142
    v_min3_f32 v236, v236, v141, v142
    v_max_f32 v228, v228, v143
    v_min_f32 v236, v236, v143
    v_max3_f32 v230, v144, v145, v146
    v_min3_f32 v238, v144, v145, v146
    v_max3_f32 v230, v230, v147, v148
    v_min3_f32 v238, v238, v147, v148
    v_max3_f32 v230, v230, v149, v150
    v_min3_f32 v238, v238, v149, v150
    v_max_f32 v230, v230, v151
    v_min_f32 v238, v238, v151
    v_permlane32_swap_b32 v224, v228
    v_permlane32_swap_b32 v226, v230
    v_permlane32_swap_b32 v232, v236
    v_permlane32_swap_b32 v234, v238
    v_max_f32 v224, v224, v228
    v_max_f32 v226, v226, v230
    v_min_f32 v232, v232, v236
    v_min_f32 v234, v234, v238
    v_permlane16_swap_b32 v224, v226
    s_nop 0
    v_permlane16_swap_b32 v232, v234
    v_max_f32 v224, v224, v226
    v_min_f32 v232, v232, v234
    v_mul_f32 v224, v224, v181
    v_mul_f32 v232, v232, v181
    v_mov_b32 v226, v224
    v_mov_b32 v234, v232
    s_nop 0
    v_permlane16_swap_b32 v224, v226
    v_permlane16_swap_b32 v232, v234
    v_mov_b32 v228, v224
    v_mov_b32 v230, v226
    v_mov_b32 v236, v232
    v_mov_b32 v238, v234
    v_permlane32_swap_b32 v224, v228
    v_permlane32_swap_b32 v226, v230
    v_permlane32_swap_b32 v232, v236
    v_permlane32_swap_b32 v234, v238
    v_pk_fma_f32 v[8:9], v[120:121], v[248:249], v[224:225] op_sel_hi:[1,0,0] neg_lo:[0,0,1] neg_hi:[0,0,1]
    v_pk_fma_f32 v[16:17], v[120:121], v[248:249], v[232:233] op_sel_hi:[1,0,0] neg_lo:[1,0,0] neg_hi:[1,0,0]
    v_pk_fma_f32 v[10:11], v[122:123], v[248:249], v[224:225] op_sel_hi:[1,0,0] neg_lo:[0,0,1] neg_hi:[0,0,1]
    v_pk_fma_f32 v[18:19], v[122:123], v[248:249], v[232:233] op_sel_hi:[1,0,0] neg_lo:[1,0,0] neg_hi:[1,0,0]
    v_pk_fma_f32 v[12:13], v[124:125], v[248:249], v[224:225] op_sel_hi:[1,0,0] neg_lo:[0,0,1] neg_hi:[0,0,1]
    v_pk_fma_f32 v[20:21], v[124:125], v[248:249], v[232:233] op_sel_hi:[1,0,0] neg_lo:[1,0,0] neg_hi:[1,0,0]
    v_pk_fma_f32 v[14:15], v[126:127], v[248:249], v[224:225] op_sel_hi:[1,0,0] neg_lo:[0,0,1] neg_hi:[0,0,1]
    v_pk_fma_f32 v[22:23], v[126:127], v[248:249], v[232:233] op_sel_hi:[1,0,0] neg_lo:[1,0,0] neg_hi:[1,0,0]
    v_exp_f32 v8, v8
    v_exp_f32 v9, v9
    v_exp_f32 v10, v10
    v_exp_f32 v11, v11
    v_exp_f32 v12, v12
    v_exp_f32 v13, v13
    v_exp_f32 v14, v14
    v_exp_f32 v15, v15
    v_exp_f32 v16, v16
    v_exp_f32 v17, v17
    v_exp_f32 v18, v18
    v_exp_f32 v19, v19
    v_exp_f32 v20, v20
    v_exp_f32 v21, v21
    v_exp_f32 v22, v22
    v_exp_f32 v23, v23
    v_pk_fma_f32 v[24:25], v[128:129], v[250:251], v[226:227] op_sel_hi:[1,0,0] neg_lo:[0,0,1] neg_hi:[0,0,1]
    v_pk_fma_f32 v[32:33], v[128:129], v[250:251], v[234:235] op_sel_hi:[1,0,0] neg_lo:[1,0,0] neg_hi:[1,0,0]
    v_pk_fma_f32 v[26:27], v[130:131], v[250:251], v[226:227] op_sel_hi:[1,0,0] neg_lo:[0,0,1] neg_hi:[0,0,1]
    v_pk_fma_f32 v[34:35], v[130:131], v[250:251], v[234:235] op_sel_hi:[1,0,0] neg_lo:[1,0,0] neg_hi:[1,0,0]
    v_pk_fma_f32 v[28:29], v[132:133], v[250:251], v[226:227] op_sel_hi:[1,0,0] neg_lo:[0,0,1] neg_hi:[0,0,1]
    v_pk_fma_f32 v[36:37], v[132:133], v[250:251], v[234:235] op_sel_hi:[1,0,0] neg_lo:[1,0,0] neg_hi:[1,0,0]
    v_pk_fma_f32 v[30:31], v[134:135], v[250:251], v[226:227] op_sel_hi:[1,0,0] neg_lo:[0,0,1] neg_hi:[0,0,1]
    v_pk_fma_f32 v[38:39], v[134:135], v[250:251], v[234:235] op_sel_hi:[1,0,0] neg_lo:[1,0,0] neg_hi:[1,0,0]
    v_exp_f32 v24, v24
    v_exp_f32 v25, v25
    v_exp_f32 v26, v26
    v_exp_f32 v27, v27
    v_exp_f32 v28, v28
    v_exp_f32 v29, v29
    v_exp_f32 v30, v30
    v_exp_f32 v31, v31
    v_exp_f32 v32, v32
    v_exp_f32 v33, v33
    v_exp_f32 v34, v34
    v_exp_f32 v35, v35
    v_exp_f32 v36, v36
    v_exp_f32 v37, v37
    v_exp_f32 v38, v38
    v_exp_f32 v39, v39
    v_pk_fma_f32 v[40:41], v[136:137], v[252:253], v[228:229] op_sel_hi:[1,0,0] neg_lo:[0,0,1] neg_hi:[0,0,1]
    v_pk_fma_f32 v[48:49], v[136:137], v[252:253], v[236:237] op_sel_hi:[1,0,0] neg_lo:[1,0,0] neg_hi:[1,0,0]
    v_pk_fma_f32 v[42:43], v[138:139], v[252:253], v[228:229] op_sel_hi:[1,0,0] neg_lo:[0,0,1] neg_hi:[0,0,1]
    v_pk_fma_f32 v[50:51], v[138:139], v[252:253], v[236:237] op_sel_hi:[1,0,0] neg_lo:[1,0,0] neg_hi:[1,0,0]
    v_pk_fma_f32 v[44:45], v[140:141], v[252:253], v[228:229] op_sel_hi:[1,0,0] neg_lo:[0,0,1] neg_hi:[0,0,1]
    v_pk_fma_f32 v[52:53], v[140:141], v[252:253], v[236:237] op_sel_hi:[1,0,0] neg_lo:[1,0,0] neg_hi:[1,0,0]
    v_pk_fma_f32 v[46:47], v[142:143], v[252:253], v[228:229] op_sel_hi:[1,0,0] neg_lo:[0,0,1] neg_hi:[0,0,1]
    v_pk_fma_f32 v[54:55], v[142:143], v[252:253], v[236:237] op_sel_hi:[1,0,0] neg_lo:[1,0,0] neg_hi:[1,0,0]
    v_exp_f32 v40, v40
    v_exp_f32 v41, v41
    v_exp_f32 v42, v42
    v_exp_f32 v43, v43
    v_exp_f32 v44, v44
    v_exp_f32 v45, v45
    v_exp_f32 v46, v46
    v_exp_f32 v47, v47
    v_exp_f32 v48, v48
    v_exp_f32 v49, v49
    v_exp_f32 v50, v50
    v_exp_f32 v51, v51
    v_exp_f32 v52, v52
    v_exp_f32 v53, v53
    v_exp_f32 v54, v54
    v_exp_f32 v55, v55
    v_pk_fma_f32 v[56:57], v[144:145], v[254:255], v[230:231] op_sel_hi:[1,0,0] neg_lo:[0,0,1] neg_hi:[0,0,1]
    v_pk_fma_f32 v[64:65], v[144:145], v[254:255], v[238:239] op_sel_hi:[1,0,0] neg_lo:[1,0,0] neg_hi:[1,0,0]
    v_pk_fma_f32 v[58:59], v[146:147], v[254:255], v[230:231] op_sel_hi:[1,0,0] neg_lo:[0,0,1] neg_hi:[0,0,1]
    v_pk_fma_f32 v[66:67], v[146:147], v[254:255], v[238:239] op_sel_hi:[1,0,0] neg_lo:[1,0,0] neg_hi:[1,0,0]
    v_pk_fma_f32 v[60:61], v[148:149], v[254:255], v[230:231] op_sel_hi:[1,0,0] neg_lo:[0,0,1] neg_hi:[0,0,1]
    v_pk_fma_f32 v[68:69], v[148:149], v[254:255], v[238:239] op_sel_hi:[1,0,0] neg_lo:[1,0,0] neg_hi:[1,0,0]
    v_pk_fma_f32 v[62:63], v[150:151], v[254:255], v[230:231] op_sel_hi:[1,0,0] neg_lo:[0,0,1] neg_hi:[0,0,1]
    v_pk_fma_f32 v[70:71], v[150:151], v[254:255], v[238:239] op_sel_hi:[1,0,0] neg_lo:[1,0,0] neg_hi:[1,0,0]
    v_exp_f32 v56, v56
    v_exp_f32 v57, v57
    v_exp_f32 v58, v58
    v_exp_f32 v59, v59
    v_exp_f32 v60, v60
    v_exp_f32 v61, v61
    v_exp_f32 v62, v62
    v_exp_f32 v63, v63
    v_exp_f32 v64, v64
    v_exp_f32 v65, v65
    v_exp_f32 v66, v66
    v_exp_f32 v67, v67
    v_exp_f32 v68, v68
    v_exp_f32 v69, v69
    v_exp_f32 v70, v70
    v_exp_f32 v71, v71
    v_pk_add_f32 v[120:121], v[8:9], v[10:11]
    v_pk_add_f32 v[122:123], v[12:13], v[14:15]
    v_pk_add_f32 v[124:125], v[16:17], v[18:19]
    v_pk_add_f32 v[126:127], v[20:21], v[22:23]
    v_pk_add_f32 v[128:129], v[24:25], v[26:27]
    v_pk_add_f32 v[130:131], v[28:29], v[30:31]
    v_pk_add_f32 v[132:133], v[32:33], v[34:35]
    v_pk_add_f32 v[134:135], v[36:37], v[38:39]
    v_pk_add_f32 v[136:137], v[40:41], v[42:43]
    v_pk_add_f32 v[138:139], v[44:45], v[46:47]
    v_pk_add_f32 v[140:141], v[48:49], v[50:51]
    v_pk_add_f32 v[142:143], v[52:53], v[54:55]
    v_pk_add_f32 v[144:145], v[56:57], v[58:59]
    v_pk_add_f32 v[146:147], v[60:61], v[62:63]
    v_pk_add_f32 v[148:149], v[64:65], v[66:67]
    v_pk_add_f32 v[150:151], v[68:69], v[70:71]
    v_pk_add_f32 v[120:121], v[120:121], v[122:123]
    v_pk_add_f32 v[124:125], v[124:125], v[126:127]
    v_pk_add_f32 v[128:129], v[128:129], v[130:131]
    v_pk_add_f32 v[132:133], v[132:133], v[134:135]
    v_pk_add_f32 v[136:137], v[136:137], v[138:139]
    v_pk_add_f32 v[140:141], v[140:141], v[142:143]
    v_pk_add_f32 v[144:145], v[144:145], v[146:147]
    v_pk_add_f32 v[148:149], v[148:149], v[150:151]
    v_add_f32 v224, v120, v121
    v_add_f32 v232, v124, v125
    v_add_f32 v226, v128, v129
    v_add_f32 v234, v132, v133
    v_add_f32 v228, v136, v137
    v_add_f32 v236, v140, v141
    v_add_f32 v230, v144, v145
    v_add_f32 v238, v148, v149
    v_permlane32_swap_b32 v224, v228
    v_permlane32_swap_b32 v226, v230
    v_permlane32_swap_b32 v232, v236
    v_permlane32_swap_b32 v234, v238
    v_add_f32 v224, v224, v228
    v_add_f32 v226, v226, v230
    v_add_f32 v232, v232, v236
    v_add_f32 v234, v234, v238
    v_permlane16_swap_b32 v224, v226
    s_nop 0
    v_permlane16_swap_b32 v232, v234
    v_add_f32 v224, v224, v226
    v_add_f32 v232, v232, v234
    v_rcp_f32 v232, v232
    s_lshl_b32 s3, s29, 12
    s_add_u32 s3, s3, 149504
    v_add_u32 v240, s3, v5
    s_lshl_b32 s3, s29, 7
    s_add_u32 s3, s3, 157696
    v_lshl_add_u32 v241, v2, 3, s3
    v_mul_f32 v232, v232, v224
    v_mul_f32 v224, 0x358637bd, v224
    v_mov_b32 v226, v224
    v_mov_b32 v234, v232
    s_nop 0
    v_permlane16_swap_b32 v224, v226
    v_permlane16_swap_b32 v232, v234
    v_mov_b32 v228, v224
    v_mov_b32 v230, v226
    v_mov_b32 v236, v232
    v_mov_b32 v238, v234
    v_permlane32_swap_b32 v224, v228
    v_permlane32_swap_b32 v226, v230
    v_permlane32_swap_b32 v232, v236
    v_permlane32_swap_b32 v234, v238
    v_pk_mul_f32 v[16:17], v[16:17], v[232:233] op_sel_hi:[1,0]
    v_pk_mul_f32 v[18:19], v[18:19], v[232:233] op_sel_hi:[1,0]
    v_pk_mul_f32 v[20:21], v[20:21], v[232:233] op_sel_hi:[1,0]
    v_pk_mul_f32 v[22:23], v[22:23], v[232:233] op_sel_hi:[1,0]
    v_cvt_pk_bf16_f32 v72, v8, v9
    v_cvt_pk_bf16_f32 v73, v10, v11
    v_cvt_pk_bf16_f32 v74, v12, v13
    v_cvt_pk_bf16_f32 v75, v14, v15
    v_cvt_pk_bf16_f32 v76, v16, v17
    v_cvt_pk_bf16_f32 v77, v18, v19
    v_cvt_pk_bf16_f32 v78, v20, v21
    v_cvt_pk_bf16_f32 v79, v22, v23
    v_pk_mul_f32 v[32:33], v[32:33], v[234:235] op_sel_hi:[1,0]
    v_pk_mul_f32 v[34:35], v[34:35], v[234:235] op_sel_hi:[1,0]
    v_pk_mul_f32 v[36:37], v[36:37], v[234:235] op_sel_hi:[1,0]
    v_pk_mul_f32 v[38:39], v[38:39], v[234:235] op_sel_hi:[1,0]
    v_cvt_pk_bf16_f32 v80, v24, v25
    v_cvt_pk_bf16_f32 v81, v26, v27
    v_cvt_pk_bf16_f32 v82, v28, v29
    v_cvt_pk_bf16_f32 v83, v30, v31
    v_cvt_pk_bf16_f32 v84, v32, v33
    v_cvt_pk_bf16_f32 v85, v34, v35
    v_cvt_pk_bf16_f32 v86, v36, v37
    v_cvt_pk_bf16_f32 v87, v38, v39
    v_pk_mul_f32 v[48:49], v[48:49], v[236:237] op_sel_hi:[1,0]
    v_pk_mul_f32 v[50:51], v[50:51], v[236:237] op_sel_hi:[1,0]
    v_pk_mul_f32 v[52:53], v[52:53], v[236:237] op_sel_hi:[1,0]
    v_pk_mul_f32 v[54:55], v[54:55], v[236:237] op_sel_hi:[1,0]
    v_cvt_pk_bf16_f32 v88, v40, v41
    v_cvt_pk_bf16_f32 v89, v42, v43
    v_cvt_pk_bf16_f32 v90, v44, v45
    v_cvt_pk_bf16_f32 v91, v46, v47
    v_cvt_pk_bf16_f32 v92, v48, v49
    v_cvt_pk_bf16_f32 v93, v50, v51
    v_cvt_pk_bf16_f32 v94, v52, v53
    v_cvt_pk_bf16_f32 v95, v54, v55
    v_pk_mul_f32 v[64:65], v[64:65], v[238:239] op_sel_hi:[1,0]
    v_pk_mul_f32 v[66:67], v[66:67], v[238:239] op_sel_hi:[1,0]
    v_pk_mul_f32 v[68:69], v[68:69], v[238:239] op_sel_hi:[1,0]
    v_pk_mul_f32 v[70:71], v[70:71], v[238:239] op_sel_hi:[1,0]
    v_cvt_pk_bf16_f32 v96, v56, v57
    v_cvt_pk_bf16_f32 v97, v58, v59
    v_cvt_pk_bf16_f32 v98, v60, v61
    v_cvt_pk_bf16_f32 v99, v62, v63
    v_cvt_pk_bf16_f32 v100, v64, v65
    v_cvt_pk_bf16_f32 v101, v66, v67
    v_cvt_pk_bf16_f32 v102, v68, v69
    v_cvt_pk_bf16_f32 v103, v70, v71
    v_mov_b32 v40, v224
    v_mov_b32 v44, v226
    v_mov_b32 v48, v228
    v_mov_b32 v52, v230
    s_lshl_b32 s3, s36, 3
    s_lshl_b32 s65, s28, 2
    s_add_u32 s3, s3, s65
    s_lshl_b32 s3, s3, 5
    s_lshl_b32 s65, s37, 1
    s_add_u32 s65, s65, s29
    s_add_u32 s3, s3, s65
    s_lshl_b32 s3, s3, 10
    s_add_u32 s3, s3, 12582912
    s_lshl_b32 s66, s36, 4
    s_add_u32 s66, s66, s37
    s_lshl_b32 s66, s66, 7
    s_add_u32 s66, s66, 1310720
    s_lshl_b32 s65, s29, 2
    s_add_u32 s65, s65, 163104
    v_mov_b32 v6, s65
L_kv:
    ds_read_b32 v7, v6
    ds_read_b64 v[120:121], v241 offset:0
    ds_read_b64 v[122:123], v241 offset:32
    ds_read_b64 v[124:125], v241 offset:64
    ds_read_b64 v[126:127], v241 offset:96
    ds_read_b128 v[104:107], v240 offset:0
    ds_read_b128 v[108:111], v240 offset:1024
    ds_read_b128 v[112:115], v240 offset:2048
    ds_read_b128 v[116:119], v240 offset:3072
    s_waitcnt lgkmcnt(4)
    v_readfirstlane_b32 s65, v7
    s_nop 0
    s_cmp_eq_u32 s65, 1
    s_cbranch_scc1 L_kvd
L_kw:
    ds_read_b32 v7, v6
    s_waitcnt lgkmcnt(0)
    v_readfirstlane_b32 s65, v7
    s_nop 0
    s_cmp_eq_u32 s65, 1
    s_cbranch_scc1 L_kv
    s_branch L_kw
L_kvd:
    v_mfma_f32_16x16x32_bf16 v[40:43], v[120:123], v[72:75], v[40:43]
    v_mfma_f32_16x16x32_bf16 v[44:47], v[120:123], v[80:83], v[44:47]
    v_mfma_f32_16x16x32_bf16 v[48:51], v[120:123], v[88:91], v[48:51]
    v_mfma_f32_16x16x32_bf16 v[52:55], v[120:123], v[96:99], v[52:55]
    v_mfma_f32_16x16x32_bf16 v[40:43], v[124:127], v[76:79], v[40:43]
    v_mfma_f32_16x16x32_bf16 v[44:47], v[124:127], v[84:87], v[44:47]
    v_mfma_f32_16x16x32_bf16 v[48:51], v[124:127], v[92:95], v[48:51]
    v_mfma_f32_16x16x32_bf16 v[52:55], v[124:127], v[100:103], v[52:55]
    s_waitcnt lgkmcnt(0)
    v_mfma_f32_16x16x32_bf16 v[8:11], v[104:107], v[72:75], 0
    v_mfma_f32_16x16x32_bf16 v[12:15], v[108:111], v[72:75], 0
    v_mfma_f32_16x16x32_bf16 v[8:11], v[112:115], v[76:79], v[8:11]
    v_mfma_f32_16x16x32_bf16 v[12:15], v[116:119], v[76:79], v[12:15]
    v_mfma_f32_16x16x32_bf16 v[16:19], v[104:107], v[80:83], 0
    v_rcp_f32 v40, v40
    v_mfma_f32_16x16x32_bf16 v[20:23], v[108:111], v[80:83], 0
    v_rcp_f32 v44, v44
    v_mfma_f32_16x16x32_bf16 v[16:19], v[112:115], v[84:87], v[16:19]
    v_rcp_f32 v48, v48
    v_mfma_f32_16x16x32_bf16 v[20:23], v[116:119], v[84:87], v[20:23]
    v_rcp_f32 v52, v52
    v_mfma_f32_16x16x32_bf16 v[24:27], v[104:107], v[88:91], 0
    v_mfma_f32_16x16x32_bf16 v[28:31], v[108:111], v[88:91], 0
    v_mul_f32 v8, v8, v40
    v_mul_f32 v9, v9, v40
    v_mul_f32 v10, v10, v40
    v_mfma_f32_16x16x32_bf16 v[24:27], v[112:115], v[92:95], v[24:27]
    v_mul_f32 v11, v11, v40
    v_mul_f32 v12, v12, v40
    v_mul_f32 v13, v13, v40
    v_mfma_f32_16x16x32_bf16 v[28:31], v[116:119], v[92:95], v[28:31]
    v_mul_f32 v14, v14, v40
    v_mul_f32 v15, v15, v40
    v_cvt_pk_bf16_f32 v128, v8, v9
    v_mfma_f32_16x16x32_bf16 v[32:35], v[104:107], v[96:99], 0
    v_cvt_pk_bf16_f32 v129, v10, v11
    v_cvt_pk_bf16_f32 v130, v12, v13
    v_cvt_pk_bf16_f32 v131, v14, v15
    v_mfma_f32_16x16x32_bf16 v[36:39], v[108:111], v[96:99], 0
    buffer_store_dwordx4 v[128:131], v5, s[12:15], s3 offen sc1
    s_add_u32 s3, s3, 32768
    v_mul_f32 v16, v16, v44
    v_mfma_f32_16x16x32_bf16 v[32:35], v[112:115], v[100:103], v[32:35]
    v_mul_f32 v17, v17, v44
    v_mul_f32 v18, v18, v44
    v_mul_f32 v19, v19, v44
    v_mfma_f32_16x16x32_bf16 v[36:39], v[116:119], v[100:103], v[36:39]
    v_mul_f32 v20, v20, v44
    v_mul_f32 v21, v21, v44
    v_mul_f32 v22, v22, v44
    v_mul_f32 v23, v23, v44
    v_cvt_pk_bf16_f32 v132, v16, v17
    v_cvt_pk_bf16_f32 v133, v18, v19
    v_cvt_pk_bf16_f32 v134, v20, v21
    v_cvt_pk_bf16_f32 v135, v22, v23
    buffer_store_dwordx4 v[132:135], v5, s[12:15], s3 offen sc1
    s_add_u32 s3, s3, 32768
    v_pk_mul_f32 v[24:25], v[24:25], v[48:49] op_sel_hi:[1,0]
    v_pk_mul_f32 v[26:27], v[26:27], v[48:49] op_sel_hi:[1,0]
    v_pk_mul_f32 v[28:29], v[28:29], v[48:49] op_sel_hi:[1,0]
    v_pk_mul_f32 v[30:31], v[30:31], v[48:49] op_sel_hi:[1,0]
    v_cvt_pk_bf16_f32 v136, v24, v25
    v_cvt_pk_bf16_f32 v137, v26, v27
    v_cvt_pk_bf16_f32 v138, v28, v29
    v_cvt_pk_bf16_f32 v139, v30, v31
    buffer_store_dwordx4 v[136:139], v5, s[12:15], s3 offen sc1
    s_add_u32 s3, s3, 32768
    v_pk_mul_f32 v[32:33], v[32:33], v[52:53] op_sel_hi:[1,0]
    v_pk_mul_f32 v[34:35], v[34:35], v[52:53] op_sel_hi:[1,0]
    v_pk_mul_f32 v[36:37], v[36:37], v[52:53] op_sel_hi:[1,0]
    v_pk_mul_f32 v[38:39], v[38:39], v[52:53] op_sel_hi:[1,0]
    v_cvt_pk_bf16_f32 v140, v32, v33
    v_cvt_pk_bf16_f32 v141, v34, v35
    v_cvt_pk_bf16_f32 v142, v36, v37
    v_cvt_pk_bf16_f32 v143, v38, v39
    buffer_store_dwordx4 v[140:143], v5, s[12:15], s3 offen sc1
    s_add_u32 s3, s3, 32768
    v_lshrrev_b32 v6, 2, v1
    v_lshlrev_b32 v6, 7, v6
    v_and_b32 v7, 3, v1
    v_lshl_add_u32 v6, v7, 3, v6
    v_bfe_u32 v7, v1, 3, 2
    v_xor_b32 v4, 0, v7
    v_lshl_add_u32 v250, v4, 5, v6
    v_xor_b32 v4, 1, v7
    v_lshl_add_u32 v251, v4, 5, v6
    v_xor_b32 v4, 2, v7
    v_lshl_add_u32 v252, v4, 5, v6
    v_xor_b32 v4, 3, v7
    v_lshl_add_u32 v253, v4, 5, v6
    s_lshl_b32 s72, s30, 3
    s_lshl_b32 s3, s38, 1
    s_add_u32 s72, s72, s3
    s_lshl_b32 s72, s72, 15
    s_add_u32 s72, s72, 12582912
    v_add_u32 v4, 32768, v5
    s_mul_i32 s3, s38, 4608
    s_add_u32 s3, s3, 131072
    v_mul_u32_u24 v6, 144, v3
    v_lshl_add_u32 v6, v2, 3, v6
    v_add_u32 v240, s3, v6
    v_mov_b32 v160, s32
    v_mov_b32 v161, s32
    v_mov_b32 v162, s32
    v_mov_b32 v163, s32
    v_mov_b32 v164, 163104
    v_mov_b32 v165, 1
    s_waitcnt vmcnt(0)
    s_mov_b64 exec, 1
    ds_add_rtn_u32 v166, v164, v165 offset:96
    s_waitcnt lgkmcnt(0)
    v_readfirstlane_b32 s3, v166
    s_mov_b64 exec, 0xff
    s_cmp_lg_u32 s3, 3
    s_cbranch_scc1 L_nof
    buffer_store_dwordx4 v[160:163], v5, s[12:15], s66 offen sc1
L_nof:
    s_mov_b64 exec, -1
    s_cmp_lg_u32 s38, 0
    s_cbranch_scc1 L_gw
    s_lshl_b32 s73, s30, 11
    s_add_u32 s73, s73, 1310720
    v_lshlrev_b32 v6, 7, v3
    s_sleep 8
    buffer_load_dword v7, v6, s[12:15], s73 offen sc1
    s_waitcnt vmcnt(0)
L_op:
    v_xor_b32 v7, s32, v7
    v_cmp_ne_u32 vcc, 0, v7
    s_nop 0
    s_cmp_eq_u64 vcc, 0
    s_cbranch_scc1 L_opok
    s_add_u32 s70, s70, 1
    s_cmp_ge_u32 s70, 200000
    s_cbranch_scc1 L_opok
    s_sleep 4
    buffer_load_dword v7, v6, s[12:15], s73 offen sc1
    s_waitcnt vmcnt(0)
    s_branch L_op
L_opok:
    ds_write_b32 v164, v165 offset:100
    s_branch L_gd
L_gw:
    ds_read_b32 v166, v164 offset:100
    s_waitcnt lgkmcnt(0)
    v_readfirstlane_b32 s3, v166
    s_nop 0
    s_cmp_eq_u32 s3, 1
    s_cbranch_scc1 L_gd
    s_sleep 1
    s_branch L_gw
L_gd:
    buffer_load_dwordx4 v[72:75], v5, s[12:15], s72 offen offset:0 sc1
    buffer_load_dwordx4 v[76:79], v4, s[12:15], s72 offen offset:0 sc1
    buffer_load_dwordx4 v[80:83], v5, s[12:15], s72 offen offset:1024 sc1
    buffer_load_dwordx4 v[84:87], v4, s[12:15], s72 offen offset:1024 sc1
    buffer_load_dwordx4 v[88:91], v5, s[12:15], s72 offen offset:2048 sc1
    buffer_load_dwordx4 v[92:95], v4, s[12:15], s72 offen offset:2048 sc1
    buffer_load_dwordx4 v[96:99], v5, s[12:15], s72 offen offset:3072 sc1
    buffer_load_dwordx4 v[100:103], v4, s[12:15], s72 offen offset:3072 sc1
    s_add_u32 s72, s72, 4096
    buffer_load_dwordx4 v[104:107], v5, s[12:15], s72 offen offset:0 sc1
    buffer_load_dwordx4 v[108:111], v4, s[12:15], s72 offen offset:0 sc1
    buffer_load_dwordx4 v[112:115], v5, s[12:15], s72 offen offset:1024 sc1
    buffer_load_dwordx4 v[116:119], v4, s[12:15], s72 offen offset:1024 sc1
    v_mov_b32 v6, 163104
L_wl:
    ds_read_b128 v[40:43], v6 offset:112
    s_waitcnt lgkmcnt(0)
    v_and_b32 v40, v40, v41
    v_and_b32 v42, v42, v43
    v_and_b32 v40, v40, v42
    s_nop 0
    v_readfirstlane_b32 s65, v40
    s_nop 0
    s_cmp_eq_u32 s65, 1
    s_cbranch_scc0 L_wl
    ds_read_b64_tr_b16 v[40:41], v250 offset:0
    ds_read_b64_tr_b16 v[42:43], v250 offset:2048
    ds_read_b64_tr_b16 v[44:45], v251 offset:0
    ds_read_b64_tr_b16 v[46:47], v251 offset:2048
    ds_read_b64_tr_b16 v[48:49], v252 offset:0
    ds_read_b64_tr_b16 v[50:51], v252 offset:2048
    ds_read_b64_tr_b16 v[52:53], v253 offset:0
    ds_read_b64_tr_b16 v[54:55], v253 offset:2048
    buffer_load_dwordx4 v[120:123], v5, s[12:15], s72 offen offset:2048 sc1
    buffer_load_dwordx4 v[124:127], v4, s[12:15], s72 offen offset:2048 sc1
    s_waitcnt vmcnt(12)
    s_waitcnt lgkmcnt(0)
    v_mfma_f32_16x16x32_bf16 v[8:11], v[40:43], v[72:75], 0
    ds_read_b64_tr_b16 v[56:57], v250 offset:4096
    v_mfma_f32_16x16x32_bf16 v[12:15], v[44:47], v[72:75], 0
    ds_read_b64_tr_b16 v[58:59], v250 offset:6144
    v_mfma_f32_16x16x32_bf16 v[16:19], v[48:51], v[72:75], 0
    ds_read_b64_tr_b16 v[60:61], v251 offset:4096
    v_mfma_f32_16x16x32_bf16 v[20:23], v[52:55], v[72:75], 0
    ds_read_b64_tr_b16 v[62:63], v251 offset:6144
    v_mfma_f32_16x16x32_bf16 v[24:27], v[40:43], v[76:79], 0
    ds_read_b64_tr_b16 v[64:65], v252 offset:4096
    v_mfma_f32_16x16x32_bf16 v[28:31], v[44:47], v[76:79], 0
    ds_read_b64_tr_b16 v[66:67], v252 offset:6144
    v_mfma_f32_16x16x32_bf16 v[32:35], v[48:51], v[76:79], 0
    ds_read_b64_tr_b16 v[68:69], v253 offset:4096
    v_mfma_f32_16x16x32_bf16 v[36:39], v[52:55], v[76:79], 0
    ds_read_b64_tr_b16 v[70:71], v253 offset:6144
    buffer_load_dwordx4 v[72:75], v5, s[12:15], s72 offen offset:3072 sc1
    buffer_load_dwordx4 v[76:79], v4, s[12:15], s72 offen offset:3072 sc1
    s_add_u32 s72, s72, 4096
    s_waitcnt vmcnt(12)
    s_waitcnt lgkmcnt(0)
    v_mfma_f32_16x16x32_bf16 v[8:11], v[56:59], v[80:83], v[8:11]
    ds_read_b64_tr_b16 v[40:41], v250 offset:8192
    v_mfma_f32_16x16x32_bf16 v[12:15], v[60:63], v[80:83], v[12:15]
    ds_read_b64_tr_b16 v[42:43], v250 offset:10240
    v_mfma_f32_16x16x32_bf16 v[16:19], v[64:67], v[80:83], v[16:19]
    ds_read_b64_tr_b16 v[44:45], v251 offset:8192
    v_mfma_f32_16x16x32_bf16 v[20:23], v[68:71], v[80:83], v[20:23]
    ds_read_b64_tr_b16 v[46:47], v251 offset:10240
    v_mfma_f32_16x16x32_bf16 v[24:27], v[56:59], v[84:87], v[24:27]
    ds_read_b64_tr_b16 v[48:49], v252 offset:8192
    v_mfma_f32_16x16x32_bf16 v[28:31], v[60:63], v[84:87], v[28:31]
    ds_read_b64_tr_b16 v[50:51], v252 offset:10240
    v_mfma_f32_16x16x32_bf16 v[32:35], v[64:67], v[84:87], v[32:35]
    ds_read_b64_tr_b16 v[52:53], v253 offset:8192
    v_mfma_f32_16x16x32_bf16 v[36:39], v[68:71], v[84:87], v[36:39]
    ds_read_b64_tr_b16 v[54:55], v253 offset:10240
    buffer_load_dwordx4 v[80:83], v5, s[12:15], s72 offen offset:0 sc1
    buffer_load_dwordx4 v[84:87], v4, s[12:15], s72 offen offset:0 sc1
    s_waitcnt vmcnt(12)
    s_waitcnt lgkmcnt(0)
    v_mfma_f32_16x16x32_bf16 v[8:11], v[40:43], v[88:91], v[8:11]
    ds_read_b64_tr_b16 v[56:57], v250 offset:12288
    v_mfma_f32_16x16x32_bf16 v[12:15], v[44:47], v[88:91], v[12:15]
    ds_read_b64_tr_b16 v[58:59], v250 offset:14336
    v_mfma_f32_16x16x32_bf16 v[16:19], v[48:51], v[88:91], v[16:19]
    ds_read_b64_tr_b16 v[60:61], v251 offset:12288
    v_mfma_f32_16x16x32_bf16 v[20:23], v[52:55], v[88:91], v[20:23]
    ds_read_b64_tr_b16 v[62:63], v251 offset:14336
    v_mfma_f32_16x16x32_bf16 v[24:27], v[40:43], v[92:95], v[24:27]
    ds_read_b64_tr_b16 v[64:65], v252 offset:12288
    v_mfma_f32_16x16x32_bf16 v[28:31], v[44:47], v[92:95], v[28:31]
    ds_read_b64_tr_b16 v[66:67], v252 offset:14336
    v_mfma_f32_16x16x32_bf16 v[32:35], v[48:51], v[92:95], v[32:35]
    ds_read_b64_tr_b16 v[68:69], v253 offset:12288
    v_mfma_f32_16x16x32_bf16 v[36:39], v[52:55], v[92:95], v[36:39]
    ds_read_b64_tr_b16 v[70:71], v253 offset:14336
    buffer_load_dwordx4 v[88:91], v5, s[12:15], s72 offen offset:1024 sc1
    buffer_load_dwordx4 v[92:95], v4, s[12:15], s72 offen offset:1024 sc1
    s_waitcnt vmcnt(12)
    s_waitcnt lgkmcnt(0)
    v_mfma_f32_16x16x32_bf16 v[8:11], v[56:59], v[96:99], v[8:11]
    ds_read_b64_tr_b16 v[40:41], v250 offset:16384
    v_mfma_f32_16x16x32_bf16 v[12:15], v[60:63], v[96:99], v[12:15]
    ds_read_b64_tr_b16 v[42:43], v250 offset:18432
    v_mfma_f32_16x16x32_bf16 v[16:19], v[64:67], v[96:99], v[16:19]
    ds_read_b64_tr_b16 v[44:45], v251 offset:16384
    v_mfma_f32_16x16x32_bf16 v[20:23], v[68:71], v[96:99], v[20:23]
    ds_read_b64_tr_b16 v[46:47], v251 offset:18432
    v_mfma_f32_16x16x32_bf16 v[24:27], v[56:59], v[100:103], v[24:27]
    ds_read_b64_tr_b16 v[48:49], v252 offset:16384
    v_mfma_f32_16x16x32_bf16 v[28:31], v[60:63], v[100:103], v[28:31]
    ds_read_b64_tr_b16 v[50:51], v252 offset:18432
    v_mfma_f32_16x16x32_bf16 v[32:35], v[64:67], v[100:103], v[32:35]
    ds_read_b64_tr_b16 v[52:53], v253 offset:16384
    v_mfma_f32_16x16x32_bf16 v[36:39], v[68:71], v[100:103], v[36:39]
    ds_read_b64_tr_b16 v[54:55], v253 offset:18432
    buffer_load_dwordx4 v[96:99], v5, s[12:15], s72 offen offset:2048 sc1
    buffer_load_dwordx4 v[100:103], v4, s[12:15], s72 offen offset:2048 sc1
    s_waitcnt vmcnt(12)
    s_waitcnt lgkmcnt(0)
    v_mfma_f32_16x16x32_bf16 v[8:11], v[40:43], v[104:107], v[8:11]
    ds_read_b64_tr_b16 v[56:57], v250 offset:20480
    v_mfma_f32_16x16x32_bf16 v[12:15], v[44:47], v[104:107], v[12:15]
    ds_read_b64_tr_b16 v[58:59], v250 offset:22528
    v_mfma_f32_16x16x32_bf16 v[16:19], v[48:51], v[104:107], v[16:19]
    ds_read_b64_tr_b16 v[60:61], v251 offset:20480
    v_mfma_f32_16x16x32_bf16 v[20:23], v[52:55], v[104:107], v[20:23]
    ds_read_b64_tr_b16 v[62:63], v251 offset:22528
    v_mfma_f32_16x16x32_bf16 v[24:27], v[40:43], v[108:111], v[24:27]
    ds_read_b64_tr_b16 v[64:65], v252 offset:20480
    v_mfma_f32_16x16x32_bf16 v[28:31], v[44:47], v[108:111], v[28:31]
    ds_read_b64_tr_b16 v[66:67], v252 offset:22528
    v_mfma_f32_16x16x32_bf16 v[32:35], v[48:51], v[108:111], v[32:35]
    ds_read_b64_tr_b16 v[68:69], v253 offset:20480
    v_mfma_f32_16x16x32_bf16 v[36:39], v[52:55], v[108:111], v[36:39]
    ds_read_b64_tr_b16 v[70:71], v253 offset:22528
    buffer_load_dwordx4 v[104:107], v5, s[12:15], s72 offen offset:3072 sc1
    buffer_load_dwordx4 v[108:111], v4, s[12:15], s72 offen offset:3072 sc1
    s_add_u32 s72, s72, 4096
    s_waitcnt vmcnt(12)
    s_waitcnt lgkmcnt(0)
    v_mfma_f32_16x16x32_bf16 v[8:11], v[56:59], v[112:115], v[8:11]
    ds_read_b64_tr_b16 v[40:41], v250 offset:24576
    v_mfma_f32_16x16x32_bf16 v[12:15], v[60:63], v[112:115], v[12:15]
    ds_read_b64_tr_b16 v[42:43], v250 offset:26624
    v_mfma_f32_16x16x32_bf16 v[16:19], v[64:67], v[112:115], v[16:19]
    ds_read_b64_tr_b16 v[44:45], v251 offset:24576
    v_mfma_f32_16x16x32_bf16 v[20:23], v[68:71], v[112:115], v[20:23]
    ds_read_b64_tr_b16 v[46:47], v251 offset:26624
    v_mfma_f32_16x16x32_bf16 v[24:27], v[56:59], v[116:119], v[24:27]
    ds_read_b64_tr_b16 v[48:49], v252 offset:24576
    v_mfma_f32_16x16x32_bf16 v[28:31], v[60:63], v[116:119], v[28:31]
    ds_read_b64_tr_b16 v[50:51], v252 offset:26624
    v_mfma_f32_16x16x32_bf16 v[32:35], v[64:67], v[116:119], v[32:35]
    ds_read_b64_tr_b16 v[52:53], v253 offset:24576
    v_mfma_f32_16x16x32_bf16 v[36:39], v[68:71], v[116:119], v[36:39]
    ds_read_b64_tr_b16 v[54:55], v253 offset:26624
    buffer_load_dwordx4 v[112:115], v5, s[12:15], s72 offen offset:0 sc1
    buffer_load_dwordx4 v[116:119], v4, s[12:15], s72 offen offset:0 sc1
    s_waitcnt vmcnt(12)
    s_waitcnt lgkmcnt(0)
    v_mfma_f32_16x16x32_bf16 v[8:11], v[40:43], v[120:123], v[8:11]
    ds_read_b64_tr_b16 v[56:57], v250 offset:28672
    v_mfma_f32_16x16x32_bf16 v[12:15], v[44:47], v[120:123], v[12:15]
    ds_read_b64_tr_b16 v[58:59], v250 offset:30720
    v_mfma_f32_16x16x32_bf16 v[16:19], v[48:51], v[120:123], v[16:19]
    ds_read_b64_tr_b16 v[60:61], v251 offset:28672
    v_mfma_f32_16x16x32_bf16 v[20:23], v[52:55], v[120:123], v[20:23]
    ds_read_b64_tr_b16 v[62:63], v251 offset:30720
    v_mfma_f32_16x16x32_bf16 v[24:27], v[40:43], v[124:127], v[24:27]
    ds_read_b64_tr_b16 v[64:65], v252 offset:28672
    v_mfma_f32_16x16x32_bf16 v[28:31], v[44:47], v[124:127], v[28:31]
    ds_read_b64_tr_b16 v[66:67], v252 offset:30720
    v_mfma_f32_16x16x32_bf16 v[32:35], v[48:51], v[124:127], v[32:35]
    ds_read_b64_tr_b16 v[68:69], v253 offset:28672
    v_mfma_f32_16x16x32_bf16 v[36:39], v[52:55], v[124:127], v[36:39]
    ds_read_b64_tr_b16 v[70:71], v253 offset:30720
    buffer_load_dwordx4 v[120:123], v5, s[12:15], s72 offen offset:1024 sc1
    buffer_load_dwordx4 v[124:127], v4, s[12:15], s72 offen offset:1024 sc1
    s_waitcnt vmcnt(12)
    s_waitcnt lgkmcnt(0)
    v_mfma_f32_16x16x32_bf16 v[8:11], v[56:59], v[72:75], v[8:11]
    ds_read_b64_tr_b16 v[40:41], v250 offset:32768
    v_mfma_f32_16x16x32_bf16 v[12:15], v[60:63], v[72:75], v[12:15]
    ds_read_b64_tr_b16 v[42:43], v250 offset:34816
    v_mfma_f32_16x16x32_bf16 v[16:19], v[64:67], v[72:75], v[16:19]
    ds_read_b64_tr_b16 v[44:45], v251 offset:32768
    v_mfma_f32_16x16x32_bf16 v[20:23], v[68:71], v[72:75], v[20:23]
    ds_read_b64_tr_b16 v[46:47], v251 offset:34816
    v_mfma_f32_16x16x32_bf16 v[24:27], v[56:59], v[76:79], v[24:27]
    ds_read_b64_tr_b16 v[48:49], v252 offset:32768
    v_mfma_f32_16x16x32_bf16 v[28:31], v[60:63], v[76:79], v[28:31]
    ds_read_b64_tr_b16 v[50:51], v252 offset:34816
    v_mfma_f32_16x16x32_bf16 v[32:35], v[64:67], v[76:79], v[32:35]
    ds_read_b64_tr_b16 v[52:53], v253 offset:32768
    v_mfma_f32_16x16x32_bf16 v[36:39], v[68:71], v[76:79], v[36:39]
    ds_read_b64_tr_b16 v[54:55], v253 offset:34816
    buffer_load_dwordx4 v[72:75], v5, s[12:15], s72 offen offset:2048 sc1
    buffer_load_dwordx4 v[76:79], v4, s[12:15], s72 offen offset:2048 sc1
    s_waitcnt vmcnt(12)
    s_waitcnt lgkmcnt(0)
    v_mfma_f32_16x16x32_bf16 v[8:11], v[40:43], v[80:83], v[8:11]
    ds_read_b64_tr_b16 v[56:57], v250 offset:36864
    v_mfma_f32_16x16x32_bf16 v[12:15], v[44:47], v[80:83], v[12:15]
    ds_read_b64_tr_b16 v[58:59], v250 offset:38912
    v_mfma_f32_16x16x32_bf16 v[16:19], v[48:51], v[80:83], v[16:19]
    ds_read_b64_tr_b16 v[60:61], v251 offset:36864
    v_mfma_f32_16x16x32_bf16 v[20:23], v[52:55], v[80:83], v[20:23]
    ds_read_b64_tr_b16 v[62:63], v251 offset:38912
    v_mfma_f32_16x16x32_bf16 v[24:27], v[40:43], v[84:87], v[24:27]
    ds_read_b64_tr_b16 v[64:65], v252 offset:36864
    v_mfma_f32_16x16x32_bf16 v[28:31], v[44:47], v[84:87], v[28:31]
    ds_read_b64_tr_b16 v[66:67], v252 offset:38912
    v_mfma_f32_16x16x32_bf16 v[32:35], v[48:51], v[84:87], v[32:35]
    ds_read_b64_tr_b16 v[68:69], v253 offset:36864
    v_mfma_f32_16x16x32_bf16 v[36:39], v[52:55], v[84:87], v[36:39]
    ds_read_b64_tr_b16 v[70:71], v253 offset:38912
    buffer_load_dwordx4 v[80:83], v5, s[12:15], s72 offen offset:3072 sc1
    buffer_load_dwordx4 v[84:87], v4, s[12:15], s72 offen offset:3072 sc1
    s_add_u32 s72, s72, 4096
    s_waitcnt vmcnt(12)
    s_waitcnt lgkmcnt(0)
    v_mfma_f32_16x16x32_bf16 v[8:11], v[56:59], v[88:91], v[8:11]
    ds_read_b64_tr_b16 v[40:41], v250 offset:40960
    v_mfma_f32_16x16x32_bf16 v[12:15], v[60:63], v[88:91], v[12:15]
    ds_read_b64_tr_b16 v[42:43], v250 offset:43008
    v_mfma_f32_16x16x32_bf16 v[16:19], v[64:67], v[88:91], v[16:19]
    ds_read_b64_tr_b16 v[44:45], v251 offset:40960
    v_mfma_f32_16x16x32_bf16 v[20:23], v[68:71], v[88:91], v[20:23]
    ds_read_b64_tr_b16 v[46:47], v251 offset:43008
    v_mfma_f32_16x16x32_bf16 v[24:27], v[56:59], v[92:95], v[24:27]
    ds_read_b64_tr_b16 v[48:49], v252 offset:40960
    v_mfma_f32_16x16x32_bf16 v[28:31], v[60:63], v[92:95], v[28:31]
    ds_read_b64_tr_b16 v[50:51], v252 offset:43008
    v_mfma_f32_16x16x32_bf16 v[32:35], v[64:67], v[92:95], v[32:35]
    ds_read_b64_tr_b16 v[52:53], v253 offset:40960
    v_mfma_f32_16x16x32_bf16 v[36:39], v[68:71], v[92:95], v[36:39]
    ds_read_b64_tr_b16 v[54:55], v253 offset:43008
    buffer_load_dwordx4 v[88:91], v5, s[12:15], s72 offen offset:0 sc1
    buffer_load_dwordx4 v[92:95], v4, s[12:15], s72 offen offset:0 sc1
    s_waitcnt vmcnt(12)
    s_waitcnt lgkmcnt(0)
    v_mfma_f32_16x16x32_bf16 v[8:11], v[40:43], v[96:99], v[8:11]
    ds_read_b64_tr_b16 v[56:57], v250 offset:45056
    v_mfma_f32_16x16x32_bf16 v[12:15], v[44:47], v[96:99], v[12:15]
    ds_read_b64_tr_b16 v[58:59], v250 offset:47104
    v_mfma_f32_16x16x32_bf16 v[16:19], v[48:51], v[96:99], v[16:19]
    ds_read_b64_tr_b16 v[60:61], v251 offset:45056
    v_mfma_f32_16x16x32_bf16 v[20:23], v[52:55], v[96:99], v[20:23]
    ds_read_b64_tr_b16 v[62:63], v251 offset:47104
    v_mfma_f32_16x16x32_bf16 v[24:27], v[40:43], v[100:103], v[24:27]
    ds_read_b64_tr_b16 v[64:65], v252 offset:45056
    v_mfma_f32_16x16x32_bf16 v[28:31], v[44:47], v[100:103], v[28:31]
    ds_read_b64_tr_b16 v[66:67], v252 offset:47104
    v_mfma_f32_16x16x32_bf16 v[32:35], v[48:51], v[100:103], v[32:35]
    ds_read_b64_tr_b16 v[68:69], v253 offset:45056
    v_mfma_f32_16x16x32_bf16 v[36:39], v[52:55], v[100:103], v[36:39]
    ds_read_b64_tr_b16 v[70:71], v253 offset:47104
    buffer_load_dwordx4 v[96:99], v5, s[12:15], s72 offen offset:1024 sc1
    buffer_load_dwordx4 v[100:103], v4, s[12:15], s72 offen offset:1024 sc1
    s_waitcnt vmcnt(12)
    s_waitcnt lgkmcnt(0)
    v_mfma_f32_16x16x32_bf16 v[8:11], v[56:59], v[104:107], v[8:11]
    ds_read_b64_tr_b16 v[40:41], v250 offset:49152
    v_mfma_f32_16x16x32_bf16 v[12:15], v[60:63], v[104:107], v[12:15]
    ds_read_b64_tr_b16 v[42:43], v250 offset:51200
    v_mfma_f32_16x16x32_bf16 v[16:19], v[64:67], v[104:107], v[16:19]
    ds_read_b64_tr_b16 v[44:45], v251 offset:49152
    v_mfma_f32_16x16x32_bf16 v[20:23], v[68:71], v[104:107], v[20:23]
    ds_read_b64_tr_b16 v[46:47], v251 offset:51200
    v_mfma_f32_16x16x32_bf16 v[24:27], v[56:59], v[108:111], v[24:27]
    ds_read_b64_tr_b16 v[48:49], v252 offset:49152
    v_mfma_f32_16x16x32_bf16 v[28:31], v[60:63], v[108:111], v[28:31]
    ds_read_b64_tr_b16 v[50:51], v252 offset:51200
    v_mfma_f32_16x16x32_bf16 v[32:35], v[64:67], v[108:111], v[32:35]
    ds_read_b64_tr_b16 v[52:53], v253 offset:49152
    v_mfma_f32_16x16x32_bf16 v[36:39], v[68:71], v[108:111], v[36:39]
    ds_read_b64_tr_b16 v[54:55], v253 offset:51200
    buffer_load_dwordx4 v[104:107], v5, s[12:15], s72 offen offset:2048 sc1
    buffer_load_dwordx4 v[108:111], v4, s[12:15], s72 offen offset:2048 sc1
    s_waitcnt vmcnt(12)
    s_waitcnt lgkmcnt(0)
    v_mfma_f32_16x16x32_bf16 v[8:11], v[40:43], v[112:115], v[8:11]
    ds_read_b64_tr_b16 v[56:57], v250 offset:53248
    v_mfma_f32_16x16x32_bf16 v[12:15], v[44:47], v[112:115], v[12:15]
    ds_read_b64_tr_b16 v[58:59], v250 offset:55296
    v_mfma_f32_16x16x32_bf16 v[16:19], v[48:51], v[112:115], v[16:19]
    ds_read_b64_tr_b16 v[60:61], v251 offset:53248
    v_mfma_f32_16x16x32_bf16 v[20:23], v[52:55], v[112:115], v[20:23]
    ds_read_b64_tr_b16 v[62:63], v251 offset:55296
    v_mfma_f32_16x16x32_bf16 v[24:27], v[40:43], v[116:119], v[24:27]
    ds_read_b64_tr_b16 v[64:65], v252 offset:53248
    v_mfma_f32_16x16x32_bf16 v[28:31], v[44:47], v[116:119], v[28:31]
    ds_read_b64_tr_b16 v[66:67], v252 offset:55296
    v_mfma_f32_16x16x32_bf16 v[32:35], v[48:51], v[116:119], v[32:35]
    ds_read_b64_tr_b16 v[68:69], v253 offset:53248
    v_mfma_f32_16x16x32_bf16 v[36:39], v[52:55], v[116:119], v[36:39]
    ds_read_b64_tr_b16 v[70:71], v253 offset:55296
    buffer_load_dwordx4 v[112:115], v5, s[12:15], s72 offen offset:3072 sc1
    buffer_load_dwordx4 v[116:119], v4, s[12:15], s72 offen offset:3072 sc1
    s_add_u32 s72, s72, 4096
    s_waitcnt vmcnt(12)
    s_waitcnt lgkmcnt(0)
    v_mfma_f32_16x16x32_bf16 v[8:11], v[56:59], v[120:123], v[8:11]
    ds_read_b64_tr_b16 v[40:41], v250 offset:57344
    v_mfma_f32_16x16x32_bf16 v[12:15], v[60:63], v[120:123], v[12:15]
    ds_read_b64_tr_b16 v[42:43], v250 offset:59392
    v_mfma_f32_16x16x32_bf16 v[16:19], v[64:67], v[120:123], v[16:19]
    ds_read_b64_tr_b16 v[44:45], v251 offset:57344
    v_mfma_f32_16x16x32_bf16 v[20:23], v[68:71], v[120:123], v[20:23]
    ds_read_b64_tr_b16 v[46:47], v251 offset:59392
    v_mfma_f32_16x16x32_bf16 v[24:27], v[56:59], v[124:127], v[24:27]
    ds_read_b64_tr_b16 v[48:49], v252 offset:57344
    v_mfma_f32_16x16x32_bf16 v[28:31], v[60:63], v[124:127], v[28:31]
    ds_read_b64_tr_b16 v[50:51], v252 offset:59392
    v_mfma_f32_16x16x32_bf16 v[32:35], v[64:67], v[124:127], v[32:35]
    ds_read_b64_tr_b16 v[52:53], v253 offset:57344
    v_mfma_f32_16x16x32_bf16 v[36:39], v[68:71], v[124:127], v[36:39]
    ds_read_b64_tr_b16 v[54:55], v253 offset:59392
    buffer_load_dwordx4 v[120:123], v5, s[12:15], s72 offen offset:0 sc1
    buffer_load_dwordx4 v[124:127], v4, s[12:15], s72 offen offset:0 sc1
    s_waitcnt vmcnt(12)
    s_waitcnt lgkmcnt(0)
    v_mfma_f32_16x16x32_bf16 v[8:11], v[40:43], v[72:75], v[8:11]
    ds_read_b64_tr_b16 v[56:57], v250 offset:61440
    v_mfma_f32_16x16x32_bf16 v[12:15], v[44:47], v[72:75], v[12:15]
    ds_read_b64_tr_b16 v[58:59], v250 offset:63488
    v_mfma_f32_16x16x32_bf16 v[16:19], v[48:51], v[72:75], v[16:19]
    ds_read_b64_tr_b16 v[60:61], v251 offset:61440
    v_mfma_f32_16x16x32_bf16 v[20:23], v[52:55], v[72:75], v[20:23]
    ds_read_b64_tr_b16 v[62:63], v251 offset:63488
    v_mfma_f32_16x16x32_bf16 v[24:27], v[40:43], v[76:79], v[24:27]
    ds_read_b64_tr_b16 v[64:65], v252 offset:61440
    v_mfma_f32_16x16x32_bf16 v[28:31], v[44:47], v[76:79], v[28:31]
    ds_read_b64_tr_b16 v[66:67], v252 offset:63488
    v_mfma_f32_16x16x32_bf16 v[32:35], v[48:51], v[76:79], v[32:35]
    ds_read_b64_tr_b16 v[68:69], v253 offset:61440
    v_mfma_f32_16x16x32_bf16 v[36:39], v[52:55], v[76:79], v[36:39]
    ds_read_b64_tr_b16 v[70:71], v253 offset:63488
    buffer_load_dwordx4 v[72:75], v5, s[12:15], s72 offen offset:1024 sc1
    buffer_load_dwordx4 v[76:79], v4, s[12:15], s72 offen offset:1024 sc1
    s_waitcnt vmcnt(12)
    s_waitcnt lgkmcnt(0)
    v_add_u32 v250, 0x10000, v250
    v_add_u32 v251, 0x10000, v251
    v_add_u32 v252, 0x10000, v252
    v_add_u32 v253, 0x10000, v253
    v_mfma_f32_16x16x32_bf16 v[8:11], v[56:59], v[80:83], v[8:11]
    ds_read_b64_tr_b16 v[40:41], v250 offset:0
    v_mfma_f32_16x16x32_bf16 v[12:15], v[60:63], v[80:83], v[12:15]
    ds_read_b64_tr_b16 v[42:43], v250 offset:2048
    v_mfma_f32_16x16x32_bf16 v[16:19], v[64:67], v[80:83], v[16:19]
    ds_read_b64_tr_b16 v[44:45], v251 offset:0
    v_mfma_f32_16x16x32_bf16 v[20:23], v[68:71], v[80:83], v[20:23]
    ds_read_b64_tr_b16 v[46:47], v251 offset:2048
    v_mfma_f32_16x16x32_bf16 v[24:27], v[56:59], v[84:87], v[24:27]
    ds_read_b64_tr_b16 v[48:49], v252 offset:0
    v_mfma_f32_16x16x32_bf16 v[28:31], v[60:63], v[84:87], v[28:31]
    ds_read_b64_tr_b16 v[50:51], v252 offset:2048
    v_mfma_f32_16x16x32_bf16 v[32:35], v[64:67], v[84:87], v[32:35]
    ds_read_b64_tr_b16 v[52:53], v253 offset:0
    v_mfma_f32_16x16x32_bf16 v[36:39], v[68:71], v[84:87], v[36:39]
    ds_read_b64_tr_b16 v[54:55], v253 offset:2048
    buffer_load_dwordx4 v[80:83], v5, s[12:15], s72 offen offset:2048 sc1
    buffer_load_dwordx4 v[84:87], v4, s[12:15], s72 offen offset:2048 sc1
    s_waitcnt vmcnt(12)
    s_waitcnt lgkmcnt(0)
    v_mfma_f32_16x16x32_bf16 v[8:11], v[40:43], v[88:91], v[8:11]
    ds_read_b64_tr_b16 v[56:57], v250 offset:4096
    v_mfma_f32_16x16x32_bf16 v[12:15], v[44:47], v[88:91], v[12:15]
    ds_read_b64_tr_b16 v[58:59], v250 offset:6144
    v_mfma_f32_16x16x32_bf16 v[16:19], v[48:51], v[88:91], v[16:19]
    ds_read_b64_tr_b16 v[60:61], v251 offset:4096
    v_mfma_f32_16x16x32_bf16 v[20:23], v[52:55], v[88:91], v[20:23]
    ds_read_b64_tr_b16 v[62:63], v251 offset:6144
    v_mfma_f32_16x16x32_bf16 v[24:27], v[40:43], v[92:95], v[24:27]
    ds_read_b64_tr_b16 v[64:65], v252 offset:4096
    v_mfma_f32_16x16x32_bf16 v[28:31], v[44:47], v[92:95], v[28:31]
    ds_read_b64_tr_b16 v[66:67], v252 offset:6144
    v_mfma_f32_16x16x32_bf16 v[32:35], v[48:51], v[92:95], v[32:35]
    ds_read_b64_tr_b16 v[68:69], v253 offset:4096
    v_mfma_f32_16x16x32_bf16 v[36:39], v[52:55], v[92:95], v[36:39]
    ds_read_b64_tr_b16 v[70:71], v253 offset:6144
    buffer_load_dwordx4 v[88:91], v5, s[12:15], s72 offen offset:3072 sc1
    buffer_load_dwordx4 v[92:95], v4, s[12:15], s72 offen offset:3072 sc1
    s_add_u32 s72, s72, 4096
    s_waitcnt vmcnt(12)
    s_waitcnt lgkmcnt(0)
    v_mfma_f32_16x16x32_bf16 v[8:11], v[56:59], v[96:99], v[8:11]
    ds_read_b64_tr_b16 v[40:41], v250 offset:8192
    v_mfma_f32_16x16x32_bf16 v[12:15], v[60:63], v[96:99], v[12:15]
    ds_read_b64_tr_b16 v[42:43], v250 offset:10240
    v_mfma_f32_16x16x32_bf16 v[16:19], v[64:67], v[96:99], v[16:19]
    ds_read_b64_tr_b16 v[44:45], v251 offset:8192
    v_mfma_f32_16x16x32_bf16 v[20:23], v[68:71], v[96:99], v[20:23]
    ds_read_b64_tr_b16 v[46:47], v251 offset:10240
    v_mfma_f32_16x16x32_bf16 v[24:27], v[56:59], v[100:103], v[24:27]
    ds_read_b64_tr_b16 v[48:49], v252 offset:8192
    v_mfma_f32_16x16x32_bf16 v[28:31], v[60:63], v[100:103], v[28:31]
    ds_read_b64_tr_b16 v[50:51], v252 offset:10240
    v_mfma_f32_16x16x32_bf16 v[32:35], v[64:67], v[100:103], v[32:35]
    ds_read_b64_tr_b16 v[52:53], v253 offset:8192
    v_mfma_f32_16x16x32_bf16 v[36:39], v[68:71], v[100:103], v[36:39]
    ds_read_b64_tr_b16 v[54:55], v253 offset:10240
    buffer_load_dwordx4 v[96:99], v5, s[12:15], s72 offen offset:0 sc1
    buffer_load_dwordx4 v[100:103], v4, s[12:15], s72 offen offset:0 sc1
    s_waitcnt vmcnt(12)
    s_waitcnt lgkmcnt(0)
    v_mfma_f32_16x16x32_bf16 v[8:11], v[40:43], v[104:107], v[8:11]
    ds_read_b64_tr_b16 v[56:57], v250 offset:12288
    v_mfma_f32_16x16x32_bf16 v[12:15], v[44:47], v[104:107], v[12:15]
    ds_read_b64_tr_b16 v[58:59], v250 offset:14336
    v_mfma_f32_16x16x32_bf16 v[16:19], v[48:51], v[104:107], v[16:19]
    ds_read_b64_tr_b16 v[60:61], v251 offset:12288
    v_mfma_f32_16x16x32_bf16 v[20:23], v[52:55], v[104:107], v[20:23]
    ds_read_b64_tr_b16 v[62:63], v251 offset:14336
    v_mfma_f32_16x16x32_bf16 v[24:27], v[40:43], v[108:111], v[24:27]
    ds_read_b64_tr_b16 v[64:65], v252 offset:12288
    v_mfma_f32_16x16x32_bf16 v[28:31], v[44:47], v[108:111], v[28:31]
    ds_read_b64_tr_b16 v[66:67], v252 offset:14336
    v_mfma_f32_16x16x32_bf16 v[32:35], v[48:51], v[108:111], v[32:35]
    ds_read_b64_tr_b16 v[68:69], v253 offset:12288
    v_mfma_f32_16x16x32_bf16 v[36:39], v[52:55], v[108:111], v[36:39]
    ds_read_b64_tr_b16 v[70:71], v253 offset:14336
    buffer_load_dwordx4 v[104:107], v5, s[12:15], s72 offen offset:1024 sc1
    buffer_load_dwordx4 v[108:111], v4, s[12:15], s72 offen offset:1024 sc1
    s_waitcnt vmcnt(12)
    s_waitcnt lgkmcnt(0)
    v_mfma_f32_16x16x32_bf16 v[8:11], v[56:59], v[112:115], v[8:11]
    ds_read_b64_tr_b16 v[40:41], v250 offset:16384
    v_mfma_f32_16x16x32_bf16 v[12:15], v[60:63], v[112:115], v[12:15]
    ds_read_b64_tr_b16 v[42:43], v250 offset:18432
    v_mfma_f32_16x16x32_bf16 v[16:19], v[64:67], v[112:115], v[16:19]
    ds_read_b64_tr_b16 v[44:45], v251 offset:16384
    v_mfma_f32_16x16x32_bf16 v[20:23], v[68:71], v[112:115], v[20:23]
    ds_read_b64_tr_b16 v[46:47], v251 offset:18432
    v_mfma_f32_16x16x32_bf16 v[24:27], v[56:59], v[116:119], v[24:27]
    ds_read_b64_tr_b16 v[48:49], v252 offset:16384
    v_mfma_f32_16x16x32_bf16 v[28:31], v[60:63], v[116:119], v[28:31]
    ds_read_b64_tr_b16 v[50:51], v252 offset:18432
    v_mfma_f32_16x16x32_bf16 v[32:35], v[64:67], v[116:119], v[32:35]
    ds_read_b64_tr_b16 v[52:53], v253 offset:16384
    v_mfma_f32_16x16x32_bf16 v[36:39], v[68:71], v[116:119], v[36:39]
    ds_read_b64_tr_b16 v[54:55], v253 offset:18432
    buffer_load_dwordx4 v[112:115], v5, s[12:15], s72 offen offset:2048 sc1
    buffer_load_dwordx4 v[116:119], v4, s[12:15], s72 offen offset:2048 sc1
    s_waitcnt vmcnt(12)
    s_waitcnt lgkmcnt(0)
    v_mfma_f32_16x16x32_bf16 v[8:11], v[40:43], v[120:123], v[8:11]
    ds_read_b64_tr_b16 v[56:57], v250 offset:20480
    v_mfma_f32_16x16x32_bf16 v[12:15], v[44:47], v[120:123], v[12:15]
    ds_read_b64_tr_b16 v[58:59], v250 offset:22528
    v_mfma_f32_16x16x32_bf16 v[16:19], v[48:51], v[120:123], v[16:19]
    ds_read_b64_tr_b16 v[60:61], v251 offset:20480
    v_mfma_f32_16x16x32_bf16 v[20:23], v[52:55], v[120:123], v[20:23]
    ds_read_b64_tr_b16 v[62:63], v251 offset:22528
    v_mfma_f32_16x16x32_bf16 v[24:27], v[40:43], v[124:127], v[24:27]
    ds_read_b64_tr_b16 v[64:65], v252 offset:20480
    v_mfma_f32_16x16x32_bf16 v[28:31], v[44:47], v[124:127], v[28:31]
    ds_read_b64_tr_b16 v[66:67], v252 offset:22528
    v_mfma_f32_16x16x32_bf16 v[32:35], v[48:51], v[124:127], v[32:35]
    ds_read_b64_tr_b16 v[68:69], v253 offset:20480
    v_mfma_f32_16x16x32_bf16 v[36:39], v[52:55], v[124:127], v[36:39]
    ds_read_b64_tr_b16 v[70:71], v253 offset:22528
    buffer_load_dwordx4 v[120:123], v5, s[12:15], s72 offen offset:3072 sc1
    buffer_load_dwordx4 v[124:127], v4, s[12:15], s72 offen offset:3072 sc1
    s_add_u32 s72, s72, 4096
    s_waitcnt vmcnt(12)
    s_waitcnt lgkmcnt(0)
    v_mfma_f32_16x16x32_bf16 v[8:11], v[56:59], v[72:75], v[8:11]
    ds_read_b64_tr_b16 v[40:41], v250 offset:24576
    v_mfma_f32_16x16x32_bf16 v[12:15], v[60:63], v[72:75], v[12:15]
    ds_read_b64_tr_b16 v[42:43], v250 offset:26624
    v_mfma_f32_16x16x32_bf16 v[16:19], v[64:67], v[72:75], v[16:19]
    ds_read_b64_tr_b16 v[44:45], v251 offset:24576
    v_mfma_f32_16x16x32_bf16 v[20:23], v[68:71], v[72:75], v[20:23]
    ds_read_b64_tr_b16 v[46:47], v251 offset:26624
    v_mfma_f32_16x16x32_bf16 v[24:27], v[56:59], v[76:79], v[24:27]
    ds_read_b64_tr_b16 v[48:49], v252 offset:24576
    v_mfma_f32_16x16x32_bf16 v[28:31], v[60:63], v[76:79], v[28:31]
    ds_read_b64_tr_b16 v[50:51], v252 offset:26624
    v_mfma_f32_16x16x32_bf16 v[32:35], v[64:67], v[76:79], v[32:35]
    ds_read_b64_tr_b16 v[52:53], v253 offset:24576
    v_mfma_f32_16x16x32_bf16 v[36:39], v[68:71], v[76:79], v[36:39]
    ds_read_b64_tr_b16 v[54:55], v253 offset:26624
    buffer_load_dwordx4 v[72:75], v5, s[12:15], s72 offen offset:0 sc1
    buffer_load_dwordx4 v[76:79], v4, s[12:15], s72 offen offset:0 sc1
    s_waitcnt vmcnt(12)
    s_waitcnt lgkmcnt(0)
    v_mfma_f32_16x16x32_bf16 v[8:11], v[40:43], v[80:83], v[8:11]
    ds_read_b64_tr_b16 v[56:57], v250 offset:28672
    v_mfma_f32_16x16x32_bf16 v[12:15], v[44:47], v[80:83], v[12:15]
    ds_read_b64_tr_b16 v[58:59], v250 offset:30720
    v_mfma_f32_16x16x32_bf16 v[16:19], v[48:51], v[80:83], v[16:19]
    ds_read_b64_tr_b16 v[60:61], v251 offset:28672
    v_mfma_f32_16x16x32_bf16 v[20:23], v[52:55], v[80:83], v[20:23]
    ds_read_b64_tr_b16 v[62:63], v251 offset:30720
    v_mfma_f32_16x16x32_bf16 v[24:27], v[40:43], v[84:87], v[24:27]
    ds_read_b64_tr_b16 v[64:65], v252 offset:28672
    v_mfma_f32_16x16x32_bf16 v[28:31], v[44:47], v[84:87], v[28:31]
    ds_read_b64_tr_b16 v[66:67], v252 offset:30720
    v_mfma_f32_16x16x32_bf16 v[32:35], v[48:51], v[84:87], v[32:35]
    ds_read_b64_tr_b16 v[68:69], v253 offset:28672
    v_mfma_f32_16x16x32_bf16 v[36:39], v[52:55], v[84:87], v[36:39]
    ds_read_b64_tr_b16 v[70:71], v253 offset:30720
    buffer_load_dwordx4 v[80:83], v5, s[12:15], s72 offen offset:1024 sc1
    buffer_load_dwordx4 v[84:87], v4, s[12:15], s72 offen offset:1024 sc1
    s_waitcnt vmcnt(12)
    s_waitcnt lgkmcnt(0)
    v_mfma_f32_16x16x32_bf16 v[8:11], v[56:59], v[88:91], v[8:11]
    ds_read_b64_tr_b16 v[40:41], v250 offset:32768
    v_mfma_f32_16x16x32_bf16 v[12:15], v[60:63], v[88:91], v[12:15]
    ds_read_b64_tr_b16 v[42:43], v250 offset:34816
    v_mfma_f32_16x16x32_bf16 v[16:19], v[64:67], v[88:91], v[16:19]
    ds_read_b64_tr_b16 v[44:45], v251 offset:32768
    v_mfma_f32_16x16x32_bf16 v[20:23], v[68:71], v[88:91], v[20:23]
    ds_read_b64_tr_b16 v[46:47], v251 offset:34816
    v_mfma_f32_16x16x32_bf16 v[24:27], v[56:59], v[92:95], v[24:27]
    ds_read_b64_tr_b16 v[48:49], v252 offset:32768
    v_mfma_f32_16x16x32_bf16 v[28:31], v[60:63], v[92:95], v[28:31]
    ds_read_b64_tr_b16 v[50:51], v252 offset:34816
    v_mfma_f32_16x16x32_bf16 v[32:35], v[64:67], v[92:95], v[32:35]
    ds_read_b64_tr_b16 v[52:53], v253 offset:32768
    v_mfma_f32_16x16x32_bf16 v[36:39], v[68:71], v[92:95], v[36:39]
    ds_read_b64_tr_b16 v[54:55], v253 offset:34816
    buffer_load_dwordx4 v[88:91], v5, s[12:15], s72 offen offset:2048 sc1
    buffer_load_dwordx4 v[92:95], v4, s[12:15], s72 offen offset:2048 sc1
    s_waitcnt vmcnt(12)
    s_waitcnt lgkmcnt(0)
    v_mfma_f32_16x16x32_bf16 v[8:11], v[40:43], v[96:99], v[8:11]
    ds_read_b64_tr_b16 v[56:57], v250 offset:36864
    v_mfma_f32_16x16x32_bf16 v[12:15], v[44:47], v[96:99], v[12:15]
    ds_read_b64_tr_b16 v[58:59], v250 offset:38912
    v_mfma_f32_16x16x32_bf16 v[16:19], v[48:51], v[96:99], v[16:19]
    ds_read_b64_tr_b16 v[60:61], v251 offset:36864
    v_mfma_f32_16x16x32_bf16 v[20:23], v[52:55], v[96:99], v[20:23]
    ds_read_b64_tr_b16 v[62:63], v251 offset:38912
    v_mfma_f32_16x16x32_bf16 v[24:27], v[40:43], v[100:103], v[24:27]
    ds_read_b64_tr_b16 v[64:65], v252 offset:36864
    v_mfma_f32_16x16x32_bf16 v[28:31], v[44:47], v[100:103], v[28:31]
    ds_read_b64_tr_b16 v[66:67], v252 offset:38912
    v_mfma_f32_16x16x32_bf16 v[32:35], v[48:51], v[100:103], v[32:35]
    ds_read_b64_tr_b16 v[68:69], v253 offset:36864
    v_mfma_f32_16x16x32_bf16 v[36:39], v[52:55], v[100:103], v[36:39]
    ds_read_b64_tr_b16 v[70:71], v253 offset:38912
    buffer_load_dwordx4 v[96:99], v5, s[12:15], s72 offen offset:3072 sc1
    buffer_load_dwordx4 v[100:103], v4, s[12:15], s72 offen offset:3072 sc1
    s_add_u32 s72, s72, 4096
    s_waitcnt vmcnt(12)
    s_waitcnt lgkmcnt(0)
    v_mfma_f32_16x16x32_bf16 v[8:11], v[56:59], v[104:107], v[8:11]
    ds_read_b64_tr_b16 v[40:41], v250 offset:40960
    v_mfma_f32_16x16x32_bf16 v[12:15], v[60:63], v[104:107], v[12:15]
    ds_read_b64_tr_b16 v[42:43], v250 offset:43008
    v_mfma_f32_16x16x32_bf16 v[16:19], v[64:67], v[104:107], v[16:19]
    ds_read_b64_tr_b16 v[44:45], v251 offset:40960
    v_mfma_f32_16x16x32_bf16 v[20:23], v[68:71], v[104:107], v[20:23]
    ds_read_b64_tr_b16 v[46:47], v251 offset:43008
    v_mfma_f32_16x16x32_bf16 v[24:27], v[56:59], v[108:111], v[24:27]
    ds_read_b64_tr_b16 v[48:49], v252 offset:40960
    v_mfma_f32_16x16x32_bf16 v[28:31], v[60:63], v[108:111], v[28:31]
    ds_read_b64_tr_b16 v[50:51], v252 offset:43008
    v_mfma_f32_16x16x32_bf16 v[32:35], v[64:67], v[108:111], v[32:35]
    ds_read_b64_tr_b16 v[52:53], v253 offset:40960
    v_mfma_f32_16x16x32_bf16 v[36:39], v[68:71], v[108:111], v[36:39]
    ds_read_b64_tr_b16 v[54:55], v253 offset:43008
    s_waitcnt vmcnt(10)
    s_waitcnt lgkmcnt(0)
    v_mfma_f32_16x16x32_bf16 v[8:11], v[40:43], v[112:115], v[8:11]
    ds_read_b64_tr_b16 v[56:57], v250 offset:45056
    v_mfma_f32_16x16x32_bf16 v[12:15], v[44:47], v[112:115], v[12:15]
    ds_read_b64_tr_b16 v[58:59], v250 offset:47104
    v_mfma_f32_16x16x32_bf16 v[16:19], v[48:51], v[112:115], v[16:19]
    ds_read_b64_tr_b16 v[60:61], v251 offset:45056
    v_mfma_f32_16x16x32_bf16 v[20:23], v[52:55], v[112:115], v[20:23]
    ds_read_b64_tr_b16 v[62:63], v251 offset:47104
    v_mfma_f32_16x16x32_bf16 v[24:27], v[40:43], v[116:119], v[24:27]
    ds_read_b64_tr_b16 v[64:65], v252 offset:45056
    v_mfma_f32_16x16x32_bf16 v[28:31], v[44:47], v[116:119], v[28:31]
    ds_read_b64_tr_b16 v[66:67], v252 offset:47104
    v_mfma_f32_16x16x32_bf16 v[32:35], v[48:51], v[116:119], v[32:35]
    ds_read_b64_tr_b16 v[68:69], v253 offset:45056
    v_mfma_f32_16x16x32_bf16 v[36:39], v[52:55], v[116:119], v[36:39]
    ds_read_b64_tr_b16 v[70:71], v253 offset:47104
    s_waitcnt vmcnt(8)
    s_waitcnt lgkmcnt(0)
    v_mfma_f32_16x16x32_bf16 v[8:11], v[56:59], v[120:123], v[8:11]
    ds_read_b64_tr_b16 v[40:41], v250 offset:49152
    v_mfma_f32_16x16x32_bf16 v[12:15], v[60:63], v[120:123], v[12:15]
    ds_read_b64_tr_b16 v[42:43], v250 offset:51200
    v_mfma_f32_16x16x32_bf16 v[16:19], v[64:67], v[120:123], v[16:19]
    ds_read_b64_tr_b16 v[44:45], v251 offset:49152
    v_mfma_f32_16x16x32_bf16 v[20:23], v[68:71], v[120:123], v[20:23]
    ds_read_b64_tr_b16 v[46:47], v251 offset:51200
    v_mfma_f32_16x16x32_bf16 v[24:27], v[56:59], v[124:127], v[24:27]
    ds_read_b64_tr_b16 v[48:49], v252 offset:49152
    v_mfma_f32_16x16x32_bf16 v[28:31], v[60:63], v[124:127], v[28:31]
    ds_read_b64_tr_b16 v[50:51], v252 offset:51200
    v_mfma_f32_16x16x32_bf16 v[32:35], v[64:67], v[124:127], v[32:35]
    ds_read_b64_tr_b16 v[52:53], v253 offset:49152
    v_mfma_f32_16x16x32_bf16 v[36:39], v[68:71], v[124:127], v[36:39]
    ds_read_b64_tr_b16 v[54:55], v253 offset:51200
    s_waitcnt vmcnt(6)
    s_waitcnt lgkmcnt(0)
    v_mfma_f32_16x16x32_bf16 v[8:11], v[40:43], v[72:75], v[8:11]
    ds_read_b64_tr_b16 v[56:57], v250 offset:53248
    v_mfma_f32_16x16x32_bf16 v[12:15], v[44:47], v[72:75], v[12:15]
    ds_read_b64_tr_b16 v[58:59], v250 offset:55296
    v_mfma_f32_16x16x32_bf16 v[16:19], v[48:51], v[72:75], v[16:19]
    ds_read_b64_tr_b16 v[60:61], v251 offset:53248
    v_mfma_f32_16x16x32_bf16 v[20:23], v[52:55], v[72:75], v[20:23]
    ds_read_b64_tr_b16 v[62:63], v251 offset:55296
    v_mfma_f32_16x16x32_bf16 v[24:27], v[40:43], v[76:79], v[24:27]
    ds_read_b64_tr_b16 v[64:65], v252 offset:53248
    v_mfma_f32_16x16x32_bf16 v[28:31], v[44:47], v[76:79], v[28:31]
    ds_read_b64_tr_b16 v[66:67], v252 offset:55296
    v_mfma_f32_16x16x32_bf16 v[32:35], v[48:51], v[76:79], v[32:35]
    ds_read_b64_tr_b16 v[68:69], v253 offset:53248
    v_mfma_f32_16x16x32_bf16 v[36:39], v[52:55], v[76:79], v[36:39]
    ds_read_b64_tr_b16 v[70:71], v253 offset:55296
    s_waitcnt vmcnt(4)
    s_waitcnt lgkmcnt(0)
    v_mfma_f32_16x16x32_bf16 v[8:11], v[56:59], v[80:83], v[8:11]
    ds_read_b64_tr_b16 v[40:41], v250 offset:57344
    v_mfma_f32_16x16x32_bf16 v[12:15], v[60:63], v[80:83], v[12:15]
    ds_read_b64_tr_b16 v[42:43], v250 offset:59392
    v_mfma_f32_16x16x32_bf16 v[16:19], v[64:67], v[80:83], v[16:19]
    ds_read_b64_tr_b16 v[44:45], v251 offset:57344
    v_mfma_f32_16x16x32_bf16 v[20:23], v[68:71], v[80:83], v[20:23]
    ds_read_b64_tr_b16 v[46:47], v251 offset:59392
    v_mfma_f32_16x16x32_bf16 v[24:27], v[56:59], v[84:87], v[24:27]
    ds_read_b64_tr_b16 v[48:49], v252 offset:57344
    v_mfma_f32_16x16x32_bf16 v[28:31], v[60:63], v[84:87], v[28:31]
    ds_read_b64_tr_b16 v[50:51], v252 offset:59392
    v_mfma_f32_16x16x32_bf16 v[32:35], v[64:67], v[84:87], v[32:35]
    ds_read_b64_tr_b16 v[52:53], v253 offset:57344
    v_mfma_f32_16x16x32_bf16 v[36:39], v[68:71], v[84:87], v[36:39]
    ds_read_b64_tr_b16 v[54:55], v253 offset:59392
    s_waitcnt vmcnt(2)
    s_waitcnt lgkmcnt(0)
    v_mov_b32 v7, 5
    ds_write_b32 v249, v7 offset:32
    v_mfma_f32_16x16x32_bf16 v[8:11], v[40:43], v[88:91], v[8:11]
    ds_read_b64_tr_b16 v[56:57], v250 offset:61440
    v_mfma_f32_16x16x32_bf16 v[12:15], v[44:47], v[88:91], v[12:15]
    ds_read_b64_tr_b16 v[58:59], v250 offset:63488
    v_mfma_f32_16x16x32_bf16 v[16:19], v[48:51], v[88:91], v[16:19]
    ds_read_b64_tr_b16 v[60:61], v251 offset:61440
    v_mfma_f32_16x16x32_bf16 v[20:23], v[52:55], v[88:91], v[20:23]
    ds_read_b64_tr_b16 v[62:63], v251 offset:63488
    v_mfma_f32_16x16x32_bf16 v[24:27], v[40:43], v[92:95], v[24:27]
    ds_read_b64_tr_b16 v[64:65], v252 offset:61440
    v_mfma_f32_16x16x32_bf16 v[28:31], v[44:47], v[92:95], v[28:31]
    ds_read_b64_tr_b16 v[66:67], v252 offset:63488
    v_mfma_f32_16x16x32_bf16 v[32:35], v[48:51], v[92:95], v[32:35]
    ds_read_b64_tr_b16 v[68:69], v253 offset:61440
    v_mfma_f32_16x16x32_bf16 v[36:39], v[52:55], v[92:95], v[36:39]
    ds_read_b64_tr_b16 v[70:71], v253 offset:63488
    s_waitcnt vmcnt(0)
    s_waitcnt lgkmcnt(0)
    v_mfma_f32_16x16x32_bf16 v[8:11], v[56:59], v[96:99], v[8:11]
    v_mfma_f32_16x16x32_bf16 v[12:15], v[60:63], v[96:99], v[12:15]
    v_mfma_f32_16x16x32_bf16 v[16:19], v[64:67], v[96:99], v[16:19]
    v_mfma_f32_16x16x32_bf16 v[20:23], v[68:71], v[96:99], v[20:23]
    v_mfma_f32_16x16x32_bf16 v[24:27], v[56:59], v[100:103], v[24:27]
    v_mfma_f32_16x16x32_bf16 v[28:31], v[60:63], v[100:103], v[28:31]
    v_mfma_f32_16x16x32_bf16 v[32:35], v[64:67], v[100:103], v[32:35]
    v_mfma_f32_16x16x32_bf16 v[36:39], v[68:71], v[100:103], v[36:39]
    s_nop 0
    v_cvt_pk_bf16_f32 v72, v8, v9
    v_cvt_pk_bf16_f32 v73, v10, v11
    ds_write_b64 v240, v[72:73] offset:0
    v_cvt_pk_bf16_f32 v74, v12, v13
    v_cvt_pk_bf16_f32 v75, v14, v15
    ds_write_b64 v240, v[74:75] offset:32
    v_cvt_pk_bf16_f32 v76, v16, v17
    v_cvt_pk_bf16_f32 v77, v18, v19
    ds_write_b64 v240, v[76:77] offset:64
    v_cvt_pk_bf16_f32 v78, v20, v21
    v_cvt_pk_bf16_f32 v79, v22, v23
    ds_write_b64 v240, v[78:79] offset:96
    v_cvt_pk_bf16_f32 v80, v24, v25
    v_cvt_pk_bf16_f32 v81, v26, v27
    ds_write_b64 v240, v[80:81] offset:2304
    v_cvt_pk_bf16_f32 v82, v28, v29
    v_cvt_pk_bf16_f32 v83, v30, v31
    ds_write_b64 v240, v[82:83] offset:2336
    v_cvt_pk_bf16_f32 v84, v32, v33
    v_cvt_pk_bf16_f32 v85, v34, v35
    ds_write_b64 v240, v[84:85] offset:2368
    v_cvt_pk_bf16_f32 v86, v36, v37
    v_cvt_pk_bf16_f32 v87, v38, v39
    ds_write_b64 v240, v[86:87] offset:2400
    v_mov_b32 v7, 7
    ds_write_b32 v249, v7 offset:32
    s_endpgm
.p2align 8
L_code_end:
.fill 3072, 4, 0xbf800000
.section .rodata,"a"
.p2align 6
.amdhsa_kernel recurrent_scan__linear_kernel_hedgehog__moe_arch_mod__prompt_kernel
  .amdhsa_next_free_vgpr 256
  .amdhsa_next_free_sgpr 102
  .amdhsa_accum_offset 256
  .amdhsa_group_segment_fixed_size 0
  .amdhsa_kernarg_size 96
  .amdhsa_user_sgpr_count 2
  .amdhsa_user_sgpr_kernarg_segment_ptr 1
  .amdhsa_system_sgpr_workgroup_id_x 1
.end_amdhsa_kernel
```

```asm
; @launch grid=(256,1,1) block=(512,1,1) lds=163840
.amdgcn_target "amdgcn-amd-amdhsa--gfx950"
.text
.globl recurrent_scan__linear_kernel_hedgehog__moe_arch_mod__prompt_kernel
.p2align 8
.type recurrent_scan__linear_kernel_hedgehog__moe_arch_mod__prompt_kernel,@function
recurrent_scan__linear_kernel_hedgehog__moe_arch_mod__prompt_kernel:
    s_cmp_ge_u32 s2, 256
    s_cbranch_scc1 L_done
    s_load_dwordx16 s[40:55], s[0:1], 0
    s_load_dwordx8 s[56:63], s[0:1], 64
    v_and_b32 v1, 63, v0
    v_lshrrev_b32 v2, 6, v0
    s_nop 0
    v_readfirstlane_b32 s38, v2
    s_and_b32 s65, s2, 1
    s_bfe_u32 s66, s2, 0x30003
    s_bfe_u32 s67, s2, 0x20001
    s_lshl_b32 s67, s67, 2
    s_lshl_b32 s36, s65, 3
    s_add_u32 s36, s36, s66
    s_lshr_b32 s3, s2, 6
    s_add_u32 s37, s67, s3
    s_lshr_b32 s39, s66, 0
    s_lshl_b32 s39, s39, 1
    s_add_u32 s39, s39, s65
    s_lshl_b32 s39, s39, 0
    s_and_b32 s101, s66, 0
    s_add_u32 s39, s39, s67
    s_and_b32 s39, s39, 15
    s_and_b32 s67, s2, 7
    s_lshl_b32 s67, s67, 1
    s_bfe_u32 s3, s2, 0x10003
    s_add_u32 s37, s67, s3
    s_lshr_b32 s36, s2, 4
    s_and_b32 s101, s36, 0
    s_sub_u32 s39, s36, s101
    s_add_u32 s39, s39, s67
    s_and_b32 s39, s39, 15
    s_cmp_lt_u32 s38, 4
    s_cbranch_scc1 L_g1
    s_sub_u32 s38, s38, 4
    s_lshl_b32 s3, s38, 4
    v_lshrrev_b32 v7, 3, v1
    v_add_u32 v3, s3, v7
    v_mul_u32_u24 v3, 6144, v3
    s_lshl_b32 s3, s37, 7
    v_add_u32 v3, s3, v3
    v_and_b32 v6, 7, v1
    v_bfe_u32 v5, v1, 4, 1
    v_lshlrev_b32 v5, 1, v5
    v_xor_b32 v5, v6, v5
    v_lshl_add_u32 v16, v5, 4, v3
    v_xor_b32 v5, 4, v5
    v_lshl_add_u32 v5, v5, 4, v3
    v_add_u32 v17, 48128, v5
    v_add_u32 v12, 2048, v16
    v_add_u32 v13, 2048, v17
    v_add_u32 v14, 4096, v16
    v_add_u32 v15, 4096, v17
    s_lshl_b32 s3, s36, 7
    s_lshl_b32 s65, s38, 5
    s_add_u32 s3, s3, s65
    v_add_u32 v3, s3, v7
    v_lshlrev_b32 v3, 11, v3
    v_lshrrev_b32 v5, 4, v1
    v_xor_b32 v6, v6, v5
    v_xor_b32 v5, 4, v6
    v_lshl_add_u32 v8, v6, 4, v3
    v_lshl_add_u32 v5, v5, 4, v3
    v_add_u32 v9, 15360, v5
    v_add_u32 v10, 30720, v8
    v_add_u32 v11, 46080, v5
    s_lshl_b32 s72, s38, 12
    s_lshl_b32 s73, s38, 11
    s_lshl_b32 s74, s39, 7
    s_mul_i32 s75, s39, 393216
    s_mov_b32 s76, s75
    s_waitcnt lgkmcnt(0)
    s_mov_b32 s8, s42
    s_mov_b32 s9, s43
    s_mov_b32 s10, 6291456
    s_mov_b32 s11, 0x00020000
    s_mov_b32 s4, s40
    s_mov_b32 s5, s41
    s_mov_b32 s6, 4194304
    s_mov_b32 s7, 0x00020000
    s_cmp_ge_u32 s38, 2
    s_cbranch_scc1 L_xw
    s_add_u32 s3, s75, 196608
    s_add_u32 m0, s73, 65536
    s_nop 0
    buffer_load_dwordx4 v12, s[8:11], s75 offen offset:0  lds
    buffer_load_dwordx4 v13, s[8:11], s75 offen offset:1024  lds
    s_add_u32 m0, s73, 73728
    s_nop 0
    buffer_load_dwordx4 v14, s[8:11], s75 offen offset:0  lds
    buffer_load_dwordx4 v15, s[8:11], s75 offen offset:1024  lds
    s_add_u32 m0, s73, 69632
    s_nop 0
    buffer_load_dwordx4 v12, s[8:11], s3 offen offset:0  lds
    buffer_load_dwordx4 v13, s[8:11], s3 offen offset:1024  lds
    s_add_u32 m0, s73, 77824
    s_nop 0
    buffer_load_dwordx4 v14, s[8:11], s3 offen offset:0  lds
    buffer_load_dwordx4 v15, s[8:11], s3 offen offset:1024  lds
    s_add_u32 s75, s75, 393216
    s_cmp_eq_u32 s75, 6291456
    s_cselect_b32 s75, 0, s75
    s_add_u32 m0, s73, 131072
    s_nop 0
    buffer_load_dwordx4 v16, s[8:11], s76 offen offset:0  lds
    buffer_load_dwordx4 v17, s[8:11], s76 offen offset:1024  lds
    s_add_u32 m0, s73, 135168
    s_add_u32 s3, s76, 196608
    buffer_load_dwordx4 v16, s[8:11], s3 offen offset:0  lds
    buffer_load_dwordx4 v17, s[8:11], s3 offen offset:1024  lds
    s_add_u32 s76, s76, 393216
    s_cmp_eq_u32 s76, 6291456
    s_cselect_b32 s76, 0, s76
    s_add_u32 m0, s72, 0
    s_nop 0
    buffer_load_dwordx4 v8, s[4:7], s74 offen offset:0  lds
    buffer_load_dwordx4 v9, s[4:7], s74 offen offset:1024  lds
    buffer_load_dwordx4 v10, s[4:7], s74 offen offset:2048  lds
    buffer_load_dwordx4 v11, s[4:7], s74 offen offset:3072  lds
    s_add_u32 m0, s72, 8192
    s_add_u32 s3, s74, 131072
    buffer_load_dwordx4 v8, s[4:7], s3 offen offset:0  lds
    buffer_load_dwordx4 v9, s[4:7], s3 offen offset:1024  lds
    buffer_load_dwordx4 v10, s[4:7], s3 offen offset:2048  lds
    buffer_load_dwordx4 v11, s[4:7], s3 offen offset:3072  lds
    s_add_u32 s74, s74, 128
    s_and_b32 s74, s74, 2047
    v_lshlrev_b32 v3, 4, v1
    s_mov_b32 s12, s62
    s_mov_b32 s13, s63
    s_mov_b32 s14, 268435456
    s_mov_b32 s15, 0x00020000
    s_mov_b32 s24, s58
    s_mov_b32 s25, s59
    s_mov_b32 s26, 4194304
    s_mov_b32 s27, 0x00020000
    s_mov_b32 s16, s60
    s_mov_b32 s17, s61
    s_mov_b32 s18, 256
    s_mov_b32 s19, 0x00020000
    s_mov_b32 s20, s44
    s_mov_b32 s21, s45
    s_mov_b32 s22, 65536
    s_mov_b32 s23, 0x00020000
    s_and_b32 s30, s2, 3
    s_lshl_b32 s30, s30, 2
    s_bfe_u32 s3, s2, 0x20003
    s_add_u32 s30, s30, s3
    s_bfe_u32 s31, s2, 0x10002
    s_lshl_b32 s31, s31, 3
    s_lshr_b32 s3, s2, 5
    s_add_u32 s31, s31, s3
    s_mov_b32 s70, 0
    s_mov_b32 s80, s52
    s_mov_b32 s81, s53
    s_mov_b32 s82, 7340032
    s_mov_b32 s83, 0x00020000
    s_mov_b32 s84, s54
    s_mov_b32 s85, s55
    s_mov_b32 s86, 7340032
    s_mov_b32 s87, 0x00020000
    s_cmp_lt_u32 s2, 224
    s_cselect_b32 s82, s82, 0
    s_cselect_b32 s86, s86, 0
    s_and_b32 s3, s2, 15
    s_lshl_b32 s3, s3, 6
    v_and_b32 v5, 0x38, v1
    v_add_u32 v5, s3, v5
    v_mul_u32_u24 v5, 7168, v5
    v_and_b32 v6, 7, v1
    v_lshl_add_u32 v2, v6, 4, v5
    s_lshr_b32 s77, s2, 4
    s_lshl_b32 s77, s77, 2
    s_add_u32 s77, s77, s38
    s_lshl_b32 s77, s77, 7
    v_and_b32 v5, 1, v1
    v_cmp_eq_u32 vcc, 0, v5
    v_mov_b32 v6, 0xffff0000
    v_mov_b32 v7, 0xffff
    v_cndmask_b32 v6, v6, v7, vcc
    v_bfe_u32 v5, v1, 1, 2
    v_cmp_eq_u32 vcc, 0, v5
    s_nop 1
    v_cndmask_b32 v88, 0, v6, vcc
    v_cmp_eq_u32 vcc, 1, v5
    s_nop 1
    v_cndmask_b32 v89, 0, v6, vcc
    v_cmp_eq_u32 vcc, 2, v5
    s_nop 1
    v_cndmask_b32 v90, 0, v6, vcc
    v_cmp_eq_u32 vcc, 3, v5
    s_nop 1
    v_cndmask_b32 v91, 0, v6, vcc
    v_and_b32 v20, 0x3f803f80, v88
    v_and_b32 v21, 0x3f803f80, v89
    v_and_b32 v22, 0x3f803f80, v90
    v_and_b32 v23, 0x3f803f80, v91
    s_lshl_b32 s3, s30, 7
    s_lshl_b32 s65, s38, 5
    s_add_u32 s3, s3, s65
    v_lshrrev_b32 v249, 3, v1
    v_add_u32 v6, s3, v249
    v_lshlrev_b32 v6, 11, v6
    v_and_b32 v250, 7, v1
    v_lshl_add_u32 v6, v250, 4, v6
    s_lshl_b32 s3, s31, 7
    v_add_u32 v248, s3, v6
    s_mov_b32 s48, 16384
    s_mov_b32 s49, 32768
    s_mov_b32 s100, 49152
    s_lshl_b32 s3, s38, 2
    s_add_u32 s3, s3, 163136
    v_mov_b32 v27, s3
    v_mov_b32 v26, 163104
    s_add_u32 m0, s72, 16384
    s_nop 0
    buffer_load_dwordx4 v8, s[4:7], s74 offen offset:0  lds
    buffer_load_dwordx4 v9, s[4:7], s74 offen offset:1024  lds
    buffer_load_dwordx4 v10, s[4:7], s74 offen offset:2048  lds
    buffer_load_dwordx4 v11, s[4:7], s74 offen offset:3072  lds
    s_add_u32 m0, s72, 24576
    s_add_u32 s3, s74, 131072
    buffer_load_dwordx4 v8, s[4:7], s3 offen offset:0  lds
    buffer_load_dwordx4 v9, s[4:7], s3 offen offset:1024  lds
    buffer_load_dwordx4 v10, s[4:7], s3 offen offset:2048  lds
    buffer_load_dwordx4 v11, s[4:7], s3 offen offset:3072  lds
    s_add_u32 s74, s74, 128
    s_and_b32 s74, s74, 2047
    s_add_u32 s3, s75, 196608
    s_add_u32 m0, s73, 81920
    s_nop 0
    buffer_load_dwordx4 v12, s[8:11], s75 offen offset:0  lds
    buffer_load_dwordx4 v13, s[8:11], s75 offen offset:1024  lds
    s_add_u32 m0, s73, 90112
    s_nop 0
    buffer_load_dwordx4 v14, s[8:11], s75 offen offset:0  lds
    buffer_load_dwordx4 v15, s[8:11], s75 offen offset:1024  lds
    s_add_u32 m0, s73, 86016
    s_nop 0
    buffer_load_dwordx4 v12, s[8:11], s3 offen offset:0  lds
    buffer_load_dwordx4 v13, s[8:11], s3 offen offset:1024  lds
    s_add_u32 m0, s73, 94208
    s_nop 0
    buffer_load_dwordx4 v14, s[8:11], s3 offen offset:0  lds
    buffer_load_dwordx4 v15, s[8:11], s3 offen offset:1024  lds
    s_add_u32 s75, s75, 393216
    s_cmp_eq_u32 s75, 6291456
    s_cselect_b32 s75, 0, s75
    s_add_u32 m0, s73, 139264
    s_nop 0
    buffer_load_dwordx4 v16, s[8:11], s76 offen offset:0  lds
    buffer_load_dwordx4 v17, s[8:11], s76 offen offset:1024  lds
    s_add_u32 m0, s73, 143360
    s_add_u32 s3, s76, 196608
    buffer_load_dwordx4 v16, s[8:11], s3 offen offset:0  lds
    buffer_load_dwordx4 v17, s[8:11], s3 offen offset:1024  lds
    s_add_u32 s76, s76, 393216
    s_cmp_eq_u32 s76, 6291456
    s_cselect_b32 s76, 0, s76
    s_waitcnt vmcnt(20)
    s_barrier
    s_add_u32 m0, s72, 32768
    s_nop 0
    buffer_load_dwordx4 v8, s[4:7], s74 offen offset:0  lds
    buffer_load_dwordx4 v9, s[4:7], s74 offen offset:1024  lds
    buffer_load_dwordx4 v10, s[4:7], s74 offen offset:2048  lds
    buffer_load_dwordx4 v11, s[4:7], s74 offen offset:3072  lds
    s_add_u32 m0, s72, 40960
    s_add_u32 s3, s74, 131072
    buffer_load_dwordx4 v8, s[4:7], s3 offen offset:0  lds
    buffer_load_dwordx4 v9, s[4:7], s3 offen offset:1024  lds
    buffer_load_dwordx4 v10, s[4:7], s3 offen offset:2048  lds
    buffer_load_dwordx4 v11, s[4:7], s3 offen offset:3072  lds
    s_add_u32 s74, s74, 128
    s_and_b32 s74, s74, 2047
    s_add_u32 s3, s75, 196608
    s_add_u32 m0, s73, 98304
    s_nop 0
    buffer_load_dwordx4 v12, s[8:11], s75 offen offset:0  lds
    buffer_load_dwordx4 v13, s[8:11], s75 offen offset:1024  lds
    s_add_u32 m0, s73, 106496
    s_nop 0
    buffer_load_dwordx4 v14, s[8:11], s75 offen offset:0  lds
    buffer_load_dwordx4 v15, s[8:11], s75 offen offset:1024  lds
    s_add_u32 m0, s73, 102400
    s_nop 0
    buffer_load_dwordx4 v12, s[8:11], s3 offen offset:0  lds
    buffer_load_dwordx4 v13, s[8:11], s3 offen offset:1024  lds
    s_add_u32 m0, s73, 110592
    s_nop 0
    buffer_load_dwordx4 v14, s[8:11], s3 offen offset:0  lds
    buffer_load_dwordx4 v15, s[8:11], s3 offen offset:1024  lds
    s_add_u32 s75, s75, 393216
    s_cmp_eq_u32 s75, 6291456
    s_cselect_b32 s75, 0, s75
    s_add_u32 m0, s73, 147456
    s_nop 0
    buffer_load_dwordx4 v16, s[8:11], s76 offen offset:0  lds
    buffer_load_dwordx4 v17, s[8:11], s76 offen offset:1024  lds
    s_add_u32 m0, s73, 151552
    s_add_u32 s3, s76, 196608
    buffer_load_dwordx4 v16, s[8:11], s3 offen offset:0  lds
    buffer_load_dwordx4 v17, s[8:11], s3 offen offset:1024  lds
    s_add_u32 s76, s76, 393216
    s_cmp_eq_u32 s76, 6291456
    s_cselect_b32 s76, 0, s76
    s_add_u32 m0, s72, 49152
    s_nop 0
    buffer_load_dwordx4 v8, s[4:7], s74 offen offset:0  lds
    buffer_load_dwordx4 v9, s[4:7], s74 offen offset:1024  lds
    buffer_load_dwordx4 v10, s[4:7], s74 offen offset:2048  lds
    buffer_load_dwordx4 v11, s[4:7], s74 offen offset:3072  lds
    s_add_u32 m0, s72, 57344
    s_add_u32 s3, s74, 131072
    buffer_load_dwordx4 v8, s[4:7], s3 offen offset:0  lds
    buffer_load_dwordx4 v9, s[4:7], s3 offen offset:1024  lds
    buffer_load_dwordx4 v10, s[4:7], s3 offen offset:2048  lds
    buffer_load_dwordx4 v11, s[4:7], s3 offen offset:3072  lds
    s_add_u32 s74, s74, 128
    s_and_b32 s74, s74, 2047
    s_waitcnt vmcnt(28)
    s_barrier
    s_add_u32 s3, s75, 196608
    s_add_u32 m0, s73, 114688
    s_nop 0
    buffer_load_dwordx4 v12, s[8:11], s75 offen offset:0  lds
    buffer_load_dwordx4 v13, s[8:11], s75 offen offset:1024  lds
    s_add_u32 m0, s73, 122880
    s_nop 0
    buffer_load_dwordx4 v14, s[8:11], s75 offen offset:0  lds
    buffer_load_dwordx4 v15, s[8:11], s75 offen offset:1024  lds
    s_add_u32 m0, s73, 118784
    s_nop 0
    buffer_load_dwordx4 v12, s[8:11], s3 offen offset:0  lds
    buffer_load_dwordx4 v13, s[8:11], s3 offen offset:1024  lds
    s_add_u32 m0, s73, 126976
    s_nop 0
    buffer_load_dwordx4 v14, s[8:11], s3 offen offset:0  lds
    buffer_load_dwordx4 v15, s[8:11], s3 offen offset:1024  lds
    s_add_u32 s75, s75, 393216
    s_cmp_eq_u32 s75, 6291456
    s_cselect_b32 s75, 0, s75
    s_add_u32 m0, s73, 131072
    s_nop 0
    buffer_load_dwordx4 v16, s[8:11], s76 offen offset:0  lds
    buffer_load_dwordx4 v17, s[8:11], s76 offen offset:1024  lds
    s_add_u32 m0, s73, 135168
    s_add_u32 s3, s76, 196608
    buffer_load_dwordx4 v16, s[8:11], s3 offen offset:0  lds
    buffer_load_dwordx4 v17, s[8:11], s3 offen offset:1024  lds
    s_add_u32 s76, s76, 393216
    s_cmp_eq_u32 s76, 6291456
    s_cselect_b32 s76, 0, s76
    s_add_u32 m0, s72, 0
    s_nop 0
    buffer_load_dwordx4 v8, s[4:7], s74 offen offset:0  lds
    buffer_load_dwordx4 v9, s[4:7], s74 offen offset:1024  lds
    buffer_load_dwordx4 v10, s[4:7], s74 offen offset:2048  lds
    buffer_load_dwordx4 v11, s[4:7], s74 offen offset:3072  lds
    s_add_u32 m0, s72, 8192
    s_add_u32 s3, s74, 131072
    buffer_load_dwordx4 v8, s[4:7], s3 offen offset:0  lds
    buffer_load_dwordx4 v9, s[4:7], s3 offen offset:1024  lds
    buffer_load_dwordx4 v10, s[4:7], s3 offen offset:2048  lds
    buffer_load_dwordx4 v11, s[4:7], s3 offen offset:3072  lds
    s_add_u32 s74, s74, 128
    s_and_b32 s74, s74, 2047
    s_add_u32 s3, s75, 196608
    s_add_u32 m0, s73, 65536
    s_nop 0
    buffer_load_dwordx4 v12, s[8:11], s75 offen offset:0  lds
    buffer_load_dwordx4 v13, s[8:11], s75 offen offset:1024  lds
    s_add_u32 m0, s73, 73728
    s_nop 0
    buffer_load_dwordx4 v14, s[8:11], s75 offen offset:0  lds
    buffer_load_dwordx4 v15, s[8:11], s75 offen offset:1024  lds
    s_add_u32 m0, s73, 69632
    s_nop 0
    buffer_load_dwordx4 v12, s[8:11], s3 offen offset:0  lds
    buffer_load_dwordx4 v13, s[8:11], s3 offen offset:1024  lds
    s_add_u32 m0, s73, 77824
    s_nop 0
    buffer_load_dwordx4 v14, s[8:11], s3 offen offset:0  lds
    buffer_load_dwordx4 v15, s[8:11], s3 offen offset:1024  lds
    s_add_u32 s75, s75, 393216
    s_cmp_eq_u32 s75, 6291456
    s_cselect_b32 s75, 0, s75
    s_waitcnt vmcnt(36)
    s_barrier
    s_add_u32 m0, s73, 139264
    s_nop 0
    buffer_load_dwordx4 v16, s[8:11], s76 offen offset:0  lds
    buffer_load_dwordx4 v17, s[8:11], s76 offen offset:1024  lds
    s_add_u32 m0, s73, 143360
    s_add_u32 s3, s76, 196608
    buffer_load_dwordx4 v16, s[8:11], s3 offen offset:0  lds
    buffer_load_dwordx4 v17, s[8:11], s3 offen offset:1024  lds
    s_add_u32 s76, s76, 393216
    s_cmp_eq_u32 s76, 6291456
    s_cselect_b32 s76, 0, s76
    s_add_u32 m0, s72, 16384
    s_nop 0
    buffer_load_dwordx4 v8, s[4:7], s74 offen offset:0  lds
    buffer_load_dwordx4 v9, s[4:7], s74 offen offset:1024  lds
    buffer_load_dwordx4 v10, s[4:7], s74 offen offset:2048  lds
    buffer_load_dwordx4 v11, s[4:7], s74 offen offset:3072  lds
    s_add_u32 m0, s72, 24576
    s_add_u32 s3, s74, 131072
    buffer_load_dwordx4 v8, s[4:7], s3 offen offset:0  lds
    buffer_load_dwordx4 v9, s[4:7], s3 offen offset:1024  lds
    buffer_load_dwordx4 v10, s[4:7], s3 offen offset:2048  lds
    buffer_load_dwordx4 v11, s[4:7], s3 offen offset:3072  lds
    s_add_u32 s74, s74, 128
    s_and_b32 s74, s74, 2047
    s_add_u32 s3, s75, 196608
    s_add_u32 m0, s73, 81920
    s_nop 0
    buffer_load_dwordx4 v12, s[8:11], s75 offen offset:0  lds
    buffer_load_dwordx4 v13, s[8:11], s75 offen offset:1024  lds
    s_add_u32 m0, s73, 90112
    s_nop 0
    buffer_load_dwordx4 v14, s[8:11], s75 offen offset:0  lds
    buffer_load_dwordx4 v15, s[8:11], s75 offen offset:1024  lds
    s_add_u32 m0, s73, 86016
    s_nop 0
    buffer_load_dwordx4 v12, s[8:11], s3 offen offset:0  lds
    buffer_load_dwordx4 v13, s[8:11], s3 offen offset:1024  lds
    s_add_u32 m0, s73, 94208
    s_nop 0
    buffer_load_dwordx4 v14, s[8:11], s3 offen offset:0  lds
    buffer_load_dwordx4 v15, s[8:11], s3 offen offset:1024  lds
    s_add_u32 s75, s75, 393216
    s_cmp_eq_u32 s75, 6291456
    s_cselect_b32 s75, 0, s75
    s_waitcnt vmcnt(36)
    s_barrier
    s_add_u32 m0, s73, 147456
    s_nop 0
    buffer_load_dwordx4 v16, s[8:11], s76 offen offset:0  lds
    buffer_load_dwordx4 v17, s[8:11], s76 offen offset:1024  lds
    s_add_u32 m0, s73, 151552
    s_add_u32 s3, s76, 196608
    buffer_load_dwordx4 v16, s[8:11], s3 offen offset:0  lds
    buffer_load_dwordx4 v17, s[8:11], s3 offen offset:1024  lds
    s_add_u32 s76, s76, 393216
    s_cmp_eq_u32 s76, 6291456
    s_cselect_b32 s76, 0, s76
    s_add_u32 m0, s72, 32768
    s_nop 0
    buffer_load_dwordx4 v8, s[4:7], s74 offen offset:0  lds
    buffer_load_dwordx4 v9, s[4:7], s74 offen offset:1024  lds
    buffer_load_dwordx4 v10, s[4:7], s74 offen offset:2048  lds
    buffer_load_dwordx4 v11, s[4:7], s74 offen offset:3072  lds
    s_add_u32 m0, s72, 40960
    s_add_u32 s3, s74, 131072
    buffer_load_dwordx4 v8, s[4:7], s3 offen offset:0  lds
    buffer_load_dwordx4 v9, s[4:7], s3 offen offset:1024  lds
    buffer_load_dwordx4 v10, s[4:7], s3 offen offset:2048  lds
    buffer_load_dwordx4 v11, s[4:7], s3 offen offset:3072  lds
    s_add_u32 s74, s74, 128
    s_and_b32 s74, s74, 2047
    s_add_u32 s3, s75, 196608
    s_add_u32 m0, s73, 98304
    s_nop 0
    buffer_load_dwordx4 v12, s[8:11], s75 offen offset:0  lds
    buffer_load_dwordx4 v13, s[8:11], s75 offen offset:1024  lds
    s_add_u32 m0, s73, 106496
    s_nop 0
    buffer_load_dwordx4 v14, s[8:11], s75 offen offset:0  lds
    buffer_load_dwordx4 v15, s[8:11], s75 offen offset:1024  lds
    s_add_u32 m0, s73, 102400
    s_nop 0
    buffer_load_dwordx4 v12, s[8:11], s3 offen offset:0  lds
    buffer_load_dwordx4 v13, s[8:11], s3 offen offset:1024  lds
    s_add_u32 m0, s73, 110592
    s_nop 0
    buffer_load_dwordx4 v14, s[8:11], s3 offen offset:0  lds
    buffer_load_dwordx4 v15, s[8:11], s3 offen offset:1024  lds
    s_add_u32 s75, s75, 393216
    s_cmp_eq_u32 s75, 6291456
    s_cselect_b32 s75, 0, s75
    s_waitcnt vmcnt(36)
    s_barrier
    s_add_u32 m0, s73, 131072
    s_nop 0
    buffer_load_dwordx4 v16, s[8:11], s76 offen offset:0  lds
    buffer_load_dwordx4 v17, s[8:11], s76 offen offset:1024  lds
    s_add_u32 m0, s73, 135168
    s_add_u32 s3, s76, 196608
    buffer_load_dwordx4 v16, s[8:11], s3 offen offset:0  lds
    buffer_load_dwordx4 v17, s[8:11], s3 offen offset:1024  lds
    s_add_u32 s76, s76, 393216
    s_cmp_eq_u32 s76, 6291456
    s_cselect_b32 s76, 0, s76
    s_add_u32 m0, s72, 49152
    s_nop 0
    buffer_load_dwordx4 v8, s[4:7], s74 offen offset:0  lds
    buffer_load_dwordx4 v9, s[4:7], s74 offen offset:1024  lds
    buffer_load_dwordx4 v10, s[4:7], s74 offen offset:2048  lds
    buffer_load_dwordx4 v11, s[4:7], s74 offen offset:3072  lds
    s_add_u32 m0, s72, 57344
    s_add_u32 s3, s74, 131072
    buffer_load_dwordx4 v8, s[4:7], s3 offen offset:0  lds
    buffer_load_dwordx4 v9, s[4:7], s3 offen offset:1024  lds
    buffer_load_dwordx4 v10, s[4:7], s3 offen offset:2048  lds
    buffer_load_dwordx4 v11, s[4:7], s3 offen offset:3072  lds
    s_add_u32 s74, s74, 128
    s_and_b32 s74, s74, 2047
    s_add_u32 s3, s75, 196608
    s_add_u32 m0, s73, 114688
    s_nop 0
    buffer_load_dwordx4 v12, s[8:11], s75 offen offset:0  lds
    buffer_load_dwordx4 v13, s[8:11], s75 offen offset:1024  lds
    s_add_u32 m0, s73, 122880
    s_nop 0
    buffer_load_dwordx4 v14, s[8:11], s75 offen offset:0  lds
    buffer_load_dwordx4 v15, s[8:11], s75 offen offset:1024  lds
    s_add_u32 m0, s73, 118784
    s_nop 0
    buffer_load_dwordx4 v12, s[8:11], s3 offen offset:0  lds
    buffer_load_dwordx4 v13, s[8:11], s3 offen offset:1024  lds
    s_add_u32 m0, s73, 126976
    s_nop 0
    buffer_load_dwordx4 v14, s[8:11], s3 offen offset:0  lds
    buffer_load_dwordx4 v15, s[8:11], s3 offen offset:1024  lds
    s_add_u32 s75, s75, 393216
    s_cmp_eq_u32 s75, 6291456
    s_cselect_b32 s75, 0, s75
    s_waitcnt vmcnt(36)
    s_barrier
    s_add_u32 m0, s73, 139264
    s_nop 0
    buffer_load_dwordx4 v16, s[8:11], s76 offen offset:0  lds
    buffer_load_dwordx4 v17, s[8:11], s76 offen offset:1024  lds
    s_add_u32 m0, s73, 143360
    s_add_u32 s3, s76, 196608
    buffer_load_dwordx4 v16, s[8:11], s3 offen offset:0  lds
    buffer_load_dwordx4 v17, s[8:11], s3 offen offset:1024  lds
    s_add_u32 s76, s76, 393216
    s_cmp_eq_u32 s76, 6291456
    s_cselect_b32 s76, 0, s76
    s_add_u32 m0, s72, 0
    s_nop 0
    buffer_load_dwordx4 v8, s[4:7], s74 offen offset:0  lds
    buffer_load_dwordx4 v9, s[4:7], s74 offen offset:1024  lds
    buffer_load_dwordx4 v10, s[4:7], s74 offen offset:2048  lds
    buffer_load_dwordx4 v11, s[4:7], s74 offen offset:3072  lds
    s_add_u32 m0, s72, 8192
    s_add_u32 s3, s74, 131072
    buffer_load_dwordx4 v8, s[4:7], s3 offen offset:0  lds
    buffer_load_dwordx4 v9, s[4:7], s3 offen offset:1024  lds
    buffer_load_dwordx4 v10, s[4:7], s3 offen offset:2048  lds
    buffer_load_dwordx4 v11, s[4:7], s3 offen offset:3072  lds
    s_add_u32 s74, s74, 128
    s_and_b32 s74, s74, 2047
    s_add_u32 s3, s75, 196608
    s_add_u32 m0, s73, 65536
    s_nop 0
    buffer_load_dwordx4 v12, s[8:11], s75 offen offset:0  lds
    buffer_load_dwordx4 v13, s[8:11], s75 offen offset:1024  lds
    s_add_u32 m0, s73, 73728
    s_nop 0
    buffer_load_dwordx4 v14, s[8:11], s75 offen offset:0  lds
    buffer_load_dwordx4 v15, s[8:11], s75 offen offset:1024  lds
    s_add_u32 m0, s73, 69632
    s_nop 0
    buffer_load_dwordx4 v12, s[8:11], s3 offen offset:0  lds
    buffer_load_dwordx4 v13, s[8:11], s3 offen offset:1024  lds
    s_add_u32 m0, s73, 77824
    s_nop 0
    buffer_load_dwordx4 v14, s[8:11], s3 offen offset:0  lds
    buffer_load_dwordx4 v15, s[8:11], s3 offen offset:1024  lds
    s_add_u32 s75, s75, 393216
    s_cmp_eq_u32 s75, 6291456
    s_cselect_b32 s75, 0, s75
    s_waitcnt vmcnt(36)
    s_barrier
    s_add_u32 m0, s73, 147456
    s_nop 0
    buffer_load_dwordx4 v16, s[8:11], s76 offen offset:0  lds
    buffer_load_dwordx4 v17, s[8:11], s76 offen offset:1024  lds
    s_add_u32 m0, s73, 151552
    s_add_u32 s3, s76, 196608
    buffer_load_dwordx4 v16, s[8:11], s3 offen offset:0  lds
    buffer_load_dwordx4 v17, s[8:11], s3 offen offset:1024  lds
    s_add_u32 s76, s76, 393216
    s_cmp_eq_u32 s76, 6291456
    s_cselect_b32 s76, 0, s76
    s_add_u32 m0, s72, 16384
    s_nop 0
    buffer_load_dwordx4 v8, s[4:7], s74 offen offset:0  lds
    buffer_load_dwordx4 v9, s[4:7], s74 offen offset:1024  lds
    buffer_load_dwordx4 v10, s[4:7], s74 offen offset:2048  lds
    buffer_load_dwordx4 v11, s[4:7], s74 offen offset:3072  lds
    s_add_u32 m0, s72, 24576
    s_add_u32 s3, s74, 131072
    buffer_load_dwordx4 v8, s[4:7], s3 offen offset:0  lds
    buffer_load_dwordx4 v9, s[4:7], s3 offen offset:1024  lds
    buffer_load_dwordx4 v10, s[4:7], s3 offen offset:2048  lds
    buffer_load_dwordx4 v11, s[4:7], s3 offen offset:3072  lds
    s_add_u32 s74, s74, 128
    s_and_b32 s74, s74, 2047
    s_add_u32 s3, s75, 196608
    s_add_u32 m0, s73, 81920
    s_nop 0
    buffer_load_dwordx4 v12, s[8:11], s75 offen offset:0  lds
    buffer_load_dwordx4 v13, s[8:11], s75 offen offset:1024  lds
    s_add_u32 m0, s73, 90112
    s_nop 0
    buffer_load_dwordx4 v14, s[8:11], s75 offen offset:0  lds
    buffer_load_dwordx4 v15, s[8:11], s75 offen offset:1024  lds
    s_add_u32 m0, s73, 86016
    s_nop 0
    buffer_load_dwordx4 v12, s[8:11], s3 offen offset:0  lds
    buffer_load_dwordx4 v13, s[8:11], s3 offen offset:1024  lds
    s_add_u32 m0, s73, 94208
    s_nop 0
    buffer_load_dwordx4 v14, s[8:11], s3 offen offset:0  lds
    buffer_load_dwordx4 v15, s[8:11], s3 offen offset:1024  lds
    s_add_u32 s75, s75, 393216
    s_cmp_eq_u32 s75, 6291456
    s_cselect_b32 s75, 0, s75
    s_waitcnt vmcnt(36)
    s_barrier
    s_add_u32 m0, s73, 131072
    s_nop 0
    buffer_load_dwordx4 v16, s[8:11], s76 offen offset:0  lds
    buffer_load_dwordx4 v17, s[8:11], s76 offen offset:1024  lds
    s_add_u32 m0, s73, 135168
    s_add_u32 s3, s76, 196608
    buffer_load_dwordx4 v16, s[8:11], s3 offen offset:0  lds
    buffer_load_dwordx4 v17, s[8:11], s3 offen offset:1024  lds
    s_add_u32 s76, s76, 393216
    s_cmp_eq_u32 s76, 6291456
    s_cselect_b32 s76, 0, s76
    s_add_u32 m0, s72, 32768
    s_nop 0
    buffer_load_dwordx4 v8, s[4:7], s74 offen offset:0  lds
    buffer_load_dwordx4 v9, s[4:7], s74 offen offset:1024  lds
    buffer_load_dwordx4 v10, s[4:7], s74 offen offset:2048  lds
    buffer_load_dwordx4 v11, s[4:7], s74 offen offset:3072  lds
    s_add_u32 m0, s72, 40960
    s_add_u32 s3, s74, 131072
    buffer_load_dwordx4 v8, s[4:7], s3 offen offset:0  lds
    buffer_load_dwordx4 v9, s[4:7], s3 offen offset:1024  lds
    buffer_load_dwordx4 v10, s[4:7], s3 offen offset:2048  lds
    buffer_load_dwordx4 v11, s[4:7], s3 offen offset:3072  lds
    s_add_u32 s74, s74, 128
    s_and_b32 s74, s74, 2047
    s_add_u32 s3, s75, 196608
    s_add_u32 m0, s73, 98304
    s_nop 0
    buffer_load_dwordx4 v12, s[8:11], s75 offen offset:0  lds
    buffer_load_dwordx4 v13, s[8:11], s75 offen offset:1024  lds
    s_add_u32 m0, s73, 106496
    s_nop 0
    buffer_load_dwordx4 v14, s[8:11], s75 offen offset:0  lds
    buffer_load_dwordx4 v15, s[8:11], s75 offen offset:1024  lds
    s_add_u32 m0, s73, 102400
    s_nop 0
    buffer_load_dwordx4 v12, s[8:11], s3 offen offset:0  lds
    buffer_load_dwordx4 v13, s[8:11], s3 offen offset:1024  lds
    s_add_u32 m0, s73, 110592
    s_nop 0
    buffer_load_dwordx4 v14, s[8:11], s3 offen offset:0  lds
    buffer_load_dwordx4 v15, s[8:11], s3 offen offset:1024  lds
    s_add_u32 s75, s75, 393216
    s_cmp_eq_u32 s75, 6291456
    s_cselect_b32 s75, 0, s75
    s_waitcnt vmcnt(36)
    s_barrier
    s_add_u32 m0, s73, 139264
    s_nop 0
    buffer_load_dwordx4 v16, s[8:11], s76 offen offset:0  lds
    buffer_load_dwordx4 v17, s[8:11], s76 offen offset:1024  lds
    s_add_u32 m0, s73, 143360
    s_add_u32 s3, s76, 196608
    buffer_load_dwordx4 v16, s[8:11], s3 offen offset:0  lds
    buffer_load_dwordx4 v17, s[8:11], s3 offen offset:1024  lds
    s_add_u32 s76, s76, 393216
    s_cmp_eq_u32 s76, 6291456
    s_cselect_b32 s76, 0, s76
    s_add_u32 m0, s72, 49152
    s_nop 0
    buffer_load_dwordx4 v8, s[4:7], s74 offen offset:0  lds
    buffer_load_dwordx4 v9, s[4:7], s74 offen offset:1024  lds
    buffer_load_dwordx4 v10, s[4:7], s74 offen offset:2048  lds
    buffer_load_dwordx4 v11, s[4:7], s74 offen offset:3072  lds
    s_add_u32 m0, s72, 57344
    s_add_u32 s3, s74, 131072
    buffer_load_dwordx4 v8, s[4:7], s3 offen offset:0  lds
    buffer_load_dwordx4 v9, s[4:7], s3 offen offset:1024  lds
    buffer_load_dwordx4 v10, s[4:7], s3 offen offset:2048  lds
    buffer_load_dwordx4 v11, s[4:7], s3 offen offset:3072  lds
    s_add_u32 s74, s74, 128
    s_and_b32 s74, s74, 2047
    s_add_u32 s3, s75, 196608
    s_add_u32 m0, s73, 114688
    s_nop 0
    buffer_load_dwordx4 v12, s[8:11], s75 offen offset:0  lds
    buffer_load_dwordx4 v13, s[8:11], s75 offen offset:1024  lds
    s_add_u32 m0, s73, 122880
    s_nop 0
    buffer_load_dwordx4 v14, s[8:11], s75 offen offset:0  lds
    buffer_load_dwordx4 v15, s[8:11], s75 offen offset:1024  lds
    s_add_u32 m0, s73, 118784
    s_nop 0
    buffer_load_dwordx4 v12, s[8:11], s3 offen offset:0  lds
    buffer_load_dwordx4 v13, s[8:11], s3 offen offset:1024  lds
    s_add_u32 m0, s73, 126976
    s_nop 0
    buffer_load_dwordx4 v14, s[8:11], s3 offen offset:0  lds
    buffer_load_dwordx4 v15, s[8:11], s3 offen offset:1024  lds
    s_add_u32 s75, s75, 393216
    s_cmp_eq_u32 s75, 6291456
    s_cselect_b32 s75, 0, s75
    s_waitcnt vmcnt(36)
    s_barrier
    s_getpc_b64 s[66:67]
L_pc2:
    s_add_u32 s66, s66, L_e1-L_pc2
    s_addc_u32 s67, s67, 0
    s_lshr_b32 s3, s2, 3
    s_lshl_b32 s3, s3, 1
    s_add_u32 s3, s3, s38
    s_lshl_b32 s3, s3, 6
    s_add_u32 s66, s66, s3
    s_addc_u32 s67, s67, 0
    s_load_dword s65, s[66:67], 0
    s_load_dword s65, s[66:67], 4096
    s_load_dword s65, s[66:67], 8192
    s_load_dword s65, s[66:67], 12288
    s_add_u32 m0, s73, 147456
    s_nop 0
    buffer_load_dwordx4 v16, s[8:11], s76 offen offset:0  lds
    buffer_load_dwordx4 v17, s[8:11], s76 offen offset:1024  lds
    s_add_u32 m0, s73, 151552
    s_add_u32 s3, s76, 196608
    buffer_load_dwordx4 v16, s[8:11], s3 offen offset:0  lds
    buffer_load_dwordx4 v17, s[8:11], s3 offen offset:1024  lds
    s_add_u32 s76, s76, 393216
    s_cmp_eq_u32 s76, 6291456
    s_cselect_b32 s76, 0, s76
    s_add_u32 m0, s72, 0
    s_nop 0
    buffer_load_dwordx4 v8, s[4:7], s74 offen offset:0  lds
    buffer_load_dwordx4 v9, s[4:7], s74 offen offset:1024  lds
    buffer_load_dwordx4 v10, s[4:7], s74 offen offset:2048  lds
    buffer_load_dwordx4 v11, s[4:7], s74 offen offset:3072  lds
    s_add_u32 m0, s72, 8192
    s_add_u32 s3, s74, 131072
    buffer_load_dwordx4 v8, s[4:7], s3 offen offset:0  lds
    buffer_load_dwordx4 v9, s[4:7], s3 offen offset:1024  lds
    buffer_load_dwordx4 v10, s[4:7], s3 offen offset:2048  lds
    buffer_load_dwordx4 v11, s[4:7], s3 offen offset:3072  lds
    s_add_u32 s74, s74, 128
    s_and_b32 s74, s74, 2047
    s_add_u32 s3, s75, 196608
    s_add_u32 m0, s73, 65536
    s_nop 0
    buffer_load_dwordx4 v12, s[8:11], s75 offen offset:0  lds
    buffer_load_dwordx4 v13, s[8:11], s75 offen offset:1024  lds
    s_add_u32 m0, s73, 73728
    s_nop 0
    buffer_load_dwordx4 v14, s[8:11], s75 offen offset:0  lds
    buffer_load_dwordx4 v15, s[8:11], s75 offen offset:1024  lds
    s_add_u32 m0, s73, 69632
    s_nop 0
    buffer_load_dwordx4 v12, s[8:11], s3 offen offset:0  lds
    buffer_load_dwordx4 v13, s[8:11], s3 offen offset:1024  lds
    s_add_u32 m0, s73, 77824
    s_nop 0
    buffer_load_dwordx4 v14, s[8:11], s3 offen offset:0  lds
    buffer_load_dwordx4 v15, s[8:11], s3 offen offset:1024  lds
    s_add_u32 s75, s75, 393216
    s_cmp_eq_u32 s75, 6291456
    s_cselect_b32 s75, 0, s75
    buffer_load_dwordx4 v[232:235], v248, s[4:7], 0 offen
    buffer_load_dwordx4 v[236:239], v248, s[4:7], s48 offen
    buffer_load_dwordx4 v[240:243], v248, s[4:7], s49 offen
    buffer_load_dwordx4 v[244:247], v248, s[4:7], s100 offen
    s_waitcnt vmcnt(40)
    s_barrier
    s_add_u32 m0, s73, 131072
    s_nop 0
    buffer_load_dwordx4 v16, s[8:11], s76 offen offset:0  lds
    buffer_load_dwordx4 v17, s[8:11], s76 offen offset:1024  lds
    s_add_u32 m0, s73, 135168
    s_add_u32 s3, s76, 196608
    buffer_load_dwordx4 v16, s[8:11], s3 offen offset:0  lds
    buffer_load_dwordx4 v17, s[8:11], s3 offen offset:1024  lds
    s_add_u32 s76, s76, 393216
    s_cmp_eq_u32 s76, 6291456
    s_cselect_b32 s76, 0, s76
    s_add_u32 m0, s72, 16384
    s_nop 0
    buffer_load_dwordx4 v8, s[4:7], s74 offen offset:0  lds
    buffer_load_dwordx4 v9, s[4:7], s74 offen offset:1024  lds
    buffer_load_dwordx4 v10, s[4:7], s74 offen offset:2048  lds
    buffer_load_dwordx4 v11, s[4:7], s74 offen offset:3072  lds
    s_add_u32 m0, s72, 24576
    s_add_u32 s3, s74, 131072
    buffer_load_dwordx4 v8, s[4:7], s3 offen offset:0  lds
    buffer_load_dwordx4 v9, s[4:7], s3 offen offset:1024  lds
    buffer_load_dwordx4 v10, s[4:7], s3 offen offset:2048  lds
    buffer_load_dwordx4 v11, s[4:7], s3 offen offset:3072  lds
    s_add_u32 s74, s74, 128
    s_and_b32 s74, s74, 2047
    s_add_u32 s3, s75, 196608
    s_add_u32 m0, s73, 81920
    s_nop 0
    buffer_load_dwordx4 v12, s[8:11], s75 offen offset:0  lds
    buffer_load_dwordx4 v13, s[8:11], s75 offen offset:1024  lds
    s_add_u32 m0, s73, 90112
    s_nop 0
    buffer_load_dwordx4 v14, s[8:11], s75 offen offset:0  lds
    buffer_load_dwordx4 v15, s[8:11], s75 offen offset:1024  lds
    s_add_u32 m0, s73, 86016
    s_nop 0
    buffer_load_dwordx4 v12, s[8:11], s3 offen offset:0  lds
    buffer_load_dwordx4 v13, s[8:11], s3 offen offset:1024  lds
    s_add_u32 m0, s73, 94208
    s_nop 0
    buffer_load_dwordx4 v14, s[8:11], s3 offen offset:0  lds
    buffer_load_dwordx4 v15, s[8:11], s3 offen offset:1024  lds
    s_add_u32 s75, s75, 393216
    s_cmp_eq_u32 s75, 6291456
    s_cselect_b32 s75, 0, s75
    s_waitcnt vmcnt(40)
    s_barrier
    s_add_u32 m0, s73, 139264
    s_nop 0
    buffer_load_dwordx4 v16, s[8:11], s76 offen offset:0  lds
    buffer_load_dwordx4 v17, s[8:11], s76 offen offset:1024  lds
    s_add_u32 m0, s73, 143360
    s_add_u32 s3, s76, 196608
    buffer_load_dwordx4 v16, s[8:11], s3 offen offset:0  lds
    buffer_load_dwordx4 v17, s[8:11], s3 offen offset:1024  lds
    s_add_u32 s76, s76, 393216
    s_cmp_eq_u32 s76, 6291456
    s_cselect_b32 s76, 0, s76
    s_add_u32 m0, s72, 32768
    s_nop 0
    buffer_load_dwordx4 v8, s[4:7], s74 offen offset:0  lds
    buffer_load_dwordx4 v9, s[4:7], s74 offen offset:1024  lds
    buffer_load_dwordx4 v10, s[4:7], s74 offen offset:2048  lds
    buffer_load_dwordx4 v11, s[4:7], s74 offen offset:3072  lds
    s_add_u32 m0, s72, 40960
    s_add_u32 s3, s74, 131072
    buffer_load_dwordx4 v8, s[4:7], s3 offen offset:0  lds
    buffer_load_dwordx4 v9, s[4:7], s3 offen offset:1024  lds
    buffer_load_dwordx4 v10, s[4:7], s3 offen offset:2048  lds
    buffer_load_dwordx4 v11, s[4:7], s3 offen offset:3072  lds
    s_add_u32 s74, s74, 128
    s_and_b32 s74, s74, 2047
    s_add_u32 s3, s75, 196608
    s_add_u32 m0, s73, 98304
    s_nop 0
    buffer_load_dwordx4 v12, s[8:11], s75 offen offset:0  lds
    buffer_load_dwordx4 v13, s[8:11], s75 offen offset:1024  lds
    s_add_u32 m0, s73, 106496
    s_nop 0
    buffer_load_dwordx4 v14, s[8:11], s75 offen offset:0  lds
    buffer_load_dwordx4 v15, s[8:11], s75 offen offset:1024  lds
    s_add_u32 m0, s73, 102400
    s_nop 0
    buffer_load_dwordx4 v12, s[8:11], s3 offen offset:0  lds
    buffer_load_dwordx4 v13, s[8:11], s3 offen offset:1024  lds
    s_add_u32 m0, s73, 110592
    s_nop 0
    buffer_load_dwordx4 v14, s[8:11], s3 offen offset:0  lds
    buffer_load_dwordx4 v15, s[8:11], s3 offen offset:1024  lds
    s_add_u32 s75, s75, 393216
    s_cmp_eq_u32 s75, 6291456
    s_cselect_b32 s75, 0, s75
    s_waitcnt vmcnt(44)
    s_waitcnt vmcnt(20)
    s_barrier
    s_add_u32 m0, s72, 49152
    s_nop 0
    buffer_load_dwordx4 v8, s[4:7], s74 offen offset:0  lds
    buffer_load_dwordx4 v9, s[4:7], s74 offen offset:1024  lds
    buffer_load_dwordx4 v10, s[4:7], s74 offen offset:2048  lds
    buffer_load_dwordx4 v11, s[4:7], s74 offen offset:3072  lds
    s_add_u32 m0, s72, 57344
    s_add_u32 s3, s74, 131072
    buffer_load_dwordx4 v8, s[4:7], s3 offen offset:0  lds
    buffer_load_dwordx4 v9, s[4:7], s3 offen offset:1024  lds
    buffer_load_dwordx4 v10, s[4:7], s3 offen offset:2048  lds
    buffer_load_dwordx4 v11, s[4:7], s3 offen offset:3072  lds
    s_add_u32 s74, s74, 128
    s_and_b32 s74, s74, 2047
    s_waitcnt vmcnt(8)
    v_mov_b32 v19, 14
    ds_write_b32 v27, v19
    s_add_u32 s3, s75, 196608
    s_add_u32 m0, s73, 114688
    s_nop 0
    buffer_load_dwordx4 v12, s[8:11], s75 offen offset:0  lds
    buffer_load_dwordx4 v13, s[8:11], s75 offen offset:1024  lds
    s_add_u32 m0, s73, 122880
    s_nop 0
    buffer_load_dwordx4 v14, s[8:11], s75 offen offset:0  lds
    buffer_load_dwordx4 v15, s[8:11], s75 offen offset:1024  lds
    s_add_u32 m0, s73, 118784
    s_nop 0
    buffer_load_dwordx4 v12, s[8:11], s3 offen offset:0  lds
    buffer_load_dwordx4 v13, s[8:11], s3 offen offset:1024  lds
    s_add_u32 m0, s73, 126976
    s_nop 0
    buffer_load_dwordx4 v14, s[8:11], s3 offen offset:0  lds
    buffer_load_dwordx4 v15, s[8:11], s3 offen offset:1024  lds
    s_add_u32 s75, s75, 393216
    s_cmp_eq_u32 s75, 6291456
    s_cselect_b32 s75, 0, s75
    s_add_u32 m0, s73, 147456
    s_nop 0
    buffer_load_dwordx4 v16, s[8:11], s76 offen offset:0  lds
    buffer_load_dwordx4 v17, s[8:11], s76 offen offset:1024  lds
    s_add_u32 m0, s73, 151552
    s_add_u32 s3, s76, 196608
    buffer_load_dwordx4 v16, s[8:11], s3 offen offset:0  lds
    buffer_load_dwordx4 v17, s[8:11], s3 offen offset:1024  lds
    s_add_u32 s76, s76, 393216
    s_cmp_eq_u32 s76, 6291456
    s_cselect_b32 s76, 0, s76
    s_waitcnt lgkmcnt(0)
    s_branch L_join
L_xw:
    v_lshlrev_b32 v3, 4, v1
    s_mov_b32 s12, s62
    s_mov_b32 s13, s63
    s_mov_b32 s14, 268435456
    s_mov_b32 s15, 0x00020000
    s_mov_b32 s24, s58
    s_mov_b32 s25, s59
    s_mov_b32 s26, 4194304
    s_mov_b32 s27, 0x00020000
    s_mov_b32 s16, s60
    s_mov_b32 s17, s61
    s_mov_b32 s18, 256
    s_mov_b32 s19, 0x00020000
    s_mov_b32 s20, s44
    s_mov_b32 s21, s45
    s_mov_b32 s22, 65536
    s_mov_b32 s23, 0x00020000
    s_and_b32 s30, s2, 3
    s_lshl_b32 s30, s30, 2
    s_bfe_u32 s3, s2, 0x20003
    s_add_u32 s30, s30, s3
    s_bfe_u32 s31, s2, 0x10002
    s_lshl_b32 s31, s31, 3
    s_lshr_b32 s3, s2, 5
    s_add_u32 s31, s31, s3
    s_mov_b32 s70, 0
    s_mov_b32 s80, s52
    s_mov_b32 s81, s53
    s_mov_b32 s82, 7340032
    s_mov_b32 s83, 0x00020000
    s_mov_b32 s84, s54
    s_mov_b32 s85, s55
    s_mov_b32 s86, 7340032
    s_mov_b32 s87, 0x00020000
    s_cmp_lt_u32 s2, 224
    s_cselect_b32 s82, s82, 0
    s_cselect_b32 s86, s86, 0
    s_and_b32 s3, s2, 15
    s_lshl_b32 s3, s3, 6
    v_and_b32 v5, 0x38, v1
    v_add_u32 v5, s3, v5
    v_mul_u32_u24 v5, 7168, v5
    v_and_b32 v6, 7, v1
    v_lshl_add_u32 v2, v6, 4, v5
    s_lshr_b32 s77, s2, 4
    s_lshl_b32 s77, s77, 2
    s_add_u32 s77, s77, s38
    s_lshl_b32 s77, s77, 7
    v_and_b32 v5, 1, v1
    v_cmp_eq_u32 vcc, 0, v5
    v_mov_b32 v6, 0xffff0000
    v_mov_b32 v7, 0xffff
    v_cndmask_b32 v6, v6, v7, vcc
    v_bfe_u32 v5, v1, 1, 2
    v_cmp_eq_u32 vcc, 0, v5
    s_nop 1
    v_cndmask_b32 v88, 0, v6, vcc
    v_cmp_eq_u32 vcc, 1, v5
    s_nop 1
    v_cndmask_b32 v89, 0, v6, vcc
    v_cmp_eq_u32 vcc, 2, v5
    s_nop 1
    v_cndmask_b32 v90, 0, v6, vcc
    v_cmp_eq_u32 vcc, 3, v5
    s_nop 1
    v_cndmask_b32 v91, 0, v6, vcc
    v_and_b32 v20, 0x3f803f80, v88
    v_and_b32 v21, 0x3f803f80, v89
    v_and_b32 v22, 0x3f803f80, v90
    v_and_b32 v23, 0x3f803f80, v91
    s_lshl_b32 s3, s30, 7
    s_lshl_b32 s65, s38, 5
    s_add_u32 s3, s3, s65
    v_lshrrev_b32 v249, 3, v1
    v_add_u32 v6, s3, v249
    v_lshlrev_b32 v6, 11, v6
    v_and_b32 v250, 7, v1
    v_lshl_add_u32 v6, v250, 4, v6
    s_lshl_b32 s3, s31, 7
    v_add_u32 v248, s3, v6
    s_mov_b32 s48, 16384
    s_mov_b32 s49, 32768
    s_mov_b32 s100, 49152
    s_lshl_b32 s3, s38, 2
    s_add_u32 s3, s3, 163136
    v_mov_b32 v27, s3
    v_mov_b32 v26, 163104
    v_mov_b32 v28, 0x3f803f80
    v_mov_b32 v29, 0x3f803f80
    v_mov_b32 v30, 0x3f803f80
    v_mov_b32 v31, 0x3f803f80
    v_lshrrev_b32 v5, 4, v1
    v_lshlrev_b32 v4, 3, v5
    v_bfe_u32 v6, v1, 2, 2
    v_add_u32 v4, v4, v6
    v_lshlrev_b32 v4, 7, v4
    v_and_b32 v5, 3, v1
    v_lshl_add_u32 v4, v5, 3, v4
    v_add_u32 v4, 65536, v4
    s_and_b32 s3, s38, 1
    s_lshl_b32 s3, s3, 1
    v_bfe_u32 v6, v1, 3, 2
    v_xor_b32 v6, s3, v6
    v_lshl_add_u32 v252, v6, 5, v4
    v_xor_b32 v6, 1, v6
    v_lshl_add_u32 v253, v6, 5, v4
    s_mul_i32 s3, s101, 43
    s_lshr_b32 s3, s3, 7
    s_mul_i32 s3, s3, 3
    s_sub_u32 s3, s101, s3
    s_lshl_b32 s65, s3, 13
    s_add_u32 s65, s65, 65536
    v_add_u32 v32, s65, v252
    v_add_u32 v33, s65, v253
    s_and_b32 s3, s101, 3
    s_lshl_b32 s3, s3, 14
    v_add_u32 v252, s3, v252
    v_add_u32 v253, s3, v253
    s_lshl_b32 s3, s37, 4
    s_add_u32 s3, s3, s36
    s_lshl_b32 s3, s3, 10
    s_and_b32 s65, s38, 1
    s_lshl_b32 s65, s65, 9
    s_add_u32 s3, s3, s65
    s_add_u32 s68, s3, 1048576
    s_mov_b32 s79, 0
    v_mov_b32 v34, 0
    v_mov_b32 v35, 0
    v_mov_b32 v5, 163104
    ds_write_b64 v5, v[34:35]
    ds_write_b64 v5, v[34:35] offset:8
    ds_write_b64 v5, v[34:35] offset:16
    ds_write_b64 v5, v[34:35] offset:24
    ds_write_b64 v5, v[34:35] offset:32
    ds_write_b64 v5, v[34:35] offset:40
    ds_write_b64 v5, v[34:35] offset:48
    ds_write_b64 v5, v[34:35] offset:56
    ds_write_b64 v5, v[34:35] offset:64
    ds_write_b64 v5, v[34:35] offset:72
    ds_write_b64 v5, v[34:35] offset:80
    ds_write_b64 v5, v[34:35] offset:88
    ds_write_b64 v5, v[34:35] offset:96
    ds_write_b64 v5, v[34:35] offset:112
    ds_write_b64 v5, v[34:35] offset:120
    v_and_b32 v5, 16, v1
    v_cmp_eq_u32 s[66:67], 0, v5
    s_getreg_b32 s69, hwreg(HW_REG_XCC_ID, 0, 4)
L_x0:
    s_barrier
    s_add_u32 s79, s79, 1
    s_cmp_le_u32 s79, s101
    s_cbranch_scc1 L_x0
    buffer_load_dword v18, v34, s[16:19], 0 offen sc1
    ds_read_b64_tr_b16 v[144:145], v252 offset:0
    ds_read_b64_tr_b16 v[146:147], v252 offset:512
    ds_read_b64_tr_b16 v[148:149], v252 offset:4096
    ds_read_b64_tr_b16 v[150:151], v252 offset:4608
    ds_read_b64_tr_b16 v[168:169], v253 offset:0
    ds_read_b64_tr_b16 v[170:171], v253 offset:512
    ds_read_b64_tr_b16 v[172:173], v253 offset:4096
    ds_read_b64_tr_b16 v[174:175], v253 offset:4608
    s_waitcnt lgkmcnt(4)
    ds_read_b64_tr_b16 v[152:153], v252 offset:8192
    ds_read_b64_tr_b16 v[154:155], v252 offset:8704
    ds_read_b64_tr_b16 v[156:157], v252 offset:12288
    ds_read_b64_tr_b16 v[158:159], v252 offset:12800
    ds_read_b64_tr_b16 v[176:177], v253 offset:8192
    ds_read_b64_tr_b16 v[178:179], v253 offset:8704
    ds_read_b64_tr_b16 v[180:181], v253 offset:12288
    ds_read_b64_tr_b16 v[182:183], v253 offset:12800
    s_waitcnt lgkmcnt(4)
    ds_read_b64_tr_b16 v[136:137], v32 offset:0
    ds_read_b64_tr_b16 v[138:139], v32 offset:512
    ds_read_b64_tr_b16 v[140:141], v32 offset:4096
    ds_read_b64_tr_b16 v[142:143], v32 offset:4608
    ds_read_b64_tr_b16 v[160:161], v33 offset:0
    ds_read_b64_tr_b16 v[162:163], v33 offset:512
    ds_read_b64_tr_b16 v[164:165], v33 offset:4096
    ds_read_b64_tr_b16 v[166:167], v33 offset:4608
    s_waitcnt lgkmcnt(0)
    s_barrier
    s_add_u32 s79, s79, 1
    v_mfma_f32_16x16x32_bf16 v[116:119], v[28:31], v[144:147], 0
    v_mfma_f32_16x16x32_bf16 v[120:123], v[28:31], v[152:155], 0
    v_mfma_f32_16x16x32_bf16 v[112:115], v[28:31], v[136:139], 0
    v_mfma_f32_16x16x32_bf16 v[128:131], v[28:31], v[168:171], 0
    v_mfma_f32_16x16x32_bf16 v[132:135], v[28:31], v[176:179], 0
    v_mfma_f32_16x16x32_bf16 v[124:127], v[28:31], v[160:163], 0
    v_mfma_f32_16x16x32_bf16 v[116:119], v[28:31], v[148:151], v[116:119]
    v_mfma_f32_16x16x32_bf16 v[120:123], v[28:31], v[156:159], v[120:123]
    v_mfma_f32_16x16x32_bf16 v[112:115], v[28:31], v[140:143], v[112:115]
    v_mfma_f32_16x16x32_bf16 v[128:131], v[28:31], v[172:175], v[128:131]
    v_mfma_f32_16x16x32_bf16 v[132:135], v[28:31], v[180:183], v[132:135]
    v_mfma_f32_16x16x32_bf16 v[124:127], v[28:31], v[164:167], v[124:127]
    s_barrier
    s_add_u32 s79, s79, 1
    s_waitcnt vmcnt(0)
    v_readfirstlane_b32 s3, v18
    s_nop 0
    s_cmp_lg_u32 s3, 0
    s_cbranch_scc1 L_nonok
L_non:
    buffer_load_dword v18, v34, s[16:19], 0 offen sc1
    s_cmp_lt_u32 s79, 12
    s_cbranch_scc0 L_xb3
    s_barrier
    s_add_u32 s79, s79, 1
L_xb3:
    s_waitcnt vmcnt(0)
    v_cmp_eq_u32 vcc, 0, v18
    s_nop 1
    v_cndmask_b32 v6, 0, 1, vcc
    v_cmp_ne_u32 vcc, 0, v6
    s_add_u32 s70, s70, 1
    s_cmp_ge_u32 s70, 200000
    s_cbranch_scc1 L_nonok
    s_cmp_lg_u64 vcc, 0
    s_cbranch_scc1 L_non
L_nonok:
    v_and_b32 v39, -16, v18
    v_or_b32 v39, s69, v39
    v_cndmask_b32 v36, v124, v112, s[66:67]
    v_cndmask_b32 v37, v128, v116, s[66:67]
    v_cndmask_b32 v38, v132, v120, s[66:67]
    s_mov_b64 exec, 0xffffffff
    buffer_store_dwordx4 v[36:39], v3, s[12:15], s68 offen sc1
    s_mov_b64 exec, -1
    s_cmp_eq_u32 s38, 3
    s_cbranch_scc1 L_xbw
    s_cmp_lt_u32 s79, 12
    s_cbranch_scc0 L_xb4
    s_barrier
    s_add_u32 s79, s79, 1
L_xb4:
    s_add_u32 m0, s73, 151552
    s_lshl_b32 s65, s37, 12
    s_add_u32 s65, s65, s73
    s_sub_u32 s65, s65, 4096
    buffer_load_dwordx4 v3, s[20:23], s65 offen offset:0 lds
    buffer_load_dwordx4 v3, s[20:23], s65 offen offset:1024 lds
    s_lshl_b32 s3, s36, 4
    s_add_u32 s3, s3, s37
    s_lshl_b32 s3, s3, 7
    s_add_u32 s3, s3, 1310720
    v_lshlrev_b32 v5, 3, v1
    s_mov_b64 exec, 0xffff
    buffer_store_dwordx2 v[34:35], v5, s[12:15], s3 offen sc1
    s_mov_b64 exec, -1
    s_mov_b64 exec, 0
    s_branch L_hk16
L_hr16:
    s_branch L_hk17
L_hr17:
    s_branch L_hk18
L_hr18:
    s_branch L_hk19
L_hr19:
    s_mov_b64 exec, -1
    s_cmp_lt_u32 s79, 12
    s_cbranch_scc0 L_xb5
    s_barrier
    s_add_u32 s79, s79, 1
L_xb5:
    s_mov_b64 exec, 0
    s_branch L_hk20
L_hr20:
    s_branch L_hk21
L_hr21:
    s_mov_b64 exec, -1
L_xu6:
    s_cmp_ge_u32 s79, 5
    s_cbranch_scc1 L_xe6
    s_barrier
    s_add_u32 s79, s79, 1
    s_branch L_xu6
L_xe6:
    s_lshl_b32 s68, s37, 14
    s_add_u32 s68, s68, 1048576
L_cs:
    s_mov_b32 s3, s68
    buffer_load_dwordx4 v[112:115], v3, s[12:15], s3 offen offset:0 sc1
    buffer_load_dwordx4 v[116:119], v3, s[12:15], s3 offen offset:1024 sc1
    buffer_load_dwordx4 v[120:123], v3, s[12:15], s3 offen offset:2048 sc1
    buffer_load_dwordx4 v[124:127], v3, s[12:15], s3 offen offset:3072 sc1
    s_add_u32 s3, s3, 4096
    buffer_load_dwordx4 v[128:131], v3, s[12:15], s3 offen offset:0 sc1
    buffer_load_dwordx4 v[132:135], v3, s[12:15], s3 offen offset:1024 sc1
    s_cmp_lt_u32 s79, 12
    s_cbranch_scc0 L_xb7
    s_barrier
    s_add_u32 s79, s79, 1
L_xb7:
    buffer_load_dwordx4 v[136:139], v3, s[12:15], s3 offen offset:2048 sc1
    buffer_load_dwordx4 v[140:143], v3, s[12:15], s3 offen offset:3072 sc1
    s_add_u32 s3, s3, 4096
    buffer_load_dwordx4 v[144:147], v3, s[12:15], s3 offen offset:0 sc1
    buffer_load_dwordx4 v[148:151], v3, s[12:15], s3 offen offset:1024 sc1
    buffer_load_dwordx4 v[152:155], v3, s[12:15], s3 offen offset:2048 sc1
    s_cmp_lt_u32 s79, 12
    s_cbranch_scc0 L_xb8
    s_barrier
    s_add_u32 s79, s79, 1
L_xb8:
    buffer_load_dwordx4 v[156:159], v3, s[12:15], s3 offen offset:3072 sc1
    s_add_u32 s3, s3, 4096
    buffer_load_dwordx4 v[160:163], v3, s[12:15], s3 offen offset:0 sc1
    buffer_load_dwordx4 v[164:167], v3, s[12:15], s3 offen offset:1024 sc1
    buffer_load_dwordx4 v[168:171], v3, s[12:15], s3 offen offset:2048 sc1
    buffer_load_dwordx4 v[172:175], v3, s[12:15], s3 offen offset:3072 sc1
    s_cmp_lt_u32 s79, 12
    s_cbranch_scc0 L_xb9
    s_barrier
    s_add_u32 s79, s79, 1
L_xb9:
    s_waitcnt vmcnt(0)
    v_and_b32 v4, v115, v119
    v_or_b32 v5, v115, v119
    v_min3_u32 v4, v4, v123, v127
    v_max3_u32 v5, v5, v123, v127
    v_min3_u32 v4, v4, v131, v135
    v_max3_u32 v5, v5, v131, v135
    v_min3_u32 v4, v4, v139, v143
    v_max3_u32 v5, v5, v139, v143
    v_min3_u32 v4, v4, v147, v151
    v_max3_u32 v5, v5, v147, v151
    v_min3_u32 v4, v4, v155, v159
    v_max3_u32 v5, v5, v155, v159
    v_min3_u32 v4, v4, v163, v167
    v_max3_u32 v5, v5, v163, v167
    v_min3_u32 v4, v4, v171, v175
    v_max3_u32 v5, v5, v171, v175
    v_xor_b32 v6, v4, v18
    v_xor_b32 v7, v5, v18
    v_or_b32 v6, v6, v7
    v_and_b32 v6, -16, v6
    v_cmp_ne_u32 vcc, 0, v6
    s_add_u32 s70, s70, 1
    s_cmp_ge_u32 s70, 200000
    s_cbranch_scc1 L_csok
    s_cmp_lg_u64 vcc, 0
    s_cbranch_scc1 L_cs
L_csok:
    v_xor_b32 v4, v4, v5
    v_mov_b32 v5, 163072
    ds_write_b32 v5, v4 offset:16
    s_cmp_lt_u32 s79, 12
    s_cbranch_scc0 L_xb10
    s_barrier
    s_add_u32 s79, s79, 1
L_xb10:
    v_add_f32 v112, v112, v144
    v_add_f32 v113, v113, v145
    v_add_f32 v114, v114, v146
    v_add_f32 v116, v116, v148
    v_add_f32 v117, v117, v149
    v_add_f32 v118, v118, v150
    v_add_f32 v120, v120, v152
    v_add_f32 v121, v121, v153
    v_add_f32 v122, v122, v154
    v_add_f32 v124, v124, v156
    v_add_f32 v125, v125, v157
    v_add_f32 v126, v126, v158
    v_add_f32 v128, v128, v160
    v_add_f32 v129, v129, v161
    v_add_f32 v130, v130, v162
    v_add_f32 v132, v132, v164
    v_add_f32 v133, v133, v165
    v_add_f32 v134, v134, v166
    v_add_f32 v136, v136, v168
    v_add_f32 v137, v137, v169
    v_add_f32 v138, v138, v170
    v_add_f32 v140, v140, v172
    v_add_f32 v141, v141, v173
    v_add_f32 v142, v142, v174
    s_cmp_lt_u32 s79, 12
    s_cbranch_scc0 L_xb11
    s_barrier
    s_add_u32 s79, s79, 1
L_xb11:
    v_add_f32 v112, v112, v128
    v_add_f32 v113, v113, v129
    v_add_f32 v114, v114, v130
    v_add_f32 v116, v116, v132
    v_add_f32 v117, v117, v133
    v_add_f32 v118, v118, v134
    v_add_f32 v120, v120, v136
    v_add_f32 v121, v121, v137
    v_add_f32 v122, v122, v138
    v_add_f32 v124, v124, v140
    v_add_f32 v125, v125, v141
    v_add_f32 v126, v126, v142
    v_add_f32 v112, v112, v120
    v_add_f32 v113, v113, v121
    v_add_f32 v114, v114, v122
    v_add_f32 v116, v116, v124
    v_add_f32 v117, v117, v125
    v_add_f32 v118, v118, v126
    v_add_f32 v112, v112, v116
    v_add_f32 v113, v113, v117
    v_add_f32 v114, v114, v118
    v_lshlrev_b32 v5, 2, v1
    v_add_u32 v5, 162304, v5
    ds_write_b32 v5, v112
    ds_write_b32 v5, v113 offset:256
    ds_write_b32 v5, v114 offset:512
    s_branch L_xend
L_xbw:
    v_and_b32 v5, 7, v1
    v_lshlrev_b32 v5, 3, v5
    v_add_u32 v6, 163264, v5
    ds_read_b64 v[140:141], v6
    s_lshl_b32 s65, s36, 4
    s_add_u32 s65, s65, s37
    s_lshl_b32 s65, s65, 6
    s_add_u32 s65, s65, 0
    s_lshl_b32 s3, s2, 4
    s_add_u32 s3, s3, 65536
    v_mov_b32 v146, v18
    v_mov_b32 v147, v18
    s_waitcnt lgkmcnt(0)
    v_mov_b32 v144, v141
    v_mov_b32 v145, v140
    s_nop 0
    v_max_u32 v144, v144, v144 quad_perm:[1,0,3,2] row_mask:0xf bank_mask:0xf
    s_nop 1
    v_max_u32 v144, v144, v144 quad_perm:[2,3,0,1] row_mask:0xf bank_mask:0xf
    s_nop 1
    v_max_u32 v144, v144, v144 row_half_mirror row_mask:0xf bank_mask:0xf
    v_cmp_eq_u32 vcc, v144, v141
    v_mov_b32 v141, v18
    s_mov_b64 exec, 0xff
    buffer_store_dwordx2 v[140:141], v5, s[12:15], s65 offen sc1
    s_and_b64 exec, exec, vcc
    buffer_store_dwordx4 v[144:147], v34, s[12:15], s3 offen sc1
    s_mov_b64 exec, -1
    s_cmp_lt_u32 s79, 12
    s_cbranch_scc0 L_xb12
    s_barrier
    s_add_u32 s79, s79, 1
L_xb12:
    s_add_u32 m0, s73, 151552
    s_lshl_b32 s65, s37, 12
    s_add_u32 s65, s65, s73
    s_sub_u32 s65, s65, 4096
    buffer_load_dwordx4 v3, s[20:23], s65 offen offset:0 lds
    buffer_load_dwordx4 v3, s[20:23], s65 offen offset:1024 lds
    s_mov_b64 exec, 0
    s_branch L_hk0
L_hr0:
    s_branch L_hk1
L_hr1:
    s_branch L_hk2
L_hr2:
    s_branch L_hk3
L_hr3:
    s_mov_b64 exec, -1
    s_cmp_lt_u32 s79, 12
    s_cbranch_scc0 L_xb13
    s_barrier
    s_add_u32 s79, s79, 1
L_xb13:
    s_mov_b64 exec, 0
    s_branch L_hk4
L_hr4:
    s_branch L_hk5
L_hr5:
    s_branch L_hk6
L_hr6:
    s_branch L_hk7
L_hr7:
    s_mov_b64 exec, -1
    s_cmp_lt_u32 s79, 12
    s_cbranch_scc0 L_xb14
    s_barrier
    s_add_u32 s79, s79, 1
L_xb14:
    s_mov_b64 exec, 0
    s_branch L_hk8
L_hr8:
    s_branch L_hk9
L_hr9:
    s_branch L_hk10
L_hr10:
    s_branch L_hk11
L_hr11:
    s_mov_b64 exec, -1
    s_cmp_lt_u32 s79, 12
    s_cbranch_scc0 L_xb15
    s_barrier
    s_add_u32 s79, s79, 1
L_xb15:
    s_mov_b64 exec, 0
    s_branch L_hk12
L_hr12:
    s_branch L_hk13
L_hr13:
    s_branch L_hk14
L_hr14:
    s_branch L_hk15
L_hr15:
    s_mov_b64 exec, -1
    s_cmp_lt_u32 s79, 12
    s_cbranch_scc0 L_xb16
    s_barrier
    s_add_u32 s79, s79, 1
L_xb16:
L_xu17:
    s_cmp_ge_u32 s79, 7
    s_cbranch_scc1 L_xe17
    s_barrier
    s_add_u32 s79, s79, 1
    s_branch L_xu17
L_xe17:
    s_mov_b32 s68, 65536
    s_lshl_b32 s66, s36, 10
    s_lshl_b32 s67, s30, 10
L_st:
    buffer_load_dwordx4 v[112:115], v3, s[12:15], s68 offen offset:0 sc1
    buffer_load_dwordx4 v[116:119], v3, s[12:15], s68 offen offset:1024 sc1
    buffer_load_dwordx4 v[120:123], v3, s[12:15], s68 offen offset:2048 sc1
    buffer_load_dwordx4 v[124:127], v3, s[12:15], s68 offen offset:3072 sc1
    buffer_load_dwordx4 v[128:131], v3, s[12:15], s66 offen offset:0 sc1
    buffer_load_dwordx4 v[132:135], v3, s[12:15], s67 offen offset:0 sc1
    s_cmp_lt_u32 s79, 12
    s_cbranch_scc0 L_xb18
    s_barrier
    s_add_u32 s79, s79, 1
L_xb18:
    s_waitcnt vmcnt(0)
    v_and_b32 v6, v114, v118
    v_or_b32 v7, v114, v118
    v_min3_u32 v6, v6, v122, v126
    v_max3_u32 v7, v7, v122, v126
    v_min3_u32 v6, v6, v129, v131
    v_max3_u32 v7, v7, v129, v131
    v_min3_u32 v6, v6, v133, v135
    v_max3_u32 v7, v7, v133, v135
    v_xor_b32 v6, v6, v18
    v_xor_b32 v7, v7, v18
    v_or_b32 v6, v6, v7
    v_cmp_ne_u32 vcc, 0, v6
    s_add_u32 s70, s70, 1
    s_cmp_ge_u32 s70, 200000
    s_cbranch_scc1 L_stok
    s_cmp_lg_u64 vcc, 0
    s_cbranch_scc1 L_st
L_stok:
    s_cmp_lt_u32 s79, 12
    s_cbranch_scc0 L_xb19
    s_barrier
    s_add_u32 s79, s79, 1
L_xb19:
    v_and_b32 v140, 0xffff0000, v128
    v_and_b32 v141, 0xffff0000, v130
    v_and_b32 v142, 0xffff0000, v132
    v_and_b32 v143, 0xffff0000, v134
    v_rcp_f32 v144, v140
    v_rcp_f32 v145, v141
    v_rcp_f32 v146, v142
    v_rcp_f32 v147, v143
    v_lshlrev_b32 v136, 16, v128
    v_lshlrev_b32 v137, 16, v130
    v_lshlrev_b32 v138, 16, v132
    v_lshlrev_b32 v139, 16, v134
    v_lshrrev_b32 v7, 16, v128
    v_or_b32 v7, v7, v141
    v_lshlrev_b32 v5, 3, v1
    v_add_u32 v5, 159744, v5
    v_lshlrev_b32 v4, 2, v1
    v_add_u32 v4, 160768, v4
    v_fma_f32 v140, -v144, v140, 1.0
    v_fma_f32 v141, -v145, v141, 1.0
    v_fma_f32 v142, -v146, v142, 1.0
    v_fma_f32 v143, -v147, v143, 1.0
    v_fmac_f32 v144, v140, v144
    v_fmac_f32 v145, v141, v145
    v_fmac_f32 v146, v142, v146
    v_fmac_f32 v147, v143, v147
    v_xor_b32 v136, 0x80000000, v136
    v_xor_b32 v137, 0x80000000, v137
    v_mul_f32 v140, 0x3fb8aa3b, v144
    v_mul_f32 v141, 0x3fb8aa3b, v145
    s_cmp_lt_u32 s79, 12
    s_cbranch_scc0 L_xb20
    s_barrier
    s_add_u32 s79, s79, 1
L_xb20:
    ds_write_b64 v5, v[140:141] offset:3584
    ds_write_b64 v5, v[136:137]
    ds_write_b64 v5, v[144:145] offset:512
    ds_write_b64 v5, v[138:139] offset:1536
    ds_write_b64 v5, v[146:147] offset:2048
    ds_write_b32 v4, v7
    v_cmp_gt_u32 vcc, v116, v112
    s_nop 1
    v_cndmask_b32 v112, v112, v116, vcc
    v_cndmask_b32 v113, v113, v117, vcc
    v_cmp_gt_u32 vcc, v124, v120
    s_nop 1
    v_cndmask_b32 v120, v120, v124, vcc
    v_cndmask_b32 v121, v121, v125, vcc
    v_cmp_gt_u32 vcc, v120, v112
    s_nop 1
    v_cndmask_b32 v112, v112, v120, vcc
    v_cndmask_b32 v113, v113, v121, vcc
    v_mov_b32 v6, v112
    s_cmp_lt_u32 s79, 12
    s_cbranch_scc0 L_xb21
    s_barrier
    s_add_u32 s79, s79, 1
L_xb21:
    v_max_u32 v6, v6, v6 quad_perm:[1,0,3,2] row_mask:0xf bank_mask:0xf
    s_nop 1
    v_max_u32 v6, v6, v6 quad_perm:[2,3,0,1] row_mask:0xf bank_mask:0xf
    s_nop 1
    v_max_u32 v6, v6, v6 row_half_mirror row_mask:0xf bank_mask:0xf
    s_nop 1
    v_max_u32 v6, v6, v6 row_mirror row_mask:0xf bank_mask:0xf
    v_mov_b32 v7, v6
    s_nop 1
    v_permlane16_swap_b32 v6, v7
    v_max_u32 v6, v6, v7
    v_mov_b32 v7, v6
    s_nop 1
    v_permlane32_swap_b32 v6, v7
    v_max_u32 v6, v6, v7
    v_cmp_eq_u32 vcc, v6, v112
    v_mov_b32 v5, 163072
    s_mov_b64 exec, vcc
    ds_write_b128 v5, v[112:115]
    s_mov_b64 exec, -1
L_xend:
    s_waitcnt lgkmcnt(0)
    buffer_load_dwordx4 v[232:235], v248, s[4:7], 0 offen
    buffer_load_dwordx4 v[236:239], v248, s[4:7], s48 offen
    buffer_load_dwordx4 v[240:243], v248, s[4:7], s49 offen
    buffer_load_dwordx4 v[244:247], v248, s[4:7], s100 offen
L_xu22:
    s_cmp_ge_u32 s79, 12
    s_cbranch_scc1 L_xe22
    s_barrier
    s_add_u32 s79, s79, 1
    s_branch L_xu22
L_xe22:
    s_barrier
    s_sleep 6
L_join:
    s_add_u32 s76, s39, 15
    s_and_b32 s76, s76, 15
    s_mul_i32 s76, s76, 393216
    buffer_load_dwordx4 v[36:39], v16, s[8:11], s76 offen offset:0
    buffer_load_dwordx4 v[40:43], v17, s[8:11], s76 offen offset:1024
    s_waitcnt vmcnt(2)
L_hk0:
    s_cbranch_execz L_hr0
    v_mov_b32 v19, 15
    ds_write_b32 v27, v19
    buffer_load_dwordx4 v[128:131], v2, s[80:83], s77 offen nt
    buffer_load_dwordx4 v[160:163], v2, s[84:87], s77 offen nt
    s_add_u32 s77, s77, 7168
    buffer_load_dwordx4 v[132:135], v2, s[80:83], s77 offen nt
    buffer_load_dwordx4 v[164:167], v2, s[84:87], s77 offen nt
    s_add_u32 s77, s77, 7168
    v_mov_b32 v5, 163072
    ds_read_b128 v[80:83], v5
    ds_read_b32 v84, v5 offset:16
    s_and_b32 s65, s2, 15
    s_lshl_b32 s65, s65, 7
    v_lshrrev_b32 v5, 3, v1
    v_lshlrev_b32 v5, 4, v5
    s_waitcnt lgkmcnt(0)
    v_readfirstlane_b32 s33, v80
    v_readfirstlane_b32 s64, v81
    v_mov_b32 v18, v82
    v_readfirstlane_b32 s88, v84
    s_and_b32 s34, s33, 0x7ff
    s_sub_u32 s34, 2047, s34
    s_lshl_b32 s3, s34, 11
    s_add_u32 s3, s3, s65
    buffer_load_dwordx4 v[76:79], v5, s[4:7], s3 offen
    s_lshr_b32 s3, s34, 7
    s_cmp_eq_u32 s3, s30
    s_cselect_b32 s35, 1, 0
    s_mov_b32 s16, s46
    s_mov_b32 s17, s47
    s_mov_b32 s18, 2097152
    s_mov_b32 s19, 0x00020000
    s_lshl_b32 s3, s2, 2
    s_add_u32 s3, s3, s38
    s_lshl_b32 s3, s3, 11
    v_lshlrev_b32 v5, 7, v1
    s_mov_b64 exec, 0xffff
    buffer_load_dword v0, v5, s[16:19], s3 offen
    s_mov_b64 exec, -1
    buffer_load_dwordx4 v[136:139], v2, s[80:83], s77 offen nt
    buffer_load_dwordx4 v[168:171], v2, s[84:87], s77 offen nt
    s_add_u32 s77, s77, 7168
    buffer_load_dwordx4 v[140:143], v2, s[80:83], s77 offen nt
    buffer_load_dwordx4 v[172:175], v2, s[84:87], s77 offen nt
    s_add_u32 s77, s77, 7168
L_pe14:
    ds_read_b128 v[224:227], v26 offset:48
    s_waitcnt lgkmcnt(0)
    v_min_u32 v224, v224, v225
    v_min3_u32 v224, v224, v226, v227
    s_nop 0
    v_readfirstlane_b32 s3, v224
    s_nop 0
    s_cmp_ge_u32 s3, 14
    s_cbranch_scc1 L_pd14
    s_sleep 3
    s_branch L_pe14
L_pd14:
    s_waitcnt vmcnt(10)
    s_add_u32 s3, s73, 65536
    v_add_u32 v24, s3, v3
    ds_write_b128 v24, v[36:39] offset:16384
    ds_write_b128 v24, v[40:43] offset:17408
    s_lshl_b32 s3, s38, 2
    s_add_u32 s3, s3, 163120
    v_mov_b32 v5, s3
L_hk1:
    s_cbranch_execz L_hr1
    v_mov_b32 v6, 1
    ds_write_b32 v5, v6
    buffer_load_dwordx4 v[144:147], v2, s[80:83], s77 offen nt
    buffer_load_dwordx4 v[176:179], v2, s[84:87], s77 offen nt
    s_add_u32 s77, s77, 7168
    buffer_load_dwordx4 v[148:151], v2, s[80:83], s77 offen nt
    buffer_load_dwordx4 v[180:183], v2, s[84:87], s77 offen nt
    s_add_u32 s77, s77, 7168
    buffer_load_dwordx4 v[152:155], v2, s[80:83], s77 offen nt
    buffer_load_dwordx4 v[184:187], v2, s[84:87], s77 offen nt
    s_add_u32 s77, s77, 7168
    buffer_load_dwordx4 v[156:159], v2, s[80:83], s77 offen nt
    buffer_load_dwordx4 v[188:191], v2, s[84:87], s77 offen nt
    s_add_u32 s77, s77, 7168
    s_mov_b32 s20, s56
    s_mov_b32 s21, s57
    s_mov_b32 s22, 7340032
    s_mov_b32 s23, 0x00020000
    s_cmp_lt_u32 s2, 224
    s_cselect_b32 s22, s22, 0
    v_lshrrev_b32 v5, 4, v1
    v_lshlrev_b32 v5, 11, v5
    v_and_b32 v6, 15, v1
    v_lshl_add_u32 v109, v6, 4, v5
    s_lshl_b32 s93, s2, 15
    s_lshl_b32 s65, s38, 9
    s_add_u32 s93, s93, s65
    buffer_load_dwordx4 v[192:195], v109, s[20:23], s93 offen offset:0 nt
    buffer_load_dwordx4 v[196:199], v109, s[20:23], s93 offen offset:256 nt
    s_add_u32 s93, s93, 8192
    buffer_load_dwordx4 v[200:203], v109, s[20:23], s93 offen offset:0 nt
    buffer_load_dwordx4 v[204:207], v109, s[20:23], s93 offen offset:256 nt
    s_add_u32 s93, s93, 8192
    buffer_load_dwordx4 v[208:211], v109, s[20:23], s93 offen offset:0 nt
    buffer_load_dwordx4 v[212:215], v109, s[20:23], s93 offen offset:256 nt
    s_add_u32 s93, s93, 8192
    buffer_load_dwordx4 v[216:219], v109, s[20:23], s93 offen offset:0 nt
    buffer_load_dwordx4 v[220:223], v109, s[20:23], s93 offen offset:256 nt
    s_lshl_b32 s65, s37, 1
    s_and_b32 s3, s38, 1
    s_add_u32 s65, s65, s3
    s_lshl_b32 s3, s36, 9
    s_lshl_b32 s89, s65, 17
    s_add_u32 s89, s89, s3
    s_add_u32 s89, s89, 2097152
    s_add_u32 s90, s89, 32768
    s_add_u32 s91, s89, 65536
    s_add_u32 s92, s89, 98304
    s_lshl_b32 s69, s65, 13
    s_add_u32 s69, s69, 524288
    s_add_u32 s68, s69, s3
    s_add_u32 s71, s69, 4096
    s_mov_b32 s94, 0xffff
    s_mov_b32 s95, 0xffff
    v_lshrrev_b32 v5, 4, v1
    v_and_b32 v6, 15, v1
    v_lshlrev_b32 v6, 4, v6
    v_lshl_add_u32 v28, v5, 13, v6
    v_lshrrev_b32 v7, 5, v1
    v_lshl_add_u32 v29, v7, 8, v6
    s_lshl_b32 s3, s38, 12
    s_add_u32 s3, s3, 141312
    v_add_u32 v30, s3, v3
    s_lshl_b32 s3, s38, 7
    s_add_u32 s3, s3, 157440
L_hk2:
    s_cbranch_execz L_hr2
    v_lshl_add_u32 v31, v5, 3, s3
    v_and_b32 v5, 8, v1
    v_cmp_eq_u32 vcc, 0, v5
    s_nop 1
    v_cndmask_b32 v112, 0, v20, vcc
    v_cndmask_b32 v116, v20, 0, vcc
    v_cndmask_b32 v113, 0, v21, vcc
    v_cndmask_b32 v117, v21, 0, vcc
    v_cndmask_b32 v114, 0, v22, vcc
    v_cndmask_b32 v118, v22, 0, vcc
    v_cndmask_b32 v115, 0, v23, vcc
    v_cndmask_b32 v119, v23, 0, vcc
    v_mov_b32 v127, v18
    s_waitcnt vmcnt(21)
    s_lshl_b32 s65, s64, 16
    s_and_b32 s66, s64, 0xffff0000
    v_rcp_f32 v6, s66
    v_lshlrev_b32 v80, 16, v76
    v_and_b32 v81, 0xffff0000, v76
    v_lshlrev_b32 v82, 16, v77
    v_and_b32 v83, 0xffff0000, v77
    v_lshlrev_b32 v84, 16, v78
    v_and_b32 v85, 0xffff0000, v78
    v_lshlrev_b32 v86, 16, v79
    v_and_b32 v87, 0xffff0000, v79
    v_fma_f32 v4, -v6, s66, 1.0
    v_fmac_f32 v6, v4, v6
    v_subrev_f32 v80, s65, v80
    v_subrev_f32 v81, s65, v81
    v_subrev_f32 v82, s65, v82
    v_subrev_f32 v83, s65, v83
    v_subrev_f32 v84, s65, v84
    v_subrev_f32 v85, s65, v85
    v_subrev_f32 v86, s65, v86
    v_subrev_f32 v87, s65, v87
    v_cvt_pk_bf16_f32 v80, v80, v80
    v_cvt_pk_bf16_f32 v81, v81, v81
    v_cvt_pk_bf16_f32 v82, v82, v82
    v_cvt_pk_bf16_f32 v83, v83, v83
    v_cvt_pk_bf16_f32 v84, v84, v84
    v_cvt_pk_bf16_f32 v85, v85, v85
    v_cvt_pk_bf16_f32 v86, v86, v86
    v_cvt_pk_bf16_f32 v87, v87, v87
    v_lshlrev_b32 v80, 16, v80
    v_lshlrev_b32 v81, 16, v81
    v_lshlrev_b32 v82, 16, v82
    v_lshlrev_b32 v83, 16, v83
    v_lshlrev_b32 v84, 16, v84
    v_lshlrev_b32 v85, 16, v85
    v_lshlrev_b32 v86, 16, v86
    v_lshlrev_b32 v87, 16, v87
    v_mul_f32 v80, v80, v6
    v_mul_f32 v81, v81, v6
    v_mul_f32 v82, v82, v6
    v_mul_f32 v83, v83, v6
    v_mul_f32 v84, v84, v6
    v_mul_f32 v85, v85, v6
    v_mul_f32 v86, v86, v6
    v_mul_f32 v87, v87, v6
    v_cvt_pk_bf16_f32 v80, v80, v80
    v_cvt_pk_bf16_f32 v81, v81, v81
    v_cvt_pk_bf16_f32 v82, v82, v82
    v_cvt_pk_bf16_f32 v83, v83, v83
    v_cvt_pk_bf16_f32 v84, v84, v84
L_hk3:
    s_cbranch_execz L_hr3
    v_cvt_pk_bf16_f32 v85, v85, v85
    v_cvt_pk_bf16_f32 v86, v86, v86
    v_cvt_pk_bf16_f32 v87, v87, v87
    v_lshrrev_b32 v5, 5, v1
    v_and_b32 v6, 7, v1
    v_lshlrev_b32 v6, 1, v6
    v_lshl_add_u32 v6, v5, 4, v6
    v_bfe_u32 v5, v1, 4, 1
    v_add_u32 v6, v6, v5
    v_lshlrev_b32 v108, 4, v6
    s_lshr_b32 s3, s2, 4
    s_lshl_b32 s3, s3, 2
    s_add_u32 s3, s3, s38
    s_lshl_b32 s3, s3, 4
    s_and_b32 s65, s2, 15
    s_add_u32 s3, s3, s65
    s_lshl_b32 s3, s3, 10
    s_add_u32 s78, s3, 6291456
    s_mov_b32 s66, 0x00ff00ff
    s_mov_b32 s67, 0x00ff00ff
    v_mov_b32 v93, v18
    v_mov_b32 v95, v18
    v_mov_b32 v97, v18
    v_mov_b32 v99, v18
    v_lshrrev_b32 v5, 3, v1
    v_lshlrev_b32 v5, 11, v5
    v_lshrrev_b32 v6, 4, v1
    v_lshlrev_b32 v6, 1, v6
    v_and_b32 v7, 7, v1
    v_xor_b32 v6, v6, v7
    v_lshl_add_u32 v5, v6, 4, v5
    s_lshl_b32 s3, s31, 7
    s_lshl_b32 s65, s38, 15
    s_add_u32 s3, s3, s65
    v_add_u32 v110, s3, v5
    v_add_u32 v111, 15360, v110
    v_and_b32 v68, v80, v88
    v_and_b32 v69, v80, v89
    v_and_b32 v70, v80, v90
    v_and_b32 v71, v80, v91
    s_nop 1
    v_mfma_f32_16x16x32_bf16 v[100:103], v[68:71], v[128:131], 0
    v_mfma_f32_16x16x32_bf16 v[104:107], v[68:71], v[160:163], 0
    v_and_b32 v72, v81, v88
    v_and_b32 v73, v81, v89
    v_and_b32 v74, v81, v90
    v_and_b32 v75, v81, v91
    s_nop 1
    v_mfma_f32_16x16x32_bf16 v[100:103], v[72:75], v[132:135], v[100:103]
    v_mfma_f32_16x16x32_bf16 v[104:107], v[72:75], v[164:167], v[104:107]
    s_waitcnt vmcnt(18)
    v_and_b32 v68, v82, v88
    v_and_b32 v69, v82, v89
    v_and_b32 v70, v82, v90
    v_and_b32 v71, v82, v91
    s_nop 1
    v_mfma_f32_16x16x32_bf16 v[100:103], v[68:71], v[136:139], v[100:103]
    v_mfma_f32_16x16x32_bf16 v[104:107], v[68:71], v[168:171], v[104:107]
    s_waitcnt vmcnt(16)
    v_and_b32 v72, v83, v88
    v_and_b32 v73, v83, v89
    v_and_b32 v74, v83, v90
    v_and_b32 v75, v83, v91
    s_nop 1
    v_mfma_f32_16x16x32_bf16 v[100:103], v[72:75], v[140:143], v[100:103]
    v_mfma_f32_16x16x32_bf16 v[104:107], v[72:75], v[172:175], v[104:107]
    s_waitcnt vmcnt(14)
L_hk4:
    s_cbranch_execz L_hr4
    v_and_b32 v68, v84, v88
    v_and_b32 v69, v84, v89
    v_and_b32 v70, v84, v90
    v_and_b32 v71, v84, v91
    s_nop 1
    v_mfma_f32_16x16x32_bf16 v[100:103], v[68:71], v[144:147], v[100:103]
    v_mfma_f32_16x16x32_bf16 v[104:107], v[68:71], v[176:179], v[104:107]
    s_waitcnt vmcnt(12)
    v_and_b32 v72, v85, v88
    v_and_b32 v73, v85, v89
    v_and_b32 v74, v85, v90
    v_and_b32 v75, v85, v91
    s_nop 1
    v_mfma_f32_16x16x32_bf16 v[100:103], v[72:75], v[148:151], v[100:103]
    v_mfma_f32_16x16x32_bf16 v[104:107], v[72:75], v[180:183], v[104:107]
    s_waitcnt vmcnt(10)
    v_and_b32 v68, v86, v88
    v_and_b32 v69, v86, v89
    v_and_b32 v70, v86, v90
    v_and_b32 v71, v86, v91
    s_nop 1
    v_mfma_f32_16x16x32_bf16 v[100:103], v[68:71], v[152:155], v[100:103]
    v_mfma_f32_16x16x32_bf16 v[104:107], v[68:71], v[184:187], v[104:107]
    s_waitcnt vmcnt(8)
    v_and_b32 v72, v87, v88
    v_and_b32 v73, v87, v89
    v_and_b32 v74, v87, v90
    v_and_b32 v75, v87, v91
    s_nop 1
    v_mfma_f32_16x16x32_bf16 v[100:103], v[72:75], v[156:159], v[100:103]
    v_mfma_f32_16x16x32_bf16 v[104:107], v[72:75], v[188:191], v[104:107]
    s_nop 7
    v_permlane32_swap_b32 v100, v104
    v_permlane32_swap_b32 v101, v105
    v_permlane32_swap_b32 v102, v106
    v_permlane32_swap_b32 v103, v107
    v_add_f32 v92, v104, v100 row_ror:8 row_mask:0xf bank_mask:0xf
    v_add_f32 v94, v105, v101 row_ror:8 row_mask:0xf bank_mask:0xf
    v_add_f32 v96, v106, v102 row_ror:8 row_mask:0xf bank_mask:0xf
    v_add_f32 v98, v107, v103 row_ror:8 row_mask:0xf bank_mask:0xf
    s_mov_b64 exec, s[66:67]
    buffer_store_dwordx4 v[92:95], v108, s[12:15], s78 offen offset:0 sc1
    buffer_store_dwordx4 v[96:99], v108, s[12:15], s78 offen offset:512 sc1
    s_mov_b64 exec, -1
    s_cmp_ge_u32 s38, 2
    s_cbranch_scc1 L_xw2
L_pe17:
    ds_read_b128 v[224:227], v26 offset:48
    s_waitcnt lgkmcnt(0)
    v_min_u32 v224, v224, v225
    v_min3_u32 v224, v224, v226, v227
    s_nop 0
    v_readfirstlane_b32 s3, v224
    s_nop 0
    s_cmp_ge_u32 s3, 17
    s_cbranch_scc1 L_pd17
    s_sleep 3
    s_branch L_pe17
L_pd17:
    s_waitcnt vmcnt(12)
    s_add_u32 m0, s73, 0
    s_mov_b32 s3, 0
    buffer_load_dwordx4 v110, s[16:19], s3 offen offset:0  lds
    buffer_load_dwordx4 v111, s[16:19], s3 offen offset:1024  lds
    s_add_u32 m0, s73, 4096
    s_add_u32 s3, s3, 65536
    buffer_load_dwordx4 v110, s[16:19], s3 offen offset:0  lds
    buffer_load_dwordx4 v111, s[16:19], s3 offen offset:1024  lds
    s_waitcnt vmcnt(12)
    s_add_u32 m0, s73, 8192
    s_mov_b32 s3, 131072
    buffer_load_dwordx4 v110, s[16:19], s3 offen offset:0  lds
    buffer_load_dwordx4 v111, s[16:19], s3 offen offset:1024  lds
    s_add_u32 m0, s73, 12288
    s_add_u32 s3, s3, 65536
    buffer_load_dwordx4 v110, s[16:19], s3 offen offset:0  lds
    buffer_load_dwordx4 v111, s[16:19], s3 offen offset:1024  lds
    s_waitcnt vmcnt(12)
    s_add_u32 m0, s73, 65536
    s_mov_b32 s3, 1048576
    buffer_load_dwordx4 v110, s[16:19], s3 offen offset:0  lds
    buffer_load_dwordx4 v111, s[16:19], s3 offen offset:1024  lds
    s_add_u32 m0, s73, 69632
    s_add_u32 s3, s3, 65536
    buffer_load_dwordx4 v110, s[16:19], s3 offen offset:0  lds
    buffer_load_dwordx4 v111, s[16:19], s3 offen offset:1024  lds
    s_waitcnt vmcnt(12)
    s_add_u32 m0, s73, 73728
    s_mov_b32 s3, 1179648
    buffer_load_dwordx4 v110, s[16:19], s3 offen offset:0  lds
    buffer_load_dwordx4 v111, s[16:19], s3 offen offset:1024  lds
    s_add_u32 m0, s73, 77824
    s_add_u32 s3, s3, 65536
    buffer_load_dwordx4 v110, s[16:19], s3 offen offset:0  lds
    buffer_load_dwordx4 v111, s[16:19], s3 offen offset:1024  lds
    s_waitcnt vmcnt(12)
    s_add_u32 m0, s73, 90112
    s_mov_b32 s3, 1441792
    buffer_load_dwordx4 v110, s[16:19], s3 offen offset:0  lds
    buffer_load_dwordx4 v111, s[16:19], s3 offen offset:1024  lds
    s_add_u32 m0, s73, 94208
    s_add_u32 s3, s3, 65536
    buffer_load_dwordx4 v110, s[16:19], s3 offen offset:0  lds
    buffer_load_dwordx4 v111, s[16:19], s3 offen offset:1024  lds
    s_waitcnt vmcnt(12)
    s_add_u32 m0, s73, 98304
    s_mov_b32 s3, 1572864
    buffer_load_dwordx4 v110, s[16:19], s3 offen offset:0  lds
    buffer_load_dwordx4 v111, s[16:19], s3 offen offset:1024  lds
    s_add_u32 m0, s73, 102400
    s_add_u32 s3, s3, 65536
    buffer_load_dwordx4 v110, s[16:19], s3 offen offset:0  lds
    buffer_load_dwordx4 v111, s[16:19], s3 offen offset:1024  lds
    s_waitcnt vmcnt(12)
    s_add_u32 m0, s73, 106496
    s_mov_b32 s3, 1703936
    buffer_load_dwordx4 v110, s[16:19], s3 offen offset:0  lds
    buffer_load_dwordx4 v111, s[16:19], s3 offen offset:1024  lds
    s_add_u32 m0, s73, 110592
    s_add_u32 s3, s3, 65536
    buffer_load_dwordx4 v110, s[16:19], s3 offen offset:0  lds
    buffer_load_dwordx4 v111, s[16:19], s3 offen offset:1024  lds
    s_waitcnt vmcnt(12)
    s_add_u32 m0, s73, 114688
    s_mov_b32 s3, 1835008
    buffer_load_dwordx4 v110, s[16:19], s3 offen offset:0  lds
    buffer_load_dwordx4 v111, s[16:19], s3 offen offset:1024  lds
    s_add_u32 m0, s73, 118784
    s_add_u32 s3, s3, 65536
    buffer_load_dwordx4 v110, s[16:19], s3 offen offset:0  lds
    buffer_load_dwordx4 v111, s[16:19], s3 offen offset:1024  lds
    s_waitcnt vmcnt(12)
    s_add_u32 m0, s73, 122880
    s_mov_b32 s3, 1966080
    buffer_load_dwordx4 v110, s[16:19], s3 offen offset:0  lds
    buffer_load_dwordx4 v111, s[16:19], s3 offen offset:1024  lds
    s_add_u32 m0, s73, 126976
    s_add_u32 s3, s3, 65536
    buffer_load_dwordx4 v110, s[16:19], s3 offen offset:0  lds
    buffer_load_dwordx4 v111, s[16:19], s3 offen offset:1024  lds
L_pe18:
    ds_read_b128 v[224:227], v26 offset:48
    s_waitcnt lgkmcnt(0)
L_hk5:
    s_cbranch_execz L_hr5
    v_min_u32 v224, v224, v225
    v_min3_u32 v224, v224, v226, v227
    s_nop 0
    v_readfirstlane_b32 s3, v224
    s_nop 0
    s_cmp_ge_u32 s3, 18
    s_cbranch_scc1 L_pd18
    s_sleep 3
    s_branch L_pe18
L_pd18:
    s_waitcnt vmcnt(12)
    s_add_u32 m0, s73, 16384
    s_mov_b32 s3, 262144
    buffer_load_dwordx4 v110, s[16:19], s3 offen offset:0  lds
    buffer_load_dwordx4 v111, s[16:19], s3 offen offset:1024  lds
    s_add_u32 m0, s73, 20480
    s_add_u32 s3, s3, 65536
    buffer_load_dwordx4 v110, s[16:19], s3 offen offset:0  lds
    buffer_load_dwordx4 v111, s[16:19], s3 offen offset:1024  lds
    s_waitcnt vmcnt(12)
    s_add_u32 m0, s73, 24576
    s_mov_b32 s3, 393216
    buffer_load_dwordx4 v110, s[16:19], s3 offen offset:0  lds
    buffer_load_dwordx4 v111, s[16:19], s3 offen offset:1024  lds
    s_add_u32 m0, s73, 28672
    s_add_u32 s3, s3, 65536
    buffer_load_dwordx4 v110, s[16:19], s3 offen offset:0  lds
    buffer_load_dwordx4 v111, s[16:19], s3 offen offset:1024  lds
L_pe19:
    ds_read_b128 v[224:227], v26 offset:48
    s_waitcnt lgkmcnt(0)
    v_min_u32 v224, v224, v225
    v_min3_u32 v224, v224, v226, v227
    s_nop 0
    v_readfirstlane_b32 s3, v224
    s_nop 0
    s_cmp_ge_u32 s3, 19
    s_cbranch_scc1 L_pd19
    s_sleep 3
    s_branch L_pe19
L_pd19:
    s_waitcnt vmcnt(12)
    s_add_u32 m0, s73, 32768
    s_mov_b32 s3, 524288
    buffer_load_dwordx4 v110, s[16:19], s3 offen offset:0  lds
    buffer_load_dwordx4 v111, s[16:19], s3 offen offset:1024  lds
    s_add_u32 m0, s73, 36864
    s_add_u32 s3, s3, 65536
    buffer_load_dwordx4 v110, s[16:19], s3 offen offset:0  lds
    buffer_load_dwordx4 v111, s[16:19], s3 offen offset:1024  lds
    s_waitcnt vmcnt(12)
    s_add_u32 m0, s73, 40960
    s_mov_b32 s3, 655360
    buffer_load_dwordx4 v110, s[16:19], s3 offen offset:0  lds
    buffer_load_dwordx4 v111, s[16:19], s3 offen offset:1024  lds
    s_add_u32 m0, s73, 45056
    s_add_u32 s3, s3, 65536
    buffer_load_dwordx4 v110, s[16:19], s3 offen offset:0  lds
    buffer_load_dwordx4 v111, s[16:19], s3 offen offset:1024  lds
L_pe20:
    ds_read_b128 v[224:227], v26 offset:48
    s_waitcnt lgkmcnt(0)
    v_min_u32 v224, v224, v225
    v_min3_u32 v224, v224, v226, v227
    s_nop 0
    v_readfirstlane_b32 s3, v224
    s_nop 0
    s_cmp_ge_u32 s3, 20
    s_cbranch_scc1 L_pd20
    s_sleep 3
    s_branch L_pe20
L_pd20:
    s_waitcnt vmcnt(12)
    s_add_u32 m0, s73, 49152
    s_mov_b32 s3, 786432
    buffer_load_dwordx4 v110, s[16:19], s3 offen offset:0  lds
    buffer_load_dwordx4 v111, s[16:19], s3 offen offset:1024  lds
    s_add_u32 m0, s73, 53248
    s_add_u32 s3, s3, 65536
    buffer_load_dwordx4 v110, s[16:19], s3 offen offset:0  lds
    buffer_load_dwordx4 v111, s[16:19], s3 offen offset:1024  lds
    s_waitcnt vmcnt(12)
    s_add_u32 m0, s73, 57344
    s_mov_b32 s3, 917504
    buffer_load_dwordx4 v110, s[16:19], s3 offen offset:0  lds
    buffer_load_dwordx4 v111, s[16:19], s3 offen offset:1024  lds
    s_add_u32 m0, s73, 61440
    s_add_u32 s3, s3, 65536
    buffer_load_dwordx4 v110, s[16:19], s3 offen offset:0  lds
    buffer_load_dwordx4 v111, s[16:19], s3 offen offset:1024  lds
    s_waitcnt vmcnt(12)
    s_add_u32 m0, s73, 81920
    s_mov_b32 s3, 1310720
    buffer_load_dwordx4 v110, s[16:19], s3 offen offset:0  lds
    buffer_load_dwordx4 v111, s[16:19], s3 offen offset:1024  lds
    s_add_u32 m0, s73, 86016
    s_add_u32 s3, s3, 65536
    buffer_load_dwordx4 v110, s[16:19], s3 offen offset:0  lds
    buffer_load_dwordx4 v111, s[16:19], s3 offen offset:1024  lds
    s_branch L_join2
L_xw2:
L_es:
    ds_read_b128 v[224:227], v26 offset:80
    s_waitcnt lgkmcnt(0)
L_hk6:
    s_cbranch_execz L_hr6
    v_min_u32 v224, v224, v225
    v_min3_u32 v224, v224, v226, v227
    s_nop 0
    v_readfirstlane_b32 s3, v224
    s_nop 0
    s_cmp_ge_u32 s3, 3
    s_cbranch_scc1 L_esd
    s_sleep 2
    s_branch L_es
L_esd:
    s_setprio 3
    buffer_load_dwordx4 v[36:39], v28, s[12:15], s89 offen offset:0 sc1 nt
    buffer_load_dwordx4 v[40:43], v28, s[12:15], s89 offen offset:256 sc1 nt
    buffer_load_dwordx4 v[44:47], v28, s[12:15], s90 offen offset:0 sc1 nt
    buffer_load_dwordx4 v[48:51], v28, s[12:15], s90 offen offset:256 sc1 nt
    buffer_load_dwordx4 v[52:55], v28, s[12:15], s91 offen offset:0 sc1 nt
    buffer_load_dwordx4 v[56:59], v28, s[12:15], s91 offen offset:256 sc1 nt
    buffer_load_dwordx4 v[60:63], v28, s[12:15], s92 offen offset:0 sc1 nt
    buffer_load_dwordx4 v[64:67], v28, s[12:15], s92 offen offset:256 sc1 nt
    s_waitcnt vmcnt(0)
L_ha:
    v_mfma_f32_16x16x32_bf16 v[120:123], v[112:115], v[36:39], 0
    v_mfma_f32_16x16x32_bf16 v[120:123], v[116:119], v[40:43], v[120:123]
    v_mfma_f32_16x16x32_bf16 v[120:123], v[112:115], v[44:47], v[120:123]
    v_mfma_f32_16x16x32_bf16 v[120:123], v[116:119], v[48:51], v[120:123]
    v_mfma_f32_16x16x32_bf16 v[120:123], v[112:115], v[52:55], v[120:123]
    v_mfma_f32_16x16x32_bf16 v[120:123], v[116:119], v[56:59], v[120:123]
    v_mfma_f32_16x16x32_bf16 v[120:123], v[112:115], v[60:63], v[120:123]
    v_mfma_f32_16x16x32_bf16 v[120:123], v[116:119], v[64:67], v[120:123]
    v_and_b32 v6, v39, v43
    v_or_b32 v7, v39, v43
    v_min3_u32 v6, v6, v47, v51
    v_max3_u32 v7, v7, v47, v51
    v_min3_u32 v6, v6, v55, v59
    v_max3_u32 v7, v7, v55, v59
    v_min3_u32 v6, v6, v63, v67
    v_max3_u32 v7, v7, v63, v67
    v_xor_b32 v6, v6, v18
    v_xor_b32 v7, v7, v18
    v_or_b32 v6, v6, v7
    v_cmp_ne_u32 vcc, 0, v6
    s_nop 0
    s_cmp_eq_u64 vcc, 0
    s_cbranch_scc1 L_haok
    s_add_u32 s70, s70, 1
    s_cmp_ge_u32 s70, 200000
    s_cbranch_scc1 L_haok
    s_sleep 2
    buffer_load_dwordx4 v[36:39], v28, s[12:15], s89 offen offset:0 sc1 nt
    buffer_load_dwordx4 v[40:43], v28, s[12:15], s89 offen offset:256 sc1 nt
    buffer_load_dwordx4 v[44:47], v28, s[12:15], s90 offen offset:0 sc1 nt
    buffer_load_dwordx4 v[48:51], v28, s[12:15], s90 offen offset:256 sc1 nt
    buffer_load_dwordx4 v[52:55], v28, s[12:15], s91 offen offset:0 sc1 nt
    buffer_load_dwordx4 v[56:59], v28, s[12:15], s91 offen offset:256 sc1 nt
    buffer_load_dwordx4 v[60:63], v28, s[12:15], s92 offen offset:0 sc1 nt
    buffer_load_dwordx4 v[64:67], v28, s[12:15], s92 offen offset:256 sc1 nt
    s_waitcnt vmcnt(0)
    s_branch L_ha
L_haok:
    v_cvt_pk_bf16_f32 v6, v120, v121
    v_cvt_pk_bf16_f32 v124, v120, v121
    v_cvt_pk_bf16_f32 v125, v122, v123
    v_permlane16_swap_b32 v6, v126
    s_mov_b64 exec, s[94:95]
    s_cmp_lg_u32 s88, 0
    s_cbranch_scc1 L_hrm
    buffer_store_dwordx4 v[124:127], v29, s[12:15], s68 offen
    s_branch L_hs
L_hrm:
    buffer_store_dwordx4 v[124:127], v29, s[12:15], s68 offen sc1
L_hs:
    s_mov_b64 exec, -1
    buffer_load_dwordx4 v[36:39], v3, s[12:15], s69 offen offset:0 sc1 nt
    buffer_load_dwordx4 v[40:43], v3, s[12:15], s69 offen offset:1024 sc1 nt
    buffer_load_dwordx4 v[44:47], v3, s[12:15], s69 offen offset:2048 sc1 nt
    buffer_load_dwordx4 v[48:51], v3, s[12:15], s69 offen offset:3072 sc1 nt
    buffer_load_dwordx4 v[52:55], v3, s[12:15], s71 offen offset:0 sc1 nt
    buffer_load_dwordx4 v[56:59], v3, s[12:15], s71 offen offset:1024 sc1 nt
    buffer_load_dwordx4 v[60:63], v3, s[12:15], s71 offen offset:2048 sc1 nt
    buffer_load_dwordx4 v[64:67], v3, s[12:15], s71 offen offset:3072 sc1 nt
L_pe119:
    ds_read_b128 v[224:227], v26 offset:48
    s_waitcnt lgkmcnt(0)
L_hk7:
    s_cbranch_execz L_hr7
    v_min_u32 v224, v224, v225
    v_min3_u32 v224, v224, v226, v227
    s_nop 0
    v_readfirstlane_b32 s3, v224
    s_nop 0
    s_cmp_ge_u32 s3, 19
    s_cbranch_scc1 L_pd119
    s_sleep 3
    s_branch L_pe119
L_pd119:
    s_waitcnt vmcnt(0)
L_hb:
    v_and_b32 v6, v39, v43
    v_or_b32 v7, v39, v43
    v_min3_u32 v6, v6, v47, v51
    v_max3_u32 v7, v7, v47, v51
    v_min3_u32 v6, v6, v55, v59
    v_max3_u32 v7, v7, v55, v59
    v_min3_u32 v6, v6, v63, v67
    v_max3_u32 v7, v7, v63, v67
    v_xor_b32 v6, v6, v18
    v_xor_b32 v7, v7, v18
    v_or_b32 v6, v6, v7
    v_cmp_ne_u32 vcc, 0, v6
    s_nop 0
    s_cmp_eq_u64 vcc, 0
    s_cbranch_scc1 L_hbok
    s_add_u32 s70, s70, 1
    s_cmp_ge_u32 s70, 200000
    s_cbranch_scc1 L_hbok
    s_sleep 2
    buffer_load_dwordx4 v[36:39], v3, s[12:15], s69 offen offset:0 sc1 nt
    buffer_load_dwordx4 v[40:43], v3, s[12:15], s69 offen offset:1024 sc1 nt
    buffer_load_dwordx4 v[44:47], v3, s[12:15], s69 offen offset:2048 sc1 nt
    buffer_load_dwordx4 v[48:51], v3, s[12:15], s69 offen offset:3072 sc1 nt
    buffer_load_dwordx4 v[52:55], v3, s[12:15], s71 offen offset:0 sc1 nt
    buffer_load_dwordx4 v[56:59], v3, s[12:15], s71 offen offset:1024 sc1 nt
    buffer_load_dwordx4 v[60:63], v3, s[12:15], s71 offen offset:2048 sc1 nt
    buffer_load_dwordx4 v[64:67], v3, s[12:15], s71 offen offset:3072 sc1 nt
    s_waitcnt vmcnt(0)
    s_branch L_hb
L_hbok:
    ds_write_b64 v30, v[36:37] offset:0
    ds_write_b64 v30, v[40:41] offset:8
    ds_write_b64 v30, v[44:45] offset:1024
    ds_write_b64 v30, v[48:49] offset:1032
    ds_write_b64 v30, v[52:53] offset:2048
    ds_write_b64 v30, v[56:57] offset:2056
    ds_write_b64 v30, v[60:61] offset:3072
    ds_write_b64 v30, v[64:65] offset:3080
    ds_write_b32 v31, v38 offset:0
    ds_write_b32 v31, v42 offset:32
    ds_write_b32 v31, v46 offset:4
    ds_write_b32 v31, v50 offset:36
    ds_write_b32 v31, v54 offset:64
    ds_write_b32 v31, v58 offset:96
    ds_write_b32 v31, v62 offset:68
    ds_write_b32 v31, v66 offset:100
    s_lshl_b32 s3, s38, 2
    s_add_u32 s3, s3, 163096
    v_mov_b32 v5, s3
    v_mov_b32 v6, 1
    ds_write_b32 v5, v6
    s_setprio 0
L_join2:
    v_lshrrev_b32 v5, 2, v1
    v_lshlrev_b32 v5, 10, v5
    v_and_b32 v6, 3, v1
    v_lshl_add_u32 v5, v6, 4, v5
    s_lshr_b32 s3, s2, 2
    s_lshl_b32 s3, s3, 14
    s_and_b32 s65, s2, 3
    s_lshl_b32 s65, s65, 6
    s_add_u32 s3, s3, s65
    s_add_u32 s3, s3, 6291456
    buffer_load_dwordx4 v[52:55], v5, s[12:15], s3 offen offset:0 sc1
    buffer_load_dwordx4 v[56:59], v5, s[12:15], s3 offen offset:512 sc1
    buffer_load_dwordx4 v[60:63], v5, s[12:15], s3 offen offset:256 sc1
    buffer_load_dwordx4 v[64:67], v5, s[12:15], s3 offen offset:768 sc1
    s_waitcnt vmcnt(4)
    s_lshl_b32 s3, s38, 2
    s_add_u32 s3, s3, 163216
    v_mov_b32 v5, s3
    v_mov_b32 v6, 1
    ds_write_b32 v5, v6
    s_waitcnt vmcnt(0)
L_gu:
    v_xor_b32 v6, v53, v18
    v_xor_b32 v7, v55, v18
    v_or_b32 v6, v6, v7
    v_xor_b32 v7, v57, v18
    v_or_b32 v6, v6, v7
    v_xor_b32 v7, v59, v18
    v_or_b32 v6, v6, v7
    v_xor_b32 v7, v61, v18
    v_or_b32 v6, v6, v7
    v_xor_b32 v7, v63, v18
    v_or_b32 v6, v6, v7
    v_xor_b32 v7, v65, v18
    v_or_b32 v6, v6, v7
    v_xor_b32 v7, v67, v18
    v_or_b32 v6, v6, v7
    v_cmp_ne_u32 vcc, 0, v6
    s_nop 0
    s_cmp_eq_u64 vcc, 0
    s_cbranch_scc1 L_guok
    s_add_u32 s70, s70, 1
    s_cmp_ge_u32 s70, 200000
    s_cbranch_scc1 L_guok
    s_sleep 8
    v_lshrrev_b32 v5, 2, v1
    v_lshlrev_b32 v5, 10, v5
    v_and_b32 v6, 3, v1
    v_lshl_add_u32 v5, v6, 4, v5
    s_lshr_b32 s3, s2, 2
    s_lshl_b32 s3, s3, 14
    s_and_b32 s65, s2, 3
    s_lshl_b32 s65, s65, 6
    s_add_u32 s3, s3, s65
    s_add_u32 s3, s3, 6291456
    buffer_load_dwordx4 v[52:55], v5, s[12:15], s3 offen offset:0 sc1
    buffer_load_dwordx4 v[56:59], v5, s[12:15], s3 offen offset:512 sc1
    buffer_load_dwordx4 v[60:63], v5, s[12:15], s3 offen offset:256 sc1
    buffer_load_dwordx4 v[64:67], v5, s[12:15], s3 offen offset:768 sc1
    s_waitcnt vmcnt(0)
    s_branch L_gu
L_guok:
    v_permlane32_swap_b32 v52, v56
    v_permlane32_swap_b32 v54, v58
    v_permlane32_swap_b32 v60, v64
    v_permlane32_swap_b32 v62, v66
    v_add_f32 v52, v52, v56
    v_add_f32 v54, v54, v58
    v_add_f32 v60, v60, v64
    v_add_f32 v62, v62, v66
    v_permlane16_swap_b32 v52, v54
    s_nop 0
    v_permlane16_swap_b32 v60, v62
    v_add_f32 v52, v52, v54
    v_add_f32 v60, v60, v62
    s_nop 0
    v_add_f32 v52, v52, v52 row_ror:4 row_mask:0xf bank_mask:0xf
    v_add_f32 v60, v60, v60 row_ror:4 row_mask:0xf bank_mask:0xf
    s_nop 0
    v_add_f32 v52, v52, v52 row_ror:8 row_mask:0xf bank_mask:0xf
    v_add_f32 v60, v60, v60 row_ror:8 row_mask:0xf bank_mask:0xf
    v_cvt_pk_bf16_f32 v52, v52, v52
    v_lshlrev_b32 v52, 16, v52
    v_cvt_pk_bf16_f32 v60, v60, v60
    v_lshlrev_b32 v60, 16, v60
    v_mul_f32 v53, 0xbfb8aa3b, v52
    v_exp_f32 v53, v53
    s_nop 0
    v_add_f32 v53, 1.0, v53
    v_rcp_f32 v53, v53
    s_nop 0
    v_mul_f32 v52, v52, v53
    v_cvt_pk_bf16_f32 v52, v52, v52
    v_lshlrev_b32 v52, 16, v52
    v_mul_f32 v52, v52, v60
    v_cvt_pk_bf16_f32 v52, v52, v52
    s_nop 1
    v_mov_b32 v80, v52 quad_perm:[0,0,0,0] row_mask:0xf bank_mask:0xf
    v_mov_b32 v81, v52 quad_perm:[1,1,1,1] row_mask:0xf bank_mask:0xf
    v_mov_b32 v82, v52 quad_perm:[2,2,2,2] row_mask:0xf bank_mask:0xf
    v_mov_b32 v83, v52 quad_perm:[3,3,3,3] row_mask:0xf bank_mask:0xf
    s_waitcnt lgkmcnt(0)
    v_and_b32 v92, v80, v88
    v_and_b32 v93, v80, v89
    v_and_b32 v94, v80, v90
    v_and_b32 v95, v80, v91
    s_nop 1
    v_mfma_f32_16x16x32_bf16 v[100:103], v[92:95], v[192:195], 0
    v_mfma_f32_16x16x32_bf16 v[104:107], v[92:95], v[196:199], 0
    v_and_b32 v96, v81, v88
    v_and_b32 v97, v81, v89
    v_and_b32 v98, v81, v90
    v_and_b32 v99, v81, v91
    s_nop 1
    v_mfma_f32_16x16x32_bf16 v[100:103], v[96:99], v[200:203], v[100:103]
    v_mfma_f32_16x16x32_bf16 v[104:107], v[96:99], v[204:207], v[104:107]
    v_and_b32 v92, v82, v88
    v_and_b32 v93, v82, v89
    v_and_b32 v94, v82, v90
    v_and_b32 v95, v82, v91
    s_nop 1
    v_mfma_f32_16x16x32_bf16 v[100:103], v[92:95], v[208:211], v[100:103]
    v_mfma_f32_16x16x32_bf16 v[104:107], v[92:95], v[212:215], v[104:107]
    v_and_b32 v96, v83, v88
    v_and_b32 v97, v83, v89
    v_and_b32 v98, v83, v90
    v_and_b32 v99, v83, v91
    s_nop 1
    v_mfma_f32_16x16x32_bf16 v[100:103], v[96:99], v[216:219], v[100:103]
    v_mfma_f32_16x16x32_bf16 v[104:107], v[96:99], v[220:223], v[104:107]
    v_and_b32 v5, 15, v1
    v_lshlrev_b32 v5, 5, v5
    v_bfe_u32 v6, v1, 4, 1
    v_lshl_add_u32 v5, v6, 4, v5
    v_lshrrev_b32 v6, 5, v1
    v_lshl_add_u32 v5, v6, 9, v5
    v_cmp_eq_u32 vcc, 0, v6
    s_lshl_b32 s3, s2, 12
    s_lshl_b32 s65, s38, 10
    s_add_u32 s3, s3, s65
    s_add_u32 s3, s3, 8388608
    v_cndmask_b32 v100, v104, v100, vcc
    v_cndmask_b32 v101, v105, v101, vcc
    v_cndmask_b32 v102, v106, v102, vcc
    v_cndmask_b32 v103, v107, v103, vcc
    v_mov_b32 v28, v18
    v_lshrrev_b32 v29, 8, v18
    v_lshrrev_b32 v30, 16, v18
    v_lshrrev_b32 v31, 24, v18
    v_mov_b32 v6, 0xff
    v_bfi_b32 v100, v6, v28, v100
    v_bfi_b32 v101, v6, v29, v101
    v_bfi_b32 v102, v6, v30, v102
    v_bfi_b32 v103, v6, v31, v103
    s_cmp_ge_u32 s2, 224
    s_cbranch_scc1 L_noy
    buffer_store_dwordx4 v[100:103], v5, s[12:15], s3 offen sc1
L_noy:
    s_lshl_b32 s3, s38, 7
    s_add_u32 s3, s3, 161280
    v_lshl_add_u32 v6, v249, 2, s3
    ds_read_b32 v112, v6 offset:0
    ds_read_b32 v120, v6 offset:512
    ds_read_b32 v114, v6 offset:32
    ds_read_b32 v122, v6 offset:544
    ds_read_b32 v116, v6 offset:64
    ds_read_b32 v124, v6 offset:576
    ds_read_b32 v118, v6 offset:96
    ds_read_b32 v126, v6 offset:608
    s_mul_i32 s3, s38, 4608
    s_add_u32 s3, s3, 131072
    v_mul_u32_u24 v6, 144, v249
    v_lshl_add_u32 v6, v250, 4, v6
    v_add_u32 v15, s3, v6
    s_mov_b32 s71, 0xbfb8aa3b
    s_waitcnt lgkmcnt(0)
    v_lshlrev_b32 v36, 16, v232
    v_and_b32 v37, 0xffff0000, v232
    v_lshlrev_b32 v38, 16, v233
    v_and_b32 v39, 0xffff0000, v233
    v_lshlrev_b32 v40, 16, v234
    v_and_b32 v41, 0xffff0000, v234
    v_lshlrev_b32 v42, 16, v235
    v_and_b32 v43, 0xffff0000, v235
    v_lshlrev_b32 v44, 16, v236
    v_and_b32 v45, 0xffff0000, v236
    v_lshlrev_b32 v46, 16, v237
    v_and_b32 v47, 0xffff0000, v237
    v_lshlrev_b32 v48, 16, v238
    v_and_b32 v49, 0xffff0000, v238
    v_lshlrev_b32 v50, 16, v239
    v_and_b32 v51, 0xffff0000, v239
    v_lshlrev_b32 v52, 16, v240
    v_and_b32 v53, 0xffff0000, v240
    v_lshlrev_b32 v54, 16, v241
    v_and_b32 v55, 0xffff0000, v241
    v_lshlrev_b32 v56, 16, v242
    v_and_b32 v57, 0xffff0000, v242
    v_lshlrev_b32 v58, 16, v243
    v_and_b32 v59, 0xffff0000, v243
    v_lshlrev_b32 v60, 16, v244
    v_and_b32 v61, 0xffff0000, v244
    v_lshlrev_b32 v62, 16, v245
    v_and_b32 v63, 0xffff0000, v245
    v_lshlrev_b32 v64, 16, v246
    v_and_b32 v65, 0xffff0000, v246
    v_lshlrev_b32 v66, 16, v247
    v_and_b32 v67, 0xffff0000, v247
    v_pk_add_f32 v[68:69], v[36:37], v[112:113] op_sel_hi:[1,0] neg_lo:[0,1] neg_hi:[0,1]
    v_pk_add_f32 v[70:71], v[38:39], v[112:113] op_sel_hi:[1,0] neg_lo:[0,1] neg_hi:[0,1]
    v_pk_add_f32 v[72:73], v[40:41], v[112:113] op_sel_hi:[1,0] neg_lo:[0,1] neg_hi:[0,1]
    v_pk_add_f32 v[74:75], v[42:43], v[112:113] op_sel_hi:[1,0] neg_lo:[0,1] neg_hi:[0,1]
    v_pk_add_f32 v[76:77], v[44:45], v[114:115] op_sel_hi:[1,0] neg_lo:[0,1] neg_hi:[0,1]
    v_pk_add_f32 v[78:79], v[46:47], v[114:115] op_sel_hi:[1,0] neg_lo:[0,1] neg_hi:[0,1]
    v_pk_add_f32 v[80:81], v[48:49], v[114:115] op_sel_hi:[1,0] neg_lo:[0,1] neg_hi:[0,1]
    v_pk_add_f32 v[82:83], v[50:51], v[114:115] op_sel_hi:[1,0] neg_lo:[0,1] neg_hi:[0,1]
    v_pk_add_f32 v[84:85], v[52:53], v[116:117] op_sel_hi:[1,0] neg_lo:[0,1] neg_hi:[0,1]
    v_pk_add_f32 v[86:87], v[54:55], v[116:117] op_sel_hi:[1,0] neg_lo:[0,1] neg_hi:[0,1]
    v_pk_add_f32 v[88:89], v[56:57], v[116:117] op_sel_hi:[1,0] neg_lo:[0,1] neg_hi:[0,1]
    v_pk_add_f32 v[90:91], v[58:59], v[116:117] op_sel_hi:[1,0] neg_lo:[0,1] neg_hi:[0,1]
    v_pk_add_f32 v[92:93], v[60:61], v[118:119] op_sel_hi:[1,0] neg_lo:[0,1] neg_hi:[0,1]
    v_pk_add_f32 v[94:95], v[62:63], v[118:119] op_sel_hi:[1,0] neg_lo:[0,1] neg_hi:[0,1]
    v_pk_add_f32 v[96:97], v[64:65], v[118:119] op_sel_hi:[1,0] neg_lo:[0,1] neg_hi:[0,1]
    v_pk_add_f32 v[98:99], v[66:67], v[118:119] op_sel_hi:[1,0] neg_lo:[0,1] neg_hi:[0,1]
    v_cvt_pk_bf16_f32 v192, v68, v69
    v_cvt_pk_bf16_f32 v193, v70, v71
    v_cvt_pk_bf16_f32 v194, v72, v73
    v_cvt_pk_bf16_f32 v195, v74, v75
    v_cvt_pk_bf16_f32 v196, v76, v77
    v_cvt_pk_bf16_f32 v197, v78, v79
    v_cvt_pk_bf16_f32 v198, v80, v81
    v_cvt_pk_bf16_f32 v199, v82, v83
    v_cvt_pk_bf16_f32 v200, v84, v85
    v_cvt_pk_bf16_f32 v201, v86, v87
    v_cvt_pk_bf16_f32 v202, v88, v89
    v_cvt_pk_bf16_f32 v203, v90, v91
    v_cvt_pk_bf16_f32 v204, v92, v93
    v_cvt_pk_bf16_f32 v205, v94, v95
    v_cvt_pk_bf16_f32 v206, v96, v97
    v_cvt_pk_bf16_f32 v207, v98, v99
    v_lshlrev_b32 v68, 16, v192
    v_and_b32 v69, 0xffff0000, v192
    v_lshlrev_b32 v70, 16, v193
    v_and_b32 v71, 0xffff0000, v193
    v_lshlrev_b32 v72, 16, v194
    v_and_b32 v73, 0xffff0000, v194
    v_lshlrev_b32 v74, 16, v195
    v_and_b32 v75, 0xffff0000, v195
    v_lshlrev_b32 v76, 16, v196
    v_and_b32 v77, 0xffff0000, v196
    v_lshlrev_b32 v78, 16, v197
    v_and_b32 v79, 0xffff0000, v197
    v_lshlrev_b32 v80, 16, v198
    v_and_b32 v81, 0xffff0000, v198
    v_lshlrev_b32 v82, 16, v199
    v_and_b32 v83, 0xffff0000, v199
    v_lshlrev_b32 v84, 16, v200
    v_and_b32 v85, 0xffff0000, v200
    v_lshlrev_b32 v86, 16, v201
    v_and_b32 v87, 0xffff0000, v201
    v_lshlrev_b32 v88, 16, v202
    v_and_b32 v89, 0xffff0000, v202
    v_lshlrev_b32 v90, 16, v203
    v_and_b32 v91, 0xffff0000, v203
    v_lshlrev_b32 v92, 16, v204
    v_and_b32 v93, 0xffff0000, v204
    v_lshlrev_b32 v94, 16, v205
    v_and_b32 v95, 0xffff0000, v205
    v_lshlrev_b32 v96, 16, v206
    v_and_b32 v97, 0xffff0000, v206
    v_lshlrev_b32 v98, 16, v207
    v_and_b32 v99, 0xffff0000, v207
    v_pk_mul_f32 v[68:69], v[68:69], v[120:121] op_sel_hi:[1,0]
    v_pk_mul_f32 v[70:71], v[70:71], v[120:121] op_sel_hi:[1,0]
    v_pk_mul_f32 v[72:73], v[72:73], v[120:121] op_sel_hi:[1,0]
    v_pk_mul_f32 v[74:75], v[74:75], v[120:121] op_sel_hi:[1,0]
    v_pk_mul_f32 v[76:77], v[76:77], v[122:123] op_sel_hi:[1,0]
    v_pk_mul_f32 v[78:79], v[78:79], v[122:123] op_sel_hi:[1,0]
    v_pk_mul_f32 v[80:81], v[80:81], v[122:123] op_sel_hi:[1,0]
    v_pk_mul_f32 v[82:83], v[82:83], v[122:123] op_sel_hi:[1,0]
    v_pk_mul_f32 v[84:85], v[84:85], v[124:125] op_sel_hi:[1,0]
    v_pk_mul_f32 v[86:87], v[86:87], v[124:125] op_sel_hi:[1,0]
    v_pk_mul_f32 v[88:89], v[88:89], v[124:125] op_sel_hi:[1,0]
    v_pk_mul_f32 v[90:91], v[90:91], v[124:125] op_sel_hi:[1,0]
    v_pk_mul_f32 v[92:93], v[92:93], v[126:127] op_sel_hi:[1,0]
    v_pk_mul_f32 v[94:95], v[94:95], v[126:127] op_sel_hi:[1,0]
    v_pk_mul_f32 v[96:97], v[96:97], v[126:127] op_sel_hi:[1,0]
    v_pk_mul_f32 v[98:99], v[98:99], v[126:127] op_sel_hi:[1,0]
    v_cvt_pk_bf16_f32 v192, v68, v69
    v_cvt_pk_bf16_f32 v193, v70, v71
    v_cvt_pk_bf16_f32 v194, v72, v73
    v_cvt_pk_bf16_f32 v195, v74, v75
    v_cvt_pk_bf16_f32 v196, v76, v77
    v_cvt_pk_bf16_f32 v197, v78, v79
    v_cvt_pk_bf16_f32 v198, v80, v81
    v_cvt_pk_bf16_f32 v199, v82, v83
    v_cvt_pk_bf16_f32 v200, v84, v85
    v_cvt_pk_bf16_f32 v201, v86, v87
    v_cvt_pk_bf16_f32 v202, v88, v89
    v_cvt_pk_bf16_f32 v203, v90, v91
    v_cvt_pk_bf16_f32 v204, v92, v93
    v_cvt_pk_bf16_f32 v205, v94, v95
    v_cvt_pk_bf16_f32 v206, v96, v97
    v_cvt_pk_bf16_f32 v207, v98, v99
    v_lshlrev_b32 v68, 16, v192
    v_and_b32 v69, 0xffff0000, v192
    v_lshlrev_b32 v70, 16, v193
    v_and_b32 v71, 0xffff0000, v193
    v_lshlrev_b32 v72, 16, v194
    v_and_b32 v73, 0xffff0000, v194
    v_lshlrev_b32 v74, 16, v195
    v_and_b32 v75, 0xffff0000, v195
    v_lshlrev_b32 v76, 16, v196
    v_and_b32 v77, 0xffff0000, v196
    v_lshlrev_b32 v78, 16, v197
    v_and_b32 v79, 0xffff0000, v197
    v_lshlrev_b32 v80, 16, v198
    v_and_b32 v81, 0xffff0000, v198
    v_lshlrev_b32 v82, 16, v199
    v_and_b32 v83, 0xffff0000, v199
    v_lshlrev_b32 v84, 16, v200
    v_and_b32 v85, 0xffff0000, v200
    v_lshlrev_b32 v86, 16, v201
    v_and_b32 v87, 0xffff0000, v201
    v_lshlrev_b32 v88, 16, v202
    v_and_b32 v89, 0xffff0000, v202
    v_lshlrev_b32 v90, 16, v203
    v_and_b32 v91, 0xffff0000, v203
    v_lshlrev_b32 v92, 16, v204
    v_and_b32 v93, 0xffff0000, v204
    v_lshlrev_b32 v94, 16, v205
    v_and_b32 v95, 0xffff0000, v205
    v_lshlrev_b32 v96, 16, v206
    v_and_b32 v97, 0xffff0000, v206
    v_lshlrev_b32 v98, 16, v207
    v_and_b32 v99, 0xffff0000, v207
    v_mul_f32 v192, s71, v68
    v_mul_f32 v193, s71, v69
    v_mul_f32 v194, s71, v70
    v_mul_f32 v195, s71, v71
    v_mul_f32 v196, s71, v72
    v_mul_f32 v197, s71, v73
    v_mul_f32 v198, s71, v74
    v_mul_f32 v199, s71, v75
    v_mul_f32 v200, s71, v76
    v_mul_f32 v201, s71, v77
    v_mul_f32 v202, s71, v78
    v_mul_f32 v203, s71, v79
    v_mul_f32 v204, s71, v80
    v_mul_f32 v205, s71, v81
    v_mul_f32 v206, s71, v82
    v_mul_f32 v207, s71, v83
    v_mul_f32 v208, s71, v84
    v_mul_f32 v209, s71, v85
    v_mul_f32 v210, s71, v86
    v_mul_f32 v211, s71, v87
    v_mul_f32 v212, s71, v88
    v_mul_f32 v213, s71, v89
    v_mul_f32 v214, s71, v90
    v_mul_f32 v215, s71, v91
    v_mul_f32 v216, s71, v92
    v_mul_f32 v217, s71, v93
    v_mul_f32 v218, s71, v94
    v_mul_f32 v219, s71, v95
    v_mul_f32 v220, s71, v96
    v_mul_f32 v221, s71, v97
    v_mul_f32 v222, s71, v98
    v_mul_f32 v223, s71, v99
    v_exp_f32 v192, v192
    v_exp_f32 v193, v193
    v_exp_f32 v194, v194
    v_exp_f32 v195, v195
    v_exp_f32 v196, v196
    v_exp_f32 v197, v197
    v_exp_f32 v198, v198
    v_exp_f32 v199, v199
    v_exp_f32 v200, v200
    v_exp_f32 v201, v201
    v_exp_f32 v202, v202
    v_exp_f32 v203, v203
    v_exp_f32 v204, v204
    v_exp_f32 v205, v205
    v_exp_f32 v206, v206
    v_exp_f32 v207, v207
    v_exp_f32 v208, v208
    v_exp_f32 v209, v209
    v_exp_f32 v210, v210
    v_exp_f32 v211, v211
    v_exp_f32 v212, v212
    v_exp_f32 v213, v213
    v_exp_f32 v214, v214
    v_exp_f32 v215, v215
    v_exp_f32 v216, v216
    v_exp_f32 v217, v217
    v_exp_f32 v218, v218
    v_exp_f32 v219, v219
    v_exp_f32 v220, v220
    v_exp_f32 v221, v221
    v_exp_f32 v222, v222
    v_exp_f32 v223, v223
    v_add_f32 v192, 1.0, v192
    v_add_f32 v193, 1.0, v193
    v_add_f32 v194, 1.0, v194
    v_add_f32 v195, 1.0, v195
    v_add_f32 v196, 1.0, v196
    v_add_f32 v197, 1.0, v197
    v_add_f32 v198, 1.0, v198
    v_add_f32 v199, 1.0, v199
    v_add_f32 v200, 1.0, v200
    v_add_f32 v201, 1.0, v201
    v_add_f32 v202, 1.0, v202
    v_add_f32 v203, 1.0, v203
    v_add_f32 v204, 1.0, v204
    v_add_f32 v205, 1.0, v205
    v_add_f32 v206, 1.0, v206
    v_add_f32 v207, 1.0, v207
    v_add_f32 v208, 1.0, v208
    v_add_f32 v209, 1.0, v209
    v_add_f32 v210, 1.0, v210
    v_add_f32 v211, 1.0, v211
    v_add_f32 v212, 1.0, v212
    v_add_f32 v213, 1.0, v213
    v_add_f32 v214, 1.0, v214
    v_add_f32 v215, 1.0, v215
    v_add_f32 v216, 1.0, v216
    v_add_f32 v217, 1.0, v217
    v_add_f32 v218, 1.0, v218
    v_add_f32 v219, 1.0, v219
    v_add_f32 v220, 1.0, v220
    v_add_f32 v221, 1.0, v221
    v_add_f32 v222, 1.0, v222
    v_add_f32 v223, 1.0, v223
    v_rcp_f32 v192, v192
    v_rcp_f32 v193, v193
    v_rcp_f32 v194, v194
    v_rcp_f32 v195, v195
    v_rcp_f32 v196, v196
    v_rcp_f32 v197, v197
    v_rcp_f32 v198, v198
    v_rcp_f32 v199, v199
    v_rcp_f32 v200, v200
    v_rcp_f32 v201, v201
    v_rcp_f32 v202, v202
    v_rcp_f32 v203, v203
    v_rcp_f32 v204, v204
    v_rcp_f32 v205, v205
    v_rcp_f32 v206, v206
    v_rcp_f32 v207, v207
    v_rcp_f32 v208, v208
    v_rcp_f32 v209, v209
    v_rcp_f32 v210, v210
    v_rcp_f32 v211, v211
    v_rcp_f32 v212, v212
    v_rcp_f32 v213, v213
    v_rcp_f32 v214, v214
    v_rcp_f32 v215, v215
    v_rcp_f32 v216, v216
    v_rcp_f32 v217, v217
    v_rcp_f32 v218, v218
    v_rcp_f32 v219, v219
    v_rcp_f32 v220, v220
    v_rcp_f32 v221, v221
    v_rcp_f32 v222, v222
    v_rcp_f32 v223, v223
    v_pk_mul_f32 v[68:69], v[68:69], v[192:193]
    v_pk_mul_f32 v[70:71], v[70:71], v[194:195]
    v_pk_mul_f32 v[72:73], v[72:73], v[196:197]
    v_pk_mul_f32 v[74:75], v[74:75], v[198:199]
    v_pk_mul_f32 v[76:77], v[76:77], v[200:201]
    v_pk_mul_f32 v[78:79], v[78:79], v[202:203]
    v_pk_mul_f32 v[80:81], v[80:81], v[204:205]
    v_pk_mul_f32 v[82:83], v[82:83], v[206:207]
    v_pk_mul_f32 v[84:85], v[84:85], v[208:209]
    v_pk_mul_f32 v[86:87], v[86:87], v[210:211]
    v_pk_mul_f32 v[88:89], v[88:89], v[212:213]
    v_pk_mul_f32 v[90:91], v[90:91], v[214:215]
    v_pk_mul_f32 v[92:93], v[92:93], v[216:217]
    v_pk_mul_f32 v[94:95], v[94:95], v[218:219]
    v_pk_mul_f32 v[96:97], v[96:97], v[220:221]
    v_pk_mul_f32 v[98:99], v[98:99], v[222:223]
    s_cmp_eq_u32 s35, 0
    s_cbranch_scc1 L_fin
    s_lshl_b32 s65, s38, 2
    v_lshrrev_b32 v5, 4, v1
    v_add_u32 v5, s65, v5
    v_lshlrev_b32 v5, 12, v5
    v_and_b32 v6, 15, v1
    v_lshl_add_u32 v11, v6, 4, v5
    v_mov_b32 v5, 163104
L_yg:
    ds_read_b32 v6, v5 offset:96
    s_waitcnt lgkmcnt(0)
    v_readfirstlane_b32 s3, v6
    s_nop 0
    s_cmp_eq_u32 s3, 4
    s_cbranch_scc1 L_ygd
    s_sleep 2
    s_branch L_yg
L_ygd:
    s_sleep 10
    s_lshl_b32 s3, s31, 8
    s_add_u32 s3, s3, 8388608
    buffer_load_dwordx4 v[128:131], v11, s[12:15], s3 offen sc1
    s_add_u32 s3, s3, 65536
    buffer_load_dwordx4 v[132:135], v11, s[12:15], s3 offen sc1
    s_add_u32 s3, s3, 65536
    buffer_load_dwordx4 v[136:139], v11, s[12:15], s3 offen sc1
    s_add_u32 s3, s3, 65536
    buffer_load_dwordx4 v[140:143], v11, s[12:15], s3 offen sc1
    s_add_u32 s3, s3, 65536
    buffer_load_dwordx4 v[144:147], v11, s[12:15], s3 offen sc1
    s_add_u32 s3, s3, 65536
    buffer_load_dwordx4 v[148:151], v11, s[12:15], s3 offen sc1
    s_add_u32 s3, s3, 65536
    buffer_load_dwordx4 v[152:155], v11, s[12:15], s3 offen sc1
    s_add_u32 s3, s3, 65536
    buffer_load_dwordx4 v[156:159], v11, s[12:15], s3 offen sc1
    s_add_u32 s3, s3, 65536
    buffer_load_dwordx4 v[160:163], v11, s[12:15], s3 offen sc1
    s_add_u32 s3, s3, 65536
    buffer_load_dwordx4 v[164:167], v11, s[12:15], s3 offen sc1
    s_add_u32 s3, s3, 65536
    buffer_load_dwordx4 v[168:171], v11, s[12:15], s3 offen sc1
    s_add_u32 s3, s3, 65536
    buffer_load_dwordx4 v[172:175], v11, s[12:15], s3 offen sc1
    s_add_u32 s3, s3, 65536
    buffer_load_dwordx4 v[176:179], v11, s[12:15], s3 offen sc1
    s_add_u32 s3, s3, 65536
    buffer_load_dwordx4 v[180:183], v11, s[12:15], s3 offen sc1
    s_lshl_b32 s68, s34, 11
    s_lshl_b32 s3, s31, 7
    s_add_u32 s68, s68, s3
    v_lshlrev_b32 v7, 1, v1
    buffer_load_ushort v8, v7, s[4:7], s68 offen
    s_and_b32 s3, s33, 0xfffff800
    s_xor_b32 s65, s3, 0x80000000
    s_not_b32 s66, s3
    s_and_b32 s66, s66, 0xfffff800
    s_bitcmp1_b32 s3, 31
    s_cselect_b32 s3, s65, s66
    v_mov_b32 v5, s3
    v_cvt_pk_bf16_f32 v5, v5, v5
    v_lshlrev_b32 v5, 16, v5
    v_mul_f32 v5, 0xbfb8aa3b, v5
    v_exp_f32 v5, v5
    s_nop 0
    v_add_f32 v5, 1.0, v5
    v_rcp_f32 v5, v5
    s_nop 0
    v_cvt_pk_bf16_f32 v5, v5, v5
    v_lshlrev_b32 v5, 16, v5
    s_lshl_b32 s65, s64, 16
    s_and_b32 s66, s64, 0xffff0000
    v_rcp_f32 v10, s66
    s_nop 0
    v_fma_f32 v4, -v10, s66, 1.0
    v_fmac_f32 v10, v4, v10
    s_waitcnt vmcnt(0)
L_yf:
    v_and_b32 v184, v128, v132
    v_or_b32 v188, v128, v132
    v_and_b32 v185, v129, v133
    v_or_b32 v189, v129, v133
    v_and_b32 v186, v130, v134
    v_or_b32 v190, v130, v134
    v_and_b32 v187, v131, v135
    v_or_b32 v191, v131, v135
    v_bitop3_b32 v184, v184, v136, v140 bitop3:0x80
    v_or3_b32 v188, v188, v136, v140
    v_bitop3_b32 v185, v185, v137, v141 bitop3:0x80
    v_or3_b32 v189, v189, v137, v141
    v_bitop3_b32 v186, v186, v138, v142 bitop3:0x80
    v_or3_b32 v190, v190, v138, v142
    v_bitop3_b32 v187, v187, v139, v143 bitop3:0x80
    v_or3_b32 v191, v191, v139, v143
    v_bitop3_b32 v184, v184, v144, v148 bitop3:0x80
    v_or3_b32 v188, v188, v144, v148
    v_bitop3_b32 v185, v185, v145, v149 bitop3:0x80
    v_or3_b32 v189, v189, v145, v149
    v_bitop3_b32 v186, v186, v146, v150 bitop3:0x80
    v_or3_b32 v190, v190, v146, v150
    v_bitop3_b32 v187, v187, v147, v151 bitop3:0x80
    v_or3_b32 v191, v191, v147, v151
    v_bitop3_b32 v184, v184, v152, v156 bitop3:0x80
    v_or3_b32 v188, v188, v152, v156
    v_bitop3_b32 v185, v185, v153, v157 bitop3:0x80
    v_or3_b32 v189, v189, v153, v157
    v_bitop3_b32 v186, v186, v154, v158 bitop3:0x80
    v_or3_b32 v190, v190, v154, v158
    v_bitop3_b32 v187, v187, v155, v159 bitop3:0x80
    v_or3_b32 v191, v191, v155, v159
    v_bitop3_b32 v184, v184, v160, v164 bitop3:0x80
    v_or3_b32 v188, v188, v160, v164
    v_bitop3_b32 v185, v185, v161, v165 bitop3:0x80
    v_or3_b32 v189, v189, v161, v165
    v_bitop3_b32 v186, v186, v162, v166 bitop3:0x80
    v_or3_b32 v190, v190, v162, v166
    v_bitop3_b32 v187, v187, v163, v167 bitop3:0x80
    v_or3_b32 v191, v191, v163, v167
    v_bitop3_b32 v184, v184, v168, v172 bitop3:0x80
    v_or3_b32 v188, v188, v168, v172
    v_bitop3_b32 v185, v185, v169, v173 bitop3:0x80
    v_or3_b32 v189, v189, v169, v173
    v_bitop3_b32 v186, v186, v170, v174 bitop3:0x80
    v_or3_b32 v190, v190, v170, v174
    v_bitop3_b32 v187, v187, v171, v175 bitop3:0x80
    v_or3_b32 v191, v191, v171, v175
    v_bitop3_b32 v184, v184, v176, v180 bitop3:0x80
    v_or3_b32 v188, v188, v176, v180
    v_bitop3_b32 v185, v185, v177, v181 bitop3:0x80
    v_or3_b32 v189, v189, v177, v181
    v_bitop3_b32 v186, v186, v178, v182 bitop3:0x80
    v_or3_b32 v190, v190, v178, v182
    v_bitop3_b32 v187, v187, v179, v183 bitop3:0x80
    v_or3_b32 v191, v191, v179, v183
    v_xor_b32 v184, v184, v28
    v_xor_b32 v188, v188, v28
    v_xor_b32 v185, v185, v29
    v_xor_b32 v189, v189, v29
    v_xor_b32 v186, v186, v30
    v_xor_b32 v190, v190, v30
    v_xor_b32 v187, v187, v31
    v_xor_b32 v191, v191, v31
    v_or3_b32 v6, v184, v185, v186
    v_or3_b32 v6, v6, v187, v188
    v_or3_b32 v6, v6, v189, v190
    v_or_b32 v6, v6, v191
    v_and_b32 v6, 0xff, v6
    v_cmp_ne_u32 vcc, 0, v6
    s_nop 0
    s_cmp_eq_u64 vcc, 0
    s_cbranch_scc1 L_yfok
    s_add_u32 s70, s70, 1
    s_cmp_ge_u32 s70, 200000
    s_cbranch_scc1 L_yfok
    s_sleep 16
    s_lshl_b32 s3, s31, 8
    s_add_u32 s3, s3, 8388608
    buffer_load_dwordx4 v[128:131], v11, s[12:15], s3 offen sc1
    s_add_u32 s3, s3, 65536
    buffer_load_dwordx4 v[132:135], v11, s[12:15], s3 offen sc1
    s_add_u32 s3, s3, 65536
    buffer_load_dwordx4 v[136:139], v11, s[12:15], s3 offen sc1
    s_add_u32 s3, s3, 65536
    buffer_load_dwordx4 v[140:143], v11, s[12:15], s3 offen sc1
    s_add_u32 s3, s3, 65536
    buffer_load_dwordx4 v[144:147], v11, s[12:15], s3 offen sc1
    s_add_u32 s3, s3, 65536
    buffer_load_dwordx4 v[148:151], v11, s[12:15], s3 offen sc1
    s_add_u32 s3, s3, 65536
    buffer_load_dwordx4 v[152:155], v11, s[12:15], s3 offen sc1
    s_add_u32 s3, s3, 65536
    buffer_load_dwordx4 v[156:159], v11, s[12:15], s3 offen sc1
    s_add_u32 s3, s3, 65536
    buffer_load_dwordx4 v[160:163], v11, s[12:15], s3 offen sc1
    s_add_u32 s3, s3, 65536
    buffer_load_dwordx4 v[164:167], v11, s[12:15], s3 offen sc1
    s_add_u32 s3, s3, 65536
    buffer_load_dwordx4 v[168:171], v11, s[12:15], s3 offen sc1
    s_add_u32 s3, s3, 65536
    buffer_load_dwordx4 v[172:175], v11, s[12:15], s3 offen sc1
    s_add_u32 s3, s3, 65536
    buffer_load_dwordx4 v[176:179], v11, s[12:15], s3 offen sc1
    s_add_u32 s3, s3, 65536
    buffer_load_dwordx4 v[180:183], v11, s[12:15], s3 offen sc1
    s_waitcnt vmcnt(0)
    s_branch L_yf
L_yfok:
    v_and_b32 v6, 15, v1
    s_mov_b32 s3, 0xffffff00
    v_and_b32 v128, s3, v128
    v_and_b32 v129, s3, v129
    v_and_b32 v130, s3, v130
    v_and_b32 v131, s3, v131
    v_and_b32 v132, s3, v132
    v_and_b32 v133, s3, v133
    v_and_b32 v134, s3, v134
    v_and_b32 v135, s3, v135
    v_and_b32 v136, s3, v136
    v_and_b32 v137, s3, v137
    v_and_b32 v138, s3, v138
    v_and_b32 v139, s3, v139
    v_and_b32 v140, s3, v140
    v_and_b32 v141, s3, v141
    v_and_b32 v142, s3, v142
    v_and_b32 v143, s3, v143
    v_and_b32 v144, s3, v144
    v_and_b32 v145, s3, v145
    v_and_b32 v146, s3, v146
    v_and_b32 v147, s3, v147
    v_and_b32 v148, s3, v148
    v_and_b32 v149, s3, v149
    v_and_b32 v150, s3, v150
    v_and_b32 v151, s3, v151
    v_and_b32 v152, s3, v152
    v_and_b32 v153, s3, v153
    v_and_b32 v154, s3, v154
    v_and_b32 v155, s3, v155
    v_and_b32 v156, s3, v156
    v_and_b32 v157, s3, v157
    v_and_b32 v158, s3, v158
    v_and_b32 v159, s3, v159
    v_and_b32 v160, s3, v160
    v_and_b32 v161, s3, v161
    v_and_b32 v162, s3, v162
    v_and_b32 v163, s3, v163
    v_and_b32 v164, s3, v164
    v_and_b32 v165, s3, v165
    v_and_b32 v166, s3, v166
    v_and_b32 v167, s3, v167
    v_and_b32 v168, s3, v168
    v_and_b32 v169, s3, v169
    v_and_b32 v170, s3, v170
    v_and_b32 v171, s3, v171
    v_and_b32 v172, s3, v172
    v_and_b32 v173, s3, v173
    v_and_b32 v174, s3, v174
    v_and_b32 v175, s3, v175
    v_and_b32 v176, s3, v176
    v_and_b32 v177, s3, v177
    v_and_b32 v178, s3, v178
    v_and_b32 v179, s3, v179
    v_and_b32 v180, s3, v180
    v_and_b32 v181, s3, v181
    v_and_b32 v182, s3, v182
    v_and_b32 v183, s3, v183
    v_pk_add_f32 v[128:129], v[128:129], v[136:137]
    v_pk_add_f32 v[130:131], v[130:131], v[138:139]
    v_pk_add_f32 v[132:133], v[132:133], v[140:141]
    v_pk_add_f32 v[134:135], v[134:135], v[142:143]
    v_pk_add_f32 v[128:129], v[128:129], v[144:145]
    v_pk_add_f32 v[130:131], v[130:131], v[146:147]
    v_pk_add_f32 v[132:133], v[132:133], v[148:149]
    v_pk_add_f32 v[134:135], v[134:135], v[150:151]
    v_pk_add_f32 v[128:129], v[128:129], v[152:153]
    v_pk_add_f32 v[130:131], v[130:131], v[154:155]
    v_pk_add_f32 v[132:133], v[132:133], v[156:157]
    v_pk_add_f32 v[134:135], v[134:135], v[158:159]
    v_pk_add_f32 v[128:129], v[128:129], v[160:161]
    v_pk_add_f32 v[130:131], v[130:131], v[162:163]
    v_pk_add_f32 v[132:133], v[132:133], v[164:165]
    v_pk_add_f32 v[134:135], v[134:135], v[166:167]
    v_pk_add_f32 v[128:129], v[128:129], v[168:169]
    v_pk_add_f32 v[130:131], v[130:131], v[170:171]
    v_pk_add_f32 v[132:133], v[132:133], v[172:173]
    v_pk_add_f32 v[134:135], v[134:135], v[174:175]
    v_pk_add_f32 v[128:129], v[128:129], v[176:177]
    v_pk_add_f32 v[130:131], v[130:131], v[178:179]
    v_pk_add_f32 v[132:133], v[132:133], v[180:181]
    v_pk_add_f32 v[134:135], v[134:135], v[182:183]
    v_pk_add_f32 v[128:129], v[128:129], v[132:133]
    v_pk_add_f32 v[130:131], v[130:131], v[134:135]
    v_mov_b32 v132, v128
    v_mov_b32 v133, v129
    v_mov_b32 v134, v130
    v_mov_b32 v135, v131
    v_permlane16_swap_b32 v128, v132
    v_permlane16_swap_b32 v129, v133
    v_permlane16_swap_b32 v130, v134
    v_permlane16_swap_b32 v131, v135
    v_pk_add_f32 v[128:129], v[128:129], v[132:133]
    v_pk_add_f32 v[130:131], v[130:131], v[134:135]
    v_mov_b32 v132, v128
    v_mov_b32 v133, v129
    v_mov_b32 v134, v130
    v_mov_b32 v135, v131
    v_permlane32_swap_b32 v128, v132
    v_permlane32_swap_b32 v129, v133
    v_permlane32_swap_b32 v130, v134
    v_permlane32_swap_b32 v131, v135
    v_pk_add_f32 v[128:129], v[128:129], v[132:133]
    v_pk_add_f32 v[130:131], v[130:131], v[134:135]
    s_lshl_b32 s3, s38, 8
    s_add_u32 s3, s3, 157952
    v_lshl_add_u32 v6, v6, 4, s3
    ds_write_b128 v6, v[128:131]
    v_lshlrev_b32 v8, 16, v8
    v_subrev_f32 v9, s65, v8
    v_cvt_pk_bf16_f32 v9, v9, v9
    v_lshlrev_b32 v9, 16, v9
    v_mul_f32 v9, v9, v10
    v_cvt_pk_bf16_f32 v9, v9, v9
    v_lshlrev_b32 v9, 16, v9
    v_mov_b32 v16, v5
    s_lshl_b32 s3, s38, 2
    s_add_u32 s3, s3, 163168
    v_mov_b32 v5, s3
    v_mov_b32 v6, 1
    ds_write_b32 v5, v6
    v_mov_b32 v5, 163104
L_yr:
    ds_read_b128 v[20:23], v5 offset:64
    s_waitcnt lgkmcnt(0)
    v_and_b32 v20, v20, v21
    v_and_b32 v22, v22, v23
    v_and_b32 v20, v20, v22
    s_nop 0
    v_readfirstlane_b32 s3, v20
    s_nop 0
    s_cmp_eq_u32 s3, 1
    s_cbranch_scc1 L_yrd
    s_sleep 1
    s_branch L_yr
L_yrd:
    v_lshlrev_b32 v6, 2, v1
    v_add_u32 v6, 157952, v6
    ds_read_b32 v20, v6 offset:0
    ds_read_b32 v21, v6 offset:256
    ds_read_b32 v22, v6 offset:512
    ds_read_b32 v23, v6 offset:768
    s_bfe_u32 s3, s34, 0x20005
    s_and_b32 s65, s34, 7
    s_lshl_b32 s65, s65, 3
    s_lshl_b64 s[66:67], 0xff, s65
    s_bfe_u32 s65, s34, 0x20003
    s_cmp_lg_u32 s3, s38
    s_cbranch_scc1 L_fin
    s_waitcnt lgkmcnt(0)
    v_add_f32 v20, v20, v21
    v_add_f32 v22, v22, v23
    v_add_f32 v20, v20, v22
    v_cvt_pk_bf16_f32 v20, v20, v20
    v_lshlrev_b32 v20, 16, v20
    v_mul_f32 v20, v20, v16
    v_cvt_pk_bf16_f32 v20, v20, v20
    v_lshlrev_b32 v20, 16, v20
    v_add_f32 v20, v20, v9
    v_cvt_pk_bf16_f32 v20, v20, v20
    v_lshlrev_b32 v20, 16, v20
    v_mul_f32 v21, 0xbfb8aa3b, v20
    v_exp_f32 v21, v21
    s_nop 0
    v_add_f32 v21, 1.0, v21
    v_rcp_f32 v21, v21
    s_nop 0
    v_mul_f32 v20, v20, v21
    ds_write_b32 v6, v20 offset:1024
    v_lshlrev_b32 v6, 5, v250
    v_add_u32 v6, 158976, v6
    s_mov_b64 exec, s[66:67]
    s_cmp_lg_u32 s65, 0
    s_cbranch_scc1 L_gr0
    ds_read_b128 v[68:71], v6
    ds_read_b128 v[72:75], v6 offset:16
L_gr0:
    s_cmp_lg_u32 s65, 1
    s_cbranch_scc1 L_gr1
    ds_read_b128 v[76:79], v6
    ds_read_b128 v[80:83], v6 offset:16
L_gr1:
    s_cmp_lg_u32 s65, 2
    s_cbranch_scc1 L_gr2
    ds_read_b128 v[84:87], v6
    ds_read_b128 v[88:91], v6 offset:16
L_gr2:
    s_cmp_lg_u32 s65, 3
    s_cbranch_scc1 L_gr3
    ds_read_b128 v[92:95], v6
    ds_read_b128 v[96:99], v6 offset:16
L_gr3:
    s_mov_b64 exec, -1
L_fin:
    s_waitcnt lgkmcnt(0)
    s_barrier
    ds_read_b128 v[232:235], v15 offset:0
    ds_read_b128 v[236:239], v15 offset:1152
    ds_read_b128 v[240:243], v15 offset:2304
    ds_read_b128 v[244:247], v15 offset:3456
    s_waitcnt lgkmcnt(3)
    v_lshlrev_b32 v192, 16, v232
    v_and_b32 v193, 0xffff0000, v232
    v_lshlrev_b32 v194, 16, v233
    v_and_b32 v195, 0xffff0000, v233
    v_lshlrev_b32 v196, 16, v234
    v_and_b32 v197, 0xffff0000, v234
    v_lshlrev_b32 v198, 16, v235
    v_and_b32 v199, 0xffff0000, v235
    v_pk_fma_f32 v[36:37], v[192:193], v[68:69], v[36:37]
    v_pk_fma_f32 v[38:39], v[194:195], v[70:71], v[38:39]
    v_pk_fma_f32 v[40:41], v[196:197], v[72:73], v[40:41]
    v_pk_fma_f32 v[42:43], v[198:199], v[74:75], v[42:43]
    v_cvt_pk_bf16_f32 v232, v36, v37
    v_cvt_pk_bf16_f32 v233, v38, v39
    v_cvt_pk_bf16_f32 v234, v40, v41
    v_cvt_pk_bf16_f32 v235, v42, v43
    buffer_store_dwordx4 v[232:235], v248, s[24:27], 0 offen nt
    s_waitcnt lgkmcnt(2)
    v_lshlrev_b32 v200, 16, v236
    v_and_b32 v201, 0xffff0000, v236
    v_lshlrev_b32 v202, 16, v237
    v_and_b32 v203, 0xffff0000, v237
    v_lshlrev_b32 v204, 16, v238
    v_and_b32 v205, 0xffff0000, v238
    v_lshlrev_b32 v206, 16, v239
    v_and_b32 v207, 0xffff0000, v239
    v_pk_fma_f32 v[44:45], v[200:201], v[76:77], v[44:45]
    v_pk_fma_f32 v[46:47], v[202:203], v[78:79], v[46:47]
    v_pk_fma_f32 v[48:49], v[204:205], v[80:81], v[48:49]
    v_pk_fma_f32 v[50:51], v[206:207], v[82:83], v[50:51]
    v_cvt_pk_bf16_f32 v236, v44, v45
    v_cvt_pk_bf16_f32 v237, v46, v47
    v_cvt_pk_bf16_f32 v238, v48, v49
    v_cvt_pk_bf16_f32 v239, v50, v51
    buffer_store_dwordx4 v[236:239], v248, s[24:27], s48 offen nt
    s_waitcnt lgkmcnt(1)
    v_lshlrev_b32 v208, 16, v240
    v_and_b32 v209, 0xffff0000, v240
    v_lshlrev_b32 v210, 16, v241
    v_and_b32 v211, 0xffff0000, v241
    v_lshlrev_b32 v212, 16, v242
    v_and_b32 v213, 0xffff0000, v242
    v_lshlrev_b32 v214, 16, v243
    v_and_b32 v215, 0xffff0000, v243
    v_pk_fma_f32 v[52:53], v[208:209], v[84:85], v[52:53]
    v_pk_fma_f32 v[54:55], v[210:211], v[86:87], v[54:55]
    v_pk_fma_f32 v[56:57], v[212:213], v[88:89], v[56:57]
    v_pk_fma_f32 v[58:59], v[214:215], v[90:91], v[58:59]
    v_cvt_pk_bf16_f32 v240, v52, v53
    v_cvt_pk_bf16_f32 v241, v54, v55
    v_cvt_pk_bf16_f32 v242, v56, v57
    v_cvt_pk_bf16_f32 v243, v58, v59
    buffer_store_dwordx4 v[240:243], v248, s[24:27], s49 offen nt
    s_waitcnt lgkmcnt(0)
    v_lshlrev_b32 v216, 16, v244
    v_and_b32 v217, 0xffff0000, v244
    v_lshlrev_b32 v218, 16, v245
    v_and_b32 v219, 0xffff0000, v245
    v_lshlrev_b32 v220, 16, v246
    v_and_b32 v221, 0xffff0000, v246
    v_lshlrev_b32 v222, 16, v247
    v_and_b32 v223, 0xffff0000, v247
    v_pk_fma_f32 v[60:61], v[216:217], v[92:93], v[60:61]
    v_pk_fma_f32 v[62:63], v[218:219], v[94:95], v[62:63]
    v_pk_fma_f32 v[64:65], v[220:221], v[96:97], v[64:65]
    v_pk_fma_f32 v[66:67], v[222:223], v[98:99], v[66:67]
    v_cvt_pk_bf16_f32 v244, v60, v61
    v_cvt_pk_bf16_f32 v245, v62, v63
    v_cvt_pk_bf16_f32 v246, v64, v65
    v_cvt_pk_bf16_f32 v247, v66, v67
    buffer_store_dwordx4 v[244:247], v248, s[24:27], s100 offen nt
L_done:
    s_endpgm
L_g1:
    s_and_b32 s28, s38, 1
    s_lshr_b32 s29, s38, 1
    s_lshl_b32 s3, s36, 7
    s_lshl_b32 s65, s37, 3
    s_add_u32 s3, s3, s65
    s_lshl_b32 s65, s38, 1
    s_add_u32 s68, s3, s65
    s_lshl_b32 s3, s68, 11
    v_and_b32 v3, 31, v1
    v_lshlrev_b32 v3, 4, v3
    v_lshrrev_b32 v4, 5, v1
    v_lshl_add_u32 v5, v4, 11, v3
    s_waitcnt lgkmcnt(0)
    s_mov_b32 s4, s40
    s_mov_b32 s5, s41
    s_mov_b32 s6, 4194304
    s_mov_b32 s7, 0x00020000
    s_mov_b32 s16, s50
    s_mov_b32 s17, s51
    s_mov_b32 s18, 2048
    s_mov_b32 s19, 0x00020000
    v_mov_b32 v224, v5
    v_mov_b32 v225, v3
    s_mov_b32 s69, s3
    s_or_b32 s3, s2, s38
    s_cmp_lg_u32 s3, 0
    s_cbranch_scc1 L_nn
    s_mov_b32 s20, s60
    s_mov_b32 s21, s61
    s_mov_b32 s22, 256
    s_mov_b32 s23, 0x00020000
    s_memrealtime s[66:67]
    s_memtime s[70:71]
    s_waitcnt lgkmcnt(0)
    s_lshl_b32 s70, s70, 20
    s_xor_b32 s66, s66, s70
    s_or_b32 s66, s66, 1
    s_and_b32 s66, s66, 0xbfffbfff
    v_mov_b32 v6, s66
    v_mov_b32 v7, 0
    s_mov_b64 exec, 1
    buffer_store_dword v6, v7, s[20:23], 0 offen sc1
    s_mov_b64 exec, -1
L_nn:
    s_getpc_b64 s[66:67]
L_pc:
    s_sub_u32 s66, s66, L_pc-recurrent_scan__linear_kernel_hedgehog__moe_arch_mod__prompt_kernel
    s_subb_u32 s67, s67, 0
    s_lshr_b32 s3, s2, 3
    s_lshl_b32 s3, s3, 2
    s_add_u32 s3, s3, s38
    s_lshl_b32 s3, s3, 6
    s_add_u32 s66, s66, s3
    s_addc_u32 s67, s67, 0
    s_load_dword s71, s[66:67], 0
    s_load_dword s71, s[66:67], 8192
    s_load_dword s71, s[66:67], 16384
    s_load_dword s71, s[66:67], 24576
    s_load_dword s71, s[66:67], 32768
    s_load_dword s71, s[66:67], 40960
    s_mov_b32 s12, s62
    s_mov_b32 s13, s63
    s_mov_b32 s14, 268435456
    s_mov_b32 s15, 0x00020000
    s_mov_b32 s8, s42
    s_mov_b32 s9, s43
    s_mov_b32 s10, 6291456
    s_mov_b32 s11, 0x00020000
    s_mov_b32 s20, s44
    s_mov_b32 s21, s45
    s_mov_b32 s22, 65536
    s_mov_b32 s23, 0x00020000
    s_mov_b32 s24, s58
    s_mov_b32 s25, s59
    s_mov_b32 s26, 4194304
    s_mov_b32 s27, 0x00020000
    s_mov_b32 s80, s52
    s_mov_b32 s81, s53
    s_mov_b32 s82, 0
    s_mov_b32 s83, 0x00020000
    s_mov_b32 s84, s54
    s_mov_b32 s85, s55
    s_mov_b32 s86, 0
    s_mov_b32 s87, 0x00020000
    s_and_b32 s30, s2, 3
    s_lshl_b32 s30, s30, 2
    s_bfe_u32 s3, s2, 0x20003
    s_add_u32 s30, s30, s3
    s_bfe_u32 s31, s2, 0x10002
    s_lshl_b32 s31, s31, 3
    s_lshr_b32 s3, s2, 5
    s_add_u32 s31, s31, s3
    s_mov_b32 s70, 0
    v_and_b32 v3, 15, v1
    v_lshlrev_b32 v6, 7, v3
    s_lshl_b32 s3, s28, 13
    v_add_u32 v6, s3, v6
    v_lshrrev_b32 v3, 1, v3
    v_lshrrev_b32 v2, 4, v1
    v_xor_b32 v3, v3, v2
    v_lshl_add_u32 v168, v3, 4, v6
    v_xor_b32 v3, 4, v3
    v_lshl_add_u32 v169, v3, 4, v6
    v_lshlrev_b32 v6, 3, v2
    v_bfe_u32 v7, v1, 2, 2
    v_add_u32 v6, v6, v7
    v_lshlrev_b32 v6, 7, v6
    v_and_b32 v7, 3, v1
    v_lshl_add_u32 v6, v7, 3, v6
    v_bfe_u32 v7, v1, 3, 2
    s_lshl_b32 s3, s29, 1
    v_xor_b32 v7, s3, v7
    v_add_u32 v6, 65536, v6
    v_lshl_add_u32 v170, v7, 5, v6
    v_xor_b32 v7, 1, v7
    v_lshl_add_u32 v171, v7, 5, v6
    v_add_u32 v189, 65536, v170
    v_add_u32 v191, 65536, v171
    v_mov_b32 v190, v4
    s_lshl_b32 s3, s38, 2
    s_add_u32 s3, s3, 163152
    v_mov_b32 v249, s3
    v_mov_b32 v251, 163072
    v_and_b32 v3, 15, v1
    s_lshl_b32 s3, s28, 8
    s_add_u32 s3, s3, 159744
    v_lshl_add_u32 v240, v3, 2, s3
    v_lshl_add_u32 v241, v1, 2, s3
    v_lshl_add_u32 v242, v2, 4, s3
    s_lshl_b32 s3, s29, 7
    s_add_u32 s3, s3, 162304
    v_lshl_add_u32 v243, v2, 4, s3
    v_lshl_add_u32 v244, v3, 2, s3
    s_lshl_b32 s3, s28, 7
    s_add_u32 s72, s3, 160768
    v_lshl_add_u32 v245, v2, 3, s72
    s_xor_b32 s3, s3, 128
    s_add_u32 s72, s3, 160768
    v_lshl_add_u32 v247, v2, 3, s72
    v_lshrrev_b32 v6, 2, v1
    v_lshlrev_b32 v4, 6, v6
    v_and_b32 v7, 3, v1
    v_lshl_add_u32 v4, v7, 3, v4
    s_lshl_b32 s3, s29, 11
    s_add_u32 s3, s3, 155648
    v_add_u32 v246, s3, v4
    v_mul_u32_u24 v4, 136, v3
    v_lshl_add_u32 v4, v2, 3, v4
    v_mul_u32_u24 v6, 136, v6
    v_lshl_add_u32 v6, v7, 3, v6
    s_lshl_b32 s3, s28, 6
    v_add_u32 v6, s3, v6
    v_lshlrev_b32 v5, 4, v1
    s_mul_i32 s72, s38, 8704
    s_add_u32 s72, s72, 96256
    s_xor_b32 s3, s38, 1
    s_mul_i32 s73, s3, 8704
    s_add_u32 s73, s73, 96256
    s_lshl_b32 s74, s38, 12
    s_add_u32 s74, s74, 65536
    s_lshl_b32 s75, s3, 12
    s_add_u32 s75, s75, 65536
    s_lshl_b32 s76, s3, 2
    s_add_u32 s76, s76, 163184
    s_lshl_b32 s3, s37, 1
    s_add_u32 s3, s3, s29
    s_lshl_b32 s3, s3, 4
    s_add_u32 s3, s3, s36
    s_lshl_b32 s3, s3, 1
    s_add_u32 s3, s3, s28
    s_lshl_b32 s3, s3, 12
    s_add_u32 s77, s3, 2097152
    v_mov_b64 v[8:9], 0
    v_mov_b64 v[10:11], 0
    v_mov_b64 v[12:13], 0
    v_mov_b64 v[14:15], 0
    v_mov_b64 v[16:17], 0
    v_mov_b64 v[18:19], 0
    v_mov_b64 v[20:21], 0
    v_mov_b64 v[22:23], 0
    v_mov_b64 v[24:25], 0
    v_mov_b64 v[26:27], 0
    v_mov_b64 v[28:29], 0
    v_mov_b64 v[30:31], 0
    v_mov_b64 v[32:33], 0
    v_mov_b64 v[34:35], 0
    v_mov_b64 v[36:37], 0
    v_mov_b64 v[38:39], 0
    v_mov_b64 v[40:41], 0
    v_mov_b64 v[42:43], 0
    v_mov_b64 v[44:45], 0
    v_mov_b64 v[46:47], 0
    v_mov_b64 v[48:49], 0
    v_mov_b64 v[50:51], 0
    v_mov_b64 v[52:53], 0
    v_mov_b64 v[54:55], 0
    v_mov_b64 v[56:57], 0
    v_mov_b64 v[58:59], 0
    v_mov_b64 v[60:61], 0
    v_mov_b64 v[62:63], 0
    v_mov_b64 v[64:65], 0
    v_mov_b64 v[66:67], 0
    v_mov_b64 v[68:69], 0
    v_mov_b64 v[70:71], 0
    v_mov_b64 v[72:73], 0
    v_mov_b64 v[74:75], 0
    v_mov_b64 v[76:77], 0
    v_mov_b64 v[78:79], 0
    v_mov_b64 v[80:81], 0
    v_mov_b64 v[82:83], 0
    v_mov_b64 v[84:85], 0
    v_mov_b64 v[86:87], 0
    v_mov_b64 v[88:89], 0
    v_mov_b64 v[90:91], 0
    v_mov_b64 v[92:93], 0
    v_mov_b64 v[94:95], 0
    v_mov_b64 v[96:97], 0
    v_mov_b64 v[98:99], 0
    v_mov_b64 v[100:101], 0
    v_mov_b64 v[102:103], 0
    buffer_load_dwordx4 v[192:195], v224, s[4:7], s69 offen offset:0
    buffer_load_dwordx4 v[196:199], v224, s[4:7], s69 offen offset:512
    buffer_load_dwordx4 v[200:203], v224, s[4:7], s69 offen offset:1024
    buffer_load_dwordx4 v[204:207], v224, s[4:7], s69 offen offset:1536
    buffer_load_dwordx4 v[208:211], v225, s[16:19], 0 offen offset:0
    buffer_load_dwordx4 v[212:215], v225, s[16:19], 0 offen offset:512
    buffer_load_dwordx4 v[216:219], v225, s[16:19], 0 offen offset:1024
    buffer_load_dwordx4 v[220:223], v225, s[16:19], 0 offen offset:1536
L_c1:
    s_waitcnt lgkmcnt(0)
    s_barrier
    ds_read_b128 v[104:107], v168 offset:0
    ds_read_b64_tr_b16 v[120:121], v170 offset:0
    ds_read_b64_tr_b16 v[122:123], v170 offset:512
    ds_read_b64_tr_b16 v[124:125], v171 offset:0
    ds_read_b64_tr_b16 v[126:127], v171 offset:512
    ds_read_b128 v[108:111], v168 offset:2048
    ds_read_b64_tr_b16 v[128:129], v170 offset:8192
    ds_read_b64_tr_b16 v[130:131], v170 offset:8704
    ds_read_b64_tr_b16 v[132:133], v171 offset:8192
    ds_read_b64_tr_b16 v[134:135], v171 offset:8704
    ds_read_b64_tr_b16 v[172:173], v189 offset:0
    ds_read_b64_tr_b16 v[174:175], v189 offset:512
    s_waitcnt lgkmcnt(8)
    ds_read_b64_tr_b16 v[176:177], v191 offset:0
    ds_read_b64_tr_b16 v[178:179], v191 offset:512
    ds_read_b128 v[112:115], v168 offset:4096
    ds_read_b128 v[116:119], v168 offset:6144
    s_waitcnt lgkmcnt(0)
    v_mfma_f32_16x16x32_bf16 v[8:11], v[120:123], v[104:107], v[8:11]
    ds_read_b128 v[136:139], v169 offset:0
    v_mfma_f32_16x16x32_bf16 v[12:15], v[124:127], v[104:107], v[12:15]
    ds_read_b64_tr_b16 v[152:153], v170 offset:4096
    v_mfma_f32_16x16x32_bf16 v[16:19], v[104:107], v[128:131], v[16:19]
    ds_read_b64_tr_b16 v[154:155], v170 offset:4608
    v_mfma_f32_16x16x32_bf16 v[20:23], v[104:107], v[132:135], v[20:23]
    ds_read_b64_tr_b16 v[156:157], v171 offset:4096
    v_mfma_f32_16x16x32_bf16 v[72:75], v[172:175], v[104:107], v[72:75]
    ds_read_b64_tr_b16 v[158:159], v171 offset:4608
    v_mfma_f32_16x16x32_bf16 v[76:79], v[176:179], v[104:107], v[76:79]
    ds_read_b128 v[140:143], v169 offset:2048
    v_mfma_f32_16x16x32_bf16 v[24:27], v[120:123], v[108:111], v[24:27]
    ds_read_b64_tr_b16 v[160:161], v170 offset:12288
    v_mfma_f32_16x16x32_bf16 v[28:31], v[124:127], v[108:111], v[28:31]
    ds_read_b64_tr_b16 v[162:163], v170 offset:12800
    v_mfma_f32_16x16x32_bf16 v[32:35], v[108:111], v[128:131], v[32:35]
    ds_read_b64_tr_b16 v[164:165], v171 offset:12288
    v_mfma_f32_16x16x32_bf16 v[36:39], v[108:111], v[132:135], v[36:39]
    ds_read_b64_tr_b16 v[166:167], v171 offset:12800
    v_mfma_f32_16x16x32_bf16 v[80:83], v[172:175], v[108:111], v[80:83]
    ds_read_b64_tr_b16 v[180:181], v189 offset:4096
    v_mfma_f32_16x16x32_bf16 v[84:87], v[176:179], v[108:111], v[84:87]
    ds_read_b64_tr_b16 v[182:183], v189 offset:4608
    v_mfma_f32_16x16x32_bf16 v[40:43], v[120:123], v[112:115], v[40:43]
    ds_read_b64_tr_b16 v[184:185], v191 offset:4096
    v_mfma_f32_16x16x32_bf16 v[44:47], v[124:127], v[112:115], v[44:47]
    ds_read_b64_tr_b16 v[186:187], v191 offset:4608
    v_mfma_f32_16x16x32_bf16 v[48:51], v[112:115], v[128:131], v[48:51]
    ds_read_b128 v[144:147], v169 offset:4096
    v_mfma_f32_16x16x32_bf16 v[52:55], v[112:115], v[132:135], v[52:55]
    ds_read_b128 v[148:151], v169 offset:6144
    v_mfma_f32_16x16x32_bf16 v[88:91], v[172:175], v[112:115], v[88:91]
    v_mfma_f32_16x16x32_bf16 v[92:95], v[176:179], v[112:115], v[92:95]
    v_mfma_f32_16x16x32_bf16 v[56:59], v[120:123], v[116:119], v[56:59]
    v_mfma_f32_16x16x32_bf16 v[60:63], v[124:127], v[116:119], v[60:63]
    v_mfma_f32_16x16x32_bf16 v[64:67], v[116:119], v[128:131], v[64:67]
    v_mfma_f32_16x16x32_bf16 v[68:71], v[116:119], v[132:135], v[68:71]
    v_mfma_f32_16x16x32_bf16 v[96:99], v[172:175], v[116:119], v[96:99]
    v_mfma_f32_16x16x32_bf16 v[100:103], v[176:179], v[116:119], v[100:103]
    s_waitcnt lgkmcnt(0)
    s_barrier
    v_mfma_f32_16x16x32_bf16 v[8:11], v[152:155], v[136:139], v[8:11]
    ds_read_b128 v[104:107], v168 offset:16384
    v_mfma_f32_16x16x32_bf16 v[12:15], v[156:159], v[136:139], v[12:15]
    ds_read_b64_tr_b16 v[120:121], v170 offset:16384
    v_mfma_f32_16x16x32_bf16 v[16:19], v[136:139], v[160:163], v[16:19]
    ds_read_b64_tr_b16 v[122:123], v170 offset:16896
    v_mfma_f32_16x16x32_bf16 v[20:23], v[136:139], v[164:167], v[20:23]
    ds_read_b64_tr_b16 v[124:125], v171 offset:16384
    v_mfma_f32_16x16x32_bf16 v[72:75], v[180:183], v[136:139], v[72:75]
    ds_read_b64_tr_b16 v[126:127], v171 offset:16896
    v_mfma_f32_16x16x32_bf16 v[76:79], v[184:187], v[136:139], v[76:79]
    ds_read_b128 v[108:111], v168 offset:18432
    v_mfma_f32_16x16x32_bf16 v[24:27], v[152:155], v[140:143], v[24:27]
    ds_read_b64_tr_b16 v[128:129], v170 offset:24576
    v_mfma_f32_16x16x32_bf16 v[28:31], v[156:159], v[140:143], v[28:31]
    ds_read_b64_tr_b16 v[130:131], v170 offset:25088
    v_mfma_f32_16x16x32_bf16 v[32:35], v[140:143], v[160:163], v[32:35]
    ds_read_b64_tr_b16 v[132:133], v171 offset:24576
    v_mfma_f32_16x16x32_bf16 v[36:39], v[140:143], v[164:167], v[36:39]
    ds_read_b64_tr_b16 v[134:135], v171 offset:25088
    v_mfma_f32_16x16x32_bf16 v[80:83], v[180:183], v[140:143], v[80:83]
    ds_read_b64_tr_b16 v[172:173], v189 offset:8192
    v_mfma_f32_16x16x32_bf16 v[84:87], v[184:187], v[140:143], v[84:87]
    ds_read_b64_tr_b16 v[174:175], v189 offset:8704
    v_mfma_f32_16x16x32_bf16 v[40:43], v[152:155], v[144:147], v[40:43]
    ds_read_b64_tr_b16 v[176:177], v191 offset:8192
    v_mfma_f32_16x16x32_bf16 v[44:47], v[156:159], v[144:147], v[44:47]
    ds_read_b64_tr_b16 v[178:179], v191 offset:8704
    v_mfma_f32_16x16x32_bf16 v[48:51], v[144:147], v[160:163], v[48:51]
    ds_read_b128 v[112:115], v168 offset:20480
    v_mfma_f32_16x16x32_bf16 v[52:55], v[144:147], v[164:167], v[52:55]
    ds_read_b128 v[116:119], v168 offset:22528
    v_mfma_f32_16x16x32_bf16 v[88:91], v[180:183], v[144:147], v[88:91]
    v_mfma_f32_16x16x32_bf16 v[92:95], v[184:187], v[144:147], v[92:95]
    v_mfma_f32_16x16x32_bf16 v[56:59], v[152:155], v[148:151], v[56:59]
    v_mfma_f32_16x16x32_bf16 v[60:63], v[156:159], v[148:151], v[60:63]
    v_mfma_f32_16x16x32_bf16 v[64:67], v[148:151], v[160:163], v[64:67]
    v_mfma_f32_16x16x32_bf16 v[68:71], v[148:151], v[164:167], v[68:71]
    v_mfma_f32_16x16x32_bf16 v[96:99], v[180:183], v[148:151], v[96:99]
    v_mfma_f32_16x16x32_bf16 v[100:103], v[184:187], v[148:151], v[100:103]
    s_waitcnt lgkmcnt(0)
    v_mfma_f32_16x16x32_bf16 v[8:11], v[120:123], v[104:107], v[8:11]
    ds_read_b128 v[136:139], v169 offset:16384
    v_mfma_f32_16x16x32_bf16 v[12:15], v[124:127], v[104:107], v[12:15]
    ds_read_b64_tr_b16 v[152:153], v170 offset:20480
    v_mfma_f32_16x16x32_bf16 v[16:19], v[104:107], v[128:131], v[16:19]
    ds_read_b64_tr_b16 v[154:155], v170 offset:20992
    v_mfma_f32_16x16x32_bf16 v[20:23], v[104:107], v[132:135], v[20:23]
    ds_read_b64_tr_b16 v[156:157], v171 offset:20480
    v_mfma_f32_16x16x32_bf16 v[72:75], v[172:175], v[104:107], v[72:75]
    ds_read_b64_tr_b16 v[158:159], v171 offset:20992
    v_mfma_f32_16x16x32_bf16 v[76:79], v[176:179], v[104:107], v[76:79]
    ds_read_b128 v[140:143], v169 offset:18432
    v_mfma_f32_16x16x32_bf16 v[24:27], v[120:123], v[108:111], v[24:27]
    ds_read_b64_tr_b16 v[160:161], v170 offset:28672
    v_mfma_f32_16x16x32_bf16 v[28:31], v[124:127], v[108:111], v[28:31]
    ds_read_b64_tr_b16 v[162:163], v170 offset:29184
    v_mfma_f32_16x16x32_bf16 v[32:35], v[108:111], v[128:131], v[32:35]
    ds_read_b64_tr_b16 v[164:165], v171 offset:28672
    v_mfma_f32_16x16x32_bf16 v[36:39], v[108:111], v[132:135], v[36:39]
    ds_read_b64_tr_b16 v[166:167], v171 offset:29184
    v_mfma_f32_16x16x32_bf16 v[80:83], v[172:175], v[108:111], v[80:83]
    ds_read_b64_tr_b16 v[180:181], v189 offset:12288
    v_mfma_f32_16x16x32_bf16 v[84:87], v[176:179], v[108:111], v[84:87]
    ds_read_b64_tr_b16 v[182:183], v189 offset:12800
    v_mfma_f32_16x16x32_bf16 v[40:43], v[120:123], v[112:115], v[40:43]
    ds_read_b64_tr_b16 v[184:185], v191 offset:12288
    v_mfma_f32_16x16x32_bf16 v[44:47], v[124:127], v[112:115], v[44:47]
    ds_read_b64_tr_b16 v[186:187], v191 offset:12800
    v_mfma_f32_16x16x32_bf16 v[48:51], v[112:115], v[128:131], v[48:51]
    ds_read_b128 v[144:147], v169 offset:20480
    v_mfma_f32_16x16x32_bf16 v[52:55], v[112:115], v[132:135], v[52:55]
    ds_read_b128 v[148:151], v169 offset:22528
    v_mfma_f32_16x16x32_bf16 v[88:91], v[172:175], v[112:115], v[88:91]
    v_mfma_f32_16x16x32_bf16 v[92:95], v[176:179], v[112:115], v[92:95]
    v_mfma_f32_16x16x32_bf16 v[56:59], v[120:123], v[116:119], v[56:59]
    v_mfma_f32_16x16x32_bf16 v[60:63], v[124:127], v[116:119], v[60:63]
    v_mfma_f32_16x16x32_bf16 v[64:67], v[116:119], v[128:131], v[64:67]
    v_mfma_f32_16x16x32_bf16 v[68:71], v[116:119], v[132:135], v[68:71]
    v_mfma_f32_16x16x32_bf16 v[96:99], v[172:175], v[116:119], v[96:99]
    v_mfma_f32_16x16x32_bf16 v[100:103], v[176:179], v[116:119], v[100:103]
    v_mov_b32 v236, 0x3f803f80
    v_mov_b32 v232, 0
    v_mov_b32 v233, 0
    v_mov_b32 v234, 0
    v_mov_b32 v235, 0
    s_waitcnt vmcnt(0)
    v_dot2_f32_bf16 v232, v192, v236, v232
    v_dot2_f32_bf16 v233, v192, v192, v233
    v_dot2_f32_bf16 v234, v192, v208, v234
    v_dot2_f32_bf16 v235, v208, v236, v235
    v_dot2_f32_bf16 v232, v193, v236, v232
    v_dot2_f32_bf16 v233, v193, v193, v233
    v_dot2_f32_bf16 v234, v193, v209, v234
    v_dot2_f32_bf16 v235, v209, v236, v235
    v_dot2_f32_bf16 v232, v194, v236, v232
    v_dot2_f32_bf16 v233, v194, v194, v233
    v_dot2_f32_bf16 v234, v194, v210, v234
    v_dot2_f32_bf16 v235, v210, v236, v235
    v_dot2_f32_bf16 v232, v195, v236, v232
    v_dot2_f32_bf16 v233, v195, v195, v233
    v_dot2_f32_bf16 v234, v195, v211, v234
    v_dot2_f32_bf16 v235, v211, v236, v235
    v_dot2_f32_bf16 v232, v196, v236, v232
    v_dot2_f32_bf16 v233, v196, v196, v233
    v_dot2_f32_bf16 v234, v196, v212, v234
    v_dot2_f32_bf16 v235, v212, v236, v235
    v_dot2_f32_bf16 v232, v197, v236, v232
    v_dot2_f32_bf16 v233, v197, v197, v233
    v_dot2_f32_bf16 v234, v197, v213, v234
    v_dot2_f32_bf16 v235, v213, v236, v235
    v_dot2_f32_bf16 v232, v198, v236, v232
    v_dot2_f32_bf16 v233, v198, v198, v233
    v_dot2_f32_bf16 v234, v198, v214, v234
    v_dot2_f32_bf16 v235, v214, v236, v235
    v_dot2_f32_bf16 v232, v199, v236, v232
    v_dot2_f32_bf16 v233, v199, v199, v233
    v_dot2_f32_bf16 v234, v199, v215, v234
    v_dot2_f32_bf16 v235, v215, v236, v235
    v_dot2_f32_bf16 v232, v200, v236, v232
    v_dot2_f32_bf16 v233, v200, v200, v233
    v_dot2_f32_bf16 v234, v200, v216, v234
    v_dot2_f32_bf16 v235, v216, v236, v235
    v_dot2_f32_bf16 v232, v201, v236, v232
    v_dot2_f32_bf16 v233, v201, v201, v233
    v_dot2_f32_bf16 v234, v201, v217, v234
    v_dot2_f32_bf16 v235, v217, v236, v235
    v_dot2_f32_bf16 v232, v202, v236, v232
    v_dot2_f32_bf16 v233, v202, v202, v233
    v_dot2_f32_bf16 v234, v202, v218, v234
    v_dot2_f32_bf16 v235, v218, v236, v235
    v_dot2_f32_bf16 v232, v203, v236, v232
    v_dot2_f32_bf16 v233, v203, v203, v233
    v_dot2_f32_bf16 v234, v203, v219, v234
    v_dot2_f32_bf16 v235, v219, v236, v235
    v_dot2_f32_bf16 v232, v204, v236, v232
    v_dot2_f32_bf16 v233, v204, v204, v233
    v_dot2_f32_bf16 v234, v204, v220, v234
    v_dot2_f32_bf16 v235, v220, v236, v235
    v_dot2_f32_bf16 v232, v205, v236, v232
    v_dot2_f32_bf16 v233, v205, v205, v233
    v_dot2_f32_bf16 v234, v205, v221, v234
    v_dot2_f32_bf16 v235, v221, v236, v235
    v_dot2_f32_bf16 v232, v206, v236, v232
    v_dot2_f32_bf16 v233, v206, v206, v233
    v_dot2_f32_bf16 v234, v206, v222, v234
    v_dot2_f32_bf16 v235, v222, v236, v235
    v_dot2_f32_bf16 v232, v207, v236, v232
    v_dot2_f32_bf16 v233, v207, v207, v233
    v_dot2_f32_bf16 v234, v207, v223, v234
    v_dot2_f32_bf16 v235, v223, v236, v235
    v_add_f32 v232, v232, v232 quad_perm:[1,0,3,2] row_mask:0xf bank_mask:0xf
    v_add_f32 v233, v233, v233 quad_perm:[1,0,3,2] row_mask:0xf bank_mask:0xf
    v_add_f32 v234, v234, v234 quad_perm:[1,0,3,2] row_mask:0xf bank_mask:0xf
    v_add_f32 v235, v235, v235 quad_perm:[1,0,3,2] row_mask:0xf bank_mask:0xf
    v_add_f32 v232, v232, v232 quad_perm:[2,3,0,1] row_mask:0xf bank_mask:0xf
    v_add_f32 v233, v233, v233 quad_perm:[2,3,0,1] row_mask:0xf bank_mask:0xf
    v_add_f32 v234, v234, v234 quad_perm:[2,3,0,1] row_mask:0xf bank_mask:0xf
    v_add_f32 v235, v235, v235 quad_perm:[2,3,0,1] row_mask:0xf bank_mask:0xf
    v_add_f32 v232, v232, v232 row_half_mirror row_mask:0xf bank_mask:0xf
    v_add_f32 v233, v233, v233 row_half_mirror row_mask:0xf bank_mask:0xf
    v_add_f32 v234, v234, v234 row_half_mirror row_mask:0xf bank_mask:0xf
    v_add_f32 v235, v235, v235 row_half_mirror row_mask:0xf bank_mask:0xf
    v_add_f32 v232, v232, v232 row_mirror row_mask:0xf bank_mask:0xf
    v_add_f32 v233, v233, v233 row_mirror row_mask:0xf bank_mask:0xf
    v_add_f32 v234, v234, v234 row_mirror row_mask:0xf bank_mask:0xf
    v_add_f32 v235, v235, v235 row_mirror row_mask:0xf bank_mask:0xf
    v_mov_b32 v236, v232
    v_mov_b32 v237, v233
    v_mov_b32 v238, v234
    v_mov_b32 v239, v235
    v_permlane16_swap_b32 v232, v236
    v_permlane16_swap_b32 v233, v237
    v_permlane16_swap_b32 v234, v238
    v_permlane16_swap_b32 v235, v239
    v_add_f32 v232, v232, v236
    v_add_f32 v233, v233, v237
    v_add_f32 v234, v234, v238
    v_add_f32 v235, v235, v239
    v_mul_f32 v232, 0x3a800000, v232
    v_mul_f32 v233, 0x3a800000, v233
    v_fma_f32 v233, -v232, v232, v233
    v_max_f32 v233, 0, v233
    v_cvt_pk_bf16_f32 v232, v232, v232
    v_lshlrev_b32 v232, 16, v232
    v_cvt_pk_bf16_f32 v233, v233, v233
    v_lshlrev_b32 v233, 16, v233
    v_add_f32 v233, 0x3727c5ac, v233
    v_cvt_pk_bf16_f32 v233, v233, v233
    v_lshlrev_b32 v233, 16, v233
    v_sqrt_f32 v233, v233
    v_fma_f32 v234, -v232, v235, v234
    v_cvt_pk_bf16_f32 v233, v233, v233
    v_lshlrev_b32 v233, 16, v233
    v_rcp_f32 v235, v233
    v_lshrrev_b32 v232, 16, v232
    v_or_b32 v232, v232, v233
    v_mul_f32 v234, v234, v235
    v_ashrrev_i32 v235, 31, v234
    v_or_b32 v235, 0x80000000, v235
    v_xor_b32 v234, v234, v235
    v_and_b32 v234, 0xfffff800, v234
    s_sub_u32 s3, 2047, s68
    v_sub_u32 v235, s3, v190
    v_or_b32 v233, v234, v235
    s_lshl_b32 s3, s38, 4
    s_add_u32 s3, s3, 163264
    v_lshl_add_u32 v235, v190, 3, s3
    ds_write_b64 v235, v[232:233]
    s_waitcnt lgkmcnt(0)
    s_barrier
    v_mfma_f32_16x16x32_bf16 v[8:11], v[152:155], v[136:139], v[8:11]
    ds_read_b128 v[104:107], v168 offset:32768
    v_mfma_f32_16x16x32_bf16 v[12:15], v[156:159], v[136:139], v[12:15]
    ds_read_b64_tr_b16 v[120:121], v170 offset:32768
    v_mfma_f32_16x16x32_bf16 v[16:19], v[136:139], v[160:163], v[16:19]
    ds_read_b64_tr_b16 v[122:123], v170 offset:33280
    v_mfma_f32_16x16x32_bf16 v[20:23], v[136:139], v[164:167], v[20:23]
    ds_read_b64_tr_b16 v[124:125], v171 offset:32768
    v_mfma_f32_16x16x32_bf16 v[72:75], v[180:183], v[136:139], v[72:75]
    ds_read_b64_tr_b16 v[126:127], v171 offset:33280
    v_mfma_f32_16x16x32_bf16 v[76:79], v[184:187], v[136:139], v[76:79]
    ds_read_b128 v[108:111], v168 offset:34816
    v_mfma_f32_16x16x32_bf16 v[24:27], v[152:155], v[140:143], v[24:27]
    ds_read_b64_tr_b16 v[128:129], v170 offset:40960
    v_mfma_f32_16x16x32_bf16 v[28:31], v[156:159], v[140:143], v[28:31]
    ds_read_b64_tr_b16 v[130:131], v170 offset:41472
    v_mfma_f32_16x16x32_bf16 v[32:35], v[140:143], v[160:163], v[32:35]
    ds_read_b64_tr_b16 v[132:133], v171 offset:40960
    v_mfma_f32_16x16x32_bf16 v[36:39], v[140:143], v[164:167], v[36:39]
    ds_read_b64_tr_b16 v[134:135], v171 offset:41472
    v_mfma_f32_16x16x32_bf16 v[80:83], v[180:183], v[140:143], v[80:83]
    ds_read_b64_tr_b16 v[172:173], v189 offset:16384
    v_mfma_f32_16x16x32_bf16 v[84:87], v[184:187], v[140:143], v[84:87]
    ds_read_b64_tr_b16 v[174:175], v189 offset:16896
    v_mfma_f32_16x16x32_bf16 v[40:43], v[152:155], v[144:147], v[40:43]
    ds_read_b64_tr_b16 v[176:177], v191 offset:16384
    v_mfma_f32_16x16x32_bf16 v[44:47], v[156:159], v[144:147], v[44:47]
    ds_read_b64_tr_b16 v[178:179], v191 offset:16896
    v_mfma_f32_16x16x32_bf16 v[48:51], v[144:147], v[160:163], v[48:51]
    ds_read_b128 v[112:115], v168 offset:36864
    v_mfma_f32_16x16x32_bf16 v[52:55], v[144:147], v[164:167], v[52:55]
    ds_read_b128 v[116:119], v168 offset:38912
    v_mfma_f32_16x16x32_bf16 v[88:91], v[180:183], v[144:147], v[88:91]
    v_mfma_f32_16x16x32_bf16 v[92:95], v[184:187], v[144:147], v[92:95]
    v_mfma_f32_16x16x32_bf16 v[56:59], v[152:155], v[148:151], v[56:59]
    v_mfma_f32_16x16x32_bf16 v[60:63], v[156:159], v[148:151], v[60:63]
    v_mfma_f32_16x16x32_bf16 v[64:67], v[148:151], v[160:163], v[64:67]
    v_mfma_f32_16x16x32_bf16 v[68:71], v[148:151], v[164:167], v[68:71]
    v_mfma_f32_16x16x32_bf16 v[96:99], v[180:183], v[148:151], v[96:99]
    v_mfma_f32_16x16x32_bf16 v[100:103], v[184:187], v[148:151], v[100:103]
    s_waitcnt lgkmcnt(0)
    v_mfma_f32_16x16x32_bf16 v[8:11], v[120:123], v[104:107], v[8:11]
    ds_read_b128 v[136:139], v169 offset:32768
    v_mfma_f32_16x16x32_bf16 v[12:15], v[124:127], v[104:107], v[12:15]
    ds_read_b64_tr_b16 v[152:153], v170 offset:36864
    v_mfma_f32_16x16x32_bf16 v[16:19], v[104:107], v[128:131], v[16:19]
    ds_read_b64_tr_b16 v[154:155], v170 offset:37376
    v_mfma_f32_16x16x32_bf16 v[20:23], v[104:107], v[132:135], v[20:23]
    ds_read_b64_tr_b16 v[156:157], v171 offset:36864
    v_mfma_f32_16x16x32_bf16 v[72:75], v[172:175], v[104:107], v[72:75]
    ds_read_b64_tr_b16 v[158:159], v171 offset:37376
    v_mfma_f32_16x16x32_bf16 v[76:79], v[176:179], v[104:107], v[76:79]
    ds_read_b128 v[140:143], v169 offset:34816
    v_mfma_f32_16x16x32_bf16 v[24:27], v[120:123], v[108:111], v[24:27]
    ds_read_b64_tr_b16 v[160:161], v170 offset:45056
    v_mfma_f32_16x16x32_bf16 v[28:31], v[124:127], v[108:111], v[28:31]
    ds_read_b64_tr_b16 v[162:163], v170 offset:45568
    v_mfma_f32_16x16x32_bf16 v[32:35], v[108:111], v[128:131], v[32:35]
    ds_read_b64_tr_b16 v[164:165], v171 offset:45056
    v_mfma_f32_16x16x32_bf16 v[36:39], v[108:111], v[132:135], v[36:39]
    ds_read_b64_tr_b16 v[166:167], v171 offset:45568
    v_mfma_f32_16x16x32_bf16 v[80:83], v[172:175], v[108:111], v[80:83]
    ds_read_b64_tr_b16 v[180:181], v189 offset:20480
    v_mfma_f32_16x16x32_bf16 v[84:87], v[176:179], v[108:111], v[84:87]
    ds_read_b64_tr_b16 v[182:183], v189 offset:20992
    v_mfma_f32_16x16x32_bf16 v[40:43], v[120:123], v[112:115], v[40:43]
    ds_read_b64_tr_b16 v[184:185], v191 offset:20480
    v_mfma_f32_16x16x32_bf16 v[44:47], v[124:127], v[112:115], v[44:47]
    ds_read_b64_tr_b16 v[186:187], v191 offset:20992
    v_mfma_f32_16x16x32_bf16 v[48:51], v[112:115], v[128:131], v[48:51]
    ds_read_b128 v[144:147], v169 offset:36864
    v_mfma_f32_16x16x32_bf16 v[52:55], v[112:115], v[132:135], v[52:55]
    ds_read_b128 v[148:151], v169 offset:38912
    v_mfma_f32_16x16x32_bf16 v[88:91], v[172:175], v[112:115], v[88:91]
    v_mfma_f32_16x16x32_bf16 v[92:95], v[176:179], v[112:115], v[92:95]
    v_mfma_f32_16x16x32_bf16 v[56:59], v[120:123], v[116:119], v[56:59]
    v_mfma_f32_16x16x32_bf16 v[60:63], v[124:127], v[116:119], v[60:63]
    v_mfma_f32_16x16x32_bf16 v[64:67], v[116:119], v[128:131], v[64:67]
    v_mfma_f32_16x16x32_bf16 v[68:71], v[116:119], v[132:135], v[68:71]
    v_mfma_f32_16x16x32_bf16 v[96:99], v[172:175], v[116:119], v[96:99]
    v_mfma_f32_16x16x32_bf16 v[100:103], v[176:179], v[116:119], v[100:103]
    s_waitcnt lgkmcnt(0)
    s_barrier
    v_mfma_f32_16x16x32_bf16 v[8:11], v[152:155], v[136:139], v[8:11]
    ds_read_b128 v[104:107], v168 offset:49152
    v_mfma_f32_16x16x32_bf16 v[12:15], v[156:159], v[136:139], v[12:15]
    ds_read_b64_tr_b16 v[120:121], v170 offset:49152
    v_mfma_f32_16x16x32_bf16 v[16:19], v[136:139], v[160:163], v[16:19]
    ds_read_b64_tr_b16 v[122:123], v170 offset:49664
    v_mfma_f32_16x16x32_bf16 v[20:23], v[136:139], v[164:167], v[20:23]
    ds_read_b64_tr_b16 v[124:125], v171 offset:49152
    v_mfma_f32_16x16x32_bf16 v[72:75], v[180:183], v[136:139], v[72:75]
    ds_read_b64_tr_b16 v[126:127], v171 offset:49664
    v_mfma_f32_16x16x32_bf16 v[76:79], v[184:187], v[136:139], v[76:79]
    ds_read_b128 v[108:111], v168 offset:51200
    v_mfma_f32_16x16x32_bf16 v[24:27], v[152:155], v[140:143], v[24:27]
    ds_read_b64_tr_b16 v[128:129], v170 offset:57344
    v_mfma_f32_16x16x32_bf16 v[28:31], v[156:159], v[140:143], v[28:31]
    ds_read_b64_tr_b16 v[130:131], v170 offset:57856
    v_mfma_f32_16x16x32_bf16 v[32:35], v[140:143], v[160:163], v[32:35]
    ds_read_b64_tr_b16 v[132:133], v171 offset:57344
    v_mfma_f32_16x16x32_bf16 v[36:39], v[140:143], v[164:167], v[36:39]
    ds_read_b64_tr_b16 v[134:135], v171 offset:57856
    v_mfma_f32_16x16x32_bf16 v[80:83], v[180:183], v[140:143], v[80:83]
    ds_read_b64_tr_b16 v[172:173], v189 offset:0
    v_mfma_f32_16x16x32_bf16 v[84:87], v[184:187], v[140:143], v[84:87]
    ds_read_b64_tr_b16 v[174:175], v189 offset:512
    v_mfma_f32_16x16x32_bf16 v[40:43], v[152:155], v[144:147], v[40:43]
    ds_read_b64_tr_b16 v[176:177], v191 offset:0
    v_mfma_f32_16x16x32_bf16 v[44:47], v[156:159], v[144:147], v[44:47]
    ds_read_b64_tr_b16 v[178:179], v191 offset:512
    v_mfma_f32_16x16x32_bf16 v[48:51], v[144:147], v[160:163], v[48:51]
    ds_read_b128 v[112:115], v168 offset:53248
    v_mfma_f32_16x16x32_bf16 v[52:55], v[144:147], v[164:167], v[52:55]
    ds_read_b128 v[116:119], v168 offset:55296
    v_mfma_f32_16x16x32_bf16 v[88:91], v[180:183], v[144:147], v[88:91]
    v_mfma_f32_16x16x32_bf16 v[92:95], v[184:187], v[144:147], v[92:95]
    v_mfma_f32_16x16x32_bf16 v[56:59], v[152:155], v[148:151], v[56:59]
    v_mfma_f32_16x16x32_bf16 v[60:63], v[156:159], v[148:151], v[60:63]
    v_mfma_f32_16x16x32_bf16 v[64:67], v[148:151], v[160:163], v[64:67]
    v_mfma_f32_16x16x32_bf16 v[68:71], v[148:151], v[164:167], v[68:71]
    v_mfma_f32_16x16x32_bf16 v[96:99], v[180:183], v[148:151], v[96:99]
    v_mfma_f32_16x16x32_bf16 v[100:103], v[184:187], v[148:151], v[100:103]
    s_waitcnt lgkmcnt(0)
    v_mfma_f32_16x16x32_bf16 v[8:11], v[120:123], v[104:107], v[8:11]
    ds_read_b128 v[136:139], v169 offset:49152
    v_mfma_f32_16x16x32_bf16 v[12:15], v[124:127], v[104:107], v[12:15]
    ds_read_b64_tr_b16 v[152:153], v170 offset:53248
    v_mfma_f32_16x16x32_bf16 v[16:19], v[104:107], v[128:131], v[16:19]
    ds_read_b64_tr_b16 v[154:155], v170 offset:53760
    v_mfma_f32_16x16x32_bf16 v[20:23], v[104:107], v[132:135], v[20:23]
    ds_read_b64_tr_b16 v[156:157], v171 offset:53248
    v_mfma_f32_16x16x32_bf16 v[72:75], v[172:175], v[104:107], v[72:75]
    ds_read_b64_tr_b16 v[158:159], v171 offset:53760
    v_mfma_f32_16x16x32_bf16 v[76:79], v[176:179], v[104:107], v[76:79]
    ds_read_b128 v[140:143], v169 offset:51200
    v_mfma_f32_16x16x32_bf16 v[24:27], v[120:123], v[108:111], v[24:27]
    ds_read_b64_tr_b16 v[160:161], v170 offset:61440
    v_mfma_f32_16x16x32_bf16 v[28:31], v[124:127], v[108:111], v[28:31]
    ds_read_b64_tr_b16 v[162:163], v170 offset:61952
    v_mfma_f32_16x16x32_bf16 v[32:35], v[108:111], v[128:131], v[32:35]
    ds_read_b64_tr_b16 v[164:165], v171 offset:61440
    v_mfma_f32_16x16x32_bf16 v[36:39], v[108:111], v[132:135], v[36:39]
    ds_read_b64_tr_b16 v[166:167], v171 offset:61952
    v_mfma_f32_16x16x32_bf16 v[80:83], v[172:175], v[108:111], v[80:83]
    ds_read_b64_tr_b16 v[180:181], v189 offset:4096
    v_mfma_f32_16x16x32_bf16 v[84:87], v[176:179], v[108:111], v[84:87]
    ds_read_b64_tr_b16 v[182:183], v189 offset:4608
    v_mfma_f32_16x16x32_bf16 v[40:43], v[120:123], v[112:115], v[40:43]
    ds_read_b64_tr_b16 v[184:185], v191 offset:4096
    v_mfma_f32_16x16x32_bf16 v[44:47], v[124:127], v[112:115], v[44:47]
    ds_read_b64_tr_b16 v[186:187], v191 offset:4608
    v_mfma_f32_16x16x32_bf16 v[48:51], v[112:115], v[128:131], v[48:51]
    ds_read_b128 v[144:147], v169 offset:53248
    v_mfma_f32_16x16x32_bf16 v[52:55], v[112:115], v[132:135], v[52:55]
    ds_read_b128 v[148:151], v169 offset:55296
    v_mfma_f32_16x16x32_bf16 v[88:91], v[172:175], v[112:115], v[88:91]
    v_mfma_f32_16x16x32_bf16 v[92:95], v[176:179], v[112:115], v[92:95]
    v_mfma_f32_16x16x32_bf16 v[56:59], v[120:123], v[116:119], v[56:59]
    v_mfma_f32_16x16x32_bf16 v[60:63], v[124:127], v[116:119], v[60:63]
    v_mfma_f32_16x16x32_bf16 v[64:67], v[116:119], v[128:131], v[64:67]
    v_mfma_f32_16x16x32_bf16 v[68:71], v[116:119], v[132:135], v[68:71]
    v_mfma_f32_16x16x32_bf16 v[96:99], v[172:175], v[116:119], v[96:99]
    v_mfma_f32_16x16x32_bf16 v[100:103], v[176:179], v[116:119], v[100:103]
    s_waitcnt lgkmcnt(0)
    s_barrier
    v_mfma_f32_16x16x32_bf16 v[8:11], v[152:155], v[136:139], v[8:11]
    ds_read_b128 v[104:107], v168 offset:0
    v_mfma_f32_16x16x32_bf16 v[12:15], v[156:159], v[136:139], v[12:15]
    ds_read_b64_tr_b16 v[120:121], v170 offset:0
    v_mfma_f32_16x16x32_bf16 v[16:19], v[136:139], v[160:163], v[16:19]
    ds_read_b64_tr_b16 v[122:123], v170 offset:512
    v_mfma_f32_16x16x32_bf16 v[20:23], v[136:139], v[164:167], v[20:23]
    ds_read_b64_tr_b16 v[124:125], v171 offset:0
    v_mfma_f32_16x16x32_bf16 v[72:75], v[180:183], v[136:139], v[72:75]
    ds_read_b64_tr_b16 v[126:127], v171 offset:512
    v_mfma_f32_16x16x32_bf16 v[76:79], v[184:187], v[136:139], v[76:79]
    ds_read_b128 v[108:111], v168 offset:2048
    v_mfma_f32_16x16x32_bf16 v[24:27], v[152:155], v[140:143], v[24:27]
    ds_read_b64_tr_b16 v[128:129], v170 offset:8192
    v_mfma_f32_16x16x32_bf16 v[28:31], v[156:159], v[140:143], v[28:31]
    ds_read_b64_tr_b16 v[130:131], v170 offset:8704
    v_mfma_f32_16x16x32_bf16 v[32:35], v[140:143], v[160:163], v[32:35]
    ds_read_b64_tr_b16 v[132:133], v171 offset:8192
    v_mfma_f32_16x16x32_bf16 v[36:39], v[140:143], v[164:167], v[36:39]
    ds_read_b64_tr_b16 v[134:135], v171 offset:8704
    v_mfma_f32_16x16x32_bf16 v[80:83], v[180:183], v[140:143], v[80:83]
    ds_read_b64_tr_b16 v[172:173], v189 offset:8192
    v_mfma_f32_16x16x32_bf16 v[84:87], v[184:187], v[140:143], v[84:87]
    ds_read_b64_tr_b16 v[174:175], v189 offset:8704
    v_mfma_f32_16x16x32_bf16 v[40:43], v[152:155], v[144:147], v[40:43]
    ds_read_b64_tr_b16 v[176:177], v191 offset:8192
    v_mfma_f32_16x16x32_bf16 v[44:47], v[156:159], v[144:147], v[44:47]
    ds_read_b64_tr_b16 v[178:179], v191 offset:8704
    v_mfma_f32_16x16x32_bf16 v[48:51], v[144:147], v[160:163], v[48:51]
    ds_read_b128 v[112:115], v168 offset:4096
    v_mfma_f32_16x16x32_bf16 v[52:55], v[144:147], v[164:167], v[52:55]
    ds_read_b128 v[116:119], v168 offset:6144
    v_mfma_f32_16x16x32_bf16 v[88:91], v[180:183], v[144:147], v[88:91]
    v_mfma_f32_16x16x32_bf16 v[92:95], v[184:187], v[144:147], v[92:95]
    v_mfma_f32_16x16x32_bf16 v[56:59], v[152:155], v[148:151], v[56:59]
    v_mfma_f32_16x16x32_bf16 v[60:63], v[156:159], v[148:151], v[60:63]
    v_mfma_f32_16x16x32_bf16 v[64:67], v[148:151], v[160:163], v[64:67]
    v_mfma_f32_16x16x32_bf16 v[68:71], v[148:151], v[164:167], v[68:71]
    v_mfma_f32_16x16x32_bf16 v[96:99], v[180:183], v[148:151], v[96:99]
    v_mfma_f32_16x16x32_bf16 v[100:103], v[184:187], v[148:151], v[100:103]
    s_waitcnt lgkmcnt(0)
    v_mfma_f32_16x16x32_bf16 v[8:11], v[120:123], v[104:107], v[8:11]
    ds_read_b128 v[136:139], v169 offset:0
    v_mfma_f32_16x16x32_bf16 v[12:15], v[124:127], v[104:107], v[12:15]
    ds_read_b64_tr_b16 v[152:153], v170 offset:4096
    v_mfma_f32_16x16x32_bf16 v[16:19], v[104:107], v[128:131], v[16:19]
    ds_read_b64_tr_b16 v[154:155], v170 offset:4608
    v_mfma_f32_16x16x32_bf16 v[20:23], v[104:107], v[132:135], v[20:23]
    ds_read_b64_tr_b16 v[156:157], v171 offset:4096
    v_mfma_f32_16x16x32_bf16 v[72:75], v[172:175], v[104:107], v[72:75]
    ds_read_b64_tr_b16 v[158:159], v171 offset:4608
    v_mfma_f32_16x16x32_bf16 v[76:79], v[176:179], v[104:107], v[76:79]
    ds_read_b128 v[140:143], v169 offset:2048
    v_mfma_f32_16x16x32_bf16 v[24:27], v[120:123], v[108:111], v[24:27]
    ds_read_b64_tr_b16 v[160:161], v170 offset:12288
    v_mfma_f32_16x16x32_bf16 v[28:31], v[124:127], v[108:111], v[28:31]
    ds_read_b64_tr_b16 v[162:163], v170 offset:12800
    v_mfma_f32_16x16x32_bf16 v[32:35], v[108:111], v[128:131], v[32:35]
    ds_read_b64_tr_b16 v[164:165], v171 offset:12288
    v_mfma_f32_16x16x32_bf16 v[36:39], v[108:111], v[132:135], v[36:39]
    ds_read_b64_tr_b16 v[166:167], v171 offset:12800
    v_mfma_f32_16x16x32_bf16 v[80:83], v[172:175], v[108:111], v[80:83]
    ds_read_b64_tr_b16 v[180:181], v189 offset:12288
    v_mfma_f32_16x16x32_bf16 v[84:87], v[176:179], v[108:111], v[84:87]
    ds_read_b64_tr_b16 v[182:183], v189 offset:12800
    v_mfma_f32_16x16x32_bf16 v[40:43], v[120:123], v[112:115], v[40:43]
    ds_read_b64_tr_b16 v[184:185], v191 offset:12288
    v_mfma_f32_16x16x32_bf16 v[44:47], v[124:127], v[112:115], v[44:47]
    ds_read_b64_tr_b16 v[186:187], v191 offset:12800
    v_mfma_f32_16x16x32_bf16 v[48:51], v[112:115], v[128:131], v[48:51]
    ds_read_b128 v[144:147], v169 offset:4096
    v_mfma_f32_16x16x32_bf16 v[52:55], v[112:115], v[132:135], v[52:55]
    ds_read_b128 v[148:151], v169 offset:6144
    v_mfma_f32_16x16x32_bf16 v[88:91], v[172:175], v[112:115], v[88:91]
    v_mfma_f32_16x16x32_bf16 v[92:95], v[176:179], v[112:115], v[92:95]
    v_mfma_f32_16x16x32_bf16 v[56:59], v[120:123], v[116:119], v[56:59]
    v_mfma_f32_16x16x32_bf16 v[60:63], v[124:127], v[116:119], v[60:63]
    v_mfma_f32_16x16x32_bf16 v[64:67], v[116:119], v[128:131], v[64:67]
    v_mfma_f32_16x16x32_bf16 v[68:71], v[116:119], v[132:135], v[68:71]
    v_mfma_f32_16x16x32_bf16 v[96:99], v[172:175], v[116:119], v[96:99]
    v_mfma_f32_16x16x32_bf16 v[100:103], v[176:179], v[116:119], v[100:103]
    s_waitcnt lgkmcnt(0)
    s_barrier
    v_mfma_f32_16x16x32_bf16 v[8:11], v[152:155], v[136:139], v[8:11]
    ds_read_b128 v[104:107], v168 offset:16384
    v_mfma_f32_16x16x32_bf16 v[12:15], v[156:159], v[136:139], v[12:15]
    ds_read_b64_tr_b16 v[120:121], v170 offset:16384
    v_mfma_f32_16x16x32_bf16 v[16:19], v[136:139], v[160:163], v[16:19]
    ds_read_b64_tr_b16 v[122:123], v170 offset:16896
    v_mfma_f32_16x16x32_bf16 v[20:23], v[136:139], v[164:167], v[20:23]
    ds_read_b64_tr_b16 v[124:125], v171 offset:16384
    v_mfma_f32_16x16x32_bf16 v[72:75], v[180:183], v[136:139], v[72:75]
    ds_read_b64_tr_b16 v[126:127], v171 offset:16896
    v_mfma_f32_16x16x32_bf16 v[76:79], v[184:187], v[136:139], v[76:79]
    ds_read_b128 v[108:111], v168 offset:18432
    v_mfma_f32_16x16x32_bf16 v[24:27], v[152:155], v[140:143], v[24:27]
    ds_read_b64_tr_b16 v[128:129], v170 offset:24576
    v_mfma_f32_16x16x32_bf16 v[28:31], v[156:159], v[140:143], v[28:31]
    ds_read_b64_tr_b16 v[130:131], v170 offset:25088
    v_mfma_f32_16x16x32_bf16 v[32:35], v[140:143], v[160:163], v[32:35]
    ds_read_b64_tr_b16 v[132:133], v171 offset:24576
    v_mfma_f32_16x16x32_bf16 v[36:39], v[140:143], v[164:167], v[36:39]
    ds_read_b64_tr_b16 v[134:135], v171 offset:25088
    v_mfma_f32_16x16x32_bf16 v[80:83], v[180:183], v[140:143], v[80:83]
    ds_read_b64_tr_b16 v[172:173], v189 offset:16384
    v_mfma_f32_16x16x32_bf16 v[84:87], v[184:187], v[140:143], v[84:87]
    ds_read_b64_tr_b16 v[174:175], v189 offset:16896
    v_mfma_f32_16x16x32_bf16 v[40:43], v[152:155], v[144:147], v[40:43]
    ds_read_b64_tr_b16 v[176:177], v191 offset:16384
    v_mfma_f32_16x16x32_bf16 v[44:47], v[156:159], v[144:147], v[44:47]
    ds_read_b64_tr_b16 v[178:179], v191 offset:16896
    v_mfma_f32_16x16x32_bf16 v[48:51], v[144:147], v[160:163], v[48:51]
    ds_read_b128 v[112:115], v168 offset:20480
    v_mfma_f32_16x16x32_bf16 v[52:55], v[144:147], v[164:167], v[52:55]
    ds_read_b128 v[116:119], v168 offset:22528
    v_mfma_f32_16x16x32_bf16 v[88:91], v[180:183], v[144:147], v[88:91]
    v_mfma_f32_16x16x32_bf16 v[92:95], v[184:187], v[144:147], v[92:95]
    v_mfma_f32_16x16x32_bf16 v[56:59], v[152:155], v[148:151], v[56:59]
    v_mfma_f32_16x16x32_bf16 v[60:63], v[156:159], v[148:151], v[60:63]
    v_mfma_f32_16x16x32_bf16 v[64:67], v[148:151], v[160:163], v[64:67]
    v_mfma_f32_16x16x32_bf16 v[68:71], v[148:151], v[164:167], v[68:71]
    v_mfma_f32_16x16x32_bf16 v[96:99], v[180:183], v[148:151], v[96:99]
    v_mfma_f32_16x16x32_bf16 v[100:103], v[184:187], v[148:151], v[100:103]
    s_waitcnt lgkmcnt(0)
    v_mfma_f32_16x16x32_bf16 v[8:11], v[120:123], v[104:107], v[8:11]
    ds_read_b128 v[136:139], v169 offset:16384
    v_mfma_f32_16x16x32_bf16 v[12:15], v[124:127], v[104:107], v[12:15]
    ds_read_b64_tr_b16 v[152:153], v170 offset:20480
    v_mfma_f32_16x16x32_bf16 v[16:19], v[104:107], v[128:131], v[16:19]
    ds_read_b64_tr_b16 v[154:155], v170 offset:20992
    v_mfma_f32_16x16x32_bf16 v[20:23], v[104:107], v[132:135], v[20:23]
    ds_read_b64_tr_b16 v[156:157], v171 offset:20480
    v_mfma_f32_16x16x32_bf16 v[72:75], v[172:175], v[104:107], v[72:75]
    ds_read_b64_tr_b16 v[158:159], v171 offset:20992
    v_mfma_f32_16x16x32_bf16 v[76:79], v[176:179], v[104:107], v[76:79]
    ds_read_b128 v[140:143], v169 offset:18432
    v_mfma_f32_16x16x32_bf16 v[24:27], v[120:123], v[108:111], v[24:27]
    ds_read_b64_tr_b16 v[160:161], v170 offset:28672
    v_mfma_f32_16x16x32_bf16 v[28:31], v[124:127], v[108:111], v[28:31]
    ds_read_b64_tr_b16 v[162:163], v170 offset:29184
    v_mfma_f32_16x16x32_bf16 v[32:35], v[108:111], v[128:131], v[32:35]
    ds_read_b64_tr_b16 v[164:165], v171 offset:28672
    v_mfma_f32_16x16x32_bf16 v[36:39], v[108:111], v[132:135], v[36:39]
    ds_read_b64_tr_b16 v[166:167], v171 offset:29184
    v_mfma_f32_16x16x32_bf16 v[80:83], v[172:175], v[108:111], v[80:83]
    ds_read_b64_tr_b16 v[180:181], v189 offset:20480
    v_mfma_f32_16x16x32_bf16 v[84:87], v[176:179], v[108:111], v[84:87]
    ds_read_b64_tr_b16 v[182:183], v189 offset:20992
    v_mfma_f32_16x16x32_bf16 v[40:43], v[120:123], v[112:115], v[40:43]
    ds_read_b64_tr_b16 v[184:185], v191 offset:20480
    v_mfma_f32_16x16x32_bf16 v[44:47], v[124:127], v[112:115], v[44:47]
    ds_read_b64_tr_b16 v[186:187], v191 offset:20992
    v_mfma_f32_16x16x32_bf16 v[48:51], v[112:115], v[128:131], v[48:51]
    ds_read_b128 v[144:147], v169 offset:20480
    v_mfma_f32_16x16x32_bf16 v[52:55], v[112:115], v[132:135], v[52:55]
    ds_read_b128 v[148:151], v169 offset:22528
    v_mfma_f32_16x16x32_bf16 v[88:91], v[172:175], v[112:115], v[88:91]
    v_mfma_f32_16x16x32_bf16 v[92:95], v[176:179], v[112:115], v[92:95]
    v_mfma_f32_16x16x32_bf16 v[56:59], v[120:123], v[116:119], v[56:59]
    v_mfma_f32_16x16x32_bf16 v[60:63], v[124:127], v[116:119], v[60:63]
    v_mfma_f32_16x16x32_bf16 v[64:67], v[116:119], v[128:131], v[64:67]
    v_mfma_f32_16x16x32_bf16 v[68:71], v[116:119], v[132:135], v[68:71]
    v_mfma_f32_16x16x32_bf16 v[96:99], v[172:175], v[116:119], v[96:99]
    v_mfma_f32_16x16x32_bf16 v[100:103], v[176:179], v[116:119], v[100:103]
    s_waitcnt lgkmcnt(0)
    s_barrier
    v_mfma_f32_16x16x32_bf16 v[8:11], v[152:155], v[136:139], v[8:11]
    ds_read_b128 v[104:107], v168 offset:32768
    v_mfma_f32_16x16x32_bf16 v[12:15], v[156:159], v[136:139], v[12:15]
    ds_read_b64_tr_b16 v[120:121], v170 offset:32768
    v_mfma_f32_16x16x32_bf16 v[16:19], v[136:139], v[160:163], v[16:19]
    ds_read_b64_tr_b16 v[122:123], v170 offset:33280
    v_mfma_f32_16x16x32_bf16 v[20:23], v[136:139], v[164:167], v[20:23]
    ds_read_b64_tr_b16 v[124:125], v171 offset:32768
    v_mfma_f32_16x16x32_bf16 v[72:75], v[180:183], v[136:139], v[72:75]
    ds_read_b64_tr_b16 v[126:127], v171 offset:33280
    v_mfma_f32_16x16x32_bf16 v[76:79], v[184:187], v[136:139], v[76:79]
    ds_read_b128 v[108:111], v168 offset:34816
    v_mfma_f32_16x16x32_bf16 v[24:27], v[152:155], v[140:143], v[24:27]
    ds_read_b64_tr_b16 v[128:129], v170 offset:40960
    v_mfma_f32_16x16x32_bf16 v[28:31], v[156:159], v[140:143], v[28:31]
    ds_read_b64_tr_b16 v[130:131], v170 offset:41472
    v_mfma_f32_16x16x32_bf16 v[32:35], v[140:143], v[160:163], v[32:35]
    ds_read_b64_tr_b16 v[132:133], v171 offset:40960
    v_mfma_f32_16x16x32_bf16 v[36:39], v[140:143], v[164:167], v[36:39]
    ds_read_b64_tr_b16 v[134:135], v171 offset:41472
    v_mfma_f32_16x16x32_bf16 v[80:83], v[180:183], v[140:143], v[80:83]
    ds_read_b64_tr_b16 v[172:173], v189 offset:0
    v_mfma_f32_16x16x32_bf16 v[84:87], v[184:187], v[140:143], v[84:87]
    ds_read_b64_tr_b16 v[174:175], v189 offset:512
    v_mfma_f32_16x16x32_bf16 v[40:43], v[152:155], v[144:147], v[40:43]
    ds_read_b64_tr_b16 v[176:177], v191 offset:0
    v_mfma_f32_16x16x32_bf16 v[44:47], v[156:159], v[144:147], v[44:47]
    ds_read_b64_tr_b16 v[178:179], v191 offset:512
    v_mfma_f32_16x16x32_bf16 v[48:51], v[144:147], v[160:163], v[48:51]
    ds_read_b128 v[112:115], v168 offset:36864
    v_mfma_f32_16x16x32_bf16 v[52:55], v[144:147], v[164:167], v[52:55]
    ds_read_b128 v[116:119], v168 offset:38912
    v_mfma_f32_16x16x32_bf16 v[88:91], v[180:183], v[144:147], v[88:91]
    v_mfma_f32_16x16x32_bf16 v[92:95], v[184:187], v[144:147], v[92:95]
    v_mfma_f32_16x16x32_bf16 v[56:59], v[152:155], v[148:151], v[56:59]
    v_mfma_f32_16x16x32_bf16 v[60:63], v[156:159], v[148:151], v[60:63]
    v_mfma_f32_16x16x32_bf16 v[64:67], v[148:151], v[160:163], v[64:67]
    v_mfma_f32_16x16x32_bf16 v[68:71], v[148:151], v[164:167], v[68:71]
    v_mfma_f32_16x16x32_bf16 v[96:99], v[180:183], v[148:151], v[96:99]
    v_mfma_f32_16x16x32_bf16 v[100:103], v[184:187], v[148:151], v[100:103]
    s_waitcnt lgkmcnt(0)
    v_mfma_f32_16x16x32_bf16 v[8:11], v[120:123], v[104:107], v[8:11]
    ds_read_b128 v[136:139], v169 offset:32768
    v_mfma_f32_16x16x32_bf16 v[12:15], v[124:127], v[104:107], v[12:15]
    ds_read_b64_tr_b16 v[152:153], v170 offset:36864
    v_mfma_f32_16x16x32_bf16 v[16:19], v[104:107], v[128:131], v[16:19]
    ds_read_b64_tr_b16 v[154:155], v170 offset:37376
    v_mfma_f32_16x16x32_bf16 v[20:23], v[104:107], v[132:135], v[20:23]
    ds_read_b64_tr_b16 v[156:157], v171 offset:36864
    v_mfma_f32_16x16x32_bf16 v[72:75], v[172:175], v[104:107], v[72:75]
    ds_read_b64_tr_b16 v[158:159], v171 offset:37376
    v_mfma_f32_16x16x32_bf16 v[76:79], v[176:179], v[104:107], v[76:79]
    ds_read_b128 v[140:143], v169 offset:34816
    v_mfma_f32_16x16x32_bf16 v[24:27], v[120:123], v[108:111], v[24:27]
    ds_read_b64_tr_b16 v[160:161], v170 offset:45056
    v_mfma_f32_16x16x32_bf16 v[28:31], v[124:127], v[108:111], v[28:31]
    ds_read_b64_tr_b16 v[162:163], v170 offset:45568
    v_mfma_f32_16x16x32_bf16 v[32:35], v[108:111], v[128:131], v[32:35]
    ds_read_b64_tr_b16 v[164:165], v171 offset:45056
    v_mfma_f32_16x16x32_bf16 v[36:39], v[108:111], v[132:135], v[36:39]
    ds_read_b64_tr_b16 v[166:167], v171 offset:45568
    v_mfma_f32_16x16x32_bf16 v[80:83], v[172:175], v[108:111], v[80:83]
    ds_read_b64_tr_b16 v[180:181], v189 offset:4096
    v_mfma_f32_16x16x32_bf16 v[84:87], v[176:179], v[108:111], v[84:87]
    ds_read_b64_tr_b16 v[182:183], v189 offset:4608
    v_mfma_f32_16x16x32_bf16 v[40:43], v[120:123], v[112:115], v[40:43]
    ds_read_b64_tr_b16 v[184:185], v191 offset:4096
    v_mfma_f32_16x16x32_bf16 v[44:47], v[124:127], v[112:115], v[44:47]
    ds_read_b64_tr_b16 v[186:187], v191 offset:4608
    v_mfma_f32_16x16x32_bf16 v[48:51], v[112:115], v[128:131], v[48:51]
    ds_read_b128 v[144:147], v169 offset:36864
    v_mfma_f32_16x16x32_bf16 v[52:55], v[112:115], v[132:135], v[52:55]
    ds_read_b128 v[148:151], v169 offset:38912
    v_mfma_f32_16x16x32_bf16 v[88:91], v[172:175], v[112:115], v[88:91]
    v_mfma_f32_16x16x32_bf16 v[92:95], v[176:179], v[112:115], v[92:95]
    v_mfma_f32_16x16x32_bf16 v[56:59], v[120:123], v[116:119], v[56:59]
    v_mfma_f32_16x16x32_bf16 v[60:63], v[124:127], v[116:119], v[60:63]
    v_mfma_f32_16x16x32_bf16 v[64:67], v[116:119], v[128:131], v[64:67]
    v_mfma_f32_16x16x32_bf16 v[68:71], v[116:119], v[132:135], v[68:71]
    v_mfma_f32_16x16x32_bf16 v[96:99], v[172:175], v[116:119], v[96:99]
    v_mfma_f32_16x16x32_bf16 v[100:103], v[176:179], v[116:119], v[100:103]
    s_waitcnt lgkmcnt(0)
    s_barrier
    v_mfma_f32_16x16x32_bf16 v[8:11], v[152:155], v[136:139], v[8:11]
    ds_read_b128 v[104:107], v168 offset:49152
    v_mfma_f32_16x16x32_bf16 v[12:15], v[156:159], v[136:139], v[12:15]
    ds_read_b64_tr_b16 v[120:121], v170 offset:49152
    v_mfma_f32_16x16x32_bf16 v[16:19], v[136:139], v[160:163], v[16:19]
    ds_read_b64_tr_b16 v[122:123], v170 offset:49664
    v_mfma_f32_16x16x32_bf16 v[20:23], v[136:139], v[164:167], v[20:23]
    ds_read_b64_tr_b16 v[124:125], v171 offset:49152
    v_mfma_f32_16x16x32_bf16 v[72:75], v[180:183], v[136:139], v[72:75]
    ds_read_b64_tr_b16 v[126:127], v171 offset:49664
    v_mfma_f32_16x16x32_bf16 v[76:79], v[184:187], v[136:139], v[76:79]
    ds_read_b128 v[108:111], v168 offset:51200
    v_mfma_f32_16x16x32_bf16 v[24:27], v[152:155], v[140:143], v[24:27]
    ds_read_b64_tr_b16 v[128:129], v170 offset:57344
    v_mfma_f32_16x16x32_bf16 v[28:31], v[156:159], v[140:143], v[28:31]
    ds_read_b64_tr_b16 v[130:131], v170 offset:57856
    v_mfma_f32_16x16x32_bf16 v[32:35], v[140:143], v[160:163], v[32:35]
    ds_read_b64_tr_b16 v[132:133], v171 offset:57344
    v_mfma_f32_16x16x32_bf16 v[36:39], v[140:143], v[164:167], v[36:39]
    ds_read_b64_tr_b16 v[134:135], v171 offset:57856
    v_mfma_f32_16x16x32_bf16 v[80:83], v[180:183], v[140:143], v[80:83]
    ds_read_b64_tr_b16 v[172:173], v189 offset:8192
    v_mfma_f32_16x16x32_bf16 v[84:87], v[184:187], v[140:143], v[84:87]
    ds_read_b64_tr_b16 v[174:175], v189 offset:8704
    v_mfma_f32_16x16x32_bf16 v[40:43], v[152:155], v[144:147], v[40:43]
    ds_read_b64_tr_b16 v[176:177], v191 offset:8192
    v_mfma_f32_16x16x32_bf16 v[44:47], v[156:159], v[144:147], v[44:47]
    ds_read_b64_tr_b16 v[178:179], v191 offset:8704
    v_mfma_f32_16x16x32_bf16 v[48:51], v[144:147], v[160:163], v[48:51]
    ds_read_b128 v[112:115], v168 offset:53248
    v_mfma_f32_16x16x32_bf16 v[52:55], v[144:147], v[164:167], v[52:55]
    ds_read_b128 v[116:119], v168 offset:55296
    v_mfma_f32_16x16x32_bf16 v[88:91], v[180:183], v[144:147], v[88:91]
    v_mfma_f32_16x16x32_bf16 v[92:95], v[184:187], v[144:147], v[92:95]
    v_mfma_f32_16x16x32_bf16 v[56:59], v[152:155], v[148:151], v[56:59]
    v_mfma_f32_16x16x32_bf16 v[60:63], v[156:159], v[148:151], v[60:63]
    v_mfma_f32_16x16x32_bf16 v[64:67], v[148:151], v[160:163], v[64:67]
    v_mfma_f32_16x16x32_bf16 v[68:71], v[148:151], v[164:167], v[68:71]
    v_mfma_f32_16x16x32_bf16 v[96:99], v[180:183], v[148:151], v[96:99]
    v_mfma_f32_16x16x32_bf16 v[100:103], v[184:187], v[148:151], v[100:103]
    s_waitcnt lgkmcnt(0)
    v_mfma_f32_16x16x32_bf16 v[8:11], v[120:123], v[104:107], v[8:11]
    ds_read_b128 v[136:139], v169 offset:49152
    v_mfma_f32_16x16x32_bf16 v[12:15], v[124:127], v[104:107], v[12:15]
    ds_read_b64_tr_b16 v[152:153], v170 offset:53248
    v_mfma_f32_16x16x32_bf16 v[16:19], v[104:107], v[128:131], v[16:19]
    ds_read_b64_tr_b16 v[154:155], v170 offset:53760
    v_mfma_f32_16x16x32_bf16 v[20:23], v[104:107], v[132:135], v[20:23]
    ds_read_b64_tr_b16 v[156:157], v171 offset:53248
    v_mfma_f32_16x16x32_bf16 v[72:75], v[172:175], v[104:107], v[72:75]
    ds_read_b64_tr_b16 v[158:159], v171 offset:53760
    v_mfma_f32_16x16x32_bf16 v[76:79], v[176:179], v[104:107], v[76:79]
    ds_read_b128 v[140:143], v169 offset:51200
    v_mfma_f32_16x16x32_bf16 v[24:27], v[120:123], v[108:111], v[24:27]
    ds_read_b64_tr_b16 v[160:161], v170 offset:61440
    v_mfma_f32_16x16x32_bf16 v[28:31], v[124:127], v[108:111], v[28:31]
    ds_read_b64_tr_b16 v[162:163], v170 offset:61952
    v_mfma_f32_16x16x32_bf16 v[32:35], v[108:111], v[128:131], v[32:35]
    ds_read_b64_tr_b16 v[164:165], v171 offset:61440
    v_mfma_f32_16x16x32_bf16 v[36:39], v[108:111], v[132:135], v[36:39]
    ds_read_b64_tr_b16 v[166:167], v171 offset:61952
    v_mfma_f32_16x16x32_bf16 v[80:83], v[172:175], v[108:111], v[80:83]
    ds_read_b64_tr_b16 v[180:181], v189 offset:12288
    v_mfma_f32_16x16x32_bf16 v[84:87], v[176:179], v[108:111], v[84:87]
    ds_read_b64_tr_b16 v[182:183], v189 offset:12800
    v_mfma_f32_16x16x32_bf16 v[40:43], v[120:123], v[112:115], v[40:43]
    ds_read_b64_tr_b16 v[184:185], v191 offset:12288
    v_mfma_f32_16x16x32_bf16 v[44:47], v[124:127], v[112:115], v[44:47]
    ds_read_b64_tr_b16 v[186:187], v191 offset:12800
    v_mfma_f32_16x16x32_bf16 v[48:51], v[112:115], v[128:131], v[48:51]
    ds_read_b128 v[144:147], v169 offset:53248
    v_mfma_f32_16x16x32_bf16 v[52:55], v[112:115], v[132:135], v[52:55]
    ds_read_b128 v[148:151], v169 offset:55296
    v_mfma_f32_16x16x32_bf16 v[88:91], v[172:175], v[112:115], v[88:91]
    v_mfma_f32_16x16x32_bf16 v[92:95], v[176:179], v[112:115], v[92:95]
    v_mfma_f32_16x16x32_bf16 v[56:59], v[120:123], v[116:119], v[56:59]
    v_mfma_f32_16x16x32_bf16 v[60:63], v[124:127], v[116:119], v[60:63]
    v_mfma_f32_16x16x32_bf16 v[64:67], v[116:119], v[128:131], v[64:67]
    v_mfma_f32_16x16x32_bf16 v[68:71], v[116:119], v[132:135], v[68:71]
    v_mfma_f32_16x16x32_bf16 v[96:99], v[172:175], v[116:119], v[96:99]
    v_mfma_f32_16x16x32_bf16 v[100:103], v[176:179], v[116:119], v[100:103]
    s_waitcnt lgkmcnt(0)
    s_barrier
    v_mfma_f32_16x16x32_bf16 v[8:11], v[152:155], v[136:139], v[8:11]
    ds_read_b128 v[104:107], v168 offset:0
    v_mfma_f32_16x16x32_bf16 v[12:15], v[156:159], v[136:139], v[12:15]
    ds_read_b64_tr_b16 v[120:121], v170 offset:0
    v_mfma_f32_16x16x32_bf16 v[16:19], v[136:139], v[160:163], v[16:19]
    ds_read_b64_tr_b16 v[122:123], v170 offset:512
    v_mfma_f32_16x16x32_bf16 v[20:23], v[136:139], v[164:167], v[20:23]
    ds_read_b64_tr_b16 v[124:125], v171 offset:0
    v_mfma_f32_16x16x32_bf16 v[72:75], v[180:183], v[136:139], v[72:75]
    ds_read_b64_tr_b16 v[126:127], v171 offset:512
    v_mfma_f32_16x16x32_bf16 v[76:79], v[184:187], v[136:139], v[76:79]
    ds_read_b128 v[108:111], v168 offset:2048
    v_mfma_f32_16x16x32_bf16 v[24:27], v[152:155], v[140:143], v[24:27]
    ds_read_b64_tr_b16 v[128:129], v170 offset:8192
    v_mfma_f32_16x16x32_bf16 v[28:31], v[156:159], v[140:143], v[28:31]
    ds_read_b64_tr_b16 v[130:131], v170 offset:8704
    v_mfma_f32_16x16x32_bf16 v[32:35], v[140:143], v[160:163], v[32:35]
    ds_read_b64_tr_b16 v[132:133], v171 offset:8192
    v_mfma_f32_16x16x32_bf16 v[36:39], v[140:143], v[164:167], v[36:39]
    ds_read_b64_tr_b16 v[134:135], v171 offset:8704
    v_mfma_f32_16x16x32_bf16 v[80:83], v[180:183], v[140:143], v[80:83]
    ds_read_b64_tr_b16 v[172:173], v189 offset:16384
    v_mfma_f32_16x16x32_bf16 v[84:87], v[184:187], v[140:143], v[84:87]
    ds_read_b64_tr_b16 v[174:175], v189 offset:16896
    v_mfma_f32_16x16x32_bf16 v[40:43], v[152:155], v[144:147], v[40:43]
    ds_read_b64_tr_b16 v[176:177], v191 offset:16384
    v_mfma_f32_16x16x32_bf16 v[44:47], v[156:159], v[144:147], v[44:47]
    ds_read_b64_tr_b16 v[178:179], v191 offset:16896
    v_mfma_f32_16x16x32_bf16 v[48:51], v[144:147], v[160:163], v[48:51]
    ds_read_b128 v[112:115], v168 offset:4096
    v_mfma_f32_16x16x32_bf16 v[52:55], v[144:147], v[164:167], v[52:55]
    ds_read_b128 v[116:119], v168 offset:6144
    v_mfma_f32_16x16x32_bf16 v[88:91], v[180:183], v[144:147], v[88:91]
    v_mfma_f32_16x16x32_bf16 v[92:95], v[184:187], v[144:147], v[92:95]
    v_mfma_f32_16x16x32_bf16 v[56:59], v[152:155], v[148:151], v[56:59]
    v_mfma_f32_16x16x32_bf16 v[60:63], v[156:159], v[148:151], v[60:63]
    v_mfma_f32_16x16x32_bf16 v[64:67], v[148:151], v[160:163], v[64:67]
    v_mfma_f32_16x16x32_bf16 v[68:71], v[148:151], v[164:167], v[68:71]
    v_mfma_f32_16x16x32_bf16 v[96:99], v[180:183], v[148:151], v[96:99]
    v_mfma_f32_16x16x32_bf16 v[100:103], v[184:187], v[148:151], v[100:103]
    s_waitcnt lgkmcnt(0)
    v_mfma_f32_16x16x32_bf16 v[8:11], v[120:123], v[104:107], v[8:11]
    ds_read_b128 v[136:139], v169 offset:0
    v_mfma_f32_16x16x32_bf16 v[12:15], v[124:127], v[104:107], v[12:15]
    ds_read_b64_tr_b16 v[152:153], v170 offset:4096
    v_mfma_f32_16x16x32_bf16 v[16:19], v[104:107], v[128:131], v[16:19]
    ds_read_b64_tr_b16 v[154:155], v170 offset:4608
    v_mfma_f32_16x16x32_bf16 v[20:23], v[104:107], v[132:135], v[20:23]
    ds_read_b64_tr_b16 v[156:157], v171 offset:4096
    v_mfma_f32_16x16x32_bf16 v[72:75], v[172:175], v[104:107], v[72:75]
    ds_read_b64_tr_b16 v[158:159], v171 offset:4608
    v_mfma_f32_16x16x32_bf16 v[76:79], v[176:179], v[104:107], v[76:79]
    ds_read_b128 v[140:143], v169 offset:2048
    v_mfma_f32_16x16x32_bf16 v[24:27], v[120:123], v[108:111], v[24:27]
    ds_read_b64_tr_b16 v[160:161], v170 offset:12288
    v_mfma_f32_16x16x32_bf16 v[28:31], v[124:127], v[108:111], v[28:31]
    ds_read_b64_tr_b16 v[162:163], v170 offset:12800
    v_mfma_f32_16x16x32_bf16 v[32:35], v[108:111], v[128:131], v[32:35]
    ds_read_b64_tr_b16 v[164:165], v171 offset:12288
    v_mfma_f32_16x16x32_bf16 v[36:39], v[108:111], v[132:135], v[36:39]
    ds_read_b64_tr_b16 v[166:167], v171 offset:12800
    v_mfma_f32_16x16x32_bf16 v[80:83], v[172:175], v[108:111], v[80:83]
    ds_read_b64_tr_b16 v[180:181], v189 offset:20480
    v_mfma_f32_16x16x32_bf16 v[84:87], v[176:179], v[108:111], v[84:87]
    ds_read_b64_tr_b16 v[182:183], v189 offset:20992
    v_mfma_f32_16x16x32_bf16 v[40:43], v[120:123], v[112:115], v[40:43]
    ds_read_b64_tr_b16 v[184:185], v191 offset:20480
    v_mfma_f32_16x16x32_bf16 v[44:47], v[124:127], v[112:115], v[44:47]
    ds_read_b64_tr_b16 v[186:187], v191 offset:20992
    v_mfma_f32_16x16x32_bf16 v[48:51], v[112:115], v[128:131], v[48:51]
    ds_read_b128 v[144:147], v169 offset:4096
    v_mfma_f32_16x16x32_bf16 v[52:55], v[112:115], v[132:135], v[52:55]
    ds_read_b128 v[148:151], v169 offset:6144
    v_mfma_f32_16x16x32_bf16 v[88:91], v[172:175], v[112:115], v[88:91]
    v_mfma_f32_16x16x32_bf16 v[92:95], v[176:179], v[112:115], v[92:95]
    v_mfma_f32_16x16x32_bf16 v[56:59], v[120:123], v[116:119], v[56:59]
    v_mfma_f32_16x16x32_bf16 v[60:63], v[124:127], v[116:119], v[60:63]
    v_mfma_f32_16x16x32_bf16 v[64:67], v[116:119], v[128:131], v[64:67]
    v_mfma_f32_16x16x32_bf16 v[68:71], v[116:119], v[132:135], v[68:71]
    v_mfma_f32_16x16x32_bf16 v[96:99], v[172:175], v[116:119], v[96:99]
    v_mfma_f32_16x16x32_bf16 v[100:103], v[176:179], v[116:119], v[100:103]
    s_waitcnt lgkmcnt(0)
    s_barrier
    v_mfma_f32_16x16x32_bf16 v[8:11], v[152:155], v[136:139], v[8:11]
    ds_read_b128 v[104:107], v168 offset:16384
    v_mfma_f32_16x16x32_bf16 v[12:15], v[156:159], v[136:139], v[12:15]
    ds_read_b64_tr_b16 v[120:121], v170 offset:16384
    v_mfma_f32_16x16x32_bf16 v[16:19], v[136:139], v[160:163], v[16:19]
    ds_read_b64_tr_b16 v[122:123], v170 offset:16896
    v_mfma_f32_16x16x32_bf16 v[20:23], v[136:139], v[164:167], v[20:23]
    ds_read_b64_tr_b16 v[124:125], v171 offset:16384
    v_mfma_f32_16x16x32_bf16 v[72:75], v[180:183], v[136:139], v[72:75]
    ds_read_b64_tr_b16 v[126:127], v171 offset:16896
    v_mfma_f32_16x16x32_bf16 v[76:79], v[184:187], v[136:139], v[76:79]
    ds_read_b128 v[108:111], v168 offset:18432
    v_mfma_f32_16x16x32_bf16 v[24:27], v[152:155], v[140:143], v[24:27]
    ds_read_b64_tr_b16 v[128:129], v170 offset:24576
    v_mfma_f32_16x16x32_bf16 v[28:31], v[156:159], v[140:143], v[28:31]
    ds_read_b64_tr_b16 v[130:131], v170 offset:25088
    v_mfma_f32_16x16x32_bf16 v[32:35], v[140:143], v[160:163], v[32:35]
    ds_read_b64_tr_b16 v[132:133], v171 offset:24576
    v_mfma_f32_16x16x32_bf16 v[36:39], v[140:143], v[164:167], v[36:39]
    ds_read_b64_tr_b16 v[134:135], v171 offset:25088
    v_mfma_f32_16x16x32_bf16 v[80:83], v[180:183], v[140:143], v[80:83]
    ds_read_b64_tr_b16 v[172:173], v189 offset:0
    v_mfma_f32_16x16x32_bf16 v[84:87], v[184:187], v[140:143], v[84:87]
    ds_read_b64_tr_b16 v[174:175], v189 offset:512
    v_mfma_f32_16x16x32_bf16 v[40:43], v[152:155], v[144:147], v[40:43]
    ds_read_b64_tr_b16 v[176:177], v191 offset:0
    v_mfma_f32_16x16x32_bf16 v[44:47], v[156:159], v[144:147], v[44:47]
    ds_read_b64_tr_b16 v[178:179], v191 offset:512
    v_mfma_f32_16x16x32_bf16 v[48:51], v[144:147], v[160:163], v[48:51]
    ds_read_b128 v[112:115], v168 offset:20480
    v_mfma_f32_16x16x32_bf16 v[52:55], v[144:147], v[164:167], v[52:55]
    ds_read_b128 v[116:119], v168 offset:22528
    v_mfma_f32_16x16x32_bf16 v[88:91], v[180:183], v[144:147], v[88:91]
    v_mfma_f32_16x16x32_bf16 v[92:95], v[184:187], v[144:147], v[92:95]
    v_mfma_f32_16x16x32_bf16 v[56:59], v[152:155], v[148:151], v[56:59]
    v_mfma_f32_16x16x32_bf16 v[60:63], v[156:159], v[148:151], v[60:63]
    v_mfma_f32_16x16x32_bf16 v[64:67], v[148:151], v[160:163], v[64:67]
    v_mfma_f32_16x16x32_bf16 v[68:71], v[148:151], v[164:167], v[68:71]
    v_mfma_f32_16x16x32_bf16 v[96:99], v[180:183], v[148:151], v[96:99]
    v_mfma_f32_16x16x32_bf16 v[100:103], v[184:187], v[148:151], v[100:103]
    s_waitcnt lgkmcnt(0)
    v_mfma_f32_16x16x32_bf16 v[8:11], v[120:123], v[104:107], v[8:11]
    ds_read_b128 v[136:139], v169 offset:16384
    v_mfma_f32_16x16x32_bf16 v[12:15], v[124:127], v[104:107], v[12:15]
    ds_read_b64_tr_b16 v[152:153], v170 offset:20480
    v_mfma_f32_16x16x32_bf16 v[16:19], v[104:107], v[128:131], v[16:19]
    ds_read_b64_tr_b16 v[154:155], v170 offset:20992
    v_mfma_f32_16x16x32_bf16 v[20:23], v[104:107], v[132:135], v[20:23]
    ds_read_b64_tr_b16 v[156:157], v171 offset:20480
    v_mfma_f32_16x16x32_bf16 v[72:75], v[172:175], v[104:107], v[72:75]
    ds_read_b64_tr_b16 v[158:159], v171 offset:20992
    v_mfma_f32_16x16x32_bf16 v[76:79], v[176:179], v[104:107], v[76:79]
    ds_read_b128 v[140:143], v169 offset:18432
    v_mfma_f32_16x16x32_bf16 v[24:27], v[120:123], v[108:111], v[24:27]
    ds_read_b64_tr_b16 v[160:161], v170 offset:28672
    v_mfma_f32_16x16x32_bf16 v[28:31], v[124:127], v[108:111], v[28:31]
    ds_read_b64_tr_b16 v[162:163], v170 offset:29184
    v_mfma_f32_16x16x32_bf16 v[32:35], v[108:111], v[128:131], v[32:35]
    ds_read_b64_tr_b16 v[164:165], v171 offset:28672
    v_mfma_f32_16x16x32_bf16 v[36:39], v[108:111], v[132:135], v[36:39]
    ds_read_b64_tr_b16 v[166:167], v171 offset:29184
    v_mfma_f32_16x16x32_bf16 v[80:83], v[172:175], v[108:111], v[80:83]
    ds_read_b64_tr_b16 v[180:181], v189 offset:4096
    v_mfma_f32_16x16x32_bf16 v[84:87], v[176:179], v[108:111], v[84:87]
    ds_read_b64_tr_b16 v[182:183], v189 offset:4608
    v_mfma_f32_16x16x32_bf16 v[40:43], v[120:123], v[112:115], v[40:43]
    ds_read_b64_tr_b16 v[184:185], v191 offset:4096
    v_mfma_f32_16x16x32_bf16 v[44:47], v[124:127], v[112:115], v[44:47]
    ds_read_b64_tr_b16 v[186:187], v191 offset:4608
    v_mfma_f32_16x16x32_bf16 v[48:51], v[112:115], v[128:131], v[48:51]
    ds_read_b128 v[144:147], v169 offset:20480
    v_mfma_f32_16x16x32_bf16 v[52:55], v[112:115], v[132:135], v[52:55]
    ds_read_b128 v[148:151], v169 offset:22528
    v_mfma_f32_16x16x32_bf16 v[88:91], v[172:175], v[112:115], v[88:91]
    v_mfma_f32_16x16x32_bf16 v[92:95], v[176:179], v[112:115], v[92:95]
    v_mfma_f32_16x16x32_bf16 v[56:59], v[120:123], v[116:119], v[56:59]
    v_mfma_f32_16x16x32_bf16 v[60:63], v[124:127], v[116:119], v[60:63]
    v_mfma_f32_16x16x32_bf16 v[64:67], v[116:119], v[128:131], v[64:67]
    v_mfma_f32_16x16x32_bf16 v[68:71], v[116:119], v[132:135], v[68:71]
    v_mfma_f32_16x16x32_bf16 v[96:99], v[172:175], v[116:119], v[96:99]
    v_mfma_f32_16x16x32_bf16 v[100:103], v[176:179], v[116:119], v[100:103]
    s_waitcnt lgkmcnt(0)
    s_barrier
    v_mfma_f32_16x16x32_bf16 v[8:11], v[152:155], v[136:139], v[8:11]
    ds_read_b128 v[104:107], v168 offset:32768
    v_mfma_f32_16x16x32_bf16 v[12:15], v[156:159], v[136:139], v[12:15]
    ds_read_b64_tr_b16 v[120:121], v170 offset:32768
    v_mfma_f32_16x16x32_bf16 v[16:19], v[136:139], v[160:163], v[16:19]
    ds_read_b64_tr_b16 v[122:123], v170 offset:33280
    v_mfma_f32_16x16x32_bf16 v[20:23], v[136:139], v[164:167], v[20:23]
    ds_read_b64_tr_b16 v[124:125], v171 offset:32768
    v_mfma_f32_16x16x32_bf16 v[72:75], v[180:183], v[136:139], v[72:75]
    ds_read_b64_tr_b16 v[126:127], v171 offset:33280
    v_mfma_f32_16x16x32_bf16 v[76:79], v[184:187], v[136:139], v[76:79]
    ds_read_b128 v[108:111], v168 offset:34816
    v_mfma_f32_16x16x32_bf16 v[24:27], v[152:155], v[140:143], v[24:27]
    ds_read_b64_tr_b16 v[128:129], v170 offset:40960
    v_mfma_f32_16x16x32_bf16 v[28:31], v[156:159], v[140:143], v[28:31]
    ds_read_b64_tr_b16 v[130:131], v170 offset:41472
    v_mfma_f32_16x16x32_bf16 v[32:35], v[140:143], v[160:163], v[32:35]
    ds_read_b64_tr_b16 v[132:133], v171 offset:40960
    v_mfma_f32_16x16x32_bf16 v[36:39], v[140:143], v[164:167], v[36:39]
    ds_read_b64_tr_b16 v[134:135], v171 offset:41472
    v_mfma_f32_16x16x32_bf16 v[80:83], v[180:183], v[140:143], v[80:83]
    ds_read_b64_tr_b16 v[172:173], v189 offset:8192
    v_mfma_f32_16x16x32_bf16 v[84:87], v[184:187], v[140:143], v[84:87]
    ds_read_b64_tr_b16 v[174:175], v189 offset:8704
    v_mfma_f32_16x16x32_bf16 v[40:43], v[152:155], v[144:147], v[40:43]
    ds_read_b64_tr_b16 v[176:177], v191 offset:8192
    v_mfma_f32_16x16x32_bf16 v[44:47], v[156:159], v[144:147], v[44:47]
    ds_read_b64_tr_b16 v[178:179], v191 offset:8704
    v_mfma_f32_16x16x32_bf16 v[48:51], v[144:147], v[160:163], v[48:51]
    ds_read_b128 v[112:115], v168 offset:36864
    v_mfma_f32_16x16x32_bf16 v[52:55], v[144:147], v[164:167], v[52:55]
    ds_read_b128 v[116:119], v168 offset:38912
    v_mfma_f32_16x16x32_bf16 v[88:91], v[180:183], v[144:147], v[88:91]
    v_mfma_f32_16x16x32_bf16 v[92:95], v[184:187], v[144:147], v[92:95]
    v_mfma_f32_16x16x32_bf16 v[56:59], v[152:155], v[148:151], v[56:59]
    v_mfma_f32_16x16x32_bf16 v[60:63], v[156:159], v[148:151], v[60:63]
    v_mfma_f32_16x16x32_bf16 v[64:67], v[148:151], v[160:163], v[64:67]
    v_mfma_f32_16x16x32_bf16 v[68:71], v[148:151], v[164:167], v[68:71]
    v_mfma_f32_16x16x32_bf16 v[96:99], v[180:183], v[148:151], v[96:99]
    v_mfma_f32_16x16x32_bf16 v[100:103], v[184:187], v[148:151], v[100:103]
    s_waitcnt lgkmcnt(0)
    v_mfma_f32_16x16x32_bf16 v[8:11], v[120:123], v[104:107], v[8:11]
    ds_read_b128 v[136:139], v169 offset:32768
    v_mfma_f32_16x16x32_bf16 v[12:15], v[124:127], v[104:107], v[12:15]
    ds_read_b64_tr_b16 v[152:153], v170 offset:36864
    v_mfma_f32_16x16x32_bf16 v[16:19], v[104:107], v[128:131], v[16:19]
    ds_read_b64_tr_b16 v[154:155], v170 offset:37376
    v_mfma_f32_16x16x32_bf16 v[20:23], v[104:107], v[132:135], v[20:23]
    ds_read_b64_tr_b16 v[156:157], v171 offset:36864
    v_mfma_f32_16x16x32_bf16 v[72:75], v[172:175], v[104:107], v[72:75]
    ds_read_b64_tr_b16 v[158:159], v171 offset:37376
    v_mfma_f32_16x16x32_bf16 v[76:79], v[176:179], v[104:107], v[76:79]
    ds_read_b128 v[140:143], v169 offset:34816
    v_mfma_f32_16x16x32_bf16 v[24:27], v[120:123], v[108:111], v[24:27]
    ds_read_b64_tr_b16 v[160:161], v170 offset:45056
    v_mfma_f32_16x16x32_bf16 v[28:31], v[124:127], v[108:111], v[28:31]
    ds_read_b64_tr_b16 v[162:163], v170 offset:45568
    v_mfma_f32_16x16x32_bf16 v[32:35], v[108:111], v[128:131], v[32:35]
    ds_read_b64_tr_b16 v[164:165], v171 offset:45056
    v_mfma_f32_16x16x32_bf16 v[36:39], v[108:111], v[132:135], v[36:39]
    ds_read_b64_tr_b16 v[166:167], v171 offset:45568
    v_mfma_f32_16x16x32_bf16 v[80:83], v[172:175], v[108:111], v[80:83]
    ds_read_b64_tr_b16 v[180:181], v189 offset:12288
    v_mfma_f32_16x16x32_bf16 v[84:87], v[176:179], v[108:111], v[84:87]
    ds_read_b64_tr_b16 v[182:183], v189 offset:12800
    v_mfma_f32_16x16x32_bf16 v[40:43], v[120:123], v[112:115], v[40:43]
    ds_read_b64_tr_b16 v[184:185], v191 offset:12288
    v_mfma_f32_16x16x32_bf16 v[44:47], v[124:127], v[112:115], v[44:47]
    ds_read_b64_tr_b16 v[186:187], v191 offset:12800
    v_mfma_f32_16x16x32_bf16 v[48:51], v[112:115], v[128:131], v[48:51]
    ds_read_b128 v[144:147], v169 offset:36864
    v_mfma_f32_16x16x32_bf16 v[52:55], v[112:115], v[132:135], v[52:55]
    ds_read_b128 v[148:151], v169 offset:38912
    v_mfma_f32_16x16x32_bf16 v[88:91], v[172:175], v[112:115], v[88:91]
    v_mfma_f32_16x16x32_bf16 v[92:95], v[176:179], v[112:115], v[92:95]
    v_mfma_f32_16x16x32_bf16 v[56:59], v[120:123], v[116:119], v[56:59]
    v_mfma_f32_16x16x32_bf16 v[60:63], v[124:127], v[116:119], v[60:63]
    v_mfma_f32_16x16x32_bf16 v[64:67], v[116:119], v[128:131], v[64:67]
    v_mfma_f32_16x16x32_bf16 v[68:71], v[116:119], v[132:135], v[68:71]
    v_mfma_f32_16x16x32_bf16 v[96:99], v[172:175], v[116:119], v[96:99]
    v_mfma_f32_16x16x32_bf16 v[100:103], v[176:179], v[116:119], v[100:103]
    s_waitcnt lgkmcnt(0)
    s_barrier
    v_mfma_f32_16x16x32_bf16 v[8:11], v[152:155], v[136:139], v[8:11]
    ds_read_b128 v[104:107], v168 offset:49152
    v_mfma_f32_16x16x32_bf16 v[12:15], v[156:159], v[136:139], v[12:15]
    ds_read_b64_tr_b16 v[120:121], v170 offset:49152
    v_mfma_f32_16x16x32_bf16 v[16:19], v[136:139], v[160:163], v[16:19]
    ds_read_b64_tr_b16 v[122:123], v170 offset:49664
    v_mfma_f32_16x16x32_bf16 v[20:23], v[136:139], v[164:167], v[20:23]
    ds_read_b64_tr_b16 v[124:125], v171 offset:49152
    v_mfma_f32_16x16x32_bf16 v[72:75], v[180:183], v[136:139], v[72:75]
    ds_read_b64_tr_b16 v[126:127], v171 offset:49664
    v_mfma_f32_16x16x32_bf16 v[76:79], v[184:187], v[136:139], v[76:79]
    ds_read_b128 v[108:111], v168 offset:51200
    v_mfma_f32_16x16x32_bf16 v[24:27], v[152:155], v[140:143], v[24:27]
    ds_read_b64_tr_b16 v[128:129], v170 offset:57344
    v_mfma_f32_16x16x32_bf16 v[28:31], v[156:159], v[140:143], v[28:31]
    ds_read_b64_tr_b16 v[130:131], v170 offset:57856
    v_mfma_f32_16x16x32_bf16 v[32:35], v[140:143], v[160:163], v[32:35]
    ds_read_b64_tr_b16 v[132:133], v171 offset:57344
    v_mfma_f32_16x16x32_bf16 v[36:39], v[140:143], v[164:167], v[36:39]
    ds_read_b64_tr_b16 v[134:135], v171 offset:57856
    v_mfma_f32_16x16x32_bf16 v[80:83], v[180:183], v[140:143], v[80:83]
    ds_read_b64_tr_b16 v[172:173], v189 offset:16384
    v_mfma_f32_16x16x32_bf16 v[84:87], v[184:187], v[140:143], v[84:87]
    ds_read_b64_tr_b16 v[174:175], v189 offset:16896
    v_mfma_f32_16x16x32_bf16 v[40:43], v[152:155], v[144:147], v[40:43]
    ds_read_b64_tr_b16 v[176:177], v191 offset:16384
    v_mfma_f32_16x16x32_bf16 v[44:47], v[156:159], v[144:147], v[44:47]
    ds_read_b64_tr_b16 v[178:179], v191 offset:16896
    v_mfma_f32_16x16x32_bf16 v[48:51], v[144:147], v[160:163], v[48:51]
    ds_read_b128 v[112:115], v168 offset:53248
    v_mfma_f32_16x16x32_bf16 v[52:55], v[144:147], v[164:167], v[52:55]
    ds_read_b128 v[116:119], v168 offset:55296
    v_mfma_f32_16x16x32_bf16 v[88:91], v[180:183], v[144:147], v[88:91]
    v_mfma_f32_16x16x32_bf16 v[92:95], v[184:187], v[144:147], v[92:95]
    v_mfma_f32_16x16x32_bf16 v[56:59], v[152:155], v[148:151], v[56:59]
    v_mfma_f32_16x16x32_bf16 v[60:63], v[156:159], v[148:151], v[60:63]
    v_mfma_f32_16x16x32_bf16 v[64:67], v[148:151], v[160:163], v[64:67]
    v_mfma_f32_16x16x32_bf16 v[68:71], v[148:151], v[164:167], v[68:71]
    v_mfma_f32_16x16x32_bf16 v[96:99], v[180:183], v[148:151], v[96:99]
    v_mfma_f32_16x16x32_bf16 v[100:103], v[184:187], v[148:151], v[100:103]
    s_waitcnt lgkmcnt(0)
    v_mfma_f32_16x16x32_bf16 v[8:11], v[120:123], v[104:107], v[8:11]
    ds_read_b128 v[136:139], v169 offset:49152
    v_mfma_f32_16x16x32_bf16 v[12:15], v[124:127], v[104:107], v[12:15]
    ds_read_b64_tr_b16 v[152:153], v170 offset:53248
    v_mfma_f32_16x16x32_bf16 v[16:19], v[104:107], v[128:131], v[16:19]
    ds_read_b64_tr_b16 v[154:155], v170 offset:53760
    v_mfma_f32_16x16x32_bf16 v[20:23], v[104:107], v[132:135], v[20:23]
    ds_read_b64_tr_b16 v[156:157], v171 offset:53248
    v_mfma_f32_16x16x32_bf16 v[72:75], v[172:175], v[104:107], v[72:75]
    ds_read_b64_tr_b16 v[158:159], v171 offset:53760
    v_mfma_f32_16x16x32_bf16 v[76:79], v[176:179], v[104:107], v[76:79]
    ds_read_b128 v[140:143], v169 offset:51200
    v_mfma_f32_16x16x32_bf16 v[24:27], v[120:123], v[108:111], v[24:27]
    ds_read_b64_tr_b16 v[160:161], v170 offset:61440
    v_mfma_f32_16x16x32_bf16 v[28:31], v[124:127], v[108:111], v[28:31]
    ds_read_b64_tr_b16 v[162:163], v170 offset:61952
    v_mfma_f32_16x16x32_bf16 v[32:35], v[108:111], v[128:131], v[32:35]
    ds_read_b64_tr_b16 v[164:165], v171 offset:61440
    v_mfma_f32_16x16x32_bf16 v[36:39], v[108:111], v[132:135], v[36:39]
    ds_read_b64_tr_b16 v[166:167], v171 offset:61952
    v_mfma_f32_16x16x32_bf16 v[80:83], v[172:175], v[108:111], v[80:83]
    ds_read_b64_tr_b16 v[180:181], v189 offset:20480
    v_mfma_f32_16x16x32_bf16 v[84:87], v[176:179], v[108:111], v[84:87]
    ds_read_b64_tr_b16 v[182:183], v189 offset:20992
    v_mfma_f32_16x16x32_bf16 v[40:43], v[120:123], v[112:115], v[40:43]
    ds_read_b64_tr_b16 v[184:185], v191 offset:20480
    v_mfma_f32_16x16x32_bf16 v[44:47], v[124:127], v[112:115], v[44:47]
    ds_read_b64_tr_b16 v[186:187], v191 offset:20992
    v_mfma_f32_16x16x32_bf16 v[48:51], v[112:115], v[128:131], v[48:51]
    ds_read_b128 v[144:147], v169 offset:53248
    v_mfma_f32_16x16x32_bf16 v[52:55], v[112:115], v[132:135], v[52:55]
    ds_read_b128 v[148:151], v169 offset:55296
    v_mfma_f32_16x16x32_bf16 v[88:91], v[172:175], v[112:115], v[88:91]
    v_mfma_f32_16x16x32_bf16 v[92:95], v[176:179], v[112:115], v[92:95]
    v_mfma_f32_16x16x32_bf16 v[56:59], v[120:123], v[116:119], v[56:59]
    v_mfma_f32_16x16x32_bf16 v[60:63], v[124:127], v[116:119], v[60:63]
    v_mfma_f32_16x16x32_bf16 v[64:67], v[116:119], v[128:131], v[64:67]
    v_mfma_f32_16x16x32_bf16 v[68:71], v[116:119], v[132:135], v[68:71]
    v_mfma_f32_16x16x32_bf16 v[96:99], v[172:175], v[116:119], v[96:99]
    v_mfma_f32_16x16x32_bf16 v[100:103], v[176:179], v[116:119], v[100:103]
L_e1:
    s_waitcnt lgkmcnt(0)
    s_barrier
    v_mfma_f32_16x16x32_bf16 v[8:11], v[152:155], v[136:139], v[8:11]
    ds_read_b128 v[104:107], v168 offset:0
    v_mfma_f32_16x16x32_bf16 v[12:15], v[156:159], v[136:139], v[12:15]
    ds_read_b64_tr_b16 v[120:121], v170 offset:0
    v_mfma_f32_16x16x32_bf16 v[16:19], v[136:139], v[160:163], v[16:19]
    ds_read_b64_tr_b16 v[122:123], v170 offset:512
    v_mfma_f32_16x16x32_bf16 v[20:23], v[136:139], v[164:167], v[20:23]
    ds_read_b64_tr_b16 v[124:125], v171 offset:0
    v_mfma_f32_16x16x32_bf16 v[72:75], v[180:183], v[136:139], v[72:75]
    ds_read_b64_tr_b16 v[126:127], v171 offset:512
    v_mfma_f32_16x16x32_bf16 v[76:79], v[184:187], v[136:139], v[76:79]
    ds_read_b128 v[108:111], v168 offset:2048
    v_mfma_f32_16x16x32_bf16 v[24:27], v[152:155], v[140:143], v[24:27]
    ds_read_b64_tr_b16 v[128:129], v170 offset:8192
    v_mfma_f32_16x16x32_bf16 v[28:31], v[156:159], v[140:143], v[28:31]
    ds_read_b64_tr_b16 v[130:131], v170 offset:8704
    v_mfma_f32_16x16x32_bf16 v[32:35], v[140:143], v[160:163], v[32:35]
    ds_read_b64_tr_b16 v[132:133], v171 offset:8192
    v_mfma_f32_16x16x32_bf16 v[36:39], v[140:143], v[164:167], v[36:39]
    ds_read_b64_tr_b16 v[134:135], v171 offset:8704
    v_mfma_f32_16x16x32_bf16 v[80:83], v[180:183], v[140:143], v[80:83]
    ds_read_b128 v[112:115], v168 offset:4096
    v_mfma_f32_16x16x32_bf16 v[84:87], v[184:187], v[140:143], v[84:87]
    ds_read_b128 v[116:119], v168 offset:6144
    v_mfma_f32_16x16x32_bf16 v[40:43], v[152:155], v[144:147], v[40:43]
    v_mfma_f32_16x16x32_bf16 v[44:47], v[156:159], v[144:147], v[44:47]
    v_mfma_f32_16x16x32_bf16 v[48:51], v[144:147], v[160:163], v[48:51]
    v_mfma_f32_16x16x32_bf16 v[52:55], v[144:147], v[164:167], v[52:55]
    v_mfma_f32_16x16x32_bf16 v[88:91], v[180:183], v[144:147], v[88:91]
    v_mfma_f32_16x16x32_bf16 v[92:95], v[184:187], v[144:147], v[92:95]
    v_mfma_f32_16x16x32_bf16 v[56:59], v[152:155], v[148:151], v[56:59]
    v_mfma_f32_16x16x32_bf16 v[60:63], v[156:159], v[148:151], v[60:63]
    v_mfma_f32_16x16x32_bf16 v[64:67], v[148:151], v[160:163], v[64:67]
    v_mfma_f32_16x16x32_bf16 v[68:71], v[148:151], v[164:167], v[68:71]
    v_mfma_f32_16x16x32_bf16 v[96:99], v[180:183], v[148:151], v[96:99]
    v_mfma_f32_16x16x32_bf16 v[100:103], v[184:187], v[148:151], v[100:103]
    s_waitcnt lgkmcnt(0)
    v_mfma_f32_16x16x32_bf16 v[8:11], v[120:123], v[104:107], v[8:11]
    ds_read_b128 v[136:139], v169 offset:0
    v_mfma_f32_16x16x32_bf16 v[12:15], v[124:127], v[104:107], v[12:15]
    ds_read_b64_tr_b16 v[152:153], v170 offset:4096
    v_mfma_f32_16x16x32_bf16 v[16:19], v[104:107], v[128:131], v[16:19]
    ds_read_b64_tr_b16 v[154:155], v170 offset:4608
    v_mfma_f32_16x16x32_bf16 v[20:23], v[104:107], v[132:135], v[20:23]
    ds_read_b64_tr_b16 v[156:157], v171 offset:4096
    v_mfma_f32_16x16x32_bf16 v[24:27], v[120:123], v[108:111], v[24:27]
    ds_read_b64_tr_b16 v[158:159], v171 offset:4608
    v_mfma_f32_16x16x32_bf16 v[28:31], v[124:127], v[108:111], v[28:31]
    ds_read_b128 v[140:143], v169 offset:2048
    v_mfma_f32_16x16x32_bf16 v[32:35], v[108:111], v[128:131], v[32:35]
    ds_read_b64_tr_b16 v[160:161], v170 offset:12288
    v_mfma_f32_16x16x32_bf16 v[36:39], v[108:111], v[132:135], v[36:39]
    ds_read_b64_tr_b16 v[162:163], v170 offset:12800
    v_mfma_f32_16x16x32_bf16 v[40:43], v[120:123], v[112:115], v[40:43]
    ds_read_b64_tr_b16 v[164:165], v171 offset:12288
    ds_read_b128 v[196:199], v243 offset:320
    v_mfma_f32_16x16x32_bf16 v[44:47], v[124:127], v[112:115], v[44:47]
    ds_read_b64_tr_b16 v[166:167], v171 offset:12800
    ds_read_b128 v[192:195], v243 offset:256
    v_mfma_f32_16x16x32_bf16 v[48:51], v[112:115], v[128:131], v[48:51]
    ds_read_b128 v[144:147], v169 offset:4096
    ds_read_b128 v[220:223], v243 offset:64
    v_mfma_f32_16x16x32_bf16 v[52:55], v[112:115], v[132:135], v[52:55]
    ds_read_b128 v[148:151], v169 offset:6144
    ds_read_b128 v[216:219], v243 offset:0
    v_mfma_f32_16x16x32_bf16 v[56:59], v[120:123], v[116:119], v[56:59]
    ds_read_b32 v186, v240 offset:192
    v_mfma_f32_16x16x32_bf16 v[60:63], v[124:127], v[116:119], v[60:63]
    ds_read_b32 v184, v240 offset:128
    v_mfma_f32_16x16x32_bf16 v[64:67], v[116:119], v[128:131], v[64:67]
    ds_read_b32 v182, v240 offset:64
    v_mfma_f32_16x16x32_bf16 v[68:71], v[116:119], v[132:135], v[68:71]
    ds_read_b32 v180, v240 offset:0
    s_waitcnt lgkmcnt(0)
    v_mov_b32 v7, 13
    ds_write_b32 v249, v7
    v_mfma_f32_16x16x32_bf16 v[8:11], v[152:155], v[136:139], v[8:11]
    ds_read_b128 v[104:107], v168 offset:16384
    v_mfma_f32_16x16x32_bf16 v[12:15], v[156:159], v[136:139], v[12:15]
    ds_read_b64_tr_b16 v[120:121], v170 offset:16384
    v_mfma_f32_16x16x32_bf16 v[16:19], v[136:139], v[160:163], v[16:19]
    ds_read_b64_tr_b16 v[122:123], v170 offset:16896
    v_mfma_f32_16x16x32_bf16 v[20:23], v[136:139], v[164:167], v[20:23]
    ds_read_b64_tr_b16 v[124:125], v171 offset:16384
    v_mfma_f32_16x16x32_bf16 v[24:27], v[152:155], v[140:143], v[24:27]
    ds_read_b64_tr_b16 v[126:127], v171 offset:16896
    v_mfma_f32_16x16x32_bf16 v[28:31], v[156:159], v[140:143], v[28:31]
    ds_read_b128 v[108:111], v168 offset:18432
    v_mfma_f32_16x16x32_bf16 v[32:35], v[140:143], v[160:163], v[32:35]
    ds_read_b64_tr_b16 v[128:129], v170 offset:24576
    v_mfma_f32_16x16x32_bf16 v[36:39], v[140:143], v[164:167], v[36:39]
    ds_read_b64_tr_b16 v[130:131], v170 offset:25088
    v_mfma_f32_16x16x32_bf16 v[40:43], v[152:155], v[144:147], v[40:43]
    ds_read_b64_tr_b16 v[132:133], v171 offset:24576
    v_mfma_f32_16x16x32_bf16 v[44:47], v[156:159], v[144:147], v[44:47]
    ds_read_b64_tr_b16 v[134:135], v171 offset:25088
    v_mfma_f32_16x16x32_bf16 v[48:51], v[144:147], v[160:163], v[48:51]
    ds_read_b128 v[112:115], v168 offset:20480
    ds_read_b128 v[212:215], v242 offset:192
    v_mfma_f32_16x16x32_bf16 v[52:55], v[144:147], v[164:167], v[52:55]
    ds_read_b128 v[116:119], v168 offset:22528
    ds_read_b128 v[208:211], v242 offset:128
    v_mfma_f32_16x16x32_bf16 v[56:59], v[152:155], v[148:151], v[56:59]
    ds_read_b128 v[204:207], v242 offset:64
    v_mfma_f32_16x16x32_bf16 v[60:63], v[156:159], v[148:151], v[60:63]
    ds_read_b128 v[200:203], v242 offset:0
    v_mfma_f32_16x16x32_bf16 v[64:67], v[148:151], v[160:163], v[64:67]
    ds_read_b32 v190, v244 offset:576
    v_mfma_f32_16x16x32_bf16 v[68:71], v[148:151], v[164:167], v[68:71]
    ds_read_b32 v188, v244 offset:512
    s_waitcnt lgkmcnt(0)
    v_mfma_f32_16x16x32_bf16 v[8:11], v[120:123], v[104:107], v[8:11]
    ds_read_b128 v[136:139], v169 offset:16384
    v_fmac_f32 v40, v184, v192
    v_mfma_f32_16x16x32_bf16 v[12:15], v[124:127], v[104:107], v[12:15]
    ds_read_b64_tr_b16 v[152:153], v170 offset:20480
    v_fmac_f32 v44, v184, v196
    v_mfma_f32_16x16x32_bf16 v[16:19], v[104:107], v[128:131], v[16:19]
    ds_read_b64_tr_b16 v[154:155], v170 offset:20992
    v_fmac_f32 v48, v208, v188
    v_mfma_f32_16x16x32_bf16 v[20:23], v[104:107], v[132:135], v[20:23]
    ds_read_b64_tr_b16 v[156:157], v171 offset:20480
    v_fmac_f32 v52, v208, v190
    v_mfma_f32_16x16x32_bf16 v[24:27], v[120:123], v[108:111], v[24:27]
    ds_read_b64_tr_b16 v[158:159], v171 offset:20992
    v_fmac_f32 v56, v186, v192
    v_mfma_f32_16x16x32_bf16 v[28:31], v[124:127], v[108:111], v[28:31]
    ds_read_b128 v[140:143], v169 offset:18432
    v_fmac_f32 v60, v186, v196
    v_mfma_f32_16x16x32_bf16 v[32:35], v[108:111], v[128:131], v[32:35]
    ds_read_b64_tr_b16 v[160:161], v170 offset:28672
    v_fmac_f32 v64, v212, v188
    v_mfma_f32_16x16x32_bf16 v[36:39], v[108:111], v[132:135], v[36:39]
    ds_read_b64_tr_b16 v[162:163], v170 offset:29184
    v_fmac_f32 v68, v212, v190
    v_mfma_f32_16x16x32_bf16 v[40:43], v[120:123], v[112:115], v[40:43]
    ds_read_b64_tr_b16 v[164:165], v171 offset:28672
    v_fmac_f32 v8, v180, v192
    v_mfma_f32_16x16x32_bf16 v[44:47], v[124:127], v[112:115], v[44:47]
    ds_read_b64_tr_b16 v[166:167], v171 offset:29184
    v_fmac_f32 v12, v180, v196
    v_mfma_f32_16x16x32_bf16 v[48:51], v[112:115], v[128:131], v[48:51]
    ds_read_b128 v[144:147], v169 offset:20480
    v_fmac_f32 v16, v200, v188
    v_mfma_f32_16x16x32_bf16 v[52:55], v[112:115], v[132:135], v[52:55]
    ds_read_b128 v[148:151], v169 offset:22528
    v_fmac_f32 v20, v200, v190
    v_mfma_f32_16x16x32_bf16 v[56:59], v[120:123], v[116:119], v[56:59]
    ds_read_b64 v[238:239], v251 offset:64
    v_fmac_f32 v24, v182, v192
    ds_read_b64_tr_b16 v[178:179], v246 offset:1056
    v_mfma_f32_16x16x32_bf16 v[60:63], v[124:127], v[116:119], v[60:63]
    v_fmac_f32 v28, v182, v196
    ds_read_b64_tr_b16 v[176:177], v246 offset:32
    v_mfma_f32_16x16x32_bf16 v[64:67], v[116:119], v[128:131], v[64:67]
    v_fmac_f32 v32, v204, v188
    ds_read_b64_tr_b16 v[174:175], v246 offset:1024
    v_mfma_f32_16x16x32_bf16 v[68:71], v[116:119], v[132:135], v[68:71]
    v_fmac_f32 v36, v204, v190
    ds_read_b64_tr_b16 v[172:173], v246 offset:0
    s_waitcnt lgkmcnt(0)
    v_mov_b32 v7, 14
    ds_write_b32 v249, v7
L_la14:
    v_min_u32 v238, v238, v239
    s_nop 0
    v_readfirstlane_b32 s3, v238
    s_nop 0
    s_cmp_ge_u32 s3, 14
    s_cbranch_scc1 L_lad14
    ds_read_b64 v[238:239], v251 offset:64
    s_waitcnt lgkmcnt(0)
    s_branch L_la14
L_lad14:
    v_mfma_f32_16x16x32_bf16 v[8:11], v[152:155], v[136:139], v[8:11]
    ds_read_b128 v[104:107], v168 offset:32768
    v_fmac_f32 v41, v184, v193
    v_mfma_f32_16x16x32_bf16 v[12:15], v[156:159], v[136:139], v[12:15]
    ds_read_b64_tr_b16 v[120:121], v170 offset:32768
    v_fmac_f32 v45, v184, v197
    v_mfma_f32_16x16x32_bf16 v[16:19], v[136:139], v[160:163], v[16:19]
    ds_read_b64_tr_b16 v[122:123], v170 offset:33280
    v_fmac_f32 v49, v209, v188
    v_mfma_f32_16x16x32_bf16 v[20:23], v[136:139], v[164:167], v[20:23]
    ds_read_b64_tr_b16 v[124:125], v171 offset:32768
    v_fmac_f32 v53, v209, v190
    v_mfma_f32_16x16x32_bf16 v[24:27], v[152:155], v[140:143], v[24:27]
    ds_read_b64_tr_b16 v[126:127], v171 offset:33280
    v_fmac_f32 v57, v186, v193
    v_mfma_f32_16x16x32_bf16 v[28:31], v[156:159], v[140:143], v[28:31]
    ds_read_b128 v[108:111], v168 offset:34816
    v_fmac_f32 v61, v186, v197
    v_mfma_f32_16x16x32_bf16 v[32:35], v[140:143], v[160:163], v[32:35]
    ds_read_b64_tr_b16 v[128:129], v170 offset:40960
    v_fmac_f32 v65, v213, v188
    v_mfma_f32_16x16x32_bf16 v[36:39], v[140:143], v[164:167], v[36:39]
    ds_read_b64_tr_b16 v[130:131], v170 offset:41472
    v_fmac_f32 v69, v213, v190
    v_mfma_f32_16x16x32_bf16 v[40:43], v[152:155], v[144:147], v[40:43]
    ds_read_b64_tr_b16 v[132:133], v171 offset:40960
    v_fmac_f32 v9, v180, v193
    v_mfma_f32_16x16x32_bf16 v[44:47], v[156:159], v[144:147], v[44:47]
    ds_read_b64_tr_b16 v[134:135], v171 offset:41472
    v_fmac_f32 v13, v180, v197
    v_mfma_f32_16x16x32_bf16 v[48:51], v[144:147], v[160:163], v[48:51]
    ds_read_b128 v[112:115], v168 offset:36864
    v_fmac_f32 v17, v201, v188
    v_mfma_f32_16x16x32_bf16 v[52:55], v[144:147], v[164:167], v[52:55]
    ds_read_b128 v[116:119], v168 offset:38912
    v_fmac_f32 v21, v201, v190
    v_mfma_f32_16x16x32_bf16 v[56:59], v[152:155], v[148:151], v[56:59]
    v_fmac_f32 v25, v182, v193
    ds_read_b32 v254, v240 offset:3776
    v_mfma_f32_16x16x32_bf16 v[60:63], v[156:159], v[148:151], v[60:63]
    v_fmac_f32 v29, v182, v197
    ds_read_b32 v252, v240 offset:3712
    v_mfma_f32_16x16x32_bf16 v[64:67], v[148:151], v[160:163], v[64:67]
    v_fmac_f32 v33, v205, v188
    ds_read_b32 v250, v240 offset:3648
    v_mfma_f32_16x16x32_bf16 v[68:71], v[148:151], v[164:167], v[68:71]
    v_fmac_f32 v37, v205, v190
    ds_read_b32 v248, v240 offset:3584
    s_waitcnt lgkmcnt(0)
    v_mfma_f32_16x16x32_bf16 v[8:11], v[120:123], v[104:107], v[8:11]
    ds_read_b128 v[136:139], v169 offset:32768
    v_fmac_f32 v42, v184, v194
    v_mfma_f32_16x16x32_bf16 v[12:15], v[124:127], v[104:107], v[12:15]
    ds_read_b64_tr_b16 v[152:153], v170 offset:36864
    v_fmac_f32 v46, v184, v198
    v_mfma_f32_16x16x32_bf16 v[16:19], v[104:107], v[128:131], v[16:19]
    ds_read_b64_tr_b16 v[154:155], v170 offset:37376
    v_fmac_f32 v50, v210, v188
    v_mfma_f32_16x16x32_bf16 v[20:23], v[104:107], v[132:135], v[20:23]
    ds_read_b64_tr_b16 v[156:157], v171 offset:36864
    v_fmac_f32 v54, v210, v190
    v_mfma_f32_16x16x32_bf16 v[24:27], v[120:123], v[108:111], v[24:27]
    ds_read_b64_tr_b16 v[158:159], v171 offset:37376
    v_fmac_f32 v58, v186, v194
    v_mfma_f32_16x16x32_bf16 v[28:31], v[124:127], v[108:111], v[28:31]
    ds_read_b128 v[140:143], v169 offset:34816
    v_fmac_f32 v62, v186, v198
    v_mfma_f32_16x16x32_bf16 v[32:35], v[108:111], v[128:131], v[32:35]
    ds_read_b64_tr_b16 v[160:161], v170 offset:45056
    v_fmac_f32 v66, v214, v188
    v_mfma_f32_16x16x32_bf16 v[36:39], v[108:111], v[132:135], v[36:39]
    ds_read_b64_tr_b16 v[162:163], v170 offset:45568
    v_fmac_f32 v70, v214, v190
    v_mfma_f32_16x16x32_bf16 v[40:43], v[120:123], v[112:115], v[40:43]
    ds_read_b64_tr_b16 v[164:165], v171 offset:45056
    v_fmac_f32 v10, v180, v194
    v_mfma_f32_16x16x32_bf16 v[44:47], v[124:127], v[112:115], v[44:47]
    ds_read_b64_tr_b16 v[166:167], v171 offset:45568
    v_fmac_f32 v14, v180, v198
    v_mfma_f32_16x16x32_bf16 v[48:51], v[112:115], v[128:131], v[48:51]
    ds_read_b128 v[144:147], v169 offset:36864
    v_fmac_f32 v18, v202, v188
    v_mfma_f32_16x16x32_bf16 v[52:55], v[112:115], v[132:135], v[52:55]
    ds_read_b128 v[148:151], v169 offset:38912
    v_fmac_f32 v22, v202, v190
    v_mfma_f32_16x16x32_bf16 v[56:59], v[120:123], v[116:119], v[56:59]
    ds_read_b64 v[238:239], v251 offset:64
    v_fmac_f32 v26, v182, v194
    ds_read_b32 v181, v241 offset:3584
    v_mfma_f32_16x16x32_bf16 v[60:63], v[124:127], v[116:119], v[60:63]
    v_fmac_f32 v30, v182, v198
    ds_read_b32 v183, v241 offset:512
    v_mfma_f32_16x16x32_bf16 v[64:67], v[116:119], v[128:131], v[64:67]
    v_fmac_f32 v34, v206, v188
    ds_read_b32 v187, v251 offset:8
    v_mfma_f32_16x16x32_bf16 v[68:71], v[116:119], v[132:135], v[68:71]
    v_fmac_f32 v38, v206, v190
    ds_read_b32 v185, v251 offset:16
    s_waitcnt lgkmcnt(0)
    v_mov_b32 v7, 15
    ds_write_b32 v249, v7
L_la15:
    v_min_u32 v238, v238, v239
    s_nop 0
    v_readfirstlane_b32 s3, v238
    s_nop 0
    s_cmp_ge_u32 s3, 15
    s_cbranch_scc1 L_lad15
    ds_read_b64 v[238:239], v251 offset:64
    s_waitcnt lgkmcnt(0)
    s_branch L_la15
L_lad15:
    v_mfma_f32_16x16x32_bf16 v[8:11], v[152:155], v[136:139], v[8:11]
    ds_read_b128 v[104:107], v168 offset:49152
    v_fmac_f32 v43, v184, v195
    v_mfma_f32_16x16x32_bf16 v[12:15], v[156:159], v[136:139], v[12:15]
    ds_read_b64_tr_b16 v[120:121], v170 offset:49152
    v_fmac_f32 v47, v184, v199
    v_mfma_f32_16x16x32_bf16 v[16:19], v[136:139], v[160:163], v[16:19]
    ds_read_b64_tr_b16 v[122:123], v170 offset:49664
    v_fmac_f32 v51, v211, v188
    v_mfma_f32_16x16x32_bf16 v[20:23], v[136:139], v[164:167], v[20:23]
    ds_read_b64_tr_b16 v[124:125], v171 offset:49152
    v_fmac_f32 v55, v211, v190
    v_mfma_f32_16x16x32_bf16 v[24:27], v[152:155], v[140:143], v[24:27]
    ds_read_b64_tr_b16 v[126:127], v171 offset:49664
    v_fmac_f32 v59, v186, v195
    v_mfma_f32_16x16x32_bf16 v[28:31], v[156:159], v[140:143], v[28:31]
    ds_read_b128 v[108:111], v168 offset:51200
    v_fmac_f32 v63, v186, v199
    v_mfma_f32_16x16x32_bf16 v[32:35], v[140:143], v[160:163], v[32:35]
    ds_read_b64_tr_b16 v[128:129], v170 offset:57344
    v_fmac_f32 v67, v215, v188
    v_mfma_f32_16x16x32_bf16 v[36:39], v[140:143], v[164:167], v[36:39]
    ds_read_b64_tr_b16 v[130:131], v170 offset:57856
    v_fmac_f32 v71, v215, v190
    v_mfma_f32_16x16x32_bf16 v[40:43], v[152:155], v[144:147], v[40:43]
    ds_read_b64_tr_b16 v[132:133], v171 offset:57344
    v_fmac_f32 v11, v180, v195
    v_mfma_f32_16x16x32_bf16 v[44:47], v[156:159], v[144:147], v[44:47]
    ds_read_b64_tr_b16 v[134:135], v171 offset:57856
    v_fmac_f32 v15, v180, v199
    v_mfma_f32_16x16x32_bf16 v[48:51], v[144:147], v[160:163], v[48:51]
    ds_read_b128 v[112:115], v168 offset:53248
    v_fmac_f32 v19, v203, v188
    v_mfma_f32_16x16x32_bf16 v[52:55], v[144:147], v[164:167], v[52:55]
    ds_read_b128 v[116:119], v168 offset:55296
    v_fmac_f32 v23, v203, v190
    v_mfma_f32_16x16x32_bf16 v[56:59], v[152:155], v[148:151], v[56:59]
    v_fmac_f32 v27, v182, v195
    v_mfma_f32_16x16x32_bf16 v[60:63], v[156:159], v[148:151], v[60:63]
    v_fmac_f32 v31, v182, v199
    v_mfma_f32_16x16x32_bf16 v[64:67], v[148:151], v[160:163], v[64:67]
    v_fmac_f32 v35, v207, v188
    v_mfma_f32_16x16x32_bf16 v[68:71], v[148:151], v[164:167], v[68:71]
    v_fmac_f32 v39, v207, v190
    s_waitcnt lgkmcnt(0)
    v_mfma_f32_16x16x32_bf16 v[8:11], v[120:123], v[104:107], v[8:11]
    ds_read_b128 v[136:139], v169 offset:49152
    v_mfma_f32_16x16x32_bf16 v[12:15], v[124:127], v[104:107], v[12:15]
    ds_read_b64_tr_b16 v[152:153], v170 offset:53248
    v_mfma_f32_16x16x32_bf16 v[16:19], v[104:107], v[128:131], v[16:19]
    ds_read_b64_tr_b16 v[154:155], v170 offset:53760
    v_mfma_f32_16x16x32_bf16 v[20:23], v[104:107], v[132:135], v[20:23]
    ds_read_b64_tr_b16 v[156:157], v171 offset:53248
    v_mfma_f32_16x16x32_bf16 v[24:27], v[120:123], v[108:111], v[24:27]
    ds_read_b64_tr_b16 v[158:159], v171 offset:53760
    v_mfma_f32_16x16x32_bf16 v[28:31], v[124:127], v[108:111], v[28:31]
    ds_read_b128 v[140:143], v169 offset:51200
    v_mfma_f32_16x16x32_bf16 v[32:35], v[108:111], v[128:131], v[32:35]
    ds_read_b64_tr_b16 v[160:161], v170 offset:61440
    v_mfma_f32_16x16x32_bf16 v[36:39], v[108:111], v[132:135], v[36:39]
    ds_read_b64_tr_b16 v[162:163], v170 offset:61952
    v_mfma_f32_16x16x32_bf16 v[40:43], v[120:123], v[112:115], v[40:43]
    ds_read_b64_tr_b16 v[164:165], v171 offset:61440
    v_mfma_f32_16x16x32_bf16 v[44:47], v[124:127], v[112:115], v[44:47]
    ds_read_b64_tr_b16 v[166:167], v171 offset:61952
    v_mfma_f32_16x16x32_bf16 v[48:51], v[112:115], v[128:131], v[48:51]
    ds_read_b128 v[144:147], v169 offset:53248
    v_mov_b32 v246, s76
    v_mfma_f32_16x16x32_bf16 v[52:55], v[112:115], v[132:135], v[52:55]
    ds_read_b128 v[148:151], v169 offset:55296
    v_add_u32 v244, s75, v5
    v_mfma_f32_16x16x32_bf16 v[56:59], v[120:123], v[116:119], v[56:59]
    v_add_u32 v243, s74, v5
    v_mfma_f32_16x16x32_bf16 v[60:63], v[124:127], v[116:119], v[60:63]
    v_add_u32 v242, s73, v6
    v_mfma_f32_16x16x32_bf16 v[64:67], v[116:119], v[128:131], v[64:67]
    v_add_u32 v241, s72, v6
    v_mfma_f32_16x16x32_bf16 v[68:71], v[116:119], v[132:135], v[68:71]
    v_add_u32 v240, s72, v4
    s_waitcnt lgkmcnt(0)
    v_mov_b32 v7, 16
    ds_write_b32 v249, v7
    v_mfma_f32_16x16x32_bf16 v[8:11], v[152:155], v[136:139], v[8:11]
    ds_read_b64 v[200:201], v245 offset:0
    v_mfma_f32_16x16x32_bf16 v[12:15], v[156:159], v[136:139], v[12:15]
    ds_read_b64 v[202:203], v245 offset:32
    v_mfma_f32_16x16x32_bf16 v[24:27], v[152:155], v[140:143], v[24:27]
    ds_read_b64 v[204:205], v245 offset:64
    v_mfma_f32_16x16x32_bf16 v[28:31], v[156:159], v[140:143], v[28:31]
    ds_read_b64 v[206:207], v245 offset:96
    v_mfma_f32_16x16x32_bf16 v[40:43], v[152:155], v[144:147], v[40:43]
    ds_read_b64 v[208:209], v247 offset:0
    v_mfma_f32_16x16x32_bf16 v[44:47], v[156:159], v[144:147], v[44:47]
    ds_read_b64 v[210:211], v247 offset:32
    v_mfma_f32_16x16x32_bf16 v[56:59], v[152:155], v[148:151], v[56:59]
    ds_read_b64 v[212:213], v247 offset:64
    v_mfma_f32_16x16x32_bf16 v[60:63], v[156:159], v[148:151], v[60:63]
    ds_read_b64 v[214:215], v247 offset:96
    v_mfma_f32_16x16x32_bf16 v[16:19], v[136:139], v[160:163], v[16:19]
    v_cvt_pk_bf16_f32 v104, v8, v9
L_hk8:
    s_cbranch_execz L_hr8
    v_cvt_pk_bf16_f32 v105, v10, v11
    v_mfma_f32_16x16x32_bf16 v[20:23], v[136:139], v[164:167], v[20:23]
    v_cvt_pk_bf16_f32 v106, v12, v13
    v_cvt_pk_bf16_f32 v107, v14, v15
    v_mfma_f32_16x16x32_bf16 v[32:35], v[140:143], v[160:163], v[32:35]
    v_cvt_pk_bf16_f32 v108, v24, v25
    v_cvt_pk_bf16_f32 v109, v26, v27
    v_mfma_f32_16x16x32_bf16 v[36:39], v[140:143], v[164:167], v[36:39]
    v_cvt_pk_bf16_f32 v110, v28, v29
    v_cvt_pk_bf16_f32 v111, v30, v31
    v_mfma_f32_16x16x32_bf16 v[48:51], v[144:147], v[160:163], v[48:51]
    v_cvt_pk_bf16_f32 v112, v40, v41
    v_cvt_pk_bf16_f32 v113, v42, v43
    v_mfma_f32_16x16x32_bf16 v[52:55], v[144:147], v[164:167], v[52:55]
    v_cvt_pk_bf16_f32 v114, v44, v45
    v_cvt_pk_bf16_f32 v115, v46, v47
    v_mfma_f32_16x16x32_bf16 v[64:67], v[148:151], v[160:163], v[64:67]
    v_cvt_pk_bf16_f32 v116, v56, v57
    v_cvt_pk_bf16_f32 v117, v58, v59
    v_mfma_f32_16x16x32_bf16 v[68:71], v[148:151], v[164:167], v[68:71]
    v_cvt_pk_bf16_f32 v118, v60, v61
    v_cvt_pk_bf16_f32 v119, v62, v63
    v_readfirstlane_b32 s88, v185
    v_readfirstlane_b32 s32, v187
    v_mfma_f32_16x16x32_bf16 v[120:123], v[172:175], v[104:107], 0
    v_cvt_pk_bf16_f32 v152, v16, v17
    v_cvt_pk_bf16_f32 v153, v18, v19
    v_mfma_f32_16x16x32_bf16 v[124:127], v[176:179], v[104:107], 0
    v_cvt_pk_bf16_f32 v156, v20, v21
    v_cvt_pk_bf16_f32 v157, v22, v23
    v_mfma_f32_16x16x32_bf16 v[128:131], v[172:175], v[108:111], 0
    v_cvt_pk_bf16_f32 v154, v32, v33
L_hk9:
    s_cbranch_execz L_hr9
    v_cvt_pk_bf16_f32 v155, v34, v35
    v_mfma_f32_16x16x32_bf16 v[132:135], v[176:179], v[108:111], 0
    v_cvt_pk_bf16_f32 v158, v36, v37
    v_cvt_pk_bf16_f32 v159, v38, v39
    v_mfma_f32_16x16x32_bf16 v[136:139], v[172:175], v[112:115], 0
    v_cvt_pk_bf16_f32 v160, v48, v49
    v_cvt_pk_bf16_f32 v161, v50, v51
    v_mfma_f32_16x16x32_bf16 v[140:143], v[176:179], v[112:115], 0
    v_cvt_pk_bf16_f32 v164, v52, v53
    v_cvt_pk_bf16_f32 v165, v54, v55
    v_mfma_f32_16x16x32_bf16 v[144:147], v[172:175], v[116:119], 0
    v_cvt_pk_bf16_f32 v162, v64, v65
    v_cvt_pk_bf16_f32 v163, v66, v67
    v_mfma_f32_16x16x32_bf16 v[148:151], v[176:179], v[116:119], 0
    v_cvt_pk_bf16_f32 v166, v68, v69
    v_cvt_pk_bf16_f32 v167, v70, v71
    ds_read_b128 v[192:195], v251 offset:80
    v_max3_f32 v224, v120, v121, v122
    v_min3_f32 v232, v120, v121, v122
    v_max3_f32 v224, v224, v123, v124
    v_min3_f32 v232, v232, v123, v124
    v_max3_f32 v224, v224, v125, v126
    v_min3_f32 v232, v232, v125, v126
    v_max_f32 v224, v224, v127
    v_min_f32 v232, v232, v127
    v_max3_f32 v226, v128, v129, v130
    v_min3_f32 v234, v128, v129, v130
    v_max3_f32 v226, v226, v131, v132
    v_min3_f32 v234, v234, v131, v132
    v_max3_f32 v226, v226, v133, v134
    v_min3_f32 v234, v234, v133, v134
    v_max_f32 v226, v226, v135
L_hk10:
    s_cbranch_execz L_hr10
    v_min_f32 v234, v234, v135
    v_max3_f32 v228, v136, v137, v138
    v_min3_f32 v236, v136, v137, v138
    v_max3_f32 v228, v228, v139, v140
    v_min3_f32 v236, v236, v139, v140
    v_max3_f32 v228, v228, v141, v142
    v_min3_f32 v236, v236, v141, v142
    v_max_f32 v228, v228, v143
    v_min_f32 v236, v236, v143
    v_max3_f32 v230, v144, v145, v146
    v_min3_f32 v238, v144, v145, v146
    v_max3_f32 v230, v230, v147, v148
    v_min3_f32 v238, v238, v147, v148
    v_max3_f32 v230, v230, v149, v150
    v_min3_f32 v238, v238, v149, v150
    v_max_f32 v230, v230, v151
    v_min_f32 v238, v238, v151
    v_permlane32_swap_b32 v224, v228
    v_permlane32_swap_b32 v226, v230
    v_permlane32_swap_b32 v232, v236
    v_permlane32_swap_b32 v234, v238
    v_max_f32 v224, v224, v228
    v_max_f32 v226, v226, v230
    v_min_f32 v232, v232, v236
    v_min_f32 v234, v234, v238
    v_permlane16_swap_b32 v224, v226
    s_nop 0
    v_permlane16_swap_b32 v232, v234
    v_max_f32 v224, v224, v226
    v_min_f32 v232, v232, v234
    v_mul_f32 v224, v224, v181
    v_mul_f32 v232, v232, v181
L_hk11:
    s_cbranch_execz L_hr11
    v_mov_b32 v226, v224
    v_mov_b32 v234, v232
    s_nop 0
    v_permlane16_swap_b32 v224, v226
    v_permlane16_swap_b32 v232, v234
    v_mov_b32 v228, v224
    v_mov_b32 v230, v226
    v_mov_b32 v236, v232
    v_mov_b32 v238, v234
    v_permlane32_swap_b32 v224, v228
    v_permlane32_swap_b32 v226, v230
    v_permlane32_swap_b32 v232, v236
    v_permlane32_swap_b32 v234, v238
    v_pk_fma_f32 v[8:9], v[120:121], v[248:249], v[224:225] op_sel_hi:[1,0,0] neg_lo:[0,0,1] neg_hi:[0,0,1]
    v_pk_fma_f32 v[16:17], v[120:121], v[248:249], v[232:233] op_sel_hi:[1,0,0] neg_lo:[1,0,0] neg_hi:[1,0,0]
    v_pk_fma_f32 v[10:11], v[122:123], v[248:249], v[224:225] op_sel_hi:[1,0,0] neg_lo:[0,0,1] neg_hi:[0,0,1]
    v_pk_fma_f32 v[18:19], v[122:123], v[248:249], v[232:233] op_sel_hi:[1,0,0] neg_lo:[1,0,0] neg_hi:[1,0,0]
    v_pk_fma_f32 v[12:13], v[124:125], v[248:249], v[224:225] op_sel_hi:[1,0,0] neg_lo:[0,0,1] neg_hi:[0,0,1]
    v_pk_fma_f32 v[20:21], v[124:125], v[248:249], v[232:233] op_sel_hi:[1,0,0] neg_lo:[1,0,0] neg_hi:[1,0,0]
    v_pk_fma_f32 v[14:15], v[126:127], v[248:249], v[224:225] op_sel_hi:[1,0,0] neg_lo:[0,0,1] neg_hi:[0,0,1]
    v_pk_fma_f32 v[22:23], v[126:127], v[248:249], v[232:233] op_sel_hi:[1,0,0] neg_lo:[1,0,0] neg_hi:[1,0,0]
L_sf:
    s_waitcnt lgkmcnt(0)
    v_min_u32 v192, v192, v193
    v_min3_u32 v192, v192, v194, v195
    s_nop 0
    v_readfirstlane_b32 s3, v192
    s_nop 0
    s_cmp_ge_u32 s3, 16
    s_cbranch_scc1 L_sfd
    ds_read_b128 v[192:195], v251 offset:80
    s_branch L_sf
L_sfd:
    ds_write_b128 v243, v[152:155] offset:0
    v_exp_f32 v8, v8
L_hk12:
    s_cbranch_execz L_hr12
    v_exp_f32 v9, v9
    v_exp_f32 v10, v10
    v_exp_f32 v11, v11
    v_exp_f32 v12, v12
    v_exp_f32 v13, v13
    v_exp_f32 v14, v14
    v_exp_f32 v15, v15
    v_exp_f32 v16, v16
    v_exp_f32 v17, v17
    v_exp_f32 v18, v18
    v_exp_f32 v19, v19
    v_exp_f32 v20, v20
    v_exp_f32 v21, v21
    v_exp_f32 v22, v22
    v_exp_f32 v23, v23
    v_pk_fma_f32 v[24:25], v[128:129], v[250:251], v[226:227] op_sel_hi:[1,0,0] neg_lo:[0,0,1] neg_hi:[0,0,1]
    v_pk_fma_f32 v[32:33], v[128:129], v[250:251], v[234:235] op_sel_hi:[1,0,0] neg_lo:[1,0,0] neg_hi:[1,0,0]
    v_pk_fma_f32 v[26:27], v[130:131], v[250:251], v[226:227] op_sel_hi:[1,0,0] neg_lo:[0,0,1] neg_hi:[0,0,1]
    v_pk_fma_f32 v[34:35], v[130:131], v[250:251], v[234:235] op_sel_hi:[1,0,0] neg_lo:[1,0,0] neg_hi:[1,0,0]
    v_pk_fma_f32 v[28:29], v[132:133], v[250:251], v[226:227] op_sel_hi:[1,0,0] neg_lo:[0,0,1] neg_hi:[0,0,1]
    v_pk_fma_f32 v[36:37], v[132:133], v[250:251], v[234:235] op_sel_hi:[1,0,0] neg_lo:[1,0,0] neg_hi:[1,0,0]
    v_pk_fma_f32 v[30:31], v[134:135], v[250:251], v[226:227] op_sel_hi:[1,0,0] neg_lo:[0,0,1] neg_hi:[0,0,1]
    v_pk_fma_f32 v[38:39], v[134:135], v[250:251], v[234:235] op_sel_hi:[1,0,0] neg_lo:[1,0,0] neg_hi:[1,0,0]
    ds_write_b128 v243, v[156:159] offset:1024
    v_exp_f32 v24, v24
    v_exp_f32 v25, v25
    v_exp_f32 v26, v26
    v_exp_f32 v27, v27
    v_exp_f32 v28, v28
    v_exp_f32 v29, v29
    v_exp_f32 v30, v30
    v_exp_f32 v31, v31
L_hk13:
    s_cbranch_execz L_hr13
    v_exp_f32 v32, v32
    v_exp_f32 v33, v33
    v_exp_f32 v34, v34
    v_exp_f32 v35, v35
    v_exp_f32 v36, v36
    v_exp_f32 v37, v37
    v_exp_f32 v38, v38
    v_exp_f32 v39, v39
    v_pk_fma_f32 v[40:41], v[136:137], v[252:253], v[228:229] op_sel_hi:[1,0,0] neg_lo:[0,0,1] neg_hi:[0,0,1]
    v_pk_fma_f32 v[48:49], v[136:137], v[252:253], v[236:237] op_sel_hi:[1,0,0] neg_lo:[1,0,0] neg_hi:[1,0,0]
    v_pk_fma_f32 v[42:43], v[138:139], v[252:253], v[228:229] op_sel_hi:[1,0,0] neg_lo:[0,0,1] neg_hi:[0,0,1]
    v_pk_fma_f32 v[50:51], v[138:139], v[252:253], v[236:237] op_sel_hi:[1,0,0] neg_lo:[1,0,0] neg_hi:[1,0,0]
    v_pk_fma_f32 v[44:45], v[140:141], v[252:253], v[228:229] op_sel_hi:[1,0,0] neg_lo:[0,0,1] neg_hi:[0,0,1]
    v_pk_fma_f32 v[52:53], v[140:141], v[252:253], v[236:237] op_sel_hi:[1,0,0] neg_lo:[1,0,0] neg_hi:[1,0,0]
    v_pk_fma_f32 v[46:47], v[142:143], v[252:253], v[228:229] op_sel_hi:[1,0,0] neg_lo:[0,0,1] neg_hi:[0,0,1]
    v_pk_fma_f32 v[54:55], v[142:143], v[252:253], v[236:237] op_sel_hi:[1,0,0] neg_lo:[1,0,0] neg_hi:[1,0,0]
    ds_write_b128 v243, v[160:163] offset:2048
    v_exp_f32 v40, v40
    v_exp_f32 v41, v41
    v_exp_f32 v42, v42
    v_exp_f32 v43, v43
    v_exp_f32 v44, v44
    v_exp_f32 v45, v45
    v_exp_f32 v46, v46
    v_exp_f32 v47, v47
    v_exp_f32 v48, v48
    v_exp_f32 v49, v49
    v_exp_f32 v50, v50
    v_exp_f32 v51, v51
    v_exp_f32 v52, v52
    v_exp_f32 v53, v53
    v_exp_f32 v54, v54
L_hk14:
    s_cbranch_execz L_hr14
    v_exp_f32 v55, v55
    v_pk_fma_f32 v[56:57], v[144:145], v[254:255], v[230:231] op_sel_hi:[1,0,0] neg_lo:[0,0,1] neg_hi:[0,0,1]
    v_pk_fma_f32 v[64:65], v[144:145], v[254:255], v[238:239] op_sel_hi:[1,0,0] neg_lo:[1,0,0] neg_hi:[1,0,0]
    v_pk_fma_f32 v[58:59], v[146:147], v[254:255], v[230:231] op_sel_hi:[1,0,0] neg_lo:[0,0,1] neg_hi:[0,0,1]
    v_pk_fma_f32 v[66:67], v[146:147], v[254:255], v[238:239] op_sel_hi:[1,0,0] neg_lo:[1,0,0] neg_hi:[1,0,0]
    v_pk_fma_f32 v[60:61], v[148:149], v[254:255], v[230:231] op_sel_hi:[1,0,0] neg_lo:[0,0,1] neg_hi:[0,0,1]
    v_pk_fma_f32 v[68:69], v[148:149], v[254:255], v[238:239] op_sel_hi:[1,0,0] neg_lo:[1,0,0] neg_hi:[1,0,0]
    v_pk_fma_f32 v[62:63], v[150:151], v[254:255], v[230:231] op_sel_hi:[1,0,0] neg_lo:[0,0,1] neg_hi:[0,0,1]
    v_pk_fma_f32 v[70:71], v[150:151], v[254:255], v[238:239] op_sel_hi:[1,0,0] neg_lo:[1,0,0] neg_hi:[1,0,0]
    ds_write_b128 v243, v[164:167] offset:3072
    v_exp_f32 v56, v56
    v_exp_f32 v57, v57
    v_exp_f32 v58, v58
    v_exp_f32 v59, v59
    v_exp_f32 v60, v60
    v_exp_f32 v61, v61
    v_exp_f32 v62, v62
    v_exp_f32 v63, v63
    v_exp_f32 v64, v64
    v_exp_f32 v65, v65
    v_exp_f32 v66, v66
    v_exp_f32 v67, v67
    v_exp_f32 v68, v68
    v_exp_f32 v69, v69
    v_exp_f32 v70, v70
    v_exp_f32 v71, v71
    v_pk_add_f32 v[120:121], v[8:9], v[10:11]
    v_pk_add_f32 v[122:123], v[12:13], v[14:15]
    v_pk_add_f32 v[124:125], v[16:17], v[18:19]
    v_pk_add_f32 v[126:127], v[20:21], v[22:23]
    v_pk_add_f32 v[128:129], v[24:25], v[26:27]
    v_pk_add_f32 v[130:131], v[28:29], v[30:31]
L_hk15:
    s_cbranch_execz L_hr15
    v_pk_add_f32 v[132:133], v[32:33], v[34:35]
    v_pk_add_f32 v[134:135], v[36:37], v[38:39]
    v_pk_add_f32 v[136:137], v[40:41], v[42:43]
    v_pk_add_f32 v[138:139], v[44:45], v[46:47]
    v_pk_add_f32 v[140:141], v[48:49], v[50:51]
    v_pk_add_f32 v[142:143], v[52:53], v[54:55]
    v_pk_add_f32 v[144:145], v[56:57], v[58:59]
    v_pk_add_f32 v[146:147], v[60:61], v[62:63]
    v_pk_add_f32 v[148:149], v[64:65], v[66:67]
    v_pk_add_f32 v[150:151], v[68:69], v[70:71]
    v_pk_add_f32 v[120:121], v[120:121], v[122:123]
    v_pk_add_f32 v[124:125], v[124:125], v[126:127]
    v_pk_add_f32 v[128:129], v[128:129], v[130:131]
    v_pk_add_f32 v[132:133], v[132:133], v[134:135]
    v_pk_add_f32 v[136:137], v[136:137], v[138:139]
    v_pk_add_f32 v[140:141], v[140:141], v[142:143]
    v_pk_add_f32 v[144:145], v[144:145], v[146:147]
    v_pk_add_f32 v[148:149], v[148:149], v[150:151]
    v_add_f32 v224, v120, v121
    v_add_f32 v232, v124, v125
    v_add_f32 v226, v128, v129
    v_add_f32 v234, v132, v133
    v_add_f32 v228, v136, v137
    v_add_f32 v236, v140, v141
    v_add_f32 v230, v144, v145
    v_add_f32 v238, v148, v149
    v_permlane32_swap_b32 v224, v228
    v_permlane32_swap_b32 v226, v230
    v_permlane32_swap_b32 v232, v236
    v_permlane32_swap_b32 v234, v238
    v_add_f32 v224, v224, v228
    v_add_f32 v226, v226, v230
L_hk16:
    s_cbranch_execz L_hr16
    v_add_f32 v232, v232, v236
    v_add_f32 v234, v234, v238
    v_permlane16_swap_b32 v224, v226
    s_nop 0
    v_permlane16_swap_b32 v232, v234
    v_add_f32 v224, v224, v226
    v_add_f32 v232, v232, v234
    v_rcp_f32 v224, v224
    v_rcp_f32 v232, v232
    v_mul_f32 v224, v224, v183
    v_mul_f32 v232, v232, v183
    v_mov_b32 v226, v224
    v_mov_b32 v234, v232
    s_nop 0
    v_permlane16_swap_b32 v224, v226
    v_permlane16_swap_b32 v232, v234
    v_mov_b32 v228, v224
    v_mov_b32 v230, v226
    v_mov_b32 v236, v232
    v_mov_b32 v238, v234
    v_permlane32_swap_b32 v224, v228
    v_permlane32_swap_b32 v226, v230
    v_permlane32_swap_b32 v232, v236
    v_permlane32_swap_b32 v234, v238
    v_pk_mul_f32 v[8:9], v[8:9], v[224:225] op_sel_hi:[1,0]
    v_pk_mul_f32 v[10:11], v[10:11], v[224:225] op_sel_hi:[1,0]
    v_pk_mul_f32 v[12:13], v[12:13], v[224:225] op_sel_hi:[1,0]
    v_pk_mul_f32 v[14:15], v[14:15], v[224:225] op_sel_hi:[1,0]
    v_cvt_pk_bf16_f32 v104, v8, v9
    v_cvt_pk_bf16_f32 v105, v10, v11
    ds_write_b64 v240, v[104:105] offset:0
    v_cvt_pk_bf16_f32 v106, v12, v13
L_hk17:
    s_cbranch_execz L_hr17
    v_cvt_pk_bf16_f32 v107, v14, v15
    ds_write_b64 v240, v[106:107] offset:32
    v_pk_mul_f32 v[16:17], v[16:17], v[232:233] op_sel_hi:[1,0]
    v_pk_mul_f32 v[18:19], v[18:19], v[232:233] op_sel_hi:[1,0]
    v_pk_mul_f32 v[20:21], v[20:21], v[232:233] op_sel_hi:[1,0]
    v_pk_mul_f32 v[22:23], v[22:23], v[232:233] op_sel_hi:[1,0]
    v_cvt_pk_bf16_f32 v108, v16, v17
    v_cvt_pk_bf16_f32 v109, v18, v19
    ds_write_b64 v240, v[108:109] offset:64
    v_cvt_pk_bf16_f32 v110, v20, v21
    v_cvt_pk_bf16_f32 v111, v22, v23
    ds_write_b64 v240, v[110:111] offset:96
    v_pk_mul_f32 v[24:25], v[24:25], v[226:227] op_sel_hi:[1,0]
    v_pk_mul_f32 v[26:27], v[26:27], v[226:227] op_sel_hi:[1,0]
    v_pk_mul_f32 v[28:29], v[28:29], v[226:227] op_sel_hi:[1,0]
    v_pk_mul_f32 v[30:31], v[30:31], v[226:227] op_sel_hi:[1,0]
    v_cvt_pk_bf16_f32 v112, v24, v25
    v_cvt_pk_bf16_f32 v113, v26, v27
    ds_write_b64 v240, v[112:113] offset:2176
    v_cvt_pk_bf16_f32 v114, v28, v29
    v_cvt_pk_bf16_f32 v115, v30, v31
    ds_write_b64 v240, v[114:115] offset:2208
    v_pk_mul_f32 v[32:33], v[32:33], v[234:235] op_sel_hi:[1,0]
    v_pk_mul_f32 v[34:35], v[34:35], v[234:235] op_sel_hi:[1,0]
    v_pk_mul_f32 v[36:37], v[36:37], v[234:235] op_sel_hi:[1,0]
    v_pk_mul_f32 v[38:39], v[38:39], v[234:235] op_sel_hi:[1,0]
    v_cvt_pk_bf16_f32 v116, v32, v33
    v_cvt_pk_bf16_f32 v117, v34, v35
    ds_write_b64 v240, v[116:117] offset:2240
    v_cvt_pk_bf16_f32 v118, v36, v37
    v_cvt_pk_bf16_f32 v119, v38, v39
    ds_write_b64 v240, v[118:119] offset:2272
    ds_read_b64_tr_b16 v[120:121], v241 offset:0
    ds_read_b64_tr_b16 v[122:123], v241 offset:2176
    ds_read_b64_tr_b16 v[124:125], v241 offset:32
    ds_read_b64_tr_b16 v[126:127], v241 offset:2208
    v_pk_mul_f32 v[40:41], v[40:41], v[228:229] op_sel_hi:[1,0]
L_hk18:
    s_cbranch_execz L_hr18
    v_pk_mul_f32 v[42:43], v[42:43], v[228:229] op_sel_hi:[1,0]
    v_pk_mul_f32 v[44:45], v[44:45], v[228:229] op_sel_hi:[1,0]
    v_pk_mul_f32 v[46:47], v[46:47], v[228:229] op_sel_hi:[1,0]
    v_cvt_pk_bf16_f32 v104, v40, v41
    v_cvt_pk_bf16_f32 v105, v42, v43
    ds_write_b64 v240, v[104:105] offset:4352
    v_cvt_pk_bf16_f32 v106, v44, v45
    v_cvt_pk_bf16_f32 v107, v46, v47
    ds_write_b64 v240, v[106:107] offset:4384
    v_pk_mul_f32 v[48:49], v[48:49], v[236:237] op_sel_hi:[1,0]
    v_pk_mul_f32 v[50:51], v[50:51], v[236:237] op_sel_hi:[1,0]
    v_pk_mul_f32 v[52:53], v[52:53], v[236:237] op_sel_hi:[1,0]
    v_pk_mul_f32 v[54:55], v[54:55], v[236:237] op_sel_hi:[1,0]
    v_cvt_pk_bf16_f32 v108, v48, v49
    v_cvt_pk_bf16_f32 v109, v50, v51
    ds_write_b64 v240, v[108:109] offset:4416
    v_cvt_pk_bf16_f32 v110, v52, v53
    v_cvt_pk_bf16_f32 v111, v54, v55
    ds_write_b64 v240, v[110:111] offset:4448
    v_pk_mul_f32 v[56:57], v[56:57], v[230:231] op_sel_hi:[1,0]
    v_pk_mul_f32 v[58:59], v[58:59], v[230:231] op_sel_hi:[1,0]
    v_pk_mul_f32 v[60:61], v[60:61], v[230:231] op_sel_hi:[1,0]
    v_pk_mul_f32 v[62:63], v[62:63], v[230:231] op_sel_hi:[1,0]
    v_cvt_pk_bf16_f32 v112, v56, v57
    v_cvt_pk_bf16_f32 v113, v58, v59
    ds_write_b64 v240, v[112:113] offset:6528
    v_cvt_pk_bf16_f32 v114, v60, v61
    v_cvt_pk_bf16_f32 v115, v62, v63
    ds_write_b64 v240, v[114:115] offset:6560
    v_pk_mul_f32 v[64:65], v[64:65], v[238:239] op_sel_hi:[1,0]
    v_pk_mul_f32 v[66:67], v[66:67], v[238:239] op_sel_hi:[1,0]
    v_pk_mul_f32 v[68:69], v[68:69], v[238:239] op_sel_hi:[1,0]
L_hk19:
    s_cbranch_execz L_hr19
    v_pk_mul_f32 v[70:71], v[70:71], v[238:239] op_sel_hi:[1,0]
    v_cvt_pk_bf16_f32 v116, v64, v65
    v_cvt_pk_bf16_f32 v117, v66, v67
    ds_write_b64 v240, v[116:117] offset:6592
    v_cvt_pk_bf16_f32 v118, v68, v69
    v_cvt_pk_bf16_f32 v119, v70, v71
    ds_write_b64 v240, v[118:119] offset:6624
    v_mov_b32 v7, 1
    ds_write_b32 v249, v7 offset:32
    ds_read_b32 v7, v246
    ds_read_b64_tr_b16 v[128:129], v241 offset:4352
    ds_read_b64_tr_b16 v[130:131], v241 offset:6528
    ds_read_b64_tr_b16 v[132:133], v241 offset:4384
    ds_read_b64_tr_b16 v[134:135], v241 offset:6560
    ds_read_b128 v[192:195], v251 offset:48
    s_waitcnt lgkmcnt(14)
    v_mfma_f32_16x16x32_bf16 v[8:11], v[120:123], v[152:155], 0
    v_mov_b32 v59, s32
    v_mfma_f32_16x16x32_bf16 v[12:15], v[120:123], v[156:159], 0
    v_mov_b32 v63, s32
    v_mfma_f32_16x16x32_bf16 v[24:27], v[120:123], v[200:203], 0
    v_mov_b32 v67, s32
    v_mfma_f32_16x16x32_bf16 v[16:19], v[124:127], v[152:155], 0
    v_mov_b32 v71, s32
    v_mfma_f32_16x16x32_bf16 v[20:23], v[124:127], v[156:159], 0
    v_mfma_f32_16x16x32_bf16 v[28:31], v[124:127], v[200:203], 0
    s_waitcnt lgkmcnt(0)
L_ex:
    v_readfirstlane_b32 s65, v7
    s_nop 0
    s_cmp_ge_u32 s65, 1
    s_cbranch_scc1 L_exd
    ds_read_b32 v7, v246
    s_waitcnt lgkmcnt(0)
    s_branch L_ex
L_exd:
    v_mfma_f32_16x16x32_bf16 v[8:11], v[128:131], v[160:163], v[8:11]
    ds_read_b64_tr_b16 v[136:137], v242 offset:0
    ds_read_b64_tr_b16 v[138:139], v242 offset:2176
    v_mfma_f32_16x16x32_bf16 v[12:15], v[128:131], v[164:167], v[12:15]
    ds_read_b64_tr_b16 v[140:141], v242 offset:32
    ds_read_b64_tr_b16 v[142:143], v242 offset:2208
    v_mfma_f32_16x16x32_bf16 v[24:27], v[128:131], v[204:207], v[24:27]
    ds_read_b128 v[32:35], v244 offset:0
    ds_read_b128 v[36:39], v244 offset:1024
    v_mfma_f32_16x16x32_bf16 v[16:19], v[132:135], v[160:163], v[16:19]
    ds_read_b64_tr_b16 v[144:145], v242 offset:4352
    ds_read_b64_tr_b16 v[146:147], v242 offset:6528
    v_mfma_f32_16x16x32_bf16 v[20:23], v[132:135], v[164:167], v[20:23]
    ds_read_b64_tr_b16 v[148:149], v242 offset:4384
    ds_read_b64_tr_b16 v[150:151], v242 offset:6560
    v_mfma_f32_16x16x32_bf16 v[28:31], v[132:135], v[204:207], v[28:31]
    ds_read_b128 v[40:43], v244 offset:2048
    ds_read_b128 v[44:47], v244 offset:3072
    s_waitcnt lgkmcnt(6)
    v_mfma_f32_16x16x32_bf16 v[8:11], v[136:139], v[32:35], v[8:11]
    v_mfma_f32_16x16x32_bf16 v[12:15], v[136:139], v[36:39], v[12:15]
    v_mfma_f32_16x16x32_bf16 v[24:27], v[136:139], v[208:211], v[24:27]
    v_mfma_f32_16x16x32_bf16 v[16:19], v[140:143], v[32:35], v[16:19]
    v_mfma_f32_16x16x32_bf16 v[20:23], v[140:143], v[36:39], v[20:23]
    v_mfma_f32_16x16x32_bf16 v[28:31], v[140:143], v[208:211], v[28:31]
    s_waitcnt lgkmcnt(0)
    v_mfma_f32_16x16x32_bf16 v[8:11], v[144:147], v[40:43], v[8:11]
    v_mfma_f32_16x16x32_bf16 v[12:15], v[144:147], v[44:47], v[12:15]
    v_mfma_f32_16x16x32_bf16 v[24:27], v[144:147], v[212:215], v[24:27]
    v_mfma_f32_16x16x32_bf16 v[16:19], v[148:151], v[40:43], v[16:19]
    v_mfma_f32_16x16x32_bf16 v[20:23], v[148:151], v[44:47], v[20:23]
    v_mfma_f32_16x16x32_bf16 v[28:31], v[148:151], v[212:215], v[28:31]
L_qr:
L_hk20:
    s_cbranch_execz L_hr20
    v_and_b32 v192, v192, v193
    v_and_b32 v194, v194, v195
    v_and_b32 v192, v192, v194
    s_nop 0
    v_readfirstlane_b32 s65, v192
    s_nop 0
    s_cmp_eq_u32 s65, 1
    s_cbranch_scc1 L_qrd
    ds_read_b128 v[192:195], v251 offset:48
    s_waitcnt lgkmcnt(0)
    s_branch L_qr
L_qrd:
    ds_read_b128 v[104:107], v168 offset:0
    ds_read_b64_tr_b16 v[120:121], v189 offset:0
    ds_read_b64_tr_b16 v[122:123], v189 offset:512
    ds_read_b64_tr_b16 v[124:125], v191 offset:0
    ds_read_b64_tr_b16 v[126:127], v191 offset:512
    ds_read_b128 v[108:111], v168 offset:2048
    ds_read_b128 v[112:115], v168 offset:4096
    ds_read_b128 v[116:119], v168 offset:6144
    v_cvt_pk_bf16_f32 v56, v8, v9
    v_cvt_pk_bf16_f32 v57, v10, v11
    v_cvt_pk_bf16_f32 v58, v24, v25
    v_cvt_pk_bf16_f32 v64, v12, v13
    v_cvt_pk_bf16_f32 v65, v14, v15
    v_cvt_pk_bf16_f32 v66, v26, v27
    v_cvt_pk_bf16_f32 v60, v16, v17
    v_cvt_pk_bf16_f32 v61, v18, v19
    v_cvt_pk_bf16_f32 v62, v28, v29
    v_cvt_pk_bf16_f32 v68, v20, v21
    v_cvt_pk_bf16_f32 v69, v22, v23
    v_cvt_pk_bf16_f32 v70, v30, v31
    s_cmp_lg_u32 s88, 0
    s_cbranch_scc1 L_kr
    buffer_store_dwordx4 v[56:59], v5, s[12:15], s77 offen offset:0
    buffer_store_dwordx4 v[60:63], v5, s[12:15], s77 offen offset:1024
    buffer_store_dwordx4 v[64:67], v5, s[12:15], s77 offen offset:2048
    buffer_store_dwordx4 v[68:71], v5, s[12:15], s77 offen offset:3072
    s_branch L_ks
L_kr:
    buffer_store_dwordx4 v[56:59], v5, s[12:15], s77 offen offset:0 sc1
    buffer_store_dwordx4 v[60:63], v5, s[12:15], s77 offen offset:1024 sc1
    buffer_store_dwordx4 v[64:67], v5, s[12:15], s77 offen offset:2048 sc1
    buffer_store_dwordx4 v[68:71], v5, s[12:15], s77 offen offset:3072 sc1
L_ks:
L_hk21:
    s_cbranch_execz L_hr21
    v_mov_b32 v7, 3
    ds_write_b32 v249, v7 offset:32
    s_waitcnt lgkmcnt(0)
    v_mfma_f32_16x16x32_bf16 v[72:75], v[120:123], v[104:107], v[72:75]
    ds_read_b128 v[136:139], v169 offset:0
    v_mfma_f32_16x16x32_bf16 v[76:79], v[124:127], v[104:107], v[76:79]
    ds_read_b64_tr_b16 v[152:153], v189 offset:4096
    v_mfma_f32_16x16x32_bf16 v[80:83], v[120:123], v[108:111], v[80:83]
    ds_read_b64_tr_b16 v[154:155], v189 offset:4608
    v_mfma_f32_16x16x32_bf16 v[84:87], v[124:127], v[108:111], v[84:87]
    ds_read_b64_tr_b16 v[156:157], v191 offset:4096
    v_mfma_f32_16x16x32_bf16 v[88:91], v[120:123], v[112:115], v[88:91]
    ds_read_b64_tr_b16 v[158:159], v191 offset:4608
    v_mfma_f32_16x16x32_bf16 v[92:95], v[124:127], v[112:115], v[92:95]
    ds_read_b128 v[140:143], v169 offset:2048
    v_mfma_f32_16x16x32_bf16 v[96:99], v[120:123], v[116:119], v[96:99]
    ds_read_b128 v[144:147], v169 offset:4096
    v_mfma_f32_16x16x32_bf16 v[100:103], v[124:127], v[116:119], v[100:103]
    ds_read_b128 v[148:151], v169 offset:6144
    s_waitcnt lgkmcnt(0)
    v_mov_b32 v7, 17
    ds_write_b32 v249, v7
    v_mfma_f32_16x16x32_bf16 v[72:75], v[152:155], v[136:139], v[72:75]
    ds_read_b128 v[104:107], v168 offset:16384
    v_mfma_f32_16x16x32_bf16 v[76:79], v[156:159], v[136:139], v[76:79]
    ds_read_b64_tr_b16 v[120:121], v189 offset:8192
    v_mfma_f32_16x16x32_bf16 v[80:83], v[152:155], v[140:143], v[80:83]
    ds_read_b64_tr_b16 v[122:123], v189 offset:8704
    v_mfma_f32_16x16x32_bf16 v[84:87], v[156:159], v[140:143], v[84:87]
    ds_read_b64_tr_b16 v[124:125], v191 offset:8192
    v_mfma_f32_16x16x32_bf16 v[88:91], v[152:155], v[144:147], v[88:91]
    ds_read_b64_tr_b16 v[126:127], v191 offset:8704
    v_mfma_f32_16x16x32_bf16 v[92:95], v[156:159], v[144:147], v[92:95]
    ds_read_b128 v[108:111], v168 offset:18432
    v_mfma_f32_16x16x32_bf16 v[96:99], v[152:155], v[148:151], v[96:99]
    ds_read_b128 v[112:115], v168 offset:20480
    v_mfma_f32_16x16x32_bf16 v[100:103], v[156:159], v[148:151], v[100:103]
    ds_read_b128 v[116:119], v168 offset:22528
    s_waitcnt lgkmcnt(0)
    v_mfma_f32_16x16x32_bf16 v[72:75], v[120:123], v[104:107], v[72:75]
    ds_read_b128 v[136:139], v169 offset:16384
    v_mfma_f32_16x16x32_bf16 v[76:79], v[124:127], v[104:107], v[76:79]
    ds_read_b64_tr_b16 v[152:153], v189 offset:12288
    v_mfma_f32_16x16x32_bf16 v[80:83], v[120:123], v[108:111], v[80:83]
    ds_read_b64_tr_b16 v[154:155], v189 offset:12800
    v_mfma_f32_16x16x32_bf16 v[84:87], v[124:127], v[108:111], v[84:87]
    ds_read_b64_tr_b16 v[156:157], v191 offset:12288
    v_mfma_f32_16x16x32_bf16 v[88:91], v[120:123], v[112:115], v[88:91]
    ds_read_b64_tr_b16 v[158:159], v191 offset:12800
    v_mfma_f32_16x16x32_bf16 v[92:95], v[124:127], v[112:115], v[92:95]
    ds_read_b128 v[140:143], v169 offset:18432
    v_mfma_f32_16x16x32_bf16 v[96:99], v[120:123], v[116:119], v[96:99]
    ds_read_b128 v[144:147], v169 offset:20480
    v_mfma_f32_16x16x32_bf16 v[100:103], v[124:127], v[116:119], v[100:103]
    ds_read_b128 v[148:151], v169 offset:22528
    s_waitcnt lgkmcnt(0)
    v_mov_b32 v7, 18
    ds_write_b32 v249, v7
    v_mfma_f32_16x16x32_bf16 v[72:75], v[152:155], v[136:139], v[72:75]
    ds_read_b128 v[104:107], v168 offset:32768
    v_mfma_f32_16x16x32_bf16 v[76:79], v[156:159], v[136:139], v[76:79]
    ds_read_b64_tr_b16 v[120:121], v189 offset:16384
    v_mfma_f32_16x16x32_bf16 v[80:83], v[152:155], v[140:143], v[80:83]
    ds_read_b64_tr_b16 v[122:123], v189 offset:16896
    v_mfma_f32_16x16x32_bf16 v[84:87], v[156:159], v[140:143], v[84:87]
    ds_read_b64_tr_b16 v[124:125], v191 offset:16384
    v_mfma_f32_16x16x32_bf16 v[88:91], v[152:155], v[144:147], v[88:91]
    ds_read_b64_tr_b16 v[126:127], v191 offset:16896
    v_mfma_f32_16x16x32_bf16 v[92:95], v[156:159], v[144:147], v[92:95]
    ds_read_b128 v[108:111], v168 offset:34816
    v_mfma_f32_16x16x32_bf16 v[96:99], v[152:155], v[148:151], v[96:99]
    ds_read_b128 v[112:115], v168 offset:36864
    v_mfma_f32_16x16x32_bf16 v[100:103], v[156:159], v[148:151], v[100:103]
    ds_read_b128 v[116:119], v168 offset:38912
    s_waitcnt lgkmcnt(0)
    v_mfma_f32_16x16x32_bf16 v[72:75], v[120:123], v[104:107], v[72:75]
    ds_read_b128 v[136:139], v169 offset:32768
    v_mfma_f32_16x16x32_bf16 v[76:79], v[124:127], v[104:107], v[76:79]
    ds_read_b64_tr_b16 v[152:153], v189 offset:20480
    v_mfma_f32_16x16x32_bf16 v[80:83], v[120:123], v[108:111], v[80:83]
    ds_read_b64_tr_b16 v[154:155], v189 offset:20992
    v_mfma_f32_16x16x32_bf16 v[84:87], v[124:127], v[108:111], v[84:87]
    ds_read_b64_tr_b16 v[156:157], v191 offset:20480
    v_mfma_f32_16x16x32_bf16 v[88:91], v[120:123], v[112:115], v[88:91]
    ds_read_b64_tr_b16 v[158:159], v191 offset:20992
    v_mfma_f32_16x16x32_bf16 v[92:95], v[124:127], v[112:115], v[92:95]
    ds_read_b128 v[140:143], v169 offset:34816
    v_mfma_f32_16x16x32_bf16 v[96:99], v[120:123], v[116:119], v[96:99]
    ds_read_b128 v[144:147], v169 offset:36864
    v_mfma_f32_16x16x32_bf16 v[100:103], v[124:127], v[116:119], v[100:103]
    ds_read_b128 v[148:151], v169 offset:38912
    s_waitcnt lgkmcnt(0)
    v_mov_b32 v7, 19
    ds_write_b32 v249, v7
    v_mfma_f32_16x16x32_bf16 v[72:75], v[152:155], v[136:139], v[72:75]
    ds_read_b128 v[104:107], v168 offset:49152
    v_mfma_f32_16x16x32_bf16 v[76:79], v[156:159], v[136:139], v[76:79]
    ds_read_b64_tr_b16 v[120:121], v170 offset:16384
    v_mfma_f32_16x16x32_bf16 v[80:83], v[152:155], v[140:143], v[80:83]
    ds_read_b64_tr_b16 v[122:123], v170 offset:16896
    v_mfma_f32_16x16x32_bf16 v[84:87], v[156:159], v[140:143], v[84:87]
    ds_read_b64_tr_b16 v[124:125], v171 offset:16384
    v_mfma_f32_16x16x32_bf16 v[88:91], v[152:155], v[144:147], v[88:91]
    ds_read_b64_tr_b16 v[126:127], v171 offset:16896
    v_mfma_f32_16x16x32_bf16 v[92:95], v[156:159], v[144:147], v[92:95]
    ds_read_b128 v[108:111], v168 offset:51200
    v_mfma_f32_16x16x32_bf16 v[96:99], v[152:155], v[148:151], v[96:99]
    ds_read_b128 v[112:115], v168 offset:53248
    v_mfma_f32_16x16x32_bf16 v[100:103], v[156:159], v[148:151], v[100:103]
    ds_read_b128 v[116:119], v168 offset:55296
    s_waitcnt lgkmcnt(0)
    v_mfma_f32_16x16x32_bf16 v[72:75], v[120:123], v[104:107], v[72:75]
    ds_read_b128 v[136:139], v169 offset:49152
    v_mfma_f32_16x16x32_bf16 v[76:79], v[124:127], v[104:107], v[76:79]
    ds_read_b64_tr_b16 v[152:153], v170 offset:20480
    v_mfma_f32_16x16x32_bf16 v[80:83], v[120:123], v[108:111], v[80:83]
    ds_read_b64_tr_b16 v[154:155], v170 offset:20992
    v_mfma_f32_16x16x32_bf16 v[84:87], v[124:127], v[108:111], v[84:87]
    ds_read_b64_tr_b16 v[156:157], v171 offset:20480
    v_mfma_f32_16x16x32_bf16 v[88:91], v[120:123], v[112:115], v[88:91]
    ds_read_b64_tr_b16 v[158:159], v171 offset:20992
    v_mfma_f32_16x16x32_bf16 v[92:95], v[124:127], v[112:115], v[92:95]
    ds_read_b128 v[140:143], v169 offset:51200
    v_mfma_f32_16x16x32_bf16 v[96:99], v[120:123], v[116:119], v[96:99]
    ds_read_b128 v[144:147], v169 offset:53248
    v_mfma_f32_16x16x32_bf16 v[100:103], v[124:127], v[116:119], v[100:103]
    ds_read_b128 v[148:151], v169 offset:55296
    s_waitcnt lgkmcnt(0)
    v_mov_b32 v7, 20
    ds_write_b32 v249, v7
    v_mfma_f32_16x16x32_bf16 v[72:75], v[152:155], v[136:139], v[72:75]
    v_mfma_f32_16x16x32_bf16 v[76:79], v[156:159], v[136:139], v[76:79]
    v_mfma_f32_16x16x32_bf16 v[80:83], v[152:155], v[140:143], v[80:83]
    v_mfma_f32_16x16x32_bf16 v[84:87], v[156:159], v[140:143], v[84:87]
    v_mfma_f32_16x16x32_bf16 v[88:91], v[152:155], v[144:147], v[88:91]
    v_mfma_f32_16x16x32_bf16 v[92:95], v[156:159], v[144:147], v[92:95]
    v_mfma_f32_16x16x32_bf16 v[96:99], v[152:155], v[148:151], v[96:99]
    v_mfma_f32_16x16x32_bf16 v[100:103], v[156:159], v[148:151], v[100:103]
    s_nop 0
    v_pk_fma_f32 v[72:73], v[180:181], v[216:217], v[72:73] op_sel_hi:[0,1,1]
    v_pk_fma_f32 v[74:75], v[180:181], v[218:219], v[74:75] op_sel_hi:[0,1,1]
    v_pk_fma_f32 v[76:77], v[180:181], v[220:221], v[76:77] op_sel_hi:[0,1,1]
    v_pk_fma_f32 v[78:79], v[180:181], v[222:223], v[78:79] op_sel_hi:[0,1,1]
    v_pk_fma_f32 v[80:81], v[182:183], v[216:217], v[80:81] op_sel_hi:[0,1,1]
    v_pk_fma_f32 v[82:83], v[182:183], v[218:219], v[82:83] op_sel_hi:[0,1,1]
    v_pk_fma_f32 v[84:85], v[182:183], v[220:221], v[84:85] op_sel_hi:[0,1,1]
    v_pk_fma_f32 v[86:87], v[182:183], v[222:223], v[86:87] op_sel_hi:[0,1,1]
    v_pk_fma_f32 v[88:89], v[184:185], v[216:217], v[88:89] op_sel_hi:[0,1,1]
    v_pk_fma_f32 v[90:91], v[184:185], v[218:219], v[90:91] op_sel_hi:[0,1,1]
    v_pk_fma_f32 v[92:93], v[184:185], v[220:221], v[92:93] op_sel_hi:[0,1,1]
    v_pk_fma_f32 v[94:95], v[184:185], v[222:223], v[94:95] op_sel_hi:[0,1,1]
    v_pk_fma_f32 v[96:97], v[186:187], v[216:217], v[96:97] op_sel_hi:[0,1,1]
    v_pk_fma_f32 v[98:99], v[186:187], v[218:219], v[98:99] op_sel_hi:[0,1,1]
    v_pk_fma_f32 v[100:101], v[186:187], v[220:221], v[100:101] op_sel_hi:[0,1,1]
    v_pk_fma_f32 v[102:103], v[186:187], v[222:223], v[102:103] op_sel_hi:[0,1,1]
    v_cvt_pk_bf16_f32 v104, v72, v73
    v_cvt_pk_bf16_f32 v105, v74, v75
    v_cvt_pk_bf16_f32 v106, v76, v77
    v_cvt_pk_bf16_f32 v107, v78, v79
    s_nop 1
    v_mfma_f32_16x16x32_bf16 v[120:123], v[172:175], v[104:107], 0
    v_cvt_pk_bf16_f32 v108, v80, v81
    v_cvt_pk_bf16_f32 v109, v82, v83
    v_mfma_f32_16x16x32_bf16 v[124:127], v[176:179], v[104:107], 0
    v_cvt_pk_bf16_f32 v110, v84, v85
    v_cvt_pk_bf16_f32 v111, v86, v87
    s_nop 1
    v_mfma_f32_16x16x32_bf16 v[128:131], v[172:175], v[108:111], 0
    v_cvt_pk_bf16_f32 v112, v88, v89
    v_cvt_pk_bf16_f32 v113, v90, v91
    v_mfma_f32_16x16x32_bf16 v[132:135], v[176:179], v[108:111], 0
    v_cvt_pk_bf16_f32 v114, v92, v93
    v_cvt_pk_bf16_f32 v115, v94, v95
    s_nop 1
    v_mfma_f32_16x16x32_bf16 v[136:139], v[172:175], v[112:115], 0
    v_cvt_pk_bf16_f32 v116, v96, v97
    v_cvt_pk_bf16_f32 v117, v98, v99
    v_mfma_f32_16x16x32_bf16 v[140:143], v[176:179], v[112:115], 0
    v_cvt_pk_bf16_f32 v118, v100, v101
    v_cvt_pk_bf16_f32 v119, v102, v103
    s_nop 1
    v_mfma_f32_16x16x32_bf16 v[144:147], v[172:175], v[116:119], 0
    v_mfma_f32_16x16x32_bf16 v[148:151], v[176:179], v[116:119], 0
    v_max3_f32 v224, v120, v121, v122
    v_min3_f32 v232, v120, v121, v122
    v_max3_f32 v224, v224, v123, v124
    v_min3_f32 v232, v232, v123, v124
    v_max3_f32 v224, v224, v125, v126
    v_min3_f32 v232, v232, v125, v126
    v_max_f32 v224, v224, v127
    v_min_f32 v232, v232, v127
    v_max3_f32 v226, v128, v129, v130
    v_min3_f32 v234, v128, v129, v130
    v_max3_f32 v226, v226, v131, v132
    v_min3_f32 v234, v234, v131, v132
    v_max3_f32 v226, v226, v133, v134
    v_min3_f32 v234, v234, v133, v134
    v_max_f32 v226, v226, v135
    v_min_f32 v234, v234, v135
    v_max3_f32 v228, v136, v137, v138
    v_min3_f32 v236, v136, v137, v138
    v_max3_f32 v228, v228, v139, v140
    v_min3_f32 v236, v236, v139, v140
    v_max3_f32 v228, v228, v141, v142
    v_min3_f32 v236, v236, v141, v142
    v_max_f32 v228, v228, v143
    v_min_f32 v236, v236, v143
    v_max3_f32 v230, v144, v145, v146
    v_min3_f32 v238, v144, v145, v146
    v_max3_f32 v230, v230, v147, v148
    v_min3_f32 v238, v238, v147, v148
    v_max3_f32 v230, v230, v149, v150
    v_min3_f32 v238, v238, v149, v150
    v_max_f32 v230, v230, v151
    v_min_f32 v238, v238, v151
    v_permlane32_swap_b32 v224, v228
    v_permlane32_swap_b32 v226, v230
    v_permlane32_swap_b32 v232, v236
    v_permlane32_swap_b32 v234, v238
    v_max_f32 v224, v224, v228
    v_max_f32 v226, v226, v230
    v_min_f32 v232, v232, v236
    v_min_f32 v234, v234, v238
    v_permlane16_swap_b32 v224, v226
    s_nop 0
    v_permlane16_swap_b32 v232, v234
    v_max_f32 v224, v224, v226
    v_min_f32 v232, v232, v234
    v_mul_f32 v224, v224, v181
    v_mul_f32 v232, v232, v181
    v_mov_b32 v226, v224
    v_mov_b32 v234, v232
    s_nop 0
    v_permlane16_swap_b32 v224, v226
    v_permlane16_swap_b32 v232, v234
    v_mov_b32 v228, v224
    v_mov_b32 v230, v226
    v_mov_b32 v236, v232
    v_mov_b32 v238, v234
    v_permlane32_swap_b32 v224, v228
    v_permlane32_swap_b32 v226, v230
    v_permlane32_swap_b32 v232, v236
    v_permlane32_swap_b32 v234, v238
    v_pk_fma_f32 v[8:9], v[120:121], v[248:249], v[224:225] op_sel_hi:[1,0,0] neg_lo:[0,0,1] neg_hi:[0,0,1]
    v_pk_fma_f32 v[16:17], v[120:121], v[248:249], v[232:233] op_sel_hi:[1,0,0] neg_lo:[1,0,0] neg_hi:[1,0,0]
    v_pk_fma_f32 v[10:11], v[122:123], v[248:249], v[224:225] op_sel_hi:[1,0,0] neg_lo:[0,0,1] neg_hi:[0,0,1]
    v_pk_fma_f32 v[18:19], v[122:123], v[248:249], v[232:233] op_sel_hi:[1,0,0] neg_lo:[1,0,0] neg_hi:[1,0,0]
    v_pk_fma_f32 v[12:13], v[124:125], v[248:249], v[224:225] op_sel_hi:[1,0,0] neg_lo:[0,0,1] neg_hi:[0,0,1]
    v_pk_fma_f32 v[20:21], v[124:125], v[248:249], v[232:233] op_sel_hi:[1,0,0] neg_lo:[1,0,0] neg_hi:[1,0,0]
    v_pk_fma_f32 v[14:15], v[126:127], v[248:249], v[224:225] op_sel_hi:[1,0,0] neg_lo:[0,0,1] neg_hi:[0,0,1]
    v_pk_fma_f32 v[22:23], v[126:127], v[248:249], v[232:233] op_sel_hi:[1,0,0] neg_lo:[1,0,0] neg_hi:[1,0,0]
    v_exp_f32 v8, v8
    v_exp_f32 v9, v9
    v_exp_f32 v10, v10
    v_exp_f32 v11, v11
    v_exp_f32 v12, v12
    v_exp_f32 v13, v13
    v_exp_f32 v14, v14
    v_exp_f32 v15, v15
    v_exp_f32 v16, v16
    v_exp_f32 v17, v17
    v_exp_f32 v18, v18
    v_exp_f32 v19, v19
    v_exp_f32 v20, v20
    v_exp_f32 v21, v21
    v_exp_f32 v22, v22
    v_exp_f32 v23, v23
    v_pk_fma_f32 v[24:25], v[128:129], v[250:251], v[226:227] op_sel_hi:[1,0,0] neg_lo:[0,0,1] neg_hi:[0,0,1]
    v_pk_fma_f32 v[32:33], v[128:129], v[250:251], v[234:235] op_sel_hi:[1,0,0] neg_lo:[1,0,0] neg_hi:[1,0,0]
    v_pk_fma_f32 v[26:27], v[130:131], v[250:251], v[226:227] op_sel_hi:[1,0,0] neg_lo:[0,0,1] neg_hi:[0,0,1]
    v_pk_fma_f32 v[34:35], v[130:131], v[250:251], v[234:235] op_sel_hi:[1,0,0] neg_lo:[1,0,0] neg_hi:[1,0,0]
    v_pk_fma_f32 v[28:29], v[132:133], v[250:251], v[226:227] op_sel_hi:[1,0,0] neg_lo:[0,0,1] neg_hi:[0,0,1]
    v_pk_fma_f32 v[36:37], v[132:133], v[250:251], v[234:235] op_sel_hi:[1,0,0] neg_lo:[1,0,0] neg_hi:[1,0,0]
    v_pk_fma_f32 v[30:31], v[134:135], v[250:251], v[226:227] op_sel_hi:[1,0,0] neg_lo:[0,0,1] neg_hi:[0,0,1]
    v_pk_fma_f32 v[38:39], v[134:135], v[250:251], v[234:235] op_sel_hi:[1,0,0] neg_lo:[1,0,0] neg_hi:[1,0,0]
    v_exp_f32 v24, v24
    v_exp_f32 v25, v25
    v_exp_f32 v26, v26
    v_exp_f32 v27, v27
    v_exp_f32 v28, v28
    v_exp_f32 v29, v29
    v_exp_f32 v30, v30
    v_exp_f32 v31, v31
    v_exp_f32 v32, v32
    v_exp_f32 v33, v33
    v_exp_f32 v34, v34
    v_exp_f32 v35, v35
    v_exp_f32 v36, v36
    v_exp_f32 v37, v37
    v_exp_f32 v38, v38
    v_exp_f32 v39, v39
    v_pk_fma_f32 v[40:41], v[136:137], v[252:253], v[228:229] op_sel_hi:[1,0,0] neg_lo:[0,0,1] neg_hi:[0,0,1]
    v_pk_fma_f32 v[48:49], v[136:137], v[252:253], v[236:237] op_sel_hi:[1,0,0] neg_lo:[1,0,0] neg_hi:[1,0,0]
    v_pk_fma_f32 v[42:43], v[138:139], v[252:253], v[228:229] op_sel_hi:[1,0,0] neg_lo:[0,0,1] neg_hi:[0,0,1]
    v_pk_fma_f32 v[50:51], v[138:139], v[252:253], v[236:237] op_sel_hi:[1,0,0] neg_lo:[1,0,0] neg_hi:[1,0,0]
    v_pk_fma_f32 v[44:45], v[140:141], v[252:253], v[228:229] op_sel_hi:[1,0,0] neg_lo:[0,0,1] neg_hi:[0,0,1]
    v_pk_fma_f32 v[52:53], v[140:141], v[252:253], v[236:237] op_sel_hi:[1,0,0] neg_lo:[1,0,0] neg_hi:[1,0,0]
    v_pk_fma_f32 v[46:47], v[142:143], v[252:253], v[228:229] op_sel_hi:[1,0,0] neg_lo:[0,0,1] neg_hi:[0,0,1]
    v_pk_fma_f32 v[54:55], v[142:143], v[252:253], v[236:237] op_sel_hi:[1,0,0] neg_lo:[1,0,0] neg_hi:[1,0,0]
    v_exp_f32 v40, v40
    v_exp_f32 v41, v41
    v_exp_f32 v42, v42
    v_exp_f32 v43, v43
    v_exp_f32 v44, v44
    v_exp_f32 v45, v45
    v_exp_f32 v46, v46
    v_exp_f32 v47, v47
    v_exp_f32 v48, v48
    v_exp_f32 v49, v49
    v_exp_f32 v50, v50
    v_exp_f32 v51, v51
    v_exp_f32 v52, v52
    v_exp_f32 v53, v53
    v_exp_f32 v54, v54
    v_exp_f32 v55, v55
    v_pk_fma_f32 v[56:57], v[144:145], v[254:255], v[230:231] op_sel_hi:[1,0,0] neg_lo:[0,0,1] neg_hi:[0,0,1]
    v_pk_fma_f32 v[64:65], v[144:145], v[254:255], v[238:239] op_sel_hi:[1,0,0] neg_lo:[1,0,0] neg_hi:[1,0,0]
    v_pk_fma_f32 v[58:59], v[146:147], v[254:255], v[230:231] op_sel_hi:[1,0,0] neg_lo:[0,0,1] neg_hi:[0,0,1]
    v_pk_fma_f32 v[66:67], v[146:147], v[254:255], v[238:239] op_sel_hi:[1,0,0] neg_lo:[1,0,0] neg_hi:[1,0,0]
    v_pk_fma_f32 v[60:61], v[148:149], v[254:255], v[230:231] op_sel_hi:[1,0,0] neg_lo:[0,0,1] neg_hi:[0,0,1]
    v_pk_fma_f32 v[68:69], v[148:149], v[254:255], v[238:239] op_sel_hi:[1,0,0] neg_lo:[1,0,0] neg_hi:[1,0,0]
    v_pk_fma_f32 v[62:63], v[150:151], v[254:255], v[230:231] op_sel_hi:[1,0,0] neg_lo:[0,0,1] neg_hi:[0,0,1]
    v_pk_fma_f32 v[70:71], v[150:151], v[254:255], v[238:239] op_sel_hi:[1,0,0] neg_lo:[1,0,0] neg_hi:[1,0,0]
    v_exp_f32 v56, v56
    v_exp_f32 v57, v57
    v_exp_f32 v58, v58
    v_exp_f32 v59, v59
    v_exp_f32 v60, v60
    v_exp_f32 v61, v61
    v_exp_f32 v62, v62
    v_exp_f32 v63, v63
    v_exp_f32 v64, v64
    v_exp_f32 v65, v65
    v_exp_f32 v66, v66
    v_exp_f32 v67, v67
    v_exp_f32 v68, v68
    v_exp_f32 v69, v69
    v_exp_f32 v70, v70
    v_exp_f32 v71, v71
    v_pk_add_f32 v[120:121], v[8:9], v[10:11]
    v_pk_add_f32 v[122:123], v[12:13], v[14:15]
    v_pk_add_f32 v[124:125], v[16:17], v[18:19]
    v_pk_add_f32 v[126:127], v[20:21], v[22:23]
    v_pk_add_f32 v[128:129], v[24:25], v[26:27]
    v_pk_add_f32 v[130:131], v[28:29], v[30:31]
    v_pk_add_f32 v[132:133], v[32:33], v[34:35]
    v_pk_add_f32 v[134:135], v[36:37], v[38:39]
    v_pk_add_f32 v[136:137], v[40:41], v[42:43]
    v_pk_add_f32 v[138:139], v[44:45], v[46:47]
    v_pk_add_f32 v[140:141], v[48:49], v[50:51]
    v_pk_add_f32 v[142:143], v[52:53], v[54:55]
    v_pk_add_f32 v[144:145], v[56:57], v[58:59]
    v_pk_add_f32 v[146:147], v[60:61], v[62:63]
    v_pk_add_f32 v[148:149], v[64:65], v[66:67]
    v_pk_add_f32 v[150:151], v[68:69], v[70:71]
    v_pk_add_f32 v[120:121], v[120:121], v[122:123]
    v_pk_add_f32 v[124:125], v[124:125], v[126:127]
    v_pk_add_f32 v[128:129], v[128:129], v[130:131]
    v_pk_add_f32 v[132:133], v[132:133], v[134:135]
    v_pk_add_f32 v[136:137], v[136:137], v[138:139]
    v_pk_add_f32 v[140:141], v[140:141], v[142:143]
    v_pk_add_f32 v[144:145], v[144:145], v[146:147]
    v_pk_add_f32 v[148:149], v[148:149], v[150:151]
    v_add_f32 v224, v120, v121
    v_add_f32 v232, v124, v125
    v_add_f32 v226, v128, v129
    v_add_f32 v234, v132, v133
    v_add_f32 v228, v136, v137
    v_add_f32 v236, v140, v141
    v_add_f32 v230, v144, v145
    v_add_f32 v238, v148, v149
    v_permlane32_swap_b32 v224, v228
    v_permlane32_swap_b32 v226, v230
    v_permlane32_swap_b32 v232, v236
    v_permlane32_swap_b32 v234, v238
    v_add_f32 v224, v224, v228
    v_add_f32 v226, v226, v230
    v_add_f32 v232, v232, v236
    v_add_f32 v234, v234, v238
    v_permlane16_swap_b32 v224, v226
    s_nop 0
    v_permlane16_swap_b32 v232, v234
    v_add_f32 v224, v224, v226
    v_add_f32 v232, v232, v234
    v_rcp_f32 v232, v232
    s_lshl_b32 s3, s29, 12
    s_add_u32 s3, s3, 149504
    v_add_u32 v240, s3, v5
    s_lshl_b32 s3, s29, 7
    s_add_u32 s3, s3, 157696
    v_lshl_add_u32 v241, v2, 3, s3
    v_mul_f32 v232, v232, v224
    v_mul_f32 v224, 0x358637bd, v224
    v_mov_b32 v226, v224
    v_mov_b32 v234, v232
    s_nop 0
    v_permlane16_swap_b32 v224, v226
    v_permlane16_swap_b32 v232, v234
    v_mov_b32 v228, v224
    v_mov_b32 v230, v226
    v_mov_b32 v236, v232
    v_mov_b32 v238, v234
    v_permlane32_swap_b32 v224, v228
    v_permlane32_swap_b32 v226, v230
    v_permlane32_swap_b32 v232, v236
    v_permlane32_swap_b32 v234, v238
    v_pk_mul_f32 v[16:17], v[16:17], v[232:233] op_sel_hi:[1,0]
    v_pk_mul_f32 v[18:19], v[18:19], v[232:233] op_sel_hi:[1,0]
    v_pk_mul_f32 v[20:21], v[20:21], v[232:233] op_sel_hi:[1,0]
    v_pk_mul_f32 v[22:23], v[22:23], v[232:233] op_sel_hi:[1,0]
    v_cvt_pk_bf16_f32 v72, v8, v9
    v_cvt_pk_bf16_f32 v73, v10, v11
    v_cvt_pk_bf16_f32 v74, v12, v13
    v_cvt_pk_bf16_f32 v75, v14, v15
    v_cvt_pk_bf16_f32 v76, v16, v17
    v_cvt_pk_bf16_f32 v77, v18, v19
    v_cvt_pk_bf16_f32 v78, v20, v21
    v_cvt_pk_bf16_f32 v79, v22, v23
    v_pk_mul_f32 v[32:33], v[32:33], v[234:235] op_sel_hi:[1,0]
    v_pk_mul_f32 v[34:35], v[34:35], v[234:235] op_sel_hi:[1,0]
    v_pk_mul_f32 v[36:37], v[36:37], v[234:235] op_sel_hi:[1,0]
    v_pk_mul_f32 v[38:39], v[38:39], v[234:235] op_sel_hi:[1,0]
    v_cvt_pk_bf16_f32 v80, v24, v25
    v_cvt_pk_bf16_f32 v81, v26, v27
    v_cvt_pk_bf16_f32 v82, v28, v29
    v_cvt_pk_bf16_f32 v83, v30, v31
    v_cvt_pk_bf16_f32 v84, v32, v33
    v_cvt_pk_bf16_f32 v85, v34, v35
    v_cvt_pk_bf16_f32 v86, v36, v37
    v_cvt_pk_bf16_f32 v87, v38, v39
    v_pk_mul_f32 v[48:49], v[48:49], v[236:237] op_sel_hi:[1,0]
    v_pk_mul_f32 v[50:51], v[50:51], v[236:237] op_sel_hi:[1,0]
    v_pk_mul_f32 v[52:53], v[52:53], v[236:237] op_sel_hi:[1,0]
    v_pk_mul_f32 v[54:55], v[54:55], v[236:237] op_sel_hi:[1,0]
    v_cvt_pk_bf16_f32 v88, v40, v41
    v_cvt_pk_bf16_f32 v89, v42, v43
    v_cvt_pk_bf16_f32 v90, v44, v45
    v_cvt_pk_bf16_f32 v91, v46, v47
    v_cvt_pk_bf16_f32 v92, v48, v49
    v_cvt_pk_bf16_f32 v93, v50, v51
    v_cvt_pk_bf16_f32 v94, v52, v53
    v_cvt_pk_bf16_f32 v95, v54, v55
    v_pk_mul_f32 v[64:65], v[64:65], v[238:239] op_sel_hi:[1,0]
    v_pk_mul_f32 v[66:67], v[66:67], v[238:239] op_sel_hi:[1,0]
    v_pk_mul_f32 v[68:69], v[68:69], v[238:239] op_sel_hi:[1,0]
    v_pk_mul_f32 v[70:71], v[70:71], v[238:239] op_sel_hi:[1,0]
    v_cvt_pk_bf16_f32 v96, v56, v57
    v_cvt_pk_bf16_f32 v97, v58, v59
    v_cvt_pk_bf16_f32 v98, v60, v61
    v_cvt_pk_bf16_f32 v99, v62, v63
    v_cvt_pk_bf16_f32 v100, v64, v65
    v_cvt_pk_bf16_f32 v101, v66, v67
    v_cvt_pk_bf16_f32 v102, v68, v69
    v_cvt_pk_bf16_f32 v103, v70, v71
    v_mov_b32 v40, v224
    v_mov_b32 v44, v226
    v_mov_b32 v48, v228
    v_mov_b32 v52, v230
    s_lshl_b32 s3, s36, 3
    s_lshl_b32 s65, s28, 2
    s_add_u32 s3, s3, s65
    s_lshl_b32 s3, s3, 5
    s_lshl_b32 s65, s37, 1
    s_add_u32 s65, s65, s29
    s_add_u32 s3, s3, s65
    s_lshl_b32 s3, s3, 10
    s_add_u32 s3, s3, 12582912
    s_lshl_b32 s66, s36, 4
    s_add_u32 s66, s66, s37
    s_lshl_b32 s66, s66, 7
    s_add_u32 s66, s66, 1310720
    s_lshl_b32 s65, s29, 2
    s_add_u32 s65, s65, 163104
    v_mov_b32 v6, s65
L_kv:
    ds_read_b32 v7, v6
    ds_read_b64 v[120:121], v241 offset:0
    ds_read_b64 v[122:123], v241 offset:32
    ds_read_b64 v[124:125], v241 offset:64
    ds_read_b64 v[126:127], v241 offset:96
    ds_read_b128 v[104:107], v240 offset:0
    ds_read_b128 v[108:111], v240 offset:1024
    ds_read_b128 v[112:115], v240 offset:2048
    ds_read_b128 v[116:119], v240 offset:3072
    s_waitcnt lgkmcnt(4)
    v_readfirstlane_b32 s65, v7
    s_nop 0
    s_cmp_eq_u32 s65, 1
    s_cbranch_scc1 L_kvd
L_kw:
    ds_read_b32 v7, v6
    s_waitcnt lgkmcnt(0)
    v_readfirstlane_b32 s65, v7
    s_nop 0
    s_cmp_eq_u32 s65, 1
    s_cbranch_scc1 L_kv
    s_branch L_kw
L_kvd:
    v_mfma_f32_16x16x32_bf16 v[40:43], v[120:123], v[72:75], v[40:43]
    v_mfma_f32_16x16x32_bf16 v[44:47], v[120:123], v[80:83], v[44:47]
    v_mfma_f32_16x16x32_bf16 v[48:51], v[120:123], v[88:91], v[48:51]
    v_mfma_f32_16x16x32_bf16 v[52:55], v[120:123], v[96:99], v[52:55]
    v_mfma_f32_16x16x32_bf16 v[40:43], v[124:127], v[76:79], v[40:43]
    v_mfma_f32_16x16x32_bf16 v[44:47], v[124:127], v[84:87], v[44:47]
    v_mfma_f32_16x16x32_bf16 v[48:51], v[124:127], v[92:95], v[48:51]
    v_mfma_f32_16x16x32_bf16 v[52:55], v[124:127], v[100:103], v[52:55]
    s_waitcnt lgkmcnt(0)
    v_mfma_f32_16x16x32_bf16 v[8:11], v[104:107], v[72:75], 0
    v_mfma_f32_16x16x32_bf16 v[12:15], v[108:111], v[72:75], 0
    v_mfma_f32_16x16x32_bf16 v[8:11], v[112:115], v[76:79], v[8:11]
    v_mfma_f32_16x16x32_bf16 v[12:15], v[116:119], v[76:79], v[12:15]
    v_mfma_f32_16x16x32_bf16 v[16:19], v[104:107], v[80:83], 0
    v_rcp_f32 v40, v40
    v_mfma_f32_16x16x32_bf16 v[20:23], v[108:111], v[80:83], 0
    v_rcp_f32 v44, v44
    v_mfma_f32_16x16x32_bf16 v[16:19], v[112:115], v[84:87], v[16:19]
    v_rcp_f32 v48, v48
    v_mfma_f32_16x16x32_bf16 v[20:23], v[116:119], v[84:87], v[20:23]
    v_rcp_f32 v52, v52
    v_mfma_f32_16x16x32_bf16 v[24:27], v[104:107], v[88:91], 0
    v_mfma_f32_16x16x32_bf16 v[28:31], v[108:111], v[88:91], 0
    v_mul_f32 v8, v8, v40
    v_mul_f32 v9, v9, v40
    v_mul_f32 v10, v10, v40
    v_mfma_f32_16x16x32_bf16 v[24:27], v[112:115], v[92:95], v[24:27]
    v_mul_f32 v11, v11, v40
    v_mul_f32 v12, v12, v40
    v_mul_f32 v13, v13, v40
    v_mfma_f32_16x16x32_bf16 v[28:31], v[116:119], v[92:95], v[28:31]
    v_mul_f32 v14, v14, v40
    v_mul_f32 v15, v15, v40
    v_cvt_pk_bf16_f32 v128, v8, v9
    v_mfma_f32_16x16x32_bf16 v[32:35], v[104:107], v[96:99], 0
    v_cvt_pk_bf16_f32 v129, v10, v11
    v_cvt_pk_bf16_f32 v130, v12, v13
    v_cvt_pk_bf16_f32 v131, v14, v15
    v_mfma_f32_16x16x32_bf16 v[36:39], v[108:111], v[96:99], 0
    buffer_store_dwordx4 v[128:131], v5, s[12:15], s3 offen sc1
    s_add_u32 s3, s3, 32768
    v_mul_f32 v16, v16, v44
    v_mfma_f32_16x16x32_bf16 v[32:35], v[112:115], v[100:103], v[32:35]
    v_mul_f32 v17, v17, v44
    v_mul_f32 v18, v18, v44
    v_mul_f32 v19, v19, v44
    v_mfma_f32_16x16x32_bf16 v[36:39], v[116:119], v[100:103], v[36:39]
    v_mul_f32 v20, v20, v44
    v_mul_f32 v21, v21, v44
    v_mul_f32 v22, v22, v44
    v_mul_f32 v23, v23, v44
    v_cvt_pk_bf16_f32 v132, v16, v17
    v_cvt_pk_bf16_f32 v133, v18, v19
    v_cvt_pk_bf16_f32 v134, v20, v21
    v_cvt_pk_bf16_f32 v135, v22, v23
    buffer_store_dwordx4 v[132:135], v5, s[12:15], s3 offen sc1
    s_add_u32 s3, s3, 32768
    v_pk_mul_f32 v[24:25], v[24:25], v[48:49] op_sel_hi:[1,0]
    v_pk_mul_f32 v[26:27], v[26:27], v[48:49] op_sel_hi:[1,0]
    v_pk_mul_f32 v[28:29], v[28:29], v[48:49] op_sel_hi:[1,0]
    v_pk_mul_f32 v[30:31], v[30:31], v[48:49] op_sel_hi:[1,0]
    v_cvt_pk_bf16_f32 v136, v24, v25
    v_cvt_pk_bf16_f32 v137, v26, v27
    v_cvt_pk_bf16_f32 v138, v28, v29
    v_cvt_pk_bf16_f32 v139, v30, v31
    buffer_store_dwordx4 v[136:139], v5, s[12:15], s3 offen sc1
    s_add_u32 s3, s3, 32768
    v_pk_mul_f32 v[32:33], v[32:33], v[52:53] op_sel_hi:[1,0]
    v_pk_mul_f32 v[34:35], v[34:35], v[52:53] op_sel_hi:[1,0]
    v_pk_mul_f32 v[36:37], v[36:37], v[52:53] op_sel_hi:[1,0]
    v_pk_mul_f32 v[38:39], v[38:39], v[52:53] op_sel_hi:[1,0]
    v_cvt_pk_bf16_f32 v140, v32, v33
    v_cvt_pk_bf16_f32 v141, v34, v35
    v_cvt_pk_bf16_f32 v142, v36, v37
    v_cvt_pk_bf16_f32 v143, v38, v39
    buffer_store_dwordx4 v[140:143], v5, s[12:15], s3 offen sc1
    s_add_u32 s3, s3, 32768
    v_lshrrev_b32 v6, 2, v1
    v_lshlrev_b32 v6, 7, v6
    v_and_b32 v7, 3, v1
    v_lshl_add_u32 v6, v7, 3, v6
    v_bfe_u32 v7, v1, 3, 2
    v_xor_b32 v4, 0, v7
    v_lshl_add_u32 v250, v4, 5, v6
    v_xor_b32 v4, 1, v7
    v_lshl_add_u32 v251, v4, 5, v6
    v_xor_b32 v4, 2, v7
    v_lshl_add_u32 v252, v4, 5, v6
    v_xor_b32 v4, 3, v7
    v_lshl_add_u32 v253, v4, 5, v6
    s_lshl_b32 s72, s30, 3
    s_lshl_b32 s3, s38, 1
    s_add_u32 s72, s72, s3
    s_lshl_b32 s72, s72, 15
    s_add_u32 s72, s72, 12582912
    v_add_u32 v4, 32768, v5
    s_mul_i32 s3, s38, 4608
    s_add_u32 s3, s3, 131072
    v_mul_u32_u24 v6, 144, v3
    v_lshl_add_u32 v6, v2, 3, v6
    v_add_u32 v240, s3, v6
    v_mov_b32 v160, s32
    v_mov_b32 v161, s32
    v_mov_b32 v162, s32
    v_mov_b32 v163, s32
    v_mov_b32 v164, 163104
    v_mov_b32 v165, 1
    s_waitcnt vmcnt(0)
    s_mov_b64 exec, 1
    ds_add_rtn_u32 v166, v164, v165 offset:96
    s_waitcnt lgkmcnt(0)
    v_readfirstlane_b32 s3, v166
    s_mov_b64 exec, 0xff
    s_cmp_lg_u32 s3, 3
    s_cbranch_scc1 L_nof
    buffer_store_dwordx4 v[160:163], v5, s[12:15], s66 offen sc1
L_nof:
    s_mov_b64 exec, -1
    v_mov_b32 v6, 163104
L_wl:
    ds_read_b128 v[40:43], v6 offset:112
    s_waitcnt lgkmcnt(0)
    v_and_b32 v40, v40, v41
    v_and_b32 v42, v42, v43
    v_and_b32 v40, v40, v42
    s_nop 0
    v_readfirstlane_b32 s65, v40
    s_nop 0
    s_cmp_eq_u32 s65, 1
    s_cbranch_scc0 L_wl
    ds_read_b64_tr_b16 v[40:41], v250 offset:0
    ds_read_b64_tr_b16 v[42:43], v250 offset:2048
    ds_read_b64_tr_b16 v[44:45], v251 offset:0
    ds_read_b64_tr_b16 v[46:47], v251 offset:2048
    ds_read_b64_tr_b16 v[48:49], v252 offset:0
    ds_read_b64_tr_b16 v[50:51], v252 offset:2048
    ds_read_b64_tr_b16 v[52:53], v253 offset:0
    ds_read_b64_tr_b16 v[54:55], v253 offset:2048
    s_cmp_lg_u32 s38, 0
    s_cbranch_scc1 L_gw
    s_lshl_b32 s73, s30, 11
    s_add_u32 s73, s73, 1310720
    v_lshlrev_b32 v6, 7, v3
    s_sleep 9
    buffer_load_dword v7, v6, s[12:15], s73 offen sc1
    s_waitcnt vmcnt(0)
L_op:
    v_xor_b32 v7, s32, v7
    v_cmp_ne_u32 vcc, 0, v7
    s_nop 0
    s_cmp_eq_u64 vcc, 0
    s_cbranch_scc1 L_opok
    s_add_u32 s70, s70, 1
    s_cmp_ge_u32 s70, 200000
    s_cbranch_scc1 L_opok
    s_sleep 4
    buffer_load_dword v7, v6, s[12:15], s73 offen sc1
    s_waitcnt vmcnt(0)
    s_branch L_op
L_opok:
    ds_write_b32 v164, v165 offset:100
    s_branch L_gd
L_gw:
    ds_read_b32 v166, v164 offset:100
    s_waitcnt lgkmcnt(0)
    v_readfirstlane_b32 s3, v166
    s_nop 0
    s_cmp_eq_u32 s3, 1
    s_cbranch_scc1 L_gd
    s_branch L_gw
L_gd:
    buffer_load_dwordx4 v[72:75], v5, s[12:15], s72 offen offset:0 sc1
    buffer_load_dwordx4 v[76:79], v4, s[12:15], s72 offen offset:0 sc1
    buffer_load_dwordx4 v[80:83], v5, s[12:15], s72 offen offset:1024 sc1
    buffer_load_dwordx4 v[84:87], v4, s[12:15], s72 offen offset:1024 sc1
    buffer_load_dwordx4 v[88:91], v5, s[12:15], s72 offen offset:2048 sc1
    buffer_load_dwordx4 v[92:95], v4, s[12:15], s72 offen offset:2048 sc1
    buffer_load_dwordx4 v[96:99], v5, s[12:15], s72 offen offset:3072 sc1
    buffer_load_dwordx4 v[100:103], v4, s[12:15], s72 offen offset:3072 sc1
    s_add_u32 s72, s72, 4096
    buffer_load_dwordx4 v[104:107], v5, s[12:15], s72 offen offset:0 sc1
    buffer_load_dwordx4 v[108:111], v4, s[12:15], s72 offen offset:0 sc1
    buffer_load_dwordx4 v[112:115], v5, s[12:15], s72 offen offset:1024 sc1
    buffer_load_dwordx4 v[116:119], v4, s[12:15], s72 offen offset:1024 sc1
    buffer_load_dwordx4 v[120:123], v5, s[12:15], s72 offen offset:2048 sc1
    buffer_load_dwordx4 v[124:127], v4, s[12:15], s72 offen offset:2048 sc1
    s_waitcnt vmcnt(12)
    s_waitcnt lgkmcnt(0)
    v_mfma_f32_16x16x32_bf16 v[8:11], v[40:43], v[72:75], 0
    ds_read_b64_tr_b16 v[56:57], v250 offset:4096
    v_mfma_f32_16x16x32_bf16 v[12:15], v[44:47], v[72:75], 0
    ds_read_b64_tr_b16 v[58:59], v250 offset:6144
    v_mfma_f32_16x16x32_bf16 v[16:19], v[48:51], v[72:75], 0
    ds_read_b64_tr_b16 v[60:61], v251 offset:4096
    v_mfma_f32_16x16x32_bf16 v[20:23], v[52:55], v[72:75], 0
    ds_read_b64_tr_b16 v[62:63], v251 offset:6144
    v_mfma_f32_16x16x32_bf16 v[24:27], v[40:43], v[76:79], 0
    ds_read_b64_tr_b16 v[64:65], v252 offset:4096
    v_mfma_f32_16x16x32_bf16 v[28:31], v[44:47], v[76:79], 0
    ds_read_b64_tr_b16 v[66:67], v252 offset:6144
    v_mfma_f32_16x16x32_bf16 v[32:35], v[48:51], v[76:79], 0
    ds_read_b64_tr_b16 v[68:69], v253 offset:4096
    v_mfma_f32_16x16x32_bf16 v[36:39], v[52:55], v[76:79], 0
    ds_read_b64_tr_b16 v[70:71], v253 offset:6144
    buffer_load_dwordx4 v[72:75], v5, s[12:15], s72 offen offset:3072 sc1
    buffer_load_dwordx4 v[76:79], v4, s[12:15], s72 offen offset:3072 sc1
    s_add_u32 s72, s72, 4096
    s_waitcnt vmcnt(12)
    s_waitcnt lgkmcnt(0)
    v_mfma_f32_16x16x32_bf16 v[8:11], v[56:59], v[80:83], v[8:11]
    ds_read_b64_tr_b16 v[40:41], v250 offset:8192
    v_mfma_f32_16x16x32_bf16 v[12:15], v[60:63], v[80:83], v[12:15]
    ds_read_b64_tr_b16 v[42:43], v250 offset:10240
    v_mfma_f32_16x16x32_bf16 v[16:19], v[64:67], v[80:83], v[16:19]
    ds_read_b64_tr_b16 v[44:45], v251 offset:8192
    v_mfma_f32_16x16x32_bf16 v[20:23], v[68:71], v[80:83], v[20:23]
    ds_read_b64_tr_b16 v[46:47], v251 offset:10240
    v_mfma_f32_16x16x32_bf16 v[24:27], v[56:59], v[84:87], v[24:27]
    ds_read_b64_tr_b16 v[48:49], v252 offset:8192
    v_mfma_f32_16x16x32_bf16 v[28:31], v[60:63], v[84:87], v[28:31]
    ds_read_b64_tr_b16 v[50:51], v252 offset:10240
    v_mfma_f32_16x16x32_bf16 v[32:35], v[64:67], v[84:87], v[32:35]
    ds_read_b64_tr_b16 v[52:53], v253 offset:8192
    v_mfma_f32_16x16x32_bf16 v[36:39], v[68:71], v[84:87], v[36:39]
    ds_read_b64_tr_b16 v[54:55], v253 offset:10240
    buffer_load_dwordx4 v[80:83], v5, s[12:15], s72 offen offset:0 sc1
    buffer_load_dwordx4 v[84:87], v4, s[12:15], s72 offen offset:0 sc1
    s_waitcnt vmcnt(12)
    s_waitcnt lgkmcnt(0)
    v_mfma_f32_16x16x32_bf16 v[8:11], v[40:43], v[88:91], v[8:11]
    ds_read_b64_tr_b16 v[56:57], v250 offset:12288
    v_mfma_f32_16x16x32_bf16 v[12:15], v[44:47], v[88:91], v[12:15]
    ds_read_b64_tr_b16 v[58:59], v250 offset:14336
    v_mfma_f32_16x16x32_bf16 v[16:19], v[48:51], v[88:91], v[16:19]
    ds_read_b64_tr_b16 v[60:61], v251 offset:12288
    v_mfma_f32_16x16x32_bf16 v[20:23], v[52:55], v[88:91], v[20:23]
    ds_read_b64_tr_b16 v[62:63], v251 offset:14336
    v_mfma_f32_16x16x32_bf16 v[24:27], v[40:43], v[92:95], v[24:27]
    ds_read_b64_tr_b16 v[64:65], v252 offset:12288
    v_mfma_f32_16x16x32_bf16 v[28:31], v[44:47], v[92:95], v[28:31]
    ds_read_b64_tr_b16 v[66:67], v252 offset:14336
    v_mfma_f32_16x16x32_bf16 v[32:35], v[48:51], v[92:95], v[32:35]
    ds_read_b64_tr_b16 v[68:69], v253 offset:12288
    v_mfma_f32_16x16x32_bf16 v[36:39], v[52:55], v[92:95], v[36:39]
    ds_read_b64_tr_b16 v[70:71], v253 offset:14336
    buffer_load_dwordx4 v[88:91], v5, s[12:15], s72 offen offset:1024 sc1
    buffer_load_dwordx4 v[92:95], v4, s[12:15], s72 offen offset:1024 sc1
    s_waitcnt vmcnt(12)
    s_waitcnt lgkmcnt(0)
    v_mfma_f32_16x16x32_bf16 v[8:11], v[56:59], v[96:99], v[8:11]
    ds_read_b64_tr_b16 v[40:41], v250 offset:16384
    v_mfma_f32_16x16x32_bf16 v[12:15], v[60:63], v[96:99], v[12:15]
    ds_read_b64_tr_b16 v[42:43], v250 offset:18432
    v_mfma_f32_16x16x32_bf16 v[16:19], v[64:67], v[96:99], v[16:19]
    ds_read_b64_tr_b16 v[44:45], v251 offset:16384
    v_mfma_f32_16x16x32_bf16 v[20:23], v[68:71], v[96:99], v[20:23]
    ds_read_b64_tr_b16 v[46:47], v251 offset:18432
    v_mfma_f32_16x16x32_bf16 v[24:27], v[56:59], v[100:103], v[24:27]
    ds_read_b64_tr_b16 v[48:49], v252 offset:16384
    v_mfma_f32_16x16x32_bf16 v[28:31], v[60:63], v[100:103], v[28:31]
    ds_read_b64_tr_b16 v[50:51], v252 offset:18432
    v_mfma_f32_16x16x32_bf16 v[32:35], v[64:67], v[100:103], v[32:35]
    ds_read_b64_tr_b16 v[52:53], v253 offset:16384
    v_mfma_f32_16x16x32_bf16 v[36:39], v[68:71], v[100:103], v[36:39]
    ds_read_b64_tr_b16 v[54:55], v253 offset:18432
    buffer_load_dwordx4 v[96:99], v5, s[12:15], s72 offen offset:2048 sc1
    buffer_load_dwordx4 v[100:103], v4, s[12:15], s72 offen offset:2048 sc1
    s_waitcnt vmcnt(12)
    s_waitcnt lgkmcnt(0)
    v_mfma_f32_16x16x32_bf16 v[8:11], v[40:43], v[104:107], v[8:11]
    ds_read_b64_tr_b16 v[56:57], v250 offset:20480
    v_mfma_f32_16x16x32_bf16 v[12:15], v[44:47], v[104:107], v[12:15]
    ds_read_b64_tr_b16 v[58:59], v250 offset:22528
    v_mfma_f32_16x16x32_bf16 v[16:19], v[48:51], v[104:107], v[16:19]
    ds_read_b64_tr_b16 v[60:61], v251 offset:20480
    v_mfma_f32_16x16x32_bf16 v[20:23], v[52:55], v[104:107], v[20:23]
    ds_read_b64_tr_b16 v[62:63], v251 offset:22528
    v_mfma_f32_16x16x32_bf16 v[24:27], v[40:43], v[108:111], v[24:27]
    ds_read_b64_tr_b16 v[64:65], v252 offset:20480
    v_mfma_f32_16x16x32_bf16 v[28:31], v[44:47], v[108:111], v[28:31]
    ds_read_b64_tr_b16 v[66:67], v252 offset:22528
    v_mfma_f32_16x16x32_bf16 v[32:35], v[48:51], v[108:111], v[32:35]
    ds_read_b64_tr_b16 v[68:69], v253 offset:20480
    v_mfma_f32_16x16x32_bf16 v[36:39], v[52:55], v[108:111], v[36:39]
    ds_read_b64_tr_b16 v[70:71], v253 offset:22528
    buffer_load_dwordx4 v[104:107], v5, s[12:15], s72 offen offset:3072 sc1
    buffer_load_dwordx4 v[108:111], v4, s[12:15], s72 offen offset:3072 sc1
    s_add_u32 s72, s72, 4096
    s_waitcnt vmcnt(12)
    s_waitcnt lgkmcnt(0)
    v_mfma_f32_16x16x32_bf16 v[8:11], v[56:59], v[112:115], v[8:11]
    ds_read_b64_tr_b16 v[40:41], v250 offset:24576
    v_mfma_f32_16x16x32_bf16 v[12:15], v[60:63], v[112:115], v[12:15]
    ds_read_b64_tr_b16 v[42:43], v250 offset:26624
    v_mfma_f32_16x16x32_bf16 v[16:19], v[64:67], v[112:115], v[16:19]
    ds_read_b64_tr_b16 v[44:45], v251 offset:24576
    v_mfma_f32_16x16x32_bf16 v[20:23], v[68:71], v[112:115], v[20:23]
    ds_read_b64_tr_b16 v[46:47], v251 offset:26624
    v_mfma_f32_16x16x32_bf16 v[24:27], v[56:59], v[116:119], v[24:27]
    ds_read_b64_tr_b16 v[48:49], v252 offset:24576
    v_mfma_f32_16x16x32_bf16 v[28:31], v[60:63], v[116:119], v[28:31]
    ds_read_b64_tr_b16 v[50:51], v252 offset:26624
    v_mfma_f32_16x16x32_bf16 v[32:35], v[64:67], v[116:119], v[32:35]
    ds_read_b64_tr_b16 v[52:53], v253 offset:24576
    v_mfma_f32_16x16x32_bf16 v[36:39], v[68:71], v[116:119], v[36:39]
    ds_read_b64_tr_b16 v[54:55], v253 offset:26624
    buffer_load_dwordx4 v[112:115], v5, s[12:15], s72 offen offset:0 sc1
    buffer_load_dwordx4 v[116:119], v4, s[12:15], s72 offen offset:0 sc1
    s_waitcnt vmcnt(12)
    s_waitcnt lgkmcnt(0)
    v_mfma_f32_16x16x32_bf16 v[8:11], v[40:43], v[120:123], v[8:11]
    ds_read_b64_tr_b16 v[56:57], v250 offset:28672
    v_mfma_f32_16x16x32_bf16 v[12:15], v[44:47], v[120:123], v[12:15]
    ds_read_b64_tr_b16 v[58:59], v250 offset:30720
    v_mfma_f32_16x16x32_bf16 v[16:19], v[48:51], v[120:123], v[16:19]
    ds_read_b64_tr_b16 v[60:61], v251 offset:28672
    v_mfma_f32_16x16x32_bf16 v[20:23], v[52:55], v[120:123], v[20:23]
    ds_read_b64_tr_b16 v[62:63], v251 offset:30720
    v_mfma_f32_16x16x32_bf16 v[24:27], v[40:43], v[124:127], v[24:27]
    ds_read_b64_tr_b16 v[64:65], v252 offset:28672
    v_mfma_f32_16x16x32_bf16 v[28:31], v[44:47], v[124:127], v[28:31]
    ds_read_b64_tr_b16 v[66:67], v252 offset:30720
    v_mfma_f32_16x16x32_bf16 v[32:35], v[48:51], v[124:127], v[32:35]
    ds_read_b64_tr_b16 v[68:69], v253 offset:28672
    v_mfma_f32_16x16x32_bf16 v[36:39], v[52:55], v[124:127], v[36:39]
    ds_read_b64_tr_b16 v[70:71], v253 offset:30720
    buffer_load_dwordx4 v[120:123], v5, s[12:15], s72 offen offset:1024 sc1
    buffer_load_dwordx4 v[124:127], v4, s[12:15], s72 offen offset:1024 sc1
    s_waitcnt vmcnt(12)
    s_waitcnt lgkmcnt(0)
    v_mfma_f32_16x16x32_bf16 v[8:11], v[56:59], v[72:75], v[8:11]
    ds_read_b64_tr_b16 v[40:41], v250 offset:32768
    v_mfma_f32_16x16x32_bf16 v[12:15], v[60:63], v[72:75], v[12:15]
    ds_read_b64_tr_b16 v[42:43], v250 offset:34816
    v_mfma_f32_16x16x32_bf16 v[16:19], v[64:67], v[72:75], v[16:19]
    ds_read_b64_tr_b16 v[44:45], v251 offset:32768
    v_mfma_f32_16x16x32_bf16 v[20:23], v[68:71], v[72:75], v[20:23]
    ds_read_b64_tr_b16 v[46:47], v251 offset:34816
    v_mfma_f32_16x16x32_bf16 v[24:27], v[56:59], v[76:79], v[24:27]
    ds_read_b64_tr_b16 v[48:49], v252 offset:32768
    v_mfma_f32_16x16x32_bf16 v[28:31], v[60:63], v[76:79], v[28:31]
    ds_read_b64_tr_b16 v[50:51], v252 offset:34816
    v_mfma_f32_16x16x32_bf16 v[32:35], v[64:67], v[76:79], v[32:35]
    ds_read_b64_tr_b16 v[52:53], v253 offset:32768
    v_mfma_f32_16x16x32_bf16 v[36:39], v[68:71], v[76:79], v[36:39]
    ds_read_b64_tr_b16 v[54:55], v253 offset:34816
    buffer_load_dwordx4 v[72:75], v5, s[12:15], s72 offen offset:2048 sc1
    buffer_load_dwordx4 v[76:79], v4, s[12:15], s72 offen offset:2048 sc1
    s_waitcnt vmcnt(12)
    s_waitcnt lgkmcnt(0)
    v_mfma_f32_16x16x32_bf16 v[8:11], v[40:43], v[80:83], v[8:11]
    ds_read_b64_tr_b16 v[56:57], v250 offset:36864
    v_mfma_f32_16x16x32_bf16 v[12:15], v[44:47], v[80:83], v[12:15]
    ds_read_b64_tr_b16 v[58:59], v250 offset:38912
    v_mfma_f32_16x16x32_bf16 v[16:19], v[48:51], v[80:83], v[16:19]
    ds_read_b64_tr_b16 v[60:61], v251 offset:36864
    v_mfma_f32_16x16x32_bf16 v[20:23], v[52:55], v[80:83], v[20:23]
    ds_read_b64_tr_b16 v[62:63], v251 offset:38912
    v_mfma_f32_16x16x32_bf16 v[24:27], v[40:43], v[84:87], v[24:27]
    ds_read_b64_tr_b16 v[64:65], v252 offset:36864
    v_mfma_f32_16x16x32_bf16 v[28:31], v[44:47], v[84:87], v[28:31]
    ds_read_b64_tr_b16 v[66:67], v252 offset:38912
    v_mfma_f32_16x16x32_bf16 v[32:35], v[48:51], v[84:87], v[32:35]
    ds_read_b64_tr_b16 v[68:69], v253 offset:36864
    v_mfma_f32_16x16x32_bf16 v[36:39], v[52:55], v[84:87], v[36:39]
    ds_read_b64_tr_b16 v[70:71], v253 offset:38912
    buffer_load_dwordx4 v[80:83], v5, s[12:15], s72 offen offset:3072 sc1
    buffer_load_dwordx4 v[84:87], v4, s[12:15], s72 offen offset:3072 sc1
    s_add_u32 s72, s72, 4096
    s_waitcnt vmcnt(12)
    s_waitcnt lgkmcnt(0)
    v_mfma_f32_16x16x32_bf16 v[8:11], v[56:59], v[88:91], v[8:11]
    ds_read_b64_tr_b16 v[40:41], v250 offset:40960
    v_mfma_f32_16x16x32_bf16 v[12:15], v[60:63], v[88:91], v[12:15]
    ds_read_b64_tr_b16 v[42:43], v250 offset:43008
    v_mfma_f32_16x16x32_bf16 v[16:19], v[64:67], v[88:91], v[16:19]
    ds_read_b64_tr_b16 v[44:45], v251 offset:40960
    v_mfma_f32_16x16x32_bf16 v[20:23], v[68:71], v[88:91], v[20:23]
    ds_read_b64_tr_b16 v[46:47], v251 offset:43008
    v_mfma_f32_16x16x32_bf16 v[24:27], v[56:59], v[92:95], v[24:27]
    ds_read_b64_tr_b16 v[48:49], v252 offset:40960
    v_mfma_f32_16x16x32_bf16 v[28:31], v[60:63], v[92:95], v[28:31]
    ds_read_b64_tr_b16 v[50:51], v252 offset:43008
    v_mfma_f32_16x16x32_bf16 v[32:35], v[64:67], v[92:95], v[32:35]
    ds_read_b64_tr_b16 v[52:53], v253 offset:40960
    v_mfma_f32_16x16x32_bf16 v[36:39], v[68:71], v[92:95], v[36:39]
    ds_read_b64_tr_b16 v[54:55], v253 offset:43008
    buffer_load_dwordx4 v[88:91], v5, s[12:15], s72 offen offset:0 sc1
    buffer_load_dwordx4 v[92:95], v4, s[12:15], s72 offen offset:0 sc1
    s_waitcnt vmcnt(12)
    s_waitcnt lgkmcnt(0)
    v_mfma_f32_16x16x32_bf16 v[8:11], v[40:43], v[96:99], v[8:11]
    ds_read_b64_tr_b16 v[56:57], v250 offset:45056
    v_mfma_f32_16x16x32_bf16 v[12:15], v[44:47], v[96:99], v[12:15]
    ds_read_b64_tr_b16 v[58:59], v250 offset:47104
    v_mfma_f32_16x16x32_bf16 v[16:19], v[48:51], v[96:99], v[16:19]
    ds_read_b64_tr_b16 v[60:61], v251 offset:45056
    v_mfma_f32_16x16x32_bf16 v[20:23], v[52:55], v[96:99], v[20:23]
    ds_read_b64_tr_b16 v[62:63], v251 offset:47104
    v_mfma_f32_16x16x32_bf16 v[24:27], v[40:43], v[100:103], v[24:27]
    ds_read_b64_tr_b16 v[64:65], v252 offset:45056
    v_mfma_f32_16x16x32_bf16 v[28:31], v[44:47], v[100:103], v[28:31]
    ds_read_b64_tr_b16 v[66:67], v252 offset:47104
    v_mfma_f32_16x16x32_bf16 v[32:35], v[48:51], v[100:103], v[32:35]
    ds_read_b64_tr_b16 v[68:69], v253 offset:45056
    v_mfma_f32_16x16x32_bf16 v[36:39], v[52:55], v[100:103], v[36:39]
    ds_read_b64_tr_b16 v[70:71], v253 offset:47104
    buffer_load_dwordx4 v[96:99], v5, s[12:15], s72 offen offset:1024 sc1
    buffer_load_dwordx4 v[100:103], v4, s[12:15], s72 offen offset:1024 sc1
    s_waitcnt vmcnt(12)
    s_waitcnt lgkmcnt(0)
    v_mfma_f32_16x16x32_bf16 v[8:11], v[56:59], v[104:107], v[8:11]
    ds_read_b64_tr_b16 v[40:41], v250 offset:49152
    v_mfma_f32_16x16x32_bf16 v[12:15], v[60:63], v[104:107], v[12:15]
    ds_read_b64_tr_b16 v[42:43], v250 offset:51200
    v_mfma_f32_16x16x32_bf16 v[16:19], v[64:67], v[104:107], v[16:19]
    ds_read_b64_tr_b16 v[44:45], v251 offset:49152
    v_mfma_f32_16x16x32_bf16 v[20:23], v[68:71], v[104:107], v[20:23]
    ds_read_b64_tr_b16 v[46:47], v251 offset:51200
    v_mfma_f32_16x16x32_bf16 v[24:27], v[56:59], v[108:111], v[24:27]
    ds_read_b64_tr_b16 v[48:49], v252 offset:49152
    v_mfma_f32_16x16x32_bf16 v[28:31], v[60:63], v[108:111], v[28:31]
    ds_read_b64_tr_b16 v[50:51], v252 offset:51200
    v_mfma_f32_16x16x32_bf16 v[32:35], v[64:67], v[108:111], v[32:35]
    ds_read_b64_tr_b16 v[52:53], v253 offset:49152
    v_mfma_f32_16x16x32_bf16 v[36:39], v[68:71], v[108:111], v[36:39]
    ds_read_b64_tr_b16 v[54:55], v253 offset:51200
    buffer_load_dwordx4 v[104:107], v5, s[12:15], s72 offen offset:2048 sc1
    buffer_load_dwordx4 v[108:111], v4, s[12:15], s72 offen offset:2048 sc1
    s_waitcnt vmcnt(12)
    s_waitcnt lgkmcnt(0)
    v_mfma_f32_16x16x32_bf16 v[8:11], v[40:43], v[112:115], v[8:11]
    ds_read_b64_tr_b16 v[56:57], v250 offset:53248
    v_mfma_f32_16x16x32_bf16 v[12:15], v[44:47], v[112:115], v[12:15]
    ds_read_b64_tr_b16 v[58:59], v250 offset:55296
    v_mfma_f32_16x16x32_bf16 v[16:19], v[48:51], v[112:115], v[16:19]
    ds_read_b64_tr_b16 v[60:61], v251 offset:53248
    v_mfma_f32_16x16x32_bf16 v[20:23], v[52:55], v[112:115], v[20:23]
    ds_read_b64_tr_b16 v[62:63], v251 offset:55296
    v_mfma_f32_16x16x32_bf16 v[24:27], v[40:43], v[116:119], v[24:27]
    ds_read_b64_tr_b16 v[64:65], v252 offset:53248
    v_mfma_f32_16x16x32_bf16 v[28:31], v[44:47], v[116:119], v[28:31]
    ds_read_b64_tr_b16 v[66:67], v252 offset:55296
    v_mfma_f32_16x16x32_bf16 v[32:35], v[48:51], v[116:119], v[32:35]
    ds_read_b64_tr_b16 v[68:69], v253 offset:53248
    v_mfma_f32_16x16x32_bf16 v[36:39], v[52:55], v[116:119], v[36:39]
    ds_read_b64_tr_b16 v[70:71], v253 offset:55296
    buffer_load_dwordx4 v[112:115], v5, s[12:15], s72 offen offset:3072 sc1
    buffer_load_dwordx4 v[116:119], v4, s[12:15], s72 offen offset:3072 sc1
    s_add_u32 s72, s72, 4096
    s_waitcnt vmcnt(12)
    s_waitcnt lgkmcnt(0)
    v_mfma_f32_16x16x32_bf16 v[8:11], v[56:59], v[120:123], v[8:11]
    ds_read_b64_tr_b16 v[40:41], v250 offset:57344
    v_mfma_f32_16x16x32_bf16 v[12:15], v[60:63], v[120:123], v[12:15]
    ds_read_b64_tr_b16 v[42:43], v250 offset:59392
    v_mfma_f32_16x16x32_bf16 v[16:19], v[64:67], v[120:123], v[16:19]
    ds_read_b64_tr_b16 v[44:45], v251 offset:57344
    v_mfma_f32_16x16x32_bf16 v[20:23], v[68:71], v[120:123], v[20:23]
    ds_read_b64_tr_b16 v[46:47], v251 offset:59392
    v_mfma_f32_16x16x32_bf16 v[24:27], v[56:59], v[124:127], v[24:27]
    ds_read_b64_tr_b16 v[48:49], v252 offset:57344
    v_mfma_f32_16x16x32_bf16 v[28:31], v[60:63], v[124:127], v[28:31]
    ds_read_b64_tr_b16 v[50:51], v252 offset:59392
    v_mfma_f32_16x16x32_bf16 v[32:35], v[64:67], v[124:127], v[32:35]
    ds_read_b64_tr_b16 v[52:53], v253 offset:57344
    v_mfma_f32_16x16x32_bf16 v[36:39], v[68:71], v[124:127], v[36:39]
    ds_read_b64_tr_b16 v[54:55], v253 offset:59392
    buffer_load_dwordx4 v[120:123], v5, s[12:15], s72 offen offset:0 sc1
    buffer_load_dwordx4 v[124:127], v4, s[12:15], s72 offen offset:0 sc1
    s_waitcnt vmcnt(12)
    s_waitcnt lgkmcnt(0)
    v_mfma_f32_16x16x32_bf16 v[8:11], v[40:43], v[72:75], v[8:11]
    ds_read_b64_tr_b16 v[56:57], v250 offset:61440
    v_mfma_f32_16x16x32_bf16 v[12:15], v[44:47], v[72:75], v[12:15]
    ds_read_b64_tr_b16 v[58:59], v250 offset:63488
    v_mfma_f32_16x16x32_bf16 v[16:19], v[48:51], v[72:75], v[16:19]
    ds_read_b64_tr_b16 v[60:61], v251 offset:61440
    v_mfma_f32_16x16x32_bf16 v[20:23], v[52:55], v[72:75], v[20:23]
    ds_read_b64_tr_b16 v[62:63], v251 offset:63488
    v_mfma_f32_16x16x32_bf16 v[24:27], v[40:43], v[76:79], v[24:27]
    ds_read_b64_tr_b16 v[64:65], v252 offset:61440
    v_mfma_f32_16x16x32_bf16 v[28:31], v[44:47], v[76:79], v[28:31]
    ds_read_b64_tr_b16 v[66:67], v252 offset:63488
    v_mfma_f32_16x16x32_bf16 v[32:35], v[48:51], v[76:79], v[32:35]
    ds_read_b64_tr_b16 v[68:69], v253 offset:61440
    v_mfma_f32_16x16x32_bf16 v[36:39], v[52:55], v[76:79], v[36:39]
    ds_read_b64_tr_b16 v[70:71], v253 offset:63488
    buffer_load_dwordx4 v[72:75], v5, s[12:15], s72 offen offset:1024 sc1
    buffer_load_dwordx4 v[76:79], v4, s[12:15], s72 offen offset:1024 sc1
    s_waitcnt vmcnt(12)
    s_waitcnt lgkmcnt(0)
    v_add_u32 v250, 0x10000, v250
    v_add_u32 v251, 0x10000, v251
    v_add_u32 v252, 0x10000, v252
    v_add_u32 v253, 0x10000, v253
    v_mfma_f32_16x16x32_bf16 v[8:11], v[56:59], v[80:83], v[8:11]
    ds_read_b64_tr_b16 v[40:41], v250 offset:0
    v_mfma_f32_16x16x32_bf16 v[12:15], v[60:63], v[80:83], v[12:15]
    ds_read_b64_tr_b16 v[42:43], v250 offset:2048
    v_mfma_f32_16x16x32_bf16 v[16:19], v[64:67], v[80:83], v[16:19]
    ds_read_b64_tr_b16 v[44:45], v251 offset:0
    v_mfma_f32_16x16x32_bf16 v[20:23], v[68:71], v[80:83], v[20:23]
    ds_read_b64_tr_b16 v[46:47], v251 offset:2048
    v_mfma_f32_16x16x32_bf16 v[24:27], v[56:59], v[84:87], v[24:27]
    ds_read_b64_tr_b16 v[48:49], v252 offset:0
    v_mfma_f32_16x16x32_bf16 v[28:31], v[60:63], v[84:87], v[28:31]
    ds_read_b64_tr_b16 v[50:51], v252 offset:2048
    v_mfma_f32_16x16x32_bf16 v[32:35], v[64:67], v[84:87], v[32:35]
    ds_read_b64_tr_b16 v[52:53], v253 offset:0
    v_mfma_f32_16x16x32_bf16 v[36:39], v[68:71], v[84:87], v[36:39]
    ds_read_b64_tr_b16 v[54:55], v253 offset:2048
    buffer_load_dwordx4 v[80:83], v5, s[12:15], s72 offen offset:2048 sc1
    buffer_load_dwordx4 v[84:87], v4, s[12:15], s72 offen offset:2048 sc1
    s_waitcnt vmcnt(12)
    s_waitcnt lgkmcnt(0)
    v_mfma_f32_16x16x32_bf16 v[8:11], v[40:43], v[88:91], v[8:11]
    ds_read_b64_tr_b16 v[56:57], v250 offset:4096
    v_mfma_f32_16x16x32_bf16 v[12:15], v[44:47], v[88:91], v[12:15]
    ds_read_b64_tr_b16 v[58:59], v250 offset:6144
    v_mfma_f32_16x16x32_bf16 v[16:19], v[48:51], v[88:91], v[16:19]
    ds_read_b64_tr_b16 v[60:61], v251 offset:4096
    v_mfma_f32_16x16x32_bf16 v[20:23], v[52:55], v[88:91], v[20:23]
    ds_read_b64_tr_b16 v[62:63], v251 offset:6144
    v_mfma_f32_16x16x32_bf16 v[24:27], v[40:43], v[92:95], v[24:27]
    ds_read_b64_tr_b16 v[64:65], v252 offset:4096
    v_mfma_f32_16x16x32_bf16 v[28:31], v[44:47], v[92:95], v[28:31]
    ds_read_b64_tr_b16 v[66:67], v252 offset:6144
    v_mfma_f32_16x16x32_bf16 v[32:35], v[48:51], v[92:95], v[32:35]
    ds_read_b64_tr_b16 v[68:69], v253 offset:4096
    v_mfma_f32_16x16x32_bf16 v[36:39], v[52:55], v[92:95], v[36:39]
    ds_read_b64_tr_b16 v[70:71], v253 offset:6144
    buffer_load_dwordx4 v[88:91], v5, s[12:15], s72 offen offset:3072 sc1
    buffer_load_dwordx4 v[92:95], v4, s[12:15], s72 offen offset:3072 sc1
    s_add_u32 s72, s72, 4096
    s_waitcnt vmcnt(12)
    s_waitcnt lgkmcnt(0)
    v_mfma_f32_16x16x32_bf16 v[8:11], v[56:59], v[96:99], v[8:11]
    ds_read_b64_tr_b16 v[40:41], v250 offset:8192
    v_mfma_f32_16x16x32_bf16 v[12:15], v[60:63], v[96:99], v[12:15]
    ds_read_b64_tr_b16 v[42:43], v250 offset:10240
    v_mfma_f32_16x16x32_bf16 v[16:19], v[64:67], v[96:99], v[16:19]
    ds_read_b64_tr_b16 v[44:45], v251 offset:8192
    v_mfma_f32_16x16x32_bf16 v[20:23], v[68:71], v[96:99], v[20:23]
    ds_read_b64_tr_b16 v[46:47], v251 offset:10240
    v_mfma_f32_16x16x32_bf16 v[24:27], v[56:59], v[100:103], v[24:27]
    ds_read_b64_tr_b16 v[48:49], v252 offset:8192
    v_mfma_f32_16x16x32_bf16 v[28:31], v[60:63], v[100:103], v[28:31]
    ds_read_b64_tr_b16 v[50:51], v252 offset:10240
    v_mfma_f32_16x16x32_bf16 v[32:35], v[64:67], v[100:103], v[32:35]
    ds_read_b64_tr_b16 v[52:53], v253 offset:8192
    v_mfma_f32_16x16x32_bf16 v[36:39], v[68:71], v[100:103], v[36:39]
    ds_read_b64_tr_b16 v[54:55], v253 offset:10240
    buffer_load_dwordx4 v[96:99], v5, s[12:15], s72 offen offset:0 sc1
    buffer_load_dwordx4 v[100:103], v4, s[12:15], s72 offen offset:0 sc1
    s_waitcnt vmcnt(12)
    s_waitcnt lgkmcnt(0)
    v_mfma_f32_16x16x32_bf16 v[8:11], v[40:43], v[104:107], v[8:11]
    ds_read_b64_tr_b16 v[56:57], v250 offset:12288
    v_mfma_f32_16x16x32_bf16 v[12:15], v[44:47], v[104:107], v[12:15]
    ds_read_b64_tr_b16 v[58:59], v250 offset:14336
    v_mfma_f32_16x16x32_bf16 v[16:19], v[48:51], v[104:107], v[16:19]
    ds_read_b64_tr_b16 v[60:61], v251 offset:12288
    v_mfma_f32_16x16x32_bf16 v[20:23], v[52:55], v[104:107], v[20:23]
    ds_read_b64_tr_b16 v[62:63], v251 offset:14336
    v_mfma_f32_16x16x32_bf16 v[24:27], v[40:43], v[108:111], v[24:27]
    ds_read_b64_tr_b16 v[64:65], v252 offset:12288
    v_mfma_f32_16x16x32_bf16 v[28:31], v[44:47], v[108:111], v[28:31]
    ds_read_b64_tr_b16 v[66:67], v252 offset:14336
    v_mfma_f32_16x16x32_bf16 v[32:35], v[48:51], v[108:111], v[32:35]
    ds_read_b64_tr_b16 v[68:69], v253 offset:12288
    v_mfma_f32_16x16x32_bf16 v[36:39], v[52:55], v[108:111], v[36:39]
    ds_read_b64_tr_b16 v[70:71], v253 offset:14336
    buffer_load_dwordx4 v[104:107], v5, s[12:15], s72 offen offset:1024 sc1
    buffer_load_dwordx4 v[108:111], v4, s[12:15], s72 offen offset:1024 sc1
    s_waitcnt vmcnt(12)
    s_waitcnt lgkmcnt(0)
    v_mfma_f32_16x16x32_bf16 v[8:11], v[56:59], v[112:115], v[8:11]
    ds_read_b64_tr_b16 v[40:41], v250 offset:16384
    v_mfma_f32_16x16x32_bf16 v[12:15], v[60:63], v[112:115], v[12:15]
    ds_read_b64_tr_b16 v[42:43], v250 offset:18432
    v_mfma_f32_16x16x32_bf16 v[16:19], v[64:67], v[112:115], v[16:19]
    ds_read_b64_tr_b16 v[44:45], v251 offset:16384
    v_mfma_f32_16x16x32_bf16 v[20:23], v[68:71], v[112:115], v[20:23]
    ds_read_b64_tr_b16 v[46:47], v251 offset:18432
    v_mfma_f32_16x16x32_bf16 v[24:27], v[56:59], v[116:119], v[24:27]
    ds_read_b64_tr_b16 v[48:49], v252 offset:16384
    v_mfma_f32_16x16x32_bf16 v[28:31], v[60:63], v[116:119], v[28:31]
    ds_read_b64_tr_b16 v[50:51], v252 offset:18432
    v_mfma_f32_16x16x32_bf16 v[32:35], v[64:67], v[116:119], v[32:35]
    ds_read_b64_tr_b16 v[52:53], v253 offset:16384
    v_mfma_f32_16x16x32_bf16 v[36:39], v[68:71], v[116:119], v[36:39]
    ds_read_b64_tr_b16 v[54:55], v253 offset:18432
    buffer_load_dwordx4 v[112:115], v5, s[12:15], s72 offen offset:2048 sc1
    buffer_load_dwordx4 v[116:119], v4, s[12:15], s72 offen offset:2048 sc1
    s_waitcnt vmcnt(12)
    s_waitcnt lgkmcnt(0)
    v_mfma_f32_16x16x32_bf16 v[8:11], v[40:43], v[120:123], v[8:11]
    ds_read_b64_tr_b16 v[56:57], v250 offset:20480
    v_mfma_f32_16x16x32_bf16 v[12:15], v[44:47], v[120:123], v[12:15]
    ds_read_b64_tr_b16 v[58:59], v250 offset:22528
    v_mfma_f32_16x16x32_bf16 v[16:19], v[48:51], v[120:123], v[16:19]
    ds_read_b64_tr_b16 v[60:61], v251 offset:20480
    v_mfma_f32_16x16x32_bf16 v[20:23], v[52:55], v[120:123], v[20:23]
    ds_read_b64_tr_b16 v[62:63], v251 offset:22528
    v_mfma_f32_16x16x32_bf16 v[24:27], v[40:43], v[124:127], v[24:27]
    ds_read_b64_tr_b16 v[64:65], v252 offset:20480
    v_mfma_f32_16x16x32_bf16 v[28:31], v[44:47], v[124:127], v[28:31]
    ds_read_b64_tr_b16 v[66:67], v252 offset:22528
    v_mfma_f32_16x16x32_bf16 v[32:35], v[48:51], v[124:127], v[32:35]
    ds_read_b64_tr_b16 v[68:69], v253 offset:20480
    v_mfma_f32_16x16x32_bf16 v[36:39], v[52:55], v[124:127], v[36:39]
    ds_read_b64_tr_b16 v[70:71], v253 offset:22528
    buffer_load_dwordx4 v[120:123], v5, s[12:15], s72 offen offset:3072 sc1
    buffer_load_dwordx4 v[124:127], v4, s[12:15], s72 offen offset:3072 sc1
    s_add_u32 s72, s72, 4096
    s_waitcnt vmcnt(12)
    s_waitcnt lgkmcnt(0)
    v_mfma_f32_16x16x32_bf16 v[8:11], v[56:59], v[72:75], v[8:11]
    ds_read_b64_tr_b16 v[40:41], v250 offset:24576
    v_mfma_f32_16x16x32_bf16 v[12:15], v[60:63], v[72:75], v[12:15]
    ds_read_b64_tr_b16 v[42:43], v250 offset:26624
    v_mfma_f32_16x16x32_bf16 v[16:19], v[64:67], v[72:75], v[16:19]
    ds_read_b64_tr_b16 v[44:45], v251 offset:24576
    v_mfma_f32_16x16x32_bf16 v[20:23], v[68:71], v[72:75], v[20:23]
    ds_read_b64_tr_b16 v[46:47], v251 offset:26624
    v_mfma_f32_16x16x32_bf16 v[24:27], v[56:59], v[76:79], v[24:27]
    ds_read_b64_tr_b16 v[48:49], v252 offset:24576
    v_mfma_f32_16x16x32_bf16 v[28:31], v[60:63], v[76:79], v[28:31]
    ds_read_b64_tr_b16 v[50:51], v252 offset:26624
    v_mfma_f32_16x16x32_bf16 v[32:35], v[64:67], v[76:79], v[32:35]
    ds_read_b64_tr_b16 v[52:53], v253 offset:24576
    v_mfma_f32_16x16x32_bf16 v[36:39], v[68:71], v[76:79], v[36:39]
    ds_read_b64_tr_b16 v[54:55], v253 offset:26624
    buffer_load_dwordx4 v[72:75], v5, s[12:15], s72 offen offset:0 sc1
    buffer_load_dwordx4 v[76:79], v4, s[12:15], s72 offen offset:0 sc1
    s_waitcnt vmcnt(12)
    s_waitcnt lgkmcnt(0)
    v_mfma_f32_16x16x32_bf16 v[8:11], v[40:43], v[80:83], v[8:11]
    ds_read_b64_tr_b16 v[56:57], v250 offset:28672
    v_mfma_f32_16x16x32_bf16 v[12:15], v[44:47], v[80:83], v[12:15]
    ds_read_b64_tr_b16 v[58:59], v250 offset:30720
    v_mfma_f32_16x16x32_bf16 v[16:19], v[48:51], v[80:83], v[16:19]
    ds_read_b64_tr_b16 v[60:61], v251 offset:28672
    v_mfma_f32_16x16x32_bf16 v[20:23], v[52:55], v[80:83], v[20:23]
    ds_read_b64_tr_b16 v[62:63], v251 offset:30720
    v_mfma_f32_16x16x32_bf16 v[24:27], v[40:43], v[84:87], v[24:27]
    ds_read_b64_tr_b16 v[64:65], v252 offset:28672
    v_mfma_f32_16x16x32_bf16 v[28:31], v[44:47], v[84:87], v[28:31]
    ds_read_b64_tr_b16 v[66:67], v252 offset:30720
    v_mfma_f32_16x16x32_bf16 v[32:35], v[48:51], v[84:87], v[32:35]
    ds_read_b64_tr_b16 v[68:69], v253 offset:28672
    v_mfma_f32_16x16x32_bf16 v[36:39], v[52:55], v[84:87], v[36:39]
    ds_read_b64_tr_b16 v[70:71], v253 offset:30720
    buffer_load_dwordx4 v[80:83], v5, s[12:15], s72 offen offset:1024 sc1
    buffer_load_dwordx4 v[84:87], v4, s[12:15], s72 offen offset:1024 sc1
    s_waitcnt vmcnt(12)
    s_waitcnt lgkmcnt(0)
    v_mfma_f32_16x16x32_bf16 v[8:11], v[56:59], v[88:91], v[8:11]
    ds_read_b64_tr_b16 v[40:41], v250 offset:32768
    v_mfma_f32_16x16x32_bf16 v[12:15], v[60:63], v[88:91], v[12:15]
    ds_read_b64_tr_b16 v[42:43], v250 offset:34816
    v_mfma_f32_16x16x32_bf16 v[16:19], v[64:67], v[88:91], v[16:19]
    ds_read_b64_tr_b16 v[44:45], v251 offset:32768
    v_mfma_f32_16x16x32_bf16 v[20:23], v[68:71], v[88:91], v[20:23]
    ds_read_b64_tr_b16 v[46:47], v251 offset:34816
    v_mfma_f32_16x16x32_bf16 v[24:27], v[56:59], v[92:95], v[24:27]
    ds_read_b64_tr_b16 v[48:49], v252 offset:32768
    v_mfma_f32_16x16x32_bf16 v[28:31], v[60:63], v[92:95], v[28:31]
    ds_read_b64_tr_b16 v[50:51], v252 offset:34816
    v_mfma_f32_16x16x32_bf16 v[32:35], v[64:67], v[92:95], v[32:35]
    ds_read_b64_tr_b16 v[52:53], v253 offset:32768
    v_mfma_f32_16x16x32_bf16 v[36:39], v[68:71], v[92:95], v[36:39]
    ds_read_b64_tr_b16 v[54:55], v253 offset:34816
    buffer_load_dwordx4 v[88:91], v5, s[12:15], s72 offen offset:2048 sc1
    buffer_load_dwordx4 v[92:95], v4, s[12:15], s72 offen offset:2048 sc1
    s_waitcnt vmcnt(12)
    s_waitcnt lgkmcnt(0)
    v_mfma_f32_16x16x32_bf16 v[8:11], v[40:43], v[96:99], v[8:11]
    ds_read_b64_tr_b16 v[56:57], v250 offset:36864
    v_mfma_f32_16x16x32_bf16 v[12:15], v[44:47], v[96:99], v[12:15]
    ds_read_b64_tr_b16 v[58:59], v250 offset:38912
    v_mfma_f32_16x16x32_bf16 v[16:19], v[48:51], v[96:99], v[16:19]
    ds_read_b64_tr_b16 v[60:61], v251 offset:36864
    v_mfma_f32_16x16x32_bf16 v[20:23], v[52:55], v[96:99], v[20:23]
    ds_read_b64_tr_b16 v[62:63], v251 offset:38912
    v_mfma_f32_16x16x32_bf16 v[24:27], v[40:43], v[100:103], v[24:27]
    ds_read_b64_tr_b16 v[64:65], v252 offset:36864
    v_mfma_f32_16x16x32_bf16 v[28:31], v[44:47], v[100:103], v[28:31]
    ds_read_b64_tr_b16 v[66:67], v252 offset:38912
    v_mfma_f32_16x16x32_bf16 v[32:35], v[48:51], v[100:103], v[32:35]
    ds_read_b64_tr_b16 v[68:69], v253 offset:36864
    v_mfma_f32_16x16x32_bf16 v[36:39], v[52:55], v[100:103], v[36:39]
    ds_read_b64_tr_b16 v[70:71], v253 offset:38912
    buffer_load_dwordx4 v[96:99], v5, s[12:15], s72 offen offset:3072 sc1
    buffer_load_dwordx4 v[100:103], v4, s[12:15], s72 offen offset:3072 sc1
    s_add_u32 s72, s72, 4096
    s_waitcnt vmcnt(12)
    s_waitcnt lgkmcnt(0)
    v_mfma_f32_16x16x32_bf16 v[8:11], v[56:59], v[104:107], v[8:11]
    ds_read_b64_tr_b16 v[40:41], v250 offset:40960
    v_mfma_f32_16x16x32_bf16 v[12:15], v[60:63], v[104:107], v[12:15]
    ds_read_b64_tr_b16 v[42:43], v250 offset:43008
    v_mfma_f32_16x16x32_bf16 v[16:19], v[64:67], v[104:107], v[16:19]
    ds_read_b64_tr_b16 v[44:45], v251 offset:40960
    v_mfma_f32_16x16x32_bf16 v[20:23], v[68:71], v[104:107], v[20:23]
    ds_read_b64_tr_b16 v[46:47], v251 offset:43008
    v_mfma_f32_16x16x32_bf16 v[24:27], v[56:59], v[108:111], v[24:27]
    ds_read_b64_tr_b16 v[48:49], v252 offset:40960
    v_mfma_f32_16x16x32_bf16 v[28:31], v[60:63], v[108:111], v[28:31]
    ds_read_b64_tr_b16 v[50:51], v252 offset:43008
    v_mfma_f32_16x16x32_bf16 v[32:35], v[64:67], v[108:111], v[32:35]
    ds_read_b64_tr_b16 v[52:53], v253 offset:40960
    v_mfma_f32_16x16x32_bf16 v[36:39], v[68:71], v[108:111], v[36:39]
    ds_read_b64_tr_b16 v[54:55], v253 offset:43008
    s_waitcnt vmcnt(10)
    s_waitcnt lgkmcnt(0)
    v_mfma_f32_16x16x32_bf16 v[8:11], v[40:43], v[112:115], v[8:11]
    ds_read_b64_tr_b16 v[56:57], v250 offset:45056
    v_mfma_f32_16x16x32_bf16 v[12:15], v[44:47], v[112:115], v[12:15]
    ds_read_b64_tr_b16 v[58:59], v250 offset:47104
    v_mfma_f32_16x16x32_bf16 v[16:19], v[48:51], v[112:115], v[16:19]
    ds_read_b64_tr_b16 v[60:61], v251 offset:45056
    v_mfma_f32_16x16x32_bf16 v[20:23], v[52:55], v[112:115], v[20:23]
    ds_read_b64_tr_b16 v[62:63], v251 offset:47104
    v_mfma_f32_16x16x32_bf16 v[24:27], v[40:43], v[116:119], v[24:27]
    ds_read_b64_tr_b16 v[64:65], v252 offset:45056
    v_mfma_f32_16x16x32_bf16 v[28:31], v[44:47], v[116:119], v[28:31]
    ds_read_b64_tr_b16 v[66:67], v252 offset:47104
    v_mfma_f32_16x16x32_bf16 v[32:35], v[48:51], v[116:119], v[32:35]
    ds_read_b64_tr_b16 v[68:69], v253 offset:45056
    v_mfma_f32_16x16x32_bf16 v[36:39], v[52:55], v[116:119], v[36:39]
    ds_read_b64_tr_b16 v[70:71], v253 offset:47104
    s_waitcnt vmcnt(8)
    s_waitcnt lgkmcnt(0)
    v_mfma_f32_16x16x32_bf16 v[8:11], v[56:59], v[120:123], v[8:11]
    ds_read_b64_tr_b16 v[40:41], v250 offset:49152
    v_mfma_f32_16x16x32_bf16 v[12:15], v[60:63], v[120:123], v[12:15]
    ds_read_b64_tr_b16 v[42:43], v250 offset:51200
    v_mfma_f32_16x16x32_bf16 v[16:19], v[64:67], v[120:123], v[16:19]
    ds_read_b64_tr_b16 v[44:45], v251 offset:49152
    v_mfma_f32_16x16x32_bf16 v[20:23], v[68:71], v[120:123], v[20:23]
    ds_read_b64_tr_b16 v[46:47], v251 offset:51200
    v_mfma_f32_16x16x32_bf16 v[24:27], v[56:59], v[124:127], v[24:27]
    ds_read_b64_tr_b16 v[48:49], v252 offset:49152
    v_mfma_f32_16x16x32_bf16 v[28:31], v[60:63], v[124:127], v[28:31]
    ds_read_b64_tr_b16 v[50:51], v252 offset:51200
    v_mfma_f32_16x16x32_bf16 v[32:35], v[64:67], v[124:127], v[32:35]
    ds_read_b64_tr_b16 v[52:53], v253 offset:49152
    v_mfma_f32_16x16x32_bf16 v[36:39], v[68:71], v[124:127], v[36:39]
    ds_read_b64_tr_b16 v[54:55], v253 offset:51200
    s_waitcnt vmcnt(6)
    s_waitcnt lgkmcnt(0)
    v_mfma_f32_16x16x32_bf16 v[8:11], v[40:43], v[72:75], v[8:11]
    ds_read_b64_tr_b16 v[56:57], v250 offset:53248
    v_mfma_f32_16x16x32_bf16 v[12:15], v[44:47], v[72:75], v[12:15]
    ds_read_b64_tr_b16 v[58:59], v250 offset:55296
    v_mfma_f32_16x16x32_bf16 v[16:19], v[48:51], v[72:75], v[16:19]
    ds_read_b64_tr_b16 v[60:61], v251 offset:53248
    v_mfma_f32_16x16x32_bf16 v[20:23], v[52:55], v[72:75], v[20:23]
    ds_read_b64_tr_b16 v[62:63], v251 offset:55296
    v_mfma_f32_16x16x32_bf16 v[24:27], v[40:43], v[76:79], v[24:27]
    ds_read_b64_tr_b16 v[64:65], v252 offset:53248
    v_mfma_f32_16x16x32_bf16 v[28:31], v[44:47], v[76:79], v[28:31]
    ds_read_b64_tr_b16 v[66:67], v252 offset:55296
    v_mfma_f32_16x16x32_bf16 v[32:35], v[48:51], v[76:79], v[32:35]
    ds_read_b64_tr_b16 v[68:69], v253 offset:53248
    v_mfma_f32_16x16x32_bf16 v[36:39], v[52:55], v[76:79], v[36:39]
    ds_read_b64_tr_b16 v[70:71], v253 offset:55296
    s_waitcnt vmcnt(4)
    s_waitcnt lgkmcnt(0)
    v_mfma_f32_16x16x32_bf16 v[8:11], v[56:59], v[80:83], v[8:11]
    ds_read_b64_tr_b16 v[40:41], v250 offset:57344
    v_mfma_f32_16x16x32_bf16 v[12:15], v[60:63], v[80:83], v[12:15]
    ds_read_b64_tr_b16 v[42:43], v250 offset:59392
    v_mfma_f32_16x16x32_bf16 v[16:19], v[64:67], v[80:83], v[16:19]
    ds_read_b64_tr_b16 v[44:45], v251 offset:57344
    v_mfma_f32_16x16x32_bf16 v[20:23], v[68:71], v[80:83], v[20:23]
    ds_read_b64_tr_b16 v[46:47], v251 offset:59392
    v_mfma_f32_16x16x32_bf16 v[24:27], v[56:59], v[84:87], v[24:27]
    ds_read_b64_tr_b16 v[48:49], v252 offset:57344
    v_mfma_f32_16x16x32_bf16 v[28:31], v[60:63], v[84:87], v[28:31]
    ds_read_b64_tr_b16 v[50:51], v252 offset:59392
    v_mfma_f32_16x16x32_bf16 v[32:35], v[64:67], v[84:87], v[32:35]
    ds_read_b64_tr_b16 v[52:53], v253 offset:57344
    v_mfma_f32_16x16x32_bf16 v[36:39], v[68:71], v[84:87], v[36:39]
    ds_read_b64_tr_b16 v[54:55], v253 offset:59392
    s_waitcnt vmcnt(2)
    s_waitcnt lgkmcnt(0)
    v_mfma_f32_16x16x32_bf16 v[8:11], v[40:43], v[88:91], v[8:11]
    ds_read_b64_tr_b16 v[56:57], v250 offset:61440
    v_mfma_f32_16x16x32_bf16 v[12:15], v[44:47], v[88:91], v[12:15]
    ds_read_b64_tr_b16 v[58:59], v250 offset:63488
    v_mfma_f32_16x16x32_bf16 v[16:19], v[48:51], v[88:91], v[16:19]
    ds_read_b64_tr_b16 v[60:61], v251 offset:61440
    v_mfma_f32_16x16x32_bf16 v[20:23], v[52:55], v[88:91], v[20:23]
    ds_read_b64_tr_b16 v[62:63], v251 offset:63488
    v_mfma_f32_16x16x32_bf16 v[24:27], v[40:43], v[92:95], v[24:27]
    ds_read_b64_tr_b16 v[64:65], v252 offset:61440
    v_mfma_f32_16x16x32_bf16 v[28:31], v[44:47], v[92:95], v[28:31]
    ds_read_b64_tr_b16 v[66:67], v252 offset:63488
    v_mfma_f32_16x16x32_bf16 v[32:35], v[48:51], v[92:95], v[32:35]
    ds_read_b64_tr_b16 v[68:69], v253 offset:61440
    v_mfma_f32_16x16x32_bf16 v[36:39], v[52:55], v[92:95], v[36:39]
    ds_read_b64_tr_b16 v[70:71], v253 offset:63488
    s_waitcnt vmcnt(0)
    s_waitcnt lgkmcnt(0)
    v_mfma_f32_16x16x32_bf16 v[8:11], v[56:59], v[96:99], v[8:11]
    v_mfma_f32_16x16x32_bf16 v[12:15], v[60:63], v[96:99], v[12:15]
    v_mfma_f32_16x16x32_bf16 v[16:19], v[64:67], v[96:99], v[16:19]
    v_mfma_f32_16x16x32_bf16 v[20:23], v[68:71], v[96:99], v[20:23]
    v_mfma_f32_16x16x32_bf16 v[24:27], v[56:59], v[100:103], v[24:27]
    v_mfma_f32_16x16x32_bf16 v[28:31], v[60:63], v[100:103], v[28:31]
    v_mfma_f32_16x16x32_bf16 v[32:35], v[64:67], v[100:103], v[32:35]
    v_mfma_f32_16x16x32_bf16 v[36:39], v[68:71], v[100:103], v[36:39]
    s_nop 0
    v_cvt_pk_bf16_f32 v72, v8, v9
    v_cvt_pk_bf16_f32 v73, v10, v11
    ds_write_b64 v240, v[72:73] offset:0
    v_cvt_pk_bf16_f32 v74, v12, v13
    v_cvt_pk_bf16_f32 v75, v14, v15
    ds_write_b64 v240, v[74:75] offset:32
    v_cvt_pk_bf16_f32 v76, v16, v17
    v_cvt_pk_bf16_f32 v77, v18, v19
    ds_write_b64 v240, v[76:77] offset:64
    v_cvt_pk_bf16_f32 v78, v20, v21
    v_cvt_pk_bf16_f32 v79, v22, v23
    ds_write_b64 v240, v[78:79] offset:96
    v_cvt_pk_bf16_f32 v80, v24, v25
    v_cvt_pk_bf16_f32 v81, v26, v27
    ds_write_b64 v240, v[80:81] offset:2304
    v_cvt_pk_bf16_f32 v82, v28, v29
    v_cvt_pk_bf16_f32 v83, v30, v31
    ds_write_b64 v240, v[82:83] offset:2336
    v_cvt_pk_bf16_f32 v84, v32, v33
    v_cvt_pk_bf16_f32 v85, v34, v35
    ds_write_b64 v240, v[84:85] offset:2368
    v_cvt_pk_bf16_f32 v86, v36, v37
    v_cvt_pk_bf16_f32 v87, v38, v39
    ds_write_b64 v240, v[86:87] offset:2400
    s_waitcnt lgkmcnt(0)
    s_barrier
    s_endpgm
.p2align 8
L_code_end:
.fill 3072, 4, 0xbf800000
.section .rodata,"a"
.p2align 6
.amdhsa_kernel recurrent_scan__linear_kernel_hedgehog__moe_arch_mod__prompt_kernel
  .amdhsa_next_free_vgpr 256
  .amdhsa_next_free_sgpr 102
  .amdhsa_accum_offset 256
  .amdhsa_group_segment_fixed_size 0
  .amdhsa_kernarg_size 96
  .amdhsa_user_sgpr_count 2
  .amdhsa_user_sgpr_kernarg_segment_ptr 1
  .amdhsa_system_sgpr_workgroup_id_x 1
.end_amdhsa_kernel
```
